```python
import torch

def _softmax(x, axis=-1):
    return torch.softmax(x, dim=axis)

def _gelu(x):
    return torch.nn.functional.gelu(x, approximate='tanh')

def _silu(x):
    return torch.nn.functional.silu(x)

def _sigmoid(x):
    return torch.sigmoid(x)

def _layernorm(x, axis=-1, eps=1e-05):
    m = x.mean(dim=axis, keepdim=True)
    v = x.var(dim=axis, keepdim=True, unbiased=False)
    return (x - m) / torch.sqrt(v + eps)

def _scatter_add(tgt, idx, src, axis=0):
    return tgt.clone().index_add_(axis, idx, src)

def _segment_sum(src, seg, n):
    out = torch.zeros((n,) + src.shape[1:], dtype=src.dtype)
    return out.index_add_(0, seg, src)

def _pad(x, pw):
    flat = tuple((v for pair in reversed(pw) for v in pair))
    return torch.nn.functional.pad(x, flat)
kernel_name = 'sequential_preLN__memory_aug_recurrent_mem_tr__dense_activation_gelu__prompt'

def setup_inputs():

    _w = lambda a: (lambda t: t.to(torch.bfloat16) if t.is_floating_point() else t)(torch.as_tensor(a))

    def _A_setup():
        B, S, Dm = (1, 2048, 448)
        H, Dh = (16, 256)
        M, seg = (8, 32)
        seg = min(seg, S)
        S = S // seg * seg
        return {'x': _w((lambda *s: torch.randn(*s, dtype=torch.bfloat16) * 0.05)(B, S, Dm)), 'mem0': _w((lambda *s: torch.randn(*s, dtype=torch.bfloat16) * 0.2)(B, M, Dm)), 'Wq': _w((lambda *s: torch.randn(*s, dtype=torch.bfloat16) * 1.6)(Dm, H, Dh) * Dm ** (-0.5)), 'Wk': _w((lambda *s: torch.randn(*s, dtype=torch.bfloat16) * 1.6)(Dm, H, Dh) * Dm ** (-0.5)), 'Wv': _w((lambda *s: torch.randn(*s, dtype=torch.bfloat16) * 0.2)(Dm, H, Dh) * Dm ** (-0.5)), 'Wo': _w((lambda *s: torch.randn(*s, dtype=torch.bfloat16) * 0.2)(H, Dh, Dm) * (H * Dh) ** (-0.5)), 'seg_len': seg}
    _A_in = _A_setup()

    def _B_setup():
        B, S, D, F = (1, 2048, 448, 1792)
        return {'x': _w((lambda *s: torch.randn(*s, dtype=torch.bfloat16) * 0.05)(B, S, D)), 'w1': _w((lambda *s: torch.randn(*s, dtype=torch.bfloat16) * 0.4)(D, F) * D ** (-0.5)), 'b1': _w((lambda *s: torch.randn(*s, dtype=torch.bfloat16) * 12.8)(F) * 0.01), 'w2': _w((lambda *s: torch.randn(*s, dtype=torch.bfloat16) * 0.2)(F, D) * F ** (-0.5)), 'b2': _w((lambda *s: torch.randn(*s, dtype=torch.bfloat16) * 1.6)(D) * 0.01)}
    _B_in = _B_setup()
    return {'A_x': _A_in['x'], 'A_mem0': _A_in['mem0'], 'A_Wq': _A_in['Wq'], 'A_Wk': _A_in['Wk'], 'A_Wv': _A_in['Wv'], 'A_Wo': _A_in['Wo'], 'A_seg_len': _A_in['seg_len'], 'B_x': _B_in['x'], 'B_w1': _B_in['w1'], 'B_b1': _B_in['b1'], 'B_w2': _B_in['w2'], 'B_b2': _B_in['b2']}

def reference(A_x, A_mem0, A_Wq, A_Wk, A_Wv, A_Wo, A_seg_len, B_x, B_w1, B_b1, B_w2, B_b2):

    def _A_ref(x, mem0, Wq, Wk, Wv, Wo, seg_len):
        B, S, Dm = x.shape
        H, Dh = (Wq.shape[1], Wq.shape[2])
        M = mem0.shape[1]
        scale = Dh ** (-0.5)
        n_seg = S // seg_len
        L = M + seg_len
        idx = torch.arange(L)
        mask = (idx[:, None] < M) | (idx[:, None] >= idx[None, :])
        mem = mem0
        outs = []
        for s in range(n_seg):
            xs = x[:, s * seg_len:(s + 1) * seg_len, :].clone()
            h = torch.concatenate([mem, xs], axis=1)
            q = torch.einsum('btd,dhe->bhte', h, Wq)
            k = torch.einsum('btd,dhe->bhte', h, Wk)
            v = torch.einsum('btd,dhe->bhte', h, Wv)
            scores = torch.einsum('bhqe,bhke->bhqk', q, k) * scale
            scores = torch.where(mask[None, None], scores, -1000000000.0)
            p = _softmax(scores, axis=-1)
            o = torch.einsum('bhqk,bhke->bhqe', p, v)
            o = torch.einsum('bhte,hed->btd', o, Wo)
            mem = o[:, :M, :].clone()
            outs.append(o[:, M:, :])
        return torch.concatenate(outs, axis=1)

    def _B_ref(x, w1, b1, w2, b2):
        h = torch.einsum('bsd,df->bsf', x, w1) + b1
        h = _gelu(h)
        return torch.einsum('bsf,fd->bsd', h, w2) + b2
    x = A_x
    h = x + _A_ref(_layernorm(x, axis=-1), A_mem0, A_Wq, A_Wk, A_Wv, A_Wo, A_seg_len)
    h2 = h + _B_ref(_layernorm(h, axis=-1), B_w1, B_b1, B_w2, B_b2)
    return h2
```

```asm
; @launch grid=(256,1,1) block=(256,1,1) lds=163840
.amdgcn_target "amdgcn-amd-amdhsa--gfx950"
.text

.globl sequential_preLN__memory_aug_recurrent_mem_tr__dense_activation_gelu__prompt_kernel
.p2align 8
.type sequential_preLN__memory_aug_recurrent_mem_tr__dense_activation_gelu__prompt_kernel,@function
sequential_preLN__memory_aug_recurrent_mem_tr__dense_activation_gelu__prompt_kernel:
s_cmp_ge_u32 s2, 256
s_cbranch_scc0 MAIN_GO
s_endpgm
MAIN_GO:
s_load_dwordx2 s[4:5], s[0:1], 112
s_load_dwordx2 s[84:85], s[0:1], 104
v_lshrrev_b32 v1, 6, v0
v_and_b32 v0, 63, v0
v_readfirstlane_b32 s20, v1
s_mov_b32 s6, 268435456
s_mov_b32 s7, 0x00020000
s_mov_b32 s86, 256
s_mov_b32 s87, 0x00020000
s_mov_b32 s24, 0x200000
s_getpc_b64 s[90:91]
MAIN_PC:
s_lshr_b32 s40, s2, 3
s_lshl_b32 s40, s40, 2
s_add_u32 s40, s40, s20
s_and_b32 s40, s40, 31
s_lshl_b32 s40, s40, 13
v_lshl_add_u32 v2, v0, 7, s40
v_min_u32 v2, CODE_END-MAIN_PC-4, v2
global_load_dword v6, v2, s[90:91]
s_getreg_b32 s21, hwreg(HW_REG_XCC_ID, 0, 3)
s_cmp_lg_u32 s20, 0
s_cbranch_scc1 MAIN_TAGGED
s_and_b32 s40, s2, 7
s_lshl_b32 s40, s40, 2
s_or_b32 s41, s21, 8
s_lshl_b32 s40, s41, s40
v_mov_b32 v1, s40
s_lshr_b32 s40, s2, 3
s_lshl_b32 s40, s40, 2
s_waitcnt lgkmcnt(0)
s_mov_b64 exec, 1
buffer_atomic_or v1, off, s[84:87], s40 offset:128
s_mov_b64 exec, -1
s_cmp_lg_u32 s2, 0
s_cbranch_scc1 MAIN_TAGGED
s_memrealtime s[40:41]
s_waitcnt lgkmcnt(0)
s_bitset1_b32 s40, 0
v_mov_b32 v2, s40
buffer_store_dword v2, off, s[84:87], 0 sc1
MAIN_TAGGED:
v_lshlrev_b32 v1, 4, v0
s_and_b32 s26, s2, 7
s_lshr_b32 s27, s2, 3
s_mov_b32 s97, 0
s_cmp_eq_u32 s26, 0
s_cbranch_scc1 PRE_FIRST
s_lshl_b32 s26, s26, 5
s_add_u32 s27, s27, s26
s_sub_u32 s27, s27, 32
s_mul_i32 s26, s27, 9363
s_lshr_b32 s26, s26, 16
s_mul_i32 s40, s26, 7
s_sub_u32 s27, s27, s40
s_and_b32 s31, s26, 1
s_lshr_b32 s26, s26, 1
s_lshl_b32 s33, s26, 5
s_add_u32 s33, s33, s27
s_lshl_b32 s33, s33, 2
s_cmp_eq_u32 s31, 0
s_cbranch_scc1 ATASK
s_add_u32 s33, s33, 2048
s_load_dwordx2 s[8:9], s[0:1], 32
s_mov_b32 s10, 3670016
s_mov_b32 s11, 0x00020000
s_load_dwordx2 s[12:13], s[0:1], 40
s_mov_b32 s14, 3670016
s_mov_b32 s15, 0x00020000
v_lshrrev_b32 v3, 5, v0
v_and_b32 v4, 31, v0
v_add_u32 v2, 0, v3
v_xor_b32 v12, v4, v2
v_lshlrev_b32 v12, 4, v12
v_add_u32 v20, 0, v3
v_lshl_add_u32 v20, v20, 13, v12
v_add_u32 v2, 2, v3
v_xor_b32 v13, v4, v2
v_lshlrev_b32 v13, 4, v13
v_add_u32 v21, 8, v3
v_lshl_add_u32 v21, v21, 13, v13
v_add_u32 v2, 4, v3
v_xor_b32 v14, v4, v2
v_lshlrev_b32 v14, 4, v14
v_add_u32 v22, 4, v3
v_lshl_add_u32 v22, v22, 13, v14
v_add_u32 v2, 6, v3
v_xor_b32 v15, v4, v2
v_lshlrev_b32 v15, 4, v15
v_add_u32 v23, 12, v3
v_lshl_add_u32 v23, v23, 13, v15
v_add_u32 v2, 8, v3
v_xor_b32 v16, v4, v2
v_lshlrev_b32 v16, 4, v16
v_add_u32 v24, 16, v3
v_lshl_add_u32 v24, v24, 13, v16
v_add_u32 v2, 10, v3
v_xor_b32 v17, v4, v2
v_lshlrev_b32 v17, 4, v17
v_add_u32 v25, 24, v3
v_lshl_add_u32 v25, v25, 13, v17
v_add_u32 v2, 12, v3
v_xor_b32 v18, v4, v2
v_lshlrev_b32 v18, 4, v18
v_add_u32 v26, 20, v3
v_lshl_add_u32 v26, v26, 13, v18
v_add_u32 v2, 14, v3
v_xor_b32 v19, v4, v2
v_lshlrev_b32 v19, 4, v19
v_add_u32 v27, 28, v3
v_lshl_add_u32 v27, v27, 13, v19
s_lshl_b32 s28, s27, 19
s_lshl_b32 s40, s26, 9
s_add_u32 s28, s28, s40
s_lshr_b32 s40, s20, 1
s_lshl_b32 s40, s40, 18
s_add_u32 s28, s28, s40
s_and_b32 s40, s20, 1
s_lshl_b32 s40, s40, 14
s_add_u32 s28, s28, s40
s_lshl_b32 s32, s20, 13
s_waitcnt lgkmcnt(0)
s_add_u32 m0, s32, 0
s_nop 0
buffer_load_dwordx4 v20, s[8:11], s28 offen lds
s_add_u32 m0, s32, 1024
s_nop 0
buffer_load_dwordx4 v21, s[8:11], s28 offen lds
s_add_u32 m0, s32, 2048
s_nop 0
buffer_load_dwordx4 v22, s[8:11], s28 offen lds
s_add_u32 m0, s32, 3072
s_nop 0
buffer_load_dwordx4 v23, s[8:11], s28 offen lds
s_add_u32 m0, s32, 4096
s_nop 0
buffer_load_dwordx4 v24, s[8:11], s28 offen lds
s_add_u32 m0, s32, 5120
s_nop 0
buffer_load_dwordx4 v25, s[8:11], s28 offen lds
s_add_u32 m0, s32, 6144
s_nop 0
buffer_load_dwordx4 v26, s[8:11], s28 offen lds
s_add_u32 m0, s32, 7168
s_nop 0
buffer_load_dwordx4 v27, s[8:11], s28 offen lds
s_mov_b32 s40, 76695845
s_mul_i32 s41, s20, 448
v_add_u32 v2, s41, v0
s_add_u32 s41, s41, 64
v_mul_hi_u32 v12, v2, s40
v_mul_u32_u24 v4, 56, v12
v_sub_u32 v2, v2, v4
v_and_b32 v4, 2, v12
v_xor_b32 v2, v2, v4
v_bfe_u32 v4, v12, 3, 1
v_lshlrev_b32 v4, 2, v4
v_xor_b32 v2, v2, v4
v_mul_u32_u24 v12, 896, v12
v_lshl_add_u32 v12, v2, 4, v12
v_add_u32 v2, s41, v0
s_add_u32 s41, s41, 64
v_mul_hi_u32 v13, v2, s40
v_mul_u32_u24 v4, 56, v13
v_sub_u32 v2, v2, v4
v_and_b32 v4, 2, v13
v_xor_b32 v2, v2, v4
v_bfe_u32 v4, v13, 3, 1
v_lshlrev_b32 v4, 2, v4
v_xor_b32 v2, v2, v4
v_mul_u32_u24 v13, 896, v13
v_lshl_add_u32 v13, v2, 4, v13
v_add_u32 v2, s41, v0
s_add_u32 s41, s41, 64
v_mul_hi_u32 v14, v2, s40
v_mul_u32_u24 v4, 56, v14
v_sub_u32 v2, v2, v4
v_and_b32 v4, 2, v14
v_xor_b32 v2, v2, v4
v_bfe_u32 v4, v14, 3, 1
v_lshlrev_b32 v4, 2, v4
v_xor_b32 v2, v2, v4
v_mul_u32_u24 v14, 896, v14
v_lshl_add_u32 v14, v2, 4, v14
v_add_u32 v2, s41, v0
s_add_u32 s41, s41, 64
v_mul_hi_u32 v15, v2, s40
v_mul_u32_u24 v4, 56, v15
v_sub_u32 v2, v2, v4
v_and_b32 v4, 2, v15
v_xor_b32 v2, v2, v4
v_bfe_u32 v4, v15, 3, 1
v_lshlrev_b32 v4, 2, v4
v_xor_b32 v2, v2, v4
v_mul_u32_u24 v15, 896, v15
v_lshl_add_u32 v15, v2, 4, v15
v_add_u32 v2, s41, v0
s_add_u32 s41, s41, 64
v_mul_hi_u32 v16, v2, s40
v_mul_u32_u24 v4, 56, v16
v_sub_u32 v2, v2, v4
v_and_b32 v4, 2, v16
v_xor_b32 v2, v2, v4
v_bfe_u32 v4, v16, 3, 1
v_lshlrev_b32 v4, 2, v4
v_xor_b32 v2, v2, v4
v_mul_u32_u24 v16, 896, v16
v_lshl_add_u32 v16, v2, 4, v16
v_add_u32 v2, s41, v0
s_add_u32 s41, s41, 64
v_mul_hi_u32 v17, v2, s40
v_mul_u32_u24 v4, 56, v17
v_sub_u32 v2, v2, v4
v_and_b32 v4, 2, v17
v_xor_b32 v2, v2, v4
v_bfe_u32 v4, v17, 3, 1
v_lshlrev_b32 v4, 2, v4
v_xor_b32 v2, v2, v4
v_mul_u32_u24 v17, 896, v17
v_lshl_add_u32 v17, v2, 4, v17
v_add_u32 v2, s41, v0
s_add_u32 s41, s41, 64
v_mul_hi_u32 v18, v2, s40
v_mul_u32_u24 v4, 56, v18
v_sub_u32 v2, v2, v4
v_and_b32 v4, 2, v18
v_xor_b32 v2, v2, v4
v_bfe_u32 v4, v18, 3, 1
v_lshlrev_b32 v4, 2, v4
v_xor_b32 v2, v2, v4
v_mul_u32_u24 v18, 896, v18
v_lshl_add_u32 v18, v2, 4, v18
s_mul_i32 s32, s20, 7168
s_mul_i32 s29, s26, 229376
s_add_u32 m0, s32, 32768
s_nop 0
buffer_load_dwordx4 v12, s[12:15], s29 offen lds
s_add_u32 m0, s32, 33792
s_nop 0
buffer_load_dwordx4 v13, s[12:15], s29 offen lds
s_add_u32 m0, s32, 34816
s_nop 0
buffer_load_dwordx4 v14, s[12:15], s29 offen lds
s_add_u32 m0, s32, 35840
s_nop 0
buffer_load_dwordx4 v15, s[12:15], s29 offen lds
s_add_u32 m0, s32, 36864
s_nop 0
buffer_load_dwordx4 v16, s[12:15], s29 offen lds
s_add_u32 m0, s32, 37888
s_nop 0
buffer_load_dwordx4 v17, s[12:15], s29 offen lds
s_add_u32 m0, s32, 38912
s_nop 0
buffer_load_dwordx4 v18, s[12:15], s29 offen lds
s_add_u32 s29, s29, 28672
s_add_u32 m0, s32, 61440
s_nop 0
buffer_load_dwordx4 v12, s[12:15], s29 offen lds
s_add_u32 m0, s32, 62464
s_nop 0
buffer_load_dwordx4 v13, s[12:15], s29 offen lds
s_add_u32 m0, s32, 63488
s_nop 0
buffer_load_dwordx4 v14, s[12:15], s29 offen lds
s_add_u32 m0, s32, 64512
s_nop 0
buffer_load_dwordx4 v15, s[12:15], s29 offen lds
s_add_u32 m0, s32, 65536
s_nop 0
buffer_load_dwordx4 v16, s[12:15], s29 offen lds
s_add_u32 m0, s32, 66560
s_nop 0
buffer_load_dwordx4 v17, s[12:15], s29 offen lds
s_add_u32 m0, s32, 67584
s_nop 0
buffer_load_dwordx4 v18, s[12:15], s29 offen lds
s_add_u32 s29, s29, 28672
v_and_b32 v2, 15, v0
v_lshrrev_b32 v3, 4, v0
v_add_u32 v4, 0, v3
v_xor_b32 v4, v4, v2
v_lshlrev_b32 v4, 4, v4
v_lshl_add_u32 v8, v2, 9, v4
v_add_u32 v4, 4, v3
v_xor_b32 v4, v4, v2
v_lshlrev_b32 v4, 4, v4
v_lshl_add_u32 v9, v2, 9, v4
v_add_u32 v4, 8, v3
v_xor_b32 v4, v4, v2
v_lshlrev_b32 v4, 4, v4
v_lshl_add_u32 v10, v2, 9, v4
v_add_u32 v4, 12, v3
v_xor_b32 v4, v4, v2
v_lshlrev_b32 v4, 4, v4
v_lshl_add_u32 v11, v2, 9, v4
v_bfe_u32 v2, v0, 2, 2
v_lshl_add_u32 v2, v3, 3, v2
v_mul_u32_u24 v20, 896, v2
v_and_b32 v2, 3, v0
v_lshl_add_u32 v20, v2, 3, v20
v_bfe_u32 v2, v0, 3, 2
s_mul_i32 s40, s20, 7
s_add_u32 s40, s40, 0
v_xor_b32 v4, s40, v2
v_lshl_add_u32 v4, v4, 5, v20
v_mov_b32 v216, v4
v_add_u32 v220, 90112, v4
s_mul_i32 s40, s20, 7
s_add_u32 s40, s40, 1
v_xor_b32 v4, s40, v2
v_lshl_add_u32 v4, v4, 5, v20
v_mov_b32 v217, v4
v_add_u32 v221, 90112, v4
s_mul_i32 s40, s20, 7
s_add_u32 s40, s40, 2
v_xor_b32 v4, s40, v2
v_lshl_add_u32 v4, v4, 5, v20
v_mov_b32 v218, v4
v_add_u32 v222, 90112, v4
s_mul_i32 s40, s20, 7
s_add_u32 s40, s40, 3
v_xor_b32 v4, s40, v2
v_lshl_add_u32 v4, v4, 5, v20
v_mov_b32 v219, v4
v_add_u32 v223, 90112, v4
s_lshr_b32 s30, s26, 2
s_mul_i32 s30, s30, 114688
s_and_b32 s40, s26, 3
s_mul_i32 s40, s40, 28672
s_add_u32 s30, s30, s40
s_lshl_b32 s40, s27, 11
s_add_u32 s30, s30, s40
s_add_u32 s30, s30, 16302080
s_waitcnt vmcnt(14)
s_barrier
ds_read_b128 a[0:3], v8
ds_read_b128 a[4:7], v8 offset:8192
ds_read_b128 a[8:11], v8 offset:16384
ds_read_b128 a[12:15], v8 offset:24576
ds_read_b128 a[16:19], v9
ds_read_b128 a[20:23], v9 offset:8192
ds_read_b128 a[24:27], v9 offset:16384
ds_read_b128 a[28:31], v9 offset:24576
s_waitcnt lgkmcnt(4)
ds_read_b128 a[32:35], v10
ds_read_b128 a[36:39], v10 offset:8192
ds_read_b128 a[40:43], v10 offset:16384
ds_read_b128 a[44:47], v10 offset:24576
ds_read_b128 a[48:51], v11
ds_read_b128 a[52:55], v11 offset:8192
ds_read_b128 a[56:59], v11 offset:16384
ds_read_b128 a[60:63], v11 offset:24576
s_waitcnt lgkmcnt(4)
ds_read_b128 a[64:67], v8 offset:256
ds_read_b128 a[68:71], v8 offset:8448
ds_read_b128 a[72:75], v8 offset:16640
ds_read_b128 a[76:79], v8 offset:24832
ds_read_b128 a[80:83], v9 offset:256
ds_read_b128 a[84:87], v9 offset:8448
ds_read_b128 a[88:91], v9 offset:16640
ds_read_b128 a[92:95], v9 offset:24832
s_waitcnt lgkmcnt(4)
ds_read_b128 a[96:99], v10 offset:256
ds_read_b128 a[100:103], v10 offset:8448
ds_read_b128 a[104:107], v10 offset:16640
ds_read_b128 a[108:111], v10 offset:24832
ds_read_b128 a[112:115], v11 offset:256
ds_read_b128 a[116:119], v11 offset:8448
ds_read_b128 a[120:123], v11 offset:16640
ds_read_b128 a[124:127], v11 offset:24832
s_waitcnt lgkmcnt(4)
s_waitcnt vmcnt(7)
s_waitcnt lgkmcnt(0)
s_barrier
ds_read_b64_tr_b16 v[144:145], v216 offset:32768
ds_read_b64_tr_b16 v[146:147], v216 offset:36352
ds_read_b64_tr_b16 v[148:149], v217 offset:32768
ds_read_b64_tr_b16 v[150:151], v217 offset:36352
ds_read_b64_tr_b16 v[152:153], v218 offset:32768
ds_read_b64_tr_b16 v[154:155], v218 offset:36352
s_waitcnt lgkmcnt(4)
v_mfma_f32_16x16x32_bf16 v[32:35], a[0:3], v[144:147], 0
ds_read_b64_tr_b16 v[156:157], v219 offset:32768
ds_read_b64_tr_b16 v[158:159], v219 offset:36352
v_mfma_f32_16x16x32_bf16 v[36:39], a[4:7], v[144:147], 0
v_mfma_f32_16x16x32_bf16 v[40:43], a[8:11], v[144:147], 0
s_add_u32 m0, s32, 90112
s_nop 0
buffer_load_dwordx4 v12, s[12:15], s29 offen lds
v_mfma_f32_16x16x32_bf16 v[44:47], a[12:15], v[144:147], 0
s_waitcnt lgkmcnt(4)
v_mfma_f32_16x16x32_bf16 v[48:51], a[0:3], v[148:151], 0
ds_read_b64_tr_b16 v[144:145], v216 offset:32896
ds_read_b64_tr_b16 v[146:147], v216 offset:36480
v_mfma_f32_16x16x32_bf16 v[52:55], a[4:7], v[148:151], 0
v_mfma_f32_16x16x32_bf16 v[56:59], a[8:11], v[148:151], 0
s_add_u32 m0, s32, 91136
s_nop 0
buffer_load_dwordx4 v13, s[12:15], s29 offen lds
v_mfma_f32_16x16x32_bf16 v[60:63], a[12:15], v[148:151], 0
s_waitcnt lgkmcnt(4)
v_mfma_f32_16x16x32_bf16 v[64:67], a[0:3], v[152:155], 0
ds_read_b64_tr_b16 v[148:149], v217 offset:32896
ds_read_b64_tr_b16 v[150:151], v217 offset:36480
v_mfma_f32_16x16x32_bf16 v[68:71], a[4:7], v[152:155], 0
v_mfma_f32_16x16x32_bf16 v[72:75], a[8:11], v[152:155], 0
s_add_u32 m0, s32, 92160
s_nop 0
buffer_load_dwordx4 v14, s[12:15], s29 offen lds
v_mfma_f32_16x16x32_bf16 v[76:79], a[12:15], v[152:155], 0
s_waitcnt lgkmcnt(4)
v_mfma_f32_16x16x32_bf16 v[80:83], a[0:3], v[156:159], 0
ds_read_b64_tr_b16 v[152:153], v218 offset:32896
ds_read_b64_tr_b16 v[154:155], v218 offset:36480
v_mfma_f32_16x16x32_bf16 v[84:87], a[4:7], v[156:159], 0
v_mfma_f32_16x16x32_bf16 v[88:91], a[8:11], v[156:159], 0
s_add_u32 m0, s32, 93184
s_nop 0
buffer_load_dwordx4 v15, s[12:15], s29 offen lds
v_mfma_f32_16x16x32_bf16 v[92:95], a[12:15], v[156:159], 0
s_waitcnt lgkmcnt(4)
v_mfma_f32_16x16x32_bf16 v[96:99], a[0:3], v[144:147], 0
v_mfma_f32_16x16x32_bf16 v[100:103], a[4:7], v[144:147], 0
v_mfma_f32_16x16x32_bf16 v[104:107], a[8:11], v[144:147], 0
s_add_u32 m0, s32, 94208
s_nop 0
buffer_load_dwordx4 v16, s[12:15], s29 offen lds
v_mfma_f32_16x16x32_bf16 v[108:111], a[12:15], v[144:147], 0
s_waitcnt lgkmcnt(2)
v_mfma_f32_16x16x32_bf16 v[112:115], a[0:3], v[148:151], 0
v_mfma_f32_16x16x32_bf16 v[116:119], a[4:7], v[148:151], 0
v_mfma_f32_16x16x32_bf16 v[120:123], a[8:11], v[148:151], 0
s_add_u32 m0, s32, 95232
s_nop 0
buffer_load_dwordx4 v17, s[12:15], s29 offen lds
v_mfma_f32_16x16x32_bf16 v[124:127], a[12:15], v[148:151], 0
s_waitcnt lgkmcnt(0)
v_mfma_f32_16x16x32_bf16 v[128:131], a[0:3], v[152:155], 0
v_mfma_f32_16x16x32_bf16 v[132:135], a[4:7], v[152:155], 0
v_mfma_f32_16x16x32_bf16 v[136:139], a[8:11], v[152:155], 0
s_add_u32 m0, s32, 96256
s_nop 0
buffer_load_dwordx4 v18, s[12:15], s29 offen lds
s_add_u32 s29, s29, 28672
v_mfma_f32_16x16x32_bf16 v[140:143], a[12:15], v[152:155], 0
s_waitcnt vmcnt(7)
s_waitcnt lgkmcnt(0)
s_barrier
ds_read_b64_tr_b16 v[156:157], v216 offset:61440
ds_read_b64_tr_b16 v[158:159], v216 offset:65024
ds_read_b64_tr_b16 v[144:145], v217 offset:61440
ds_read_b64_tr_b16 v[146:147], v217 offset:65024
ds_read_b64_tr_b16 v[148:149], v218 offset:61440
ds_read_b64_tr_b16 v[150:151], v218 offset:65024
s_waitcnt lgkmcnt(4)
v_mfma_f32_16x16x32_bf16 v[32:35], a[16:19], v[156:159], v[32:35]
ds_read_b64_tr_b16 v[152:153], v219 offset:61440
ds_read_b64_tr_b16 v[154:155], v219 offset:65024
v_mfma_f32_16x16x32_bf16 v[36:39], a[20:23], v[156:159], v[36:39]
v_mfma_f32_16x16x32_bf16 v[40:43], a[24:27], v[156:159], v[40:43]
s_add_u32 m0, s32, 118784
s_nop 0
buffer_load_dwordx4 v12, s[12:15], s29 offen lds
v_mfma_f32_16x16x32_bf16 v[44:47], a[28:31], v[156:159], v[44:47]
s_waitcnt lgkmcnt(4)
v_mfma_f32_16x16x32_bf16 v[48:51], a[16:19], v[144:147], v[48:51]
ds_read_b64_tr_b16 v[156:157], v216 offset:61568
ds_read_b64_tr_b16 v[158:159], v216 offset:65152
v_mfma_f32_16x16x32_bf16 v[52:55], a[20:23], v[144:147], v[52:55]
v_mfma_f32_16x16x32_bf16 v[56:59], a[24:27], v[144:147], v[56:59]
s_add_u32 m0, s32, 119808
s_nop 0
buffer_load_dwordx4 v13, s[12:15], s29 offen lds
v_mfma_f32_16x16x32_bf16 v[60:63], a[28:31], v[144:147], v[60:63]
s_waitcnt lgkmcnt(4)
v_mfma_f32_16x16x32_bf16 v[64:67], a[16:19], v[148:151], v[64:67]
ds_read_b64_tr_b16 v[144:145], v217 offset:61568
ds_read_b64_tr_b16 v[146:147], v217 offset:65152
v_mfma_f32_16x16x32_bf16 v[68:71], a[20:23], v[148:151], v[68:71]
v_mfma_f32_16x16x32_bf16 v[72:75], a[24:27], v[148:151], v[72:75]
s_add_u32 m0, s32, 120832
s_nop 0
buffer_load_dwordx4 v14, s[12:15], s29 offen lds
v_mfma_f32_16x16x32_bf16 v[76:79], a[28:31], v[148:151], v[76:79]
s_waitcnt lgkmcnt(4)
v_mfma_f32_16x16x32_bf16 v[80:83], a[16:19], v[152:155], v[80:83]
ds_read_b64_tr_b16 v[148:149], v218 offset:61568
ds_read_b64_tr_b16 v[150:151], v218 offset:65152
v_mfma_f32_16x16x32_bf16 v[84:87], a[20:23], v[152:155], v[84:87]
v_mfma_f32_16x16x32_bf16 v[88:91], a[24:27], v[152:155], v[88:91]
s_add_u32 m0, s32, 121856
s_nop 0
buffer_load_dwordx4 v15, s[12:15], s29 offen lds
v_mfma_f32_16x16x32_bf16 v[92:95], a[28:31], v[152:155], v[92:95]
s_waitcnt lgkmcnt(4)
v_mfma_f32_16x16x32_bf16 v[96:99], a[16:19], v[156:159], v[96:99]
v_mfma_f32_16x16x32_bf16 v[100:103], a[20:23], v[156:159], v[100:103]
v_mfma_f32_16x16x32_bf16 v[104:107], a[24:27], v[156:159], v[104:107]
s_add_u32 m0, s32, 122880
s_nop 0
buffer_load_dwordx4 v16, s[12:15], s29 offen lds
v_mfma_f32_16x16x32_bf16 v[108:111], a[28:31], v[156:159], v[108:111]
s_waitcnt lgkmcnt(2)
v_mfma_f32_16x16x32_bf16 v[112:115], a[16:19], v[144:147], v[112:115]
v_mfma_f32_16x16x32_bf16 v[116:119], a[20:23], v[144:147], v[116:119]
v_mfma_f32_16x16x32_bf16 v[120:123], a[24:27], v[144:147], v[120:123]
s_add_u32 m0, s32, 123904
s_nop 0
buffer_load_dwordx4 v17, s[12:15], s29 offen lds
v_mfma_f32_16x16x32_bf16 v[124:127], a[28:31], v[144:147], v[124:127]
s_waitcnt lgkmcnt(0)
v_mfma_f32_16x16x32_bf16 v[128:131], a[16:19], v[148:151], v[128:131]
v_mfma_f32_16x16x32_bf16 v[132:135], a[20:23], v[148:151], v[132:135]
v_mfma_f32_16x16x32_bf16 v[136:139], a[24:27], v[148:151], v[136:139]
s_add_u32 m0, s32, 124928
s_nop 0
buffer_load_dwordx4 v18, s[12:15], s29 offen lds
s_add_u32 s29, s29, 28672
v_mfma_f32_16x16x32_bf16 v[140:143], a[28:31], v[148:151], v[140:143]
s_waitcnt vmcnt(7)
s_waitcnt lgkmcnt(0)
s_barrier
ds_read_b64_tr_b16 v[152:153], v220
ds_read_b64_tr_b16 v[154:155], v220 offset:3584
ds_read_b64_tr_b16 v[156:157], v221
ds_read_b64_tr_b16 v[158:159], v221 offset:3584
ds_read_b64_tr_b16 v[144:145], v222
ds_read_b64_tr_b16 v[146:147], v222 offset:3584
s_waitcnt lgkmcnt(4)
v_mfma_f32_16x16x32_bf16 v[32:35], a[32:35], v[152:155], v[32:35]
ds_read_b64_tr_b16 v[148:149], v223
ds_read_b64_tr_b16 v[150:151], v223 offset:3584
v_mfma_f32_16x16x32_bf16 v[36:39], a[36:39], v[152:155], v[36:39]
v_mfma_f32_16x16x32_bf16 v[40:43], a[40:43], v[152:155], v[40:43]
s_add_u32 m0, s32, 0
s_nop 0
buffer_load_dwordx4 v12, s[12:15], s29 offen lds
v_mfma_f32_16x16x32_bf16 v[44:47], a[44:47], v[152:155], v[44:47]
s_waitcnt lgkmcnt(4)
v_mfma_f32_16x16x32_bf16 v[48:51], a[32:35], v[156:159], v[48:51]
ds_read_b64_tr_b16 v[152:153], v220 offset:128
ds_read_b64_tr_b16 v[154:155], v220 offset:3712
v_mfma_f32_16x16x32_bf16 v[52:55], a[36:39], v[156:159], v[52:55]
v_mfma_f32_16x16x32_bf16 v[56:59], a[40:43], v[156:159], v[56:59]
s_add_u32 m0, s32, 1024
s_nop 0
buffer_load_dwordx4 v13, s[12:15], s29 offen lds
v_mfma_f32_16x16x32_bf16 v[60:63], a[44:47], v[156:159], v[60:63]
s_waitcnt lgkmcnt(4)
v_mfma_f32_16x16x32_bf16 v[64:67], a[32:35], v[144:147], v[64:67]
ds_read_b64_tr_b16 v[156:157], v221 offset:128
ds_read_b64_tr_b16 v[158:159], v221 offset:3712
v_mfma_f32_16x16x32_bf16 v[68:71], a[36:39], v[144:147], v[68:71]
v_mfma_f32_16x16x32_bf16 v[72:75], a[40:43], v[144:147], v[72:75]
s_add_u32 m0, s32, 2048
s_nop 0
buffer_load_dwordx4 v14, s[12:15], s29 offen lds
v_mfma_f32_16x16x32_bf16 v[76:79], a[44:47], v[144:147], v[76:79]
s_waitcnt lgkmcnt(4)
v_mfma_f32_16x16x32_bf16 v[80:83], a[32:35], v[148:151], v[80:83]
ds_read_b64_tr_b16 v[144:145], v222 offset:128
ds_read_b64_tr_b16 v[146:147], v222 offset:3712
v_mfma_f32_16x16x32_bf16 v[84:87], a[36:39], v[148:151], v[84:87]
v_mfma_f32_16x16x32_bf16 v[88:91], a[40:43], v[148:151], v[88:91]
s_add_u32 m0, s32, 3072
s_nop 0
buffer_load_dwordx4 v15, s[12:15], s29 offen lds
v_mfma_f32_16x16x32_bf16 v[92:95], a[44:47], v[148:151], v[92:95]
s_waitcnt lgkmcnt(4)
v_mfma_f32_16x16x32_bf16 v[96:99], a[32:35], v[152:155], v[96:99]
v_mfma_f32_16x16x32_bf16 v[100:103], a[36:39], v[152:155], v[100:103]
v_mfma_f32_16x16x32_bf16 v[104:107], a[40:43], v[152:155], v[104:107]
s_add_u32 m0, s32, 4096
s_nop 0
buffer_load_dwordx4 v16, s[12:15], s29 offen lds
v_mfma_f32_16x16x32_bf16 v[108:111], a[44:47], v[152:155], v[108:111]
s_waitcnt lgkmcnt(2)
v_mfma_f32_16x16x32_bf16 v[112:115], a[32:35], v[156:159], v[112:115]
v_mfma_f32_16x16x32_bf16 v[116:119], a[36:39], v[156:159], v[116:119]
v_mfma_f32_16x16x32_bf16 v[120:123], a[40:43], v[156:159], v[120:123]
s_add_u32 m0, s32, 5120
s_nop 0
buffer_load_dwordx4 v17, s[12:15], s29 offen lds
v_mfma_f32_16x16x32_bf16 v[124:127], a[44:47], v[156:159], v[124:127]
s_waitcnt lgkmcnt(0)
v_mfma_f32_16x16x32_bf16 v[128:131], a[32:35], v[144:147], v[128:131]
v_mfma_f32_16x16x32_bf16 v[132:135], a[36:39], v[144:147], v[132:135]
v_mfma_f32_16x16x32_bf16 v[136:139], a[40:43], v[144:147], v[136:139]
s_add_u32 m0, s32, 6144
s_nop 0
buffer_load_dwordx4 v18, s[12:15], s29 offen lds
s_add_u32 s29, s29, 28672
v_mfma_f32_16x16x32_bf16 v[140:143], a[44:47], v[144:147], v[140:143]
s_waitcnt vmcnt(7)
s_waitcnt lgkmcnt(0)
s_barrier
ds_read_b64_tr_b16 v[148:149], v220 offset:28672
ds_read_b64_tr_b16 v[150:151], v220 offset:32256
ds_read_b64_tr_b16 v[152:153], v221 offset:28672
ds_read_b64_tr_b16 v[154:155], v221 offset:32256
ds_read_b64_tr_b16 v[156:157], v222 offset:28672
ds_read_b64_tr_b16 v[158:159], v222 offset:32256
s_waitcnt lgkmcnt(4)
v_mfma_f32_16x16x32_bf16 v[32:35], a[48:51], v[148:151], v[32:35]
ds_read_b64_tr_b16 v[144:145], v223 offset:28672
ds_read_b64_tr_b16 v[146:147], v223 offset:32256
v_mfma_f32_16x16x32_bf16 v[36:39], a[52:55], v[148:151], v[36:39]
v_mfma_f32_16x16x32_bf16 v[40:43], a[56:59], v[148:151], v[40:43]
s_add_u32 m0, s32, 32768
s_nop 0
buffer_load_dwordx4 v12, s[12:15], s29 offen lds
v_mfma_f32_16x16x32_bf16 v[44:47], a[60:63], v[148:151], v[44:47]
s_waitcnt lgkmcnt(4)
v_mfma_f32_16x16x32_bf16 v[48:51], a[48:51], v[152:155], v[48:51]
ds_read_b64_tr_b16 v[148:149], v220 offset:28800
ds_read_b64_tr_b16 v[150:151], v220 offset:32384
v_mfma_f32_16x16x32_bf16 v[52:55], a[52:55], v[152:155], v[52:55]
v_mfma_f32_16x16x32_bf16 v[56:59], a[56:59], v[152:155], v[56:59]
s_add_u32 m0, s32, 33792
s_nop 0
buffer_load_dwordx4 v13, s[12:15], s29 offen lds
v_mfma_f32_16x16x32_bf16 v[60:63], a[60:63], v[152:155], v[60:63]
s_waitcnt lgkmcnt(4)
v_mfma_f32_16x16x32_bf16 v[64:67], a[48:51], v[156:159], v[64:67]
ds_read_b64_tr_b16 v[152:153], v221 offset:28800
ds_read_b64_tr_b16 v[154:155], v221 offset:32384
v_mfma_f32_16x16x32_bf16 v[68:71], a[52:55], v[156:159], v[68:71]
v_mfma_f32_16x16x32_bf16 v[72:75], a[56:59], v[156:159], v[72:75]
s_add_u32 m0, s32, 34816
s_nop 0
buffer_load_dwordx4 v14, s[12:15], s29 offen lds
v_mfma_f32_16x16x32_bf16 v[76:79], a[60:63], v[156:159], v[76:79]
s_waitcnt lgkmcnt(4)
v_mfma_f32_16x16x32_bf16 v[80:83], a[48:51], v[144:147], v[80:83]
ds_read_b64_tr_b16 v[156:157], v222 offset:28800
ds_read_b64_tr_b16 v[158:159], v222 offset:32384
v_mfma_f32_16x16x32_bf16 v[84:87], a[52:55], v[144:147], v[84:87]
v_mfma_f32_16x16x32_bf16 v[88:91], a[56:59], v[144:147], v[88:91]
s_add_u32 m0, s32, 35840
s_nop 0
buffer_load_dwordx4 v15, s[12:15], s29 offen lds
v_mfma_f32_16x16x32_bf16 v[92:95], a[60:63], v[144:147], v[92:95]
s_waitcnt lgkmcnt(4)
v_mfma_f32_16x16x32_bf16 v[96:99], a[48:51], v[148:151], v[96:99]
v_mfma_f32_16x16x32_bf16 v[100:103], a[52:55], v[148:151], v[100:103]
v_mfma_f32_16x16x32_bf16 v[104:107], a[56:59], v[148:151], v[104:107]
s_add_u32 m0, s32, 36864
s_nop 0
buffer_load_dwordx4 v16, s[12:15], s29 offen lds
v_mfma_f32_16x16x32_bf16 v[108:111], a[60:63], v[148:151], v[108:111]
s_waitcnt lgkmcnt(2)
v_mfma_f32_16x16x32_bf16 v[112:115], a[48:51], v[152:155], v[112:115]
v_mfma_f32_16x16x32_bf16 v[116:119], a[52:55], v[152:155], v[116:119]
v_mfma_f32_16x16x32_bf16 v[120:123], a[56:59], v[152:155], v[120:123]
s_add_u32 m0, s32, 37888
s_nop 0
buffer_load_dwordx4 v17, s[12:15], s29 offen lds
v_mfma_f32_16x16x32_bf16 v[124:127], a[60:63], v[152:155], v[124:127]
s_waitcnt lgkmcnt(0)
v_mfma_f32_16x16x32_bf16 v[128:131], a[48:51], v[156:159], v[128:131]
v_mfma_f32_16x16x32_bf16 v[132:135], a[52:55], v[156:159], v[132:135]
v_mfma_f32_16x16x32_bf16 v[136:139], a[56:59], v[156:159], v[136:139]
s_add_u32 m0, s32, 38912
s_nop 0
buffer_load_dwordx4 v18, s[12:15], s29 offen lds
s_add_u32 s29, s29, 28672
v_mfma_f32_16x16x32_bf16 v[140:143], a[60:63], v[156:159], v[140:143]
s_waitcnt vmcnt(7)
s_waitcnt lgkmcnt(0)
s_barrier
ds_read_b64_tr_b16 v[144:145], v216
ds_read_b64_tr_b16 v[146:147], v216 offset:3584
ds_read_b64_tr_b16 v[148:149], v217
ds_read_b64_tr_b16 v[150:151], v217 offset:3584
ds_read_b64_tr_b16 v[152:153], v218
ds_read_b64_tr_b16 v[154:155], v218 offset:3584
s_waitcnt lgkmcnt(4)
v_mfma_f32_16x16x32_bf16 v[32:35], a[64:67], v[144:147], v[32:35]
ds_read_b64_tr_b16 v[156:157], v219
ds_read_b64_tr_b16 v[158:159], v219 offset:3584
v_mfma_f32_16x16x32_bf16 v[36:39], a[68:71], v[144:147], v[36:39]
v_mfma_f32_16x16x32_bf16 v[40:43], a[72:75], v[144:147], v[40:43]
s_add_u32 m0, s32, 61440
s_nop 0
buffer_load_dwordx4 v12, s[12:15], s29 offen lds
v_mfma_f32_16x16x32_bf16 v[44:47], a[76:79], v[144:147], v[44:47]
s_waitcnt lgkmcnt(4)
v_mfma_f32_16x16x32_bf16 v[48:51], a[64:67], v[148:151], v[48:51]
ds_read_b64_tr_b16 v[144:145], v216 offset:128
ds_read_b64_tr_b16 v[146:147], v216 offset:3712
v_mfma_f32_16x16x32_bf16 v[52:55], a[68:71], v[148:151], v[52:55]
v_mfma_f32_16x16x32_bf16 v[56:59], a[72:75], v[148:151], v[56:59]
s_add_u32 m0, s32, 62464
s_nop 0
buffer_load_dwordx4 v13, s[12:15], s29 offen lds
v_mfma_f32_16x16x32_bf16 v[60:63], a[76:79], v[148:151], v[60:63]
s_waitcnt lgkmcnt(4)
v_mfma_f32_16x16x32_bf16 v[64:67], a[64:67], v[152:155], v[64:67]
ds_read_b64_tr_b16 v[148:149], v217 offset:128
ds_read_b64_tr_b16 v[150:151], v217 offset:3712
v_mfma_f32_16x16x32_bf16 v[68:71], a[68:71], v[152:155], v[68:71]
v_mfma_f32_16x16x32_bf16 v[72:75], a[72:75], v[152:155], v[72:75]
s_add_u32 m0, s32, 63488
s_nop 0
buffer_load_dwordx4 v14, s[12:15], s29 offen lds
v_mfma_f32_16x16x32_bf16 v[76:79], a[76:79], v[152:155], v[76:79]
s_waitcnt lgkmcnt(4)
v_mfma_f32_16x16x32_bf16 v[80:83], a[64:67], v[156:159], v[80:83]
ds_read_b64_tr_b16 v[152:153], v218 offset:128
ds_read_b64_tr_b16 v[154:155], v218 offset:3712
v_mfma_f32_16x16x32_bf16 v[84:87], a[68:71], v[156:159], v[84:87]
v_mfma_f32_16x16x32_bf16 v[88:91], a[72:75], v[156:159], v[88:91]
s_add_u32 m0, s32, 64512
s_nop 0
buffer_load_dwordx4 v15, s[12:15], s29 offen lds
v_mfma_f32_16x16x32_bf16 v[92:95], a[76:79], v[156:159], v[92:95]
s_waitcnt lgkmcnt(4)
v_mfma_f32_16x16x32_bf16 v[96:99], a[64:67], v[144:147], v[96:99]
v_mfma_f32_16x16x32_bf16 v[100:103], a[68:71], v[144:147], v[100:103]
v_mfma_f32_16x16x32_bf16 v[104:107], a[72:75], v[144:147], v[104:107]
s_add_u32 m0, s32, 65536
s_nop 0
buffer_load_dwordx4 v16, s[12:15], s29 offen lds
v_mfma_f32_16x16x32_bf16 v[108:111], a[76:79], v[144:147], v[108:111]
s_waitcnt lgkmcnt(2)
v_mfma_f32_16x16x32_bf16 v[112:115], a[64:67], v[148:151], v[112:115]
v_mfma_f32_16x16x32_bf16 v[116:119], a[68:71], v[148:151], v[116:119]
v_mfma_f32_16x16x32_bf16 v[120:123], a[72:75], v[148:151], v[120:123]
s_add_u32 m0, s32, 66560
s_nop 0
buffer_load_dwordx4 v17, s[12:15], s29 offen lds
v_mfma_f32_16x16x32_bf16 v[124:127], a[76:79], v[148:151], v[124:127]
s_waitcnt lgkmcnt(0)
v_mfma_f32_16x16x32_bf16 v[128:131], a[64:67], v[152:155], v[128:131]
v_mfma_f32_16x16x32_bf16 v[132:135], a[68:71], v[152:155], v[132:135]
v_mfma_f32_16x16x32_bf16 v[136:139], a[72:75], v[152:155], v[136:139]
s_add_u32 m0, s32, 67584
s_nop 0
buffer_load_dwordx4 v18, s[12:15], s29 offen lds
s_add_u32 s29, s29, 28672
v_mfma_f32_16x16x32_bf16 v[140:143], a[76:79], v[152:155], v[140:143]
s_waitcnt vmcnt(7)
s_waitcnt lgkmcnt(0)
s_barrier
ds_read_b64_tr_b16 v[156:157], v216 offset:32768
ds_read_b64_tr_b16 v[158:159], v216 offset:36352
ds_read_b64_tr_b16 v[144:145], v217 offset:32768
ds_read_b64_tr_b16 v[146:147], v217 offset:36352
ds_read_b64_tr_b16 v[148:149], v218 offset:32768
ds_read_b64_tr_b16 v[150:151], v218 offset:36352
s_waitcnt lgkmcnt(4)
v_mfma_f32_16x16x32_bf16 v[32:35], a[80:83], v[156:159], v[32:35]
ds_read_b64_tr_b16 v[152:153], v219 offset:32768
ds_read_b64_tr_b16 v[154:155], v219 offset:36352
v_mfma_f32_16x16x32_bf16 v[36:39], a[84:87], v[156:159], v[36:39]
v_mfma_f32_16x16x32_bf16 v[40:43], a[88:91], v[156:159], v[40:43]
s_add_u32 m0, s32, 90112
s_nop 0
buffer_load_dwordx4 v12, s[12:15], s29 offen lds
v_mfma_f32_16x16x32_bf16 v[44:47], a[92:95], v[156:159], v[44:47]
s_waitcnt lgkmcnt(4)
v_mfma_f32_16x16x32_bf16 v[48:51], a[80:83], v[144:147], v[48:51]
ds_read_b64_tr_b16 v[156:157], v216 offset:32896
ds_read_b64_tr_b16 v[158:159], v216 offset:36480
v_mfma_f32_16x16x32_bf16 v[52:55], a[84:87], v[144:147], v[52:55]
v_mfma_f32_16x16x32_bf16 v[56:59], a[88:91], v[144:147], v[56:59]
s_add_u32 m0, s32, 91136
s_nop 0
buffer_load_dwordx4 v13, s[12:15], s29 offen lds
v_mfma_f32_16x16x32_bf16 v[60:63], a[92:95], v[144:147], v[60:63]
s_waitcnt lgkmcnt(4)
v_mfma_f32_16x16x32_bf16 v[64:67], a[80:83], v[148:151], v[64:67]
ds_read_b64_tr_b16 v[144:145], v217 offset:32896
ds_read_b64_tr_b16 v[146:147], v217 offset:36480
v_mfma_f32_16x16x32_bf16 v[68:71], a[84:87], v[148:151], v[68:71]
v_mfma_f32_16x16x32_bf16 v[72:75], a[88:91], v[148:151], v[72:75]
s_add_u32 m0, s32, 92160
s_nop 0
buffer_load_dwordx4 v14, s[12:15], s29 offen lds
v_mfma_f32_16x16x32_bf16 v[76:79], a[92:95], v[148:151], v[76:79]
s_waitcnt lgkmcnt(4)
v_mfma_f32_16x16x32_bf16 v[80:83], a[80:83], v[152:155], v[80:83]
ds_read_b64_tr_b16 v[148:149], v218 offset:32896
ds_read_b64_tr_b16 v[150:151], v218 offset:36480
v_mfma_f32_16x16x32_bf16 v[84:87], a[84:87], v[152:155], v[84:87]
v_mfma_f32_16x16x32_bf16 v[88:91], a[88:91], v[152:155], v[88:91]
s_add_u32 m0, s32, 93184
s_nop 0
buffer_load_dwordx4 v15, s[12:15], s29 offen lds
v_mfma_f32_16x16x32_bf16 v[92:95], a[92:95], v[152:155], v[92:95]
s_waitcnt lgkmcnt(4)
v_mfma_f32_16x16x32_bf16 v[96:99], a[80:83], v[156:159], v[96:99]
v_mfma_f32_16x16x32_bf16 v[100:103], a[84:87], v[156:159], v[100:103]
v_mfma_f32_16x16x32_bf16 v[104:107], a[88:91], v[156:159], v[104:107]
s_add_u32 m0, s32, 94208
s_nop 0
buffer_load_dwordx4 v16, s[12:15], s29 offen lds
v_mfma_f32_16x16x32_bf16 v[108:111], a[92:95], v[156:159], v[108:111]
s_waitcnt lgkmcnt(2)
v_mfma_f32_16x16x32_bf16 v[112:115], a[80:83], v[144:147], v[112:115]
v_mfma_f32_16x16x32_bf16 v[116:119], a[84:87], v[144:147], v[116:119]
v_mfma_f32_16x16x32_bf16 v[120:123], a[88:91], v[144:147], v[120:123]
s_add_u32 m0, s32, 95232
s_nop 0
buffer_load_dwordx4 v17, s[12:15], s29 offen lds
v_mfma_f32_16x16x32_bf16 v[124:127], a[92:95], v[144:147], v[124:127]
s_waitcnt lgkmcnt(0)
v_mfma_f32_16x16x32_bf16 v[128:131], a[80:83], v[148:151], v[128:131]
v_mfma_f32_16x16x32_bf16 v[132:135], a[84:87], v[148:151], v[132:135]
v_mfma_f32_16x16x32_bf16 v[136:139], a[88:91], v[148:151], v[136:139]
s_add_u32 m0, s32, 96256
s_nop 0
buffer_load_dwordx4 v18, s[12:15], s29 offen lds
s_add_u32 s29, s29, 28672
v_mfma_f32_16x16x32_bf16 v[140:143], a[92:95], v[148:151], v[140:143]
s_waitcnt vmcnt(0)
s_waitcnt lgkmcnt(0)
s_barrier
ds_read_b64_tr_b16 v[152:153], v216 offset:61440
ds_read_b64_tr_b16 v[154:155], v216 offset:65024
ds_read_b64_tr_b16 v[156:157], v220
ds_read_b64_tr_b16 v[158:159], v220 offset:3584
ds_read_b64_tr_b16 v[144:145], v217 offset:61440
ds_read_b64_tr_b16 v[146:147], v217 offset:65024
s_waitcnt lgkmcnt(4)
v_mfma_f32_16x16x32_bf16 v[32:35], a[96:99], v[152:155], v[32:35]
ds_read_b64_tr_b16 v[148:149], v221
ds_read_b64_tr_b16 v[150:151], v221 offset:3584
v_mfma_f32_16x16x32_bf16 v[36:39], a[100:103], v[152:155], v[36:39]
v_mfma_f32_16x16x32_bf16 v[40:43], a[104:107], v[152:155], v[40:43]
v_mfma_f32_16x16x32_bf16 v[44:47], a[108:111], v[152:155], v[44:47]
s_waitcnt lgkmcnt(4)
v_mfma_f32_16x16x32_bf16 v[32:35], a[112:115], v[156:159], v[32:35]
ds_read_b64_tr_b16 v[152:153], v218 offset:61440
ds_read_b64_tr_b16 v[154:155], v218 offset:65024
v_mfma_f32_16x16x32_bf16 v[36:39], a[116:119], v[156:159], v[36:39]
v_mfma_f32_16x16x32_bf16 v[40:43], a[120:123], v[156:159], v[40:43]
v_mfma_f32_16x16x32_bf16 v[44:47], a[124:127], v[156:159], v[44:47]
s_waitcnt lgkmcnt(4)
v_mfma_f32_16x16x32_bf16 v[48:51], a[96:99], v[144:147], v[48:51]
ds_read_b64_tr_b16 v[156:157], v222
ds_read_b64_tr_b16 v[158:159], v222 offset:3584
v_mfma_f32_16x16x32_bf16 v[52:55], a[100:103], v[144:147], v[52:55]
v_mfma_f32_16x16x32_bf16 v[56:59], a[104:107], v[144:147], v[56:59]
v_mfma_f32_16x16x32_bf16 v[60:63], a[108:111], v[144:147], v[60:63]
s_mul_i32 s40, s20, 7
s_add_u32 s40, s40, 0
s_lshr_b32 s41, s40, 1
s_mul_i32 s41, s41, 458752
s_and_b32 s40, s40, 1
s_mul_i32 s40, s40, 14336
s_add_u32 s40, s40, s41
s_add_u32 s40, s40, s30
v_cvt_pk_bf16_f32 v160, v32, v33
v_cvt_pk_bf16_f32 v161, v34, v35
v_cvt_pk_bf16_f32 v162, v36, v37
v_cvt_pk_bf16_f32 v163, v38, v39
buffer_store_dwordx4 v[160:163], v1, s[4:7], s40 offen sc1
v_cvt_pk_bf16_f32 v164, v40, v41
v_cvt_pk_bf16_f32 v165, v42, v43
v_cvt_pk_bf16_f32 v166, v44, v45
v_cvt_pk_bf16_f32 v167, v46, v47
buffer_store_dwordx4 v[164:167], v1, s[4:7], s40 offen offset:1024 sc1
s_waitcnt lgkmcnt(4)
v_mfma_f32_16x16x32_bf16 v[48:51], a[112:115], v[148:151], v[48:51]
ds_read_b64_tr_b16 v[144:145], v219 offset:61440
ds_read_b64_tr_b16 v[146:147], v219 offset:65024
v_mfma_f32_16x16x32_bf16 v[52:55], a[116:119], v[148:151], v[52:55]
v_mfma_f32_16x16x32_bf16 v[56:59], a[120:123], v[148:151], v[56:59]
v_mfma_f32_16x16x32_bf16 v[60:63], a[124:127], v[148:151], v[60:63]
s_waitcnt lgkmcnt(4)
v_mfma_f32_16x16x32_bf16 v[64:67], a[96:99], v[152:155], v[64:67]
ds_read_b64_tr_b16 v[148:149], v223
ds_read_b64_tr_b16 v[150:151], v223 offset:3584
v_mfma_f32_16x16x32_bf16 v[68:71], a[100:103], v[152:155], v[68:71]
v_mfma_f32_16x16x32_bf16 v[72:75], a[104:107], v[152:155], v[72:75]
v_mfma_f32_16x16x32_bf16 v[76:79], a[108:111], v[152:155], v[76:79]
s_mul_i32 s40, s20, 7
s_add_u32 s40, s40, 1
s_lshr_b32 s41, s40, 1
s_mul_i32 s41, s41, 458752
s_and_b32 s40, s40, 1
s_mul_i32 s40, s40, 14336
s_add_u32 s40, s40, s41
s_add_u32 s40, s40, s30
v_cvt_pk_bf16_f32 v168, v48, v49
v_cvt_pk_bf16_f32 v169, v50, v51
v_cvt_pk_bf16_f32 v170, v52, v53
v_cvt_pk_bf16_f32 v171, v54, v55
buffer_store_dwordx4 v[168:171], v1, s[4:7], s40 offen sc1
v_cvt_pk_bf16_f32 v172, v56, v57
v_cvt_pk_bf16_f32 v173, v58, v59
v_cvt_pk_bf16_f32 v174, v60, v61
v_cvt_pk_bf16_f32 v175, v62, v63
buffer_store_dwordx4 v[172:175], v1, s[4:7], s40 offen offset:1024 sc1
s_waitcnt lgkmcnt(4)
v_mfma_f32_16x16x32_bf16 v[64:67], a[112:115], v[156:159], v[64:67]
ds_read_b64_tr_b16 v[152:153], v216 offset:61568
ds_read_b64_tr_b16 v[154:155], v216 offset:65152
v_mfma_f32_16x16x32_bf16 v[68:71], a[116:119], v[156:159], v[68:71]
v_mfma_f32_16x16x32_bf16 v[72:75], a[120:123], v[156:159], v[72:75]
v_mfma_f32_16x16x32_bf16 v[76:79], a[124:127], v[156:159], v[76:79]
s_waitcnt lgkmcnt(4)
v_mfma_f32_16x16x32_bf16 v[80:83], a[96:99], v[144:147], v[80:83]
ds_read_b64_tr_b16 v[156:157], v220 offset:128
ds_read_b64_tr_b16 v[158:159], v220 offset:3712
v_mfma_f32_16x16x32_bf16 v[84:87], a[100:103], v[144:147], v[84:87]
v_mfma_f32_16x16x32_bf16 v[88:91], a[104:107], v[144:147], v[88:91]
v_mfma_f32_16x16x32_bf16 v[92:95], a[108:111], v[144:147], v[92:95]
s_mul_i32 s40, s20, 7
s_add_u32 s40, s40, 2
s_lshr_b32 s41, s40, 1
s_mul_i32 s41, s41, 458752
s_and_b32 s40, s40, 1
s_mul_i32 s40, s40, 14336
s_add_u32 s40, s40, s41
s_add_u32 s40, s40, s30
v_cvt_pk_bf16_f32 v176, v64, v65
v_cvt_pk_bf16_f32 v177, v66, v67
v_cvt_pk_bf16_f32 v178, v68, v69
v_cvt_pk_bf16_f32 v179, v70, v71
buffer_store_dwordx4 v[176:179], v1, s[4:7], s40 offen sc1
v_cvt_pk_bf16_f32 v180, v72, v73
v_cvt_pk_bf16_f32 v181, v74, v75
v_cvt_pk_bf16_f32 v182, v76, v77
v_cvt_pk_bf16_f32 v183, v78, v79
buffer_store_dwordx4 v[180:183], v1, s[4:7], s40 offen offset:1024 sc1
s_waitcnt lgkmcnt(4)
v_mfma_f32_16x16x32_bf16 v[80:83], a[112:115], v[148:151], v[80:83]
ds_read_b64_tr_b16 v[144:145], v217 offset:61568
ds_read_b64_tr_b16 v[146:147], v217 offset:65152
v_mfma_f32_16x16x32_bf16 v[84:87], a[116:119], v[148:151], v[84:87]
v_mfma_f32_16x16x32_bf16 v[88:91], a[120:123], v[148:151], v[88:91]
v_mfma_f32_16x16x32_bf16 v[92:95], a[124:127], v[148:151], v[92:95]
s_waitcnt lgkmcnt(4)
v_mfma_f32_16x16x32_bf16 v[96:99], a[96:99], v[152:155], v[96:99]
ds_read_b64_tr_b16 v[148:149], v221 offset:128
ds_read_b64_tr_b16 v[150:151], v221 offset:3712
v_mfma_f32_16x16x32_bf16 v[100:103], a[100:103], v[152:155], v[100:103]
v_mfma_f32_16x16x32_bf16 v[104:107], a[104:107], v[152:155], v[104:107]
v_mfma_f32_16x16x32_bf16 v[108:111], a[108:111], v[152:155], v[108:111]
s_mul_i32 s40, s20, 7
s_add_u32 s40, s40, 3
s_lshr_b32 s41, s40, 1
s_mul_i32 s41, s41, 458752
s_and_b32 s40, s40, 1
s_mul_i32 s40, s40, 14336
s_add_u32 s40, s40, s41
s_add_u32 s40, s40, s30
v_cvt_pk_bf16_f32 v184, v80, v81
v_cvt_pk_bf16_f32 v185, v82, v83
v_cvt_pk_bf16_f32 v186, v84, v85
v_cvt_pk_bf16_f32 v187, v86, v87
buffer_store_dwordx4 v[184:187], v1, s[4:7], s40 offen sc1
v_cvt_pk_bf16_f32 v188, v88, v89
v_cvt_pk_bf16_f32 v189, v90, v91
v_cvt_pk_bf16_f32 v190, v92, v93
v_cvt_pk_bf16_f32 v191, v94, v95
buffer_store_dwordx4 v[188:191], v1, s[4:7], s40 offen offset:1024 sc1
s_waitcnt lgkmcnt(4)
v_mfma_f32_16x16x32_bf16 v[96:99], a[112:115], v[156:159], v[96:99]
ds_read_b64_tr_b16 v[152:153], v218 offset:61568
ds_read_b64_tr_b16 v[154:155], v218 offset:65152
v_mfma_f32_16x16x32_bf16 v[100:103], a[116:119], v[156:159], v[100:103]
v_mfma_f32_16x16x32_bf16 v[104:107], a[120:123], v[156:159], v[104:107]
v_mfma_f32_16x16x32_bf16 v[108:111], a[124:127], v[156:159], v[108:111]
s_waitcnt lgkmcnt(4)
v_mfma_f32_16x16x32_bf16 v[112:115], a[96:99], v[144:147], v[112:115]
ds_read_b64_tr_b16 v[156:157], v222 offset:128
ds_read_b64_tr_b16 v[158:159], v222 offset:3712
v_mfma_f32_16x16x32_bf16 v[116:119], a[100:103], v[144:147], v[116:119]
v_mfma_f32_16x16x32_bf16 v[120:123], a[104:107], v[144:147], v[120:123]
v_mfma_f32_16x16x32_bf16 v[124:127], a[108:111], v[144:147], v[124:127]
s_mul_i32 s40, s20, 7
s_add_u32 s40, s40, 4
s_lshr_b32 s41, s40, 1
s_mul_i32 s41, s41, 458752
s_and_b32 s40, s40, 1
s_mul_i32 s40, s40, 14336
s_add_u32 s40, s40, s41
s_add_u32 s40, s40, s30
v_cvt_pk_bf16_f32 v192, v96, v97
v_cvt_pk_bf16_f32 v193, v98, v99
v_cvt_pk_bf16_f32 v194, v100, v101
v_cvt_pk_bf16_f32 v195, v102, v103
buffer_store_dwordx4 v[192:195], v1, s[4:7], s40 offen sc1
v_cvt_pk_bf16_f32 v196, v104, v105
v_cvt_pk_bf16_f32 v197, v106, v107
v_cvt_pk_bf16_f32 v198, v108, v109
v_cvt_pk_bf16_f32 v199, v110, v111
buffer_store_dwordx4 v[196:199], v1, s[4:7], s40 offen offset:1024 sc1
s_waitcnt lgkmcnt(4)
v_mfma_f32_16x16x32_bf16 v[112:115], a[112:115], v[148:151], v[112:115]
v_mfma_f32_16x16x32_bf16 v[116:119], a[116:119], v[148:151], v[116:119]
v_mfma_f32_16x16x32_bf16 v[120:123], a[120:123], v[148:151], v[120:123]
v_mfma_f32_16x16x32_bf16 v[124:127], a[124:127], v[148:151], v[124:127]
s_waitcnt lgkmcnt(2)
v_mfma_f32_16x16x32_bf16 v[128:131], a[96:99], v[152:155], v[128:131]
v_mfma_f32_16x16x32_bf16 v[132:135], a[100:103], v[152:155], v[132:135]
v_mfma_f32_16x16x32_bf16 v[136:139], a[104:107], v[152:155], v[136:139]
v_mfma_f32_16x16x32_bf16 v[140:143], a[108:111], v[152:155], v[140:143]
s_mul_i32 s40, s20, 7
s_add_u32 s40, s40, 5
s_lshr_b32 s41, s40, 1
s_mul_i32 s41, s41, 458752
s_and_b32 s40, s40, 1
s_mul_i32 s40, s40, 14336
s_add_u32 s40, s40, s41
s_add_u32 s40, s40, s30
v_cvt_pk_bf16_f32 v200, v112, v113
v_cvt_pk_bf16_f32 v201, v114, v115
v_cvt_pk_bf16_f32 v202, v116, v117
v_cvt_pk_bf16_f32 v203, v118, v119
buffer_store_dwordx4 v[200:203], v1, s[4:7], s40 offen sc1
v_cvt_pk_bf16_f32 v204, v120, v121
v_cvt_pk_bf16_f32 v205, v122, v123
v_cvt_pk_bf16_f32 v206, v124, v125
v_cvt_pk_bf16_f32 v207, v126, v127
buffer_store_dwordx4 v[204:207], v1, s[4:7], s40 offen offset:1024 sc1
s_waitcnt lgkmcnt(0)
v_mfma_f32_16x16x32_bf16 v[128:131], a[112:115], v[156:159], v[128:131]
v_mfma_f32_16x16x32_bf16 v[132:135], a[116:119], v[156:159], v[132:135]
v_mfma_f32_16x16x32_bf16 v[136:139], a[120:123], v[156:159], v[136:139]
v_mfma_f32_16x16x32_bf16 v[140:143], a[124:127], v[156:159], v[140:143]
s_nop 0
s_mul_i32 s40, s20, 7
s_add_u32 s40, s40, 6
s_lshr_b32 s41, s40, 1
s_mul_i32 s41, s41, 458752
s_and_b32 s40, s40, 1
s_mul_i32 s40, s40, 14336
s_add_u32 s40, s40, s41
s_add_u32 s40, s40, s30
v_cvt_pk_bf16_f32 v208, v128, v129
v_cvt_pk_bf16_f32 v209, v130, v131
v_cvt_pk_bf16_f32 v210, v132, v133
v_cvt_pk_bf16_f32 v211, v134, v135
buffer_store_dwordx4 v[208:211], v1, s[4:7], s40 offen sc1
v_cvt_pk_bf16_f32 v212, v136, v137
v_cvt_pk_bf16_f32 v213, v138, v139
v_cvt_pk_bf16_f32 v214, v140, v141
v_cvt_pk_bf16_f32 v215, v142, v143
buffer_store_dwordx4 v[212:215], v1, s[4:7], s40 offen offset:1024 sc1
s_branch PRE_DONE
ATASK:
s_load_dwordx2 s[8:9], s[0:1], 16
s_mov_b32 s10, 3670016
s_mov_b32 s11, 0x00020000
s_load_dwordx2 s[12:13], s[0:1], 24
s_mov_b32 s14, 3670016
s_mov_b32 s15, 0x00020000
v_lshrrev_b32 v3, 5, v0
v_and_b32 v4, 31, v0
v_add_u32 v2, 0, v3
v_xor_b32 v12, v4, v2
v_lshlrev_b32 v12, 4, v12
v_add_u32 v20, 0, v3
v_lshl_add_u32 v20, v20, 13, v12
v_lshl_add_u32 v12, v2, 13, v12
v_add_u32 v2, 2, v3
v_xor_b32 v13, v4, v2
v_lshlrev_b32 v13, 4, v13
v_add_u32 v21, 8, v3
v_lshl_add_u32 v21, v21, 13, v13
v_lshl_add_u32 v13, v2, 13, v13
v_add_u32 v2, 4, v3
v_xor_b32 v14, v4, v2
v_lshlrev_b32 v14, 4, v14
v_add_u32 v22, 4, v3
v_lshl_add_u32 v22, v22, 13, v14
v_lshl_add_u32 v14, v2, 13, v14
v_add_u32 v2, 6, v3
v_xor_b32 v15, v4, v2
v_lshlrev_b32 v15, 4, v15
v_add_u32 v23, 12, v3
v_lshl_add_u32 v23, v23, 13, v15
v_lshl_add_u32 v15, v2, 13, v15
v_add_u32 v2, 8, v3
v_xor_b32 v16, v4, v2
v_lshlrev_b32 v16, 4, v16
v_add_u32 v24, 16, v3
v_lshl_add_u32 v24, v24, 13, v16
v_lshl_add_u32 v16, v2, 13, v16
v_add_u32 v2, 10, v3
v_xor_b32 v17, v4, v2
v_lshlrev_b32 v17, 4, v17
v_add_u32 v25, 24, v3
v_lshl_add_u32 v25, v25, 13, v17
v_lshl_add_u32 v17, v2, 13, v17
v_add_u32 v2, 12, v3
v_xor_b32 v18, v4, v2
v_lshlrev_b32 v18, 4, v18
v_add_u32 v26, 20, v3
v_lshl_add_u32 v26, v26, 13, v18
v_lshl_add_u32 v18, v2, 13, v18
v_add_u32 v2, 14, v3
v_xor_b32 v19, v4, v2
v_lshlrev_b32 v19, 4, v19
v_add_u32 v27, 28, v3
v_lshl_add_u32 v27, v27, 13, v19
v_lshl_add_u32 v19, v2, 13, v19
s_lshl_b32 s28, s27, 19
s_lshl_b32 s40, s26, 9
s_add_u32 s28, s28, s40
s_lshr_b32 s40, s20, 1
s_lshl_b32 s40, s40, 18
s_add_u32 s28, s28, s40
s_and_b32 s40, s20, 1
s_lshl_b32 s40, s40, 14
s_add_u32 s28, s28, s40
s_lshl_b32 s32, s20, 13
s_waitcnt lgkmcnt(0)
s_add_u32 m0, s32, 0
s_nop 0
buffer_load_dwordx4 v20, s[8:11], s28 offen lds
s_add_u32 m0, s32, 1024
s_nop 0
buffer_load_dwordx4 v21, s[8:11], s28 offen lds
s_add_u32 m0, s32, 2048
s_nop 0
buffer_load_dwordx4 v22, s[8:11], s28 offen lds
s_add_u32 m0, s32, 3072
s_nop 0
buffer_load_dwordx4 v23, s[8:11], s28 offen lds
s_add_u32 m0, s32, 4096
s_nop 0
buffer_load_dwordx4 v24, s[8:11], s28 offen lds
s_add_u32 m0, s32, 5120
s_nop 0
buffer_load_dwordx4 v25, s[8:11], s28 offen lds
s_add_u32 m0, s32, 6144
s_nop 0
buffer_load_dwordx4 v26, s[8:11], s28 offen lds
s_add_u32 m0, s32, 7168
s_nop 0
buffer_load_dwordx4 v27, s[8:11], s28 offen lds
s_mul_i32 s29, s20, 917504
s_lshl_b32 s40, s26, 9
s_add_u32 s29, s29, s40
s_lshl_b32 s32, s20, 15
s_add_u32 s32, s32, 32768
s_mov_b32 s36, 0x70000000
s_add_u32 m0, s32, 0
s_nop 0
buffer_load_dwordx4 v12, s[12:15], s29 offen lds
s_add_u32 m0, s32, 1024
s_nop 0
buffer_load_dwordx4 v13, s[12:15], s29 offen lds
s_add_u32 m0, s32, 2048
s_nop 0
buffer_load_dwordx4 v14, s[12:15], s29 offen lds
s_add_u32 m0, s32, 3072
s_nop 0
buffer_load_dwordx4 v15, s[12:15], s29 offen lds
s_add_u32 m0, s32, 4096
s_nop 0
buffer_load_dwordx4 v16, s[12:15], s29 offen lds
s_add_u32 m0, s32, 5120
s_nop 0
buffer_load_dwordx4 v17, s[12:15], s29 offen lds
s_add_u32 m0, s32, 6144
s_nop 0
buffer_load_dwordx4 v18, s[12:15], s29 offen lds
s_add_u32 m0, s32, 7168
s_nop 0
buffer_load_dwordx4 v19, s[12:15], s29 offen lds
s_add_u32 s29, s29, 131072
s_add_u32 m0, s32, 8192
s_nop 0
buffer_load_dwordx4 v12, s[12:15], s29 offen lds
s_add_u32 m0, s32, 9216
s_nop 0
buffer_load_dwordx4 v13, s[12:15], s29 offen lds
s_add_u32 m0, s32, 10240
s_nop 0
buffer_load_dwordx4 v14, s[12:15], s29 offen lds
s_add_u32 m0, s32, 11264
s_nop 0
buffer_load_dwordx4 v15, s[12:15], s29 offen lds
s_add_u32 m0, s32, 12288
s_nop 0
buffer_load_dwordx4 v16, s[12:15], s29 offen lds
s_add_u32 m0, s32, 13312
s_nop 0
buffer_load_dwordx4 v17, s[12:15], s29 offen lds
s_add_u32 m0, s32, 14336
s_nop 0
buffer_load_dwordx4 v18, s[12:15], s29 offen lds
s_add_u32 m0, s32, 15360
s_nop 0
buffer_load_dwordx4 v19, s[12:15], s29 offen lds
s_add_u32 s29, s29, 131072
buffer_load_dword v7, off, s[12:15], s36
buffer_load_dword v7, off, s[12:15], s36
s_add_u32 m0, s32, 16384
s_nop 0
buffer_load_dwordx4 v12, s[12:15], s29 offen lds
s_add_u32 m0, s32, 17408
s_nop 0
buffer_load_dwordx4 v13, s[12:15], s29 offen lds
s_add_u32 m0, s32, 18432
s_nop 0
buffer_load_dwordx4 v14, s[12:15], s29 offen lds
s_add_u32 m0, s32, 19456
s_nop 0
buffer_load_dwordx4 v15, s[12:15], s29 offen lds
s_add_u32 m0, s32, 20480
s_nop 0
buffer_load_dwordx4 v16, s[12:15], s29 offen lds
s_add_u32 m0, s32, 21504
s_nop 0
buffer_load_dwordx4 v17, s[12:15], s29 offen lds
s_add_u32 m0, s32, 22528
s_nop 0
buffer_load_dwordx4 v18, s[12:15], s29 offen lds
s_add_u32 m0, s32, 23552
s_nop 0
buffer_load_dwordx4 v19, s[12:15], s29 offen lds
s_add_u32 s29, s29, 131072
v_and_b32 v2, 15, v0
v_lshrrev_b32 v3, 4, v0
v_add_u32 v4, 0, v3
v_xor_b32 v4, v4, v2
v_lshlrev_b32 v4, 4, v4
v_lshl_add_u32 v8, v2, 9, v4
v_add_u32 v4, 4, v3
v_xor_b32 v4, v4, v2
v_lshlrev_b32 v4, 4, v4
v_lshl_add_u32 v9, v2, 9, v4
v_add_u32 v4, 8, v3
v_xor_b32 v4, v4, v2
v_lshlrev_b32 v4, 4, v4
v_lshl_add_u32 v10, v2, 9, v4
v_add_u32 v4, 12, v3
v_xor_b32 v4, v4, v2
v_lshlrev_b32 v4, 4, v4
v_lshl_add_u32 v11, v2, 9, v4
v_add_u32 v144, s32, v8
v_add_u32 v145, s32, v9
v_add_u32 v146, s32, v10
v_add_u32 v147, s32, v11
s_mul_i32 s30, s26, 401408
s_mul_i32 s40, s20, 100352
s_add_u32 s30, s30, s40
s_lshl_b32 s40, s27, 11
s_add_u32 s30, s30, s40
s_add_u32 s30, s30, 9879552
s_mov_b32 s31, 0x3db8aa3b
s_mov_b32 s34, s32
s_xor_b32 s35, s32, 16384
s_mov_b32 s37, 0
s_waitcnt vmcnt(26)
s_barrier
ds_read_b128 a[0:3], v8
ds_read_b128 a[4:7], v8 offset:8192
ds_read_b128 a[8:11], v8 offset:16384
ds_read_b128 a[12:15], v8 offset:24576
ds_read_b128 a[16:19], v9
ds_read_b128 a[20:23], v9 offset:8192
ds_read_b128 a[24:27], v9 offset:16384
ds_read_b128 a[28:31], v9 offset:24576
s_waitcnt lgkmcnt(4)
ds_read_b128 a[32:35], v10
ds_read_b128 a[36:39], v10 offset:8192
ds_read_b128 a[40:43], v10 offset:16384
ds_read_b128 a[44:47], v10 offset:24576
ds_read_b128 a[48:51], v11
ds_read_b128 a[52:55], v11 offset:8192
ds_read_b128 a[56:59], v11 offset:16384
ds_read_b128 a[60:63], v11 offset:24576
s_waitcnt lgkmcnt(4)
ds_read_b128 a[64:67], v8 offset:256
ds_read_b128 a[68:71], v8 offset:8448
ds_read_b128 a[72:75], v8 offset:16640
ds_read_b128 a[76:79], v8 offset:24832
ds_read_b128 a[80:83], v9 offset:256
ds_read_b128 a[84:87], v9 offset:8448
ds_read_b128 a[88:91], v9 offset:16640
ds_read_b128 a[92:95], v9 offset:24832
s_waitcnt lgkmcnt(4)
ds_read_b128 a[96:99], v10 offset:256
ds_read_b128 a[100:103], v10 offset:8448
ds_read_b128 a[104:107], v10 offset:16640
ds_read_b128 a[108:111], v10 offset:24832
ds_read_b128 a[112:115], v11 offset:256
ds_read_b128 a[116:119], v11 offset:8448
ds_read_b128 a[120:123], v11 offset:16640
ds_read_b128 a[124:127], v11 offset:24832
s_waitcnt lgkmcnt(4)
s_waitcnt vmcnt(18)
ds_read_b128 v[80:83], v144
ds_read_b128 v[84:87], v145
ds_read_b128 v[88:91], v146
ds_read_b128 v[92:95], v147
ds_read_b128 v[96:99], v144 offset:256
ds_read_b128 v[100:103], v145 offset:256
ds_read_b128 v[104:107], v146 offset:256
ds_read_b128 v[108:111], v147 offset:256
ATASK_PAIR:
s_waitcnt lgkmcnt(7)
v_mfma_f32_16x16x32_bf16 v[32:35], a[0:3], v[80:83], 0
s_add_u32 m0, s35, 8192
s_nop 0
buffer_load_dwordx4 v12, s[12:15], s29 offen lds
v_mfma_f32_16x16x32_bf16 v[36:39], a[4:7], v[80:83], 0
v_mfma_f32_16x16x32_bf16 v[40:43], a[8:11], v[80:83], 0
s_waitcnt vmcnt(11)
ds_read_b128 v[112:115], v144 offset:8192
v_mfma_f32_16x16x32_bf16 v[44:47], a[12:15], v[80:83], 0
s_waitcnt lgkmcnt(7)
v_mfma_f32_16x16x32_bf16 v[32:35], a[16:19], v[84:87], v[32:35]
s_add_u32 m0, s35, 9216
s_nop 0
buffer_load_dwordx4 v13, s[12:15], s29 offen lds
v_mfma_f32_16x16x32_bf16 v[36:39], a[20:23], v[84:87], v[36:39]
v_mul_f32 v48, s31, v48
v_mul_f32 v49, s31, v49
v_mfma_f32_16x16x32_bf16 v[40:43], a[24:27], v[84:87], v[40:43]
ds_read_b128 v[116:119], v145 offset:8192
v_mfma_f32_16x16x32_bf16 v[44:47], a[28:31], v[84:87], v[44:47]
v_mul_f32 v50, s31, v50
v_mul_f32 v51, s31, v51
v_cvt_pk_bf16_f32 v72, v48, v49
s_waitcnt lgkmcnt(7)
v_mfma_f32_16x16x32_bf16 v[32:35], a[32:35], v[88:91], v[32:35]
s_add_u32 m0, s35, 10240
s_nop 0
buffer_load_dwordx4 v14, s[12:15], s29 offen lds
v_mfma_f32_16x16x32_bf16 v[36:39], a[36:39], v[88:91], v[36:39]
v_cvt_pk_bf16_f32 v73, v50, v51
v_mul_f32 v52, s31, v52
v_mfma_f32_16x16x32_bf16 v[40:43], a[40:43], v[88:91], v[40:43]
ds_read_b128 v[120:123], v146 offset:8192
v_mfma_f32_16x16x32_bf16 v[44:47], a[44:47], v[88:91], v[44:47]
v_mul_f32 v53, s31, v53
v_mul_f32 v54, s31, v54
v_mul_f32 v55, s31, v55
s_waitcnt lgkmcnt(7)
v_mfma_f32_16x16x32_bf16 v[32:35], a[48:51], v[92:95], v[32:35]
s_add_u32 m0, s35, 11264
s_nop 0
buffer_load_dwordx4 v15, s[12:15], s29 offen lds
v_mfma_f32_16x16x32_bf16 v[36:39], a[52:55], v[92:95], v[36:39]
v_cvt_pk_bf16_f32 v74, v52, v53
v_cvt_pk_bf16_f32 v75, v54, v55
v_mfma_f32_16x16x32_bf16 v[40:43], a[56:59], v[92:95], v[40:43]
ds_read_b128 v[124:127], v147 offset:8192
v_mfma_f32_16x16x32_bf16 v[44:47], a[60:63], v[92:95], v[44:47]
buffer_store_dwordx4 v[72:75], v1, s[4:7], s36 offen sc1
s_waitcnt lgkmcnt(7)
v_mfma_f32_16x16x32_bf16 v[32:35], a[64:67], v[96:99], v[32:35]
s_add_u32 m0, s35, 12288
s_nop 0
buffer_load_dwordx4 v16, s[12:15], s29 offen lds
v_mfma_f32_16x16x32_bf16 v[36:39], a[68:71], v[96:99], v[36:39]
v_mul_f32 v56, s31, v56
v_mul_f32 v57, s31, v57
v_mfma_f32_16x16x32_bf16 v[40:43], a[72:75], v[96:99], v[40:43]
ds_read_b128 v[128:131], v144 offset:8448
v_mfma_f32_16x16x32_bf16 v[44:47], a[76:79], v[96:99], v[44:47]
v_mul_f32 v58, s31, v58
v_mul_f32 v59, s31, v59
v_cvt_pk_bf16_f32 v76, v56, v57
s_waitcnt lgkmcnt(7)
v_mfma_f32_16x16x32_bf16 v[32:35], a[80:83], v[100:103], v[32:35]
s_add_u32 m0, s35, 13312
s_nop 0
buffer_load_dwordx4 v17, s[12:15], s29 offen lds
v_mfma_f32_16x16x32_bf16 v[36:39], a[84:87], v[100:103], v[36:39]
v_cvt_pk_bf16_f32 v77, v58, v59
v_mul_f32 v60, s31, v60
v_mfma_f32_16x16x32_bf16 v[40:43], a[88:91], v[100:103], v[40:43]
ds_read_b128 v[132:135], v145 offset:8448
v_mfma_f32_16x16x32_bf16 v[44:47], a[92:95], v[100:103], v[44:47]
v_mul_f32 v61, s31, v61
v_mul_f32 v62, s31, v62
v_mul_f32 v63, s31, v63
s_waitcnt lgkmcnt(7)
v_mfma_f32_16x16x32_bf16 v[32:35], a[96:99], v[104:107], v[32:35]
s_add_u32 m0, s35, 14336
s_nop 0
buffer_load_dwordx4 v18, s[12:15], s29 offen lds
v_mfma_f32_16x16x32_bf16 v[36:39], a[100:103], v[104:107], v[36:39]
v_cvt_pk_bf16_f32 v78, v60, v61
v_cvt_pk_bf16_f32 v79, v62, v63
v_mfma_f32_16x16x32_bf16 v[40:43], a[104:107], v[104:107], v[40:43]
ds_read_b128 v[136:139], v146 offset:8448
v_mfma_f32_16x16x32_bf16 v[44:47], a[108:111], v[104:107], v[44:47]
buffer_store_dwordx4 v[76:79], v1, s[4:7], s36 offen offset:1024 sc1
s_waitcnt lgkmcnt(7)
v_mfma_f32_16x16x32_bf16 v[32:35], a[112:115], v[108:111], v[32:35]
s_add_u32 m0, s35, 15360
s_nop 0
buffer_load_dwordx4 v19, s[12:15], s29 offen lds
s_add_u32 s29, s29, 131072
v_mfma_f32_16x16x32_bf16 v[36:39], a[116:119], v[108:111], v[36:39]
v_mfma_f32_16x16x32_bf16 v[40:43], a[120:123], v[108:111], v[40:43]
ds_read_b128 v[140:143], v147 offset:8448
v_mfma_f32_16x16x32_bf16 v[44:47], a[124:127], v[108:111], v[44:47]
s_mov_b32 s36, s30
s_add_u32 s30, s30, 14336
s_cmp_eq_u32 s37, 6
s_cbranch_scc1 ATASK_LAST
v_xor_b32 v144, 16384, v144
v_xor_b32 v145, 16384, v145
v_xor_b32 v146, 16384, v146
v_xor_b32 v147, 16384, v147
s_waitcnt lgkmcnt(7)
v_mfma_f32_16x16x32_bf16 v[48:51], a[0:3], v[112:115], 0
s_add_u32 m0, s34, 0
s_nop 0
buffer_load_dwordx4 v12, s[12:15], s29 offen lds
v_mfma_f32_16x16x32_bf16 v[52:55], a[4:7], v[112:115], 0
v_mfma_f32_16x16x32_bf16 v[56:59], a[8:11], v[112:115], 0
s_waitcnt vmcnt(11)
ds_read_b128 v[80:83], v144
v_mfma_f32_16x16x32_bf16 v[60:63], a[12:15], v[112:115], 0
s_waitcnt lgkmcnt(7)
v_mfma_f32_16x16x32_bf16 v[48:51], a[16:19], v[116:119], v[48:51]
s_add_u32 m0, s34, 1024
s_nop 0
buffer_load_dwordx4 v13, s[12:15], s29 offen lds
v_mfma_f32_16x16x32_bf16 v[52:55], a[20:23], v[116:119], v[52:55]
v_mul_f32 v32, s31, v32
v_mul_f32 v33, s31, v33
v_mfma_f32_16x16x32_bf16 v[56:59], a[24:27], v[116:119], v[56:59]
ds_read_b128 v[84:87], v145
v_mfma_f32_16x16x32_bf16 v[60:63], a[28:31], v[116:119], v[60:63]
v_mul_f32 v34, s31, v34
v_mul_f32 v35, s31, v35
v_cvt_pk_bf16_f32 v64, v32, v33
s_waitcnt lgkmcnt(7)
v_mfma_f32_16x16x32_bf16 v[48:51], a[32:35], v[120:123], v[48:51]
s_add_u32 m0, s34, 2048
s_nop 0
buffer_load_dwordx4 v14, s[12:15], s29 offen lds
v_mfma_f32_16x16x32_bf16 v[52:55], a[36:39], v[120:123], v[52:55]
v_cvt_pk_bf16_f32 v65, v34, v35
v_mul_f32 v36, s31, v36
v_mfma_f32_16x16x32_bf16 v[56:59], a[40:43], v[120:123], v[56:59]
ds_read_b128 v[88:91], v146
v_mfma_f32_16x16x32_bf16 v[60:63], a[44:47], v[120:123], v[60:63]
v_mul_f32 v37, s31, v37
v_mul_f32 v38, s31, v38
v_mul_f32 v39, s31, v39
s_waitcnt lgkmcnt(7)
v_mfma_f32_16x16x32_bf16 v[48:51], a[48:51], v[124:127], v[48:51]
s_add_u32 m0, s34, 3072
s_nop 0
buffer_load_dwordx4 v15, s[12:15], s29 offen lds
v_mfma_f32_16x16x32_bf16 v[52:55], a[52:55], v[124:127], v[52:55]
v_cvt_pk_bf16_f32 v66, v36, v37
v_cvt_pk_bf16_f32 v67, v38, v39
v_mfma_f32_16x16x32_bf16 v[56:59], a[56:59], v[124:127], v[56:59]
ds_read_b128 v[92:95], v147
v_mfma_f32_16x16x32_bf16 v[60:63], a[60:63], v[124:127], v[60:63]
buffer_store_dwordx4 v[64:67], v1, s[4:7], s36 offen sc1
s_waitcnt lgkmcnt(7)
v_mfma_f32_16x16x32_bf16 v[48:51], a[64:67], v[128:131], v[48:51]
s_add_u32 m0, s34, 4096
s_nop 0
buffer_load_dwordx4 v16, s[12:15], s29 offen lds
v_mfma_f32_16x16x32_bf16 v[52:55], a[68:71], v[128:131], v[52:55]
v_mul_f32 v40, s31, v40
v_mul_f32 v41, s31, v41
v_mfma_f32_16x16x32_bf16 v[56:59], a[72:75], v[128:131], v[56:59]
ds_read_b128 v[96:99], v144 offset:256
v_mfma_f32_16x16x32_bf16 v[60:63], a[76:79], v[128:131], v[60:63]
v_mul_f32 v42, s31, v42
v_mul_f32 v43, s31, v43
v_cvt_pk_bf16_f32 v68, v40, v41
s_waitcnt lgkmcnt(7)
v_mfma_f32_16x16x32_bf16 v[48:51], a[80:83], v[132:135], v[48:51]
s_add_u32 m0, s34, 5120
s_nop 0
buffer_load_dwordx4 v17, s[12:15], s29 offen lds
v_mfma_f32_16x16x32_bf16 v[52:55], a[84:87], v[132:135], v[52:55]
v_cvt_pk_bf16_f32 v69, v42, v43
v_mul_f32 v44, s31, v44
v_mfma_f32_16x16x32_bf16 v[56:59], a[88:91], v[132:135], v[56:59]
ds_read_b128 v[100:103], v145 offset:256
v_mfma_f32_16x16x32_bf16 v[60:63], a[92:95], v[132:135], v[60:63]
v_mul_f32 v45, s31, v45
v_mul_f32 v46, s31, v46
v_mul_f32 v47, s31, v47
s_waitcnt lgkmcnt(7)
v_mfma_f32_16x16x32_bf16 v[48:51], a[96:99], v[136:139], v[48:51]
s_add_u32 m0, s34, 6144
s_nop 0
buffer_load_dwordx4 v18, s[12:15], s29 offen lds
v_mfma_f32_16x16x32_bf16 v[52:55], a[100:103], v[136:139], v[52:55]
v_cvt_pk_bf16_f32 v70, v44, v45
v_cvt_pk_bf16_f32 v71, v46, v47
v_mfma_f32_16x16x32_bf16 v[56:59], a[104:107], v[136:139], v[56:59]
ds_read_b128 v[104:107], v146 offset:256
v_mfma_f32_16x16x32_bf16 v[60:63], a[108:111], v[136:139], v[60:63]
buffer_store_dwordx4 v[68:71], v1, s[4:7], s36 offen offset:1024 sc1
s_waitcnt lgkmcnt(7)
v_mfma_f32_16x16x32_bf16 v[48:51], a[112:115], v[140:143], v[48:51]
s_add_u32 m0, s34, 7168
s_nop 0
buffer_load_dwordx4 v19, s[12:15], s29 offen lds
s_add_u32 s29, s29, 131072
v_mfma_f32_16x16x32_bf16 v[52:55], a[116:119], v[140:143], v[52:55]
v_mfma_f32_16x16x32_bf16 v[56:59], a[120:123], v[140:143], v[56:59]
ds_read_b128 v[108:111], v147 offset:256
v_mfma_f32_16x16x32_bf16 v[60:63], a[124:127], v[140:143], v[60:63]
s_mov_b32 s36, s30
s_add_u32 s30, s30, 14336
s_xor_b32 s34, s34, 16384
s_xor_b32 s35, s35, 16384
s_add_u32 s37, s37, 2
s_cmp_lt_u32 s37, 4
s_cselect_b32 s14, s14, 0
s_branch ATASK_PAIR
ATASK_LAST:
s_nop 7
v_mul_f32 v32, s31, v32
v_mul_f32 v33, s31, v33
v_mul_f32 v34, s31, v34
v_mul_f32 v35, s31, v35
v_cvt_pk_bf16_f32 v64, v32, v33
v_cvt_pk_bf16_f32 v65, v34, v35
v_mul_f32 v36, s31, v36
v_mul_f32 v37, s31, v37
v_mul_f32 v38, s31, v38
v_mul_f32 v39, s31, v39
v_cvt_pk_bf16_f32 v66, v36, v37
v_cvt_pk_bf16_f32 v67, v38, v39
buffer_store_dwordx4 v[64:67], v1, s[4:7], s36 offen sc1
v_mul_f32 v40, s31, v40
v_mul_f32 v41, s31, v41
v_mul_f32 v42, s31, v42
v_mul_f32 v43, s31, v43
v_cvt_pk_bf16_f32 v68, v40, v41
v_cvt_pk_bf16_f32 v69, v42, v43
v_mul_f32 v44, s31, v44
v_mul_f32 v45, s31, v45
v_mul_f32 v46, s31, v46
v_mul_f32 v47, s31, v47
v_cvt_pk_bf16_f32 v70, v44, v45
v_cvt_pk_bf16_f32 v71, v46, v47
buffer_store_dwordx4 v[68:71], v1, s[4:7], s36 offen offset:1024 sc1
s_branch PRE_DONE
SELF:
s_load_dwordx2 s[8:9], s[0:1], 16
s_mov_b32 s10, 3670016
s_mov_b32 s11, 0x00020000
s_load_dwordx2 s[12:13], s[0:1], 24
s_mov_b32 s14, 3670016
s_mov_b32 s15, 0x00020000
s_mov_b32 s33, 8064
s_add_u32 s97, s26, 1
s_and_b32 s41, s20, 1
s_lshl_b32 s41, s41, 3
v_lshrrev_b32 v3, 5, v0
v_and_b32 v4, 31, v0
v_add_u32 v2, 0, v3
v_xor_b32 v12, v4, v2
v_lshlrev_b32 v12, 4, v12
v_lshl_add_u32 v12, v2, 13, v12
v_add_u32 v2, 2, v3
v_xor_b32 v13, v4, v2
v_lshlrev_b32 v13, 4, v13
v_lshl_add_u32 v13, v2, 13, v13
v_add_u32 v2, 4, v3
v_xor_b32 v14, v4, v2
v_lshlrev_b32 v14, 4, v14
v_lshl_add_u32 v14, v2, 13, v14
v_add_u32 v2, 6, v3
v_xor_b32 v15, v4, v2
v_lshlrev_b32 v15, 4, v15
v_lshl_add_u32 v15, v2, 13, v15
v_add_u32 v2, 8, v3
v_xor_b32 v16, v4, v2
v_lshlrev_b32 v16, 4, v16
v_lshl_add_u32 v16, v2, 13, v16
v_add_u32 v2, 10, v3
v_xor_b32 v17, v4, v2
v_lshlrev_b32 v17, 4, v17
v_lshl_add_u32 v17, v2, 13, v17
v_add_u32 v2, 12, v3
v_xor_b32 v18, v4, v2
v_lshlrev_b32 v18, 4, v18
v_lshl_add_u32 v18, v2, 13, v18
v_add_u32 v2, 14, v3
v_xor_b32 v19, v4, v2
v_lshlrev_b32 v19, 4, v19
v_lshl_add_u32 v19, v2, 13, v19
v_xor_b32 v4, s41, v4
v_add_u32 v2, 0, v3
v_xor_b32 v2, v4, v2
v_lshlrev_b32 v2, 4, v2
v_add_u32 v20, 0, v3
v_lshl_add_u32 v20, v20, 13, v2
v_add_u32 v2, 2, v3
v_xor_b32 v2, v4, v2
v_lshlrev_b32 v2, 4, v2
v_add_u32 v21, 8, v3
v_lshl_add_u32 v21, v21, 13, v2
v_add_u32 v2, 4, v3
v_xor_b32 v2, v4, v2
v_lshlrev_b32 v2, 4, v2
v_add_u32 v22, 4, v3
v_lshl_add_u32 v22, v22, 13, v2
v_add_u32 v2, 6, v3
v_xor_b32 v2, v4, v2
v_lshlrev_b32 v2, 4, v2
v_add_u32 v23, 12, v3
v_lshl_add_u32 v23, v23, 13, v2
s_lshl_b32 s28, s41, 14
s_lshl_b32 s29, s26, 9
s_add_u32 s28, s28, s29
s_lshr_b32 s40, s20, 1
s_lshl_b32 s40, s40, 14
s_add_u32 s28, s28, s40
s_mul_i32 s40, s20, 917504
s_add_u32 s29, s29, s40
s_lshl_b32 s32, s20, 12
s_lshl_b32 s30, s20, 15
s_add_u32 s30, s30, 32768
s_mov_b32 s31, 0x3db8aa3b
s_waitcnt lgkmcnt(0)
s_add_u32 m0, s30, 0
s_nop 0
buffer_load_dwordx4 v12, s[12:15], s29 offen lds
s_add_u32 m0, s30, 1024
s_nop 0
buffer_load_dwordx4 v13, s[12:15], s29 offen lds
s_add_u32 m0, s30, 2048
s_nop 0
buffer_load_dwordx4 v14, s[12:15], s29 offen lds
s_add_u32 m0, s30, 3072
s_nop 0
buffer_load_dwordx4 v15, s[12:15], s29 offen lds
s_add_u32 m0, s30, 4096
s_nop 0
buffer_load_dwordx4 v16, s[12:15], s29 offen lds
s_add_u32 m0, s30, 5120
s_nop 0
buffer_load_dwordx4 v17, s[12:15], s29 offen lds
s_add_u32 m0, s30, 6144
s_nop 0
buffer_load_dwordx4 v18, s[12:15], s29 offen lds
s_add_u32 m0, s30, 7168
s_nop 0
buffer_load_dwordx4 v19, s[12:15], s29 offen lds
s_add_u32 s29, s29, 131072
s_add_u32 m0, s30, 8192
s_nop 0
buffer_load_dwordx4 v12, s[12:15], s29 offen lds
s_add_u32 m0, s30, 9216
s_nop 0
buffer_load_dwordx4 v13, s[12:15], s29 offen lds
s_add_u32 m0, s30, 10240
s_nop 0
buffer_load_dwordx4 v14, s[12:15], s29 offen lds
s_add_u32 m0, s30, 11264
s_nop 0
buffer_load_dwordx4 v15, s[12:15], s29 offen lds
s_add_u32 m0, s30, 12288
s_nop 0
buffer_load_dwordx4 v16, s[12:15], s29 offen lds
s_add_u32 m0, s30, 13312
s_nop 0
buffer_load_dwordx4 v17, s[12:15], s29 offen lds
s_add_u32 m0, s30, 14336
s_nop 0
buffer_load_dwordx4 v18, s[12:15], s29 offen lds
s_add_u32 m0, s30, 15360
s_nop 0
buffer_load_dwordx4 v19, s[12:15], s29 offen lds
s_add_u32 s29, s29, 131072
s_add_u32 m0, s32, 0
s_nop 0
buffer_load_dwordx4 v20, s[8:11], s28 offen lds
s_add_u32 m0, s32, 1024
s_nop 0
buffer_load_dwordx4 v21, s[8:11], s28 offen lds
s_add_u32 m0, s32, 2048
s_nop 0
buffer_load_dwordx4 v22, s[8:11], s28 offen lds
s_add_u32 m0, s32, 3072
s_nop 0
buffer_load_dwordx4 v23, s[8:11], s28 offen lds
s_add_u32 s28, s28, 262144
s_add_u32 m0, s32, 16384
s_nop 0
buffer_load_dwordx4 v20, s[8:11], s28 offen lds
s_add_u32 m0, s32, 17408
s_nop 0
buffer_load_dwordx4 v21, s[8:11], s28 offen lds
s_add_u32 m0, s32, 18432
s_nop 0
buffer_load_dwordx4 v22, s[8:11], s28 offen lds
s_add_u32 m0, s32, 19456
s_nop 0
buffer_load_dwordx4 v23, s[8:11], s28 offen lds
s_add_u32 s28, s28, 262144
s_add_u32 m0, s30, 16384
s_nop 0
buffer_load_dwordx4 v12, s[12:15], s29 offen lds
s_add_u32 m0, s30, 17408
s_nop 0
buffer_load_dwordx4 v13, s[12:15], s29 offen lds
s_add_u32 m0, s30, 18432
s_nop 0
buffer_load_dwordx4 v14, s[12:15], s29 offen lds
s_add_u32 m0, s30, 19456
s_nop 0
buffer_load_dwordx4 v15, s[12:15], s29 offen lds
s_add_u32 m0, s30, 20480
s_nop 0
buffer_load_dwordx4 v16, s[12:15], s29 offen lds
s_add_u32 m0, s30, 21504
s_nop 0
buffer_load_dwordx4 v17, s[12:15], s29 offen lds
s_add_u32 m0, s30, 22528
s_nop 0
buffer_load_dwordx4 v18, s[12:15], s29 offen lds
s_add_u32 m0, s30, 23552
s_nop 0
buffer_load_dwordx4 v19, s[12:15], s29 offen lds
s_add_u32 s29, s29, 131072
s_add_u32 m0, s30, 24576
s_nop 0
buffer_load_dwordx4 v12, s[12:15], s29 offen lds
s_add_u32 m0, s30, 25600
s_nop 0
buffer_load_dwordx4 v13, s[12:15], s29 offen lds
s_add_u32 m0, s30, 26624
s_nop 0
buffer_load_dwordx4 v14, s[12:15], s29 offen lds
s_add_u32 m0, s30, 27648
s_nop 0
buffer_load_dwordx4 v15, s[12:15], s29 offen lds
s_add_u32 m0, s30, 28672
s_nop 0
buffer_load_dwordx4 v16, s[12:15], s29 offen lds
s_add_u32 m0, s30, 29696
s_nop 0
buffer_load_dwordx4 v17, s[12:15], s29 offen lds
s_add_u32 m0, s30, 30720
s_nop 0
buffer_load_dwordx4 v18, s[12:15], s29 offen lds
s_add_u32 m0, s30, 31744
s_nop 0
buffer_load_dwordx4 v19, s[12:15], s29 offen lds
s_add_u32 s29, s29, 131072
v_and_b32 v2, 15, v0
v_lshrrev_b32 v3, 4, v0
v_add_u32 v4, 0, v3
v_xor_b32 v4, v4, v2
v_lshlrev_b32 v4, 4, v4
v_lshl_add_u32 v8, v2, 9, v4
v_add_u32 v4, 4, v3
v_xor_b32 v4, v4, v2
v_lshlrev_b32 v4, 4, v4
v_lshl_add_u32 v9, v2, 9, v4
v_add_u32 v4, 8, v3
v_xor_b32 v4, v4, v2
v_lshlrev_b32 v4, 4, v4
v_lshl_add_u32 v10, v2, 9, v4
v_add_u32 v4, 12, v3
v_xor_b32 v4, v4, v2
v_lshlrev_b32 v4, 4, v4
v_lshl_add_u32 v11, v2, 9, v4
v_add_u32 v24, s30, v8
v_add_u32 v25, s30, v9
v_add_u32 v26, s30, v10
v_add_u32 v27, s30, v11
s_waitcnt vmcnt(32)
ds_read_b128 v[120:123], v24
ds_read_b128 v[124:127], v25
ds_read_b128 v[128:131], v26
ds_read_b128 v[132:135], v27
ds_read_b128 v[136:139], v24 offset:256
ds_read_b128 v[140:143], v25 offset:256
ds_read_b128 v[144:147], v26 offset:256
ds_read_b128 v[148:151], v27 offset:256
s_waitcnt lgkmcnt(0)
s_waitcnt vmcnt(24)
ds_read_b128 v[152:155], v24 offset:8192
ds_read_b128 v[156:159], v25 offset:8192
ds_read_b128 v[160:163], v26 offset:8192
ds_read_b128 v[164:167], v27 offset:8192
ds_read_b128 v[168:171], v24 offset:8448
ds_read_b128 v[172:175], v25 offset:8448
ds_read_b128 v[176:179], v26 offset:8448
ds_read_b128 v[180:183], v27 offset:8448
s_waitcnt lgkmcnt(0)
s_waitcnt vmcnt(8)
ds_read_b128 v[184:187], v24 offset:16384
ds_read_b128 v[188:191], v25 offset:16384
ds_read_b128 v[192:195], v26 offset:16384
ds_read_b128 v[196:199], v27 offset:16384
ds_read_b128 v[200:203], v24 offset:16640
ds_read_b128 v[204:207], v25 offset:16640
ds_read_b128 v[208:211], v26 offset:16640
ds_read_b128 v[212:215], v27 offset:16640
s_waitcnt lgkmcnt(0)
s_waitcnt vmcnt(0)
ds_read_b128 v[216:219], v24 offset:24576
ds_read_b128 v[220:223], v25 offset:24576
ds_read_b128 v[224:227], v26 offset:24576
ds_read_b128 v[228:231], v27 offset:24576
ds_read_b128 v[232:235], v24 offset:24832
ds_read_b128 v[236:239], v25 offset:24832
ds_read_b128 v[240:243], v26 offset:24832
ds_read_b128 v[244:247], v27 offset:24832
s_waitcnt lgkmcnt(0)
v_add_u32 v24, 65536, v8
v_add_u32 v12, 131072, v8
v_add_u32 v25, 65536, v9
v_add_u32 v13, 131072, v9
v_add_u32 v26, 65536, v10
v_add_u32 v14, 131072, v10
v_add_u32 v27, 65536, v11
v_add_u32 v15, 131072, v11
s_waitcnt vmcnt(0)
s_barrier
v_add_u32 v28, s32, v1
v_add_u32 v29, 65536, v28
v_add_u32 v30, 131072, v28
v_lshrrev_b32 v2, 1, v0
v_lshlrev_b32 v2, 2, v2
v_min_u32 v3, 6, v0
v_lshlrev_b32 v3, 2, v3
s_lshl_b32 s29, s26, 7
s_add_u32 m0, s32, 32768
s_nop 0
buffer_load_dwordx4 v20, s[8:11], s28 offen lds
s_add_u32 m0, s32, 33792
s_nop 0
buffer_load_dwordx4 v21, s[8:11], s28 offen lds
s_add_u32 m0, s32, 34816
s_nop 0
buffer_load_dwordx4 v22, s[8:11], s28 offen lds
s_add_u32 m0, s32, 35840
s_nop 0
buffer_load_dwordx4 v23, s[8:11], s28 offen lds
s_add_u32 s28, s28, 262144
s_add_u32 m0, s32, 49152
s_nop 0
buffer_load_dwordx4 v20, s[8:11], s28 offen lds
s_add_u32 m0, s32, 50176
s_nop 0
buffer_load_dwordx4 v21, s[8:11], s28 offen lds
s_add_u32 m0, s32, 51200
s_nop 0
buffer_load_dwordx4 v22, s[8:11], s28 offen lds
s_add_u32 m0, s32, 52224
s_nop 0
buffer_load_dwordx4 v23, s[8:11], s28 offen lds
s_add_u32 s28, s28, 262144
ds_read_b128 v[32:35], v8
ds_read_b128 v[36:39], v8 offset:8192
s_barrier
s_waitcnt lgkmcnt(0)
v_mfma_f32_16x16x32_bf16 v[48:51], v[32:35], v[120:123], 0
ds_read_b128 v[40:43], v9
ds_read_b128 v[44:47], v9 offset:8192
v_mfma_f32_16x16x32_bf16 v[52:55], v[36:39], v[120:123], 0
v_mfma_f32_16x16x32_bf16 v[56:59], v[32:35], v[152:155], 0
v_mfma_f32_16x16x32_bf16 v[60:63], v[36:39], v[152:155], 0
v_mfma_f32_16x16x32_bf16 v[64:67], v[32:35], v[184:187], 0
v_mfma_f32_16x16x32_bf16 v[68:71], v[36:39], v[184:187], 0
v_mfma_f32_16x16x32_bf16 v[72:75], v[32:35], v[216:219], 0
v_mfma_f32_16x16x32_bf16 v[76:79], v[36:39], v[216:219], 0
s_waitcnt lgkmcnt(0)
v_mfma_f32_16x16x32_bf16 v[48:51], v[40:43], v[124:127], v[48:51]
ds_read_b128 v[32:35], v10
ds_read_b128 v[36:39], v10 offset:8192
v_mfma_f32_16x16x32_bf16 v[52:55], v[44:47], v[124:127], v[52:55]
v_mfma_f32_16x16x32_bf16 v[56:59], v[40:43], v[156:159], v[56:59]
s_add_u32 m0, s32, 65536
s_nop 0
buffer_load_dwordx4 v20, s[8:11], s28 offen lds
v_mfma_f32_16x16x32_bf16 v[60:63], v[44:47], v[156:159], v[60:63]
v_mfma_f32_16x16x32_bf16 v[64:67], v[40:43], v[188:191], v[64:67]
v_mfma_f32_16x16x32_bf16 v[68:71], v[44:47], v[188:191], v[68:71]
v_mfma_f32_16x16x32_bf16 v[72:75], v[40:43], v[220:223], v[72:75]
v_mfma_f32_16x16x32_bf16 v[76:79], v[44:47], v[220:223], v[76:79]
s_waitcnt lgkmcnt(0)
v_mfma_f32_16x16x32_bf16 v[48:51], v[32:35], v[128:131], v[48:51]
ds_read_b128 v[40:43], v11
ds_read_b128 v[44:47], v11 offset:8192
v_mfma_f32_16x16x32_bf16 v[52:55], v[36:39], v[128:131], v[52:55]
v_mfma_f32_16x16x32_bf16 v[56:59], v[32:35], v[160:163], v[56:59]
v_mfma_f32_16x16x32_bf16 v[60:63], v[36:39], v[160:163], v[60:63]
v_mfma_f32_16x16x32_bf16 v[64:67], v[32:35], v[192:195], v[64:67]
v_mfma_f32_16x16x32_bf16 v[68:71], v[36:39], v[192:195], v[68:71]
v_mfma_f32_16x16x32_bf16 v[72:75], v[32:35], v[224:227], v[72:75]
v_mfma_f32_16x16x32_bf16 v[76:79], v[36:39], v[224:227], v[76:79]
s_waitcnt lgkmcnt(0)
v_mfma_f32_16x16x32_bf16 v[48:51], v[40:43], v[132:135], v[48:51]
ds_read_b128 v[32:35], v8 offset:256
ds_read_b128 v[36:39], v8 offset:8448
v_mfma_f32_16x16x32_bf16 v[52:55], v[44:47], v[132:135], v[52:55]
v_mfma_f32_16x16x32_bf16 v[56:59], v[40:43], v[164:167], v[56:59]
s_add_u32 m0, s32, 66560
s_nop 0
buffer_load_dwordx4 v21, s[8:11], s28 offen lds
v_mfma_f32_16x16x32_bf16 v[60:63], v[44:47], v[164:167], v[60:63]
v_mfma_f32_16x16x32_bf16 v[64:67], v[40:43], v[196:199], v[64:67]
v_mfma_f32_16x16x32_bf16 v[68:71], v[44:47], v[196:199], v[68:71]
v_mfma_f32_16x16x32_bf16 v[72:75], v[40:43], v[228:231], v[72:75]
v_mfma_f32_16x16x32_bf16 v[76:79], v[44:47], v[228:231], v[76:79]
s_waitcnt lgkmcnt(0)
v_mfma_f32_16x16x32_bf16 v[48:51], v[32:35], v[136:139], v[48:51]
ds_read_b128 v[40:43], v9 offset:256
ds_read_b128 v[44:47], v9 offset:8448
v_mfma_f32_16x16x32_bf16 v[52:55], v[36:39], v[136:139], v[52:55]
v_mfma_f32_16x16x32_bf16 v[56:59], v[32:35], v[168:171], v[56:59]
v_mfma_f32_16x16x32_bf16 v[60:63], v[36:39], v[168:171], v[60:63]
v_mfma_f32_16x16x32_bf16 v[64:67], v[32:35], v[200:203], v[64:67]
v_mfma_f32_16x16x32_bf16 v[68:71], v[36:39], v[200:203], v[68:71]
v_mfma_f32_16x16x32_bf16 v[72:75], v[32:35], v[232:235], v[72:75]
v_mfma_f32_16x16x32_bf16 v[76:79], v[36:39], v[232:235], v[76:79]
s_waitcnt lgkmcnt(0)
v_mfma_f32_16x16x32_bf16 v[48:51], v[40:43], v[140:143], v[48:51]
ds_read_b128 v[32:35], v10 offset:256
ds_read_b128 v[36:39], v10 offset:8448
v_mfma_f32_16x16x32_bf16 v[52:55], v[44:47], v[140:143], v[52:55]
v_mfma_f32_16x16x32_bf16 v[56:59], v[40:43], v[172:175], v[56:59]
s_add_u32 m0, s32, 67584
s_nop 0
buffer_load_dwordx4 v22, s[8:11], s28 offen lds
v_mfma_f32_16x16x32_bf16 v[60:63], v[44:47], v[172:175], v[60:63]
v_mfma_f32_16x16x32_bf16 v[64:67], v[40:43], v[204:207], v[64:67]
v_mfma_f32_16x16x32_bf16 v[68:71], v[44:47], v[204:207], v[68:71]
v_mfma_f32_16x16x32_bf16 v[72:75], v[40:43], v[236:239], v[72:75]
v_mfma_f32_16x16x32_bf16 v[76:79], v[44:47], v[236:239], v[76:79]
s_waitcnt lgkmcnt(0)
v_mfma_f32_16x16x32_bf16 v[48:51], v[32:35], v[144:147], v[48:51]
ds_read_b128 v[40:43], v11 offset:256
ds_read_b128 v[44:47], v11 offset:8448
v_mfma_f32_16x16x32_bf16 v[52:55], v[36:39], v[144:147], v[52:55]
v_mfma_f32_16x16x32_bf16 v[56:59], v[32:35], v[176:179], v[56:59]
v_mfma_f32_16x16x32_bf16 v[60:63], v[36:39], v[176:179], v[60:63]
v_mfma_f32_16x16x32_bf16 v[64:67], v[32:35], v[208:211], v[64:67]
v_mfma_f32_16x16x32_bf16 v[68:71], v[36:39], v[208:211], v[68:71]
v_mfma_f32_16x16x32_bf16 v[72:75], v[32:35], v[240:243], v[72:75]
v_mfma_f32_16x16x32_bf16 v[76:79], v[36:39], v[240:243], v[76:79]
s_waitcnt lgkmcnt(0)
v_mfma_f32_16x16x32_bf16 v[48:51], v[40:43], v[148:151], v[48:51]
ds_read_b128 v[32:35], v8 offset:16384
ds_read_b128 v[36:39], v8 offset:24576
v_mfma_f32_16x16x32_bf16 v[52:55], v[44:47], v[148:151], v[52:55]
v_mfma_f32_16x16x32_bf16 v[56:59], v[40:43], v[180:183], v[56:59]
s_add_u32 m0, s32, 68608
s_nop 0
buffer_load_dwordx4 v23, s[8:11], s28 offen lds
s_add_u32 s28, s28, 262144
v_mfma_f32_16x16x32_bf16 v[60:63], v[44:47], v[180:183], v[60:63]
v_mfma_f32_16x16x32_bf16 v[64:67], v[40:43], v[212:215], v[64:67]
v_mfma_f32_16x16x32_bf16 v[68:71], v[44:47], v[212:215], v[68:71]
v_mfma_f32_16x16x32_bf16 v[72:75], v[40:43], v[244:247], v[72:75]
v_mfma_f32_16x16x32_bf16 v[76:79], v[44:47], v[244:247], v[76:79]
s_waitcnt vmcnt(8)
s_barrier
s_waitcnt lgkmcnt(0)
v_mfma_f32_16x16x32_bf16 v[80:83], v[32:35], v[120:123], 0
ds_read_b128 v[40:43], v9 offset:16384
ds_read_b128 v[44:47], v9 offset:24576
v_mfma_f32_16x16x32_bf16 v[84:87], v[36:39], v[120:123], 0
v_mfma_f32_16x16x32_bf16 v[88:91], v[32:35], v[152:155], 0
v_mfma_f32_16x16x32_bf16 v[92:95], v[36:39], v[152:155], 0
v_mul_f32 v48, s31, v48
v_mul_f32 v49, s31, v49
v_mfma_f32_16x16x32_bf16 v[96:99], v[32:35], v[184:187], 0
v_mul_f32 v50, s31, v50
v_mul_f32 v51, s31, v51
v_mfma_f32_16x16x32_bf16 v[100:103], v[36:39], v[184:187], 0
v_mul_f32 v52, s31, v52
v_mul_f32 v53, s31, v53
v_mfma_f32_16x16x32_bf16 v[104:107], v[32:35], v[216:219], 0
v_mul_f32 v54, s31, v54
v_mul_f32 v55, s31, v55
v_mfma_f32_16x16x32_bf16 v[108:111], v[36:39], v[216:219], 0
v_cvt_pk_bf16_f32 v48, v48, v49
v_cvt_pk_bf16_f32 v50, v50, v51
s_waitcnt lgkmcnt(0)
v_mfma_f32_16x16x32_bf16 v[80:83], v[40:43], v[124:127], v[80:83]
ds_read_b128 v[32:35], v10 offset:16384
ds_read_b128 v[36:39], v10 offset:24576
v_mfma_f32_16x16x32_bf16 v[84:87], v[44:47], v[124:127], v[84:87]
v_cvt_pk_bf16_f32 v52, v52, v53
v_cvt_pk_bf16_f32 v54, v54, v55
v_mfma_f32_16x16x32_bf16 v[88:91], v[40:43], v[156:159], v[88:91]
s_add_u32 m0, s32, 81920
s_nop 0
buffer_load_dwordx4 v20, s[8:11], s28 offen lds
v_accvgpr_write_b32 a0, v48
v_accvgpr_write_b32 a1, v50
v_mfma_f32_16x16x32_bf16 v[92:95], v[44:47], v[156:159], v[92:95]
v_accvgpr_write_b32 a2, v52
v_accvgpr_write_b32 a3, v54
v_mfma_f32_16x16x32_bf16 v[96:99], v[40:43], v[188:191], v[96:99]
v_mul_f32 v56, s31, v56
v_mul_f32 v57, s31, v57
v_mfma_f32_16x16x32_bf16 v[100:103], v[44:47], v[188:191], v[100:103]
v_mul_f32 v58, s31, v58
v_mul_f32 v59, s31, v59
v_mfma_f32_16x16x32_bf16 v[104:107], v[40:43], v[220:223], v[104:107]
v_mul_f32 v60, s31, v60
v_mul_f32 v61, s31, v61
v_mfma_f32_16x16x32_bf16 v[108:111], v[44:47], v[220:223], v[108:111]
v_mul_f32 v62, s31, v62
v_mul_f32 v63, s31, v63
s_waitcnt lgkmcnt(0)
v_mfma_f32_16x16x32_bf16 v[80:83], v[32:35], v[128:131], v[80:83]
ds_read_b128 v[40:43], v11 offset:16384
ds_read_b128 v[44:47], v11 offset:24576
v_mfma_f32_16x16x32_bf16 v[84:87], v[36:39], v[128:131], v[84:87]
v_cvt_pk_bf16_f32 v56, v56, v57
v_cvt_pk_bf16_f32 v58, v58, v59
v_mfma_f32_16x16x32_bf16 v[88:91], v[32:35], v[160:163], v[88:91]
v_cvt_pk_bf16_f32 v60, v60, v61
v_cvt_pk_bf16_f32 v62, v62, v63
v_mfma_f32_16x16x32_bf16 v[92:95], v[36:39], v[160:163], v[92:95]
v_accvgpr_write_b32 a56, v56
v_accvgpr_write_b32 a57, v58
v_mfma_f32_16x16x32_bf16 v[96:99], v[32:35], v[192:195], v[96:99]
v_accvgpr_write_b32 a58, v60
v_accvgpr_write_b32 a59, v62
v_mfma_f32_16x16x32_bf16 v[100:103], v[36:39], v[192:195], v[100:103]
v_mul_f32 v64, s31, v64
v_mul_f32 v65, s31, v65
v_mfma_f32_16x16x32_bf16 v[104:107], v[32:35], v[224:227], v[104:107]
v_mul_f32 v66, s31, v66
v_mul_f32 v67, s31, v67
v_mfma_f32_16x16x32_bf16 v[108:111], v[36:39], v[224:227], v[108:111]
v_mul_f32 v68, s31, v68
v_mul_f32 v69, s31, v69
s_waitcnt lgkmcnt(0)
v_mfma_f32_16x16x32_bf16 v[80:83], v[40:43], v[132:135], v[80:83]
ds_read_b128 v[32:35], v8 offset:16640
ds_read_b128 v[36:39], v8 offset:24832
v_mfma_f32_16x16x32_bf16 v[84:87], v[44:47], v[132:135], v[84:87]
v_mul_f32 v70, s31, v70
v_mul_f32 v71, s31, v71
v_mfma_f32_16x16x32_bf16 v[88:91], v[40:43], v[164:167], v[88:91]
s_add_u32 m0, s32, 82944
s_nop 0
buffer_load_dwordx4 v21, s[8:11], s28 offen lds
v_cvt_pk_bf16_f32 v64, v64, v65
v_cvt_pk_bf16_f32 v66, v66, v67
v_mfma_f32_16x16x32_bf16 v[92:95], v[44:47], v[164:167], v[92:95]
v_cvt_pk_bf16_f32 v68, v68, v69
v_cvt_pk_bf16_f32 v70, v70, v71
v_mfma_f32_16x16x32_bf16 v[96:99], v[40:43], v[196:199], v[96:99]
v_accvgpr_write_b32 a112, v64
v_accvgpr_write_b32 a113, v66
v_mfma_f32_16x16x32_bf16 v[100:103], v[44:47], v[196:199], v[100:103]
v_accvgpr_write_b32 a114, v68
v_accvgpr_write_b32 a115, v70
v_mfma_f32_16x16x32_bf16 v[104:107], v[40:43], v[228:231], v[104:107]
v_mul_f32 v72, s31, v72
v_mul_f32 v73, s31, v73
v_mfma_f32_16x16x32_bf16 v[108:111], v[44:47], v[228:231], v[108:111]
v_mul_f32 v74, s31, v74
v_mul_f32 v75, s31, v75
s_waitcnt lgkmcnt(0)
v_mfma_f32_16x16x32_bf16 v[80:83], v[32:35], v[136:139], v[80:83]
ds_read_b128 v[40:43], v9 offset:16640
ds_read_b128 v[44:47], v9 offset:24832
v_mfma_f32_16x16x32_bf16 v[84:87], v[36:39], v[136:139], v[84:87]
v_mul_f32 v76, s31, v76
v_mul_f32 v77, s31, v77
v_mfma_f32_16x16x32_bf16 v[88:91], v[32:35], v[168:171], v[88:91]
v_mul_f32 v78, s31, v78
v_mul_f32 v79, s31, v79
v_mfma_f32_16x16x32_bf16 v[92:95], v[36:39], v[168:171], v[92:95]
v_cvt_pk_bf16_f32 v72, v72, v73
v_cvt_pk_bf16_f32 v74, v74, v75
v_mfma_f32_16x16x32_bf16 v[96:99], v[32:35], v[200:203], v[96:99]
v_cvt_pk_bf16_f32 v76, v76, v77
v_cvt_pk_bf16_f32 v78, v78, v79
v_mfma_f32_16x16x32_bf16 v[100:103], v[36:39], v[200:203], v[100:103]
v_accvgpr_write_b32 a168, v72
v_accvgpr_write_b32 a169, v74
v_mfma_f32_16x16x32_bf16 v[104:107], v[32:35], v[232:235], v[104:107]
v_accvgpr_write_b32 a170, v76
v_accvgpr_write_b32 a171, v78
v_mfma_f32_16x16x32_bf16 v[108:111], v[36:39], v[232:235], v[108:111]
s_waitcnt lgkmcnt(0)
v_mfma_f32_16x16x32_bf16 v[80:83], v[40:43], v[140:143], v[80:83]
ds_read_b128 v[32:35], v10 offset:16640
ds_read_b128 v[36:39], v10 offset:24832
v_mfma_f32_16x16x32_bf16 v[84:87], v[44:47], v[140:143], v[84:87]
v_mfma_f32_16x16x32_bf16 v[88:91], v[40:43], v[172:175], v[88:91]
s_add_u32 m0, s32, 83968
s_nop 0
buffer_load_dwordx4 v22, s[8:11], s28 offen lds
v_mfma_f32_16x16x32_bf16 v[92:95], v[44:47], v[172:175], v[92:95]
v_mfma_f32_16x16x32_bf16 v[96:99], v[40:43], v[204:207], v[96:99]
v_mfma_f32_16x16x32_bf16 v[100:103], v[44:47], v[204:207], v[100:103]
v_mfma_f32_16x16x32_bf16 v[104:107], v[40:43], v[236:239], v[104:107]
v_mfma_f32_16x16x32_bf16 v[108:111], v[44:47], v[236:239], v[108:111]
s_waitcnt lgkmcnt(0)
v_mfma_f32_16x16x32_bf16 v[80:83], v[32:35], v[144:147], v[80:83]
ds_read_b128 v[40:43], v11 offset:16640
ds_read_b128 v[44:47], v11 offset:24832
v_mfma_f32_16x16x32_bf16 v[84:87], v[36:39], v[144:147], v[84:87]
v_mfma_f32_16x16x32_bf16 v[88:91], v[32:35], v[176:179], v[88:91]
v_mfma_f32_16x16x32_bf16 v[92:95], v[36:39], v[176:179], v[92:95]
v_mfma_f32_16x16x32_bf16 v[96:99], v[32:35], v[208:211], v[96:99]
v_mfma_f32_16x16x32_bf16 v[100:103], v[36:39], v[208:211], v[100:103]
v_mfma_f32_16x16x32_bf16 v[104:107], v[32:35], v[240:243], v[104:107]
v_mfma_f32_16x16x32_bf16 v[108:111], v[36:39], v[240:243], v[108:111]
s_waitcnt lgkmcnt(0)
v_mfma_f32_16x16x32_bf16 v[80:83], v[40:43], v[148:151], v[80:83]
ds_read_b128 v[32:35], v8 offset:32768
ds_read_b128 v[36:39], v8 offset:40960
v_mfma_f32_16x16x32_bf16 v[84:87], v[44:47], v[148:151], v[84:87]
v_mfma_f32_16x16x32_bf16 v[88:91], v[40:43], v[180:183], v[88:91]
s_add_u32 m0, s32, 84992
s_nop 0
buffer_load_dwordx4 v23, s[8:11], s28 offen lds
s_add_u32 s28, s28, 262144
v_mfma_f32_16x16x32_bf16 v[92:95], v[44:47], v[180:183], v[92:95]
v_mfma_f32_16x16x32_bf16 v[96:99], v[40:43], v[212:215], v[96:99]
v_mfma_f32_16x16x32_bf16 v[100:103], v[44:47], v[212:215], v[100:103]
v_mfma_f32_16x16x32_bf16 v[104:107], v[40:43], v[244:247], v[104:107]
v_mfma_f32_16x16x32_bf16 v[108:111], v[44:47], v[244:247], v[108:111]
s_waitcnt vmcnt(8)
s_barrier
s_waitcnt lgkmcnt(0)
v_mfma_f32_16x16x32_bf16 v[48:51], v[32:35], v[120:123], 0
ds_read_b128 v[40:43], v9 offset:32768
ds_read_b128 v[44:47], v9 offset:40960
v_mfma_f32_16x16x32_bf16 v[52:55], v[36:39], v[120:123], 0
v_mfma_f32_16x16x32_bf16 v[56:59], v[32:35], v[152:155], 0
v_mfma_f32_16x16x32_bf16 v[60:63], v[36:39], v[152:155], 0
v_mul_f32 v80, s31, v80
v_mul_f32 v81, s31, v81
v_mfma_f32_16x16x32_bf16 v[64:67], v[32:35], v[184:187], 0
v_mul_f32 v82, s31, v82
v_mul_f32 v83, s31, v83
v_mfma_f32_16x16x32_bf16 v[68:71], v[36:39], v[184:187], 0
v_mul_f32 v84, s31, v84
v_mul_f32 v85, s31, v85
v_mfma_f32_16x16x32_bf16 v[72:75], v[32:35], v[216:219], 0
v_mul_f32 v86, s31, v86
v_mul_f32 v87, s31, v87
v_mfma_f32_16x16x32_bf16 v[76:79], v[36:39], v[216:219], 0
v_cvt_pk_bf16_f32 v80, v80, v81
v_cvt_pk_bf16_f32 v82, v82, v83
s_waitcnt lgkmcnt(0)
v_mfma_f32_16x16x32_bf16 v[48:51], v[40:43], v[124:127], v[48:51]
ds_read_b128 v[32:35], v10 offset:32768
ds_read_b128 v[36:39], v10 offset:40960
v_mfma_f32_16x16x32_bf16 v[52:55], v[44:47], v[124:127], v[52:55]
v_cvt_pk_bf16_f32 v84, v84, v85
v_cvt_pk_bf16_f32 v86, v86, v87
v_mfma_f32_16x16x32_bf16 v[56:59], v[40:43], v[156:159], v[56:59]
s_add_u32 m0, s32, 98304
s_nop 0
buffer_load_dwordx4 v20, s[8:11], s28 offen lds
v_accvgpr_write_b32 a4, v80
v_accvgpr_write_b32 a5, v82
v_mfma_f32_16x16x32_bf16 v[60:63], v[44:47], v[156:159], v[60:63]
v_accvgpr_write_b32 a6, v84
v_accvgpr_write_b32 a7, v86
v_mfma_f32_16x16x32_bf16 v[64:67], v[40:43], v[188:191], v[64:67]
v_mul_f32 v88, s31, v88
v_mul_f32 v89, s31, v89
v_mfma_f32_16x16x32_bf16 v[68:71], v[44:47], v[188:191], v[68:71]
v_mul_f32 v90, s31, v90
v_mul_f32 v91, s31, v91
v_mfma_f32_16x16x32_bf16 v[72:75], v[40:43], v[220:223], v[72:75]
v_mul_f32 v92, s31, v92
v_mul_f32 v93, s31, v93
v_mfma_f32_16x16x32_bf16 v[76:79], v[44:47], v[220:223], v[76:79]
v_mul_f32 v94, s31, v94
v_mul_f32 v95, s31, v95
s_waitcnt lgkmcnt(0)
v_mfma_f32_16x16x32_bf16 v[48:51], v[32:35], v[128:131], v[48:51]
ds_read_b128 v[40:43], v11 offset:32768
ds_read_b128 v[44:47], v11 offset:40960
v_mfma_f32_16x16x32_bf16 v[52:55], v[36:39], v[128:131], v[52:55]
v_cvt_pk_bf16_f32 v88, v88, v89
v_cvt_pk_bf16_f32 v90, v90, v91
v_mfma_f32_16x16x32_bf16 v[56:59], v[32:35], v[160:163], v[56:59]
v_cvt_pk_bf16_f32 v92, v92, v93
v_cvt_pk_bf16_f32 v94, v94, v95
v_mfma_f32_16x16x32_bf16 v[60:63], v[36:39], v[160:163], v[60:63]
v_accvgpr_write_b32 a60, v88
v_accvgpr_write_b32 a61, v90
v_mfma_f32_16x16x32_bf16 v[64:67], v[32:35], v[192:195], v[64:67]
v_accvgpr_write_b32 a62, v92
v_accvgpr_write_b32 a63, v94
v_mfma_f32_16x16x32_bf16 v[68:71], v[36:39], v[192:195], v[68:71]
v_mul_f32 v96, s31, v96
v_mul_f32 v97, s31, v97
v_mfma_f32_16x16x32_bf16 v[72:75], v[32:35], v[224:227], v[72:75]
v_mul_f32 v98, s31, v98
v_mul_f32 v99, s31, v99
v_mfma_f32_16x16x32_bf16 v[76:79], v[36:39], v[224:227], v[76:79]
v_mul_f32 v100, s31, v100
v_mul_f32 v101, s31, v101
s_waitcnt lgkmcnt(0)
v_mfma_f32_16x16x32_bf16 v[48:51], v[40:43], v[132:135], v[48:51]
ds_read_b128 v[32:35], v8 offset:33024
ds_read_b128 v[36:39], v8 offset:41216
v_mfma_f32_16x16x32_bf16 v[52:55], v[44:47], v[132:135], v[52:55]
v_mul_f32 v102, s31, v102
v_mul_f32 v103, s31, v103
v_mfma_f32_16x16x32_bf16 v[56:59], v[40:43], v[164:167], v[56:59]
s_add_u32 m0, s32, 99328
s_nop 0
buffer_load_dwordx4 v21, s[8:11], s28 offen lds
v_cvt_pk_bf16_f32 v96, v96, v97
v_cvt_pk_bf16_f32 v98, v98, v99
v_mfma_f32_16x16x32_bf16 v[60:63], v[44:47], v[164:167], v[60:63]
v_cvt_pk_bf16_f32 v100, v100, v101
v_cvt_pk_bf16_f32 v102, v102, v103
v_mfma_f32_16x16x32_bf16 v[64:67], v[40:43], v[196:199], v[64:67]
v_accvgpr_write_b32 a116, v96
v_accvgpr_write_b32 a117, v98
v_mfma_f32_16x16x32_bf16 v[68:71], v[44:47], v[196:199], v[68:71]
v_accvgpr_write_b32 a118, v100
v_accvgpr_write_b32 a119, v102
v_mfma_f32_16x16x32_bf16 v[72:75], v[40:43], v[228:231], v[72:75]
v_mul_f32 v104, s31, v104
v_mul_f32 v105, s31, v105
v_mfma_f32_16x16x32_bf16 v[76:79], v[44:47], v[228:231], v[76:79]
v_mul_f32 v106, s31, v106
v_mul_f32 v107, s31, v107
s_waitcnt lgkmcnt(0)
v_mfma_f32_16x16x32_bf16 v[48:51], v[32:35], v[136:139], v[48:51]
ds_read_b128 v[40:43], v9 offset:33024
ds_read_b128 v[44:47], v9 offset:41216
v_mfma_f32_16x16x32_bf16 v[52:55], v[36:39], v[136:139], v[52:55]
v_mul_f32 v108, s31, v108
v_mul_f32 v109, s31, v109
v_mfma_f32_16x16x32_bf16 v[56:59], v[32:35], v[168:171], v[56:59]
v_mul_f32 v110, s31, v110
v_mul_f32 v111, s31, v111
v_mfma_f32_16x16x32_bf16 v[60:63], v[36:39], v[168:171], v[60:63]
v_cvt_pk_bf16_f32 v104, v104, v105
v_cvt_pk_bf16_f32 v106, v106, v107
v_mfma_f32_16x16x32_bf16 v[64:67], v[32:35], v[200:203], v[64:67]
v_cvt_pk_bf16_f32 v108, v108, v109
v_cvt_pk_bf16_f32 v110, v110, v111
v_mfma_f32_16x16x32_bf16 v[68:71], v[36:39], v[200:203], v[68:71]
v_accvgpr_write_b32 a172, v104
v_accvgpr_write_b32 a173, v106
v_mfma_f32_16x16x32_bf16 v[72:75], v[32:35], v[232:235], v[72:75]
v_accvgpr_write_b32 a174, v108
v_accvgpr_write_b32 a175, v110
v_mfma_f32_16x16x32_bf16 v[76:79], v[36:39], v[232:235], v[76:79]
s_waitcnt lgkmcnt(0)
v_mfma_f32_16x16x32_bf16 v[48:51], v[40:43], v[140:143], v[48:51]
ds_read_b128 v[32:35], v10 offset:33024
ds_read_b128 v[36:39], v10 offset:41216
v_mfma_f32_16x16x32_bf16 v[52:55], v[44:47], v[140:143], v[52:55]
v_mfma_f32_16x16x32_bf16 v[56:59], v[40:43], v[172:175], v[56:59]
s_add_u32 m0, s32, 100352
s_nop 0
buffer_load_dwordx4 v22, s[8:11], s28 offen lds
v_mfma_f32_16x16x32_bf16 v[60:63], v[44:47], v[172:175], v[60:63]
v_mfma_f32_16x16x32_bf16 v[64:67], v[40:43], v[204:207], v[64:67]
v_mfma_f32_16x16x32_bf16 v[68:71], v[44:47], v[204:207], v[68:71]
v_mfma_f32_16x16x32_bf16 v[72:75], v[40:43], v[236:239], v[72:75]
v_mfma_f32_16x16x32_bf16 v[76:79], v[44:47], v[236:239], v[76:79]
s_waitcnt lgkmcnt(0)
v_mfma_f32_16x16x32_bf16 v[48:51], v[32:35], v[144:147], v[48:51]
ds_read_b128 v[40:43], v11 offset:33024
ds_read_b128 v[44:47], v11 offset:41216
v_mfma_f32_16x16x32_bf16 v[52:55], v[36:39], v[144:147], v[52:55]
v_mfma_f32_16x16x32_bf16 v[56:59], v[32:35], v[176:179], v[56:59]
v_mfma_f32_16x16x32_bf16 v[60:63], v[36:39], v[176:179], v[60:63]
v_mfma_f32_16x16x32_bf16 v[64:67], v[32:35], v[208:211], v[64:67]
v_mfma_f32_16x16x32_bf16 v[68:71], v[36:39], v[208:211], v[68:71]
v_mfma_f32_16x16x32_bf16 v[72:75], v[32:35], v[240:243], v[72:75]
v_mfma_f32_16x16x32_bf16 v[76:79], v[36:39], v[240:243], v[76:79]
s_waitcnt lgkmcnt(0)
v_mfma_f32_16x16x32_bf16 v[48:51], v[40:43], v[148:151], v[48:51]
ds_read_b128 v[32:35], v8 offset:49152
ds_read_b128 v[36:39], v8 offset:57344
v_mfma_f32_16x16x32_bf16 v[52:55], v[44:47], v[148:151], v[52:55]
v_mfma_f32_16x16x32_bf16 v[56:59], v[40:43], v[180:183], v[56:59]
s_add_u32 m0, s32, 101376
s_nop 0
buffer_load_dwordx4 v23, s[8:11], s28 offen lds
s_add_u32 s28, s28, 262144
v_mfma_f32_16x16x32_bf16 v[60:63], v[44:47], v[180:183], v[60:63]
v_mfma_f32_16x16x32_bf16 v[64:67], v[40:43], v[212:215], v[64:67]
v_mfma_f32_16x16x32_bf16 v[68:71], v[44:47], v[212:215], v[68:71]
v_mfma_f32_16x16x32_bf16 v[72:75], v[40:43], v[244:247], v[72:75]
v_mfma_f32_16x16x32_bf16 v[76:79], v[44:47], v[244:247], v[76:79]
s_waitcnt vmcnt(8)
s_barrier
s_waitcnt lgkmcnt(0)
v_mfma_f32_16x16x32_bf16 v[80:83], v[32:35], v[120:123], 0
ds_read_b128 v[40:43], v9 offset:49152
ds_read_b128 v[44:47], v9 offset:57344
v_mfma_f32_16x16x32_bf16 v[84:87], v[36:39], v[120:123], 0
v_mfma_f32_16x16x32_bf16 v[88:91], v[32:35], v[152:155], 0
v_mfma_f32_16x16x32_bf16 v[92:95], v[36:39], v[152:155], 0
v_mul_f32 v48, s31, v48
v_mul_f32 v49, s31, v49
v_mfma_f32_16x16x32_bf16 v[96:99], v[32:35], v[184:187], 0
v_mul_f32 v50, s31, v50
v_mul_f32 v51, s31, v51
v_mfma_f32_16x16x32_bf16 v[100:103], v[36:39], v[184:187], 0
v_mul_f32 v52, s31, v52
v_mul_f32 v53, s31, v53
v_mfma_f32_16x16x32_bf16 v[104:107], v[32:35], v[216:219], 0
v_mul_f32 v54, s31, v54
v_mul_f32 v55, s31, v55
v_mfma_f32_16x16x32_bf16 v[108:111], v[36:39], v[216:219], 0
v_cvt_pk_bf16_f32 v48, v48, v49
v_cvt_pk_bf16_f32 v50, v50, v51
s_waitcnt lgkmcnt(0)
v_mfma_f32_16x16x32_bf16 v[80:83], v[40:43], v[124:127], v[80:83]
ds_read_b128 v[32:35], v10 offset:49152
ds_read_b128 v[36:39], v10 offset:57344
v_mfma_f32_16x16x32_bf16 v[84:87], v[44:47], v[124:127], v[84:87]
v_cvt_pk_bf16_f32 v52, v52, v53
v_cvt_pk_bf16_f32 v54, v54, v55
v_mfma_f32_16x16x32_bf16 v[88:91], v[40:43], v[156:159], v[88:91]
s_add_u32 m0, s32, 114688
s_nop 0
buffer_load_dwordx4 v20, s[8:11], s28 offen lds
v_accvgpr_write_b32 a8, v48
v_accvgpr_write_b32 a9, v50
v_mfma_f32_16x16x32_bf16 v[92:95], v[44:47], v[156:159], v[92:95]
v_accvgpr_write_b32 a10, v52
v_accvgpr_write_b32 a11, v54
v_mfma_f32_16x16x32_bf16 v[96:99], v[40:43], v[188:191], v[96:99]
v_mul_f32 v56, s31, v56
v_mul_f32 v57, s31, v57
v_mfma_f32_16x16x32_bf16 v[100:103], v[44:47], v[188:191], v[100:103]
v_mul_f32 v58, s31, v58
v_mul_f32 v59, s31, v59
v_mfma_f32_16x16x32_bf16 v[104:107], v[40:43], v[220:223], v[104:107]
v_mul_f32 v60, s31, v60
v_mul_f32 v61, s31, v61
v_mfma_f32_16x16x32_bf16 v[108:111], v[44:47], v[220:223], v[108:111]
v_mul_f32 v62, s31, v62
v_mul_f32 v63, s31, v63
s_waitcnt lgkmcnt(0)
v_mfma_f32_16x16x32_bf16 v[80:83], v[32:35], v[128:131], v[80:83]
ds_read_b128 v[40:43], v11 offset:49152
ds_read_b128 v[44:47], v11 offset:57344
v_mfma_f32_16x16x32_bf16 v[84:87], v[36:39], v[128:131], v[84:87]
v_cvt_pk_bf16_f32 v56, v56, v57
v_cvt_pk_bf16_f32 v58, v58, v59
v_mfma_f32_16x16x32_bf16 v[88:91], v[32:35], v[160:163], v[88:91]
v_cvt_pk_bf16_f32 v60, v60, v61
v_cvt_pk_bf16_f32 v62, v62, v63
v_mfma_f32_16x16x32_bf16 v[92:95], v[36:39], v[160:163], v[92:95]
v_accvgpr_write_b32 a64, v56
v_accvgpr_write_b32 a65, v58
v_mfma_f32_16x16x32_bf16 v[96:99], v[32:35], v[192:195], v[96:99]
v_accvgpr_write_b32 a66, v60
v_accvgpr_write_b32 a67, v62
v_mfma_f32_16x16x32_bf16 v[100:103], v[36:39], v[192:195], v[100:103]
v_mul_f32 v64, s31, v64
v_mul_f32 v65, s31, v65
v_mfma_f32_16x16x32_bf16 v[104:107], v[32:35], v[224:227], v[104:107]
v_mul_f32 v66, s31, v66
v_mul_f32 v67, s31, v67
v_mfma_f32_16x16x32_bf16 v[108:111], v[36:39], v[224:227], v[108:111]
v_mul_f32 v68, s31, v68
v_mul_f32 v69, s31, v69
s_waitcnt lgkmcnt(0)
v_mfma_f32_16x16x32_bf16 v[80:83], v[40:43], v[132:135], v[80:83]
ds_read_b128 v[32:35], v8 offset:49408
ds_read_b128 v[36:39], v8 offset:57600
v_mfma_f32_16x16x32_bf16 v[84:87], v[44:47], v[132:135], v[84:87]
v_mul_f32 v70, s31, v70
v_mul_f32 v71, s31, v71
v_mfma_f32_16x16x32_bf16 v[88:91], v[40:43], v[164:167], v[88:91]
s_add_u32 m0, s32, 115712
s_nop 0
buffer_load_dwordx4 v21, s[8:11], s28 offen lds
v_cvt_pk_bf16_f32 v64, v64, v65
v_cvt_pk_bf16_f32 v66, v66, v67
v_mfma_f32_16x16x32_bf16 v[92:95], v[44:47], v[164:167], v[92:95]
v_cvt_pk_bf16_f32 v68, v68, v69
v_cvt_pk_bf16_f32 v70, v70, v71
v_mfma_f32_16x16x32_bf16 v[96:99], v[40:43], v[196:199], v[96:99]
v_accvgpr_write_b32 a120, v64
v_accvgpr_write_b32 a121, v66
v_mfma_f32_16x16x32_bf16 v[100:103], v[44:47], v[196:199], v[100:103]
v_accvgpr_write_b32 a122, v68
v_accvgpr_write_b32 a123, v70
v_mfma_f32_16x16x32_bf16 v[104:107], v[40:43], v[228:231], v[104:107]
v_mul_f32 v72, s31, v72
v_mul_f32 v73, s31, v73
v_mfma_f32_16x16x32_bf16 v[108:111], v[44:47], v[228:231], v[108:111]
v_mul_f32 v74, s31, v74
v_mul_f32 v75, s31, v75
s_waitcnt lgkmcnt(0)
v_mfma_f32_16x16x32_bf16 v[80:83], v[32:35], v[136:139], v[80:83]
ds_read_b128 v[40:43], v9 offset:49408
ds_read_b128 v[44:47], v9 offset:57600
v_mfma_f32_16x16x32_bf16 v[84:87], v[36:39], v[136:139], v[84:87]
v_mul_f32 v76, s31, v76
v_mul_f32 v77, s31, v77
v_mfma_f32_16x16x32_bf16 v[88:91], v[32:35], v[168:171], v[88:91]
v_mul_f32 v78, s31, v78
v_mul_f32 v79, s31, v79
v_mfma_f32_16x16x32_bf16 v[92:95], v[36:39], v[168:171], v[92:95]
v_cvt_pk_bf16_f32 v72, v72, v73
v_cvt_pk_bf16_f32 v74, v74, v75
v_mfma_f32_16x16x32_bf16 v[96:99], v[32:35], v[200:203], v[96:99]
v_cvt_pk_bf16_f32 v76, v76, v77
v_cvt_pk_bf16_f32 v78, v78, v79
v_mfma_f32_16x16x32_bf16 v[100:103], v[36:39], v[200:203], v[100:103]
v_accvgpr_write_b32 a176, v72
v_accvgpr_write_b32 a177, v74
v_mfma_f32_16x16x32_bf16 v[104:107], v[32:35], v[232:235], v[104:107]
v_accvgpr_write_b32 a178, v76
v_accvgpr_write_b32 a179, v78
v_mfma_f32_16x16x32_bf16 v[108:111], v[36:39], v[232:235], v[108:111]
s_waitcnt lgkmcnt(0)
v_mfma_f32_16x16x32_bf16 v[80:83], v[40:43], v[140:143], v[80:83]
ds_read_b128 v[32:35], v10 offset:49408
ds_read_b128 v[36:39], v10 offset:57600
v_mfma_f32_16x16x32_bf16 v[84:87], v[44:47], v[140:143], v[84:87]
v_mfma_f32_16x16x32_bf16 v[88:91], v[40:43], v[172:175], v[88:91]
s_add_u32 m0, s32, 116736
s_nop 0
buffer_load_dwordx4 v22, s[8:11], s28 offen lds
v_mfma_f32_16x16x32_bf16 v[92:95], v[44:47], v[172:175], v[92:95]
v_mfma_f32_16x16x32_bf16 v[96:99], v[40:43], v[204:207], v[96:99]
v_mfma_f32_16x16x32_bf16 v[100:103], v[44:47], v[204:207], v[100:103]
v_mfma_f32_16x16x32_bf16 v[104:107], v[40:43], v[236:239], v[104:107]
v_mfma_f32_16x16x32_bf16 v[108:111], v[44:47], v[236:239], v[108:111]
s_waitcnt lgkmcnt(0)
v_mfma_f32_16x16x32_bf16 v[80:83], v[32:35], v[144:147], v[80:83]
ds_read_b128 v[40:43], v11 offset:49408
ds_read_b128 v[44:47], v11 offset:57600
v_mfma_f32_16x16x32_bf16 v[84:87], v[36:39], v[144:147], v[84:87]
v_mfma_f32_16x16x32_bf16 v[88:91], v[32:35], v[176:179], v[88:91]
v_mfma_f32_16x16x32_bf16 v[92:95], v[36:39], v[176:179], v[92:95]
v_mfma_f32_16x16x32_bf16 v[96:99], v[32:35], v[208:211], v[96:99]
v_mfma_f32_16x16x32_bf16 v[100:103], v[36:39], v[208:211], v[100:103]
v_mfma_f32_16x16x32_bf16 v[104:107], v[32:35], v[240:243], v[104:107]
v_mfma_f32_16x16x32_bf16 v[108:111], v[36:39], v[240:243], v[108:111]
s_waitcnt lgkmcnt(0)
v_mfma_f32_16x16x32_bf16 v[80:83], v[40:43], v[148:151], v[80:83]
ds_read_b128 v[32:35], v24
ds_read_b128 v[36:39], v24 offset:8192
v_mfma_f32_16x16x32_bf16 v[84:87], v[44:47], v[148:151], v[84:87]
v_mfma_f32_16x16x32_bf16 v[88:91], v[40:43], v[180:183], v[88:91]
s_add_u32 m0, s32, 117760
s_nop 0
buffer_load_dwordx4 v23, s[8:11], s28 offen lds
s_add_u32 s28, s28, 262144
v_mfma_f32_16x16x32_bf16 v[92:95], v[44:47], v[180:183], v[92:95]
v_mfma_f32_16x16x32_bf16 v[96:99], v[40:43], v[212:215], v[96:99]
v_mfma_f32_16x16x32_bf16 v[100:103], v[44:47], v[212:215], v[100:103]
v_mfma_f32_16x16x32_bf16 v[104:107], v[40:43], v[244:247], v[104:107]
v_mfma_f32_16x16x32_bf16 v[108:111], v[44:47], v[244:247], v[108:111]
s_waitcnt vmcnt(8)
s_barrier
s_waitcnt lgkmcnt(0)
v_mfma_f32_16x16x32_bf16 v[48:51], v[32:35], v[120:123], 0
ds_read_b128 v[40:43], v25
ds_read_b128 v[44:47], v25 offset:8192
v_mfma_f32_16x16x32_bf16 v[52:55], v[36:39], v[120:123], 0
v_mfma_f32_16x16x32_bf16 v[56:59], v[32:35], v[152:155], 0
v_mfma_f32_16x16x32_bf16 v[60:63], v[36:39], v[152:155], 0
v_mul_f32 v80, s31, v80
v_mul_f32 v81, s31, v81
v_mfma_f32_16x16x32_bf16 v[64:67], v[32:35], v[184:187], 0
v_mul_f32 v82, s31, v82
v_mul_f32 v83, s31, v83
v_mfma_f32_16x16x32_bf16 v[68:71], v[36:39], v[184:187], 0
v_mul_f32 v84, s31, v84
v_mul_f32 v85, s31, v85
v_mfma_f32_16x16x32_bf16 v[72:75], v[32:35], v[216:219], 0
v_mul_f32 v86, s31, v86
v_mul_f32 v87, s31, v87
v_mfma_f32_16x16x32_bf16 v[76:79], v[36:39], v[216:219], 0
v_cvt_pk_bf16_f32 v80, v80, v81
v_cvt_pk_bf16_f32 v82, v82, v83
s_waitcnt lgkmcnt(0)
v_mfma_f32_16x16x32_bf16 v[48:51], v[40:43], v[124:127], v[48:51]
ds_read_b128 v[32:35], v26
ds_read_b128 v[36:39], v26 offset:8192
v_mfma_f32_16x16x32_bf16 v[52:55], v[44:47], v[124:127], v[52:55]
v_cvt_pk_bf16_f32 v84, v84, v85
v_cvt_pk_bf16_f32 v86, v86, v87
v_mfma_f32_16x16x32_bf16 v[56:59], v[40:43], v[156:159], v[56:59]
s_add_u32 m0, s32, 131072
s_nop 0
buffer_load_dwordx4 v20, s[8:11], s28 offen lds
v_accvgpr_write_b32 a12, v80
v_accvgpr_write_b32 a13, v82
v_mfma_f32_16x16x32_bf16 v[60:63], v[44:47], v[156:159], v[60:63]
v_accvgpr_write_b32 a14, v84
v_accvgpr_write_b32 a15, v86
v_mfma_f32_16x16x32_bf16 v[64:67], v[40:43], v[188:191], v[64:67]
v_mul_f32 v88, s31, v88
v_mul_f32 v89, s31, v89
v_mfma_f32_16x16x32_bf16 v[68:71], v[44:47], v[188:191], v[68:71]
v_mul_f32 v90, s31, v90
v_mul_f32 v91, s31, v91
v_mfma_f32_16x16x32_bf16 v[72:75], v[40:43], v[220:223], v[72:75]
v_mul_f32 v92, s31, v92
v_mul_f32 v93, s31, v93
v_mfma_f32_16x16x32_bf16 v[76:79], v[44:47], v[220:223], v[76:79]
v_mul_f32 v94, s31, v94
v_mul_f32 v95, s31, v95
s_waitcnt lgkmcnt(0)
v_mfma_f32_16x16x32_bf16 v[48:51], v[32:35], v[128:131], v[48:51]
ds_read_b128 v[40:43], v27
ds_read_b128 v[44:47], v27 offset:8192
v_mfma_f32_16x16x32_bf16 v[52:55], v[36:39], v[128:131], v[52:55]
v_cvt_pk_bf16_f32 v88, v88, v89
v_cvt_pk_bf16_f32 v90, v90, v91
v_mfma_f32_16x16x32_bf16 v[56:59], v[32:35], v[160:163], v[56:59]
v_cvt_pk_bf16_f32 v92, v92, v93
v_cvt_pk_bf16_f32 v94, v94, v95
v_mfma_f32_16x16x32_bf16 v[60:63], v[36:39], v[160:163], v[60:63]
v_accvgpr_write_b32 a68, v88
v_accvgpr_write_b32 a69, v90
v_mfma_f32_16x16x32_bf16 v[64:67], v[32:35], v[192:195], v[64:67]
v_accvgpr_write_b32 a70, v92
v_accvgpr_write_b32 a71, v94
v_mfma_f32_16x16x32_bf16 v[68:71], v[36:39], v[192:195], v[68:71]
v_mul_f32 v96, s31, v96
v_mul_f32 v97, s31, v97
v_mfma_f32_16x16x32_bf16 v[72:75], v[32:35], v[224:227], v[72:75]
v_mul_f32 v98, s31, v98
v_mul_f32 v99, s31, v99
v_mfma_f32_16x16x32_bf16 v[76:79], v[36:39], v[224:227], v[76:79]
v_mul_f32 v100, s31, v100
v_mul_f32 v101, s31, v101
s_waitcnt lgkmcnt(0)
v_mfma_f32_16x16x32_bf16 v[48:51], v[40:43], v[132:135], v[48:51]
ds_read_b128 v[32:35], v24 offset:256
ds_read_b128 v[36:39], v24 offset:8448
v_mfma_f32_16x16x32_bf16 v[52:55], v[44:47], v[132:135], v[52:55]
v_mul_f32 v102, s31, v102
v_mul_f32 v103, s31, v103
v_mfma_f32_16x16x32_bf16 v[56:59], v[40:43], v[164:167], v[56:59]
s_add_u32 m0, s32, 132096
s_nop 0
buffer_load_dwordx4 v21, s[8:11], s28 offen lds
v_cvt_pk_bf16_f32 v96, v96, v97
v_cvt_pk_bf16_f32 v98, v98, v99
v_mfma_f32_16x16x32_bf16 v[60:63], v[44:47], v[164:167], v[60:63]
v_cvt_pk_bf16_f32 v100, v100, v101
v_cvt_pk_bf16_f32 v102, v102, v103
v_mfma_f32_16x16x32_bf16 v[64:67], v[40:43], v[196:199], v[64:67]
v_accvgpr_write_b32 a124, v96
v_accvgpr_write_b32 a125, v98
v_mfma_f32_16x16x32_bf16 v[68:71], v[44:47], v[196:199], v[68:71]
v_accvgpr_write_b32 a126, v100
v_accvgpr_write_b32 a127, v102
v_mfma_f32_16x16x32_bf16 v[72:75], v[40:43], v[228:231], v[72:75]
v_mul_f32 v104, s31, v104
v_mul_f32 v105, s31, v105
v_mfma_f32_16x16x32_bf16 v[76:79], v[44:47], v[228:231], v[76:79]
v_mul_f32 v106, s31, v106
v_mul_f32 v107, s31, v107
s_waitcnt lgkmcnt(0)
v_mfma_f32_16x16x32_bf16 v[48:51], v[32:35], v[136:139], v[48:51]
ds_read_b128 v[40:43], v25 offset:256
ds_read_b128 v[44:47], v25 offset:8448
v_mfma_f32_16x16x32_bf16 v[52:55], v[36:39], v[136:139], v[52:55]
v_mul_f32 v108, s31, v108
v_mul_f32 v109, s31, v109
v_mfma_f32_16x16x32_bf16 v[56:59], v[32:35], v[168:171], v[56:59]
v_mul_f32 v110, s31, v110
v_mul_f32 v111, s31, v111
v_mfma_f32_16x16x32_bf16 v[60:63], v[36:39], v[168:171], v[60:63]
v_cvt_pk_bf16_f32 v104, v104, v105
v_cvt_pk_bf16_f32 v106, v106, v107
v_mfma_f32_16x16x32_bf16 v[64:67], v[32:35], v[200:203], v[64:67]
v_cvt_pk_bf16_f32 v108, v108, v109
v_cvt_pk_bf16_f32 v110, v110, v111
v_mfma_f32_16x16x32_bf16 v[68:71], v[36:39], v[200:203], v[68:71]
v_accvgpr_write_b32 a180, v104
v_accvgpr_write_b32 a181, v106
v_mfma_f32_16x16x32_bf16 v[72:75], v[32:35], v[232:235], v[72:75]
v_accvgpr_write_b32 a182, v108
v_accvgpr_write_b32 a183, v110
v_mfma_f32_16x16x32_bf16 v[76:79], v[36:39], v[232:235], v[76:79]
s_waitcnt lgkmcnt(0)
v_mfma_f32_16x16x32_bf16 v[48:51], v[40:43], v[140:143], v[48:51]
ds_read_b128 v[32:35], v26 offset:256
ds_read_b128 v[36:39], v26 offset:8448
v_mfma_f32_16x16x32_bf16 v[52:55], v[44:47], v[140:143], v[52:55]
v_mfma_f32_16x16x32_bf16 v[56:59], v[40:43], v[172:175], v[56:59]
s_add_u32 m0, s32, 133120
s_nop 0
buffer_load_dwordx4 v22, s[8:11], s28 offen lds
v_mfma_f32_16x16x32_bf16 v[60:63], v[44:47], v[172:175], v[60:63]
v_mfma_f32_16x16x32_bf16 v[64:67], v[40:43], v[204:207], v[64:67]
v_mfma_f32_16x16x32_bf16 v[68:71], v[44:47], v[204:207], v[68:71]
v_mfma_f32_16x16x32_bf16 v[72:75], v[40:43], v[236:239], v[72:75]
v_mfma_f32_16x16x32_bf16 v[76:79], v[44:47], v[236:239], v[76:79]
s_waitcnt lgkmcnt(0)
v_mfma_f32_16x16x32_bf16 v[48:51], v[32:35], v[144:147], v[48:51]
ds_read_b128 v[40:43], v27 offset:256
ds_read_b128 v[44:47], v27 offset:8448
v_mfma_f32_16x16x32_bf16 v[52:55], v[36:39], v[144:147], v[52:55]
v_mfma_f32_16x16x32_bf16 v[56:59], v[32:35], v[176:179], v[56:59]
v_mfma_f32_16x16x32_bf16 v[60:63], v[36:39], v[176:179], v[60:63]
v_mfma_f32_16x16x32_bf16 v[64:67], v[32:35], v[208:211], v[64:67]
v_mfma_f32_16x16x32_bf16 v[68:71], v[36:39], v[208:211], v[68:71]
v_mfma_f32_16x16x32_bf16 v[72:75], v[32:35], v[240:243], v[72:75]
v_mfma_f32_16x16x32_bf16 v[76:79], v[36:39], v[240:243], v[76:79]
s_waitcnt lgkmcnt(0)
v_mfma_f32_16x16x32_bf16 v[48:51], v[40:43], v[148:151], v[48:51]
ds_read_b128 v[32:35], v24 offset:16384
ds_read_b128 v[36:39], v24 offset:24576
v_mfma_f32_16x16x32_bf16 v[52:55], v[44:47], v[148:151], v[52:55]
v_mfma_f32_16x16x32_bf16 v[56:59], v[40:43], v[180:183], v[56:59]
s_add_u32 m0, s32, 134144
s_nop 0
buffer_load_dwordx4 v23, s[8:11], s28 offen lds
s_add_u32 s28, s28, 262144
v_mfma_f32_16x16x32_bf16 v[60:63], v[44:47], v[180:183], v[60:63]
v_mfma_f32_16x16x32_bf16 v[64:67], v[40:43], v[212:215], v[64:67]
v_mfma_f32_16x16x32_bf16 v[68:71], v[44:47], v[212:215], v[68:71]
v_mfma_f32_16x16x32_bf16 v[72:75], v[40:43], v[244:247], v[72:75]
v_mfma_f32_16x16x32_bf16 v[76:79], v[44:47], v[244:247], v[76:79]
s_waitcnt vmcnt(8)
s_barrier
s_waitcnt lgkmcnt(0)
v_mfma_f32_16x16x32_bf16 v[80:83], v[32:35], v[120:123], 0
ds_read_b128 v[40:43], v25 offset:16384
ds_read_b128 v[44:47], v25 offset:24576
v_mfma_f32_16x16x32_bf16 v[84:87], v[36:39], v[120:123], 0
v_mfma_f32_16x16x32_bf16 v[88:91], v[32:35], v[152:155], 0
v_mfma_f32_16x16x32_bf16 v[92:95], v[36:39], v[152:155], 0
v_mul_f32 v48, s31, v48
v_mul_f32 v49, s31, v49
v_mfma_f32_16x16x32_bf16 v[96:99], v[32:35], v[184:187], 0
v_mul_f32 v50, s31, v50
v_mul_f32 v51, s31, v51
v_mfma_f32_16x16x32_bf16 v[100:103], v[36:39], v[184:187], 0
v_mul_f32 v52, s31, v52
v_mul_f32 v53, s31, v53
v_mfma_f32_16x16x32_bf16 v[104:107], v[32:35], v[216:219], 0
v_mul_f32 v54, s31, v54
v_mul_f32 v55, s31, v55
v_mfma_f32_16x16x32_bf16 v[108:111], v[36:39], v[216:219], 0
v_cvt_pk_bf16_f32 v48, v48, v49
v_cvt_pk_bf16_f32 v50, v50, v51
s_waitcnt lgkmcnt(0)
v_mfma_f32_16x16x32_bf16 v[80:83], v[40:43], v[124:127], v[80:83]
ds_read_b128 v[32:35], v26 offset:16384
ds_read_b128 v[36:39], v26 offset:24576
v_mfma_f32_16x16x32_bf16 v[84:87], v[44:47], v[124:127], v[84:87]
v_cvt_pk_bf16_f32 v52, v52, v53
v_cvt_pk_bf16_f32 v54, v54, v55
v_mfma_f32_16x16x32_bf16 v[88:91], v[40:43], v[156:159], v[88:91]
s_add_u32 m0, s32, 147456
s_nop 0
buffer_load_dwordx4 v20, s[8:11], s28 offen lds
v_accvgpr_write_b32 a16, v48
v_accvgpr_write_b32 a17, v50
v_mfma_f32_16x16x32_bf16 v[92:95], v[44:47], v[156:159], v[92:95]
v_accvgpr_write_b32 a18, v52
v_accvgpr_write_b32 a19, v54
v_mfma_f32_16x16x32_bf16 v[96:99], v[40:43], v[188:191], v[96:99]
v_mul_f32 v56, s31, v56
v_mul_f32 v57, s31, v57
v_mfma_f32_16x16x32_bf16 v[100:103], v[44:47], v[188:191], v[100:103]
v_mul_f32 v58, s31, v58
v_mul_f32 v59, s31, v59
v_mfma_f32_16x16x32_bf16 v[104:107], v[40:43], v[220:223], v[104:107]
v_mul_f32 v60, s31, v60
v_mul_f32 v61, s31, v61
v_mfma_f32_16x16x32_bf16 v[108:111], v[44:47], v[220:223], v[108:111]
v_mul_f32 v62, s31, v62
v_mul_f32 v63, s31, v63
s_waitcnt lgkmcnt(0)
v_mfma_f32_16x16x32_bf16 v[80:83], v[32:35], v[128:131], v[80:83]
ds_read_b128 v[40:43], v27 offset:16384
ds_read_b128 v[44:47], v27 offset:24576
v_mfma_f32_16x16x32_bf16 v[84:87], v[36:39], v[128:131], v[84:87]
v_cvt_pk_bf16_f32 v56, v56, v57
v_cvt_pk_bf16_f32 v58, v58, v59
v_mfma_f32_16x16x32_bf16 v[88:91], v[32:35], v[160:163], v[88:91]
v_cvt_pk_bf16_f32 v60, v60, v61
v_cvt_pk_bf16_f32 v62, v62, v63
v_mfma_f32_16x16x32_bf16 v[92:95], v[36:39], v[160:163], v[92:95]
v_accvgpr_write_b32 a72, v56
v_accvgpr_write_b32 a73, v58
v_mfma_f32_16x16x32_bf16 v[96:99], v[32:35], v[192:195], v[96:99]
v_accvgpr_write_b32 a74, v60
v_accvgpr_write_b32 a75, v62
v_mfma_f32_16x16x32_bf16 v[100:103], v[36:39], v[192:195], v[100:103]
v_mul_f32 v64, s31, v64
v_mul_f32 v65, s31, v65
v_mfma_f32_16x16x32_bf16 v[104:107], v[32:35], v[224:227], v[104:107]
v_mul_f32 v66, s31, v66
v_mul_f32 v67, s31, v67
v_mfma_f32_16x16x32_bf16 v[108:111], v[36:39], v[224:227], v[108:111]
v_mul_f32 v68, s31, v68
v_mul_f32 v69, s31, v69
s_waitcnt lgkmcnt(0)
v_mfma_f32_16x16x32_bf16 v[80:83], v[40:43], v[132:135], v[80:83]
ds_read_b128 v[32:35], v24 offset:16640
ds_read_b128 v[36:39], v24 offset:24832
v_mfma_f32_16x16x32_bf16 v[84:87], v[44:47], v[132:135], v[84:87]
v_mul_f32 v70, s31, v70
v_mul_f32 v71, s31, v71
v_mfma_f32_16x16x32_bf16 v[88:91], v[40:43], v[164:167], v[88:91]
s_add_u32 m0, s32, 148480
s_nop 0
buffer_load_dwordx4 v21, s[8:11], s28 offen lds
v_cvt_pk_bf16_f32 v64, v64, v65
v_cvt_pk_bf16_f32 v66, v66, v67
v_mfma_f32_16x16x32_bf16 v[92:95], v[44:47], v[164:167], v[92:95]
v_cvt_pk_bf16_f32 v68, v68, v69
v_cvt_pk_bf16_f32 v70, v70, v71
v_mfma_f32_16x16x32_bf16 v[96:99], v[40:43], v[196:199], v[96:99]
v_accvgpr_write_b32 a128, v64
v_accvgpr_write_b32 a129, v66
v_mfma_f32_16x16x32_bf16 v[100:103], v[44:47], v[196:199], v[100:103]
v_accvgpr_write_b32 a130, v68
v_accvgpr_write_b32 a131, v70
v_mfma_f32_16x16x32_bf16 v[104:107], v[40:43], v[228:231], v[104:107]
v_mul_f32 v72, s31, v72
v_mul_f32 v73, s31, v73
v_mfma_f32_16x16x32_bf16 v[108:111], v[44:47], v[228:231], v[108:111]
v_mul_f32 v74, s31, v74
v_mul_f32 v75, s31, v75
s_waitcnt lgkmcnt(0)
v_mfma_f32_16x16x32_bf16 v[80:83], v[32:35], v[136:139], v[80:83]
ds_read_b128 v[40:43], v25 offset:16640
ds_read_b128 v[44:47], v25 offset:24832
v_mfma_f32_16x16x32_bf16 v[84:87], v[36:39], v[136:139], v[84:87]
v_mul_f32 v76, s31, v76
v_mul_f32 v77, s31, v77
v_mfma_f32_16x16x32_bf16 v[88:91], v[32:35], v[168:171], v[88:91]
v_mul_f32 v78, s31, v78
v_mul_f32 v79, s31, v79
v_mfma_f32_16x16x32_bf16 v[92:95], v[36:39], v[168:171], v[92:95]
v_cvt_pk_bf16_f32 v72, v72, v73
v_cvt_pk_bf16_f32 v74, v74, v75
v_mfma_f32_16x16x32_bf16 v[96:99], v[32:35], v[200:203], v[96:99]
v_cvt_pk_bf16_f32 v76, v76, v77
v_cvt_pk_bf16_f32 v78, v78, v79
v_mfma_f32_16x16x32_bf16 v[100:103], v[36:39], v[200:203], v[100:103]
v_accvgpr_write_b32 a184, v72
v_accvgpr_write_b32 a185, v74
v_mfma_f32_16x16x32_bf16 v[104:107], v[32:35], v[232:235], v[104:107]
v_accvgpr_write_b32 a186, v76
v_accvgpr_write_b32 a187, v78
v_mfma_f32_16x16x32_bf16 v[108:111], v[36:39], v[232:235], v[108:111]
s_waitcnt lgkmcnt(0)
v_mfma_f32_16x16x32_bf16 v[80:83], v[40:43], v[140:143], v[80:83]
ds_read_b128 v[32:35], v26 offset:16640
ds_read_b128 v[36:39], v26 offset:24832
v_mfma_f32_16x16x32_bf16 v[84:87], v[44:47], v[140:143], v[84:87]
v_mfma_f32_16x16x32_bf16 v[88:91], v[40:43], v[172:175], v[88:91]
s_add_u32 m0, s32, 149504
s_nop 0
buffer_load_dwordx4 v22, s[8:11], s28 offen lds
v_mfma_f32_16x16x32_bf16 v[92:95], v[44:47], v[172:175], v[92:95]
v_mfma_f32_16x16x32_bf16 v[96:99], v[40:43], v[204:207], v[96:99]
v_mfma_f32_16x16x32_bf16 v[100:103], v[44:47], v[204:207], v[100:103]
v_mfma_f32_16x16x32_bf16 v[104:107], v[40:43], v[236:239], v[104:107]
v_mfma_f32_16x16x32_bf16 v[108:111], v[44:47], v[236:239], v[108:111]
s_waitcnt lgkmcnt(0)
v_mfma_f32_16x16x32_bf16 v[80:83], v[32:35], v[144:147], v[80:83]
ds_read_b128 v[40:43], v27 offset:16640
ds_read_b128 v[44:47], v27 offset:24832
v_mfma_f32_16x16x32_bf16 v[84:87], v[36:39], v[144:147], v[84:87]
v_mfma_f32_16x16x32_bf16 v[88:91], v[32:35], v[176:179], v[88:91]
v_mfma_f32_16x16x32_bf16 v[92:95], v[36:39], v[176:179], v[92:95]
v_mfma_f32_16x16x32_bf16 v[96:99], v[32:35], v[208:211], v[96:99]
v_mfma_f32_16x16x32_bf16 v[100:103], v[36:39], v[208:211], v[100:103]
v_mfma_f32_16x16x32_bf16 v[104:107], v[32:35], v[240:243], v[104:107]
v_mfma_f32_16x16x32_bf16 v[108:111], v[36:39], v[240:243], v[108:111]
s_waitcnt lgkmcnt(0)
v_mfma_f32_16x16x32_bf16 v[80:83], v[40:43], v[148:151], v[80:83]
ds_read_b128 v[32:35], v24 offset:32768
ds_read_b128 v[36:39], v24 offset:40960
v_mfma_f32_16x16x32_bf16 v[84:87], v[44:47], v[148:151], v[84:87]
v_mfma_f32_16x16x32_bf16 v[88:91], v[40:43], v[180:183], v[88:91]
s_add_u32 m0, s32, 150528
s_nop 0
buffer_load_dwordx4 v23, s[8:11], s28 offen lds
s_add_u32 s28, s28, 262144
v_mfma_f32_16x16x32_bf16 v[92:95], v[44:47], v[180:183], v[92:95]
v_mfma_f32_16x16x32_bf16 v[96:99], v[40:43], v[212:215], v[96:99]
v_mfma_f32_16x16x32_bf16 v[100:103], v[44:47], v[212:215], v[100:103]
v_mfma_f32_16x16x32_bf16 v[104:107], v[40:43], v[244:247], v[104:107]
v_mfma_f32_16x16x32_bf16 v[108:111], v[44:47], v[244:247], v[108:111]
s_waitcnt vmcnt(8)
s_barrier
s_waitcnt lgkmcnt(0)
v_mfma_f32_16x16x32_bf16 v[48:51], v[32:35], v[120:123], 0
ds_read_b128 v[40:43], v25 offset:32768
ds_read_b128 v[44:47], v25 offset:40960
v_mfma_f32_16x16x32_bf16 v[52:55], v[36:39], v[120:123], 0
v_mfma_f32_16x16x32_bf16 v[56:59], v[32:35], v[152:155], 0
v_mfma_f32_16x16x32_bf16 v[60:63], v[36:39], v[152:155], 0
v_mul_f32 v80, s31, v80
v_mul_f32 v81, s31, v81
v_mfma_f32_16x16x32_bf16 v[64:67], v[32:35], v[184:187], 0
v_mul_f32 v82, s31, v82
v_mul_f32 v83, s31, v83
v_mfma_f32_16x16x32_bf16 v[68:71], v[36:39], v[184:187], 0
v_mul_f32 v84, s31, v84
v_mul_f32 v85, s31, v85
v_mfma_f32_16x16x32_bf16 v[72:75], v[32:35], v[216:219], 0
v_mul_f32 v86, s31, v86
v_mul_f32 v87, s31, v87
v_mfma_f32_16x16x32_bf16 v[76:79], v[36:39], v[216:219], 0
v_cvt_pk_bf16_f32 v80, v80, v81
v_cvt_pk_bf16_f32 v82, v82, v83
s_waitcnt lgkmcnt(0)
v_mfma_f32_16x16x32_bf16 v[48:51], v[40:43], v[124:127], v[48:51]
ds_read_b128 v[32:35], v26 offset:32768
ds_read_b128 v[36:39], v26 offset:40960
v_mfma_f32_16x16x32_bf16 v[52:55], v[44:47], v[124:127], v[52:55]
v_cvt_pk_bf16_f32 v84, v84, v85
v_cvt_pk_bf16_f32 v86, v86, v87
v_mfma_f32_16x16x32_bf16 v[56:59], v[40:43], v[156:159], v[56:59]
s_add_u32 m0, s32, 0
s_nop 0
buffer_load_dwordx4 v20, s[8:11], s28 offen lds
v_accvgpr_write_b32 a20, v80
v_accvgpr_write_b32 a21, v82
v_mfma_f32_16x16x32_bf16 v[60:63], v[44:47], v[156:159], v[60:63]
v_accvgpr_write_b32 a22, v84
v_accvgpr_write_b32 a23, v86
v_mfma_f32_16x16x32_bf16 v[64:67], v[40:43], v[188:191], v[64:67]
v_mul_f32 v88, s31, v88
v_mul_f32 v89, s31, v89
v_mfma_f32_16x16x32_bf16 v[68:71], v[44:47], v[188:191], v[68:71]
v_mul_f32 v90, s31, v90
v_mul_f32 v91, s31, v91
v_mfma_f32_16x16x32_bf16 v[72:75], v[40:43], v[220:223], v[72:75]
v_mul_f32 v92, s31, v92
v_mul_f32 v93, s31, v93
v_mfma_f32_16x16x32_bf16 v[76:79], v[44:47], v[220:223], v[76:79]
v_mul_f32 v94, s31, v94
v_mul_f32 v95, s31, v95
s_waitcnt lgkmcnt(0)
v_mfma_f32_16x16x32_bf16 v[48:51], v[32:35], v[128:131], v[48:51]
ds_read_b128 v[40:43], v27 offset:32768
ds_read_b128 v[44:47], v27 offset:40960
v_mfma_f32_16x16x32_bf16 v[52:55], v[36:39], v[128:131], v[52:55]
v_cvt_pk_bf16_f32 v88, v88, v89
v_cvt_pk_bf16_f32 v90, v90, v91
v_mfma_f32_16x16x32_bf16 v[56:59], v[32:35], v[160:163], v[56:59]
v_cvt_pk_bf16_f32 v92, v92, v93
v_cvt_pk_bf16_f32 v94, v94, v95
v_mfma_f32_16x16x32_bf16 v[60:63], v[36:39], v[160:163], v[60:63]
v_accvgpr_write_b32 a76, v88
v_accvgpr_write_b32 a77, v90
v_mfma_f32_16x16x32_bf16 v[64:67], v[32:35], v[192:195], v[64:67]
v_accvgpr_write_b32 a78, v92
v_accvgpr_write_b32 a79, v94
v_mfma_f32_16x16x32_bf16 v[68:71], v[36:39], v[192:195], v[68:71]
v_mul_f32 v96, s31, v96
v_mul_f32 v97, s31, v97
v_mfma_f32_16x16x32_bf16 v[72:75], v[32:35], v[224:227], v[72:75]
v_mul_f32 v98, s31, v98
v_mul_f32 v99, s31, v99
v_mfma_f32_16x16x32_bf16 v[76:79], v[36:39], v[224:227], v[76:79]
v_mul_f32 v100, s31, v100
v_mul_f32 v101, s31, v101
s_waitcnt lgkmcnt(0)
v_mfma_f32_16x16x32_bf16 v[48:51], v[40:43], v[132:135], v[48:51]
ds_read_b128 v[32:35], v24 offset:33024
ds_read_b128 v[36:39], v24 offset:41216
v_mfma_f32_16x16x32_bf16 v[52:55], v[44:47], v[132:135], v[52:55]
v_mul_f32 v102, s31, v102
v_mul_f32 v103, s31, v103
v_mfma_f32_16x16x32_bf16 v[56:59], v[40:43], v[164:167], v[56:59]
s_add_u32 m0, s32, 1024
s_nop 0
buffer_load_dwordx4 v21, s[8:11], s28 offen lds
v_cvt_pk_bf16_f32 v96, v96, v97
v_cvt_pk_bf16_f32 v98, v98, v99
v_mfma_f32_16x16x32_bf16 v[60:63], v[44:47], v[164:167], v[60:63]
v_cvt_pk_bf16_f32 v100, v100, v101
v_cvt_pk_bf16_f32 v102, v102, v103
v_mfma_f32_16x16x32_bf16 v[64:67], v[40:43], v[196:199], v[64:67]
v_accvgpr_write_b32 a132, v96
v_accvgpr_write_b32 a133, v98
v_mfma_f32_16x16x32_bf16 v[68:71], v[44:47], v[196:199], v[68:71]
v_accvgpr_write_b32 a134, v100
v_accvgpr_write_b32 a135, v102
v_mfma_f32_16x16x32_bf16 v[72:75], v[40:43], v[228:231], v[72:75]
v_mul_f32 v104, s31, v104
v_mul_f32 v105, s31, v105
v_mfma_f32_16x16x32_bf16 v[76:79], v[44:47], v[228:231], v[76:79]
v_mul_f32 v106, s31, v106
v_mul_f32 v107, s31, v107
s_waitcnt lgkmcnt(0)
v_mfma_f32_16x16x32_bf16 v[48:51], v[32:35], v[136:139], v[48:51]
ds_read_b128 v[40:43], v25 offset:33024
ds_read_b128 v[44:47], v25 offset:41216
v_mfma_f32_16x16x32_bf16 v[52:55], v[36:39], v[136:139], v[52:55]
buffer_load_dword v6, off, s[84:87], 0 sc1
buffer_load_dword v7, v2, s[84:87], 0 offen offset:128 sc1
v_mul_f32 v108, s31, v108
v_mul_f32 v109, s31, v109
v_mfma_f32_16x16x32_bf16 v[56:59], v[32:35], v[168:171], v[56:59]
v_mul_f32 v110, s31, v110
v_mul_f32 v111, s31, v111
v_mfma_f32_16x16x32_bf16 v[60:63], v[36:39], v[168:171], v[60:63]
v_cvt_pk_bf16_f32 v104, v104, v105
v_cvt_pk_bf16_f32 v106, v106, v107
v_mfma_f32_16x16x32_bf16 v[64:67], v[32:35], v[200:203], v[64:67]
v_cvt_pk_bf16_f32 v108, v108, v109
v_cvt_pk_bf16_f32 v110, v110, v111
v_mfma_f32_16x16x32_bf16 v[68:71], v[36:39], v[200:203], v[68:71]
v_accvgpr_write_b32 a188, v104
v_accvgpr_write_b32 a189, v106
v_mfma_f32_16x16x32_bf16 v[72:75], v[32:35], v[232:235], v[72:75]
v_accvgpr_write_b32 a190, v108
v_accvgpr_write_b32 a191, v110
v_mfma_f32_16x16x32_bf16 v[76:79], v[36:39], v[232:235], v[76:79]
s_waitcnt lgkmcnt(0)
v_mfma_f32_16x16x32_bf16 v[48:51], v[40:43], v[140:143], v[48:51]
ds_read_b128 v[32:35], v26 offset:33024
ds_read_b128 v[36:39], v26 offset:41216
v_mfma_f32_16x16x32_bf16 v[52:55], v[44:47], v[140:143], v[52:55]
v_mfma_f32_16x16x32_bf16 v[56:59], v[40:43], v[172:175], v[56:59]
s_add_u32 m0, s32, 2048
s_nop 0
buffer_load_dwordx4 v22, s[8:11], s28 offen lds
v_mfma_f32_16x16x32_bf16 v[60:63], v[44:47], v[172:175], v[60:63]
v_mfma_f32_16x16x32_bf16 v[64:67], v[40:43], v[204:207], v[64:67]
v_mfma_f32_16x16x32_bf16 v[68:71], v[44:47], v[204:207], v[68:71]
v_mfma_f32_16x16x32_bf16 v[72:75], v[40:43], v[236:239], v[72:75]
v_mfma_f32_16x16x32_bf16 v[76:79], v[44:47], v[236:239], v[76:79]
s_waitcnt lgkmcnt(0)
v_mfma_f32_16x16x32_bf16 v[48:51], v[32:35], v[144:147], v[48:51]
ds_read_b128 v[40:43], v27 offset:33024
ds_read_b128 v[44:47], v27 offset:41216
v_mfma_f32_16x16x32_bf16 v[52:55], v[36:39], v[144:147], v[52:55]
v_mfma_f32_16x16x32_bf16 v[56:59], v[32:35], v[176:179], v[56:59]
v_mfma_f32_16x16x32_bf16 v[60:63], v[36:39], v[176:179], v[60:63]
v_mfma_f32_16x16x32_bf16 v[64:67], v[32:35], v[208:211], v[64:67]
v_mfma_f32_16x16x32_bf16 v[68:71], v[36:39], v[208:211], v[68:71]
v_mfma_f32_16x16x32_bf16 v[72:75], v[32:35], v[240:243], v[72:75]
v_mfma_f32_16x16x32_bf16 v[76:79], v[36:39], v[240:243], v[76:79]
s_waitcnt lgkmcnt(0)
v_mfma_f32_16x16x32_bf16 v[48:51], v[40:43], v[148:151], v[48:51]
ds_read_b128 v[32:35], v24 offset:49152
ds_read_b128 v[36:39], v24 offset:57344
v_mfma_f32_16x16x32_bf16 v[52:55], v[44:47], v[148:151], v[52:55]
v_mfma_f32_16x16x32_bf16 v[56:59], v[40:43], v[180:183], v[56:59]
s_add_u32 m0, s32, 3072
s_nop 0
buffer_load_dwordx4 v23, s[8:11], s28 offen lds
s_add_u32 s28, s28, 262144
v_mfma_f32_16x16x32_bf16 v[60:63], v[44:47], v[180:183], v[60:63]
v_mfma_f32_16x16x32_bf16 v[64:67], v[40:43], v[212:215], v[64:67]
v_mfma_f32_16x16x32_bf16 v[68:71], v[44:47], v[212:215], v[68:71]
v_mfma_f32_16x16x32_bf16 v[72:75], v[40:43], v[244:247], v[72:75]
v_mfma_f32_16x16x32_bf16 v[76:79], v[44:47], v[244:247], v[76:79]
s_waitcnt vmcnt(10)
s_barrier
s_waitcnt lgkmcnt(0)
v_mfma_f32_16x16x32_bf16 v[80:83], v[32:35], v[120:123], 0
ds_read_b128 v[40:43], v25 offset:49152
ds_read_b128 v[44:47], v25 offset:57344
v_mfma_f32_16x16x32_bf16 v[84:87], v[36:39], v[120:123], 0
v_mfma_f32_16x16x32_bf16 v[88:91], v[32:35], v[152:155], 0
v_mfma_f32_16x16x32_bf16 v[92:95], v[36:39], v[152:155], 0
v_mul_f32 v48, s31, v48
v_mul_f32 v49, s31, v49
v_mfma_f32_16x16x32_bf16 v[96:99], v[32:35], v[184:187], 0
v_mul_f32 v50, s31, v50
v_mul_f32 v51, s31, v51
v_mfma_f32_16x16x32_bf16 v[100:103], v[36:39], v[184:187], 0
v_mul_f32 v52, s31, v52
v_mul_f32 v53, s31, v53
v_mfma_f32_16x16x32_bf16 v[104:107], v[32:35], v[216:219], 0
v_mul_f32 v54, s31, v54
v_mul_f32 v55, s31, v55
v_mfma_f32_16x16x32_bf16 v[108:111], v[36:39], v[216:219], 0
v_cvt_pk_bf16_f32 v48, v48, v49
v_cvt_pk_bf16_f32 v50, v50, v51
s_waitcnt lgkmcnt(0)
v_mfma_f32_16x16x32_bf16 v[80:83], v[40:43], v[124:127], v[80:83]
ds_read_b128 v[32:35], v26 offset:49152
ds_read_b128 v[36:39], v26 offset:57344
v_mfma_f32_16x16x32_bf16 v[84:87], v[44:47], v[124:127], v[84:87]
v_cvt_pk_bf16_f32 v52, v52, v53
v_cvt_pk_bf16_f32 v54, v54, v55
v_mfma_f32_16x16x32_bf16 v[88:91], v[40:43], v[156:159], v[88:91]
s_add_u32 m0, s32, 16384
s_nop 0
buffer_load_dwordx4 v20, s[8:11], s28 offen lds
v_accvgpr_write_b32 a24, v48
v_accvgpr_write_b32 a25, v50
v_mfma_f32_16x16x32_bf16 v[92:95], v[44:47], v[156:159], v[92:95]
v_accvgpr_write_b32 a26, v52
v_accvgpr_write_b32 a27, v54
v_mfma_f32_16x16x32_bf16 v[96:99], v[40:43], v[188:191], v[96:99]
v_mul_f32 v56, s31, v56
v_mul_f32 v57, s31, v57
v_mfma_f32_16x16x32_bf16 v[100:103], v[44:47], v[188:191], v[100:103]
v_mul_f32 v58, s31, v58
v_mul_f32 v59, s31, v59
v_mfma_f32_16x16x32_bf16 v[104:107], v[40:43], v[220:223], v[104:107]
v_mul_f32 v60, s31, v60
v_mul_f32 v61, s31, v61
v_mfma_f32_16x16x32_bf16 v[108:111], v[44:47], v[220:223], v[108:111]
v_mul_f32 v62, s31, v62
v_mul_f32 v63, s31, v63
s_waitcnt lgkmcnt(0)
v_mfma_f32_16x16x32_bf16 v[80:83], v[32:35], v[128:131], v[80:83]
ds_read_b128 v[40:43], v27 offset:49152
ds_read_b128 v[44:47], v27 offset:57344
v_mfma_f32_16x16x32_bf16 v[84:87], v[36:39], v[128:131], v[84:87]
v_cvt_pk_bf16_f32 v56, v56, v57
v_cvt_pk_bf16_f32 v58, v58, v59
v_mfma_f32_16x16x32_bf16 v[88:91], v[32:35], v[160:163], v[88:91]
v_cvt_pk_bf16_f32 v60, v60, v61
v_cvt_pk_bf16_f32 v62, v62, v63
v_mfma_f32_16x16x32_bf16 v[92:95], v[36:39], v[160:163], v[92:95]
v_accvgpr_write_b32 a80, v56
v_accvgpr_write_b32 a81, v58
v_mfma_f32_16x16x32_bf16 v[96:99], v[32:35], v[192:195], v[96:99]
v_accvgpr_write_b32 a82, v60
v_accvgpr_write_b32 a83, v62
v_mfma_f32_16x16x32_bf16 v[100:103], v[36:39], v[192:195], v[100:103]
v_mul_f32 v64, s31, v64
v_mul_f32 v65, s31, v65
v_mfma_f32_16x16x32_bf16 v[104:107], v[32:35], v[224:227], v[104:107]
v_mul_f32 v66, s31, v66
v_mul_f32 v67, s31, v67
v_mfma_f32_16x16x32_bf16 v[108:111], v[36:39], v[224:227], v[108:111]
v_mul_f32 v68, s31, v68
v_mul_f32 v69, s31, v69
s_waitcnt lgkmcnt(0)
v_mfma_f32_16x16x32_bf16 v[80:83], v[40:43], v[132:135], v[80:83]
ds_read_b128 v[32:35], v24 offset:49408
ds_read_b128 v[36:39], v24 offset:57600
v_mfma_f32_16x16x32_bf16 v[84:87], v[44:47], v[132:135], v[84:87]
v_mul_f32 v70, s31, v70
v_mul_f32 v71, s31, v71
v_mfma_f32_16x16x32_bf16 v[88:91], v[40:43], v[164:167], v[88:91]
s_add_u32 m0, s32, 17408
s_nop 0
buffer_load_dwordx4 v21, s[8:11], s28 offen lds
v_cvt_pk_bf16_f32 v64, v64, v65
v_cvt_pk_bf16_f32 v66, v66, v67
v_mfma_f32_16x16x32_bf16 v[92:95], v[44:47], v[164:167], v[92:95]
v_cvt_pk_bf16_f32 v68, v68, v69
v_cvt_pk_bf16_f32 v70, v70, v71
v_mfma_f32_16x16x32_bf16 v[96:99], v[40:43], v[196:199], v[96:99]
v_accvgpr_write_b32 a136, v64
v_accvgpr_write_b32 a137, v66
v_mfma_f32_16x16x32_bf16 v[100:103], v[44:47], v[196:199], v[100:103]
v_accvgpr_write_b32 a138, v68
v_accvgpr_write_b32 a139, v70
v_mfma_f32_16x16x32_bf16 v[104:107], v[40:43], v[228:231], v[104:107]
v_mul_f32 v72, s31, v72
v_mul_f32 v73, s31, v73
v_mfma_f32_16x16x32_bf16 v[108:111], v[44:47], v[228:231], v[108:111]
v_mul_f32 v74, s31, v74
v_mul_f32 v75, s31, v75
s_waitcnt lgkmcnt(0)
v_mfma_f32_16x16x32_bf16 v[80:83], v[32:35], v[136:139], v[80:83]
ds_read_b128 v[40:43], v25 offset:49408
ds_read_b128 v[44:47], v25 offset:57600
v_mfma_f32_16x16x32_bf16 v[84:87], v[36:39], v[136:139], v[84:87]
v_mul_f32 v76, s31, v76
v_mul_f32 v77, s31, v77
v_mfma_f32_16x16x32_bf16 v[88:91], v[32:35], v[168:171], v[88:91]
v_mul_f32 v78, s31, v78
v_mul_f32 v79, s31, v79
v_mfma_f32_16x16x32_bf16 v[92:95], v[36:39], v[168:171], v[92:95]
v_cvt_pk_bf16_f32 v72, v72, v73
v_cvt_pk_bf16_f32 v74, v74, v75
v_mfma_f32_16x16x32_bf16 v[96:99], v[32:35], v[200:203], v[96:99]
v_cvt_pk_bf16_f32 v76, v76, v77
v_cvt_pk_bf16_f32 v78, v78, v79
v_mfma_f32_16x16x32_bf16 v[100:103], v[36:39], v[200:203], v[100:103]
v_accvgpr_write_b32 a192, v72
v_accvgpr_write_b32 a193, v74
v_mfma_f32_16x16x32_bf16 v[104:107], v[32:35], v[232:235], v[104:107]
v_accvgpr_write_b32 a194, v76
v_accvgpr_write_b32 a195, v78
v_mfma_f32_16x16x32_bf16 v[108:111], v[36:39], v[232:235], v[108:111]
s_waitcnt lgkmcnt(0)
v_mfma_f32_16x16x32_bf16 v[80:83], v[40:43], v[140:143], v[80:83]
ds_read_b128 v[32:35], v26 offset:49408
ds_read_b128 v[36:39], v26 offset:57600
v_mfma_f32_16x16x32_bf16 v[84:87], v[44:47], v[140:143], v[84:87]
v_mfma_f32_16x16x32_bf16 v[88:91], v[40:43], v[172:175], v[88:91]
s_add_u32 m0, s32, 18432
s_nop 0
buffer_load_dwordx4 v22, s[8:11], s28 offen lds
v_mfma_f32_16x16x32_bf16 v[92:95], v[44:47], v[172:175], v[92:95]
v_mfma_f32_16x16x32_bf16 v[96:99], v[40:43], v[204:207], v[96:99]
v_mfma_f32_16x16x32_bf16 v[100:103], v[44:47], v[204:207], v[100:103]
v_mfma_f32_16x16x32_bf16 v[104:107], v[40:43], v[236:239], v[104:107]
v_mfma_f32_16x16x32_bf16 v[108:111], v[44:47], v[236:239], v[108:111]
s_waitcnt lgkmcnt(0)
v_mfma_f32_16x16x32_bf16 v[80:83], v[32:35], v[144:147], v[80:83]
ds_read_b128 v[40:43], v27 offset:49408
ds_read_b128 v[44:47], v27 offset:57600
v_mfma_f32_16x16x32_bf16 v[84:87], v[36:39], v[144:147], v[84:87]
v_mfma_f32_16x16x32_bf16 v[88:91], v[32:35], v[176:179], v[88:91]
v_mfma_f32_16x16x32_bf16 v[92:95], v[36:39], v[176:179], v[92:95]
v_mfma_f32_16x16x32_bf16 v[96:99], v[32:35], v[208:211], v[96:99]
v_mfma_f32_16x16x32_bf16 v[100:103], v[36:39], v[208:211], v[100:103]
v_mfma_f32_16x16x32_bf16 v[104:107], v[32:35], v[240:243], v[104:107]
v_mfma_f32_16x16x32_bf16 v[108:111], v[36:39], v[240:243], v[108:111]
s_waitcnt lgkmcnt(0)
v_mfma_f32_16x16x32_bf16 v[80:83], v[40:43], v[148:151], v[80:83]
ds_read_b128 v[32:35], v12
ds_read_b128 v[36:39], v12 offset:8192
v_mfma_f32_16x16x32_bf16 v[84:87], v[44:47], v[148:151], v[84:87]
v_mfma_f32_16x16x32_bf16 v[88:91], v[40:43], v[180:183], v[88:91]
s_add_u32 m0, s32, 19456
s_nop 0
buffer_load_dwordx4 v23, s[8:11], s28 offen lds
s_add_u32 s28, s28, 262144
v_mfma_f32_16x16x32_bf16 v[92:95], v[44:47], v[180:183], v[92:95]
v_mfma_f32_16x16x32_bf16 v[96:99], v[40:43], v[212:215], v[96:99]
v_mfma_f32_16x16x32_bf16 v[100:103], v[44:47], v[212:215], v[100:103]
v_mfma_f32_16x16x32_bf16 v[104:107], v[40:43], v[244:247], v[104:107]
v_mfma_f32_16x16x32_bf16 v[108:111], v[44:47], v[244:247], v[108:111]
s_waitcnt vmcnt(10)
s_barrier
s_waitcnt lgkmcnt(0)
v_mfma_f32_16x16x32_bf16 v[48:51], v[32:35], v[120:123], 0
ds_read_b128 v[40:43], v13
ds_read_b128 v[44:47], v13 offset:8192
v_mfma_f32_16x16x32_bf16 v[52:55], v[36:39], v[120:123], 0
v_mfma_f32_16x16x32_bf16 v[56:59], v[32:35], v[152:155], 0
v_mfma_f32_16x16x32_bf16 v[60:63], v[36:39], v[152:155], 0
v_mul_f32 v80, s31, v80
v_mul_f32 v81, s31, v81
v_mfma_f32_16x16x32_bf16 v[64:67], v[32:35], v[184:187], 0
v_mul_f32 v82, s31, v82
v_mul_f32 v83, s31, v83
v_mfma_f32_16x16x32_bf16 v[68:71], v[36:39], v[184:187], 0
v_mul_f32 v84, s31, v84
v_mul_f32 v85, s31, v85
v_mfma_f32_16x16x32_bf16 v[72:75], v[32:35], v[216:219], 0
v_mul_f32 v86, s31, v86
v_mul_f32 v87, s31, v87
v_mfma_f32_16x16x32_bf16 v[76:79], v[36:39], v[216:219], 0
v_cvt_pk_bf16_f32 v80, v80, v81
v_cvt_pk_bf16_f32 v82, v82, v83
s_waitcnt lgkmcnt(0)
v_mfma_f32_16x16x32_bf16 v[48:51], v[40:43], v[124:127], v[48:51]
ds_read_b128 v[32:35], v14
ds_read_b128 v[36:39], v14 offset:8192
v_mfma_f32_16x16x32_bf16 v[52:55], v[44:47], v[124:127], v[52:55]
v_cvt_pk_bf16_f32 v84, v84, v85
v_cvt_pk_bf16_f32 v86, v86, v87
v_mfma_f32_16x16x32_bf16 v[56:59], v[40:43], v[156:159], v[56:59]
s_add_u32 m0, s32, 32768
s_nop 0
buffer_load_dwordx4 v20, s[8:11], s28 offen lds
v_accvgpr_write_b32 a28, v80
v_accvgpr_write_b32 a29, v82
v_mfma_f32_16x16x32_bf16 v[60:63], v[44:47], v[156:159], v[60:63]
v_accvgpr_write_b32 a30, v84
v_accvgpr_write_b32 a31, v86
v_mfma_f32_16x16x32_bf16 v[64:67], v[40:43], v[188:191], v[64:67]
v_mul_f32 v88, s31, v88
v_mul_f32 v89, s31, v89
v_mfma_f32_16x16x32_bf16 v[68:71], v[44:47], v[188:191], v[68:71]
v_mul_f32 v90, s31, v90
v_mul_f32 v91, s31, v91
v_mfma_f32_16x16x32_bf16 v[72:75], v[40:43], v[220:223], v[72:75]
v_mul_f32 v92, s31, v92
v_mul_f32 v93, s31, v93
v_mfma_f32_16x16x32_bf16 v[76:79], v[44:47], v[220:223], v[76:79]
v_mul_f32 v94, s31, v94
v_mul_f32 v95, s31, v95
s_waitcnt lgkmcnt(0)
v_mfma_f32_16x16x32_bf16 v[48:51], v[32:35], v[128:131], v[48:51]
ds_read_b128 v[40:43], v15
ds_read_b128 v[44:47], v15 offset:8192
v_mfma_f32_16x16x32_bf16 v[52:55], v[36:39], v[128:131], v[52:55]
v_cvt_pk_bf16_f32 v88, v88, v89
v_cvt_pk_bf16_f32 v90, v90, v91
v_mfma_f32_16x16x32_bf16 v[56:59], v[32:35], v[160:163], v[56:59]
v_cvt_pk_bf16_f32 v92, v92, v93
v_cvt_pk_bf16_f32 v94, v94, v95
v_mfma_f32_16x16x32_bf16 v[60:63], v[36:39], v[160:163], v[60:63]
v_accvgpr_write_b32 a84, v88
v_accvgpr_write_b32 a85, v90
v_mfma_f32_16x16x32_bf16 v[64:67], v[32:35], v[192:195], v[64:67]
v_accvgpr_write_b32 a86, v92
v_accvgpr_write_b32 a87, v94
v_mfma_f32_16x16x32_bf16 v[68:71], v[36:39], v[192:195], v[68:71]
v_mul_f32 v96, s31, v96
v_mul_f32 v97, s31, v97
v_mfma_f32_16x16x32_bf16 v[72:75], v[32:35], v[224:227], v[72:75]
v_mul_f32 v98, s31, v98
v_mul_f32 v99, s31, v99
v_mfma_f32_16x16x32_bf16 v[76:79], v[36:39], v[224:227], v[76:79]
v_mul_f32 v100, s31, v100
v_mul_f32 v101, s31, v101
s_waitcnt lgkmcnt(0)
v_mfma_f32_16x16x32_bf16 v[48:51], v[40:43], v[132:135], v[48:51]
ds_read_b128 v[32:35], v12 offset:256
ds_read_b128 v[36:39], v12 offset:8448
v_mfma_f32_16x16x32_bf16 v[52:55], v[44:47], v[132:135], v[52:55]
v_mul_f32 v102, s31, v102
v_mul_f32 v103, s31, v103
v_mfma_f32_16x16x32_bf16 v[56:59], v[40:43], v[164:167], v[56:59]
s_add_u32 m0, s32, 33792
s_nop 0
buffer_load_dwordx4 v21, s[8:11], s28 offen lds
v_cvt_pk_bf16_f32 v96, v96, v97
v_cvt_pk_bf16_f32 v98, v98, v99
v_mfma_f32_16x16x32_bf16 v[60:63], v[44:47], v[164:167], v[60:63]
v_cvt_pk_bf16_f32 v100, v100, v101
v_cvt_pk_bf16_f32 v102, v102, v103
v_mfma_f32_16x16x32_bf16 v[64:67], v[40:43], v[196:199], v[64:67]
v_accvgpr_write_b32 a140, v96
v_accvgpr_write_b32 a141, v98
v_mfma_f32_16x16x32_bf16 v[68:71], v[44:47], v[196:199], v[68:71]
v_accvgpr_write_b32 a142, v100
v_accvgpr_write_b32 a143, v102
v_mfma_f32_16x16x32_bf16 v[72:75], v[40:43], v[228:231], v[72:75]
v_mul_f32 v104, s31, v104
v_mul_f32 v105, s31, v105
v_mfma_f32_16x16x32_bf16 v[76:79], v[44:47], v[228:231], v[76:79]
v_mul_f32 v106, s31, v106
v_mul_f32 v107, s31, v107
s_waitcnt lgkmcnt(0)
v_mfma_f32_16x16x32_bf16 v[48:51], v[32:35], v[136:139], v[48:51]
ds_read_b128 v[40:43], v13 offset:256
ds_read_b128 v[44:47], v13 offset:8448
v_mfma_f32_16x16x32_bf16 v[52:55], v[36:39], v[136:139], v[52:55]
s_waitcnt vmcnt(8)
v_readfirstlane_b32 s88, v6
v_mul_f32 v108, s31, v108
v_mul_f32 v109, s31, v109
v_mfma_f32_16x16x32_bf16 v[56:59], v[32:35], v[168:171], v[56:59]
v_mul_f32 v110, s31, v110
v_mul_f32 v111, s31, v111
v_mfma_f32_16x16x32_bf16 v[60:63], v[36:39], v[168:171], v[60:63]
v_cvt_pk_bf16_f32 v104, v104, v105
v_cvt_pk_bf16_f32 v106, v106, v107
v_mfma_f32_16x16x32_bf16 v[64:67], v[32:35], v[200:203], v[64:67]
v_cvt_pk_bf16_f32 v108, v108, v109
v_cvt_pk_bf16_f32 v110, v110, v111
v_mfma_f32_16x16x32_bf16 v[68:71], v[36:39], v[200:203], v[68:71]
v_accvgpr_write_b32 a196, v104
v_accvgpr_write_b32 a197, v106
v_mfma_f32_16x16x32_bf16 v[72:75], v[32:35], v[232:235], v[72:75]
v_accvgpr_write_b32 a198, v108
v_accvgpr_write_b32 a199, v110
v_mfma_f32_16x16x32_bf16 v[76:79], v[36:39], v[232:235], v[76:79]
s_waitcnt lgkmcnt(0)
v_mfma_f32_16x16x32_bf16 v[48:51], v[40:43], v[140:143], v[48:51]
ds_read_b128 v[32:35], v14 offset:256
ds_read_b128 v[36:39], v14 offset:8448
v_mfma_f32_16x16x32_bf16 v[52:55], v[44:47], v[140:143], v[52:55]
v_mfma_f32_16x16x32_bf16 v[56:59], v[40:43], v[172:175], v[56:59]
s_add_u32 m0, s32, 34816
s_nop 0
buffer_load_dwordx4 v22, s[8:11], s28 offen lds
v_mfma_f32_16x16x32_bf16 v[60:63], v[44:47], v[172:175], v[60:63]
v_mfma_f32_16x16x32_bf16 v[64:67], v[40:43], v[204:207], v[64:67]
v_mfma_f32_16x16x32_bf16 v[68:71], v[44:47], v[204:207], v[68:71]
v_mfma_f32_16x16x32_bf16 v[72:75], v[40:43], v[236:239], v[72:75]
v_mfma_f32_16x16x32_bf16 v[76:79], v[44:47], v[236:239], v[76:79]
s_waitcnt lgkmcnt(0)
v_mfma_f32_16x16x32_bf16 v[48:51], v[32:35], v[144:147], v[48:51]
ds_read_b128 v[40:43], v15 offset:256
ds_read_b128 v[44:47], v15 offset:8448
v_mfma_f32_16x16x32_bf16 v[52:55], v[36:39], v[144:147], v[52:55]
v_mfma_f32_16x16x32_bf16 v[56:59], v[32:35], v[176:179], v[56:59]
v_mfma_f32_16x16x32_bf16 v[60:63], v[36:39], v[176:179], v[60:63]
v_mfma_f32_16x16x32_bf16 v[64:67], v[32:35], v[208:211], v[64:67]
v_mfma_f32_16x16x32_bf16 v[68:71], v[36:39], v[208:211], v[68:71]
v_mfma_f32_16x16x32_bf16 v[72:75], v[32:35], v[240:243], v[72:75]
v_mfma_f32_16x16x32_bf16 v[76:79], v[36:39], v[240:243], v[76:79]
s_waitcnt lgkmcnt(0)
v_mfma_f32_16x16x32_bf16 v[48:51], v[40:43], v[148:151], v[48:51]
ds_read_b128 v[32:35], v12 offset:16384
ds_read_b128 v[36:39], v12 offset:24576
v_mfma_f32_16x16x32_bf16 v[52:55], v[44:47], v[148:151], v[52:55]
v_mfma_f32_16x16x32_bf16 v[56:59], v[40:43], v[180:183], v[56:59]
s_add_u32 m0, s32, 35840
s_nop 0
buffer_load_dwordx4 v23, s[8:11], s28 offen lds
s_add_u32 s28, s28, 262144
v_mfma_f32_16x16x32_bf16 v[60:63], v[44:47], v[180:183], v[60:63]
v_mfma_f32_16x16x32_bf16 v[64:67], v[40:43], v[212:215], v[64:67]
v_mfma_f32_16x16x32_bf16 v[68:71], v[44:47], v[212:215], v[68:71]
v_mfma_f32_16x16x32_bf16 v[72:75], v[40:43], v[244:247], v[72:75]
v_mfma_f32_16x16x32_bf16 v[76:79], v[44:47], v[244:247], v[76:79]
s_waitcnt vmcnt(8)
s_barrier
s_waitcnt lgkmcnt(0)
v_mfma_f32_16x16x32_bf16 v[80:83], v[32:35], v[120:123], 0
ds_read_b128 v[40:43], v13 offset:16384
ds_read_b128 v[44:47], v13 offset:24576
v_mfma_f32_16x16x32_bf16 v[84:87], v[36:39], v[120:123], 0
v_mfma_f32_16x16x32_bf16 v[88:91], v[32:35], v[152:155], 0
v_mfma_f32_16x16x32_bf16 v[92:95], v[36:39], v[152:155], 0
v_mul_f32 v48, s31, v48
v_mul_f32 v49, s31, v49
v_mfma_f32_16x16x32_bf16 v[96:99], v[32:35], v[184:187], 0
v_mul_f32 v50, s31, v50
v_mul_f32 v51, s31, v51
v_mfma_f32_16x16x32_bf16 v[100:103], v[36:39], v[184:187], 0
v_mul_f32 v52, s31, v52
v_mul_f32 v53, s31, v53
v_mfma_f32_16x16x32_bf16 v[104:107], v[32:35], v[216:219], 0
v_mul_f32 v54, s31, v54
v_mul_f32 v55, s31, v55
v_mfma_f32_16x16x32_bf16 v[108:111], v[36:39], v[216:219], 0
v_cvt_pk_bf16_f32 v48, v48, v49
v_cvt_pk_bf16_f32 v50, v50, v51
s_waitcnt lgkmcnt(0)
v_mfma_f32_16x16x32_bf16 v[80:83], v[40:43], v[124:127], v[80:83]
ds_read_b128 v[32:35], v14 offset:16384
ds_read_b128 v[36:39], v14 offset:24576
v_mfma_f32_16x16x32_bf16 v[84:87], v[44:47], v[124:127], v[84:87]
v_cvt_pk_bf16_f32 v52, v52, v53
v_cvt_pk_bf16_f32 v54, v54, v55
v_mfma_f32_16x16x32_bf16 v[88:91], v[40:43], v[156:159], v[88:91]
s_add_u32 m0, s32, 49152
s_nop 0
buffer_load_dwordx4 v20, s[8:11], s28 offen lds
v_accvgpr_write_b32 a32, v48
v_accvgpr_write_b32 a33, v50
v_mfma_f32_16x16x32_bf16 v[92:95], v[44:47], v[156:159], v[92:95]
v_accvgpr_write_b32 a34, v52
v_accvgpr_write_b32 a35, v54
v_mfma_f32_16x16x32_bf16 v[96:99], v[40:43], v[188:191], v[96:99]
v_mul_f32 v56, s31, v56
v_mul_f32 v57, s31, v57
v_mfma_f32_16x16x32_bf16 v[100:103], v[44:47], v[188:191], v[100:103]
v_mul_f32 v58, s31, v58
v_mul_f32 v59, s31, v59
v_mfma_f32_16x16x32_bf16 v[104:107], v[40:43], v[220:223], v[104:107]
v_mul_f32 v60, s31, v60
v_mul_f32 v61, s31, v61
v_mfma_f32_16x16x32_bf16 v[108:111], v[44:47], v[220:223], v[108:111]
v_mul_f32 v62, s31, v62
v_mul_f32 v63, s31, v63
s_waitcnt lgkmcnt(0)
v_mfma_f32_16x16x32_bf16 v[80:83], v[32:35], v[128:131], v[80:83]
ds_read_b128 v[40:43], v15 offset:16384
ds_read_b128 v[44:47], v15 offset:24576
v_mfma_f32_16x16x32_bf16 v[84:87], v[36:39], v[128:131], v[84:87]
v_cvt_pk_bf16_f32 v56, v56, v57
v_cvt_pk_bf16_f32 v58, v58, v59
v_mfma_f32_16x16x32_bf16 v[88:91], v[32:35], v[160:163], v[88:91]
v_cvt_pk_bf16_f32 v60, v60, v61
v_cvt_pk_bf16_f32 v62, v62, v63
v_mfma_f32_16x16x32_bf16 v[92:95], v[36:39], v[160:163], v[92:95]
v_accvgpr_write_b32 a88, v56
v_accvgpr_write_b32 a89, v58
v_mfma_f32_16x16x32_bf16 v[96:99], v[32:35], v[192:195], v[96:99]
v_accvgpr_write_b32 a90, v60
v_accvgpr_write_b32 a91, v62
v_mfma_f32_16x16x32_bf16 v[100:103], v[36:39], v[192:195], v[100:103]
v_mul_f32 v64, s31, v64
v_mul_f32 v65, s31, v65
v_mfma_f32_16x16x32_bf16 v[104:107], v[32:35], v[224:227], v[104:107]
v_mul_f32 v66, s31, v66
v_mul_f32 v67, s31, v67
v_mfma_f32_16x16x32_bf16 v[108:111], v[36:39], v[224:227], v[108:111]
v_mul_f32 v68, s31, v68
v_mul_f32 v69, s31, v69
s_waitcnt lgkmcnt(0)
v_mfma_f32_16x16x32_bf16 v[80:83], v[40:43], v[132:135], v[80:83]
ds_read_b128 v[32:35], v12 offset:16640
ds_read_b128 v[36:39], v12 offset:24832
v_mfma_f32_16x16x32_bf16 v[84:87], v[44:47], v[132:135], v[84:87]
v_mul_f32 v70, s31, v70
v_mul_f32 v71, s31, v71
v_mfma_f32_16x16x32_bf16 v[88:91], v[40:43], v[164:167], v[88:91]
s_add_u32 m0, s32, 50176
s_nop 0
buffer_load_dwordx4 v21, s[8:11], s28 offen lds
v_cvt_pk_bf16_f32 v64, v64, v65
v_cvt_pk_bf16_f32 v66, v66, v67
v_mfma_f32_16x16x32_bf16 v[92:95], v[44:47], v[164:167], v[92:95]
v_cvt_pk_bf16_f32 v68, v68, v69
v_cvt_pk_bf16_f32 v70, v70, v71
v_mfma_f32_16x16x32_bf16 v[96:99], v[40:43], v[196:199], v[96:99]
v_accvgpr_write_b32 a144, v64
v_accvgpr_write_b32 a145, v66
v_mfma_f32_16x16x32_bf16 v[100:103], v[44:47], v[196:199], v[100:103]
v_accvgpr_write_b32 a146, v68
v_accvgpr_write_b32 a147, v70
v_mfma_f32_16x16x32_bf16 v[104:107], v[40:43], v[228:231], v[104:107]
v_mul_f32 v72, s31, v72
v_mul_f32 v73, s31, v73
v_mfma_f32_16x16x32_bf16 v[108:111], v[44:47], v[228:231], v[108:111]
v_mul_f32 v74, s31, v74
v_mul_f32 v75, s31, v75
s_waitcnt lgkmcnt(0)
v_mfma_f32_16x16x32_bf16 v[80:83], v[32:35], v[136:139], v[80:83]
ds_read_b128 v[40:43], v13 offset:16640
ds_read_b128 v[44:47], v13 offset:24832
v_mfma_f32_16x16x32_bf16 v[84:87], v[36:39], v[136:139], v[84:87]
v_mul_f32 v76, s31, v76
v_mul_f32 v77, s31, v77
v_mfma_f32_16x16x32_bf16 v[88:91], v[32:35], v[168:171], v[88:91]
v_mul_f32 v78, s31, v78
v_mul_f32 v79, s31, v79
v_mfma_f32_16x16x32_bf16 v[92:95], v[36:39], v[168:171], v[92:95]
v_cvt_pk_bf16_f32 v72, v72, v73
v_cvt_pk_bf16_f32 v74, v74, v75
v_mfma_f32_16x16x32_bf16 v[96:99], v[32:35], v[200:203], v[96:99]
v_cvt_pk_bf16_f32 v76, v76, v77
v_cvt_pk_bf16_f32 v78, v78, v79
v_mfma_f32_16x16x32_bf16 v[100:103], v[36:39], v[200:203], v[100:103]
v_accvgpr_write_b32 a200, v72
v_accvgpr_write_b32 a201, v74
v_mfma_f32_16x16x32_bf16 v[104:107], v[32:35], v[232:235], v[104:107]
v_accvgpr_write_b32 a202, v76
v_accvgpr_write_b32 a203, v78
v_mfma_f32_16x16x32_bf16 v[108:111], v[36:39], v[232:235], v[108:111]
s_waitcnt lgkmcnt(0)
v_mfma_f32_16x16x32_bf16 v[80:83], v[40:43], v[140:143], v[80:83]
ds_read_b128 v[32:35], v14 offset:16640
ds_read_b128 v[36:39], v14 offset:24832
v_mfma_f32_16x16x32_bf16 v[84:87], v[44:47], v[140:143], v[84:87]
v_mfma_f32_16x16x32_bf16 v[88:91], v[40:43], v[172:175], v[88:91]
s_add_u32 m0, s32, 51200
s_nop 0
buffer_load_dwordx4 v22, s[8:11], s28 offen lds
v_mfma_f32_16x16x32_bf16 v[92:95], v[44:47], v[172:175], v[92:95]
v_mfma_f32_16x16x32_bf16 v[96:99], v[40:43], v[204:207], v[96:99]
v_mfma_f32_16x16x32_bf16 v[100:103], v[44:47], v[204:207], v[100:103]
v_mfma_f32_16x16x32_bf16 v[104:107], v[40:43], v[236:239], v[104:107]
v_mfma_f32_16x16x32_bf16 v[108:111], v[44:47], v[236:239], v[108:111]
s_waitcnt lgkmcnt(0)
v_mfma_f32_16x16x32_bf16 v[80:83], v[32:35], v[144:147], v[80:83]
ds_read_b128 v[40:43], v15 offset:16640
ds_read_b128 v[44:47], v15 offset:24832
v_mfma_f32_16x16x32_bf16 v[84:87], v[36:39], v[144:147], v[84:87]
v_mfma_f32_16x16x32_bf16 v[88:91], v[32:35], v[176:179], v[88:91]
v_mfma_f32_16x16x32_bf16 v[92:95], v[36:39], v[176:179], v[92:95]
v_mfma_f32_16x16x32_bf16 v[96:99], v[32:35], v[208:211], v[96:99]
v_mfma_f32_16x16x32_bf16 v[100:103], v[36:39], v[208:211], v[100:103]
v_mfma_f32_16x16x32_bf16 v[104:107], v[32:35], v[240:243], v[104:107]
v_mfma_f32_16x16x32_bf16 v[108:111], v[36:39], v[240:243], v[108:111]
s_waitcnt lgkmcnt(0)
v_mfma_f32_16x16x32_bf16 v[80:83], v[40:43], v[148:151], v[80:83]
ds_read_b128 v[32:35], v8
ds_read_b128 v[36:39], v8 offset:8192
v_mfma_f32_16x16x32_bf16 v[84:87], v[44:47], v[148:151], v[84:87]
v_mfma_f32_16x16x32_bf16 v[88:91], v[40:43], v[180:183], v[88:91]
s_add_u32 m0, s32, 52224
s_nop 0
buffer_load_dwordx4 v23, s[8:11], s28 offen lds
s_add_u32 s28, s28, 262144
v_mfma_f32_16x16x32_bf16 v[92:95], v[44:47], v[180:183], v[92:95]
v_mfma_f32_16x16x32_bf16 v[96:99], v[40:43], v[212:215], v[96:99]
v_mfma_f32_16x16x32_bf16 v[100:103], v[44:47], v[212:215], v[100:103]
v_mfma_f32_16x16x32_bf16 v[104:107], v[40:43], v[244:247], v[104:107]
v_mfma_f32_16x16x32_bf16 v[108:111], v[44:47], v[244:247], v[108:111]
s_waitcnt vmcnt(8)
s_barrier
s_waitcnt lgkmcnt(0)
v_mfma_f32_16x16x32_bf16 v[48:51], v[32:35], v[120:123], 0
ds_read_b128 v[40:43], v9
ds_read_b128 v[44:47], v9 offset:8192
v_mfma_f32_16x16x32_bf16 v[52:55], v[36:39], v[120:123], 0
v_mfma_f32_16x16x32_bf16 v[56:59], v[32:35], v[152:155], 0
v_mfma_f32_16x16x32_bf16 v[60:63], v[36:39], v[152:155], 0
v_mul_f32 v80, s31, v80
v_mul_f32 v81, s31, v81
v_mfma_f32_16x16x32_bf16 v[64:67], v[32:35], v[184:187], 0
v_mul_f32 v82, s31, v82
v_mul_f32 v83, s31, v83
v_mfma_f32_16x16x32_bf16 v[68:71], v[36:39], v[184:187], 0
v_mul_f32 v84, s31, v84
v_mul_f32 v85, s31, v85
v_mfma_f32_16x16x32_bf16 v[72:75], v[32:35], v[216:219], 0
v_mul_f32 v86, s31, v86
v_mul_f32 v87, s31, v87
v_mfma_f32_16x16x32_bf16 v[76:79], v[36:39], v[216:219], 0
v_cvt_pk_bf16_f32 v80, v80, v81
v_cvt_pk_bf16_f32 v82, v82, v83
s_waitcnt lgkmcnt(0)
v_mfma_f32_16x16x32_bf16 v[48:51], v[40:43], v[124:127], v[48:51]
ds_read_b128 v[32:35], v10
ds_read_b128 v[36:39], v10 offset:8192
v_mfma_f32_16x16x32_bf16 v[52:55], v[44:47], v[124:127], v[52:55]
v_cvt_pk_bf16_f32 v84, v84, v85
v_cvt_pk_bf16_f32 v86, v86, v87
v_mfma_f32_16x16x32_bf16 v[56:59], v[40:43], v[156:159], v[56:59]
v_accvgpr_write_b32 a36, v80
v_accvgpr_write_b32 a37, v82
v_mfma_f32_16x16x32_bf16 v[60:63], v[44:47], v[156:159], v[60:63]
v_accvgpr_write_b32 a38, v84
v_accvgpr_write_b32 a39, v86
v_mfma_f32_16x16x32_bf16 v[64:67], v[40:43], v[188:191], v[64:67]
v_mul_f32 v88, s31, v88
v_mul_f32 v89, s31, v89
v_mfma_f32_16x16x32_bf16 v[68:71], v[44:47], v[188:191], v[68:71]
v_mul_f32 v90, s31, v90
v_mul_f32 v91, s31, v91
v_mfma_f32_16x16x32_bf16 v[72:75], v[40:43], v[220:223], v[72:75]
v_mul_f32 v92, s31, v92
v_mul_f32 v93, s31, v93
v_mfma_f32_16x16x32_bf16 v[76:79], v[44:47], v[220:223], v[76:79]
v_mul_f32 v94, s31, v94
v_mul_f32 v95, s31, v95
s_waitcnt lgkmcnt(0)
v_mfma_f32_16x16x32_bf16 v[48:51], v[32:35], v[128:131], v[48:51]
ds_read_b128 v[40:43], v11
ds_read_b128 v[44:47], v11 offset:8192
v_mfma_f32_16x16x32_bf16 v[52:55], v[36:39], v[128:131], v[52:55]
v_cvt_pk_bf16_f32 v88, v88, v89
v_cvt_pk_bf16_f32 v90, v90, v91
v_mfma_f32_16x16x32_bf16 v[56:59], v[32:35], v[160:163], v[56:59]
v_cvt_pk_bf16_f32 v92, v92, v93
v_cvt_pk_bf16_f32 v94, v94, v95
v_mfma_f32_16x16x32_bf16 v[60:63], v[36:39], v[160:163], v[60:63]
v_accvgpr_write_b32 a92, v88
v_accvgpr_write_b32 a93, v90
v_mfma_f32_16x16x32_bf16 v[64:67], v[32:35], v[192:195], v[64:67]
v_accvgpr_write_b32 a94, v92
v_accvgpr_write_b32 a95, v94
v_mfma_f32_16x16x32_bf16 v[68:71], v[36:39], v[192:195], v[68:71]
v_mul_f32 v96, s31, v96
v_mul_f32 v97, s31, v97
v_mfma_f32_16x16x32_bf16 v[72:75], v[32:35], v[224:227], v[72:75]
v_mul_f32 v98, s31, v98
v_mul_f32 v99, s31, v99
v_mfma_f32_16x16x32_bf16 v[76:79], v[36:39], v[224:227], v[76:79]
v_mul_f32 v100, s31, v100
v_mul_f32 v101, s31, v101
s_waitcnt lgkmcnt(0)
v_mfma_f32_16x16x32_bf16 v[48:51], v[40:43], v[132:135], v[48:51]
ds_read_b128 v[32:35], v8 offset:256
ds_read_b128 v[36:39], v8 offset:8448
v_mfma_f32_16x16x32_bf16 v[52:55], v[44:47], v[132:135], v[52:55]
v_mul_f32 v102, s31, v102
v_mul_f32 v103, s31, v103
v_mfma_f32_16x16x32_bf16 v[56:59], v[40:43], v[164:167], v[56:59]
v_cvt_pk_bf16_f32 v96, v96, v97
v_cvt_pk_bf16_f32 v98, v98, v99
v_mfma_f32_16x16x32_bf16 v[60:63], v[44:47], v[164:167], v[60:63]
v_cvt_pk_bf16_f32 v100, v100, v101
v_cvt_pk_bf16_f32 v102, v102, v103
v_mfma_f32_16x16x32_bf16 v[64:67], v[40:43], v[196:199], v[64:67]
v_accvgpr_write_b32 a148, v96
v_accvgpr_write_b32 a149, v98
v_mfma_f32_16x16x32_bf16 v[68:71], v[44:47], v[196:199], v[68:71]
v_accvgpr_write_b32 a150, v100
v_accvgpr_write_b32 a151, v102
v_mfma_f32_16x16x32_bf16 v[72:75], v[40:43], v[228:231], v[72:75]
v_mul_f32 v104, s31, v104
v_mul_f32 v105, s31, v105
v_mfma_f32_16x16x32_bf16 v[76:79], v[44:47], v[228:231], v[76:79]
v_mul_f32 v106, s31, v106
v_mul_f32 v107, s31, v107
s_waitcnt lgkmcnt(0)
v_mfma_f32_16x16x32_bf16 v[48:51], v[32:35], v[136:139], v[48:51]
ds_read_b128 v[40:43], v9 offset:256
ds_read_b128 v[44:47], v9 offset:8448
v_mfma_f32_16x16x32_bf16 v[52:55], v[36:39], v[136:139], v[52:55]
buffer_load_dword v4, v3, s[4:7], s29 offen sc1
v_mul_f32 v108, s31, v108
v_mul_f32 v109, s31, v109
v_mfma_f32_16x16x32_bf16 v[56:59], v[32:35], v[168:171], v[56:59]
v_mul_f32 v110, s31, v110
v_mul_f32 v111, s31, v111
v_mfma_f32_16x16x32_bf16 v[60:63], v[36:39], v[168:171], v[60:63]
v_cvt_pk_bf16_f32 v104, v104, v105
v_cvt_pk_bf16_f32 v106, v106, v107
v_mfma_f32_16x16x32_bf16 v[64:67], v[32:35], v[200:203], v[64:67]
v_cvt_pk_bf16_f32 v108, v108, v109
v_cvt_pk_bf16_f32 v110, v110, v111
v_mfma_f32_16x16x32_bf16 v[68:71], v[36:39], v[200:203], v[68:71]
v_accvgpr_write_b32 a204, v104
v_accvgpr_write_b32 a205, v106
v_mfma_f32_16x16x32_bf16 v[72:75], v[32:35], v[232:235], v[72:75]
v_accvgpr_write_b32 a206, v108
v_accvgpr_write_b32 a207, v110
v_mfma_f32_16x16x32_bf16 v[76:79], v[36:39], v[232:235], v[76:79]
s_waitcnt lgkmcnt(0)
v_mfma_f32_16x16x32_bf16 v[48:51], v[40:43], v[140:143], v[48:51]
ds_read_b128 v[32:35], v10 offset:256
ds_read_b128 v[36:39], v10 offset:8448
v_mfma_f32_16x16x32_bf16 v[52:55], v[44:47], v[140:143], v[52:55]
v_mfma_f32_16x16x32_bf16 v[56:59], v[40:43], v[172:175], v[56:59]
v_mfma_f32_16x16x32_bf16 v[60:63], v[44:47], v[172:175], v[60:63]
v_mfma_f32_16x16x32_bf16 v[64:67], v[40:43], v[204:207], v[64:67]
v_mfma_f32_16x16x32_bf16 v[68:71], v[44:47], v[204:207], v[68:71]
v_mfma_f32_16x16x32_bf16 v[72:75], v[40:43], v[236:239], v[72:75]
v_mfma_f32_16x16x32_bf16 v[76:79], v[44:47], v[236:239], v[76:79]
s_waitcnt lgkmcnt(0)
v_mfma_f32_16x16x32_bf16 v[48:51], v[32:35], v[144:147], v[48:51]
ds_read_b128 v[40:43], v11 offset:256
ds_read_b128 v[44:47], v11 offset:8448
v_mfma_f32_16x16x32_bf16 v[52:55], v[36:39], v[144:147], v[52:55]
v_mfma_f32_16x16x32_bf16 v[56:59], v[32:35], v[176:179], v[56:59]
v_mfma_f32_16x16x32_bf16 v[60:63], v[36:39], v[176:179], v[60:63]
v_mfma_f32_16x16x32_bf16 v[64:67], v[32:35], v[208:211], v[64:67]
v_mfma_f32_16x16x32_bf16 v[68:71], v[36:39], v[208:211], v[68:71]
v_mfma_f32_16x16x32_bf16 v[72:75], v[32:35], v[240:243], v[72:75]
v_mfma_f32_16x16x32_bf16 v[76:79], v[36:39], v[240:243], v[76:79]
s_waitcnt lgkmcnt(0)
v_mfma_f32_16x16x32_bf16 v[48:51], v[40:43], v[148:151], v[48:51]
ds_read_b128 v[32:35], v8 offset:16384
ds_read_b128 v[36:39], v8 offset:24576
v_mfma_f32_16x16x32_bf16 v[52:55], v[44:47], v[148:151], v[52:55]
v_mfma_f32_16x16x32_bf16 v[56:59], v[40:43], v[180:183], v[56:59]
v_mfma_f32_16x16x32_bf16 v[60:63], v[44:47], v[180:183], v[60:63]
v_mfma_f32_16x16x32_bf16 v[64:67], v[40:43], v[212:215], v[64:67]
v_mfma_f32_16x16x32_bf16 v[68:71], v[44:47], v[212:215], v[68:71]
v_mfma_f32_16x16x32_bf16 v[72:75], v[40:43], v[244:247], v[72:75]
v_mfma_f32_16x16x32_bf16 v[76:79], v[44:47], v[244:247], v[76:79]
s_waitcnt vmcnt(5)
s_barrier
s_waitcnt lgkmcnt(0)
v_mfma_f32_16x16x32_bf16 v[80:83], v[32:35], v[120:123], 0
ds_read_b128 v[40:43], v9 offset:16384
ds_read_b128 v[44:47], v9 offset:24576
v_mfma_f32_16x16x32_bf16 v[84:87], v[36:39], v[120:123], 0
v_mfma_f32_16x16x32_bf16 v[88:91], v[32:35], v[152:155], 0
v_mfma_f32_16x16x32_bf16 v[92:95], v[36:39], v[152:155], 0
v_mul_f32 v48, s31, v48
v_mul_f32 v49, s31, v49
v_mfma_f32_16x16x32_bf16 v[96:99], v[32:35], v[184:187], 0
v_mul_f32 v50, s31, v50
v_mul_f32 v51, s31, v51
v_mfma_f32_16x16x32_bf16 v[100:103], v[36:39], v[184:187], 0
v_mul_f32 v52, s31, v52
v_mul_f32 v53, s31, v53
v_mfma_f32_16x16x32_bf16 v[104:107], v[32:35], v[216:219], 0
v_mul_f32 v54, s31, v54
v_mul_f32 v55, s31, v55
v_mfma_f32_16x16x32_bf16 v[108:111], v[36:39], v[216:219], 0
v_cvt_pk_bf16_f32 v48, v48, v49
v_cvt_pk_bf16_f32 v50, v50, v51
s_waitcnt lgkmcnt(0)
v_mfma_f32_16x16x32_bf16 v[80:83], v[40:43], v[124:127], v[80:83]
ds_read_b128 v[32:35], v10 offset:16384
ds_read_b128 v[36:39], v10 offset:24576
v_mfma_f32_16x16x32_bf16 v[84:87], v[44:47], v[124:127], v[84:87]
v_cvt_pk_bf16_f32 v52, v52, v53
v_cvt_pk_bf16_f32 v54, v54, v55
v_mfma_f32_16x16x32_bf16 v[88:91], v[40:43], v[156:159], v[88:91]
v_accvgpr_write_b32 a40, v48
v_accvgpr_write_b32 a41, v50
v_mfma_f32_16x16x32_bf16 v[92:95], v[44:47], v[156:159], v[92:95]
v_accvgpr_write_b32 a42, v52
v_accvgpr_write_b32 a43, v54
v_mfma_f32_16x16x32_bf16 v[96:99], v[40:43], v[188:191], v[96:99]
v_mul_f32 v56, s31, v56
v_mul_f32 v57, s31, v57
v_mfma_f32_16x16x32_bf16 v[100:103], v[44:47], v[188:191], v[100:103]
v_mul_f32 v58, s31, v58
v_mul_f32 v59, s31, v59
v_mfma_f32_16x16x32_bf16 v[104:107], v[40:43], v[220:223], v[104:107]
v_mul_f32 v60, s31, v60
v_mul_f32 v61, s31, v61
v_mfma_f32_16x16x32_bf16 v[108:111], v[44:47], v[220:223], v[108:111]
v_mul_f32 v62, s31, v62
v_mul_f32 v63, s31, v63
s_waitcnt lgkmcnt(0)
v_mfma_f32_16x16x32_bf16 v[80:83], v[32:35], v[128:131], v[80:83]
ds_read_b128 v[40:43], v11 offset:16384
ds_read_b128 v[44:47], v11 offset:24576
v_mfma_f32_16x16x32_bf16 v[84:87], v[36:39], v[128:131], v[84:87]
v_cvt_pk_bf16_f32 v56, v56, v57
v_cvt_pk_bf16_f32 v58, v58, v59
v_mfma_f32_16x16x32_bf16 v[88:91], v[32:35], v[160:163], v[88:91]
v_cvt_pk_bf16_f32 v60, v60, v61
v_cvt_pk_bf16_f32 v62, v62, v63
v_mfma_f32_16x16x32_bf16 v[92:95], v[36:39], v[160:163], v[92:95]
v_accvgpr_write_b32 a96, v56
v_accvgpr_write_b32 a97, v58
v_mfma_f32_16x16x32_bf16 v[96:99], v[32:35], v[192:195], v[96:99]
v_accvgpr_write_b32 a98, v60
v_accvgpr_write_b32 a99, v62
v_mfma_f32_16x16x32_bf16 v[100:103], v[36:39], v[192:195], v[100:103]
v_mul_f32 v64, s31, v64
v_mul_f32 v65, s31, v65
v_mfma_f32_16x16x32_bf16 v[104:107], v[32:35], v[224:227], v[104:107]
v_mul_f32 v66, s31, v66
v_mul_f32 v67, s31, v67
v_mfma_f32_16x16x32_bf16 v[108:111], v[36:39], v[224:227], v[108:111]
v_mul_f32 v68, s31, v68
v_mul_f32 v69, s31, v69
s_waitcnt lgkmcnt(0)
v_mfma_f32_16x16x32_bf16 v[80:83], v[40:43], v[132:135], v[80:83]
ds_read_b128 v[32:35], v8 offset:16640
ds_read_b128 v[36:39], v8 offset:24832
v_mfma_f32_16x16x32_bf16 v[84:87], v[44:47], v[132:135], v[84:87]
v_mul_f32 v70, s31, v70
v_mul_f32 v71, s31, v71
v_mfma_f32_16x16x32_bf16 v[88:91], v[40:43], v[164:167], v[88:91]
v_cvt_pk_bf16_f32 v64, v64, v65
v_cvt_pk_bf16_f32 v66, v66, v67
v_mfma_f32_16x16x32_bf16 v[92:95], v[44:47], v[164:167], v[92:95]
v_cvt_pk_bf16_f32 v68, v68, v69
v_cvt_pk_bf16_f32 v70, v70, v71
v_mfma_f32_16x16x32_bf16 v[96:99], v[40:43], v[196:199], v[96:99]
v_accvgpr_write_b32 a152, v64
v_accvgpr_write_b32 a153, v66
v_mfma_f32_16x16x32_bf16 v[100:103], v[44:47], v[196:199], v[100:103]
v_accvgpr_write_b32 a154, v68
v_accvgpr_write_b32 a155, v70
v_mfma_f32_16x16x32_bf16 v[104:107], v[40:43], v[228:231], v[104:107]
v_mul_f32 v72, s31, v72
v_mul_f32 v73, s31, v73
v_mfma_f32_16x16x32_bf16 v[108:111], v[44:47], v[228:231], v[108:111]
v_mul_f32 v74, s31, v74
v_mul_f32 v75, s31, v75
s_waitcnt lgkmcnt(0)
v_mfma_f32_16x16x32_bf16 v[80:83], v[32:35], v[136:139], v[80:83]
ds_read_b128 v[40:43], v9 offset:16640
ds_read_b128 v[44:47], v9 offset:24832
v_mfma_f32_16x16x32_bf16 v[84:87], v[36:39], v[136:139], v[84:87]
v_mul_f32 v76, s31, v76
v_mul_f32 v77, s31, v77
v_mfma_f32_16x16x32_bf16 v[88:91], v[32:35], v[168:171], v[88:91]
v_mul_f32 v78, s31, v78
v_mul_f32 v79, s31, v79
v_mfma_f32_16x16x32_bf16 v[92:95], v[36:39], v[168:171], v[92:95]
v_cvt_pk_bf16_f32 v72, v72, v73
v_cvt_pk_bf16_f32 v74, v74, v75
v_mfma_f32_16x16x32_bf16 v[96:99], v[32:35], v[200:203], v[96:99]
v_cvt_pk_bf16_f32 v76, v76, v77
v_cvt_pk_bf16_f32 v78, v78, v79
v_mfma_f32_16x16x32_bf16 v[100:103], v[36:39], v[200:203], v[100:103]
v_accvgpr_write_b32 a208, v72
v_accvgpr_write_b32 a209, v74
v_mfma_f32_16x16x32_bf16 v[104:107], v[32:35], v[232:235], v[104:107]
v_accvgpr_write_b32 a210, v76
v_accvgpr_write_b32 a211, v78
v_mfma_f32_16x16x32_bf16 v[108:111], v[36:39], v[232:235], v[108:111]
s_waitcnt lgkmcnt(0)
v_mfma_f32_16x16x32_bf16 v[80:83], v[40:43], v[140:143], v[80:83]
ds_read_b128 v[32:35], v10 offset:16640
ds_read_b128 v[36:39], v10 offset:24832
v_mfma_f32_16x16x32_bf16 v[84:87], v[44:47], v[140:143], v[84:87]
v_mfma_f32_16x16x32_bf16 v[88:91], v[40:43], v[172:175], v[88:91]
v_mfma_f32_16x16x32_bf16 v[92:95], v[44:47], v[172:175], v[92:95]
v_mfma_f32_16x16x32_bf16 v[96:99], v[40:43], v[204:207], v[96:99]
v_mfma_f32_16x16x32_bf16 v[100:103], v[44:47], v[204:207], v[100:103]
v_mfma_f32_16x16x32_bf16 v[104:107], v[40:43], v[236:239], v[104:107]
v_mfma_f32_16x16x32_bf16 v[108:111], v[44:47], v[236:239], v[108:111]
s_waitcnt lgkmcnt(0)
v_mfma_f32_16x16x32_bf16 v[80:83], v[32:35], v[144:147], v[80:83]
ds_read_b128 v[40:43], v11 offset:16640
ds_read_b128 v[44:47], v11 offset:24832
v_mfma_f32_16x16x32_bf16 v[84:87], v[36:39], v[144:147], v[84:87]
v_mfma_f32_16x16x32_bf16 v[88:91], v[32:35], v[176:179], v[88:91]
v_mfma_f32_16x16x32_bf16 v[92:95], v[36:39], v[176:179], v[92:95]
v_mfma_f32_16x16x32_bf16 v[96:99], v[32:35], v[208:211], v[96:99]
v_mfma_f32_16x16x32_bf16 v[100:103], v[36:39], v[208:211], v[100:103]
v_mfma_f32_16x16x32_bf16 v[104:107], v[32:35], v[240:243], v[104:107]
v_mfma_f32_16x16x32_bf16 v[108:111], v[36:39], v[240:243], v[108:111]
s_waitcnt lgkmcnt(0)
v_mfma_f32_16x16x32_bf16 v[80:83], v[40:43], v[148:151], v[80:83]
ds_read_b128 v[32:35], v8 offset:32768
ds_read_b128 v[36:39], v8 offset:40960
v_mfma_f32_16x16x32_bf16 v[84:87], v[44:47], v[148:151], v[84:87]
v_mfma_f32_16x16x32_bf16 v[88:91], v[40:43], v[180:183], v[88:91]
v_mfma_f32_16x16x32_bf16 v[92:95], v[44:47], v[180:183], v[92:95]
v_mfma_f32_16x16x32_bf16 v[96:99], v[40:43], v[212:215], v[96:99]
v_mfma_f32_16x16x32_bf16 v[100:103], v[44:47], v[212:215], v[100:103]
v_mfma_f32_16x16x32_bf16 v[104:107], v[40:43], v[244:247], v[104:107]
v_mfma_f32_16x16x32_bf16 v[108:111], v[44:47], v[244:247], v[108:111]
s_waitcnt vmcnt(1)
s_barrier
s_waitcnt lgkmcnt(0)
v_mfma_f32_16x16x32_bf16 v[48:51], v[32:35], v[120:123], 0
ds_read_b128 v[40:43], v9 offset:32768
ds_read_b128 v[44:47], v9 offset:40960
v_mfma_f32_16x16x32_bf16 v[52:55], v[36:39], v[120:123], 0
v_mfma_f32_16x16x32_bf16 v[56:59], v[32:35], v[152:155], 0
v_mfma_f32_16x16x32_bf16 v[60:63], v[36:39], v[152:155], 0
v_mul_f32 v80, s31, v80
v_mul_f32 v81, s31, v81
v_mfma_f32_16x16x32_bf16 v[64:67], v[32:35], v[184:187], 0
v_mul_f32 v82, s31, v82
v_mul_f32 v83, s31, v83
v_mfma_f32_16x16x32_bf16 v[68:71], v[36:39], v[184:187], 0
v_mul_f32 v84, s31, v84
v_mul_f32 v85, s31, v85
v_mfma_f32_16x16x32_bf16 v[72:75], v[32:35], v[216:219], 0
v_mul_f32 v86, s31, v86
v_mul_f32 v87, s31, v87
v_mfma_f32_16x16x32_bf16 v[76:79], v[36:39], v[216:219], 0
v_cvt_pk_bf16_f32 v80, v80, v81
v_cvt_pk_bf16_f32 v82, v82, v83
s_waitcnt lgkmcnt(0)
v_mfma_f32_16x16x32_bf16 v[48:51], v[40:43], v[124:127], v[48:51]
ds_read_b128 v[32:35], v10 offset:32768
ds_read_b128 v[36:39], v10 offset:40960
v_mfma_f32_16x16x32_bf16 v[52:55], v[44:47], v[124:127], v[52:55]
v_cvt_pk_bf16_f32 v84, v84, v85
v_cvt_pk_bf16_f32 v86, v86, v87
v_mfma_f32_16x16x32_bf16 v[56:59], v[40:43], v[156:159], v[56:59]
v_accvgpr_write_b32 a44, v80
v_accvgpr_write_b32 a45, v82
v_mfma_f32_16x16x32_bf16 v[60:63], v[44:47], v[156:159], v[60:63]
v_accvgpr_write_b32 a46, v84
v_accvgpr_write_b32 a47, v86
v_mfma_f32_16x16x32_bf16 v[64:67], v[40:43], v[188:191], v[64:67]
v_mul_f32 v88, s31, v88
v_mul_f32 v89, s31, v89
v_mfma_f32_16x16x32_bf16 v[68:71], v[44:47], v[188:191], v[68:71]
v_mul_f32 v90, s31, v90
v_mul_f32 v91, s31, v91
v_mfma_f32_16x16x32_bf16 v[72:75], v[40:43], v[220:223], v[72:75]
v_mul_f32 v92, s31, v92
v_mul_f32 v93, s31, v93
v_mfma_f32_16x16x32_bf16 v[76:79], v[44:47], v[220:223], v[76:79]
v_mul_f32 v94, s31, v94
v_mul_f32 v95, s31, v95
s_waitcnt lgkmcnt(0)
v_mfma_f32_16x16x32_bf16 v[48:51], v[32:35], v[128:131], v[48:51]
ds_read_b128 v[40:43], v11 offset:32768
ds_read_b128 v[44:47], v11 offset:40960
v_mfma_f32_16x16x32_bf16 v[52:55], v[36:39], v[128:131], v[52:55]
v_cvt_pk_bf16_f32 v88, v88, v89
v_cvt_pk_bf16_f32 v90, v90, v91
v_mfma_f32_16x16x32_bf16 v[56:59], v[32:35], v[160:163], v[56:59]
v_cvt_pk_bf16_f32 v92, v92, v93
v_cvt_pk_bf16_f32 v94, v94, v95
v_mfma_f32_16x16x32_bf16 v[60:63], v[36:39], v[160:163], v[60:63]
v_accvgpr_write_b32 a100, v88
v_accvgpr_write_b32 a101, v90
v_mfma_f32_16x16x32_bf16 v[64:67], v[32:35], v[192:195], v[64:67]
v_accvgpr_write_b32 a102, v92
v_accvgpr_write_b32 a103, v94
v_mfma_f32_16x16x32_bf16 v[68:71], v[36:39], v[192:195], v[68:71]
v_mul_f32 v96, s31, v96
v_mul_f32 v97, s31, v97
v_mfma_f32_16x16x32_bf16 v[72:75], v[32:35], v[224:227], v[72:75]
v_mul_f32 v98, s31, v98
v_mul_f32 v99, s31, v99
v_mfma_f32_16x16x32_bf16 v[76:79], v[36:39], v[224:227], v[76:79]
v_mul_f32 v100, s31, v100
v_mul_f32 v101, s31, v101
s_waitcnt lgkmcnt(0)
v_mfma_f32_16x16x32_bf16 v[48:51], v[40:43], v[132:135], v[48:51]
ds_read_b128 v[32:35], v8 offset:33024
ds_read_b128 v[36:39], v8 offset:41216
v_mfma_f32_16x16x32_bf16 v[52:55], v[44:47], v[132:135], v[52:55]
v_mul_f32 v102, s31, v102
v_mul_f32 v103, s31, v103
v_mfma_f32_16x16x32_bf16 v[56:59], v[40:43], v[164:167], v[56:59]
v_cvt_pk_bf16_f32 v96, v96, v97
v_cvt_pk_bf16_f32 v98, v98, v99
v_mfma_f32_16x16x32_bf16 v[60:63], v[44:47], v[164:167], v[60:63]
v_cvt_pk_bf16_f32 v100, v100, v101
v_cvt_pk_bf16_f32 v102, v102, v103
v_mfma_f32_16x16x32_bf16 v[64:67], v[40:43], v[196:199], v[64:67]
v_accvgpr_write_b32 a156, v96
v_accvgpr_write_b32 a157, v98
v_mfma_f32_16x16x32_bf16 v[68:71], v[44:47], v[196:199], v[68:71]
v_accvgpr_write_b32 a158, v100
v_accvgpr_write_b32 a159, v102
v_mfma_f32_16x16x32_bf16 v[72:75], v[40:43], v[228:231], v[72:75]
v_mul_f32 v104, s31, v104
v_mul_f32 v105, s31, v105
v_mfma_f32_16x16x32_bf16 v[76:79], v[44:47], v[228:231], v[76:79]
v_mul_f32 v106, s31, v106
v_mul_f32 v107, s31, v107
s_waitcnt lgkmcnt(0)
v_mfma_f32_16x16x32_bf16 v[48:51], v[32:35], v[136:139], v[48:51]
ds_read_b128 v[40:43], v9 offset:33024
ds_read_b128 v[44:47], v9 offset:41216
v_mfma_f32_16x16x32_bf16 v[52:55], v[36:39], v[136:139], v[52:55]
s_waitcnt vmcnt(0)
v_cmp_ne_u32 vcc, s88, v4
s_cmp_eq_u32 s88, 0
s_cselect_b64 vcc, -1, vcc
s_cmp_eq_u64 vcc, 0
s_cselect_b32 s45, 256, 0
v_mul_f32 v108, s31, v108
v_mul_f32 v109, s31, v109
v_mfma_f32_16x16x32_bf16 v[56:59], v[32:35], v[168:171], v[56:59]
v_mul_f32 v110, s31, v110
v_mul_f32 v111, s31, v111
v_mfma_f32_16x16x32_bf16 v[60:63], v[36:39], v[168:171], v[60:63]
v_cvt_pk_bf16_f32 v104, v104, v105
v_cvt_pk_bf16_f32 v106, v106, v107
v_mfma_f32_16x16x32_bf16 v[64:67], v[32:35], v[200:203], v[64:67]
v_cvt_pk_bf16_f32 v108, v108, v109
v_cvt_pk_bf16_f32 v110, v110, v111
v_mfma_f32_16x16x32_bf16 v[68:71], v[36:39], v[200:203], v[68:71]
v_accvgpr_write_b32 a212, v104
v_accvgpr_write_b32 a213, v106
v_mfma_f32_16x16x32_bf16 v[72:75], v[32:35], v[232:235], v[72:75]
v_accvgpr_write_b32 a214, v108
v_accvgpr_write_b32 a215, v110
v_mfma_f32_16x16x32_bf16 v[76:79], v[36:39], v[232:235], v[76:79]
s_waitcnt lgkmcnt(0)
v_mfma_f32_16x16x32_bf16 v[48:51], v[40:43], v[140:143], v[48:51]
ds_read_b128 v[32:35], v10 offset:33024
ds_read_b128 v[36:39], v10 offset:41216
v_mfma_f32_16x16x32_bf16 v[52:55], v[44:47], v[140:143], v[52:55]
v_mfma_f32_16x16x32_bf16 v[56:59], v[40:43], v[172:175], v[56:59]
v_mfma_f32_16x16x32_bf16 v[60:63], v[44:47], v[172:175], v[60:63]
v_mfma_f32_16x16x32_bf16 v[64:67], v[40:43], v[204:207], v[64:67]
v_mfma_f32_16x16x32_bf16 v[68:71], v[44:47], v[204:207], v[68:71]
v_mfma_f32_16x16x32_bf16 v[72:75], v[40:43], v[236:239], v[72:75]
v_mfma_f32_16x16x32_bf16 v[76:79], v[44:47], v[236:239], v[76:79]
s_waitcnt lgkmcnt(0)
v_mfma_f32_16x16x32_bf16 v[48:51], v[32:35], v[144:147], v[48:51]
ds_read_b128 v[40:43], v11 offset:33024
ds_read_b128 v[44:47], v11 offset:41216
v_mfma_f32_16x16x32_bf16 v[52:55], v[36:39], v[144:147], v[52:55]
v_mfma_f32_16x16x32_bf16 v[56:59], v[32:35], v[176:179], v[56:59]
v_mfma_f32_16x16x32_bf16 v[60:63], v[36:39], v[176:179], v[60:63]
v_mfma_f32_16x16x32_bf16 v[64:67], v[32:35], v[208:211], v[64:67]
v_mfma_f32_16x16x32_bf16 v[68:71], v[36:39], v[208:211], v[68:71]
v_mfma_f32_16x16x32_bf16 v[72:75], v[32:35], v[240:243], v[72:75]
v_mfma_f32_16x16x32_bf16 v[76:79], v[36:39], v[240:243], v[76:79]
s_waitcnt lgkmcnt(0)
v_mfma_f32_16x16x32_bf16 v[48:51], v[40:43], v[148:151], v[48:51]
ds_read_b128 v[32:35], v8 offset:49152
ds_read_b128 v[36:39], v8 offset:57344
v_mfma_f32_16x16x32_bf16 v[52:55], v[44:47], v[148:151], v[52:55]
v_mfma_f32_16x16x32_bf16 v[56:59], v[40:43], v[180:183], v[56:59]
v_mfma_f32_16x16x32_bf16 v[60:63], v[44:47], v[180:183], v[60:63]
v_mfma_f32_16x16x32_bf16 v[64:67], v[40:43], v[212:215], v[64:67]
v_mfma_f32_16x16x32_bf16 v[68:71], v[44:47], v[212:215], v[68:71]
v_mfma_f32_16x16x32_bf16 v[72:75], v[40:43], v[244:247], v[72:75]
v_mfma_f32_16x16x32_bf16 v[76:79], v[44:47], v[244:247], v[76:79]
s_waitcnt lgkmcnt(0)
v_mfma_f32_16x16x32_bf16 v[80:83], v[32:35], v[120:123], 0
ds_read_b128 v[40:43], v9 offset:49152
ds_read_b128 v[44:47], v9 offset:57344
v_mfma_f32_16x16x32_bf16 v[84:87], v[36:39], v[120:123], 0
v_mfma_f32_16x16x32_bf16 v[88:91], v[32:35], v[152:155], 0
v_mfma_f32_16x16x32_bf16 v[92:95], v[36:39], v[152:155], 0
v_mul_f32 v48, s31, v48
v_mul_f32 v49, s31, v49
v_mfma_f32_16x16x32_bf16 v[96:99], v[32:35], v[184:187], 0
v_mul_f32 v50, s31, v50
v_mul_f32 v51, s31, v51
v_mfma_f32_16x16x32_bf16 v[100:103], v[36:39], v[184:187], 0
v_mul_f32 v52, s31, v52
v_mul_f32 v53, s31, v53
v_mfma_f32_16x16x32_bf16 v[104:107], v[32:35], v[216:219], 0
v_mul_f32 v54, s31, v54
v_mul_f32 v55, s31, v55
v_mfma_f32_16x16x32_bf16 v[108:111], v[36:39], v[216:219], 0
v_cvt_pk_bf16_f32 v48, v48, v49
v_cvt_pk_bf16_f32 v50, v50, v51
s_waitcnt lgkmcnt(0)
v_mfma_f32_16x16x32_bf16 v[80:83], v[40:43], v[124:127], v[80:83]
ds_read_b128 v[32:35], v10 offset:49152
ds_read_b128 v[36:39], v10 offset:57344
v_mfma_f32_16x16x32_bf16 v[84:87], v[44:47], v[124:127], v[84:87]
v_cvt_pk_bf16_f32 v52, v52, v53
v_cvt_pk_bf16_f32 v54, v54, v55
v_mfma_f32_16x16x32_bf16 v[88:91], v[40:43], v[156:159], v[88:91]
v_accvgpr_write_b32 a48, v48
v_accvgpr_write_b32 a49, v50
v_mfma_f32_16x16x32_bf16 v[92:95], v[44:47], v[156:159], v[92:95]
v_accvgpr_write_b32 a50, v52
v_accvgpr_write_b32 a51, v54
v_mfma_f32_16x16x32_bf16 v[96:99], v[40:43], v[188:191], v[96:99]
v_mul_f32 v56, s31, v56
v_mul_f32 v57, s31, v57
v_mfma_f32_16x16x32_bf16 v[100:103], v[44:47], v[188:191], v[100:103]
v_mul_f32 v58, s31, v58
v_mul_f32 v59, s31, v59
v_mfma_f32_16x16x32_bf16 v[104:107], v[40:43], v[220:223], v[104:107]
v_mul_f32 v60, s31, v60
v_mul_f32 v61, s31, v61
v_mfma_f32_16x16x32_bf16 v[108:111], v[44:47], v[220:223], v[108:111]
v_mul_f32 v62, s31, v62
v_mul_f32 v63, s31, v63
s_waitcnt lgkmcnt(0)
v_mfma_f32_16x16x32_bf16 v[80:83], v[32:35], v[128:131], v[80:83]
ds_read_b128 v[40:43], v11 offset:49152
ds_read_b128 v[44:47], v11 offset:57344
v_mfma_f32_16x16x32_bf16 v[84:87], v[36:39], v[128:131], v[84:87]
v_cvt_pk_bf16_f32 v56, v56, v57
v_cvt_pk_bf16_f32 v58, v58, v59
v_mfma_f32_16x16x32_bf16 v[88:91], v[32:35], v[160:163], v[88:91]
v_cvt_pk_bf16_f32 v60, v60, v61
v_cvt_pk_bf16_f32 v62, v62, v63
v_mfma_f32_16x16x32_bf16 v[92:95], v[36:39], v[160:163], v[92:95]
v_accvgpr_write_b32 a104, v56
v_accvgpr_write_b32 a105, v58
v_mfma_f32_16x16x32_bf16 v[96:99], v[32:35], v[192:195], v[96:99]
v_accvgpr_write_b32 a106, v60
v_accvgpr_write_b32 a107, v62
v_mfma_f32_16x16x32_bf16 v[100:103], v[36:39], v[192:195], v[100:103]
v_mul_f32 v64, s31, v64
v_mul_f32 v65, s31, v65
v_mfma_f32_16x16x32_bf16 v[104:107], v[32:35], v[224:227], v[104:107]
v_mul_f32 v66, s31, v66
v_mul_f32 v67, s31, v67
v_mfma_f32_16x16x32_bf16 v[108:111], v[36:39], v[224:227], v[108:111]
v_mul_f32 v68, s31, v68
v_mul_f32 v69, s31, v69
s_waitcnt lgkmcnt(0)
v_mfma_f32_16x16x32_bf16 v[80:83], v[40:43], v[132:135], v[80:83]
ds_read_b128 v[32:35], v8 offset:49408
ds_read_b128 v[36:39], v8 offset:57600
v_mfma_f32_16x16x32_bf16 v[84:87], v[44:47], v[132:135], v[84:87]
v_mul_f32 v70, s31, v70
v_mul_f32 v71, s31, v71
v_mfma_f32_16x16x32_bf16 v[88:91], v[40:43], v[164:167], v[88:91]
v_cvt_pk_bf16_f32 v64, v64, v65
v_cvt_pk_bf16_f32 v66, v66, v67
v_mfma_f32_16x16x32_bf16 v[92:95], v[44:47], v[164:167], v[92:95]
v_cvt_pk_bf16_f32 v68, v68, v69
v_cvt_pk_bf16_f32 v70, v70, v71
v_mfma_f32_16x16x32_bf16 v[96:99], v[40:43], v[196:199], v[96:99]
v_accvgpr_write_b32 a160, v64
v_accvgpr_write_b32 a161, v66
v_mfma_f32_16x16x32_bf16 v[100:103], v[44:47], v[196:199], v[100:103]
v_accvgpr_write_b32 a162, v68
v_accvgpr_write_b32 a163, v70
v_mfma_f32_16x16x32_bf16 v[104:107], v[40:43], v[228:231], v[104:107]
v_mul_f32 v72, s31, v72
v_mul_f32 v73, s31, v73
v_mfma_f32_16x16x32_bf16 v[108:111], v[44:47], v[228:231], v[108:111]
v_mul_f32 v74, s31, v74
v_mul_f32 v75, s31, v75
s_waitcnt lgkmcnt(0)
v_mfma_f32_16x16x32_bf16 v[80:83], v[32:35], v[136:139], v[80:83]
ds_read_b128 v[40:43], v9 offset:49408
ds_read_b128 v[44:47], v9 offset:57600
v_mfma_f32_16x16x32_bf16 v[84:87], v[36:39], v[136:139], v[84:87]
v_mul_f32 v76, s31, v76
v_mul_f32 v77, s31, v77
v_mfma_f32_16x16x32_bf16 v[88:91], v[32:35], v[168:171], v[88:91]
v_mul_f32 v78, s31, v78
v_mul_f32 v79, s31, v79
v_mfma_f32_16x16x32_bf16 v[92:95], v[36:39], v[168:171], v[92:95]
v_cvt_pk_bf16_f32 v72, v72, v73
v_cvt_pk_bf16_f32 v74, v74, v75
v_mfma_f32_16x16x32_bf16 v[96:99], v[32:35], v[200:203], v[96:99]
v_cvt_pk_bf16_f32 v76, v76, v77
v_cvt_pk_bf16_f32 v78, v78, v79
v_mfma_f32_16x16x32_bf16 v[100:103], v[36:39], v[200:203], v[100:103]
v_accvgpr_write_b32 a216, v72
v_accvgpr_write_b32 a217, v74
v_mfma_f32_16x16x32_bf16 v[104:107], v[32:35], v[232:235], v[104:107]
v_accvgpr_write_b32 a218, v76
v_accvgpr_write_b32 a219, v78
v_mfma_f32_16x16x32_bf16 v[108:111], v[36:39], v[232:235], v[108:111]
s_waitcnt lgkmcnt(0)
v_mfma_f32_16x16x32_bf16 v[80:83], v[40:43], v[140:143], v[80:83]
ds_read_b128 v[32:35], v10 offset:49408
ds_read_b128 v[36:39], v10 offset:57600
v_mfma_f32_16x16x32_bf16 v[84:87], v[44:47], v[140:143], v[84:87]
v_mfma_f32_16x16x32_bf16 v[88:91], v[40:43], v[172:175], v[88:91]
v_mfma_f32_16x16x32_bf16 v[92:95], v[44:47], v[172:175], v[92:95]
v_mfma_f32_16x16x32_bf16 v[96:99], v[40:43], v[204:207], v[96:99]
v_mfma_f32_16x16x32_bf16 v[100:103], v[44:47], v[204:207], v[100:103]
v_mfma_f32_16x16x32_bf16 v[104:107], v[40:43], v[236:239], v[104:107]
v_mfma_f32_16x16x32_bf16 v[108:111], v[44:47], v[236:239], v[108:111]
s_waitcnt lgkmcnt(0)
v_mfma_f32_16x16x32_bf16 v[80:83], v[32:35], v[144:147], v[80:83]
ds_read_b128 v[40:43], v11 offset:49408
ds_read_b128 v[44:47], v11 offset:57600
v_mfma_f32_16x16x32_bf16 v[84:87], v[36:39], v[144:147], v[84:87]
v_mfma_f32_16x16x32_bf16 v[88:91], v[32:35], v[176:179], v[88:91]
v_mfma_f32_16x16x32_bf16 v[92:95], v[36:39], v[176:179], v[92:95]
v_mfma_f32_16x16x32_bf16 v[96:99], v[32:35], v[208:211], v[96:99]
v_mfma_f32_16x16x32_bf16 v[100:103], v[36:39], v[208:211], v[100:103]
v_mfma_f32_16x16x32_bf16 v[104:107], v[32:35], v[240:243], v[104:107]
v_mfma_f32_16x16x32_bf16 v[108:111], v[36:39], v[240:243], v[108:111]
s_waitcnt lgkmcnt(0)
v_mfma_f32_16x16x32_bf16 v[80:83], v[40:43], v[148:151], v[80:83]
v_mfma_f32_16x16x32_bf16 v[84:87], v[44:47], v[148:151], v[84:87]
v_mfma_f32_16x16x32_bf16 v[88:91], v[40:43], v[180:183], v[88:91]
v_mfma_f32_16x16x32_bf16 v[92:95], v[44:47], v[180:183], v[92:95]
v_mfma_f32_16x16x32_bf16 v[96:99], v[40:43], v[212:215], v[96:99]
v_mfma_f32_16x16x32_bf16 v[100:103], v[44:47], v[212:215], v[100:103]
v_mfma_f32_16x16x32_bf16 v[104:107], v[40:43], v[244:247], v[104:107]
v_mfma_f32_16x16x32_bf16 v[108:111], v[44:47], v[244:247], v[108:111]
s_add_u32 s97, s97, s45
s_nop 7
v_mul_f32 v80, s31, v80
v_mul_f32 v81, s31, v81
v_mul_f32 v82, s31, v82
v_mul_f32 v83, s31, v83
v_mul_f32 v84, s31, v84
v_mul_f32 v85, s31, v85
v_mul_f32 v86, s31, v86
v_mul_f32 v87, s31, v87
v_cvt_pk_bf16_f32 v80, v80, v81
v_cvt_pk_bf16_f32 v82, v82, v83
v_cvt_pk_bf16_f32 v84, v84, v85
v_cvt_pk_bf16_f32 v86, v86, v87
v_accvgpr_write_b32 a52, v80
v_accvgpr_write_b32 a53, v82
v_accvgpr_write_b32 a54, v84
v_accvgpr_write_b32 a55, v86
v_mul_f32 v88, s31, v88
v_mul_f32 v89, s31, v89
v_mul_f32 v90, s31, v90
v_mul_f32 v91, s31, v91
v_mul_f32 v92, s31, v92
v_mul_f32 v93, s31, v93
v_mul_f32 v94, s31, v94
v_mul_f32 v95, s31, v95
v_cvt_pk_bf16_f32 v88, v88, v89
v_cvt_pk_bf16_f32 v90, v90, v91
v_cvt_pk_bf16_f32 v92, v92, v93
v_cvt_pk_bf16_f32 v94, v94, v95
v_accvgpr_write_b32 a108, v88
v_accvgpr_write_b32 a109, v90
v_accvgpr_write_b32 a110, v92
v_accvgpr_write_b32 a111, v94
v_mul_f32 v96, s31, v96
v_mul_f32 v97, s31, v97
v_mul_f32 v98, s31, v98
v_mul_f32 v99, s31, v99
v_mul_f32 v100, s31, v100
v_mul_f32 v101, s31, v101
v_mul_f32 v102, s31, v102
v_mul_f32 v103, s31, v103
v_cvt_pk_bf16_f32 v96, v96, v97
v_cvt_pk_bf16_f32 v98, v98, v99
v_cvt_pk_bf16_f32 v100, v100, v101
v_cvt_pk_bf16_f32 v102, v102, v103
v_accvgpr_write_b32 a164, v96
v_accvgpr_write_b32 a165, v98
v_accvgpr_write_b32 a166, v100
v_accvgpr_write_b32 a167, v102
v_mul_f32 v104, s31, v104
v_mul_f32 v105, s31, v105
v_mul_f32 v106, s31, v106
v_mul_f32 v107, s31, v107
v_mul_f32 v108, s31, v108
v_mul_f32 v109, s31, v109
v_mul_f32 v110, s31, v110
v_mul_f32 v111, s31, v111
v_cvt_pk_bf16_f32 v104, v104, v105
v_cvt_pk_bf16_f32 v106, v106, v107
v_cvt_pk_bf16_f32 v108, v108, v109
v_cvt_pk_bf16_f32 v110, v110, v111
v_accvgpr_write_b32 a220, v104
v_accvgpr_write_b32 a221, v106
v_accvgpr_write_b32 a222, v108
v_accvgpr_write_b32 a223, v110
s_branch PRE_DONE
PRE_FIRST:
s_mov_b32 s26, s27
s_cmp_lt_u32 s27, 16
s_cbranch_scc1 SELF
s_sub_u32 s27, s27, 16
s_lshr_b32 s33, s27, 3
s_lshl_b32 s33, s33, 5
s_and_b32 s40, s27, 7
s_add_u32 s33, s33, s40
s_lshl_b32 s33, s33, 2
s_add_u32 s33, s33, 4352
s_lshl_b32 s26, s27, 2
s_add_u32 s26, s26, s20
PRE_LN:
s_load_dwordx2 s[8:9], s[0:1], 0
s_mov_b32 s10, 1835008
s_mov_b32 s11, 0x00020000
s_mul_i32 s28, s26, 14336
v_and_b32 v5, 15, v0
v_mul_u32_u24 v5, 896, v5
v_lshrrev_b32 v3, 4, v0
v_lshl_add_u32 v5, v3, 4, v5
s_waitcnt lgkmcnt(0)
buffer_load_dwordx4 v[16:19], v5, s[8:11], s28 offen
buffer_load_dwordx4 v[20:23], v5, s[8:11], s28 offen offset:64
buffer_load_dwordx4 v[24:27], v5, s[8:11], s28 offen offset:128
buffer_load_dwordx4 v[28:31], v5, s[8:11], s28 offen offset:192
buffer_load_dwordx4 v[32:35], v5, s[8:11], s28 offen offset:256
buffer_load_dwordx4 v[36:39], v5, s[8:11], s28 offen offset:320
buffer_load_dwordx4 v[40:43], v5, s[8:11], s28 offen offset:384
buffer_load_dwordx4 v[44:47], v5, s[8:11], s28 offen offset:448
buffer_load_dwordx4 v[48:51], v5, s[8:11], s28 offen offset:512
buffer_load_dwordx4 v[52:55], v5, s[8:11], s28 offen offset:576
buffer_load_dwordx4 v[56:59], v5, s[8:11], s28 offen offset:640
buffer_load_dwordx4 v[60:63], v5, s[8:11], s28 offen offset:704
buffer_load_dwordx4 v[64:67], v5, s[8:11], s28 offen offset:768
buffer_load_dwordx4 v[68:71], v5, s[8:11], s28 offen offset:832
v_mov_b32 v8, 0
v_mov_b32 v9, 0
s_waitcnt vmcnt(13)
v_lshlrev_b32 v80, 16, v16
v_and_b32 v81, 0xffff0000, v16
v_add_f32 v8, v8, v80
v_add_f32 v9, v9, v81
v_lshlrev_b32 v82, 16, v17
v_and_b32 v83, 0xffff0000, v17
v_add_f32 v8, v8, v82
v_add_f32 v9, v9, v83
v_lshlrev_b32 v84, 16, v18
v_and_b32 v85, 0xffff0000, v18
v_add_f32 v8, v8, v84
v_add_f32 v9, v9, v85
v_lshlrev_b32 v86, 16, v19
v_and_b32 v87, 0xffff0000, v19
v_add_f32 v8, v8, v86
v_add_f32 v9, v9, v87
s_waitcnt vmcnt(12)
v_lshlrev_b32 v88, 16, v20
v_and_b32 v89, 0xffff0000, v20
v_add_f32 v8, v8, v88
v_add_f32 v9, v9, v89
v_lshlrev_b32 v90, 16, v21
v_and_b32 v91, 0xffff0000, v21
v_add_f32 v8, v8, v90
v_add_f32 v9, v9, v91
v_lshlrev_b32 v92, 16, v22
v_and_b32 v93, 0xffff0000, v22
v_add_f32 v8, v8, v92
v_add_f32 v9, v9, v93
v_lshlrev_b32 v94, 16, v23
v_and_b32 v95, 0xffff0000, v23
v_add_f32 v8, v8, v94
v_add_f32 v9, v9, v95
s_waitcnt vmcnt(11)
v_lshlrev_b32 v96, 16, v24
v_and_b32 v97, 0xffff0000, v24
v_add_f32 v8, v8, v96
v_add_f32 v9, v9, v97
v_lshlrev_b32 v98, 16, v25
v_and_b32 v99, 0xffff0000, v25
v_add_f32 v8, v8, v98
v_add_f32 v9, v9, v99
v_lshlrev_b32 v100, 16, v26
v_and_b32 v101, 0xffff0000, v26
v_add_f32 v8, v8, v100
v_add_f32 v9, v9, v101
v_lshlrev_b32 v102, 16, v27
v_and_b32 v103, 0xffff0000, v27
v_add_f32 v8, v8, v102
v_add_f32 v9, v9, v103
s_waitcnt vmcnt(10)
v_lshlrev_b32 v104, 16, v28
v_and_b32 v105, 0xffff0000, v28
v_add_f32 v8, v8, v104
v_add_f32 v9, v9, v105
v_lshlrev_b32 v106, 16, v29
v_and_b32 v107, 0xffff0000, v29
v_add_f32 v8, v8, v106
v_add_f32 v9, v9, v107
v_lshlrev_b32 v108, 16, v30
v_and_b32 v109, 0xffff0000, v30
v_add_f32 v8, v8, v108
v_add_f32 v9, v9, v109
v_lshlrev_b32 v110, 16, v31
v_and_b32 v111, 0xffff0000, v31
v_add_f32 v8, v8, v110
v_add_f32 v9, v9, v111
s_waitcnt vmcnt(9)
v_lshlrev_b32 v112, 16, v32
v_and_b32 v113, 0xffff0000, v32
v_add_f32 v8, v8, v112
v_add_f32 v9, v9, v113
v_lshlrev_b32 v114, 16, v33
v_and_b32 v115, 0xffff0000, v33
v_add_f32 v8, v8, v114
v_add_f32 v9, v9, v115
v_lshlrev_b32 v116, 16, v34
v_and_b32 v117, 0xffff0000, v34
v_add_f32 v8, v8, v116
v_add_f32 v9, v9, v117
v_lshlrev_b32 v118, 16, v35
v_and_b32 v119, 0xffff0000, v35
v_add_f32 v8, v8, v118
v_add_f32 v9, v9, v119
s_waitcnt vmcnt(8)
v_lshlrev_b32 v120, 16, v36
v_and_b32 v121, 0xffff0000, v36
v_add_f32 v8, v8, v120
v_add_f32 v9, v9, v121
v_lshlrev_b32 v122, 16, v37
v_and_b32 v123, 0xffff0000, v37
v_add_f32 v8, v8, v122
v_add_f32 v9, v9, v123
v_lshlrev_b32 v124, 16, v38
v_and_b32 v125, 0xffff0000, v38
v_add_f32 v8, v8, v124
v_add_f32 v9, v9, v125
v_lshlrev_b32 v126, 16, v39
v_and_b32 v127, 0xffff0000, v39
v_add_f32 v8, v8, v126
v_add_f32 v9, v9, v127
s_waitcnt vmcnt(7)
v_lshlrev_b32 v128, 16, v40
v_and_b32 v129, 0xffff0000, v40
v_add_f32 v8, v8, v128
v_add_f32 v9, v9, v129
v_lshlrev_b32 v130, 16, v41
v_and_b32 v131, 0xffff0000, v41
v_add_f32 v8, v8, v130
v_add_f32 v9, v9, v131
v_lshlrev_b32 v132, 16, v42
v_and_b32 v133, 0xffff0000, v42
v_add_f32 v8, v8, v132
v_add_f32 v9, v9, v133
v_lshlrev_b32 v134, 16, v43
v_and_b32 v135, 0xffff0000, v43
v_add_f32 v8, v8, v134
v_add_f32 v9, v9, v135
s_waitcnt vmcnt(6)
v_lshlrev_b32 v136, 16, v44
v_and_b32 v137, 0xffff0000, v44
v_add_f32 v8, v8, v136
v_add_f32 v9, v9, v137
v_lshlrev_b32 v138, 16, v45
v_and_b32 v139, 0xffff0000, v45
v_add_f32 v8, v8, v138
v_add_f32 v9, v9, v139
v_lshlrev_b32 v140, 16, v46
v_and_b32 v141, 0xffff0000, v46
v_add_f32 v8, v8, v140
v_add_f32 v9, v9, v141
v_lshlrev_b32 v142, 16, v47
v_and_b32 v143, 0xffff0000, v47
v_add_f32 v8, v8, v142
v_add_f32 v9, v9, v143
s_waitcnt vmcnt(5)
v_lshlrev_b32 v144, 16, v48
v_and_b32 v145, 0xffff0000, v48
v_add_f32 v8, v8, v144
v_add_f32 v9, v9, v145
v_lshlrev_b32 v146, 16, v49
v_and_b32 v147, 0xffff0000, v49
v_add_f32 v8, v8, v146
v_add_f32 v9, v9, v147
v_lshlrev_b32 v148, 16, v50
v_and_b32 v149, 0xffff0000, v50
v_add_f32 v8, v8, v148
v_add_f32 v9, v9, v149
v_lshlrev_b32 v150, 16, v51
v_and_b32 v151, 0xffff0000, v51
v_add_f32 v8, v8, v150
v_add_f32 v9, v9, v151
s_waitcnt vmcnt(4)
v_lshlrev_b32 v152, 16, v52
v_and_b32 v153, 0xffff0000, v52
v_add_f32 v8, v8, v152
v_add_f32 v9, v9, v153
v_lshlrev_b32 v154, 16, v53
v_and_b32 v155, 0xffff0000, v53
v_add_f32 v8, v8, v154
v_add_f32 v9, v9, v155
v_lshlrev_b32 v156, 16, v54
v_and_b32 v157, 0xffff0000, v54
v_add_f32 v8, v8, v156
v_add_f32 v9, v9, v157
v_lshlrev_b32 v158, 16, v55
v_and_b32 v159, 0xffff0000, v55
v_add_f32 v8, v8, v158
v_add_f32 v9, v9, v159
s_waitcnt vmcnt(3)
v_lshlrev_b32 v160, 16, v56
v_and_b32 v161, 0xffff0000, v56
v_add_f32 v8, v8, v160
v_add_f32 v9, v9, v161
v_lshlrev_b32 v162, 16, v57
v_and_b32 v163, 0xffff0000, v57
v_add_f32 v8, v8, v162
v_add_f32 v9, v9, v163
v_lshlrev_b32 v164, 16, v58
v_and_b32 v165, 0xffff0000, v58
v_add_f32 v8, v8, v164
v_add_f32 v9, v9, v165
v_lshlrev_b32 v166, 16, v59
v_and_b32 v167, 0xffff0000, v59
v_add_f32 v8, v8, v166
v_add_f32 v9, v9, v167
s_waitcnt vmcnt(2)
v_lshlrev_b32 v168, 16, v60
v_and_b32 v169, 0xffff0000, v60
v_add_f32 v8, v8, v168
v_add_f32 v9, v9, v169
v_lshlrev_b32 v170, 16, v61
v_and_b32 v171, 0xffff0000, v61
v_add_f32 v8, v8, v170
v_add_f32 v9, v9, v171
v_lshlrev_b32 v172, 16, v62
v_and_b32 v173, 0xffff0000, v62
v_add_f32 v8, v8, v172
v_add_f32 v9, v9, v173
v_lshlrev_b32 v174, 16, v63
v_and_b32 v175, 0xffff0000, v63
v_add_f32 v8, v8, v174
v_add_f32 v9, v9, v175
s_waitcnt vmcnt(1)
v_lshlrev_b32 v176, 16, v64
v_and_b32 v177, 0xffff0000, v64
v_add_f32 v8, v8, v176
v_add_f32 v9, v9, v177
v_lshlrev_b32 v178, 16, v65
v_and_b32 v179, 0xffff0000, v65
v_add_f32 v8, v8, v178
v_add_f32 v9, v9, v179
v_lshlrev_b32 v180, 16, v66
v_and_b32 v181, 0xffff0000, v66
v_add_f32 v8, v8, v180
v_add_f32 v9, v9, v181
v_lshlrev_b32 v182, 16, v67
v_and_b32 v183, 0xffff0000, v67
v_add_f32 v8, v8, v182
v_add_f32 v9, v9, v183
s_waitcnt vmcnt(0)
v_lshlrev_b32 v184, 16, v68
v_and_b32 v185, 0xffff0000, v68
v_add_f32 v8, v8, v184
v_add_f32 v9, v9, v185
v_lshlrev_b32 v186, 16, v69
v_and_b32 v187, 0xffff0000, v69
v_add_f32 v8, v8, v186
v_add_f32 v9, v9, v187
v_lshlrev_b32 v188, 16, v70
v_and_b32 v189, 0xffff0000, v70
v_add_f32 v8, v8, v188
v_add_f32 v9, v9, v189
v_lshlrev_b32 v190, 16, v71
v_and_b32 v191, 0xffff0000, v71
v_add_f32 v8, v8, v190
v_add_f32 v9, v9, v191
v_add_f32 v8, v8, v9
v_mov_b32 v10, v8
s_nop 1
v_permlane32_swap_b32 v10, v8
v_add_f32 v8, v8, v10
v_mov_b32 v10, v8
s_nop 1
v_permlane16_swap_b32 v10, v8
v_add_f32 v8, v8, v10
v_mul_f32 v8, 0x3b124925, v8
v_mov_b32 v9, 0
v_mov_b32 v2, 0
v_sub_f32 v10, v80, v8
v_sub_f32 v11, v81, v8
v_fmac_f32 v9, v10, v10
v_fmac_f32 v2, v11, v11
v_sub_f32 v10, v82, v8
v_sub_f32 v11, v83, v8
v_fmac_f32 v9, v10, v10
v_fmac_f32 v2, v11, v11
v_sub_f32 v10, v84, v8
v_sub_f32 v11, v85, v8
v_fmac_f32 v9, v10, v10
v_fmac_f32 v2, v11, v11
v_sub_f32 v10, v86, v8
v_sub_f32 v11, v87, v8
v_fmac_f32 v9, v10, v10
v_fmac_f32 v2, v11, v11
v_sub_f32 v10, v88, v8
v_sub_f32 v11, v89, v8
v_fmac_f32 v9, v10, v10
v_fmac_f32 v2, v11, v11
v_sub_f32 v10, v90, v8
v_sub_f32 v11, v91, v8
v_fmac_f32 v9, v10, v10
v_fmac_f32 v2, v11, v11
v_sub_f32 v10, v92, v8
v_sub_f32 v11, v93, v8
v_fmac_f32 v9, v10, v10
v_fmac_f32 v2, v11, v11
v_sub_f32 v10, v94, v8
v_sub_f32 v11, v95, v8
v_fmac_f32 v9, v10, v10
v_fmac_f32 v2, v11, v11
v_sub_f32 v10, v96, v8
v_sub_f32 v11, v97, v8
v_fmac_f32 v9, v10, v10
v_fmac_f32 v2, v11, v11
v_sub_f32 v10, v98, v8
v_sub_f32 v11, v99, v8
v_fmac_f32 v9, v10, v10
v_fmac_f32 v2, v11, v11
v_sub_f32 v10, v100, v8
v_sub_f32 v11, v101, v8
v_fmac_f32 v9, v10, v10
v_fmac_f32 v2, v11, v11
v_sub_f32 v10, v102, v8
v_sub_f32 v11, v103, v8
v_fmac_f32 v9, v10, v10
v_fmac_f32 v2, v11, v11
v_sub_f32 v10, v104, v8
v_sub_f32 v11, v105, v8
v_fmac_f32 v9, v10, v10
v_fmac_f32 v2, v11, v11
v_sub_f32 v10, v106, v8
v_sub_f32 v11, v107, v8
v_fmac_f32 v9, v10, v10
v_fmac_f32 v2, v11, v11
v_sub_f32 v10, v108, v8
v_sub_f32 v11, v109, v8
v_fmac_f32 v9, v10, v10
v_fmac_f32 v2, v11, v11
v_sub_f32 v10, v110, v8
v_sub_f32 v11, v111, v8
v_fmac_f32 v9, v10, v10
v_fmac_f32 v2, v11, v11
v_sub_f32 v10, v112, v8
v_sub_f32 v11, v113, v8
v_fmac_f32 v9, v10, v10
v_fmac_f32 v2, v11, v11
v_sub_f32 v10, v114, v8
v_sub_f32 v11, v115, v8
v_fmac_f32 v9, v10, v10
v_fmac_f32 v2, v11, v11
v_sub_f32 v10, v116, v8
v_sub_f32 v11, v117, v8
v_fmac_f32 v9, v10, v10
v_fmac_f32 v2, v11, v11
v_sub_f32 v10, v118, v8
v_sub_f32 v11, v119, v8
v_fmac_f32 v9, v10, v10
v_fmac_f32 v2, v11, v11
v_sub_f32 v10, v120, v8
v_sub_f32 v11, v121, v8
v_fmac_f32 v9, v10, v10
v_fmac_f32 v2, v11, v11
v_sub_f32 v10, v122, v8
v_sub_f32 v11, v123, v8
v_fmac_f32 v9, v10, v10
v_fmac_f32 v2, v11, v11
v_sub_f32 v10, v124, v8
v_sub_f32 v11, v125, v8
v_fmac_f32 v9, v10, v10
v_fmac_f32 v2, v11, v11
v_sub_f32 v10, v126, v8
v_sub_f32 v11, v127, v8
v_fmac_f32 v9, v10, v10
v_fmac_f32 v2, v11, v11
v_sub_f32 v10, v128, v8
v_sub_f32 v11, v129, v8
v_fmac_f32 v9, v10, v10
v_fmac_f32 v2, v11, v11
v_sub_f32 v10, v130, v8
v_sub_f32 v11, v131, v8
v_fmac_f32 v9, v10, v10
v_fmac_f32 v2, v11, v11
v_sub_f32 v10, v132, v8
v_sub_f32 v11, v133, v8
v_fmac_f32 v9, v10, v10
v_fmac_f32 v2, v11, v11
v_sub_f32 v10, v134, v8
v_sub_f32 v11, v135, v8
v_fmac_f32 v9, v10, v10
v_fmac_f32 v2, v11, v11
v_sub_f32 v10, v136, v8
v_sub_f32 v11, v137, v8
v_fmac_f32 v9, v10, v10
v_fmac_f32 v2, v11, v11
v_sub_f32 v10, v138, v8
v_sub_f32 v11, v139, v8
v_fmac_f32 v9, v10, v10
v_fmac_f32 v2, v11, v11
v_sub_f32 v10, v140, v8
v_sub_f32 v11, v141, v8
v_fmac_f32 v9, v10, v10
v_fmac_f32 v2, v11, v11
v_sub_f32 v10, v142, v8
v_sub_f32 v11, v143, v8
v_fmac_f32 v9, v10, v10
v_fmac_f32 v2, v11, v11
v_sub_f32 v10, v144, v8
v_sub_f32 v11, v145, v8
v_fmac_f32 v9, v10, v10
v_fmac_f32 v2, v11, v11
v_sub_f32 v10, v146, v8
v_sub_f32 v11, v147, v8
v_fmac_f32 v9, v10, v10
v_fmac_f32 v2, v11, v11
v_sub_f32 v10, v148, v8
v_sub_f32 v11, v149, v8
v_fmac_f32 v9, v10, v10
v_fmac_f32 v2, v11, v11
v_sub_f32 v10, v150, v8
v_sub_f32 v11, v151, v8
v_fmac_f32 v9, v10, v10
v_fmac_f32 v2, v11, v11
v_sub_f32 v10, v152, v8
v_sub_f32 v11, v153, v8
v_fmac_f32 v9, v10, v10
v_fmac_f32 v2, v11, v11
v_sub_f32 v10, v154, v8
v_sub_f32 v11, v155, v8
v_fmac_f32 v9, v10, v10
v_fmac_f32 v2, v11, v11
v_sub_f32 v10, v156, v8
v_sub_f32 v11, v157, v8
v_fmac_f32 v9, v10, v10
v_fmac_f32 v2, v11, v11
v_sub_f32 v10, v158, v8
v_sub_f32 v11, v159, v8
v_fmac_f32 v9, v10, v10
v_fmac_f32 v2, v11, v11
v_sub_f32 v10, v160, v8
v_sub_f32 v11, v161, v8
v_fmac_f32 v9, v10, v10
v_fmac_f32 v2, v11, v11
v_sub_f32 v10, v162, v8
v_sub_f32 v11, v163, v8
v_fmac_f32 v9, v10, v10
v_fmac_f32 v2, v11, v11
v_sub_f32 v10, v164, v8
v_sub_f32 v11, v165, v8
v_fmac_f32 v9, v10, v10
v_fmac_f32 v2, v11, v11
v_sub_f32 v10, v166, v8
v_sub_f32 v11, v167, v8
v_fmac_f32 v9, v10, v10
v_fmac_f32 v2, v11, v11
v_sub_f32 v10, v168, v8
v_sub_f32 v11, v169, v8
v_fmac_f32 v9, v10, v10
v_fmac_f32 v2, v11, v11
v_sub_f32 v10, v170, v8
v_sub_f32 v11, v171, v8
v_fmac_f32 v9, v10, v10
v_fmac_f32 v2, v11, v11
v_sub_f32 v10, v172, v8
v_sub_f32 v11, v173, v8
v_fmac_f32 v9, v10, v10
v_fmac_f32 v2, v11, v11
v_sub_f32 v10, v174, v8
v_sub_f32 v11, v175, v8
v_fmac_f32 v9, v10, v10
v_fmac_f32 v2, v11, v11
v_sub_f32 v10, v176, v8
v_sub_f32 v11, v177, v8
v_fmac_f32 v9, v10, v10
v_fmac_f32 v2, v11, v11
v_sub_f32 v10, v178, v8
v_sub_f32 v11, v179, v8
v_fmac_f32 v9, v10, v10
v_fmac_f32 v2, v11, v11
v_sub_f32 v10, v180, v8
v_sub_f32 v11, v181, v8
v_fmac_f32 v9, v10, v10
v_fmac_f32 v2, v11, v11
v_sub_f32 v10, v182, v8
v_sub_f32 v11, v183, v8
v_fmac_f32 v9, v10, v10
v_fmac_f32 v2, v11, v11
v_sub_f32 v10, v184, v8
v_sub_f32 v11, v185, v8
v_fmac_f32 v9, v10, v10
v_fmac_f32 v2, v11, v11
v_sub_f32 v10, v186, v8
v_sub_f32 v11, v187, v8
v_fmac_f32 v9, v10, v10
v_fmac_f32 v2, v11, v11
v_sub_f32 v10, v188, v8
v_sub_f32 v11, v189, v8
v_fmac_f32 v9, v10, v10
v_fmac_f32 v2, v11, v11
v_sub_f32 v10, v190, v8
v_sub_f32 v11, v191, v8
v_fmac_f32 v9, v10, v10
v_fmac_f32 v2, v11, v11
v_add_f32 v9, v9, v2
v_mov_b32 v10, v9
s_nop 1
v_permlane32_swap_b32 v10, v9
v_add_f32 v9, v9, v10
v_mov_b32 v10, v9
s_nop 1
v_permlane16_swap_b32 v10, v9
v_add_f32 v9, v9, v10
v_mul_f32 v9, 0x3b124925, v9
v_cvt_pk_bf16_f32 v8, v8, v8
v_and_b32 v8, 0xffff0000, v8
v_cvt_pk_bf16_f32 v9, v9, v9
v_and_b32 v9, 0xffff0000, v9
v_add_f32 v9, 0x3727c5ac, v9
v_cvt_pk_bf16_f32 v9, v9, v9
v_and_b32 v9, 0xffff0000, v9
v_sqrt_f32 v9, v9
s_nop 0
v_cvt_pk_bf16_f32 v9, v9, v9
v_and_b32 v9, 0xffff0000, v9
v_rcp_f32 v9, v9
s_nop 0
s_add_u32 s29, s28, 6205440
s_add_u32 s30, s28, 8044544
v_sub_f32 v80, v80, v8
v_sub_f32 v81, v81, v8
v_cvt_pk_bf16_f32 v81, v80, v81
v_lshlrev_b32 v80, 16, v81
v_and_b32 v81, 0xffff0000, v81
v_mul_f32 v80, v80, v9
v_mul_f32 v81, v81, v9
v_cvt_pk_bf16_f32 v16, v80, v81
v_sub_f32 v82, v82, v8
v_sub_f32 v83, v83, v8
v_cvt_pk_bf16_f32 v83, v82, v83
v_lshlrev_b32 v82, 16, v83
v_and_b32 v83, 0xffff0000, v83
v_mul_f32 v82, v82, v9
v_mul_f32 v83, v83, v9
v_cvt_pk_bf16_f32 v17, v82, v83
v_sub_f32 v84, v84, v8
v_sub_f32 v85, v85, v8
v_cvt_pk_bf16_f32 v85, v84, v85
v_lshlrev_b32 v84, 16, v85
v_and_b32 v85, 0xffff0000, v85
v_mul_f32 v84, v84, v9
v_mul_f32 v85, v85, v9
v_cvt_pk_bf16_f32 v18, v84, v85
v_sub_f32 v86, v86, v8
v_sub_f32 v87, v87, v8
v_cvt_pk_bf16_f32 v87, v86, v87
v_lshlrev_b32 v86, 16, v87
v_and_b32 v87, 0xffff0000, v87
v_mul_f32 v86, v86, v9
v_mul_f32 v87, v87, v9
v_cvt_pk_bf16_f32 v19, v86, v87
buffer_store_dwordx4 v[16:19], v1, s[4:7], s29 offen sc1
v_mov_b32 v80, v16
v_mov_b32 v81, v18
v_mov_b32 v82, v17
v_mov_b32 v83, v19
s_nop 0
v_permlane16_swap_b32 v80, v81
v_permlane16_swap_b32 v82, v83
buffer_store_dwordx4 v[80:83], v1, s[4:7], s30 offen sc1
v_sub_f32 v88, v88, v8
v_sub_f32 v89, v89, v8
v_cvt_pk_bf16_f32 v89, v88, v89
v_lshlrev_b32 v88, 16, v89
v_and_b32 v89, 0xffff0000, v89
v_mul_f32 v88, v88, v9
v_mul_f32 v89, v89, v9
v_cvt_pk_bf16_f32 v20, v88, v89
v_sub_f32 v90, v90, v8
v_sub_f32 v91, v91, v8
v_cvt_pk_bf16_f32 v91, v90, v91
v_lshlrev_b32 v90, 16, v91
v_and_b32 v91, 0xffff0000, v91
v_mul_f32 v90, v90, v9
v_mul_f32 v91, v91, v9
v_cvt_pk_bf16_f32 v21, v90, v91
v_sub_f32 v92, v92, v8
v_sub_f32 v93, v93, v8
v_cvt_pk_bf16_f32 v93, v92, v93
v_lshlrev_b32 v92, 16, v93
v_and_b32 v93, 0xffff0000, v93
v_mul_f32 v92, v92, v9
v_mul_f32 v93, v93, v9
v_cvt_pk_bf16_f32 v22, v92, v93
v_sub_f32 v94, v94, v8
v_sub_f32 v95, v95, v8
v_cvt_pk_bf16_f32 v95, v94, v95
v_lshlrev_b32 v94, 16, v95
v_and_b32 v95, 0xffff0000, v95
v_mul_f32 v94, v94, v9
v_mul_f32 v95, v95, v9
v_cvt_pk_bf16_f32 v23, v94, v95
buffer_store_dwordx4 v[20:23], v1, s[4:7], s29 offen offset:1024 sc1
v_mov_b32 v88, v20
v_mov_b32 v89, v22
v_mov_b32 v90, v21
v_mov_b32 v91, v23
s_nop 0
v_permlane16_swap_b32 v88, v89
v_permlane16_swap_b32 v90, v91
buffer_store_dwordx4 v[88:91], v1, s[4:7], s30 offen offset:1024 sc1
v_sub_f32 v96, v96, v8
v_sub_f32 v97, v97, v8
v_cvt_pk_bf16_f32 v97, v96, v97
v_lshlrev_b32 v96, 16, v97
v_and_b32 v97, 0xffff0000, v97
v_mul_f32 v96, v96, v9
v_mul_f32 v97, v97, v9
v_cvt_pk_bf16_f32 v24, v96, v97
v_sub_f32 v98, v98, v8
v_sub_f32 v99, v99, v8
v_cvt_pk_bf16_f32 v99, v98, v99
v_lshlrev_b32 v98, 16, v99
v_and_b32 v99, 0xffff0000, v99
v_mul_f32 v98, v98, v9
v_mul_f32 v99, v99, v9
v_cvt_pk_bf16_f32 v25, v98, v99
v_sub_f32 v100, v100, v8
v_sub_f32 v101, v101, v8
v_cvt_pk_bf16_f32 v101, v100, v101
v_lshlrev_b32 v100, 16, v101
v_and_b32 v101, 0xffff0000, v101
v_mul_f32 v100, v100, v9
v_mul_f32 v101, v101, v9
v_cvt_pk_bf16_f32 v26, v100, v101
v_sub_f32 v102, v102, v8
v_sub_f32 v103, v103, v8
v_cvt_pk_bf16_f32 v103, v102, v103
v_lshlrev_b32 v102, 16, v103
v_and_b32 v103, 0xffff0000, v103
v_mul_f32 v102, v102, v9
v_mul_f32 v103, v103, v9
v_cvt_pk_bf16_f32 v27, v102, v103
buffer_store_dwordx4 v[24:27], v1, s[4:7], s29 offen offset:2048 sc1
v_mov_b32 v96, v24
v_mov_b32 v97, v26
v_mov_b32 v98, v25
v_mov_b32 v99, v27
s_nop 0
v_permlane16_swap_b32 v96, v97
v_permlane16_swap_b32 v98, v99
buffer_store_dwordx4 v[96:99], v1, s[4:7], s30 offen offset:2048 sc1
v_sub_f32 v104, v104, v8
v_sub_f32 v105, v105, v8
v_cvt_pk_bf16_f32 v105, v104, v105
v_lshlrev_b32 v104, 16, v105
v_and_b32 v105, 0xffff0000, v105
v_mul_f32 v104, v104, v9
v_mul_f32 v105, v105, v9
v_cvt_pk_bf16_f32 v28, v104, v105
v_sub_f32 v106, v106, v8
v_sub_f32 v107, v107, v8
v_cvt_pk_bf16_f32 v107, v106, v107
v_lshlrev_b32 v106, 16, v107
v_and_b32 v107, 0xffff0000, v107
v_mul_f32 v106, v106, v9
v_mul_f32 v107, v107, v9
v_cvt_pk_bf16_f32 v29, v106, v107
v_sub_f32 v108, v108, v8
v_sub_f32 v109, v109, v8
v_cvt_pk_bf16_f32 v109, v108, v109
v_lshlrev_b32 v108, 16, v109
v_and_b32 v109, 0xffff0000, v109
v_mul_f32 v108, v108, v9
v_mul_f32 v109, v109, v9
v_cvt_pk_bf16_f32 v30, v108, v109
v_sub_f32 v110, v110, v8
v_sub_f32 v111, v111, v8
v_cvt_pk_bf16_f32 v111, v110, v111
v_lshlrev_b32 v110, 16, v111
v_and_b32 v111, 0xffff0000, v111
v_mul_f32 v110, v110, v9
v_mul_f32 v111, v111, v9
v_cvt_pk_bf16_f32 v31, v110, v111
buffer_store_dwordx4 v[28:31], v1, s[4:7], s29 offen offset:3072 sc1
v_mov_b32 v104, v28
v_mov_b32 v105, v30
v_mov_b32 v106, v29
v_mov_b32 v107, v31
s_nop 0
v_permlane16_swap_b32 v104, v105
v_permlane16_swap_b32 v106, v107
buffer_store_dwordx4 v[104:107], v1, s[4:7], s30 offen offset:3072 sc1
v_sub_f32 v112, v112, v8
v_sub_f32 v113, v113, v8
v_cvt_pk_bf16_f32 v113, v112, v113
v_lshlrev_b32 v112, 16, v113
v_and_b32 v113, 0xffff0000, v113
v_mul_f32 v112, v112, v9
v_mul_f32 v113, v113, v9
v_cvt_pk_bf16_f32 v32, v112, v113
v_sub_f32 v114, v114, v8
v_sub_f32 v115, v115, v8
v_cvt_pk_bf16_f32 v115, v114, v115
v_lshlrev_b32 v114, 16, v115
v_and_b32 v115, 0xffff0000, v115
v_mul_f32 v114, v114, v9
v_mul_f32 v115, v115, v9
v_cvt_pk_bf16_f32 v33, v114, v115
v_sub_f32 v116, v116, v8
v_sub_f32 v117, v117, v8
v_cvt_pk_bf16_f32 v117, v116, v117
v_lshlrev_b32 v116, 16, v117
v_and_b32 v117, 0xffff0000, v117
v_mul_f32 v116, v116, v9
v_mul_f32 v117, v117, v9
v_cvt_pk_bf16_f32 v34, v116, v117
v_sub_f32 v118, v118, v8
v_sub_f32 v119, v119, v8
v_cvt_pk_bf16_f32 v119, v118, v119
v_lshlrev_b32 v118, 16, v119
v_and_b32 v119, 0xffff0000, v119
v_mul_f32 v118, v118, v9
v_mul_f32 v119, v119, v9
v_cvt_pk_bf16_f32 v35, v118, v119
s_add_u32 s29, s29, 4096
s_add_u32 s30, s30, 4096
buffer_store_dwordx4 v[32:35], v1, s[4:7], s29 offen sc1
v_mov_b32 v112, v32
v_mov_b32 v113, v34
v_mov_b32 v114, v33
v_mov_b32 v115, v35
s_nop 0
v_permlane16_swap_b32 v112, v113
v_permlane16_swap_b32 v114, v115
buffer_store_dwordx4 v[112:115], v1, s[4:7], s30 offen sc1
v_sub_f32 v120, v120, v8
v_sub_f32 v121, v121, v8
v_cvt_pk_bf16_f32 v121, v120, v121
v_lshlrev_b32 v120, 16, v121
v_and_b32 v121, 0xffff0000, v121
v_mul_f32 v120, v120, v9
v_mul_f32 v121, v121, v9
v_cvt_pk_bf16_f32 v36, v120, v121
v_sub_f32 v122, v122, v8
v_sub_f32 v123, v123, v8
v_cvt_pk_bf16_f32 v123, v122, v123
v_lshlrev_b32 v122, 16, v123
v_and_b32 v123, 0xffff0000, v123
v_mul_f32 v122, v122, v9
v_mul_f32 v123, v123, v9
v_cvt_pk_bf16_f32 v37, v122, v123
v_sub_f32 v124, v124, v8
v_sub_f32 v125, v125, v8
v_cvt_pk_bf16_f32 v125, v124, v125
v_lshlrev_b32 v124, 16, v125
v_and_b32 v125, 0xffff0000, v125
v_mul_f32 v124, v124, v9
v_mul_f32 v125, v125, v9
v_cvt_pk_bf16_f32 v38, v124, v125
v_sub_f32 v126, v126, v8
v_sub_f32 v127, v127, v8
v_cvt_pk_bf16_f32 v127, v126, v127
v_lshlrev_b32 v126, 16, v127
v_and_b32 v127, 0xffff0000, v127
v_mul_f32 v126, v126, v9
v_mul_f32 v127, v127, v9
v_cvt_pk_bf16_f32 v39, v126, v127
buffer_store_dwordx4 v[36:39], v1, s[4:7], s29 offen offset:1024 sc1
v_mov_b32 v120, v36
v_mov_b32 v121, v38
v_mov_b32 v122, v37
v_mov_b32 v123, v39
s_nop 0
v_permlane16_swap_b32 v120, v121
v_permlane16_swap_b32 v122, v123
buffer_store_dwordx4 v[120:123], v1, s[4:7], s30 offen offset:1024 sc1
v_sub_f32 v128, v128, v8
v_sub_f32 v129, v129, v8
v_cvt_pk_bf16_f32 v129, v128, v129
v_lshlrev_b32 v128, 16, v129
v_and_b32 v129, 0xffff0000, v129
v_mul_f32 v128, v128, v9
v_mul_f32 v129, v129, v9
v_cvt_pk_bf16_f32 v40, v128, v129
v_sub_f32 v130, v130, v8
v_sub_f32 v131, v131, v8
v_cvt_pk_bf16_f32 v131, v130, v131
v_lshlrev_b32 v130, 16, v131
v_and_b32 v131, 0xffff0000, v131
v_mul_f32 v130, v130, v9
v_mul_f32 v131, v131, v9
v_cvt_pk_bf16_f32 v41, v130, v131
v_sub_f32 v132, v132, v8
v_sub_f32 v133, v133, v8
v_cvt_pk_bf16_f32 v133, v132, v133
v_lshlrev_b32 v132, 16, v133
v_and_b32 v133, 0xffff0000, v133
v_mul_f32 v132, v132, v9
v_mul_f32 v133, v133, v9
v_cvt_pk_bf16_f32 v42, v132, v133
v_sub_f32 v134, v134, v8
v_sub_f32 v135, v135, v8
v_cvt_pk_bf16_f32 v135, v134, v135
v_lshlrev_b32 v134, 16, v135
v_and_b32 v135, 0xffff0000, v135
v_mul_f32 v134, v134, v9
v_mul_f32 v135, v135, v9
v_cvt_pk_bf16_f32 v43, v134, v135
buffer_store_dwordx4 v[40:43], v1, s[4:7], s29 offen offset:2048 sc1
v_mov_b32 v128, v40
v_mov_b32 v129, v42
v_mov_b32 v130, v41
v_mov_b32 v131, v43
s_nop 0
v_permlane16_swap_b32 v128, v129
v_permlane16_swap_b32 v130, v131
buffer_store_dwordx4 v[128:131], v1, s[4:7], s30 offen offset:2048 sc1
v_sub_f32 v136, v136, v8
v_sub_f32 v137, v137, v8
v_cvt_pk_bf16_f32 v137, v136, v137
v_lshlrev_b32 v136, 16, v137
v_and_b32 v137, 0xffff0000, v137
v_mul_f32 v136, v136, v9
v_mul_f32 v137, v137, v9
v_cvt_pk_bf16_f32 v44, v136, v137
v_sub_f32 v138, v138, v8
v_sub_f32 v139, v139, v8
v_cvt_pk_bf16_f32 v139, v138, v139
v_lshlrev_b32 v138, 16, v139
v_and_b32 v139, 0xffff0000, v139
v_mul_f32 v138, v138, v9
v_mul_f32 v139, v139, v9
v_cvt_pk_bf16_f32 v45, v138, v139
v_sub_f32 v140, v140, v8
v_sub_f32 v141, v141, v8
v_cvt_pk_bf16_f32 v141, v140, v141
v_lshlrev_b32 v140, 16, v141
v_and_b32 v141, 0xffff0000, v141
v_mul_f32 v140, v140, v9
v_mul_f32 v141, v141, v9
v_cvt_pk_bf16_f32 v46, v140, v141
v_sub_f32 v142, v142, v8
v_sub_f32 v143, v143, v8
v_cvt_pk_bf16_f32 v143, v142, v143
v_lshlrev_b32 v142, 16, v143
v_and_b32 v143, 0xffff0000, v143
v_mul_f32 v142, v142, v9
v_mul_f32 v143, v143, v9
v_cvt_pk_bf16_f32 v47, v142, v143
buffer_store_dwordx4 v[44:47], v1, s[4:7], s29 offen offset:3072 sc1
v_mov_b32 v136, v44
v_mov_b32 v137, v46
v_mov_b32 v138, v45
v_mov_b32 v139, v47
s_nop 0
v_permlane16_swap_b32 v136, v137
v_permlane16_swap_b32 v138, v139
buffer_store_dwordx4 v[136:139], v1, s[4:7], s30 offen offset:3072 sc1
v_sub_f32 v144, v144, v8
v_sub_f32 v145, v145, v8
v_cvt_pk_bf16_f32 v145, v144, v145
v_lshlrev_b32 v144, 16, v145
v_and_b32 v145, 0xffff0000, v145
v_mul_f32 v144, v144, v9
v_mul_f32 v145, v145, v9
v_cvt_pk_bf16_f32 v48, v144, v145
v_sub_f32 v146, v146, v8
v_sub_f32 v147, v147, v8
v_cvt_pk_bf16_f32 v147, v146, v147
v_lshlrev_b32 v146, 16, v147
v_and_b32 v147, 0xffff0000, v147
v_mul_f32 v146, v146, v9
v_mul_f32 v147, v147, v9
v_cvt_pk_bf16_f32 v49, v146, v147
v_sub_f32 v148, v148, v8
v_sub_f32 v149, v149, v8
v_cvt_pk_bf16_f32 v149, v148, v149
v_lshlrev_b32 v148, 16, v149
v_and_b32 v149, 0xffff0000, v149
v_mul_f32 v148, v148, v9
v_mul_f32 v149, v149, v9
v_cvt_pk_bf16_f32 v50, v148, v149
v_sub_f32 v150, v150, v8
v_sub_f32 v151, v151, v8
v_cvt_pk_bf16_f32 v151, v150, v151
v_lshlrev_b32 v150, 16, v151
v_and_b32 v151, 0xffff0000, v151
v_mul_f32 v150, v150, v9
v_mul_f32 v151, v151, v9
v_cvt_pk_bf16_f32 v51, v150, v151
s_add_u32 s29, s29, 4096
s_add_u32 s30, s30, 4096
buffer_store_dwordx4 v[48:51], v1, s[4:7], s29 offen sc1
v_mov_b32 v144, v48
v_mov_b32 v145, v50
v_mov_b32 v146, v49
v_mov_b32 v147, v51
s_nop 0
v_permlane16_swap_b32 v144, v145
v_permlane16_swap_b32 v146, v147
buffer_store_dwordx4 v[144:147], v1, s[4:7], s30 offen sc1
v_sub_f32 v152, v152, v8
v_sub_f32 v153, v153, v8
v_cvt_pk_bf16_f32 v153, v152, v153
v_lshlrev_b32 v152, 16, v153
v_and_b32 v153, 0xffff0000, v153
v_mul_f32 v152, v152, v9
v_mul_f32 v153, v153, v9
v_cvt_pk_bf16_f32 v52, v152, v153
v_sub_f32 v154, v154, v8
v_sub_f32 v155, v155, v8
v_cvt_pk_bf16_f32 v155, v154, v155
v_lshlrev_b32 v154, 16, v155
v_and_b32 v155, 0xffff0000, v155
v_mul_f32 v154, v154, v9
v_mul_f32 v155, v155, v9
v_cvt_pk_bf16_f32 v53, v154, v155
v_sub_f32 v156, v156, v8
v_sub_f32 v157, v157, v8
v_cvt_pk_bf16_f32 v157, v156, v157
v_lshlrev_b32 v156, 16, v157
v_and_b32 v157, 0xffff0000, v157
v_mul_f32 v156, v156, v9
v_mul_f32 v157, v157, v9
v_cvt_pk_bf16_f32 v54, v156, v157
v_sub_f32 v158, v158, v8
v_sub_f32 v159, v159, v8
v_cvt_pk_bf16_f32 v159, v158, v159
v_lshlrev_b32 v158, 16, v159
v_and_b32 v159, 0xffff0000, v159
v_mul_f32 v158, v158, v9
v_mul_f32 v159, v159, v9
v_cvt_pk_bf16_f32 v55, v158, v159
buffer_store_dwordx4 v[52:55], v1, s[4:7], s29 offen offset:1024 sc1
v_mov_b32 v152, v52
v_mov_b32 v153, v54
v_mov_b32 v154, v53
v_mov_b32 v155, v55
s_nop 0
v_permlane16_swap_b32 v152, v153
v_permlane16_swap_b32 v154, v155
buffer_store_dwordx4 v[152:155], v1, s[4:7], s30 offen offset:1024 sc1
v_sub_f32 v160, v160, v8
v_sub_f32 v161, v161, v8
v_cvt_pk_bf16_f32 v161, v160, v161
v_lshlrev_b32 v160, 16, v161
v_and_b32 v161, 0xffff0000, v161
v_mul_f32 v160, v160, v9
v_mul_f32 v161, v161, v9
v_cvt_pk_bf16_f32 v56, v160, v161
v_sub_f32 v162, v162, v8
v_sub_f32 v163, v163, v8
v_cvt_pk_bf16_f32 v163, v162, v163
v_lshlrev_b32 v162, 16, v163
v_and_b32 v163, 0xffff0000, v163
v_mul_f32 v162, v162, v9
v_mul_f32 v163, v163, v9
v_cvt_pk_bf16_f32 v57, v162, v163
v_sub_f32 v164, v164, v8
v_sub_f32 v165, v165, v8
v_cvt_pk_bf16_f32 v165, v164, v165
v_lshlrev_b32 v164, 16, v165
v_and_b32 v165, 0xffff0000, v165
v_mul_f32 v164, v164, v9
v_mul_f32 v165, v165, v9
v_cvt_pk_bf16_f32 v58, v164, v165
v_sub_f32 v166, v166, v8
v_sub_f32 v167, v167, v8
v_cvt_pk_bf16_f32 v167, v166, v167
v_lshlrev_b32 v166, 16, v167
v_and_b32 v167, 0xffff0000, v167
v_mul_f32 v166, v166, v9
v_mul_f32 v167, v167, v9
v_cvt_pk_bf16_f32 v59, v166, v167
buffer_store_dwordx4 v[56:59], v1, s[4:7], s29 offen offset:2048 sc1
v_mov_b32 v160, v56
v_mov_b32 v161, v58
v_mov_b32 v162, v57
v_mov_b32 v163, v59
s_nop 0
v_permlane16_swap_b32 v160, v161
v_permlane16_swap_b32 v162, v163
buffer_store_dwordx4 v[160:163], v1, s[4:7], s30 offen offset:2048 sc1
v_sub_f32 v168, v168, v8
v_sub_f32 v169, v169, v8
v_cvt_pk_bf16_f32 v169, v168, v169
v_lshlrev_b32 v168, 16, v169
v_and_b32 v169, 0xffff0000, v169
v_mul_f32 v168, v168, v9
v_mul_f32 v169, v169, v9
v_cvt_pk_bf16_f32 v60, v168, v169
v_sub_f32 v170, v170, v8
v_sub_f32 v171, v171, v8
v_cvt_pk_bf16_f32 v171, v170, v171
v_lshlrev_b32 v170, 16, v171
v_and_b32 v171, 0xffff0000, v171
v_mul_f32 v170, v170, v9
v_mul_f32 v171, v171, v9
v_cvt_pk_bf16_f32 v61, v170, v171
v_sub_f32 v172, v172, v8
v_sub_f32 v173, v173, v8
v_cvt_pk_bf16_f32 v173, v172, v173
v_lshlrev_b32 v172, 16, v173
v_and_b32 v173, 0xffff0000, v173
v_mul_f32 v172, v172, v9
v_mul_f32 v173, v173, v9
v_cvt_pk_bf16_f32 v62, v172, v173
v_sub_f32 v174, v174, v8
v_sub_f32 v175, v175, v8
v_cvt_pk_bf16_f32 v175, v174, v175
v_lshlrev_b32 v174, 16, v175
v_and_b32 v175, 0xffff0000, v175
v_mul_f32 v174, v174, v9
v_mul_f32 v175, v175, v9
v_cvt_pk_bf16_f32 v63, v174, v175
buffer_store_dwordx4 v[60:63], v1, s[4:7], s29 offen offset:3072 sc1
v_mov_b32 v168, v60
v_mov_b32 v169, v62
v_mov_b32 v170, v61
v_mov_b32 v171, v63
s_nop 0
v_permlane16_swap_b32 v168, v169
v_permlane16_swap_b32 v170, v171
buffer_store_dwordx4 v[168:171], v1, s[4:7], s30 offen offset:3072 sc1
v_sub_f32 v176, v176, v8
v_sub_f32 v177, v177, v8
v_cvt_pk_bf16_f32 v177, v176, v177
v_lshlrev_b32 v176, 16, v177
v_and_b32 v177, 0xffff0000, v177
v_mul_f32 v176, v176, v9
v_mul_f32 v177, v177, v9
v_cvt_pk_bf16_f32 v64, v176, v177
v_sub_f32 v178, v178, v8
v_sub_f32 v179, v179, v8
v_cvt_pk_bf16_f32 v179, v178, v179
v_lshlrev_b32 v178, 16, v179
v_and_b32 v179, 0xffff0000, v179
v_mul_f32 v178, v178, v9
v_mul_f32 v179, v179, v9
v_cvt_pk_bf16_f32 v65, v178, v179
v_sub_f32 v180, v180, v8
v_sub_f32 v181, v181, v8
v_cvt_pk_bf16_f32 v181, v180, v181
v_lshlrev_b32 v180, 16, v181
v_and_b32 v181, 0xffff0000, v181
v_mul_f32 v180, v180, v9
v_mul_f32 v181, v181, v9
v_cvt_pk_bf16_f32 v66, v180, v181
v_sub_f32 v182, v182, v8
v_sub_f32 v183, v183, v8
v_cvt_pk_bf16_f32 v183, v182, v183
v_lshlrev_b32 v182, 16, v183
v_and_b32 v183, 0xffff0000, v183
v_mul_f32 v182, v182, v9
v_mul_f32 v183, v183, v9
v_cvt_pk_bf16_f32 v67, v182, v183
s_add_u32 s29, s29, 4096
s_add_u32 s30, s30, 4096
buffer_store_dwordx4 v[64:67], v1, s[4:7], s29 offen sc1
v_mov_b32 v176, v64
v_mov_b32 v177, v66
v_mov_b32 v178, v65
v_mov_b32 v179, v67
s_nop 0
v_permlane16_swap_b32 v176, v177
v_permlane16_swap_b32 v178, v179
buffer_store_dwordx4 v[176:179], v1, s[4:7], s30 offen sc1
v_sub_f32 v184, v184, v8
v_sub_f32 v185, v185, v8
v_cvt_pk_bf16_f32 v185, v184, v185
v_lshlrev_b32 v184, 16, v185
v_and_b32 v185, 0xffff0000, v185
v_mul_f32 v184, v184, v9
v_mul_f32 v185, v185, v9
v_cvt_pk_bf16_f32 v68, v184, v185
v_sub_f32 v186, v186, v8
v_sub_f32 v187, v187, v8
v_cvt_pk_bf16_f32 v187, v186, v187
v_lshlrev_b32 v186, 16, v187
v_and_b32 v187, 0xffff0000, v187
v_mul_f32 v186, v186, v9
v_mul_f32 v187, v187, v9
v_cvt_pk_bf16_f32 v69, v186, v187
v_sub_f32 v188, v188, v8
v_sub_f32 v189, v189, v8
v_cvt_pk_bf16_f32 v189, v188, v189
v_lshlrev_b32 v188, 16, v189
v_and_b32 v189, 0xffff0000, v189
v_mul_f32 v188, v188, v9
v_mul_f32 v189, v189, v9
v_cvt_pk_bf16_f32 v70, v188, v189
v_sub_f32 v190, v190, v8
v_sub_f32 v191, v191, v8
v_cvt_pk_bf16_f32 v191, v190, v191
v_lshlrev_b32 v190, 16, v191
v_and_b32 v191, 0xffff0000, v191
v_mul_f32 v190, v190, v9
v_mul_f32 v191, v191, v9
v_cvt_pk_bf16_f32 v71, v190, v191
buffer_store_dwordx4 v[68:71], v1, s[4:7], s29 offen offset:1024 sc1
v_mov_b32 v184, v68
v_mov_b32 v185, v70
v_mov_b32 v186, v69
v_mov_b32 v187, v71
s_nop 0
v_permlane16_swap_b32 v184, v185
v_permlane16_swap_b32 v186, v187
buffer_store_dwordx4 v[184:187], v1, s[4:7], s30 offen offset:1024 sc1
s_cmp_ge_u32 s26, 64
s_cbranch_scc1 LN_DONE
PRE_DONE:
v_mov_b32 v4, 49136
v_lshrrev_b32 v2, 1, v0
v_lshlrev_b32 v2, 2, v2
s_waitcnt lgkmcnt(0)
s_cmp_lg_u32 s97, 0
s_cbranch_scc1 MAIN_DRAINED
s_cmp_lg_u32 s20, 0
s_cbranch_scc1 MAIN_DRAIN
buffer_load_dword v6, off, s[84:87], 0 sc1
buffer_load_dword v7, v2, s[84:87], 0 offen offset:128 sc1
MAIN_DRAIN:
s_waitcnt vmcnt(0)
MAIN_DRAINED:
s_barrier
s_cmp_lg_u32 s20, 0
s_cbranch_scc1 MAIN_MAIL
s_mov_b32 s23, 2
s_mov_b32 s22, 0
s_mov_b32 s96, 0
v_and_b32 v5, 1, v0
v_lshlrev_b32 v5, 4, v5
MAIN_CHECK:
v_readfirstlane_b32 s88, v6
v_lshrrev_b32 v3, v5, v7
v_and_b32 v1, 0x8888, v3
s_cmp_eq_u32 s88, 0
s_cbranch_scc1 MAIN_AGAIN
buffer_store_dword v6, off, s[4:7], s33 sc1
v_cmp_ne_u32 vcc, 0x8888, v1
s_cbranch_vccz MAIN_ALL
MAIN_AGAIN:
s_sleep 2
buffer_load_dword v6, off, s[84:87], 0 sc1
buffer_load_dword v7, v2, s[84:87], 0 offen offset:128 sc1
s_waitcnt vmcnt(0)
s_sub_u32 s24, s24, 1
s_cbranch_scc0 MAIN_CHECK
s_branch MAIN_DECIDED
MAIN_ALL:
v_mov_b32 v12, 1
v_mov_b32 v13, 0
v_lshlrev_b32 v1, 2, v0
v_bfe_u32 v8, v3, 0, 3
v_cmp_gt_u32 vcc, s2, v1
v_add_u32 v1, 1, v1
v_lshlrev_b32 v9, 3, v8
v_cndmask_b32 v8, -1, v8, vcc
v_lshlrev_b64 v[14:15], v9, v[12:13]
v_cmp_eq_u32 s[26:27], s21, v8
v_bfe_u32 v8, v3, 4, 3
v_cmp_gt_u32 vcc, s2, v1
v_add_u32 v1, 1, v1
v_lshlrev_b32 v9, 3, v8
v_cndmask_b32 v8, -1, v8, vcc
v_lshlrev_b64 v[16:17], v9, v[12:13]
v_cmp_eq_u32 s[28:29], s21, v8
v_bfe_u32 v8, v3, 8, 3
v_cmp_gt_u32 vcc, s2, v1
v_add_u32 v1, 1, v1
v_lshlrev_b32 v9, 3, v8
v_cndmask_b32 v8, -1, v8, vcc
v_lshlrev_b64 v[18:19], v9, v[12:13]
v_cmp_eq_u32 s[30:31], s21, v8
v_bfe_u32 v8, v3, 12, 3
v_cmp_gt_u32 vcc, s2, v1
v_add_u32 v1, 1, v1
v_lshlrev_b32 v9, 3, v8
v_cndmask_b32 v8, -1, v8, vcc
v_lshlrev_b64 v[20:21], v9, v[12:13]
v_cmp_eq_u32 s[32:33], s21, v8
v_add3_u32 v14, v14, v16, v18
v_add_u32 v14, v14, v20
v_add3_u32 v15, v15, v17, v19
v_add_u32 v15, v15, v21
s_nop 0
v_add_u32_dpp v14, v14, v14 row_shr:1 row_mask:0xf bank_mask:0xf
v_add_u32_dpp v15, v15, v15 row_shr:1 row_mask:0xf bank_mask:0xf
s_nop 0
v_add_u32_dpp v14, v14, v14 row_shr:2 row_mask:0xf bank_mask:0xf
v_add_u32_dpp v15, v15, v15 row_shr:2 row_mask:0xf bank_mask:0xf
s_nop 0
v_add_u32_dpp v14, v14, v14 row_shr:4 row_mask:0xf bank_mask:0xf
v_add_u32_dpp v15, v15, v15 row_shr:4 row_mask:0xf bank_mask:0xf
s_nop 0
v_add_u32_dpp v14, v14, v14 row_shr:8 row_mask:0xf bank_mask:0xf
v_add_u32_dpp v15, v15, v15 row_shr:8 row_mask:0xf bank_mask:0xf
s_nop 0
v_add_u32_dpp v14, v14, v14 row_bcast:15 row_mask:0xa bank_mask:0xf
v_add_u32_dpp v15, v15, v15 row_bcast:15 row_mask:0xa bank_mask:0xf
s_nop 0
v_add_u32_dpp v14, v14, v14 row_bcast:31 row_mask:0xc bank_mask:0xf
v_add_u32_dpp v15, v15, v15 row_bcast:31 row_mask:0xc bank_mask:0xf
s_bcnt1_i32_b64 s41, s[26:27]
s_add_u32 s22, s22, s41
s_bcnt1_i32_b64 s41, s[28:29]
s_add_u32 s22, s22, s41
s_bcnt1_i32_b64 s41, s[30:31]
s_add_u32 s22, s22, s41
s_bcnt1_i32_b64 s41, s[32:33]
s_add_u32 s22, s22, s41
v_readlane_b32 s96, v3, 0
v_readlane_b32 s40, v14, 63
v_readlane_b32 s41, v15, 63
s_nop 0
s_xor_b32 s40, s40, 0x20202020
s_xor_b32 s41, s41, 0x20202020
s_or_b32 s40, s40, s41
s_cselect_b32 s23, 1, 0
MAIN_DECIDED:
v_mov_b32 v8, s22
v_mov_b32 v9, s23
v_mov_b32 v10, s88
v_mov_b32 v11, s96
ds_write_b128 v4, v[8:11]
s_waitcnt lgkmcnt(0)
MAIN_MAIL:
s_barrier
ds_read_b128 v[8:11], v4
s_waitcnt lgkmcnt(0)
v_readfirstlane_b32 s22, v8
v_readfirstlane_b32 s23, v9
v_readfirstlane_b32 s88, v10
v_readfirstlane_b32 s40, v11
s_barrier
s_nop 3
s_sub_u32 s21, s21, s40
s_and_b32 s21, s21, 7
s_cmp_lt_u32 s23, 2
s_cbranch_scc1 MAIN_ALIVE
s_endpgm
MAIN_ALIVE:
s_and_b32 s40, s2, 7
s_lshr_b32 s41, s2, 3
s_cmp_lg_u32 s23, 0
s_cselect_b32 s21, s40, s21
s_cselect_b32 s22, s41, s22
s_cmp_eq_u32 s21, 0
s_cbranch_scc0 MAIN_NOTREC
s_cmp_lt_u32 s22, 16
s_cbranch_scc0 MAIN_NOTS1
s_cmp_eq_u32 s20, 0
s_cbranch_scc1 S1_W0
s_cmp_eq_u32 s20, 1
s_cbranch_scc1 S1_W1
s_cmp_eq_u32 s20, 2
s_cbranch_scc1 S1_W2
s_branch S1_W3
MAIN_NOTS1:
s_cmp_lt_u32 s22, 30
s_cbranch_scc0 WM
s_cmp_eq_u32 s20, 0
s_cbranch_scc1 S2_W0
s_cmp_eq_u32 s20, 1
s_cbranch_scc1 S2_W1
s_cmp_eq_u32 s20, 2
s_cbranch_scc1 S2_W2
s_branch S2_W3
MAIN_NOTREC:
s_cmp_le_u32 s21, 4
s_cbranch_scc0 MAIN_NOTTOK
s_sub_u32 s21, s21, 1
s_cmp_lt_u32 s22, 16
s_cbranch_scc0 MAIN_NOTTA
s_cmp_eq_u32 s20, 0
s_cbranch_scc1 TA_W0
s_cmp_eq_u32 s20, 1
s_cbranch_scc1 TA_W1
s_cmp_eq_u32 s20, 2
s_cbranch_scc1 TA_W2
s_branch TA_W3
MAIN_NOTTA:
s_cmp_lt_u32 s22, 30
s_cbranch_scc0 MAIN_IDLE
s_cmp_eq_u32 s20, 0
s_cbranch_scc1 TB_W0
s_cmp_eq_u32 s20, 1
s_cbranch_scc1 TB_W1
s_cmp_eq_u32 s20, 2
s_cbranch_scc1 TB_W2
s_branch TB_W3
MAIN_NOTTOK:
s_cmp_le_u32 s21, 4
s_cbranch_scc1 MAIN_IDLE
s_sub_u32 s21, s21, 5
v_lshlrev_b32 v1, 4, v0
s_lshl_b32 s26, s21, 5
s_add_u32 s26, s26, s22
s_lshl_b32 s40, s20, 6
s_or_b32 s40, s40, s26
s_add_u32 s26, s26, 64
s_cmp_lt_u32 s40, 64
s_cbranch_scc1 PRE_LN
LN_DONE:
s_load_dwordx2 s[16:17], s[0:1], 8
s_mov_b32 s18, 7168
s_mov_b32 s19, 0x00020000
s_lshl_b32 s44, s21, 5
s_add_u32 s44, s44, s22
s_lshl_b32 s40, s44, 2
s_add_u32 s40, s40, s20
v_mov_b32 v8, -1
v_mov_b32 v9, -1
v_mov_b32 v10, -1
v_mov_b32 v11, -1
v_and_b32 v2, 7, v0
v_mul_u32_u24 v2, 896, v2
v_lshrrev_b32 v3, 3, v0
v_lshl_add_u32 v2, v3, 4, v2
s_mov_b32 s6, 6205440
s_lshl_b32 s42, s40, 10
s_add_u32 s42, s42, 176128
s_waitcnt lgkmcnt(0)
v_mov_b32 v3, s88
s_lshr_b32 s45, s44, 3
s_lshl_b32 s45, s45, 7
s_and_b32 s44, s44, 7
s_lshl_b32 s44, s44, 2
s_add_u32 s44, s44, s45
s_add_u32 s44, s44, 4096
v_mov_b32 v12, -1
v_mov_b32 v13, -1
v_mov_b32 v14, -1
v_mov_b32 v15, -1
s_sub_u32 s41, s40, 0
s_cmp_lt_u32 s41, 7
s_cbranch_scc0 Lnomem_1
s_lshl_b32 s41, s41, 7
buffer_load_dwordx4 v[12:15], v2, s[16:19], s41 offen
s_waitcnt vmcnt(0)
v_min_u32 v12, -2, v12
v_min_u32 v13, -2, v13
v_min_u32 v14, -2, v14
v_min_u32 v15, -2, v15
Lnomem_1:
buffer_store_dwordx4 v[12:15], v1, s[4:7], s42 offen sc1
s_add_u32 s42, s42, 393216
v_mov_b32 v16, -1
v_mov_b32 v17, -1
v_mov_b32 v18, -1
v_mov_b32 v19, -1
s_sub_u32 s41, s40, 64
s_cmp_lt_u32 s41, 7
s_cbranch_scc0 Lnomem_2
s_lshl_b32 s41, s41, 7
buffer_load_dwordx4 v[16:19], v2, s[16:19], s41 offen
s_waitcnt vmcnt(0)
v_min_u32 v16, -2, v16
v_min_u32 v17, -2, v17
v_min_u32 v18, -2, v18
v_min_u32 v19, -2, v19
Lnomem_2:
buffer_store_dwordx4 v[16:19], v1, s[4:7], s42 offen sc1
s_add_u32 s42, s42, 393216
buffer_store_dwordx4 v[8:11], v1, s[4:7], s42 offen sc1
s_add_u32 s42, s42, 393216
buffer_store_dwordx4 v[8:11], v1, s[4:7], s42 offen sc1
s_add_u32 s42, s42, 393216
s_waitcnt vmcnt(0)
s_barrier
s_cmp_lg_u32 s20, 0
s_cbranch_scc1 Lmute_3
buffer_store_dword v3, off, s[4:7], s44 offset:512 sc1
Lmute_3:
s_mov_b32 s40, 139392
s_branch Lfirst_5
Lflag_4:
v_cmp_ne_u32 vcc, s88, v2
s_cbranch_vccz Lset_6
s_sleep 16
Lfirst_5:
buffer_load_dword v2, off, s[4:7], s40 sc1
s_waitcnt vmcnt(0)
s_sub_u32 s24, s24, 1
s_cbranch_scc0 Lflag_4
s_endpgm
Lset_6:
v_min_u32 v4, 55, v0
v_and_b32 v2, 3, v4
v_lshlrev_b32 v2, 3, v2
v_lshrrev_b32 v4, 2, v4
v_lshl_add_u32 v2, v4, 7, v2
s_mov_b32 s43, 4352
Llz_7:
buffer_load_dwordx2 v[4:5], v2, s[4:7], s43 offen sc1
s_waitcnt vmcnt(0)
v_cmp_ne_u32 vcc, s88, v4
v_cmp_ne_u32 s[40:41], s88, v5
s_or_b64 vcc, vcc, s[40:41]
s_cbranch_vccz Llzok_8
s_sleep 8
s_sub_u32 s24, s24, 1
s_cbranch_scc0 Llz_7
s_endpgm
Llzok_8:
s_mul_i32 s40, s21, 0
s_add_u32 s40, s40, 656384
Lstp_9:
buffer_load_dword v2, off, s[4:7], s40 sc1
s_waitcnt vmcnt(0)
v_cmp_eq_u32 vcc, -1, v2
s_cbranch_vccz Lstpok_10
s_sleep 16
s_sub_u32 s24, s24, 1
s_cbranch_scc0 Lstp_9
s_endpgm
Lstpok_10:
buffer_store_dwordx4 v[8:11], v1, s[4:7], s42 offen sc1
s_add_u32 s42, s42, 393216
buffer_store_dwordx4 v[8:11], v1, s[4:7], s42 offen sc1
s_add_u32 s42, s42, 393216
buffer_store_dwordx4 v[8:11], v1, s[4:7], s42 offen sc1
s_add_u32 s42, s42, 393216
buffer_store_dwordx4 v[8:11], v1, s[4:7], s42 offen sc1
s_add_u32 s42, s42, 393216
buffer_store_dwordx4 v[8:11], v1, s[4:7], s42 offen sc1
s_add_u32 s42, s42, 393216
buffer_store_dwordx4 v[8:11], v1, s[4:7], s42 offen sc1
s_add_u32 s42, s42, 393216
buffer_store_dwordx4 v[8:11], v1, s[4:7], s42 offen sc1
s_add_u32 s42, s42, 393216
buffer_store_dwordx4 v[8:11], v1, s[4:7], s42 offen sc1
s_add_u32 s42, s42, 393216
buffer_store_dwordx4 v[8:11], v1, s[4:7], s42 offen sc1
s_add_u32 s42, s42, 393216
buffer_store_dwordx4 v[8:11], v1, s[4:7], s42 offen sc1
s_add_u32 s42, s42, 393216
buffer_store_dwordx4 v[8:11], v1, s[4:7], s42 offen sc1
s_add_u32 s42, s42, 393216
buffer_store_dwordx4 v[8:11], v1, s[4:7], s42 offen sc1
s_add_u32 s42, s42, 393216
s_mov_b32 s6, 268435456
s_waitcnt vmcnt(0)
s_barrier
s_cmp_lg_u32 s20, 0
s_cbranch_scc1 Lmute_11
buffer_store_dword v3, off, s[4:7], s44 offset:2048 sc1
Lmute_11:
v_min_u32 v4, 55, v0
v_and_b32 v2, 3, v4
v_lshlrev_b32 v2, 3, v2
v_lshrrev_b32 v4, 2, v4
v_lshl_add_u32 v2, v4, 7, v2
s_mov_b32 s43, 4352
Llz_12:
buffer_load_dwordx2 v[4:5], v2, s[4:7], s43 offen sc1
s_waitcnt vmcnt(0)
v_cmp_ne_u32 vcc, s88, v4
v_cmp_ne_u32 s[40:41], s88, v5
s_or_b64 vcc, vcc, s[40:41]
s_cbranch_vccz Llzok_13
s_sleep 8
s_sub_u32 s24, s24, 1
s_cbranch_scc0 Llz_12
s_endpgm
Llzok_13:
s_mul_i32 s40, s21, 7168
s_add_u32 s40, s40, 692224
Lstp_14:
buffer_load_dword v2, off, s[4:7], s40 sc1
s_waitcnt vmcnt(0)
v_cmp_eq_u32 vcc, -1, v2
s_cbranch_vccz Lstpok_15
s_sleep 16
s_sub_u32 s24, s24, 1
s_cbranch_scc0 Lstp_14
s_endpgm
Lstpok_15:
s_cmp_lt_u32 s22, 14
s_cbranch_scc0 MAIN_NOTF1
s_cmp_eq_u32 s20, 0
s_cbranch_scc1 F1_W0
s_cmp_eq_u32 s20, 1
s_cbranch_scc1 F1_W1
s_cmp_eq_u32 s20, 2
s_cbranch_scc1 F1_W2
s_branch F1_W3
MAIN_NOTF1:
s_cmp_lt_u32 s22, 28
s_cbranch_scc0 MAIN_IDLE
s_cmp_eq_u32 s20, 0
s_cbranch_scc1 F2_W0
s_cmp_eq_u32 s20, 1
s_cbranch_scc1 F2_W1
s_cmp_eq_u32 s20, 2
s_cbranch_scc1 F2_W2
s_branch F2_W3
MAIN_IDLE:
s_cmp_eq_u32 s22, 31
s_cbranch_scc0 MAIN_END
s_cmp_eq_u32 s20, 0
s_cbranch_scc1 CLEAN
MAIN_END:
s_endpgm
CLEAN:
v_min_u32 v2, 55, v0
v_and_b32 v1, 3, v2
v_lshlrev_b32 v1, 3, v1
v_lshrrev_b32 v2, 2, v2
v_lshl_add_u32 v1, v2, 7, v1
s_mov_b32 s43, 4352
Llz_16:
buffer_load_dwordx2 v[2:3], v1, s[4:7], s43 offen sc1
s_waitcnt vmcnt(0)
v_cmp_ne_u32 vcc, s88, v2
v_cmp_ne_u32 s[40:41], s88, v3
s_or_b64 vcc, vcc, s[40:41]
s_cbranch_vccz Llzok_17
s_sleep 8
s_sub_u32 s24, s24, 1
s_cbranch_scc0 Llz_16
s_endpgm
Llzok_17:
s_mul_i32 s40, s21, 0
s_add_u32 s40, s40, 1007616
Lstp_18:
buffer_load_dword v1, off, s[4:7], s40 sc1
s_waitcnt vmcnt(0)
v_cmp_eq_u32 vcc, -1, v1
s_cbranch_vccz Lstpok_19
s_sleep 32
s_sub_u32 s24, s24, 1
s_cbranch_scc0 Lstp_18
s_endpgm
Lstpok_19:
buffer_wbl2 sc1
s_waitcnt vmcnt(0)
s_mul_i32 s40, s21, 0
s_add_u32 s40, s40, 1072128
Lstp_20:
buffer_load_dword v1, off, s[4:7], s40 sc1
s_waitcnt vmcnt(0)
v_cmp_eq_u32 vcc, -1, v1
s_cbranch_vccz Lstpok_21
s_sleep 32
s_sub_u32 s24, s24, 1
s_cbranch_scc0 Lstp_20
s_endpgm
Lstpok_21:
buffer_wbl2 sc1
s_waitcnt vmcnt(0)
s_endpgm
WM:
s_sub_u32 s30, s22, 30
s_lshl_b32 s30, s30, 2
s_add_u32 s30, s30, s20
s_mov_b32 s25, 0
s_cmp_eq_u32 s30, 7
s_cbranch_scc0 WM_LINES
v_min_u32 v3, 55, v0
v_and_b32 v2, 3, v3
v_lshlrev_b32 v2, 2, v2
v_lshrrev_b32 v3, 2, v3
v_lshl_add_u32 v2, v3, 7, v2
s_mov_b32 s29, 8192
s_mov_b32 s31, 126976
WM_Y:
s_branch Lfirst_23
Lflag_22:
v_cmp_ne_u32 vcc, s88, v3
s_cbranch_vccz Lset_24
s_sleep 8
Lfirst_23:
buffer_load_dword v3, v2, s[4:7], s29 offen sc1
s_waitcnt vmcnt(0)
s_sub_u32 s24, s24, 1
s_cbranch_scc0 Lflag_22
s_endpgm
Lset_24:
buffer_store_dword v3, off, s[4:7], s31
s_cmp_lt_u32 s25, 8
s_cbranch_scc0 WM_NOGATE
s_add_u32 s40, s31, 12288
buffer_store_dword v3, off, s[4:7], s40 sc1
WM_NOGATE:
s_add_u32 s29, s29, 1792
s_add_u32 s31, s31, 128
s_add_u32 s25, s25, 1
s_cmp_lt_u32 s25, 64
s_cbranch_scc1 WM_Y
s_endpgm
WM_LINES:
v_min_u32 v8, 55, v0
v_and_b32 v3, 3, v8
v_lshlrev_b32 v3, 3, v3
v_lshrrev_b32 v8, 2, v8
v_lshl_add_u32 v3, v8, 7, v3
s_mov_b32 s43, 4352
Llz_25:
buffer_load_dwordx2 v[8:9], v3, s[4:7], s43 offen sc1
s_waitcnt vmcnt(0)
v_cmp_ne_u32 vcc, s88, v8
v_cmp_ne_u32 s[40:41], s88, v9
s_or_b64 vcc, vcc, s[40:41]
s_cbranch_vccz Llzok_26
s_sleep 8
s_sub_u32 s24, s24, 1
s_cbranch_scc0 Llz_25
s_endpgm
Llzok_26:
v_lshlrev_b32 v1, 7, v0
s_mul_i32 s26, s23, 458752
s_add_u32 s26, s26, 176128
s_mul_i32 s27, s30, 7168
s_add_u32 s27, s27, 6205440
s_mov_b32 s28, 28672
s_cmp_lt_u32 s30, 4
s_cbranch_scc1 WM_GO
s_mov_b32 s27, s26
s_mov_b32 s28, 7168
s_cmp_eq_u32 s30, 4
s_cbranch_scc1 WM_GO
s_and_b32 s27, s30, 1
s_lshl_b32 s27, s27, 11
s_add_u32 s27, s27, 1093632
s_mov_b32 s28, 10240
WM_GO:
buffer_load_dword v4, v1, s[4:7], s27 offen sc1
s_add_u32 s27, s27, s28
buffer_load_dword v4, v1, s[4:7], s27 offen sc1
s_add_u32 s27, s27, s28
v_and_b32 v3, 7, v0
v_lshlrev_b32 v2, 7, v3
v_lshrrev_b32 v3, 3, v0
v_lshl_add_u32 v2, v3, 13, v2
s_lshl_b32 s29, s30, 16
s_add_u32 s29, s29, 30527488
s_mov_b32 s31, 127104
WM_STEP:
buffer_load_dword v3, off, s[4:7], s26 sc1
buffer_load_dword v5, off, s[4:7], s31 sc1
s_sub_u32 s40, s31, 128
buffer_load_dword v6, off, s[4:7], s40 sc1
s_waitcnt vmcnt(0)
v_cmp_eq_u32 vcc, -1, v3
s_cbranch_vccz WM_RUN
s_sleep 4
s_sub_u32 s24, s24, 1
s_cbranch_scc0 WM_STEP
s_endpgm
WM_RUN:
buffer_load_dword v4, v1, s[4:7], s27 offen sc1
v_cmp_ne_u32 vcc, s88, v5
s_cbranch_vccnz WM_NOY
buffer_load_dword v4, v2, s[4:7], s29 offen offset:2048 sc1
buffer_load_dword v4, v2, s[4:7], s29 offen offset:3072 sc1
WM_NOY:
s_add_u32 s29, s29, 458752
s_add_u32 s31, s31, 128
s_add_u32 s27, s27, s28
s_add_u32 s26, s26, 7168
s_add_u32 s25, s25, 1
s_cmp_lt_u32 s25, 62
s_cbranch_scc1 WM_STEP
s_endpgm
S1_W0:
v_lshlrev_b32 v1, 4, v0
s_sub_u32 s41, s97, 257
s_cmp_eq_u32 s41, s22
s_cbranch_scc1 Lknown_28
v_min_u32 v9, 6, v0
v_lshlrev_b32 v9, 2, v9
s_lshl_b32 s40, s22, 7
s_branch Lfirst_30
Lflag_29:
v_cmp_ne_u32 vcc, s88, v10
s_cbranch_vccz Lset_31
s_sleep 4
Lfirst_30:
buffer_load_dword v10, v9, s[4:7], s40 offen sc1
s_waitcnt vmcnt(0)
s_sub_u32 s24, s24, 1
s_cbranch_scc0 Lflag_29
s_endpgm
Lset_31:
Lknown_28:
s_mul_i32 s40, s22, 401408
s_add_u32 s40, s40, 9879552
s_and_b32 s41, s97, 255
s_sub_u32 s41, s41, 1
s_cmp_eq_u32 s41, s22
s_cbranch_scc1 Lheld_27
s_mov_b32 s41, s40
buffer_load_dwordx4 a[0:3], v1, s[4:7], s41 offen
buffer_load_dwordx4 a[4:7], v1, s[4:7], s41 offen offset:1024
buffer_load_dwordx4 a[8:11], v1, s[4:7], s41 offen offset:2048
buffer_load_dwordx4 a[12:15], v1, s[4:7], s41 offen offset:3072
s_add_u32 s41, s41, 4096
buffer_load_dwordx4 a[16:19], v1, s[4:7], s41 offen
buffer_load_dwordx4 a[20:23], v1, s[4:7], s41 offen offset:1024
buffer_load_dwordx4 a[24:27], v1, s[4:7], s41 offen offset:2048
buffer_load_dwordx4 a[28:31], v1, s[4:7], s41 offen offset:3072
s_add_u32 s41, s41, 4096
buffer_load_dwordx4 a[32:35], v1, s[4:7], s41 offen
buffer_load_dwordx4 a[36:39], v1, s[4:7], s41 offen offset:1024
buffer_load_dwordx4 a[40:43], v1, s[4:7], s41 offen offset:2048
buffer_load_dwordx4 a[44:47], v1, s[4:7], s41 offen offset:3072
s_add_u32 s41, s41, 4096
buffer_load_dwordx4 a[48:51], v1, s[4:7], s41 offen
buffer_load_dwordx4 a[52:55], v1, s[4:7], s41 offen offset:1024
buffer_load_dwordx4 a[56:59], v1, s[4:7], s41 offen offset:2048
buffer_load_dwordx4 a[60:63], v1, s[4:7], s41 offen offset:3072
s_add_u32 s41, s41, 4096
buffer_load_dwordx4 a[64:67], v1, s[4:7], s41 offen
buffer_load_dwordx4 a[68:71], v1, s[4:7], s41 offen offset:1024
buffer_load_dwordx4 a[72:75], v1, s[4:7], s41 offen offset:2048
buffer_load_dwordx4 a[76:79], v1, s[4:7], s41 offen offset:3072
s_add_u32 s41, s41, 4096
buffer_load_dwordx4 a[80:83], v1, s[4:7], s41 offen
buffer_load_dwordx4 a[84:87], v1, s[4:7], s41 offen offset:1024
buffer_load_dwordx4 a[88:91], v1, s[4:7], s41 offen offset:2048
buffer_load_dwordx4 a[92:95], v1, s[4:7], s41 offen offset:3072
s_add_u32 s41, s41, 4096
buffer_load_dwordx4 a[96:99], v1, s[4:7], s41 offen
buffer_load_dwordx4 a[100:103], v1, s[4:7], s41 offen offset:1024
buffer_load_dwordx4 a[104:107], v1, s[4:7], s41 offen offset:2048
buffer_load_dwordx4 a[108:111], v1, s[4:7], s41 offen offset:3072
s_add_u32 s41, s41, 4096
buffer_load_dwordx4 a[112:115], v1, s[4:7], s41 offen
buffer_load_dwordx4 a[116:119], v1, s[4:7], s41 offen offset:1024
buffer_load_dwordx4 a[120:123], v1, s[4:7], s41 offen offset:2048
buffer_load_dwordx4 a[124:127], v1, s[4:7], s41 offen offset:3072
s_add_u32 s41, s41, 4096
buffer_load_dwordx4 a[128:131], v1, s[4:7], s41 offen
buffer_load_dwordx4 a[132:135], v1, s[4:7], s41 offen offset:1024
buffer_load_dwordx4 a[136:139], v1, s[4:7], s41 offen offset:2048
buffer_load_dwordx4 a[140:143], v1, s[4:7], s41 offen offset:3072
s_add_u32 s41, s41, 4096
buffer_load_dwordx4 a[144:147], v1, s[4:7], s41 offen
buffer_load_dwordx4 a[148:151], v1, s[4:7], s41 offen offset:1024
buffer_load_dwordx4 a[152:155], v1, s[4:7], s41 offen offset:2048
buffer_load_dwordx4 a[156:159], v1, s[4:7], s41 offen offset:3072
s_add_u32 s41, s41, 4096
buffer_load_dwordx4 a[160:163], v1, s[4:7], s41 offen
buffer_load_dwordx4 a[164:167], v1, s[4:7], s41 offen offset:1024
buffer_load_dwordx4 a[168:171], v1, s[4:7], s41 offen offset:2048
buffer_load_dwordx4 a[172:175], v1, s[4:7], s41 offen offset:3072
s_add_u32 s41, s41, 4096
buffer_load_dwordx4 a[176:179], v1, s[4:7], s41 offen
buffer_load_dwordx4 a[180:183], v1, s[4:7], s41 offen offset:1024
buffer_load_dwordx4 a[184:187], v1, s[4:7], s41 offen offset:2048
buffer_load_dwordx4 a[188:191], v1, s[4:7], s41 offen offset:3072
s_add_u32 s41, s41, 4096
s_waitcnt vmcnt(40)
buffer_load_dwordx4 a[192:195], v1, s[4:7], s41 offen
buffer_load_dwordx4 a[196:199], v1, s[4:7], s41 offen offset:1024
buffer_load_dwordx4 a[200:203], v1, s[4:7], s41 offen offset:2048
buffer_load_dwordx4 a[204:207], v1, s[4:7], s41 offen offset:3072
s_add_u32 s41, s41, 4096
buffer_load_dwordx4 a[208:211], v1, s[4:7], s41 offen
buffer_load_dwordx4 a[212:215], v1, s[4:7], s41 offen offset:1024
buffer_load_dwordx4 a[216:219], v1, s[4:7], s41 offen offset:2048
buffer_load_dwordx4 a[220:223], v1, s[4:7], s41 offen offset:3072
s_waitcnt vmcnt(8)
Lheld_27:
s_add_u32 s40, s40, 57344
buffer_load_dwordx4 a[224:227], v1, s[4:7], s40 offen
buffer_load_dwordx4 a[228:231], v1, s[4:7], s40 offen offset:1024
buffer_load_dwordx4 a[232:235], v1, s[4:7], s40 offen offset:2048
buffer_load_dwordx4 a[236:239], v1, s[4:7], s40 offen offset:3072
s_add_u32 s40, s40, 4096
buffer_load_dwordx4 a[240:243], v1, s[4:7], s40 offen
buffer_load_dwordx4 a[244:247], v1, s[4:7], s40 offen offset:1024
buffer_load_dwordx4 a[248:251], v1, s[4:7], s40 offen offset:2048
buffer_load_dwordx4 a[252:255], v1, s[4:7], s40 offen offset:3072
s_add_u32 s40, s40, 4096
buffer_load_dwordx4 v[120:123], v1, s[4:7], s40 offen
buffer_load_dwordx4 v[124:127], v1, s[4:7], s40 offen offset:1024
buffer_load_dwordx4 v[128:131], v1, s[4:7], s40 offen offset:2048
buffer_load_dwordx4 v[132:135], v1, s[4:7], s40 offen offset:3072
s_add_u32 s40, s40, 4096
buffer_load_dwordx4 v[136:139], v1, s[4:7], s40 offen
buffer_load_dwordx4 v[140:143], v1, s[4:7], s40 offen offset:1024
buffer_load_dwordx4 v[144:147], v1, s[4:7], s40 offen offset:2048
buffer_load_dwordx4 v[148:151], v1, s[4:7], s40 offen offset:3072
s_add_u32 s40, s40, 4096
buffer_load_dwordx4 v[152:155], v1, s[4:7], s40 offen
buffer_load_dwordx4 v[156:159], v1, s[4:7], s40 offen offset:1024
buffer_load_dwordx4 v[160:163], v1, s[4:7], s40 offen offset:2048
buffer_load_dwordx4 v[164:167], v1, s[4:7], s40 offen offset:3072
s_add_u32 s40, s40, 4096
buffer_load_dwordx4 v[168:171], v1, s[4:7], s40 offen
buffer_load_dwordx4 v[172:175], v1, s[4:7], s40 offen offset:1024
buffer_load_dwordx4 v[176:179], v1, s[4:7], s40 offen offset:2048
buffer_load_dwordx4 v[180:183], v1, s[4:7], s40 offen offset:3072
s_add_u32 s40, s40, 4096
buffer_load_dwordx4 v[184:187], v1, s[4:7], s40 offen
buffer_load_dwordx4 v[188:191], v1, s[4:7], s40 offen offset:1024
buffer_load_dwordx4 v[192:195], v1, s[4:7], s40 offen offset:2048
buffer_load_dwordx4 v[196:199], v1, s[4:7], s40 offen offset:3072
s_add_u32 s40, s40, 4096
buffer_load_dwordx4 v[200:203], v1, s[4:7], s40 offen
buffer_load_dwordx4 v[204:207], v1, s[4:7], s40 offen offset:1024
buffer_load_dwordx4 v[208:211], v1, s[4:7], s40 offen offset:2048
buffer_load_dwordx4 v[212:215], v1, s[4:7], s40 offen offset:3072
s_add_u32 s40, s40, 4096
buffer_load_dwordx4 v[216:219], v1, s[4:7], s40 offen
buffer_load_dwordx4 v[220:223], v1, s[4:7], s40 offen offset:1024
buffer_load_dwordx4 v[224:227], v1, s[4:7], s40 offen offset:2048
buffer_load_dwordx4 v[228:231], v1, s[4:7], s40 offen offset:3072
s_add_u32 s40, s40, 4096
buffer_load_dwordx4 v[232:235], v1, s[4:7], s40 offen
buffer_load_dwordx4 v[236:239], v1, s[4:7], s40 offen offset:1024
buffer_load_dwordx4 v[240:243], v1, s[4:7], s40 offen offset:2048
buffer_load_dwordx4 v[244:247], v1, s[4:7], s40 offen offset:3072
s_add_u32 s40, s40, 4096
buffer_load_dwordx4 v[248:251], v1, s[4:7], s40 offen
buffer_load_dwordx4 v[252:255], v1, s[4:7], s40 offen offset:1024
v_and_b32 v9, 15, v0
v_lshrrev_b32 v10, 5, v0
v_mul_u32_u24 v2, 14, v10
v_bfe_u32 v10, v0, 4, 1
v_add_u32 v2, v2, v10
v_lshlrev_b32 v2, 8, v2
v_lshl_add_u32 v2, v9, 4, v2
v_bfe_u32 v7, v0, 5, 1
v_bfe_u32 v10, v0, 4, 1
v_lshl_add_u32 v7, v10, 1, v7
v_lshlrev_b32 v3, 2, v7
v_lshl_add_u32 v3, v9, 4, v3
v_add_u32 v3, 8192, v3
v_lshrrev_b32 v10, 4, v0
v_bfe_u32 v4, v0, 2, 2
v_lshl_add_u32 v4, v10, 3, v4
v_lshlrev_b32 v4, 5, v4
v_and_b32 v5, 3, v0
v_lshl_add_u32 v4, v5, 3, v4
v_add_u32 v4, 8192, v4
v_lshlrev_b32 v6, 5, v10
v_add_u32 v6, 16384, v6
v_cmp_eq_u32 vcc, 0, v9
v_add_u32 v10, 0, v6
v_lshlrev_b32 v5, 2, v0
v_add_u32 v5, 16512, v5
v_cndmask_b32 v5, v5, v10, vcc
v_and_b32 v10, 1, v0
v_cmp_eq_u32 s[34:35], 0, v10
v_lshl_add_u32 v6, v10, 4, v6
v_lshlrev_b32 v7, 5, v7
v_lshl_add_u32 v7, v10, 4, v7
v_bfe_u32 v10, v0, 3, 1
v_lshl_add_u32 v7, v10, 7, v7
v_and_b32 v10, 6, v0
v_lshl_add_u32 v7, v10, 1, v7
v_and_b32 v9, 8, v0
v_cmp_eq_u32 vcc, 0, v9
v_mov_b32 v9, 0x88884444
v_mov_b32 v8, 0xddddeeee
v_cndmask_b32 v8, v8, v9, vcc
s_mul_i32 s26, s23, 458752
s_add_u32 s26, s26, 176128
s_lshl_b32 s27, s22, 9
s_add_u32 s27, s27, 1093632
s_mov_b32 s30, s23
s_mov_b32 s31, 0
s_mov_b32 s32, 562036736
s_mov_b32 s33, 1342177280
s_mov_b32 s28, 6205440
s_add_u32 s29, s28, 7168
s_mov_b32 s25, 0
v_min_u32 v12, 55, v0
v_and_b32 v14, 3, v12
v_lshlrev_b32 v14, 3, v14
v_lshrrev_b32 v12, 2, v12
v_lshl_add_u32 v14, v12, 7, v14
s_mov_b32 s43, 4352
Llz_32:
buffer_load_dwordx2 v[12:13], v14, s[4:7], s43 offen sc1
s_waitcnt vmcnt(0)
v_cmp_ne_u32 vcc, s88, v12
v_cmp_ne_u32 s[40:41], s88, v13
s_or_b64 vcc, vcc, s[40:41]
s_cbranch_vccz Llzok_33
s_sleep 8
s_sub_u32 s24, s24, 1
s_cbranch_scc0 Llz_32
s_endpgm
Llzok_33:
.p2align 6
S1_STEP0:
s_waitcnt vmcnt(0)
s_nop 15
s_nop 7
buffer_load_dwordx4 v[44:47], v1, s[4:7], s26 offen sc1
buffer_load_dwordx4 v[48:51], v1, s[4:7], s26 offen offset:1024 sc1
v_mov_b32 v12, 0
v_mov_b32 v13, 0
v_mov_b32 v14, 0
v_mov_b32 v15, 0
v_mov_b32 v16, 0
v_mov_b32 v17, 0
v_mov_b32 v18, 0
v_mov_b32 v19, 0
v_mov_b32 v20, 0
v_mov_b32 v21, 0
v_mov_b32 v22, 0
v_mov_b32 v23, 0
v_mov_b32 v24, 0
v_mov_b32 v25, 0
v_mov_b32 v26, 0
v_mov_b32 v27, 0
v_mov_b32 v28, 0
v_mov_b32 v29, 0
v_mov_b32 v30, 0
v_mov_b32 v31, 0
v_mov_b32 v32, 0
v_mov_b32 v33, 0
v_mov_b32 v34, 0
v_mov_b32 v35, 0
v_mov_b32 v36, 0
v_mov_b32 v37, 0
v_mov_b32 v38, 0
v_mov_b32 v39, 0
v_mov_b32 v40, 0
v_mov_b32 v41, 0
v_mov_b32 v42, 0
v_mov_b32 v43, 0
Lspin_34:
buffer_load_dwordx4 v[44:47], v1, s[4:7], s26 offen sc1
buffer_load_dwordx4 v[48:51], v1, s[4:7], s26 offen offset:1024 sc1
s_sub_u32 s24, s24, 1
s_cbranch_scc1 CODE_END
s_waitcnt vmcnt(2)
v_max3_u32 v9, v44, v45, v46
v_max3_u32 v9, v9, v47, v48
v_max3_u32 v9, v9, v49, v50
v_max_u32 v9, v9, v51
v_cmp_eq_u32 vcc, -1, v9
ds_write_b128 v1, v[44:47]
ds_write_b128 v1, v[48:51] offset:1024
s_cbranch_vccnz Lspin_34
v_smfmac_f32_16x16x64_bf16 v[16:19], v[44:47], a[0:7], v8
v_smfmac_f32_16x16x64_bf16 v[20:23], v[44:47], a[56:63], v8
v_smfmac_f32_16x16x64_bf16 v[24:27], v[44:47], a[112:119], v8
s_waitcnt lgkmcnt(0)
s_barrier
ds_read_b128 v[52:55], v1 offset:2048
v_smfmac_f32_16x16x64_bf16 v[28:31], v[44:47], a[168:175], v8
ds_read_b128 v[56:59], v1 offset:3072
v_smfmac_f32_16x16x64_bf16 v[32:35], v[44:47], a[224:231], v8
buffer_load_dwordx4 v[72:75], v2, s[4:7], s28 offen
ds_read_b128 v[60:63], v1 offset:4096
v_smfmac_f32_16x16x64_bf16 v[36:39], v[44:47], v[144:151], v8
ds_read_b128 v[64:67], v1 offset:5120
v_smfmac_f32_16x16x64_bf16 v[40:43], v[44:47], v[200:207], v8
buffer_load_dwordx4 v[76:79], v2, s[4:7], s29 offen
ds_read_b128 v[68:71], v1 offset:6144
v_smfmac_f32_16x16x64_bf16 v[16:19], v[48:51], a[8:15], v8
v_smfmac_f32_16x16x64_bf16 v[20:23], v[48:51], a[64:71], v8
buffer_load_dwordx4 v[80:83], v2, s[4:7], s28 offen offset:512
v_smfmac_f32_16x16x64_bf16 v[24:27], v[48:51], a[120:127], v8
v_smfmac_f32_16x16x64_bf16 v[28:31], v[48:51], a[176:183], v8
buffer_load_dwordx4 v[84:87], v2, s[4:7], s29 offen offset:512
v_smfmac_f32_16x16x64_bf16 v[32:35], v[48:51], a[232:239], v8
v_smfmac_f32_16x16x64_bf16 v[36:39], v[48:51], v[152:159], v8
buffer_load_dwordx4 v[88:91], v2, s[4:7], s28 offen offset:1024
v_smfmac_f32_16x16x64_bf16 v[40:43], v[48:51], v[208:215], v8
s_waitcnt lgkmcnt(4)
v_smfmac_f32_16x16x64_bf16 v[16:19], v[52:55], a[16:23], v8
buffer_load_dwordx4 v[92:95], v2, s[4:7], s29 offen offset:1024
s_waitcnt lgkmcnt(3)
v_smfmac_f32_16x16x64_bf16 v[16:19], v[56:59], a[24:31], v8
s_waitcnt lgkmcnt(2)
v_smfmac_f32_16x16x64_bf16 v[16:19], v[60:63], a[32:39], v8
buffer_load_dwordx4 v[96:99], v2, s[4:7], s28 offen offset:1536
s_waitcnt lgkmcnt(1)
v_smfmac_f32_16x16x64_bf16 v[16:19], v[64:67], a[40:47], v8
s_waitcnt lgkmcnt(0)
v_smfmac_f32_16x16x64_bf16 v[16:19], v[68:71], a[48:55], v8
buffer_load_dwordx4 v[100:103], v2, s[4:7], s29 offen offset:1536
v_smfmac_f32_16x16x64_bf16 v[20:23], v[52:55], a[72:79], v8
v_smfmac_f32_16x16x64_bf16 v[20:23], v[56:59], a[80:87], v8
buffer_load_dwordx4 v[104:107], v2, s[4:7], s28 offen offset:2048
v_smfmac_f32_16x16x64_bf16 v[20:23], v[60:63], a[88:95], v8
v_permlane32_swap_b32 v16, v18
v_smfmac_f32_16x16x64_bf16 v[20:23], v[64:67], a[96:103], v8
v_permlane32_swap_b32 v17, v19
v_smfmac_f32_16x16x64_bf16 v[20:23], v[68:71], a[104:111], v8
buffer_load_dwordx4 v[108:111], v2, s[4:7], s29 offen offset:2048
v_add_f32 v16, v16, v18
v_smfmac_f32_16x16x64_bf16 v[24:27], v[52:55], a[128:135], v8
v_add_f32 v17, v17, v19
v_smfmac_f32_16x16x64_bf16 v[24:27], v[56:59], a[136:143], v8
buffer_load_dwordx4 v[112:115], v2, s[4:7], s28 offen offset:2560
v_cvt_pk_bf16_f32 v16, v16, v17
v_smfmac_f32_16x16x64_bf16 v[24:27], v[60:63], a[144:151], v8
ds_write_b32 v3, v16
v_permlane32_swap_b32 v20, v22
v_smfmac_f32_16x16x64_bf16 v[24:27], v[64:67], a[152:159], v8
v_permlane32_swap_b32 v21, v23
v_smfmac_f32_16x16x64_bf16 v[24:27], v[68:71], a[160:167], v8
buffer_load_dwordx4 v[116:119], v2, s[4:7], s29 offen offset:2560
v_add_f32 v20, v20, v22
v_smfmac_f32_16x16x64_bf16 v[28:31], v[52:55], a[184:191], v8
v_add_f32 v21, v21, v23
v_smfmac_f32_16x16x64_bf16 v[28:31], v[56:59], a[192:199], v8
s_waitcnt vmcnt(12)
buffer_load_dwordx4 v[44:47], v2, s[4:7], s28 offen offset:3072
v_cvt_pk_bf16_f32 v20, v20, v21
v_smfmac_f32_16x16x64_bf16 v[28:31], v[60:63], a[200:207], v8
ds_write_b32 v3, v20 offset:1024
v_permlane32_swap_b32 v24, v26
v_smfmac_f32_16x16x64_bf16 v[28:31], v[64:67], a[208:215], v8
v_permlane32_swap_b32 v25, v27
v_smfmac_f32_16x16x64_bf16 v[28:31], v[68:71], a[216:223], v8
buffer_load_dwordx4 v[48:51], v2, s[4:7], s29 offen offset:3072
v_add_f32 v24, v24, v26
v_smfmac_f32_16x16x64_bf16 v[32:35], v[52:55], a[240:247], v8
v_add_f32 v25, v25, v27
v_smfmac_f32_16x16x64_bf16 v[32:35], v[56:59], a[248:255], v8
v_cvt_pk_bf16_f32 v24, v24, v25
v_smfmac_f32_16x16x64_bf16 v[32:35], v[60:63], v[120:127], v8
ds_write_b32 v3, v24 offset:2048
v_permlane32_swap_b32 v28, v30
v_smfmac_f32_16x16x64_bf16 v[32:35], v[64:67], v[128:135], v8
v_permlane32_swap_b32 v29, v31
v_smfmac_f32_16x16x64_bf16 v[32:35], v[68:71], v[136:143], v8
v_add_f32 v28, v28, v30
s_waitcnt lgkmcnt(0)
s_barrier
v_smfmac_f32_16x16x64_bf16 v[36:39], v[52:55], v[160:167], v8
ds_read_b64_tr_b16 v[16:17], v4
ds_read_b64_tr_b16 v[18:19], v4 offset:128
v_add_f32 v29, v29, v31
v_smfmac_f32_16x16x64_bf16 v[36:39], v[56:59], v[168:175], v8
ds_read_b64_tr_b16 v[20:21], v4 offset:1024
ds_read_b64_tr_b16 v[22:23], v4 offset:1152
v_cvt_pk_bf16_f32 v28, v28, v29
v_smfmac_f32_16x16x64_bf16 v[36:39], v[60:63], v[176:183], v8
ds_write_b32 v3, v28 offset:3072
v_permlane32_swap_b32 v32, v34
v_smfmac_f32_16x16x64_bf16 v[36:39], v[64:67], v[184:191], v8
v_permlane32_swap_b32 v33, v35
v_smfmac_f32_16x16x64_bf16 v[36:39], v[68:71], v[192:199], v8
ds_read_b64_tr_b16 v[24:25], v4 offset:2048
ds_read_b64_tr_b16 v[26:27], v4 offset:2176
v_add_f32 v32, v32, v34
v_smfmac_f32_16x16x64_bf16 v[40:43], v[52:55], v[216:223], v8
v_add_f32 v33, v33, v35
v_smfmac_f32_16x16x64_bf16 v[40:43], v[56:59], v[224:231], v8
v_cvt_pk_bf16_f32 v32, v32, v33
v_smfmac_f32_16x16x64_bf16 v[40:43], v[60:63], v[232:239], v8
ds_write_b32 v3, v32 offset:4096
v_permlane32_swap_b32 v36, v38
v_smfmac_f32_16x16x64_bf16 v[40:43], v[64:67], v[240:247], v8
v_permlane32_swap_b32 v37, v39
v_smfmac_f32_16x16x64_bf16 v[40:43], v[68:71], v[248:255], v8
v_add_f32 v36, v36, v38
s_waitcnt vmcnt(8)
s_waitcnt lgkmcnt(6)
v_smfmac_f32_16x16x64_bf16 v[12:15], v[16:19], v[72:79], v8 abid:1
v_add_f32 v37, v37, v39
s_waitcnt lgkmcnt(4)
v_smfmac_f32_16x16x64_bf16 v[12:15], v[20:23], v[80:87], v8 abid:1
v_cvt_pk_bf16_f32 v36, v36, v37
s_waitcnt lgkmcnt(1)
v_smfmac_f32_16x16x64_bf16 v[12:15], v[24:27], v[88:95], v8 abid:1
ds_write_b32 v3, v36 offset:5120
v_permlane32_swap_b32 v40, v42
v_permlane32_swap_b32 v41, v43
v_add_f32 v40, v40, v42
v_add_f32 v41, v41, v43
v_cvt_pk_bf16_f32 v40, v40, v41
ds_write_b32 v3, v40 offset:6144
s_waitcnt lgkmcnt(0)
s_barrier
ds_read_b64_tr_b16 v[28:29], v4 offset:3072
ds_read_b64_tr_b16 v[30:31], v4 offset:3200
ds_read_b64_tr_b16 v[32:33], v4 offset:4096
ds_read_b64_tr_b16 v[34:35], v4 offset:4224
ds_read_b64_tr_b16 v[36:37], v4 offset:5120
ds_read_b64_tr_b16 v[38:39], v4 offset:5248
ds_read_b64_tr_b16 v[40:41], v4 offset:6144
ds_read_b64_tr_b16 v[42:43], v4 offset:6272
s_waitcnt vmcnt(0)
s_waitcnt lgkmcnt(6)
v_smfmac_f32_16x16x64_bf16 v[12:15], v[28:31], v[96:103], v8 abid:1
s_waitcnt lgkmcnt(4)
v_smfmac_f32_16x16x64_bf16 v[12:15], v[32:35], v[104:111], v8 abid:1
s_waitcnt lgkmcnt(2)
v_smfmac_f32_16x16x64_bf16 v[12:15], v[36:39], v[112:119], v8 abid:1
s_waitcnt lgkmcnt(0)
v_smfmac_f32_16x16x64_bf16 v[12:15], v[40:43], v[44:51], v8 abid:1
s_nop 7
v_permlane32_swap_b32 v12, v14
v_permlane32_swap_b32 v13, v15
v_add_f32 v12, v12, v14
v_add_f32 v13, v13, v15
v_exp_f32 v16, v12
v_exp_f32 v17, v13
s_nop 0
v_add_f32_dpp v20, v16, v16 quad_perm:[1,0,3,2] row_mask:0xf bank_mask:0xf
v_add_f32_dpp v21, v17, v17 quad_perm:[1,0,3,2] row_mask:0xf bank_mask:0xf
v_cndmask_b32 v22, v16, v17, s[34:35]
v_add_f32_dpp v20, v20, v20 quad_perm:[2,3,0,1] row_mask:0xf bank_mask:0xf
v_add_f32_dpp v21, v21, v21 quad_perm:[2,3,0,1] row_mask:0xf bank_mask:0xf
v_mov_b32_dpp v23, v22 quad_perm:[1,0,3,2] row_mask:0xf bank_mask:0xf
v_add_f32_dpp v20, v20, v20 row_half_mirror row_mask:0xf bank_mask:0xf
v_add_f32_dpp v21, v21, v21 row_half_mirror row_mask:0xf bank_mask:0xf
s_nop 0
v_add_f32_dpp v20, v20, v20 row_mirror row_mask:0xf bank_mask:0xf
v_add_f32_dpp v21, v21, v21 row_mirror row_mask:0xf bank_mask:0xf
ds_write2_b32 v5, v20, v21 offset0:0 offset1:4
v_cndmask_b32 v18, v23, v16, s[34:35]
v_cndmask_b32 v19, v17, v23, s[34:35]
s_waitcnt lgkmcnt(0)
s_barrier
ds_read_b128 v[24:27], v6
s_waitcnt lgkmcnt(0)
v_add_f32 v20, v24, v25
v_add_f32 v20, v20, v26
v_rcp_f32 v24, v20
v_subrev_u32 v20, s32, v20
v_cmp_le_u32 vcc, s33, v20
v_pk_mul_f32 v[18:19], v[18:19], v[24:25] op_sel_hi:[1,0] clamp
v_cvt_pk_bf16_f32 v18, v18, v19
s_or_b64 s[40:41], vcc, s[30:31]
s_cbranch_scc1 Lrare_35
buffer_store_dword v18, v7, s[4:7], s27 offen
Lback_36:
s_add_u32 s26, s26, 7168
s_add_u32 s27, s27, 10240
s_add_u32 s28, s28, 28672
s_add_u32 s29, s29, 28672
s_add_u32 s25, s25, 1
s_cmp_lt_u32 s25, 63
s_cbranch_scc1 S1_STEP0
s_endpgm
Lrare_35:
s_cbranch_vccz Lready_37
s_nop 0
v_max_f32_dpp v20, v12, v12 quad_perm:[1,0,3,2] row_mask:0xf bank_mask:0xf
v_max_f32_dpp v21, v13, v13 quad_perm:[1,0,3,2] row_mask:0xf bank_mask:0xf
s_nop 0
v_max_f32_dpp v20, v20, v20 quad_perm:[2,3,0,1] row_mask:0xf bank_mask:0xf
v_max_f32_dpp v21, v21, v21 quad_perm:[2,3,0,1] row_mask:0xf bank_mask:0xf
s_nop 0
v_max_f32_dpp v20, v20, v20 row_half_mirror row_mask:0xf bank_mask:0xf
v_max_f32_dpp v21, v21, v21 row_half_mirror row_mask:0xf bank_mask:0xf
s_nop 0
v_max_f32_dpp v20, v20, v20 row_mirror row_mask:0xf bank_mask:0xf
v_max_f32_dpp v21, v21, v21 row_mirror row_mask:0xf bank_mask:0xf
ds_write2_b32 v5, v20, v21 offset0:112 offset1:116
s_waitcnt lgkmcnt(0)
s_barrier
ds_read_b128 v[24:27], v6 offset:448
s_waitcnt lgkmcnt(0)
v_max3_f32 v20, v24, v25, v26
s_nop 1
v_mov_b32_dpp v21, v20 quad_perm:[1,0,3,2] row_mask:0xf bank_mask:0xf
v_cndmask_b32 v22, v21, v20, s[34:35]
v_cndmask_b32 v23, v20, v21, s[34:35]
v_sub_f32 v12, v12, v22
v_sub_f32 v13, v13, v23
v_exp_f32 v16, v12
v_exp_f32 v17, v13
s_nop 0
v_add_f32_dpp v20, v16, v16 quad_perm:[1,0,3,2] row_mask:0xf bank_mask:0xf
v_add_f32_dpp v21, v17, v17 quad_perm:[1,0,3,2] row_mask:0xf bank_mask:0xf
v_cndmask_b32 v22, v16, v17, s[34:35]
v_add_f32_dpp v20, v20, v20 quad_perm:[2,3,0,1] row_mask:0xf bank_mask:0xf
v_add_f32_dpp v21, v21, v21 quad_perm:[2,3,0,1] row_mask:0xf bank_mask:0xf
v_mov_b32_dpp v23, v22 quad_perm:[1,0,3,2] row_mask:0xf bank_mask:0xf
v_add_f32_dpp v20, v20, v20 row_half_mirror row_mask:0xf bank_mask:0xf
v_add_f32_dpp v21, v21, v21 row_half_mirror row_mask:0xf bank_mask:0xf
s_nop 0
v_add_f32_dpp v20, v20, v20 row_mirror row_mask:0xf bank_mask:0xf
v_add_f32_dpp v21, v21, v21 row_mirror row_mask:0xf bank_mask:0xf
ds_write2_b32 v5, v20, v21 offset0:224 offset1:228
v_cndmask_b32 v18, v23, v16, s[34:35]
v_cndmask_b32 v19, v17, v23, s[34:35]
s_waitcnt lgkmcnt(0)
s_barrier
ds_read_b128 v[24:27], v6 offset:896
s_waitcnt lgkmcnt(0)
v_add_f32 v20, v24, v25
v_add_f32 v20, v20, v26
v_rcp_f32 v24, v20
s_nop 0
v_pk_mul_f32 v[18:19], v[18:19], v[24:25] op_sel_hi:[1,0] clamp
v_cvt_pk_bf16_f32 v18, v18, v19
Lready_37:
s_cmp_lg_u32 s23, 0
s_cbranch_scc1 Lwt_38
buffer_store_dword v18, v7, s[4:7], s27 offen
s_branch Lst_39
Lwt_38:
buffer_store_dword v18, v7, s[4:7], s27 offen sc1
Lst_39:
s_branch Lback_36
S1_W1:
v_lshlrev_b32 v1, 4, v0
s_sub_u32 s41, s97, 257
s_cmp_eq_u32 s41, s22
s_cbranch_scc1 Lknown_41
v_min_u32 v9, 6, v0
v_lshlrev_b32 v9, 2, v9
s_lshl_b32 s40, s22, 7
s_branch Lfirst_43
Lflag_42:
v_cmp_ne_u32 vcc, s88, v10
s_cbranch_vccz Lset_44
s_sleep 4
Lfirst_43:
buffer_load_dword v10, v9, s[4:7], s40 offen sc1
s_waitcnt vmcnt(0)
s_sub_u32 s24, s24, 1
s_cbranch_scc0 Lflag_42
s_endpgm
Lset_44:
Lknown_41:
s_mul_i32 s40, s22, 401408
s_add_u32 s40, s40, 9979904
s_and_b32 s41, s97, 255
s_sub_u32 s41, s41, 1
s_cmp_eq_u32 s41, s22
s_cbranch_scc1 Lheld_40
s_mov_b32 s41, s40
buffer_load_dwordx4 a[0:3], v1, s[4:7], s41 offen
buffer_load_dwordx4 a[4:7], v1, s[4:7], s41 offen offset:1024
buffer_load_dwordx4 a[8:11], v1, s[4:7], s41 offen offset:2048
buffer_load_dwordx4 a[12:15], v1, s[4:7], s41 offen offset:3072
s_add_u32 s41, s41, 4096
buffer_load_dwordx4 a[16:19], v1, s[4:7], s41 offen
buffer_load_dwordx4 a[20:23], v1, s[4:7], s41 offen offset:1024
buffer_load_dwordx4 a[24:27], v1, s[4:7], s41 offen offset:2048
buffer_load_dwordx4 a[28:31], v1, s[4:7], s41 offen offset:3072
s_add_u32 s41, s41, 4096
buffer_load_dwordx4 a[32:35], v1, s[4:7], s41 offen
buffer_load_dwordx4 a[36:39], v1, s[4:7], s41 offen offset:1024
buffer_load_dwordx4 a[40:43], v1, s[4:7], s41 offen offset:2048
buffer_load_dwordx4 a[44:47], v1, s[4:7], s41 offen offset:3072
s_add_u32 s41, s41, 4096
buffer_load_dwordx4 a[48:51], v1, s[4:7], s41 offen
buffer_load_dwordx4 a[52:55], v1, s[4:7], s41 offen offset:1024
buffer_load_dwordx4 a[56:59], v1, s[4:7], s41 offen offset:2048
buffer_load_dwordx4 a[60:63], v1, s[4:7], s41 offen offset:3072
s_add_u32 s41, s41, 4096
buffer_load_dwordx4 a[64:67], v1, s[4:7], s41 offen
buffer_load_dwordx4 a[68:71], v1, s[4:7], s41 offen offset:1024
buffer_load_dwordx4 a[72:75], v1, s[4:7], s41 offen offset:2048
buffer_load_dwordx4 a[76:79], v1, s[4:7], s41 offen offset:3072
s_add_u32 s41, s41, 4096
buffer_load_dwordx4 a[80:83], v1, s[4:7], s41 offen
buffer_load_dwordx4 a[84:87], v1, s[4:7], s41 offen offset:1024
buffer_load_dwordx4 a[88:91], v1, s[4:7], s41 offen offset:2048
buffer_load_dwordx4 a[92:95], v1, s[4:7], s41 offen offset:3072
s_add_u32 s41, s41, 4096
buffer_load_dwordx4 a[96:99], v1, s[4:7], s41 offen
buffer_load_dwordx4 a[100:103], v1, s[4:7], s41 offen offset:1024
buffer_load_dwordx4 a[104:107], v1, s[4:7], s41 offen offset:2048
buffer_load_dwordx4 a[108:111], v1, s[4:7], s41 offen offset:3072
s_add_u32 s41, s41, 4096
buffer_load_dwordx4 a[112:115], v1, s[4:7], s41 offen
buffer_load_dwordx4 a[116:119], v1, s[4:7], s41 offen offset:1024
buffer_load_dwordx4 a[120:123], v1, s[4:7], s41 offen offset:2048
buffer_load_dwordx4 a[124:127], v1, s[4:7], s41 offen offset:3072
s_add_u32 s41, s41, 4096
buffer_load_dwordx4 a[128:131], v1, s[4:7], s41 offen
buffer_load_dwordx4 a[132:135], v1, s[4:7], s41 offen offset:1024
buffer_load_dwordx4 a[136:139], v1, s[4:7], s41 offen offset:2048
buffer_load_dwordx4 a[140:143], v1, s[4:7], s41 offen offset:3072
s_add_u32 s41, s41, 4096
buffer_load_dwordx4 a[144:147], v1, s[4:7], s41 offen
buffer_load_dwordx4 a[148:151], v1, s[4:7], s41 offen offset:1024
buffer_load_dwordx4 a[152:155], v1, s[4:7], s41 offen offset:2048
buffer_load_dwordx4 a[156:159], v1, s[4:7], s41 offen offset:3072
s_add_u32 s41, s41, 4096
buffer_load_dwordx4 a[160:163], v1, s[4:7], s41 offen
buffer_load_dwordx4 a[164:167], v1, s[4:7], s41 offen offset:1024
buffer_load_dwordx4 a[168:171], v1, s[4:7], s41 offen offset:2048
buffer_load_dwordx4 a[172:175], v1, s[4:7], s41 offen offset:3072
s_add_u32 s41, s41, 4096
buffer_load_dwordx4 a[176:179], v1, s[4:7], s41 offen
buffer_load_dwordx4 a[180:183], v1, s[4:7], s41 offen offset:1024
buffer_load_dwordx4 a[184:187], v1, s[4:7], s41 offen offset:2048
buffer_load_dwordx4 a[188:191], v1, s[4:7], s41 offen offset:3072
s_add_u32 s41, s41, 4096
s_waitcnt vmcnt(40)
buffer_load_dwordx4 a[192:195], v1, s[4:7], s41 offen
buffer_load_dwordx4 a[196:199], v1, s[4:7], s41 offen offset:1024
buffer_load_dwordx4 a[200:203], v1, s[4:7], s41 offen offset:2048
buffer_load_dwordx4 a[204:207], v1, s[4:7], s41 offen offset:3072
s_add_u32 s41, s41, 4096
buffer_load_dwordx4 a[208:211], v1, s[4:7], s41 offen
buffer_load_dwordx4 a[212:215], v1, s[4:7], s41 offen offset:1024
buffer_load_dwordx4 a[216:219], v1, s[4:7], s41 offen offset:2048
buffer_load_dwordx4 a[220:223], v1, s[4:7], s41 offen offset:3072
s_waitcnt vmcnt(8)
Lheld_40:
s_add_u32 s40, s40, 57344
buffer_load_dwordx4 a[224:227], v1, s[4:7], s40 offen
buffer_load_dwordx4 a[228:231], v1, s[4:7], s40 offen offset:1024
buffer_load_dwordx4 a[232:235], v1, s[4:7], s40 offen offset:2048
buffer_load_dwordx4 a[236:239], v1, s[4:7], s40 offen offset:3072
s_add_u32 s40, s40, 4096
buffer_load_dwordx4 a[240:243], v1, s[4:7], s40 offen
buffer_load_dwordx4 a[244:247], v1, s[4:7], s40 offen offset:1024
buffer_load_dwordx4 a[248:251], v1, s[4:7], s40 offen offset:2048
buffer_load_dwordx4 a[252:255], v1, s[4:7], s40 offen offset:3072
s_add_u32 s40, s40, 4096
buffer_load_dwordx4 v[120:123], v1, s[4:7], s40 offen
buffer_load_dwordx4 v[124:127], v1, s[4:7], s40 offen offset:1024
buffer_load_dwordx4 v[128:131], v1, s[4:7], s40 offen offset:2048
buffer_load_dwordx4 v[132:135], v1, s[4:7], s40 offen offset:3072
s_add_u32 s40, s40, 4096
buffer_load_dwordx4 v[136:139], v1, s[4:7], s40 offen
buffer_load_dwordx4 v[140:143], v1, s[4:7], s40 offen offset:1024
buffer_load_dwordx4 v[144:147], v1, s[4:7], s40 offen offset:2048
buffer_load_dwordx4 v[148:151], v1, s[4:7], s40 offen offset:3072
s_add_u32 s40, s40, 4096
buffer_load_dwordx4 v[152:155], v1, s[4:7], s40 offen
buffer_load_dwordx4 v[156:159], v1, s[4:7], s40 offen offset:1024
buffer_load_dwordx4 v[160:163], v1, s[4:7], s40 offen offset:2048
buffer_load_dwordx4 v[164:167], v1, s[4:7], s40 offen offset:3072
s_add_u32 s40, s40, 4096
buffer_load_dwordx4 v[168:171], v1, s[4:7], s40 offen
buffer_load_dwordx4 v[172:175], v1, s[4:7], s40 offen offset:1024
buffer_load_dwordx4 v[176:179], v1, s[4:7], s40 offen offset:2048
buffer_load_dwordx4 v[180:183], v1, s[4:7], s40 offen offset:3072
s_add_u32 s40, s40, 4096
buffer_load_dwordx4 v[184:187], v1, s[4:7], s40 offen
buffer_load_dwordx4 v[188:191], v1, s[4:7], s40 offen offset:1024
buffer_load_dwordx4 v[192:195], v1, s[4:7], s40 offen offset:2048
buffer_load_dwordx4 v[196:199], v1, s[4:7], s40 offen offset:3072
s_add_u32 s40, s40, 4096
buffer_load_dwordx4 v[200:203], v1, s[4:7], s40 offen
buffer_load_dwordx4 v[204:207], v1, s[4:7], s40 offen offset:1024
buffer_load_dwordx4 v[208:211], v1, s[4:7], s40 offen offset:2048
buffer_load_dwordx4 v[212:215], v1, s[4:7], s40 offen offset:3072
s_add_u32 s40, s40, 4096
buffer_load_dwordx4 v[216:219], v1, s[4:7], s40 offen
buffer_load_dwordx4 v[220:223], v1, s[4:7], s40 offen offset:1024
buffer_load_dwordx4 v[224:227], v1, s[4:7], s40 offen offset:2048
buffer_load_dwordx4 v[228:231], v1, s[4:7], s40 offen offset:3072
s_add_u32 s40, s40, 4096
buffer_load_dwordx4 v[232:235], v1, s[4:7], s40 offen
buffer_load_dwordx4 v[236:239], v1, s[4:7], s40 offen offset:1024
buffer_load_dwordx4 v[240:243], v1, s[4:7], s40 offen offset:2048
buffer_load_dwordx4 v[244:247], v1, s[4:7], s40 offen offset:3072
s_add_u32 s40, s40, 4096
buffer_load_dwordx4 v[248:251], v1, s[4:7], s40 offen
buffer_load_dwordx4 v[252:255], v1, s[4:7], s40 offen offset:1024
v_and_b32 v9, 15, v0
v_lshrrev_b32 v10, 5, v0
v_mul_u32_u24 v2, 14, v10
v_bfe_u32 v10, v0, 4, 1
v_add_u32 v2, v2, v10
v_lshlrev_b32 v2, 8, v2
v_lshl_add_u32 v2, v9, 4, v2
v_bfe_u32 v7, v0, 5, 1
v_bfe_u32 v10, v0, 4, 1
v_lshl_add_u32 v7, v10, 1, v7
v_lshlrev_b32 v3, 2, v7
v_lshl_add_u32 v3, v9, 4, v3
v_add_u32 v3, 8448, v3
v_lshrrev_b32 v10, 4, v0
v_bfe_u32 v4, v0, 2, 2
v_lshl_add_u32 v4, v10, 3, v4
v_lshlrev_b32 v4, 5, v4
v_and_b32 v5, 3, v0
v_lshl_add_u32 v4, v5, 3, v4
v_add_u32 v4, 8192, v4
v_lshlrev_b32 v6, 5, v10
v_add_u32 v6, 16384, v6
v_cmp_eq_u32 vcc, 0, v9
v_add_u32 v10, 4, v6
v_lshlrev_b32 v5, 2, v0
v_add_u32 v5, 16512, v5
v_cndmask_b32 v5, v5, v10, vcc
v_and_b32 v10, 1, v0
v_cmp_eq_u32 s[34:35], 0, v10
v_lshl_add_u32 v6, v10, 4, v6
v_lshlrev_b32 v7, 5, v7
v_lshl_add_u32 v7, v10, 4, v7
v_bfe_u32 v10, v0, 3, 1
v_lshl_add_u32 v7, v10, 7, v7
v_and_b32 v10, 6, v0
v_lshl_add_u32 v7, v10, 1, v7
v_and_b32 v9, 8, v0
v_cmp_eq_u32 vcc, 0, v9
v_mov_b32 v9, 0x88884444
v_mov_b32 v8, 0xddddeeee
v_cndmask_b32 v8, v8, v9, vcc
s_mul_i32 s26, s23, 458752
s_add_u32 s26, s26, 178176
s_lshl_b32 s27, s22, 9
s_add_u32 s27, s27, 1093888
s_mov_b32 s30, s23
s_mov_b32 s31, 0
s_mov_b32 s32, 562036736
s_mov_b32 s33, 1342177280
s_mov_b32 s28, 6219776
s_add_u32 s29, s28, 7168
s_mov_b32 s25, 0
v_min_u32 v12, 55, v0
v_and_b32 v14, 3, v12
v_lshlrev_b32 v14, 3, v14
v_lshrrev_b32 v12, 2, v12
v_lshl_add_u32 v14, v12, 7, v14
s_mov_b32 s43, 4352
Llz_45:
buffer_load_dwordx2 v[12:13], v14, s[4:7], s43 offen sc1
s_waitcnt vmcnt(0)
v_cmp_ne_u32 vcc, s88, v12
v_cmp_ne_u32 s[40:41], s88, v13
s_or_b64 vcc, vcc, s[40:41]
s_cbranch_vccz Llzok_46
s_sleep 8
s_sub_u32 s24, s24, 1
s_cbranch_scc0 Llz_45
s_endpgm
Llzok_46:
.p2align 6
S1_STEP1:
s_waitcnt vmcnt(0)
s_nop 15
s_nop 7
buffer_load_dwordx4 v[52:55], v1, s[4:7], s26 offen sc1
buffer_load_dwordx4 v[56:59], v1, s[4:7], s26 offen offset:1024 sc1
v_mov_b32 v12, 0
v_mov_b32 v13, 0
v_mov_b32 v14, 0
v_mov_b32 v15, 0
v_mov_b32 v16, 0
v_mov_b32 v17, 0
v_mov_b32 v18, 0
v_mov_b32 v19, 0
v_mov_b32 v20, 0
v_mov_b32 v21, 0
v_mov_b32 v22, 0
v_mov_b32 v23, 0
v_mov_b32 v24, 0
v_mov_b32 v25, 0
v_mov_b32 v26, 0
v_mov_b32 v27, 0
v_mov_b32 v28, 0
v_mov_b32 v29, 0
v_mov_b32 v30, 0
v_mov_b32 v31, 0
v_mov_b32 v32, 0
v_mov_b32 v33, 0
v_mov_b32 v34, 0
v_mov_b32 v35, 0
v_mov_b32 v36, 0
v_mov_b32 v37, 0
v_mov_b32 v38, 0
v_mov_b32 v39, 0
v_mov_b32 v40, 0
v_mov_b32 v41, 0
v_mov_b32 v42, 0
v_mov_b32 v43, 0
Lspin_47:
buffer_load_dwordx4 v[52:55], v1, s[4:7], s26 offen sc1
buffer_load_dwordx4 v[56:59], v1, s[4:7], s26 offen offset:1024 sc1
s_sub_u32 s24, s24, 1
s_cbranch_scc1 CODE_END
s_waitcnt vmcnt(2)
v_max3_u32 v9, v52, v53, v54
v_max3_u32 v9, v9, v55, v56
v_max3_u32 v9, v9, v57, v58
v_max_u32 v9, v9, v59
v_cmp_eq_u32 vcc, -1, v9
ds_write_b128 v1, v[52:55] offset:2048
ds_write_b128 v1, v[56:59] offset:3072
s_cbranch_vccnz Lspin_47
v_smfmac_f32_16x16x64_bf16 v[16:19], v[52:55], a[16:23], v8
v_smfmac_f32_16x16x64_bf16 v[20:23], v[52:55], a[72:79], v8
v_smfmac_f32_16x16x64_bf16 v[24:27], v[52:55], a[128:135], v8
s_waitcnt lgkmcnt(0)
s_barrier
ds_read_b128 v[44:47], v1
v_smfmac_f32_16x16x64_bf16 v[28:31], v[52:55], a[184:191], v8
ds_read_b128 v[48:51], v1 offset:1024
v_smfmac_f32_16x16x64_bf16 v[32:35], v[52:55], a[240:247], v8
buffer_load_dwordx4 v[72:75], v2, s[4:7], s28 offen
ds_read_b128 v[60:63], v1 offset:4096
v_smfmac_f32_16x16x64_bf16 v[36:39], v[52:55], v[160:167], v8
ds_read_b128 v[64:67], v1 offset:5120
v_smfmac_f32_16x16x64_bf16 v[40:43], v[52:55], v[216:223], v8
buffer_load_dwordx4 v[76:79], v2, s[4:7], s29 offen
ds_read_b128 v[68:71], v1 offset:6144
v_smfmac_f32_16x16x64_bf16 v[16:19], v[56:59], a[24:31], v8
v_smfmac_f32_16x16x64_bf16 v[20:23], v[56:59], a[80:87], v8
buffer_load_dwordx4 v[80:83], v2, s[4:7], s28 offen offset:512
v_smfmac_f32_16x16x64_bf16 v[24:27], v[56:59], a[136:143], v8
v_smfmac_f32_16x16x64_bf16 v[28:31], v[56:59], a[192:199], v8
buffer_load_dwordx4 v[84:87], v2, s[4:7], s29 offen offset:512
v_smfmac_f32_16x16x64_bf16 v[32:35], v[56:59], a[248:255], v8
v_smfmac_f32_16x16x64_bf16 v[36:39], v[56:59], v[168:175], v8
buffer_load_dwordx4 v[88:91], v2, s[4:7], s28 offen offset:1024
v_smfmac_f32_16x16x64_bf16 v[40:43], v[56:59], v[224:231], v8
s_waitcnt lgkmcnt(4)
v_smfmac_f32_16x16x64_bf16 v[16:19], v[44:47], a[0:7], v8
buffer_load_dwordx4 v[92:95], v2, s[4:7], s29 offen offset:1024
s_waitcnt lgkmcnt(3)
v_smfmac_f32_16x16x64_bf16 v[16:19], v[48:51], a[8:15], v8
s_waitcnt lgkmcnt(2)
v_smfmac_f32_16x16x64_bf16 v[16:19], v[60:63], a[32:39], v8
buffer_load_dwordx4 v[96:99], v2, s[4:7], s28 offen offset:1536
s_waitcnt lgkmcnt(1)
v_smfmac_f32_16x16x64_bf16 v[16:19], v[64:67], a[40:47], v8
s_waitcnt lgkmcnt(0)
v_smfmac_f32_16x16x64_bf16 v[16:19], v[68:71], a[48:55], v8
buffer_load_dwordx4 v[100:103], v2, s[4:7], s29 offen offset:1536
v_smfmac_f32_16x16x64_bf16 v[20:23], v[44:47], a[56:63], v8
v_smfmac_f32_16x16x64_bf16 v[20:23], v[48:51], a[64:71], v8
buffer_load_dwordx4 v[104:107], v2, s[4:7], s28 offen offset:2048
v_smfmac_f32_16x16x64_bf16 v[20:23], v[60:63], a[88:95], v8
v_permlane32_swap_b32 v16, v18
v_smfmac_f32_16x16x64_bf16 v[20:23], v[64:67], a[96:103], v8
v_permlane32_swap_b32 v17, v19
v_smfmac_f32_16x16x64_bf16 v[20:23], v[68:71], a[104:111], v8
buffer_load_dwordx4 v[108:111], v2, s[4:7], s29 offen offset:2048
v_add_f32 v16, v16, v18
v_smfmac_f32_16x16x64_bf16 v[24:27], v[44:47], a[112:119], v8
v_add_f32 v17, v17, v19
v_smfmac_f32_16x16x64_bf16 v[24:27], v[48:51], a[120:127], v8
buffer_load_dwordx4 v[112:115], v2, s[4:7], s28 offen offset:2560
v_cvt_pk_bf16_f32 v16, v16, v17
v_smfmac_f32_16x16x64_bf16 v[24:27], v[60:63], a[144:151], v8
ds_write_b32 v3, v16
v_permlane32_swap_b32 v20, v22
v_smfmac_f32_16x16x64_bf16 v[24:27], v[64:67], a[152:159], v8
v_permlane32_swap_b32 v21, v23
v_smfmac_f32_16x16x64_bf16 v[24:27], v[68:71], a[160:167], v8
buffer_load_dwordx4 v[116:119], v2, s[4:7], s29 offen offset:2560
v_add_f32 v20, v20, v22
v_smfmac_f32_16x16x64_bf16 v[28:31], v[44:47], a[168:175], v8
v_add_f32 v21, v21, v23
v_smfmac_f32_16x16x64_bf16 v[28:31], v[48:51], a[176:183], v8
s_waitcnt vmcnt(12)
buffer_load_dwordx4 v[52:55], v2, s[4:7], s28 offen offset:3072
v_cvt_pk_bf16_f32 v20, v20, v21
v_smfmac_f32_16x16x64_bf16 v[28:31], v[60:63], a[200:207], v8
ds_write_b32 v3, v20 offset:1024
v_permlane32_swap_b32 v24, v26
v_smfmac_f32_16x16x64_bf16 v[28:31], v[64:67], a[208:215], v8
v_permlane32_swap_b32 v25, v27
v_smfmac_f32_16x16x64_bf16 v[28:31], v[68:71], a[216:223], v8
buffer_load_dwordx4 v[56:59], v2, s[4:7], s29 offen offset:3072
v_add_f32 v24, v24, v26
v_smfmac_f32_16x16x64_bf16 v[32:35], v[44:47], a[224:231], v8
v_add_f32 v25, v25, v27
v_smfmac_f32_16x16x64_bf16 v[32:35], v[48:51], a[232:239], v8
v_cvt_pk_bf16_f32 v24, v24, v25
v_smfmac_f32_16x16x64_bf16 v[32:35], v[60:63], v[120:127], v8
ds_write_b32 v3, v24 offset:2048
v_permlane32_swap_b32 v28, v30
v_smfmac_f32_16x16x64_bf16 v[32:35], v[64:67], v[128:135], v8
v_permlane32_swap_b32 v29, v31
v_smfmac_f32_16x16x64_bf16 v[32:35], v[68:71], v[136:143], v8
v_add_f32 v28, v28, v30
s_waitcnt lgkmcnt(0)
s_barrier
v_smfmac_f32_16x16x64_bf16 v[36:39], v[44:47], v[144:151], v8
ds_read_b64_tr_b16 v[16:17], v4
ds_read_b64_tr_b16 v[18:19], v4 offset:128
v_add_f32 v29, v29, v31
v_smfmac_f32_16x16x64_bf16 v[36:39], v[48:51], v[152:159], v8
ds_read_b64_tr_b16 v[20:21], v4 offset:1024
ds_read_b64_tr_b16 v[22:23], v4 offset:1152
v_cvt_pk_bf16_f32 v28, v28, v29
v_smfmac_f32_16x16x64_bf16 v[36:39], v[60:63], v[176:183], v8
ds_write_b32 v3, v28 offset:3072
v_permlane32_swap_b32 v32, v34
v_smfmac_f32_16x16x64_bf16 v[36:39], v[64:67], v[184:191], v8
v_permlane32_swap_b32 v33, v35
v_smfmac_f32_16x16x64_bf16 v[36:39], v[68:71], v[192:199], v8
ds_read_b64_tr_b16 v[24:25], v4 offset:2048
ds_read_b64_tr_b16 v[26:27], v4 offset:2176
v_add_f32 v32, v32, v34
v_smfmac_f32_16x16x64_bf16 v[40:43], v[44:47], v[200:207], v8
v_add_f32 v33, v33, v35
v_smfmac_f32_16x16x64_bf16 v[40:43], v[48:51], v[208:215], v8
v_cvt_pk_bf16_f32 v32, v32, v33
v_smfmac_f32_16x16x64_bf16 v[40:43], v[60:63], v[232:239], v8
ds_write_b32 v3, v32 offset:4096
v_permlane32_swap_b32 v36, v38
v_smfmac_f32_16x16x64_bf16 v[40:43], v[64:67], v[240:247], v8
v_permlane32_swap_b32 v37, v39
v_smfmac_f32_16x16x64_bf16 v[40:43], v[68:71], v[248:255], v8
v_add_f32 v36, v36, v38
s_waitcnt vmcnt(8)
s_waitcnt lgkmcnt(6)
v_smfmac_f32_16x16x64_bf16 v[12:15], v[16:19], v[72:79], v8 abid:1
v_add_f32 v37, v37, v39
s_waitcnt lgkmcnt(4)
v_smfmac_f32_16x16x64_bf16 v[12:15], v[20:23], v[80:87], v8 abid:1
v_cvt_pk_bf16_f32 v36, v36, v37
s_waitcnt lgkmcnt(1)
v_smfmac_f32_16x16x64_bf16 v[12:15], v[24:27], v[88:95], v8 abid:1
ds_write_b32 v3, v36 offset:5120
v_permlane32_swap_b32 v40, v42
v_permlane32_swap_b32 v41, v43
v_add_f32 v40, v40, v42
v_add_f32 v41, v41, v43
v_cvt_pk_bf16_f32 v40, v40, v41
ds_write_b32 v3, v40 offset:6144
s_waitcnt lgkmcnt(0)
s_barrier
ds_read_b64_tr_b16 v[28:29], v4 offset:3072
ds_read_b64_tr_b16 v[30:31], v4 offset:3200
ds_read_b64_tr_b16 v[32:33], v4 offset:4096
ds_read_b64_tr_b16 v[34:35], v4 offset:4224
ds_read_b64_tr_b16 v[36:37], v4 offset:5120
ds_read_b64_tr_b16 v[38:39], v4 offset:5248
ds_read_b64_tr_b16 v[40:41], v4 offset:6144
ds_read_b64_tr_b16 v[42:43], v4 offset:6272
s_waitcnt vmcnt(0)
s_waitcnt lgkmcnt(6)
v_smfmac_f32_16x16x64_bf16 v[12:15], v[28:31], v[96:103], v8 abid:1
s_waitcnt lgkmcnt(4)
v_smfmac_f32_16x16x64_bf16 v[12:15], v[32:35], v[104:111], v8 abid:1
s_waitcnt lgkmcnt(2)
v_smfmac_f32_16x16x64_bf16 v[12:15], v[36:39], v[112:119], v8 abid:1
s_waitcnt lgkmcnt(0)
v_smfmac_f32_16x16x64_bf16 v[12:15], v[40:43], v[52:59], v8 abid:1
s_nop 7
v_permlane32_swap_b32 v12, v14
v_permlane32_swap_b32 v13, v15
v_add_f32 v12, v12, v14
v_add_f32 v13, v13, v15
v_exp_f32 v16, v12
v_exp_f32 v17, v13
s_nop 0
v_add_f32_dpp v20, v16, v16 quad_perm:[1,0,3,2] row_mask:0xf bank_mask:0xf
v_add_f32_dpp v21, v17, v17 quad_perm:[1,0,3,2] row_mask:0xf bank_mask:0xf
v_cndmask_b32 v22, v16, v17, s[34:35]
v_add_f32_dpp v20, v20, v20 quad_perm:[2,3,0,1] row_mask:0xf bank_mask:0xf
v_add_f32_dpp v21, v21, v21 quad_perm:[2,3,0,1] row_mask:0xf bank_mask:0xf
v_mov_b32_dpp v23, v22 quad_perm:[1,0,3,2] row_mask:0xf bank_mask:0xf
v_add_f32_dpp v20, v20, v20 row_half_mirror row_mask:0xf bank_mask:0xf
v_add_f32_dpp v21, v21, v21 row_half_mirror row_mask:0xf bank_mask:0xf
s_nop 0
v_add_f32_dpp v20, v20, v20 row_mirror row_mask:0xf bank_mask:0xf
v_add_f32_dpp v21, v21, v21 row_mirror row_mask:0xf bank_mask:0xf
ds_write2_b32 v5, v20, v21 offset0:0 offset1:4
v_cndmask_b32 v18, v23, v16, s[34:35]
v_cndmask_b32 v19, v17, v23, s[34:35]
s_waitcnt lgkmcnt(0)
s_barrier
ds_read_b128 v[24:27], v6
s_waitcnt lgkmcnt(0)
v_add_f32 v20, v24, v25
v_add_f32 v20, v20, v26
v_rcp_f32 v24, v20
v_subrev_u32 v20, s32, v20
v_cmp_le_u32 vcc, s33, v20
v_pk_mul_f32 v[18:19], v[18:19], v[24:25] op_sel_hi:[1,0] clamp
v_cvt_pk_bf16_f32 v18, v18, v19
s_or_b64 s[40:41], vcc, s[30:31]
s_cbranch_scc1 Lrare_48
buffer_store_dword v18, v7, s[4:7], s27 offen
Lback_49:
s_add_u32 s26, s26, 7168
s_add_u32 s27, s27, 10240
s_add_u32 s28, s28, 28672
s_add_u32 s29, s29, 28672
s_add_u32 s25, s25, 1
s_cmp_lt_u32 s25, 63
s_cbranch_scc1 S1_STEP1
s_endpgm
Lrare_48:
s_cbranch_vccz Lready_50
s_nop 0
v_max_f32_dpp v20, v12, v12 quad_perm:[1,0,3,2] row_mask:0xf bank_mask:0xf
v_max_f32_dpp v21, v13, v13 quad_perm:[1,0,3,2] row_mask:0xf bank_mask:0xf
s_nop 0
v_max_f32_dpp v20, v20, v20 quad_perm:[2,3,0,1] row_mask:0xf bank_mask:0xf
v_max_f32_dpp v21, v21, v21 quad_perm:[2,3,0,1] row_mask:0xf bank_mask:0xf
s_nop 0
v_max_f32_dpp v20, v20, v20 row_half_mirror row_mask:0xf bank_mask:0xf
v_max_f32_dpp v21, v21, v21 row_half_mirror row_mask:0xf bank_mask:0xf
s_nop 0
v_max_f32_dpp v20, v20, v20 row_mirror row_mask:0xf bank_mask:0xf
v_max_f32_dpp v21, v21, v21 row_mirror row_mask:0xf bank_mask:0xf
ds_write2_b32 v5, v20, v21 offset0:112 offset1:116
s_waitcnt lgkmcnt(0)
s_barrier
ds_read_b128 v[24:27], v6 offset:448
s_waitcnt lgkmcnt(0)
v_max3_f32 v20, v24, v25, v26
s_nop 1
v_mov_b32_dpp v21, v20 quad_perm:[1,0,3,2] row_mask:0xf bank_mask:0xf
v_cndmask_b32 v22, v21, v20, s[34:35]
v_cndmask_b32 v23, v20, v21, s[34:35]
v_sub_f32 v12, v12, v22
v_sub_f32 v13, v13, v23
v_exp_f32 v16, v12
v_exp_f32 v17, v13
s_nop 0
v_add_f32_dpp v20, v16, v16 quad_perm:[1,0,3,2] row_mask:0xf bank_mask:0xf
v_add_f32_dpp v21, v17, v17 quad_perm:[1,0,3,2] row_mask:0xf bank_mask:0xf
v_cndmask_b32 v22, v16, v17, s[34:35]
v_add_f32_dpp v20, v20, v20 quad_perm:[2,3,0,1] row_mask:0xf bank_mask:0xf
v_add_f32_dpp v21, v21, v21 quad_perm:[2,3,0,1] row_mask:0xf bank_mask:0xf
v_mov_b32_dpp v23, v22 quad_perm:[1,0,3,2] row_mask:0xf bank_mask:0xf
v_add_f32_dpp v20, v20, v20 row_half_mirror row_mask:0xf bank_mask:0xf
v_add_f32_dpp v21, v21, v21 row_half_mirror row_mask:0xf bank_mask:0xf
s_nop 0
v_add_f32_dpp v20, v20, v20 row_mirror row_mask:0xf bank_mask:0xf
v_add_f32_dpp v21, v21, v21 row_mirror row_mask:0xf bank_mask:0xf
ds_write2_b32 v5, v20, v21 offset0:224 offset1:228
v_cndmask_b32 v18, v23, v16, s[34:35]
v_cndmask_b32 v19, v17, v23, s[34:35]
s_waitcnt lgkmcnt(0)
s_barrier
ds_read_b128 v[24:27], v6 offset:896
s_waitcnt lgkmcnt(0)
v_add_f32 v20, v24, v25
v_add_f32 v20, v20, v26
v_rcp_f32 v24, v20
s_nop 0
v_pk_mul_f32 v[18:19], v[18:19], v[24:25] op_sel_hi:[1,0] clamp
v_cvt_pk_bf16_f32 v18, v18, v19
Lready_50:
s_cmp_lg_u32 s23, 0
s_cbranch_scc1 Lwt_51
buffer_store_dword v18, v7, s[4:7], s27 offen
s_branch Lst_52
Lwt_51:
buffer_store_dword v18, v7, s[4:7], s27 offen sc1
Lst_52:
s_branch Lback_49
S1_W2:
v_lshlrev_b32 v1, 4, v0
s_sub_u32 s41, s97, 257
s_cmp_eq_u32 s41, s22
s_cbranch_scc1 Lknown_54
v_min_u32 v9, 6, v0
v_lshlrev_b32 v9, 2, v9
s_lshl_b32 s40, s22, 7
s_branch Lfirst_56
Lflag_55:
v_cmp_ne_u32 vcc, s88, v10
s_cbranch_vccz Lset_57
s_sleep 4
Lfirst_56:
buffer_load_dword v10, v9, s[4:7], s40 offen sc1
s_waitcnt vmcnt(0)
s_sub_u32 s24, s24, 1
s_cbranch_scc0 Lflag_55
s_endpgm
Lset_57:
Lknown_54:
s_mul_i32 s40, s22, 401408
s_add_u32 s40, s40, 10080256
s_and_b32 s41, s97, 255
s_sub_u32 s41, s41, 1
s_cmp_eq_u32 s41, s22
s_cbranch_scc1 Lheld_53
s_mov_b32 s41, s40
buffer_load_dwordx4 a[0:3], v1, s[4:7], s41 offen
buffer_load_dwordx4 a[4:7], v1, s[4:7], s41 offen offset:1024
buffer_load_dwordx4 a[8:11], v1, s[4:7], s41 offen offset:2048
buffer_load_dwordx4 a[12:15], v1, s[4:7], s41 offen offset:3072
s_add_u32 s41, s41, 4096
buffer_load_dwordx4 a[16:19], v1, s[4:7], s41 offen
buffer_load_dwordx4 a[20:23], v1, s[4:7], s41 offen offset:1024
buffer_load_dwordx4 a[24:27], v1, s[4:7], s41 offen offset:2048
buffer_load_dwordx4 a[28:31], v1, s[4:7], s41 offen offset:3072
s_add_u32 s41, s41, 4096
buffer_load_dwordx4 a[32:35], v1, s[4:7], s41 offen
buffer_load_dwordx4 a[36:39], v1, s[4:7], s41 offen offset:1024
buffer_load_dwordx4 a[40:43], v1, s[4:7], s41 offen offset:2048
buffer_load_dwordx4 a[44:47], v1, s[4:7], s41 offen offset:3072
s_add_u32 s41, s41, 4096
buffer_load_dwordx4 a[48:51], v1, s[4:7], s41 offen
buffer_load_dwordx4 a[52:55], v1, s[4:7], s41 offen offset:1024
buffer_load_dwordx4 a[56:59], v1, s[4:7], s41 offen offset:2048
buffer_load_dwordx4 a[60:63], v1, s[4:7], s41 offen offset:3072
s_add_u32 s41, s41, 4096
buffer_load_dwordx4 a[64:67], v1, s[4:7], s41 offen
buffer_load_dwordx4 a[68:71], v1, s[4:7], s41 offen offset:1024
buffer_load_dwordx4 a[72:75], v1, s[4:7], s41 offen offset:2048
buffer_load_dwordx4 a[76:79], v1, s[4:7], s41 offen offset:3072
s_add_u32 s41, s41, 4096
buffer_load_dwordx4 a[80:83], v1, s[4:7], s41 offen
buffer_load_dwordx4 a[84:87], v1, s[4:7], s41 offen offset:1024
buffer_load_dwordx4 a[88:91], v1, s[4:7], s41 offen offset:2048
buffer_load_dwordx4 a[92:95], v1, s[4:7], s41 offen offset:3072
s_add_u32 s41, s41, 4096
buffer_load_dwordx4 a[96:99], v1, s[4:7], s41 offen
buffer_load_dwordx4 a[100:103], v1, s[4:7], s41 offen offset:1024
buffer_load_dwordx4 a[104:107], v1, s[4:7], s41 offen offset:2048
buffer_load_dwordx4 a[108:111], v1, s[4:7], s41 offen offset:3072
s_add_u32 s41, s41, 4096
buffer_load_dwordx4 a[112:115], v1, s[4:7], s41 offen
buffer_load_dwordx4 a[116:119], v1, s[4:7], s41 offen offset:1024
buffer_load_dwordx4 a[120:123], v1, s[4:7], s41 offen offset:2048
buffer_load_dwordx4 a[124:127], v1, s[4:7], s41 offen offset:3072
s_add_u32 s41, s41, 4096
buffer_load_dwordx4 a[128:131], v1, s[4:7], s41 offen
buffer_load_dwordx4 a[132:135], v1, s[4:7], s41 offen offset:1024
buffer_load_dwordx4 a[136:139], v1, s[4:7], s41 offen offset:2048
buffer_load_dwordx4 a[140:143], v1, s[4:7], s41 offen offset:3072
s_add_u32 s41, s41, 4096
buffer_load_dwordx4 a[144:147], v1, s[4:7], s41 offen
buffer_load_dwordx4 a[148:151], v1, s[4:7], s41 offen offset:1024
buffer_load_dwordx4 a[152:155], v1, s[4:7], s41 offen offset:2048
buffer_load_dwordx4 a[156:159], v1, s[4:7], s41 offen offset:3072
s_add_u32 s41, s41, 4096
buffer_load_dwordx4 a[160:163], v1, s[4:7], s41 offen
buffer_load_dwordx4 a[164:167], v1, s[4:7], s41 offen offset:1024
buffer_load_dwordx4 a[168:171], v1, s[4:7], s41 offen offset:2048
buffer_load_dwordx4 a[172:175], v1, s[4:7], s41 offen offset:3072
s_add_u32 s41, s41, 4096
buffer_load_dwordx4 a[176:179], v1, s[4:7], s41 offen
buffer_load_dwordx4 a[180:183], v1, s[4:7], s41 offen offset:1024
buffer_load_dwordx4 a[184:187], v1, s[4:7], s41 offen offset:2048
buffer_load_dwordx4 a[188:191], v1, s[4:7], s41 offen offset:3072
s_add_u32 s41, s41, 4096
s_waitcnt vmcnt(40)
buffer_load_dwordx4 a[192:195], v1, s[4:7], s41 offen
buffer_load_dwordx4 a[196:199], v1, s[4:7], s41 offen offset:1024
buffer_load_dwordx4 a[200:203], v1, s[4:7], s41 offen offset:2048
buffer_load_dwordx4 a[204:207], v1, s[4:7], s41 offen offset:3072
s_add_u32 s41, s41, 4096
buffer_load_dwordx4 a[208:211], v1, s[4:7], s41 offen
buffer_load_dwordx4 a[212:215], v1, s[4:7], s41 offen offset:1024
buffer_load_dwordx4 a[216:219], v1, s[4:7], s41 offen offset:2048
buffer_load_dwordx4 a[220:223], v1, s[4:7], s41 offen offset:3072
s_waitcnt vmcnt(8)
Lheld_53:
s_add_u32 s40, s40, 57344
buffer_load_dwordx4 a[224:227], v1, s[4:7], s40 offen
buffer_load_dwordx4 a[228:231], v1, s[4:7], s40 offen offset:1024
buffer_load_dwordx4 a[232:235], v1, s[4:7], s40 offen offset:2048
buffer_load_dwordx4 a[236:239], v1, s[4:7], s40 offen offset:3072
s_add_u32 s40, s40, 4096
buffer_load_dwordx4 a[240:243], v1, s[4:7], s40 offen
buffer_load_dwordx4 a[244:247], v1, s[4:7], s40 offen offset:1024
buffer_load_dwordx4 a[248:251], v1, s[4:7], s40 offen offset:2048
buffer_load_dwordx4 a[252:255], v1, s[4:7], s40 offen offset:3072
s_add_u32 s40, s40, 4096
buffer_load_dwordx4 v[120:123], v1, s[4:7], s40 offen
buffer_load_dwordx4 v[124:127], v1, s[4:7], s40 offen offset:1024
buffer_load_dwordx4 v[128:131], v1, s[4:7], s40 offen offset:2048
buffer_load_dwordx4 v[132:135], v1, s[4:7], s40 offen offset:3072
s_add_u32 s40, s40, 4096
buffer_load_dwordx4 v[136:139], v1, s[4:7], s40 offen
buffer_load_dwordx4 v[140:143], v1, s[4:7], s40 offen offset:1024
buffer_load_dwordx4 v[144:147], v1, s[4:7], s40 offen offset:2048
buffer_load_dwordx4 v[148:151], v1, s[4:7], s40 offen offset:3072
s_add_u32 s40, s40, 4096
buffer_load_dwordx4 v[152:155], v1, s[4:7], s40 offen
buffer_load_dwordx4 v[156:159], v1, s[4:7], s40 offen offset:1024
buffer_load_dwordx4 v[160:163], v1, s[4:7], s40 offen offset:2048
buffer_load_dwordx4 v[164:167], v1, s[4:7], s40 offen offset:3072
s_add_u32 s40, s40, 4096
buffer_load_dwordx4 v[168:171], v1, s[4:7], s40 offen
buffer_load_dwordx4 v[172:175], v1, s[4:7], s40 offen offset:1024
buffer_load_dwordx4 v[176:179], v1, s[4:7], s40 offen offset:2048
buffer_load_dwordx4 v[180:183], v1, s[4:7], s40 offen offset:3072
s_add_u32 s40, s40, 4096
buffer_load_dwordx4 v[184:187], v1, s[4:7], s40 offen
buffer_load_dwordx4 v[188:191], v1, s[4:7], s40 offen offset:1024
buffer_load_dwordx4 v[192:195], v1, s[4:7], s40 offen offset:2048
buffer_load_dwordx4 v[196:199], v1, s[4:7], s40 offen offset:3072
s_add_u32 s40, s40, 4096
buffer_load_dwordx4 v[200:203], v1, s[4:7], s40 offen
buffer_load_dwordx4 v[204:207], v1, s[4:7], s40 offen offset:1024
buffer_load_dwordx4 v[208:211], v1, s[4:7], s40 offen offset:2048
buffer_load_dwordx4 v[212:215], v1, s[4:7], s40 offen offset:3072
s_add_u32 s40, s40, 4096
buffer_load_dwordx4 v[216:219], v1, s[4:7], s40 offen
buffer_load_dwordx4 v[220:223], v1, s[4:7], s40 offen offset:1024
buffer_load_dwordx4 v[224:227], v1, s[4:7], s40 offen offset:2048
buffer_load_dwordx4 v[228:231], v1, s[4:7], s40 offen offset:3072
s_add_u32 s40, s40, 4096
buffer_load_dwordx4 v[232:235], v1, s[4:7], s40 offen
buffer_load_dwordx4 v[236:239], v1, s[4:7], s40 offen offset:1024
buffer_load_dwordx4 v[240:243], v1, s[4:7], s40 offen offset:2048
buffer_load_dwordx4 v[244:247], v1, s[4:7], s40 offen offset:3072
s_add_u32 s40, s40, 4096
buffer_load_dwordx4 v[248:251], v1, s[4:7], s40 offen
buffer_load_dwordx4 v[252:255], v1, s[4:7], s40 offen offset:1024
v_and_b32 v9, 15, v0
v_lshrrev_b32 v10, 5, v0
v_mul_u32_u24 v2, 14, v10
v_bfe_u32 v10, v0, 4, 1
v_add_u32 v2, v2, v10
v_and_b32 v10, 7, v0
v_lshlrev_b32 v10, 4, v10
v_lshl_add_u32 v2, v2, 7, v10
v_bfe_u32 v7, v0, 5, 1
v_bfe_u32 v10, v0, 4, 1
v_lshl_add_u32 v7, v10, 1, v7
v_lshlrev_b32 v3, 2, v7
v_lshl_add_u32 v3, v9, 4, v3
v_add_u32 v3, 8704, v3
v_lshrrev_b32 v10, 4, v0
v_bfe_u32 v4, v0, 2, 2
v_lshl_add_u32 v4, v10, 3, v4
v_lshlrev_b32 v4, 5, v4
v_and_b32 v5, 3, v0
v_lshl_add_u32 v4, v5, 3, v4
v_add_u32 v4, 8192, v4
v_lshlrev_b32 v6, 5, v10
v_add_u32 v6, 16384, v6
v_cmp_eq_u32 vcc, 0, v9
v_add_u32 v10, 8, v6
v_lshlrev_b32 v5, 2, v0
v_add_u32 v5, 16512, v5
v_cndmask_b32 v5, v5, v10, vcc
v_and_b32 v10, 1, v0
v_cmp_eq_u32 s[34:35], 0, v10
v_lshl_add_u32 v6, v10, 4, v6
v_lshlrev_b32 v7, 5, v7
v_lshl_add_u32 v7, v10, 4, v7
v_bfe_u32 v10, v0, 1, 1
v_lshl_add_u32 v7, v10, 7, v7
v_bfe_u32 v10, v0, 2, 1
v_lshl_add_u32 v7, v10, 3, v7
v_bfe_u32 v10, v0, 3, 1
v_lshlrev_b32 v10, 30, v10
v_or_b32 v7, v7, v10
v_and_b32 v9, 8, v0
v_cmp_eq_u32 vcc, 0, v9
v_mov_b32 v9, 0x88884444
v_mov_b32 v8, 0xddddeeee
v_cndmask_b32 v8, v8, v9, vcc
s_mul_i32 s26, s23, 458752
s_add_u32 s26, s26, 180224
s_lshr_b32 s27, s22, 1
s_lshl_b32 s27, s27, 8
s_and_b32 s40, s22, 1
s_lshl_b32 s40, s40, 2
s_add_u32 s27, s27, s40
s_add_u32 s27, s27, 1101824
s_mov_b32 s30, s23
s_mov_b32 s31, 0
s_mov_b32 s32, 562036736
s_mov_b32 s33, 1342177280
s_mov_b32 s28, 6205440
s_add_u32 s29, s28, 7168
s_mov_b32 s25, 0
v_min_u32 v12, 55, v0
v_and_b32 v14, 3, v12
v_lshlrev_b32 v14, 3, v14
v_lshrrev_b32 v12, 2, v12
v_lshl_add_u32 v14, v12, 7, v14
s_mov_b32 s43, 4352
Llz_58:
buffer_load_dwordx2 v[12:13], v14, s[4:7], s43 offen sc1
s_waitcnt vmcnt(0)
v_cmp_ne_u32 vcc, s88, v12
v_cmp_ne_u32 s[40:41], s88, v13
s_or_b64 vcc, vcc, s[40:41]
s_cbranch_vccz Llzok_59
s_sleep 8
s_sub_u32 s24, s24, 1
s_cbranch_scc0 Llz_58
s_endpgm
Llzok_59:
.p2align 6
S1_STEP2:
s_waitcnt vmcnt(0)
s_nop 15
s_nop 7
buffer_load_dwordx4 v[60:63], v1, s[4:7], s26 offen sc1
buffer_load_dwordx4 v[64:67], v1, s[4:7], s26 offen offset:1024 sc1
v_mov_b32 v12, 0
v_mov_b32 v13, 0
v_mov_b32 v14, 0
v_mov_b32 v15, 0
v_mov_b32 v16, 0
v_mov_b32 v17, 0
v_mov_b32 v18, 0
v_mov_b32 v19, 0
v_mov_b32 v20, 0
v_mov_b32 v21, 0
v_mov_b32 v22, 0
v_mov_b32 v23, 0
v_mov_b32 v24, 0
v_mov_b32 v25, 0
v_mov_b32 v26, 0
v_mov_b32 v27, 0
v_mov_b32 v28, 0
v_mov_b32 v29, 0
v_mov_b32 v30, 0
v_mov_b32 v31, 0
v_mov_b32 v32, 0
v_mov_b32 v33, 0
v_mov_b32 v34, 0
v_mov_b32 v35, 0
v_mov_b32 v36, 0
v_mov_b32 v37, 0
v_mov_b32 v38, 0
v_mov_b32 v39, 0
v_mov_b32 v40, 0
v_mov_b32 v41, 0
v_mov_b32 v42, 0
v_mov_b32 v43, 0
Lspin_60:
buffer_load_dwordx4 v[60:63], v1, s[4:7], s26 offen sc1
buffer_load_dwordx4 v[64:67], v1, s[4:7], s26 offen offset:1024 sc1
s_sub_u32 s24, s24, 1
s_cbranch_scc1 CODE_END
s_waitcnt vmcnt(2)
v_max3_u32 v9, v60, v61, v62
v_max3_u32 v9, v9, v63, v64
v_max3_u32 v9, v9, v65, v66
v_max_u32 v9, v9, v67
v_cmp_eq_u32 vcc, -1, v9
ds_write_b128 v1, v[60:63] offset:4096
ds_write_b128 v1, v[64:67] offset:5120
s_cbranch_vccnz Lspin_60
v_smfmac_f32_16x16x64_bf16 v[16:19], v[60:63], a[32:39], v8
v_smfmac_f32_16x16x64_bf16 v[20:23], v[60:63], a[88:95], v8
v_smfmac_f32_16x16x64_bf16 v[24:27], v[60:63], a[144:151], v8
s_waitcnt lgkmcnt(0)
s_barrier
ds_read_b128 v[44:47], v1
v_smfmac_f32_16x16x64_bf16 v[28:31], v[60:63], a[200:207], v8
ds_read_b128 v[48:51], v1 offset:1024
v_smfmac_f32_16x16x64_bf16 v[32:35], v[60:63], v[120:127], v8
ds_read_b128 v[52:55], v1 offset:2048
v_smfmac_f32_16x16x64_bf16 v[36:39], v[60:63], v[176:183], v8
ds_read_b128 v[56:59], v1 offset:3072
v_smfmac_f32_16x16x64_bf16 v[40:43], v[60:63], v[232:239], v8
ds_read_b128 v[68:71], v1 offset:6144
v_smfmac_f32_16x16x64_bf16 v[16:19], v[64:67], a[40:47], v8
v_smfmac_f32_16x16x64_bf16 v[20:23], v[64:67], a[96:103], v8
ds_read_b128 v[72:75], v2
v_smfmac_f32_16x16x64_bf16 v[24:27], v[64:67], a[152:159], v8
ds_read_b128 v[76:79], v2 offset:3584
v_smfmac_f32_16x16x64_bf16 v[28:31], v[64:67], a[208:215], v8
ds_read_b128 v[80:83], v2 offset:256
v_smfmac_f32_16x16x64_bf16 v[32:35], v[64:67], v[128:135], v8
ds_read_b128 v[84:87], v2 offset:3840
v_smfmac_f32_16x16x64_bf16 v[36:39], v[64:67], v[184:191], v8
ds_read_b128 v[88:91], v2 offset:512
v_smfmac_f32_16x16x64_bf16 v[40:43], v[64:67], v[240:247], v8
ds_read_b128 v[92:95], v2 offset:4096
s_waitcnt lgkmcnt(10)
v_smfmac_f32_16x16x64_bf16 v[16:19], v[44:47], a[0:7], v8
ds_read_b128 v[96:99], v2 offset:768
s_waitcnt lgkmcnt(10)
v_smfmac_f32_16x16x64_bf16 v[16:19], v[48:51], a[8:15], v8
ds_read_b128 v[100:103], v2 offset:4352
s_waitcnt lgkmcnt(10)
v_smfmac_f32_16x16x64_bf16 v[16:19], v[52:55], a[16:23], v8
ds_read_b128 v[104:107], v2 offset:1024
s_waitcnt lgkmcnt(10)
v_smfmac_f32_16x16x64_bf16 v[16:19], v[56:59], a[24:31], v8
ds_read_b128 v[108:111], v2 offset:4608
s_waitcnt lgkmcnt(10)
v_smfmac_f32_16x16x64_bf16 v[16:19], v[68:71], a[48:55], v8
ds_read_b128 v[112:115], v2 offset:1280
v_smfmac_f32_16x16x64_bf16 v[20:23], v[44:47], a[56:63], v8
ds_read_b128 v[116:119], v2 offset:4864
v_smfmac_f32_16x16x64_bf16 v[20:23], v[48:51], a[64:71], v8
v_smfmac_f32_16x16x64_bf16 v[20:23], v[52:55], a[72:79], v8
v_permlane32_swap_b32 v16, v18
v_smfmac_f32_16x16x64_bf16 v[20:23], v[56:59], a[80:87], v8
v_permlane32_swap_b32 v17, v19
v_smfmac_f32_16x16x64_bf16 v[20:23], v[68:71], a[104:111], v8
s_waitcnt vmcnt(0)
ds_read_b128 v[60:63], v2 offset:1536
v_add_f32 v16, v16, v18
v_smfmac_f32_16x16x64_bf16 v[24:27], v[44:47], a[112:119], v8
v_add_f32 v17, v17, v19
v_smfmac_f32_16x16x64_bf16 v[24:27], v[48:51], a[120:127], v8
ds_read_b128 v[64:67], v2 offset:5120
v_cvt_pk_bf16_f32 v16, v16, v17
v_smfmac_f32_16x16x64_bf16 v[24:27], v[52:55], a[128:135], v8
ds_write_b32 v3, v16
v_permlane32_swap_b32 v20, v22
v_smfmac_f32_16x16x64_bf16 v[24:27], v[56:59], a[136:143], v8
v_permlane32_swap_b32 v21, v23
v_smfmac_f32_16x16x64_bf16 v[24:27], v[68:71], a[160:167], v8
v_add_f32 v20, v20, v22
v_smfmac_f32_16x16x64_bf16 v[28:31], v[44:47], a[168:175], v8
v_add_f32 v21, v21, v23
v_smfmac_f32_16x16x64_bf16 v[28:31], v[48:51], a[176:183], v8
v_cvt_pk_bf16_f32 v20, v20, v21
v_smfmac_f32_16x16x64_bf16 v[28:31], v[52:55], a[184:191], v8
ds_write_b32 v3, v20 offset:1024
v_permlane32_swap_b32 v24, v26
v_smfmac_f32_16x16x64_bf16 v[28:31], v[56:59], a[192:199], v8
v_permlane32_swap_b32 v25, v27
v_smfmac_f32_16x16x64_bf16 v[28:31], v[68:71], a[216:223], v8
v_add_f32 v24, v24, v26
v_smfmac_f32_16x16x64_bf16 v[32:35], v[44:47], a[224:231], v8
v_add_f32 v25, v25, v27
v_smfmac_f32_16x16x64_bf16 v[32:35], v[48:51], a[232:239], v8
v_cvt_pk_bf16_f32 v24, v24, v25
v_smfmac_f32_16x16x64_bf16 v[32:35], v[52:55], a[240:247], v8
ds_write_b32 v3, v24 offset:2048
v_permlane32_swap_b32 v28, v30
v_smfmac_f32_16x16x64_bf16 v[32:35], v[56:59], a[248:255], v8
v_permlane32_swap_b32 v29, v31
v_smfmac_f32_16x16x64_bf16 v[32:35], v[68:71], v[136:143], v8
v_add_f32 v28, v28, v30
s_waitcnt lgkmcnt(0)
s_barrier
v_smfmac_f32_16x16x64_bf16 v[36:39], v[44:47], v[144:151], v8
ds_read_b64_tr_b16 v[16:17], v4
ds_read_b64_tr_b16 v[18:19], v4 offset:128
v_add_f32 v29, v29, v31
v_smfmac_f32_16x16x64_bf16 v[36:39], v[48:51], v[152:159], v8
ds_read_b64_tr_b16 v[20:21], v4 offset:1024
ds_read_b64_tr_b16 v[22:23], v4 offset:1152
v_cvt_pk_bf16_f32 v28, v28, v29
v_smfmac_f32_16x16x64_bf16 v[36:39], v[52:55], v[160:167], v8
ds_write_b32 v3, v28 offset:3072
v_permlane32_swap_b32 v32, v34
v_smfmac_f32_16x16x64_bf16 v[36:39], v[56:59], v[168:175], v8
v_permlane32_swap_b32 v33, v35
v_smfmac_f32_16x16x64_bf16 v[36:39], v[68:71], v[192:199], v8
ds_read_b64_tr_b16 v[24:25], v4 offset:2048
ds_read_b64_tr_b16 v[26:27], v4 offset:2176
v_add_f32 v32, v32, v34
v_smfmac_f32_16x16x64_bf16 v[40:43], v[44:47], v[200:207], v8
v_add_f32 v33, v33, v35
v_smfmac_f32_16x16x64_bf16 v[40:43], v[48:51], v[208:215], v8
v_cvt_pk_bf16_f32 v32, v32, v33
v_smfmac_f32_16x16x64_bf16 v[40:43], v[52:55], v[216:223], v8
ds_write_b32 v3, v32 offset:4096
v_permlane32_swap_b32 v36, v38
v_smfmac_f32_16x16x64_bf16 v[40:43], v[56:59], v[224:231], v8
v_permlane32_swap_b32 v37, v39
v_smfmac_f32_16x16x64_bf16 v[40:43], v[68:71], v[248:255], v8
v_add_f32 v36, v36, v38
s_waitcnt lgkmcnt(6)
v_smfmac_f32_16x16x64_bf16 v[12:15], v[16:19], v[72:79], v8 abid:1
v_add_f32 v37, v37, v39
s_waitcnt lgkmcnt(4)
v_smfmac_f32_16x16x64_bf16 v[12:15], v[20:23], v[80:87], v8 abid:1
v_cvt_pk_bf16_f32 v36, v36, v37
s_waitcnt lgkmcnt(1)
v_smfmac_f32_16x16x64_bf16 v[12:15], v[24:27], v[88:95], v8 abid:1
ds_write_b32 v3, v36 offset:5120
v_permlane32_swap_b32 v40, v42
v_permlane32_swap_b32 v41, v43
v_add_f32 v40, v40, v42
v_add_f32 v41, v41, v43
v_cvt_pk_bf16_f32 v40, v40, v41
ds_write_b32 v3, v40 offset:6144
s_waitcnt lgkmcnt(0)
s_barrier
ds_read_b64_tr_b16 v[28:29], v4 offset:3072
ds_read_b64_tr_b16 v[30:31], v4 offset:3200
ds_read_b64_tr_b16 v[32:33], v4 offset:4096
ds_read_b64_tr_b16 v[34:35], v4 offset:4224
ds_read_b64_tr_b16 v[36:37], v4 offset:5120
ds_read_b64_tr_b16 v[38:39], v4 offset:5248
ds_read_b64_tr_b16 v[40:41], v4 offset:6144
ds_read_b64_tr_b16 v[42:43], v4 offset:6272
s_waitcnt lgkmcnt(6)
v_smfmac_f32_16x16x64_bf16 v[12:15], v[28:31], v[96:103], v8 abid:1
s_waitcnt lgkmcnt(4)
v_smfmac_f32_16x16x64_bf16 v[12:15], v[32:35], v[104:111], v8 abid:1
s_waitcnt lgkmcnt(2)
v_smfmac_f32_16x16x64_bf16 v[12:15], v[36:39], v[112:119], v8 abid:1
s_waitcnt lgkmcnt(0)
v_smfmac_f32_16x16x64_bf16 v[12:15], v[40:43], v[60:67], v8 abid:1
s_nop 7
v_permlane32_swap_b32 v12, v14
v_permlane32_swap_b32 v13, v15
v_add_f32 v12, v12, v14
v_add_f32 v13, v13, v15
v_exp_f32 v16, v12
v_exp_f32 v17, v13
s_nop 0
v_add_f32_dpp v20, v16, v16 quad_perm:[1,0,3,2] row_mask:0xf bank_mask:0xf
v_add_f32_dpp v21, v17, v17 quad_perm:[1,0,3,2] row_mask:0xf bank_mask:0xf
v_cndmask_b32 v22, v16, v17, s[34:35]
v_add_f32_dpp v20, v20, v20 quad_perm:[2,3,0,1] row_mask:0xf bank_mask:0xf
v_add_f32_dpp v21, v21, v21 quad_perm:[2,3,0,1] row_mask:0xf bank_mask:0xf
v_mov_b32_dpp v23, v22 quad_perm:[1,0,3,2] row_mask:0xf bank_mask:0xf
v_add_f32_dpp v20, v20, v20 row_half_mirror row_mask:0xf bank_mask:0xf
v_add_f32_dpp v21, v21, v21 row_half_mirror row_mask:0xf bank_mask:0xf
ds_write2_b32 v5, v20, v21 offset0:0 offset1:4
v_cndmask_b32 v18, v23, v16, s[34:35]
v_cndmask_b32 v19, v17, v23, s[34:35]
s_waitcnt lgkmcnt(0)
s_barrier
ds_read_b128 v[24:27], v6
s_waitcnt lgkmcnt(0)
v_add_f32 v20, v24, v25
v_add_f32 v20, v20, v26
v_rcp_f32 v24, v20
v_subrev_u32 v20, s32, v20
v_cmp_le_u32 vcc, s33, v20
v_pk_mul_f32 v[18:19], v[18:19], v[24:25] op_sel_hi:[1,0] clamp
v_cvt_pk_bf16_f32 v18, v18, v19
s_or_b64 s[40:41], vcc, s[30:31]
s_cbranch_scc1 Lrare_61
buffer_store_dword v18, v7, s[4:7], s27 offen
Lback_62:
s_add_u32 s26, s26, 7168
s_add_u32 s27, s27, 10240
s_add_u32 s28, s28, 28672
s_add_u32 s29, s29, 28672
s_add_u32 s25, s25, 1
s_cmp_lt_u32 s25, 63
s_cbranch_scc1 S1_STEP2
s_endpgm
Lrare_61:
s_cbranch_vccz Lready_63
s_nop 0
v_max_f32_dpp v20, v12, v12 quad_perm:[1,0,3,2] row_mask:0xf bank_mask:0xf
v_max_f32_dpp v21, v13, v13 quad_perm:[1,0,3,2] row_mask:0xf bank_mask:0xf
s_nop 0
v_max_f32_dpp v20, v20, v20 quad_perm:[2,3,0,1] row_mask:0xf bank_mask:0xf
v_max_f32_dpp v21, v21, v21 quad_perm:[2,3,0,1] row_mask:0xf bank_mask:0xf
s_nop 0
v_max_f32_dpp v20, v20, v20 row_half_mirror row_mask:0xf bank_mask:0xf
v_max_f32_dpp v21, v21, v21 row_half_mirror row_mask:0xf bank_mask:0xf
ds_write2_b32 v5, v20, v21 offset0:112 offset1:116
s_waitcnt lgkmcnt(0)
s_barrier
ds_read_b128 v[24:27], v6 offset:448
s_waitcnt lgkmcnt(0)
v_max3_f32 v20, v24, v25, v26
s_nop 1
v_mov_b32_dpp v21, v20 quad_perm:[1,0,3,2] row_mask:0xf bank_mask:0xf
v_cndmask_b32 v22, v21, v20, s[34:35]
v_cndmask_b32 v23, v20, v21, s[34:35]
v_sub_f32 v12, v12, v22
v_sub_f32 v13, v13, v23
v_exp_f32 v16, v12
v_exp_f32 v17, v13
s_nop 0
v_add_f32_dpp v20, v16, v16 quad_perm:[1,0,3,2] row_mask:0xf bank_mask:0xf
v_add_f32_dpp v21, v17, v17 quad_perm:[1,0,3,2] row_mask:0xf bank_mask:0xf
v_cndmask_b32 v22, v16, v17, s[34:35]
v_add_f32_dpp v20, v20, v20 quad_perm:[2,3,0,1] row_mask:0xf bank_mask:0xf
v_add_f32_dpp v21, v21, v21 quad_perm:[2,3,0,1] row_mask:0xf bank_mask:0xf
v_mov_b32_dpp v23, v22 quad_perm:[1,0,3,2] row_mask:0xf bank_mask:0xf
v_add_f32_dpp v20, v20, v20 row_half_mirror row_mask:0xf bank_mask:0xf
v_add_f32_dpp v21, v21, v21 row_half_mirror row_mask:0xf bank_mask:0xf
ds_write2_b32 v5, v20, v21 offset0:224 offset1:228
v_cndmask_b32 v18, v23, v16, s[34:35]
v_cndmask_b32 v19, v17, v23, s[34:35]
s_waitcnt lgkmcnt(0)
s_barrier
ds_read_b128 v[24:27], v6 offset:896
s_waitcnt lgkmcnt(0)
v_add_f32 v20, v24, v25
v_add_f32 v20, v20, v26
v_rcp_f32 v24, v20
s_nop 0
v_pk_mul_f32 v[18:19], v[18:19], v[24:25] op_sel_hi:[1,0] clamp
v_cvt_pk_bf16_f32 v18, v18, v19
Lready_63:
s_cmp_lg_u32 s23, 0
s_cbranch_scc1 Lwt_64
buffer_store_dword v18, v7, s[4:7], s27 offen
s_branch Lst_65
Lwt_64:
buffer_store_dword v18, v7, s[4:7], s27 offen sc1
Lst_65:
s_branch Lback_62
S1_W3:
v_lshlrev_b32 v1, 4, v0
s_sub_u32 s41, s97, 257
s_cmp_eq_u32 s41, s22
s_cbranch_scc1 Lknown_67
v_min_u32 v9, 6, v0
v_lshlrev_b32 v9, 2, v9
s_lshl_b32 s40, s22, 7
s_branch Lfirst_69
Lflag_68:
v_cmp_ne_u32 vcc, s88, v10
s_cbranch_vccz Lset_70
s_sleep 4
Lfirst_69:
buffer_load_dword v10, v9, s[4:7], s40 offen sc1
s_waitcnt vmcnt(0)
s_sub_u32 s24, s24, 1
s_cbranch_scc0 Lflag_68
s_endpgm
Lset_70:
Lknown_67:
s_mul_i32 s40, s22, 401408
s_add_u32 s40, s40, 10180608
s_and_b32 s41, s97, 255
s_sub_u32 s41, s41, 1
s_cmp_eq_u32 s41, s22
s_cbranch_scc1 Lheld_66
s_mov_b32 s41, s40
buffer_load_dwordx4 a[0:3], v1, s[4:7], s41 offen
buffer_load_dwordx4 a[4:7], v1, s[4:7], s41 offen offset:1024
buffer_load_dwordx4 a[8:11], v1, s[4:7], s41 offen offset:2048
buffer_load_dwordx4 a[12:15], v1, s[4:7], s41 offen offset:3072
s_add_u32 s41, s41, 4096
buffer_load_dwordx4 a[16:19], v1, s[4:7], s41 offen
buffer_load_dwordx4 a[20:23], v1, s[4:7], s41 offen offset:1024
buffer_load_dwordx4 a[24:27], v1, s[4:7], s41 offen offset:2048
buffer_load_dwordx4 a[28:31], v1, s[4:7], s41 offen offset:3072
s_add_u32 s41, s41, 4096
buffer_load_dwordx4 a[32:35], v1, s[4:7], s41 offen
buffer_load_dwordx4 a[36:39], v1, s[4:7], s41 offen offset:1024
buffer_load_dwordx4 a[40:43], v1, s[4:7], s41 offen offset:2048
buffer_load_dwordx4 a[44:47], v1, s[4:7], s41 offen offset:3072
s_add_u32 s41, s41, 4096
buffer_load_dwordx4 a[48:51], v1, s[4:7], s41 offen
buffer_load_dwordx4 a[52:55], v1, s[4:7], s41 offen offset:1024
buffer_load_dwordx4 a[56:59], v1, s[4:7], s41 offen offset:2048
buffer_load_dwordx4 a[60:63], v1, s[4:7], s41 offen offset:3072
s_add_u32 s41, s41, 4096
buffer_load_dwordx4 a[64:67], v1, s[4:7], s41 offen
buffer_load_dwordx4 a[68:71], v1, s[4:7], s41 offen offset:1024
buffer_load_dwordx4 a[72:75], v1, s[4:7], s41 offen offset:2048
buffer_load_dwordx4 a[76:79], v1, s[4:7], s41 offen offset:3072
s_add_u32 s41, s41, 4096
buffer_load_dwordx4 a[80:83], v1, s[4:7], s41 offen
buffer_load_dwordx4 a[84:87], v1, s[4:7], s41 offen offset:1024
buffer_load_dwordx4 a[88:91], v1, s[4:7], s41 offen offset:2048
buffer_load_dwordx4 a[92:95], v1, s[4:7], s41 offen offset:3072
s_add_u32 s41, s41, 4096
buffer_load_dwordx4 a[96:99], v1, s[4:7], s41 offen
buffer_load_dwordx4 a[100:103], v1, s[4:7], s41 offen offset:1024
buffer_load_dwordx4 a[104:107], v1, s[4:7], s41 offen offset:2048
buffer_load_dwordx4 a[108:111], v1, s[4:7], s41 offen offset:3072
s_add_u32 s41, s41, 4096
buffer_load_dwordx4 a[112:115], v1, s[4:7], s41 offen
buffer_load_dwordx4 a[116:119], v1, s[4:7], s41 offen offset:1024
buffer_load_dwordx4 a[120:123], v1, s[4:7], s41 offen offset:2048
buffer_load_dwordx4 a[124:127], v1, s[4:7], s41 offen offset:3072
s_add_u32 s41, s41, 4096
buffer_load_dwordx4 a[128:131], v1, s[4:7], s41 offen
buffer_load_dwordx4 a[132:135], v1, s[4:7], s41 offen offset:1024
buffer_load_dwordx4 a[136:139], v1, s[4:7], s41 offen offset:2048
buffer_load_dwordx4 a[140:143], v1, s[4:7], s41 offen offset:3072
s_add_u32 s41, s41, 4096
buffer_load_dwordx4 a[144:147], v1, s[4:7], s41 offen
buffer_load_dwordx4 a[148:151], v1, s[4:7], s41 offen offset:1024
buffer_load_dwordx4 a[152:155], v1, s[4:7], s41 offen offset:2048
buffer_load_dwordx4 a[156:159], v1, s[4:7], s41 offen offset:3072
s_add_u32 s41, s41, 4096
buffer_load_dwordx4 a[160:163], v1, s[4:7], s41 offen
buffer_load_dwordx4 a[164:167], v1, s[4:7], s41 offen offset:1024
buffer_load_dwordx4 a[168:171], v1, s[4:7], s41 offen offset:2048
buffer_load_dwordx4 a[172:175], v1, s[4:7], s41 offen offset:3072
s_add_u32 s41, s41, 4096
buffer_load_dwordx4 a[176:179], v1, s[4:7], s41 offen
buffer_load_dwordx4 a[180:183], v1, s[4:7], s41 offen offset:1024
buffer_load_dwordx4 a[184:187], v1, s[4:7], s41 offen offset:2048
buffer_load_dwordx4 a[188:191], v1, s[4:7], s41 offen offset:3072
s_add_u32 s41, s41, 4096
s_waitcnt vmcnt(40)
buffer_load_dwordx4 a[192:195], v1, s[4:7], s41 offen
buffer_load_dwordx4 a[196:199], v1, s[4:7], s41 offen offset:1024
buffer_load_dwordx4 a[200:203], v1, s[4:7], s41 offen offset:2048
buffer_load_dwordx4 a[204:207], v1, s[4:7], s41 offen offset:3072
s_add_u32 s41, s41, 4096
buffer_load_dwordx4 a[208:211], v1, s[4:7], s41 offen
buffer_load_dwordx4 a[212:215], v1, s[4:7], s41 offen offset:1024
buffer_load_dwordx4 a[216:219], v1, s[4:7], s41 offen offset:2048
buffer_load_dwordx4 a[220:223], v1, s[4:7], s41 offen offset:3072
s_waitcnt vmcnt(8)
Lheld_66:
s_add_u32 s40, s40, 57344
buffer_load_dwordx4 a[224:227], v1, s[4:7], s40 offen
buffer_load_dwordx4 a[228:231], v1, s[4:7], s40 offen offset:1024
buffer_load_dwordx4 a[232:235], v1, s[4:7], s40 offen offset:2048
buffer_load_dwordx4 a[236:239], v1, s[4:7], s40 offen offset:3072
s_add_u32 s40, s40, 4096
buffer_load_dwordx4 a[240:243], v1, s[4:7], s40 offen
buffer_load_dwordx4 a[244:247], v1, s[4:7], s40 offen offset:1024
buffer_load_dwordx4 a[248:251], v1, s[4:7], s40 offen offset:2048
buffer_load_dwordx4 a[252:255], v1, s[4:7], s40 offen offset:3072
s_add_u32 s40, s40, 4096
buffer_load_dwordx4 v[120:123], v1, s[4:7], s40 offen
buffer_load_dwordx4 v[124:127], v1, s[4:7], s40 offen offset:1024
buffer_load_dwordx4 v[128:131], v1, s[4:7], s40 offen offset:2048
buffer_load_dwordx4 v[132:135], v1, s[4:7], s40 offen offset:3072
s_add_u32 s40, s40, 4096
buffer_load_dwordx4 v[136:139], v1, s[4:7], s40 offen
buffer_load_dwordx4 v[140:143], v1, s[4:7], s40 offen offset:1024
buffer_load_dwordx4 v[144:147], v1, s[4:7], s40 offen offset:2048
buffer_load_dwordx4 v[148:151], v1, s[4:7], s40 offen offset:3072
s_add_u32 s40, s40, 4096
buffer_load_dwordx4 v[152:155], v1, s[4:7], s40 offen
buffer_load_dwordx4 v[156:159], v1, s[4:7], s40 offen offset:1024
buffer_load_dwordx4 v[160:163], v1, s[4:7], s40 offen offset:2048
buffer_load_dwordx4 v[164:167], v1, s[4:7], s40 offen offset:3072
s_add_u32 s40, s40, 4096
buffer_load_dwordx4 v[168:171], v1, s[4:7], s40 offen
buffer_load_dwordx4 v[172:175], v1, s[4:7], s40 offen offset:1024
buffer_load_dwordx4 v[176:179], v1, s[4:7], s40 offen offset:2048
buffer_load_dwordx4 v[180:183], v1, s[4:7], s40 offen offset:3072
s_add_u32 s40, s40, 4096
buffer_load_dwordx4 v[184:187], v1, s[4:7], s40 offen
buffer_load_dwordx4 v[188:191], v1, s[4:7], s40 offen offset:1024
buffer_load_dwordx4 v[192:195], v1, s[4:7], s40 offen offset:2048
buffer_load_dwordx4 v[196:199], v1, s[4:7], s40 offen offset:3072
s_add_u32 s40, s40, 4096
buffer_load_dwordx4 v[200:203], v1, s[4:7], s40 offen
buffer_load_dwordx4 v[204:207], v1, s[4:7], s40 offen offset:1024
buffer_load_dwordx4 v[208:211], v1, s[4:7], s40 offen offset:2048
buffer_load_dwordx4 v[212:215], v1, s[4:7], s40 offen offset:3072
s_add_u32 s40, s40, 4096
buffer_load_dwordx4 v[216:219], v1, s[4:7], s40 offen
buffer_load_dwordx4 v[220:223], v1, s[4:7], s40 offen offset:1024
buffer_load_dwordx4 v[224:227], v1, s[4:7], s40 offen offset:2048
buffer_load_dwordx4 v[228:231], v1, s[4:7], s40 offen offset:3072
s_add_u32 s40, s40, 4096
buffer_load_dwordx4 v[232:235], v1, s[4:7], s40 offen
buffer_load_dwordx4 v[236:239], v1, s[4:7], s40 offen offset:1024
buffer_load_dwordx4 v[240:243], v1, s[4:7], s40 offen offset:2048
buffer_load_dwordx4 v[244:247], v1, s[4:7], s40 offen offset:3072
s_add_u32 s40, s40, 4096
buffer_load_dwordx4 v[248:251], v1, s[4:7], s40 offen
buffer_load_dwordx4 v[252:255], v1, s[4:7], s40 offen offset:1024
v_and_b32 v9, 15, v0
v_lshrrev_b32 v10, 5, v0
v_mul_u32_u24 v2, 14, v10
v_bfe_u32 v10, v0, 4, 1
v_add_u32 v2, v2, v10
v_and_b32 v10, 7, v0
v_lshlrev_b32 v10, 4, v10
v_lshl_add_u32 v2, v2, 7, v10
v_bfe_u32 v7, v0, 5, 1
v_bfe_u32 v10, v0, 4, 1
v_lshl_add_u32 v7, v10, 1, v7
v_lshlrev_b32 v3, 2, v7
v_lshl_add_u32 v3, v9, 4, v3
v_add_u32 v3, 8960, v3
v_lshrrev_b32 v10, 4, v0
v_bfe_u32 v4, v0, 2, 2
v_lshl_add_u32 v4, v10, 3, v4
v_lshlrev_b32 v4, 5, v4
v_and_b32 v5, 3, v0
v_lshl_add_u32 v4, v5, 3, v4
v_add_u32 v4, 8192, v4
v_lshlrev_b32 v6, 5, v10
v_add_u32 v6, 16384, v6
v_cmp_eq_u32 vcc, 0, v9
v_add_u32 v10, 12, v6
v_lshlrev_b32 v5, 2, v0
v_add_u32 v5, 16512, v5
v_cndmask_b32 v5, v5, v10, vcc
v_and_b32 v10, 1, v0
v_cmp_eq_u32 s[34:35], 0, v10
v_lshl_add_u32 v6, v10, 4, v6
v_lshlrev_b32 v7, 5, v7
v_lshl_add_u32 v7, v10, 4, v7
v_bfe_u32 v10, v0, 1, 1
v_lshl_add_u32 v7, v10, 7, v7
v_bfe_u32 v10, v0, 2, 1
v_lshl_add_u32 v7, v10, 3, v7
v_bfe_u32 v10, v0, 3, 1
v_lshlrev_b32 v10, 30, v10
v_or_b32 v7, v7, v10
v_and_b32 v9, 8, v0
v_cmp_eq_u32 vcc, 0, v9
v_mov_b32 v9, 0x88884444
v_mov_b32 v8, 0xddddeeee
v_cndmask_b32 v8, v8, v9, vcc
s_mul_i32 s26, s23, 458752
s_add_u32 s26, s26, 181248
s_lshr_b32 s27, s22, 1
s_lshl_b32 s27, s27, 8
s_and_b32 s40, s22, 1
s_lshl_b32 s40, s40, 2
s_add_u32 s27, s27, s40
s_add_u32 s27, s27, 1101824
s_mov_b32 s30, s23
s_mov_b32 s31, 0
s_mov_b32 s32, 562036736
s_mov_b32 s33, 1342177280
s_mov_b32 s28, 6219776
s_add_u32 s29, s28, 7168
s_mov_b32 s25, 0
v_min_u32 v12, 55, v0
v_and_b32 v14, 3, v12
v_lshlrev_b32 v14, 3, v14
v_lshrrev_b32 v12, 2, v12
v_lshl_add_u32 v14, v12, 7, v14
s_mov_b32 s43, 4352
Llz_71:
buffer_load_dwordx2 v[12:13], v14, s[4:7], s43 offen sc1
s_waitcnt vmcnt(0)
v_cmp_ne_u32 vcc, s88, v12
v_cmp_ne_u32 s[40:41], s88, v13
s_or_b64 vcc, vcc, s[40:41]
s_cbranch_vccz Llzok_72
s_sleep 8
s_sub_u32 s24, s24, 1
s_cbranch_scc0 Llz_71
s_endpgm
Llzok_72:
.p2align 6
S1_STEP3:
s_waitcnt vmcnt(0)
s_nop 15
s_nop 7
buffer_load_dwordx4 v[64:67], v1, s[4:7], s26 offen sc1
buffer_load_dwordx4 v[68:71], v1, s[4:7], s26 offen offset:1024 sc1
v_mov_b32 v12, 0
v_mov_b32 v13, 0
v_mov_b32 v14, 0
v_mov_b32 v15, 0
v_mov_b32 v16, 0
v_mov_b32 v17, 0
v_mov_b32 v18, 0
v_mov_b32 v19, 0
v_mov_b32 v20, 0
v_mov_b32 v21, 0
v_mov_b32 v22, 0
v_mov_b32 v23, 0
v_mov_b32 v24, 0
v_mov_b32 v25, 0
v_mov_b32 v26, 0
v_mov_b32 v27, 0
v_mov_b32 v28, 0
v_mov_b32 v29, 0
v_mov_b32 v30, 0
v_mov_b32 v31, 0
v_mov_b32 v32, 0
v_mov_b32 v33, 0
v_mov_b32 v34, 0
v_mov_b32 v35, 0
v_mov_b32 v36, 0
v_mov_b32 v37, 0
v_mov_b32 v38, 0
v_mov_b32 v39, 0
v_mov_b32 v40, 0
v_mov_b32 v41, 0
v_mov_b32 v42, 0
v_mov_b32 v43, 0
Lspin_73:
buffer_load_dwordx4 v[64:67], v1, s[4:7], s26 offen sc1
buffer_load_dwordx4 v[68:71], v1, s[4:7], s26 offen offset:1024 sc1
s_sub_u32 s24, s24, 1
s_cbranch_scc1 CODE_END
s_waitcnt vmcnt(2)
v_max3_u32 v9, v64, v65, v66
v_max3_u32 v9, v9, v67, v68
v_max3_u32 v9, v9, v69, v70
v_max_u32 v9, v9, v71
v_cmp_eq_u32 vcc, -1, v9
ds_write_b128 v1, v[68:71] offset:6144
s_cbranch_vccnz Lspin_73
v_smfmac_f32_16x16x64_bf16 v[16:19], v[64:67], a[40:47], v8
v_smfmac_f32_16x16x64_bf16 v[20:23], v[64:67], a[96:103], v8
v_smfmac_f32_16x16x64_bf16 v[24:27], v[64:67], a[152:159], v8
s_waitcnt lgkmcnt(0)
s_barrier
ds_read_b128 v[44:47], v1
v_smfmac_f32_16x16x64_bf16 v[28:31], v[64:67], a[208:215], v8
ds_read_b128 v[48:51], v1 offset:1024
v_smfmac_f32_16x16x64_bf16 v[32:35], v[64:67], v[128:135], v8
ds_read_b128 v[52:55], v1 offset:2048
v_smfmac_f32_16x16x64_bf16 v[36:39], v[64:67], v[184:191], v8
ds_read_b128 v[56:59], v1 offset:3072
v_smfmac_f32_16x16x64_bf16 v[40:43], v[64:67], v[240:247], v8
ds_read_b128 v[60:63], v1 offset:4096
v_smfmac_f32_16x16x64_bf16 v[16:19], v[68:71], a[48:55], v8
v_smfmac_f32_16x16x64_bf16 v[20:23], v[68:71], a[104:111], v8
v_smfmac_f32_16x16x64_bf16 v[24:27], v[68:71], a[160:167], v8
v_smfmac_f32_16x16x64_bf16 v[28:31], v[68:71], a[216:223], v8
v_smfmac_f32_16x16x64_bf16 v[32:35], v[68:71], v[136:143], v8
v_smfmac_f32_16x16x64_bf16 v[36:39], v[68:71], v[192:199], v8
v_smfmac_f32_16x16x64_bf16 v[40:43], v[68:71], v[248:255], v8
s_waitcnt lgkmcnt(4)
v_smfmac_f32_16x16x64_bf16 v[16:19], v[44:47], a[0:7], v8
s_waitcnt lgkmcnt(3)
v_smfmac_f32_16x16x64_bf16 v[16:19], v[48:51], a[8:15], v8
s_waitcnt lgkmcnt(2)
v_smfmac_f32_16x16x64_bf16 v[16:19], v[52:55], a[16:23], v8
s_waitcnt lgkmcnt(1)
v_smfmac_f32_16x16x64_bf16 v[16:19], v[56:59], a[24:31], v8
s_waitcnt lgkmcnt(0)
v_smfmac_f32_16x16x64_bf16 v[16:19], v[60:63], a[32:39], v8
v_smfmac_f32_16x16x64_bf16 v[20:23], v[44:47], a[56:63], v8
v_smfmac_f32_16x16x64_bf16 v[20:23], v[48:51], a[64:71], v8
v_smfmac_f32_16x16x64_bf16 v[20:23], v[52:55], a[72:79], v8
v_permlane32_swap_b32 v16, v18
v_smfmac_f32_16x16x64_bf16 v[20:23], v[56:59], a[80:87], v8
v_permlane32_swap_b32 v17, v19
v_smfmac_f32_16x16x64_bf16 v[20:23], v[60:63], a[88:95], v8
v_add_f32 v16, v16, v18
v_smfmac_f32_16x16x64_bf16 v[24:27], v[44:47], a[112:119], v8
v_add_f32 v17, v17, v19
v_smfmac_f32_16x16x64_bf16 v[24:27], v[48:51], a[120:127], v8
v_cvt_pk_bf16_f32 v16, v16, v17
v_smfmac_f32_16x16x64_bf16 v[24:27], v[52:55], a[128:135], v8
ds_write_b32 v3, v16
v_permlane32_swap_b32 v20, v22
v_smfmac_f32_16x16x64_bf16 v[24:27], v[56:59], a[136:143], v8
v_permlane32_swap_b32 v21, v23
v_smfmac_f32_16x16x64_bf16 v[24:27], v[60:63], a[144:151], v8
v_add_f32 v20, v20, v22
v_smfmac_f32_16x16x64_bf16 v[28:31], v[44:47], a[168:175], v8
v_add_f32 v21, v21, v23
v_smfmac_f32_16x16x64_bf16 v[28:31], v[48:51], a[176:183], v8
v_cvt_pk_bf16_f32 v20, v20, v21
v_smfmac_f32_16x16x64_bf16 v[28:31], v[52:55], a[184:191], v8
ds_write_b32 v3, v20 offset:1024
v_permlane32_swap_b32 v24, v26
v_smfmac_f32_16x16x64_bf16 v[28:31], v[56:59], a[192:199], v8
v_permlane32_swap_b32 v25, v27
v_smfmac_f32_16x16x64_bf16 v[28:31], v[60:63], a[200:207], v8
v_add_f32 v24, v24, v26
v_smfmac_f32_16x16x64_bf16 v[32:35], v[44:47], a[224:231], v8
v_add_f32 v25, v25, v27
v_smfmac_f32_16x16x64_bf16 v[32:35], v[48:51], a[232:239], v8
v_cvt_pk_bf16_f32 v24, v24, v25
v_smfmac_f32_16x16x64_bf16 v[32:35], v[52:55], a[240:247], v8
ds_write_b32 v3, v24 offset:2048
v_permlane32_swap_b32 v28, v30
v_smfmac_f32_16x16x64_bf16 v[32:35], v[56:59], a[248:255], v8
v_permlane32_swap_b32 v29, v31
v_smfmac_f32_16x16x64_bf16 v[32:35], v[60:63], v[120:127], v8
v_add_f32 v28, v28, v30
s_waitcnt lgkmcnt(0)
s_barrier
v_smfmac_f32_16x16x64_bf16 v[36:39], v[44:47], v[144:151], v8
v_add_f32 v29, v29, v31
v_smfmac_f32_16x16x64_bf16 v[36:39], v[48:51], v[152:159], v8
v_cvt_pk_bf16_f32 v28, v28, v29
v_smfmac_f32_16x16x64_bf16 v[36:39], v[52:55], v[160:167], v8
ds_write_b32 v3, v28 offset:3072
v_permlane32_swap_b32 v32, v34
v_smfmac_f32_16x16x64_bf16 v[36:39], v[56:59], v[168:175], v8
v_permlane32_swap_b32 v33, v35
v_smfmac_f32_16x16x64_bf16 v[36:39], v[60:63], v[176:183], v8
v_add_f32 v32, v32, v34
v_smfmac_f32_16x16x64_bf16 v[40:43], v[44:47], v[200:207], v8
v_add_f32 v33, v33, v35
v_smfmac_f32_16x16x64_bf16 v[40:43], v[48:51], v[208:215], v8
v_cvt_pk_bf16_f32 v32, v32, v33
v_smfmac_f32_16x16x64_bf16 v[40:43], v[52:55], v[216:223], v8
ds_write_b32 v3, v32 offset:4096
v_permlane32_swap_b32 v36, v38
v_smfmac_f32_16x16x64_bf16 v[40:43], v[56:59], v[224:231], v8
v_permlane32_swap_b32 v37, v39
v_smfmac_f32_16x16x64_bf16 v[40:43], v[60:63], v[232:239], v8
v_add_f32 v36, v36, v38
v_add_f32 v37, v37, v39
v_cvt_pk_bf16_f32 v36, v36, v37
s_nop 5
ds_write_b32 v3, v36 offset:5120
v_permlane32_swap_b32 v40, v42
v_permlane32_swap_b32 v41, v43
v_add_f32 v40, v40, v42
v_add_f32 v41, v41, v43
v_cvt_pk_bf16_f32 v40, v40, v41
ds_write_b32 v3, v40 offset:6144
s_waitcnt lgkmcnt(0)
s_barrier
s_waitcnt lgkmcnt(0)
s_barrier
ds_read_b128 v[24:27], v6
s_waitcnt lgkmcnt(0)
v_add_f32 v20, v24, v25
v_add_f32 v20, v20, v26
v_subrev_u32 v20, s32, v20
v_cmp_le_u32 vcc, s33, v20
s_or_b64 s[40:41], vcc, s[30:31]
s_cbranch_scc1 Lrare_74
Lback_75:
s_add_u32 s26, s26, 7168
s_add_u32 s27, s27, 10240
s_add_u32 s28, s28, 28672
s_add_u32 s29, s29, 28672
s_add_u32 s25, s25, 1
s_cmp_lt_u32 s25, 63
s_cbranch_scc1 S1_STEP3
s_cmp_eq_u32 s22, 0
s_cbranch_scc0 Ldirty_76
s_mul_i32 s40, s21, 0
s_add_u32 s40, s40, 1086464
Lstp_77:
buffer_load_dword v9, off, s[4:7], s40 sc1
s_waitcnt vmcnt(0)
v_cmp_eq_u32 vcc, -1, v9
s_cbranch_vccz Lstpok_78
s_sleep 4
s_sub_u32 s24, s24, 1
s_cbranch_scc0 Lstp_77
s_endpgm
Lstpok_78:
buffer_wbl2 sc1
s_waitcnt vmcnt(0)
Ldirty_76:
s_endpgm
Lrare_74:
s_cbranch_vccz Lready_79
s_waitcnt lgkmcnt(0)
s_barrier
ds_read_b128 v[24:27], v6 offset:448
s_waitcnt lgkmcnt(0)
s_waitcnt lgkmcnt(0)
s_barrier
ds_read_b128 v[24:27], v6 offset:896
s_waitcnt lgkmcnt(0)
v_add_f32 v20, v24, v25
v_add_f32 v20, v20, v26
s_nop 0
Lready_79:
s_branch Lback_75
S2_W0:
s_sub_u32 s22, s22, 16
v_lshlrev_b32 v1, 4, v0
v_and_b32 v9, 7, v0
v_min_u32 v9, 6, v9
v_lshlrev_b32 v9, 2, v9
v_bfe_u32 v10, v0, 3, 2
v_lshl_add_u32 v9, v10, 7, v9
s_mov_b32 s40, 2048
s_branch Lfirst_81
Lflag_80:
v_cmp_ne_u32 vcc, s88, v10
s_cbranch_vccz Lset_82
s_sleep 4
Lfirst_81:
buffer_load_dword v10, v9, s[4:7], s40 offen sc1
s_waitcnt vmcnt(0)
s_sub_u32 s24, s24, 1
s_cbranch_scc0 Lflag_80
s_endpgm
Lset_82:
s_mul_i32 s40, s22, 458752
s_add_u32 s40, s40, 16302080
s_add_u32 s41, s40, 86016
s_add_u32 s43, s40, 57344
buffer_load_dwordx4 a[0:3], v1, s[4:7], s40 offen
buffer_load_dwordx4 a[4:7], v1, s[4:7], s40 offen offset:1024
buffer_load_dwordx4 a[8:11], v1, s[4:7], s40 offen offset:2048
buffer_load_dwordx4 a[12:15], v1, s[4:7], s40 offen offset:3072
s_add_u32 s40, s40, 4096
buffer_load_dwordx4 a[16:19], v1, s[4:7], s40 offen
buffer_load_dwordx4 a[20:23], v1, s[4:7], s40 offen offset:1024
buffer_load_dwordx4 a[24:27], v1, s[4:7], s40 offen offset:2048
buffer_load_dwordx4 a[28:31], v1, s[4:7], s40 offen offset:3072
s_add_u32 s40, s40, 4096
buffer_load_dwordx4 a[32:35], v1, s[4:7], s40 offen
buffer_load_dwordx4 a[36:39], v1, s[4:7], s40 offen offset:1024
buffer_load_dwordx4 a[40:43], v1, s[4:7], s40 offen offset:2048
buffer_load_dwordx4 a[44:47], v1, s[4:7], s40 offen offset:3072
s_add_u32 s40, s40, 4096
buffer_load_dwordx4 a[48:51], v1, s[4:7], s40 offen
buffer_load_dwordx4 a[52:55], v1, s[4:7], s40 offen offset:1024
buffer_load_dwordx4 a[56:59], v1, s[4:7], s40 offen offset:2048
buffer_load_dwordx4 a[60:63], v1, s[4:7], s40 offen offset:3072
s_add_u32 s40, s40, 4096
buffer_load_dwordx4 a[64:67], v1, s[4:7], s40 offen
buffer_load_dwordx4 a[68:71], v1, s[4:7], s40 offen offset:1024
buffer_load_dwordx4 a[72:75], v1, s[4:7], s40 offen offset:2048
buffer_load_dwordx4 a[76:79], v1, s[4:7], s40 offen offset:3072
s_add_u32 s40, s40, 4096
buffer_load_dwordx4 a[80:83], v1, s[4:7], s40 offen
buffer_load_dwordx4 a[84:87], v1, s[4:7], s40 offen offset:1024
buffer_load_dwordx4 a[88:91], v1, s[4:7], s40 offen offset:2048
buffer_load_dwordx4 a[92:95], v1, s[4:7], s40 offen offset:3072
s_add_u32 s40, s40, 4096
buffer_load_dwordx4 a[96:99], v1, s[4:7], s40 offen
buffer_load_dwordx4 a[100:103], v1, s[4:7], s40 offen offset:1024
buffer_load_dwordx4 a[104:107], v1, s[4:7], s40 offen offset:2048
buffer_load_dwordx4 a[108:111], v1, s[4:7], s40 offen offset:3072
s_add_u32 s40, s40, 4096
buffer_load_dwordx4 a[112:115], v1, s[4:7], s40 offen
buffer_load_dwordx4 a[116:119], v1, s[4:7], s40 offen offset:1024
buffer_load_dwordx4 a[120:123], v1, s[4:7], s40 offen offset:2048
buffer_load_dwordx4 a[124:127], v1, s[4:7], s40 offen offset:3072
s_add_u32 s40, s40, 4096
buffer_load_dwordx4 a[128:131], v1, s[4:7], s40 offen
buffer_load_dwordx4 a[132:135], v1, s[4:7], s40 offen offset:1024
buffer_load_dwordx4 a[136:139], v1, s[4:7], s40 offen offset:2048
buffer_load_dwordx4 a[140:143], v1, s[4:7], s40 offen offset:3072
s_add_u32 s40, s40, 4096
buffer_load_dwordx4 a[144:147], v1, s[4:7], s40 offen
buffer_load_dwordx4 a[148:151], v1, s[4:7], s40 offen offset:1024
buffer_load_dwordx4 a[152:155], v1, s[4:7], s40 offen offset:2048
buffer_load_dwordx4 a[156:159], v1, s[4:7], s40 offen offset:3072
s_add_u32 s40, s40, 4096
s_waitcnt vmcnt(32)
buffer_load_dwordx4 a[160:163], v1, s[4:7], s40 offen
buffer_load_dwordx4 a[164:167], v1, s[4:7], s40 offen offset:1024
buffer_load_dwordx4 a[168:171], v1, s[4:7], s40 offen offset:2048
buffer_load_dwordx4 a[172:175], v1, s[4:7], s40 offen offset:3072
s_add_u32 s40, s40, 4096
buffer_load_dwordx4 a[176:179], v1, s[4:7], s40 offen
buffer_load_dwordx4 a[180:183], v1, s[4:7], s40 offen offset:1024
buffer_load_dwordx4 a[184:187], v1, s[4:7], s40 offen offset:2048
buffer_load_dwordx4 a[188:191], v1, s[4:7], s40 offen offset:3072
s_add_u32 s40, s40, 4096
s_waitcnt vmcnt(32)
buffer_load_dwordx4 a[192:195], v1, s[4:7], s40 offen
buffer_load_dwordx4 a[196:199], v1, s[4:7], s40 offen offset:1024
buffer_load_dwordx4 a[200:203], v1, s[4:7], s40 offen offset:2048
buffer_load_dwordx4 a[204:207], v1, s[4:7], s40 offen offset:3072
s_add_u32 s40, s40, 4096
buffer_load_dwordx4 a[208:211], v1, s[4:7], s40 offen
buffer_load_dwordx4 a[212:215], v1, s[4:7], s40 offen offset:1024
buffer_load_dwordx4 a[216:219], v1, s[4:7], s40 offen offset:2048
buffer_load_dwordx4 a[220:223], v1, s[4:7], s40 offen offset:3072
s_waitcnt vmcnt(40)
s_mov_b32 m0, 49152
s_add_u32 s42, s41, 0
buffer_load_dwordx4 v1, s[4:7], s42 offen lds
s_mov_b32 m0, 50176
s_add_u32 s42, s41, 1024
buffer_load_dwordx4 v1, s[4:7], s42 offen lds
s_mov_b32 m0, 51200
s_add_u32 s42, s41, 2048
buffer_load_dwordx4 v1, s[4:7], s42 offen lds
s_mov_b32 m0, 52224
s_add_u32 s42, s41, 3072
buffer_load_dwordx4 v1, s[4:7], s42 offen lds
s_mov_b32 m0, 53248
s_add_u32 s42, s41, 4096
buffer_load_dwordx4 v1, s[4:7], s42 offen lds
s_mov_b32 m0, 54272
s_add_u32 s42, s41, 5120
buffer_load_dwordx4 v1, s[4:7], s42 offen lds
s_mov_b32 m0, 55296
s_add_u32 s42, s41, 6144
buffer_load_dwordx4 v1, s[4:7], s42 offen lds
s_mov_b32 m0, 56320
s_add_u32 s42, s41, 7168
buffer_load_dwordx4 v1, s[4:7], s42 offen lds
s_waitcnt vmcnt(40)
s_mov_b32 m0, 57344
s_add_u32 s42, s41, 8192
buffer_load_dwordx4 v1, s[4:7], s42 offen lds
s_mov_b32 m0, 58368
s_add_u32 s42, s41, 9216
buffer_load_dwordx4 v1, s[4:7], s42 offen lds
s_mov_b32 m0, 59392
s_add_u32 s42, s41, 10240
buffer_load_dwordx4 v1, s[4:7], s42 offen lds
s_mov_b32 m0, 60416
s_add_u32 s42, s41, 11264
buffer_load_dwordx4 v1, s[4:7], s42 offen lds
s_mov_b32 m0, 61440
s_add_u32 s42, s41, 12288
buffer_load_dwordx4 v1, s[4:7], s42 offen lds
s_mov_b32 m0, 62464
s_add_u32 s42, s41, 13312
buffer_load_dwordx4 v1, s[4:7], s42 offen lds
s_mov_b32 m0, 63488
s_add_u32 s42, s41, 14336
buffer_load_dwordx4 v1, s[4:7], s42 offen lds
s_mov_b32 m0, 64512
s_add_u32 s42, s41, 15360
buffer_load_dwordx4 v1, s[4:7], s42 offen lds
s_waitcnt vmcnt(40)
s_mov_b32 m0, 65536
s_add_u32 s42, s41, 16384
buffer_load_dwordx4 v1, s[4:7], s42 offen lds
s_mov_b32 m0, 66560
s_add_u32 s42, s41, 17408
buffer_load_dwordx4 v1, s[4:7], s42 offen lds
s_mov_b32 m0, 67584
s_add_u32 s42, s41, 18432
buffer_load_dwordx4 v1, s[4:7], s42 offen lds
s_mov_b32 m0, 68608
s_add_u32 s42, s41, 19456
buffer_load_dwordx4 v1, s[4:7], s42 offen lds
s_mov_b32 m0, 69632
s_add_u32 s42, s41, 20480
buffer_load_dwordx4 v1, s[4:7], s42 offen lds
s_mov_b32 m0, 70656
s_add_u32 s42, s41, 21504
buffer_load_dwordx4 v1, s[4:7], s42 offen lds
s_mov_b32 m0, 71680
s_add_u32 s42, s41, 22528
buffer_load_dwordx4 v1, s[4:7], s42 offen lds
s_mov_b32 m0, 72704
s_add_u32 s42, s41, 23552
buffer_load_dwordx4 v1, s[4:7], s42 offen lds
s_waitcnt vmcnt(40)
s_mov_b32 m0, 73728
s_add_u32 s42, s41, 24576
buffer_load_dwordx4 v1, s[4:7], s42 offen lds
s_mov_b32 m0, 74752
s_add_u32 s42, s41, 25600
buffer_load_dwordx4 v1, s[4:7], s42 offen lds
s_mov_b32 m0, 75776
s_add_u32 s42, s41, 26624
buffer_load_dwordx4 v1, s[4:7], s42 offen lds
s_mov_b32 m0, 76800
s_add_u32 s42, s41, 27648
buffer_load_dwordx4 v1, s[4:7], s42 offen lds
s_waitcnt vmcnt(52)
buffer_load_dwordx4 a[224:227], v1, s[4:7], s43 offen
buffer_load_dwordx4 a[228:231], v1, s[4:7], s43 offen offset:1024
buffer_load_dwordx4 a[232:235], v1, s[4:7], s43 offen offset:2048
buffer_load_dwordx4 a[236:239], v1, s[4:7], s43 offen offset:3072
s_add_u32 s43, s43, 4096
s_waitcnt vmcnt(52)
buffer_load_dwordx4 a[240:243], v1, s[4:7], s43 offen
buffer_load_dwordx4 a[244:247], v1, s[4:7], s43 offen offset:1024
buffer_load_dwordx4 a[248:251], v1, s[4:7], s43 offen offset:2048
buffer_load_dwordx4 a[252:255], v1, s[4:7], s43 offen offset:3072
s_add_u32 s43, s43, 4096
s_waitcnt vmcnt(52)
buffer_load_dwordx4 v[176:179], v1, s[4:7], s43 offen
buffer_load_dwordx4 v[180:183], v1, s[4:7], s43 offen offset:1024
buffer_load_dwordx4 v[184:187], v1, s[4:7], s43 offen offset:2048
buffer_load_dwordx4 v[188:191], v1, s[4:7], s43 offen offset:3072
s_add_u32 s43, s43, 4096
s_waitcnt vmcnt(52)
buffer_load_dwordx4 v[192:195], v1, s[4:7], s43 offen
buffer_load_dwordx4 v[196:199], v1, s[4:7], s43 offen offset:1024
buffer_load_dwordx4 v[200:203], v1, s[4:7], s43 offen offset:2048
buffer_load_dwordx4 v[204:207], v1, s[4:7], s43 offen offset:3072
s_add_u32 s43, s43, 4096
s_waitcnt vmcnt(52)
buffer_load_dwordx4 v[208:211], v1, s[4:7], s43 offen
buffer_load_dwordx4 v[212:215], v1, s[4:7], s43 offen offset:1024
buffer_load_dwordx4 v[216:219], v1, s[4:7], s43 offen offset:2048
buffer_load_dwordx4 v[220:223], v1, s[4:7], s43 offen offset:3072
s_add_u32 s43, s43, 4096
s_waitcnt vmcnt(52)
buffer_load_dwordx4 v[224:227], v1, s[4:7], s43 offen
buffer_load_dwordx4 v[228:231], v1, s[4:7], s43 offen offset:1024
buffer_load_dwordx4 v[232:235], v1, s[4:7], s43 offen offset:2048
buffer_load_dwordx4 v[236:239], v1, s[4:7], s43 offen offset:3072
s_add_u32 s43, s43, 4096
s_waitcnt vmcnt(52)
buffer_load_dwordx4 v[240:243], v1, s[4:7], s43 offen
buffer_load_dwordx4 v[244:247], v1, s[4:7], s43 offen offset:1024
buffer_load_dwordx4 v[248:251], v1, s[4:7], s43 offen offset:2048
buffer_load_dwordx4 v[252:255], v1, s[4:7], s43 offen offset:3072
s_add_u32 s43, s43, 4096
v_add_u32 v2, 49152, v1
v_and_b32 v9, 15, v0
v_lshrrev_b32 v10, 5, v0
v_lshlrev_b32 v3, 4, v9
v_lshl_add_u32 v3, v10, 8, v3
v_bfe_u32 v4, v0, 5, 1
v_bfe_u32 v10, v0, 4, 1
v_lshl_add_u32 v4, v10, 1, v4
v_lshlrev_b32 v4, 7, v4
v_lshl_add_u32 v4, v9, 2, v4
v_add_u32 v4, 8192, v4
v_lshlrev_b32 v5, 3, v0
v_add_u32 v5, 8192, v5
v_lshrrev_b32 v9, 3, v0
v_lshlrev_b32 v6, 4, v9
v_bfe_u32 v9, v0, 2, 1
v_lshl_add_u32 v6, v9, 7, v6
v_and_b32 v9, 3, v0
v_lshl_add_u32 v6, v9, 2, v6
v_and_b32 v9, 8, v0
v_cmp_eq_u32 vcc, 0, v9
v_mov_b32 v9, 0x88884444
v_mov_b32 v7, 0xddddeeee
v_cndmask_b32 v7, v7, v9, vcc
s_mul_i32 s26, s23, 458752
s_add_u32 s26, s26, 176128
s_mov_b32 s27, 1093632
s_mov_b32 s28, 1101824
s_lshl_b32 s29, s22, 15
s_add_u32 s29, s29, 30064640
s_add_u32 s30, s29, 4096
s_lshl_b32 s31, s22, 7
s_add_u32 s31, s31, 8192
s_lshl_b32 s32, s22, 9
s_add_u32 s32, s32, 183296
s_mov_b32 s25, 0
s_mov_b32 s89, 172032
s_lshl_b32 s34, s22, 2
s_add_u32 s34, s34, 172288
s_add_u32 s33, s88, 1
buffer_load_dword v8, off, s[4:7], s31 sc1
v_mov_b32 v128, 0
v_mov_b32 v129, 0
v_mov_b32 v130, 0
v_mov_b32 v131, 0
v_mov_b32 v132, 0
v_mov_b32 v133, 0
v_mov_b32 v134, 0
v_mov_b32 v135, 0
v_mov_b32 v136, 0
v_mov_b32 v137, 0
v_mov_b32 v138, 0
v_mov_b32 v139, 0
v_mov_b32 v140, 0
v_mov_b32 v141, 0
v_mov_b32 v142, 0
v_mov_b32 v143, 0
v_mov_b32 v144, 0
v_mov_b32 v145, 0
v_mov_b32 v146, 0
v_mov_b32 v147, 0
v_mov_b32 v148, 0
v_mov_b32 v149, 0
v_mov_b32 v150, 0
v_mov_b32 v151, 0
v_mov_b32 v152, 0
v_mov_b32 v153, 0
v_mov_b32 v154, 0
v_mov_b32 v155, 0
v_mov_b32 v156, 0
v_mov_b32 v157, 0
v_mov_b32 v158, 0
v_mov_b32 v159, 0
v_min_u32 v12, 55, v0
v_and_b32 v9, 3, v12
v_lshlrev_b32 v9, 3, v9
v_lshrrev_b32 v12, 2, v12
v_lshl_add_u32 v9, v12, 7, v9
s_mov_b32 s43, 4352
Llz_83:
buffer_load_dwordx2 v[12:13], v9, s[4:7], s43 offen sc1
s_waitcnt vmcnt(0)
v_cmp_ne_u32 vcc, s88, v12
v_cmp_ne_u32 s[40:41], s88, v13
s_or_b64 vcc, vcc, s[40:41]
s_cbranch_vccz Llzok_84
s_sleep 8
s_sub_u32 s24, s24, 1
s_cbranch_scc0 Llz_83
s_endpgm
Llzok_84:
v_cmp_ne_u32 vcc, s88, v8
s_cmp_lg_u64 vcc, 0
s_cselect_b32 s35, 0x40000000, 0
s_add_u32 s29, s29, s35
s_add_u32 s30, s30, s35
v_mov_b32 v12, 0
v_mov_b32 v13, 0
v_mov_b32 v14, 0
v_mov_b32 v15, 0
.p2align 6
s_nop 0
S2_STEP0:
ds_read_b128 v[104:107], v2
ds_read_b128 v[108:111], v2 offset:1024
ds_read_b128 v[112:115], v2 offset:2048
ds_read_b128 v[116:119], v2 offset:3072
ds_read_b128 v[120:123], v2 offset:4096
ds_read_b128 v[124:127], v2 offset:5120
v_mov_b32 v128, 0
v_mov_b32 v129, 0
v_mov_b32 v130, 0
v_mov_b32 v131, 0
v_mov_b32 v132, 0
v_mov_b32 v133, 0
v_mov_b32 v134, 0
v_mov_b32 v135, 0
v_mov_b32 v136, 0
v_mov_b32 v137, 0
v_mov_b32 v138, 0
v_mov_b32 v139, 0
v_mov_b32 v140, 0
v_mov_b32 v141, 0
v_mov_b32 v142, 0
v_mov_b32 v143, 0
Lspin_85:
buffer_load_dwordx4 v[16:19], v1, s[4:7], s26 offen sc1
buffer_load_dwordx4 v[20:23], v1, s[4:7], s26 offen offset:1024 sc1
s_sub_u32 s24, s24, 1
s_cbranch_scc1 CODE_END
s_waitcnt vmcnt(0)
v_max3_u32 v9, v16, v17, v18
v_max3_u32 v9, v9, v19, v20
v_max3_u32 v9, v9, v21, v22
v_max_u32 v9, v9, v23
v_cmp_eq_u32 vcc, -1, v9
s_cbranch_vccnz Lspin_85
ds_write_b128 v1, v[16:19]
ds_write_b128 v1, v[20:23] offset:1024
s_add_u32 s31, s31, 1792
s_waitcnt lgkmcnt(0)
s_barrier
ds_read_b128 v[24:27], v1 offset:2048
ds_read_b128 v[28:31], v1 offset:3072
ds_read_b128 v[32:35], v1 offset:4096
ds_read_b128 v[36:39], v1 offset:5120
ds_read_b128 v[40:43], v1 offset:6144
buffer_load_dword v8, off, s[4:7], s31 sc1
v_smfmac_f32_16x16x64_bf16 v[128:131], v[16:19], a[0:7], v7
v_smfmac_f32_16x16x64_bf16 v[132:135], v[16:19], a[56:63], v7
v_smfmac_f32_16x16x64_bf16 v[136:139], v[16:19], a[112:119], v7
v_mov_b32 v144, 0
v_mov_b32 v158, 0
v_smfmac_f32_16x16x64_bf16 v[140:143], v[16:19], v[104:111], v7
buffer_load_dwordx4 v[44:47], v1, s[4:7], s29 offen sc1
v_mov_b32 v145, 0
v_mov_b32 v159, 0
v_smfmac_f32_16x16x64_bf16 v[128:131], v[20:23], a[8:15], v7
ds_read_b128 v[104:107], v2 offset:6144
v_smfmac_f32_16x16x64_bf16 v[132:135], v[20:23], a[64:71], v7
ds_read_b128 v[108:111], v2 offset:7168
v_smfmac_f32_16x16x64_bf16 v[136:139], v[20:23], a[120:127], v7
v_mov_b32 v146, 0
v_smfmac_f32_16x16x64_bf16 v[140:143], v[20:23], v[112:119], v7
buffer_load_dwordx4 v[48:51], v1, s[4:7], s29 offen offset:1024 sc1
v_mov_b32 v147, 0
s_waitcnt lgkmcnt(6)
v_smfmac_f32_16x16x64_bf16 v[128:131], v[24:27], a[16:23], v7
ds_read_b128 v[112:115], v2 offset:8192
v_smfmac_f32_16x16x64_bf16 v[132:135], v[24:27], a[72:79], v7
ds_read_b128 v[116:119], v2 offset:9216
v_smfmac_f32_16x16x64_bf16 v[136:139], v[24:27], a[128:135], v7
v_mov_b32 v148, 0
v_smfmac_f32_16x16x64_bf16 v[140:143], v[24:27], v[120:127], v7
buffer_load_dwordx4 v[52:55], v1, s[4:7], s29 offen offset:2048 sc1
v_mov_b32 v149, 0
s_waitcnt lgkmcnt(7)
v_smfmac_f32_16x16x64_bf16 v[128:131], v[28:31], a[24:31], v7
ds_read_b128 v[120:123], v2 offset:10240
v_smfmac_f32_16x16x64_bf16 v[132:135], v[28:31], a[80:87], v7
ds_read_b128 v[124:127], v2 offset:11264
v_smfmac_f32_16x16x64_bf16 v[136:139], v[28:31], a[136:143], v7
v_mov_b32 v150, 0
s_waitcnt lgkmcnt(4)
v_smfmac_f32_16x16x64_bf16 v[140:143], v[28:31], v[104:111], v7
buffer_load_dwordx4 v[56:59], v1, s[4:7], s29 offen offset:3072 sc1
v_mov_b32 v151, 0
v_smfmac_f32_16x16x64_bf16 v[128:131], v[32:35], a[32:39], v7
ds_read_b128 v[104:107], v2 offset:12288
v_smfmac_f32_16x16x64_bf16 v[132:135], v[32:35], a[88:95], v7
ds_read_b128 v[108:111], v2 offset:13312
v_smfmac_f32_16x16x64_bf16 v[136:139], v[32:35], a[144:151], v7
v_mov_b32 v152, 0
s_waitcnt lgkmcnt(4)
v_smfmac_f32_16x16x64_bf16 v[140:143], v[32:35], v[112:119], v7
buffer_load_dwordx4 v[60:63], v1, s[4:7], s30 offen sc1
v_mov_b32 v153, 0
v_smfmac_f32_16x16x64_bf16 v[128:131], v[36:39], a[40:47], v7
ds_read_b128 v[112:115], v2 offset:14336
v_smfmac_f32_16x16x64_bf16 v[132:135], v[36:39], a[96:103], v7
ds_read_b128 v[116:119], v2 offset:15360
v_smfmac_f32_16x16x64_bf16 v[136:139], v[36:39], a[152:159], v7
v_mov_b32 v154, 0
s_waitcnt lgkmcnt(4)
v_smfmac_f32_16x16x64_bf16 v[140:143], v[36:39], v[120:127], v7
buffer_load_dwordx4 v[64:67], v1, s[4:7], s30 offen offset:1024 sc1
v_mov_b32 v155, 0
v_smfmac_f32_16x16x64_bf16 v[128:131], v[40:43], a[48:55], v7
ds_read_b128 v[120:123], v2 offset:16384
v_smfmac_f32_16x16x64_bf16 v[132:135], v[40:43], a[104:111], v7
ds_read_b128 v[124:127], v2 offset:17408
v_smfmac_f32_16x16x64_bf16 v[136:139], v[40:43], a[160:167], v7
v_mov_b32 v156, 0
s_waitcnt lgkmcnt(4)
v_smfmac_f32_16x16x64_bf16 v[140:143], v[40:43], v[104:111], v7
buffer_load_dwordx4 v[68:71], v1, s[4:7], s30 offen offset:2048 sc1
v_mov_b32 v157, 0
v_smfmac_f32_16x16x64_bf16 v[144:147], v[16:19], a[168:175], v7
ds_read_b128 v[104:107], v2 offset:18432
v_smfmac_f32_16x16x64_bf16 v[148:151], v[16:19], a[224:231], v7
ds_read_b128 v[108:111], v2 offset:19456
v_smfmac_f32_16x16x64_bf16 v[152:155], v[16:19], v[200:207], v7
v_cvt_pk_bf16_f32 v76, v128, v129
s_waitcnt lgkmcnt(4)
v_smfmac_f32_16x16x64_bf16 v[156:159], v[16:19], v[112:119], v7
buffer_load_dwordx4 v[72:75], v1, s[4:7], s30 offen offset:3072 sc1
v_cvt_pk_bf16_f32 v77, v130, v131
v_smfmac_f32_16x16x64_bf16 v[144:147], v[20:23], a[176:183], v7
ds_read_b128 v[112:115], v2 offset:20480
v_smfmac_f32_16x16x64_bf16 v[148:151], v[20:23], a[232:239], v7
ds_read_b128 v[116:119], v2 offset:21504
v_smfmac_f32_16x16x64_bf16 v[152:155], v[20:23], v[208:215], v7
v_cvt_pk_bf16_f32 v84, v132, v133
s_waitcnt lgkmcnt(4)
v_smfmac_f32_16x16x64_bf16 v[156:159], v[20:23], v[120:127], v7
v_cvt_pk_bf16_f32 v85, v134, v135
v_smfmac_f32_16x16x64_bf16 v[144:147], v[24:27], a[184:191], v7
ds_read_b128 v[120:123], v2 offset:22528
v_smfmac_f32_16x16x64_bf16 v[148:151], v[24:27], a[240:247], v7
ds_read_b128 v[124:127], v2 offset:23552
v_smfmac_f32_16x16x64_bf16 v[152:155], v[24:27], v[216:223], v7
v_cvt_pk_bf16_f32 v78, v136, v137
s_waitcnt lgkmcnt(4)
v_smfmac_f32_16x16x64_bf16 v[156:159], v[24:27], v[104:111], v7
v_cvt_pk_bf16_f32 v79, v138, v139
v_smfmac_f32_16x16x64_bf16 v[144:147], v[28:31], a[192:199], v7
ds_read_b128 v[104:107], v2 offset:24576
v_smfmac_f32_16x16x64_bf16 v[148:151], v[28:31], a[248:255], v7
ds_read_b128 v[108:111], v2 offset:25600
v_smfmac_f32_16x16x64_bf16 v[152:155], v[28:31], v[224:231], v7
v_cvt_pk_bf16_f32 v82, v140, v141
s_waitcnt lgkmcnt(4)
v_smfmac_f32_16x16x64_bf16 v[156:159], v[28:31], v[112:119], v7
v_cvt_pk_bf16_f32 v83, v142, v143
v_smfmac_f32_16x16x64_bf16 v[144:147], v[32:35], a[200:207], v7
ds_read_b128 v[112:115], v2 offset:26624
v_smfmac_f32_16x16x64_bf16 v[148:151], v[32:35], v[176:183], v7
ds_read_b128 v[116:119], v2 offset:27648
v_smfmac_f32_16x16x64_bf16 v[152:155], v[32:35], v[232:239], v7
s_waitcnt lgkmcnt(4)
v_smfmac_f32_16x16x64_bf16 v[156:159], v[32:35], v[120:127], v7
v_smfmac_f32_16x16x64_bf16 v[144:147], v[36:39], a[208:215], v7
v_smfmac_f32_16x16x64_bf16 v[148:151], v[36:39], v[184:191], v7
v_smfmac_f32_16x16x64_bf16 v[152:155], v[36:39], v[240:247], v7
s_waitcnt lgkmcnt(2)
v_smfmac_f32_16x16x64_bf16 v[156:159], v[36:39], v[104:111], v7
v_smfmac_f32_16x16x64_bf16 v[144:147], v[40:43], a[216:223], v7
v_smfmac_f32_16x16x64_bf16 v[148:151], v[40:43], v[192:199], v7
v_smfmac_f32_16x16x64_bf16 v[152:155], v[40:43], v[248:255], v7
s_waitcnt lgkmcnt(0)
v_smfmac_f32_16x16x64_bf16 v[156:159], v[40:43], v[112:119], v7
s_nop 2
v_cvt_pk_bf16_f32 v86, v144, v145
v_cvt_pk_bf16_f32 v87, v146, v147
v_cvt_pk_bf16_f32 v80, v148, v149
v_cvt_pk_bf16_f32 v81, v150, v151
v_cvt_pk_bf16_f32 v88, v152, v153
v_cvt_pk_bf16_f32 v89, v154, v155
v_cvt_pk_bf16_f32 v90, v156, v157
v_cvt_pk_bf16_f32 v91, v158, v159
v_mov_b32 v160, 0
v_mov_b32 v161, 0
v_mov_b32 v162, 0
v_mov_b32 v163, 0
v_mov_b32 v164, 0
v_mov_b32 v165, 0
v_mov_b32 v166, 0
v_mov_b32 v167, 0
s_cmp_eq_u32 s35, 0
s_cbranch_scc1 Lintime_86
s_sub_u32 s29, s29, s35
s_sub_u32 s30, s30, s35
s_mov_b32 s35, 0
s_sub_u32 s40, s31, 1792
s_branch Lfirst_88
Lflag_87:
v_cmp_ne_u32 vcc, s88, v10
s_cbranch_vccz Lset_89
s_sleep 2
Lfirst_88:
buffer_load_dword v10, off, s[4:7], s40 sc1
s_waitcnt vmcnt(0)
s_sub_u32 s24, s24, 1
s_cbranch_scc0 Lflag_87
s_endpgm
Lset_89:
buffer_load_dwordx4 v[44:47], v1, s[4:7], s29 offen sc1
buffer_load_dwordx4 v[48:51], v1, s[4:7], s29 offen offset:1024 sc1
buffer_load_dwordx4 v[52:55], v1, s[4:7], s29 offen offset:2048 sc1
buffer_load_dwordx4 v[56:59], v1, s[4:7], s29 offen offset:3072 sc1
buffer_load_dwordx4 v[60:63], v1, s[4:7], s30 offen sc1
buffer_load_dwordx4 v[64:67], v1, s[4:7], s30 offen offset:1024 sc1
buffer_load_dwordx4 v[68:71], v1, s[4:7], s30 offen offset:2048 sc1
buffer_load_dwordx4 v[72:75], v1, s[4:7], s30 offen offset:3072 sc1
Lintime_86:
s_waitcnt vmcnt(0)
v_cmp_ne_u32 s[36:37], s88, v8
buffer_load_dwordx4 v[92:95], v1, s[4:7], s27 offen sc1
buffer_load_dwordx4 v[96:99], v1, s[4:7], s27 offen offset:1024 sc1
buffer_load_dwordx4 v[100:103], v3, s[4:7], s28 offen sc1
s_nop 15
s_nop 13
Lspin_90:
buffer_load_dwordx4 v[92:95], v1, s[4:7], s27 offen sc1
buffer_load_dwordx4 v[96:99], v1, s[4:7], s27 offen offset:1024 sc1
buffer_load_dwordx4 v[100:103], v3, s[4:7], s28 offen sc1
s_sub_u32 s24, s24, 1
s_cbranch_scc1 CODE_END
v_mfma_f32_16x16x32_bf16 v[160:163], v[12:15], v[12:15], 0
s_waitcnt vmcnt(3)
v_max3_u32 v9, v92, v93, v94
v_max3_u32 v9, v9, v95, v96
v_max3_u32 v9, v9, v97, v98
v_max3_u32 v9, v9, v99, v100
v_max3_u32 v9, v9, v101, v102
v_max_u32 v9, v9, v103
v_cmp_eq_u32 vcc, -1, v9
v_smfmac_f32_16x16x64_bf16 v[160:163], v[92:95], v[44:51], v7
v_smfmac_f32_16x16x64_bf16 v[160:163], v[96:99], v[60:67], v7
s_cbranch_vccnz Lspin_90
v_smfmac_f32_16x16x64_bf16 v[160:163], v[100:103], v[76:83], v7
v_smfmac_f32_16x16x64_bf16 v[164:167], v[92:95], v[52:59], v7
v_smfmac_f32_16x16x64_bf16 v[164:167], v[96:99], v[68:75], v7
v_smfmac_f32_16x16x64_bf16 v[164:167], v[100:103], v[84:91], v7
v_permlane32_swap_b32 v160, v162
v_permlane32_swap_b32 v161, v163
v_add_f32 v160, v160, v162
v_add_f32 v161, v161, v163
ds_write2_b32 v4, v160, v161 offset0:0 offset1:16
s_nop 1
v_permlane32_swap_b32 v164, v166
v_permlane32_swap_b32 v165, v167
v_add_f32 v164, v164, v166
v_add_f32 v165, v165, v167
ds_write2_b32 v4, v164, v165 offset0:128 offset1:144
s_waitcnt lgkmcnt(0)
s_barrier
ds_read_b64 v[160:161], v5
ds_read_b64 v[162:163], v5 offset:1024
ds_read_b64 v[164:165], v5 offset:2048
ds_read_b64 v[166:167], v5 offset:3072
s_waitcnt lgkmcnt(2)
v_pk_add_f32 v[160:161], v[160:161], v[162:163]
s_waitcnt lgkmcnt(0)
v_pk_add_f32 v[164:165], v[164:165], v[166:167]
v_pk_add_f32 v[160:161], v[160:161], v[164:165]
v_cvt_pk_bf16_f32 v160, v160, v161
v_min_u32 v160, -2, v160
buffer_store_dword v160, v6, s[4:7], s32 offen
s_cmp_eq_u64 s[36:37], 0
s_cbranch_scc1 Lseen_91
buffer_load_dword v8, off, s[4:7], s31 sc1
s_waitcnt vmcnt(0)
v_cmp_ne_u32 vcc, s88, v8
s_cmp_lg_u64 vcc, 0
s_cselect_b32 s35, 0x40000000, 0
s_add_u32 s29, s29, s35
s_add_u32 s30, s30, s35
Lseen_91:
s_add_u32 s26, s26, 7168
s_add_u32 s32, s32, 7168
s_add_u32 s33, s33, 1
s_add_u32 s27, s27, 10240
s_add_u32 s28, s28, 10240
s_add_u32 s29, s29, 458752
s_add_u32 s30, s30, 458752
s_add_u32 s25, s25, 1
s_cmp_lt_u32 s25, 63
s_cbranch_scc1 S2_STEP0
s_endpgm
S2_W1:
s_sub_u32 s22, s22, 16
v_lshlrev_b32 v1, 4, v0
v_and_b32 v9, 7, v0
v_min_u32 v9, 6, v9
v_lshlrev_b32 v9, 2, v9
v_bfe_u32 v10, v0, 3, 2
v_lshl_add_u32 v9, v10, 7, v9
s_mov_b32 s40, 2560
s_branch Lfirst_93
Lflag_92:
v_cmp_ne_u32 vcc, s88, v10
s_cbranch_vccz Lset_94
s_sleep 4
Lfirst_93:
buffer_load_dword v10, v9, s[4:7], s40 offen sc1
s_waitcnt vmcnt(0)
s_sub_u32 s24, s24, 1
s_cbranch_scc0 Lflag_92
s_endpgm
Lset_94:
s_mul_i32 s40, s22, 458752
s_add_u32 s40, s40, 16416768
s_add_u32 s41, s40, 86016
s_add_u32 s43, s40, 57344
buffer_load_dwordx4 a[0:3], v1, s[4:7], s40 offen
buffer_load_dwordx4 a[4:7], v1, s[4:7], s40 offen offset:1024
buffer_load_dwordx4 a[8:11], v1, s[4:7], s40 offen offset:2048
buffer_load_dwordx4 a[12:15], v1, s[4:7], s40 offen offset:3072
s_add_u32 s40, s40, 4096
buffer_load_dwordx4 a[16:19], v1, s[4:7], s40 offen
buffer_load_dwordx4 a[20:23], v1, s[4:7], s40 offen offset:1024
buffer_load_dwordx4 a[24:27], v1, s[4:7], s40 offen offset:2048
buffer_load_dwordx4 a[28:31], v1, s[4:7], s40 offen offset:3072
s_add_u32 s40, s40, 4096
buffer_load_dwordx4 a[32:35], v1, s[4:7], s40 offen
buffer_load_dwordx4 a[36:39], v1, s[4:7], s40 offen offset:1024
buffer_load_dwordx4 a[40:43], v1, s[4:7], s40 offen offset:2048
buffer_load_dwordx4 a[44:47], v1, s[4:7], s40 offen offset:3072
s_add_u32 s40, s40, 4096
buffer_load_dwordx4 a[48:51], v1, s[4:7], s40 offen
buffer_load_dwordx4 a[52:55], v1, s[4:7], s40 offen offset:1024
buffer_load_dwordx4 a[56:59], v1, s[4:7], s40 offen offset:2048
buffer_load_dwordx4 a[60:63], v1, s[4:7], s40 offen offset:3072
s_add_u32 s40, s40, 4096
buffer_load_dwordx4 a[64:67], v1, s[4:7], s40 offen
buffer_load_dwordx4 a[68:71], v1, s[4:7], s40 offen offset:1024
buffer_load_dwordx4 a[72:75], v1, s[4:7], s40 offen offset:2048
buffer_load_dwordx4 a[76:79], v1, s[4:7], s40 offen offset:3072
s_add_u32 s40, s40, 4096
buffer_load_dwordx4 a[80:83], v1, s[4:7], s40 offen
buffer_load_dwordx4 a[84:87], v1, s[4:7], s40 offen offset:1024
buffer_load_dwordx4 a[88:91], v1, s[4:7], s40 offen offset:2048
buffer_load_dwordx4 a[92:95], v1, s[4:7], s40 offen offset:3072
s_add_u32 s40, s40, 4096
buffer_load_dwordx4 a[96:99], v1, s[4:7], s40 offen
buffer_load_dwordx4 a[100:103], v1, s[4:7], s40 offen offset:1024
buffer_load_dwordx4 a[104:107], v1, s[4:7], s40 offen offset:2048
buffer_load_dwordx4 a[108:111], v1, s[4:7], s40 offen offset:3072
s_add_u32 s40, s40, 4096
buffer_load_dwordx4 a[112:115], v1, s[4:7], s40 offen
buffer_load_dwordx4 a[116:119], v1, s[4:7], s40 offen offset:1024
buffer_load_dwordx4 a[120:123], v1, s[4:7], s40 offen offset:2048
buffer_load_dwordx4 a[124:127], v1, s[4:7], s40 offen offset:3072
s_add_u32 s40, s40, 4096
buffer_load_dwordx4 a[128:131], v1, s[4:7], s40 offen
buffer_load_dwordx4 a[132:135], v1, s[4:7], s40 offen offset:1024
buffer_load_dwordx4 a[136:139], v1, s[4:7], s40 offen offset:2048
buffer_load_dwordx4 a[140:143], v1, s[4:7], s40 offen offset:3072
s_add_u32 s40, s40, 4096
buffer_load_dwordx4 a[144:147], v1, s[4:7], s40 offen
buffer_load_dwordx4 a[148:151], v1, s[4:7], s40 offen offset:1024
buffer_load_dwordx4 a[152:155], v1, s[4:7], s40 offen offset:2048
buffer_load_dwordx4 a[156:159], v1, s[4:7], s40 offen offset:3072
s_add_u32 s40, s40, 4096
s_waitcnt vmcnt(32)
buffer_load_dwordx4 a[160:163], v1, s[4:7], s40 offen
buffer_load_dwordx4 a[164:167], v1, s[4:7], s40 offen offset:1024
buffer_load_dwordx4 a[168:171], v1, s[4:7], s40 offen offset:2048
buffer_load_dwordx4 a[172:175], v1, s[4:7], s40 offen offset:3072
s_add_u32 s40, s40, 4096
buffer_load_dwordx4 a[176:179], v1, s[4:7], s40 offen
buffer_load_dwordx4 a[180:183], v1, s[4:7], s40 offen offset:1024
buffer_load_dwordx4 a[184:187], v1, s[4:7], s40 offen offset:2048
buffer_load_dwordx4 a[188:191], v1, s[4:7], s40 offen offset:3072
s_add_u32 s40, s40, 4096
s_waitcnt vmcnt(32)
buffer_load_dwordx4 a[192:195], v1, s[4:7], s40 offen
buffer_load_dwordx4 a[196:199], v1, s[4:7], s40 offen offset:1024
buffer_load_dwordx4 a[200:203], v1, s[4:7], s40 offen offset:2048
buffer_load_dwordx4 a[204:207], v1, s[4:7], s40 offen offset:3072
s_add_u32 s40, s40, 4096
buffer_load_dwordx4 a[208:211], v1, s[4:7], s40 offen
buffer_load_dwordx4 a[212:215], v1, s[4:7], s40 offen offset:1024
buffer_load_dwordx4 a[216:219], v1, s[4:7], s40 offen offset:2048
buffer_load_dwordx4 a[220:223], v1, s[4:7], s40 offen offset:3072
s_waitcnt vmcnt(40)
s_mov_b32 m0, 77824
s_add_u32 s42, s41, 0
buffer_load_dwordx4 v1, s[4:7], s42 offen lds
s_mov_b32 m0, 78848
s_add_u32 s42, s41, 1024
buffer_load_dwordx4 v1, s[4:7], s42 offen lds
s_mov_b32 m0, 79872
s_add_u32 s42, s41, 2048
buffer_load_dwordx4 v1, s[4:7], s42 offen lds
s_mov_b32 m0, 80896
s_add_u32 s42, s41, 3072
buffer_load_dwordx4 v1, s[4:7], s42 offen lds
s_mov_b32 m0, 81920
s_add_u32 s42, s41, 4096
buffer_load_dwordx4 v1, s[4:7], s42 offen lds
s_mov_b32 m0, 82944
s_add_u32 s42, s41, 5120
buffer_load_dwordx4 v1, s[4:7], s42 offen lds
s_mov_b32 m0, 83968
s_add_u32 s42, s41, 6144
buffer_load_dwordx4 v1, s[4:7], s42 offen lds
s_mov_b32 m0, 84992
s_add_u32 s42, s41, 7168
buffer_load_dwordx4 v1, s[4:7], s42 offen lds
s_waitcnt vmcnt(40)
s_mov_b32 m0, 86016
s_add_u32 s42, s41, 8192
buffer_load_dwordx4 v1, s[4:7], s42 offen lds
s_mov_b32 m0, 87040
s_add_u32 s42, s41, 9216
buffer_load_dwordx4 v1, s[4:7], s42 offen lds
s_mov_b32 m0, 88064
s_add_u32 s42, s41, 10240
buffer_load_dwordx4 v1, s[4:7], s42 offen lds
s_mov_b32 m0, 89088
s_add_u32 s42, s41, 11264
buffer_load_dwordx4 v1, s[4:7], s42 offen lds
s_mov_b32 m0, 90112
s_add_u32 s42, s41, 12288
buffer_load_dwordx4 v1, s[4:7], s42 offen lds
s_mov_b32 m0, 91136
s_add_u32 s42, s41, 13312
buffer_load_dwordx4 v1, s[4:7], s42 offen lds
s_mov_b32 m0, 92160
s_add_u32 s42, s41, 14336
buffer_load_dwordx4 v1, s[4:7], s42 offen lds
s_mov_b32 m0, 93184
s_add_u32 s42, s41, 15360
buffer_load_dwordx4 v1, s[4:7], s42 offen lds
s_waitcnt vmcnt(40)
s_mov_b32 m0, 94208
s_add_u32 s42, s41, 16384
buffer_load_dwordx4 v1, s[4:7], s42 offen lds
s_mov_b32 m0, 95232
s_add_u32 s42, s41, 17408
buffer_load_dwordx4 v1, s[4:7], s42 offen lds
s_mov_b32 m0, 96256
s_add_u32 s42, s41, 18432
buffer_load_dwordx4 v1, s[4:7], s42 offen lds
s_mov_b32 m0, 97280
s_add_u32 s42, s41, 19456
buffer_load_dwordx4 v1, s[4:7], s42 offen lds
s_mov_b32 m0, 98304
s_add_u32 s42, s41, 20480
buffer_load_dwordx4 v1, s[4:7], s42 offen lds
s_mov_b32 m0, 99328
s_add_u32 s42, s41, 21504
buffer_load_dwordx4 v1, s[4:7], s42 offen lds
s_mov_b32 m0, 100352
s_add_u32 s42, s41, 22528
buffer_load_dwordx4 v1, s[4:7], s42 offen lds
s_mov_b32 m0, 101376
s_add_u32 s42, s41, 23552
buffer_load_dwordx4 v1, s[4:7], s42 offen lds
s_waitcnt vmcnt(40)
s_mov_b32 m0, 102400
s_add_u32 s42, s41, 24576
buffer_load_dwordx4 v1, s[4:7], s42 offen lds
s_mov_b32 m0, 103424
s_add_u32 s42, s41, 25600
buffer_load_dwordx4 v1, s[4:7], s42 offen lds
s_mov_b32 m0, 104448
s_add_u32 s42, s41, 26624
buffer_load_dwordx4 v1, s[4:7], s42 offen lds
s_mov_b32 m0, 105472
s_add_u32 s42, s41, 27648
buffer_load_dwordx4 v1, s[4:7], s42 offen lds
s_waitcnt vmcnt(52)
buffer_load_dwordx4 a[224:227], v1, s[4:7], s43 offen
buffer_load_dwordx4 a[228:231], v1, s[4:7], s43 offen offset:1024
buffer_load_dwordx4 a[232:235], v1, s[4:7], s43 offen offset:2048
buffer_load_dwordx4 a[236:239], v1, s[4:7], s43 offen offset:3072
s_add_u32 s43, s43, 4096
s_waitcnt vmcnt(52)
buffer_load_dwordx4 a[240:243], v1, s[4:7], s43 offen
buffer_load_dwordx4 a[244:247], v1, s[4:7], s43 offen offset:1024
buffer_load_dwordx4 a[248:251], v1, s[4:7], s43 offen offset:2048
buffer_load_dwordx4 a[252:255], v1, s[4:7], s43 offen offset:3072
s_add_u32 s43, s43, 4096
s_waitcnt vmcnt(52)
buffer_load_dwordx4 v[176:179], v1, s[4:7], s43 offen
buffer_load_dwordx4 v[180:183], v1, s[4:7], s43 offen offset:1024
buffer_load_dwordx4 v[184:187], v1, s[4:7], s43 offen offset:2048
buffer_load_dwordx4 v[188:191], v1, s[4:7], s43 offen offset:3072
s_add_u32 s43, s43, 4096
s_waitcnt vmcnt(52)
buffer_load_dwordx4 v[192:195], v1, s[4:7], s43 offen
buffer_load_dwordx4 v[196:199], v1, s[4:7], s43 offen offset:1024
buffer_load_dwordx4 v[200:203], v1, s[4:7], s43 offen offset:2048
buffer_load_dwordx4 v[204:207], v1, s[4:7], s43 offen offset:3072
s_add_u32 s43, s43, 4096
s_waitcnt vmcnt(52)
buffer_load_dwordx4 v[208:211], v1, s[4:7], s43 offen
buffer_load_dwordx4 v[212:215], v1, s[4:7], s43 offen offset:1024
buffer_load_dwordx4 v[216:219], v1, s[4:7], s43 offen offset:2048
buffer_load_dwordx4 v[220:223], v1, s[4:7], s43 offen offset:3072
s_add_u32 s43, s43, 4096
s_waitcnt vmcnt(52)
buffer_load_dwordx4 v[224:227], v1, s[4:7], s43 offen
buffer_load_dwordx4 v[228:231], v1, s[4:7], s43 offen offset:1024
buffer_load_dwordx4 v[232:235], v1, s[4:7], s43 offen offset:2048
buffer_load_dwordx4 v[236:239], v1, s[4:7], s43 offen offset:3072
s_add_u32 s43, s43, 4096
s_waitcnt vmcnt(52)
buffer_load_dwordx4 v[240:243], v1, s[4:7], s43 offen
buffer_load_dwordx4 v[244:247], v1, s[4:7], s43 offen offset:1024
buffer_load_dwordx4 v[248:251], v1, s[4:7], s43 offen offset:2048
buffer_load_dwordx4 v[252:255], v1, s[4:7], s43 offen offset:3072
s_add_u32 s43, s43, 4096
v_add_u32 v2, 77824, v1
v_and_b32 v9, 15, v0
v_lshrrev_b32 v10, 5, v0
v_lshlrev_b32 v3, 4, v9
v_lshl_add_u32 v3, v10, 8, v3
v_bfe_u32 v4, v0, 5, 1
v_bfe_u32 v10, v0, 4, 1
v_lshl_add_u32 v4, v10, 1, v4
v_lshlrev_b32 v4, 7, v4
v_lshl_add_u32 v4, v9, 2, v4
v_add_u32 v4, 9216, v4
v_lshlrev_b32 v5, 3, v0
v_add_u32 v5, 8704, v5
v_lshrrev_b32 v9, 3, v0
v_lshlrev_b32 v6, 4, v9
v_bfe_u32 v9, v0, 2, 1
v_lshl_add_u32 v6, v9, 7, v6
v_and_b32 v9, 3, v0
v_lshl_add_u32 v6, v9, 2, v6
v_and_b32 v9, 8, v0
v_cmp_eq_u32 vcc, 0, v9
v_mov_b32 v9, 0x88884444
v_mov_b32 v7, 0xddddeeee
v_cndmask_b32 v7, v7, v9, vcc
s_mul_i32 s26, s23, 458752
s_add_u32 s26, s26, 178176
s_mov_b32 s27, 1095680
s_mov_b32 s28, 1102336
s_lshl_b32 s29, s22, 15
s_add_u32 s29, s29, 30072832
s_add_u32 s30, s29, 4096
s_lshl_b32 s31, s22, 7
s_add_u32 s31, s31, 8196
s_lshl_b32 s32, s22, 9
s_add_u32 s32, s32, 183552
s_mov_b32 s25, 0
s_mov_b32 s89, 172032
s_lshl_b32 s34, s22, 2
s_add_u32 s34, s34, 172288
s_add_u32 s33, s88, 1
buffer_load_dword v8, off, s[4:7], s31 sc1
v_mov_b32 v128, 0
v_mov_b32 v129, 0
v_mov_b32 v130, 0
v_mov_b32 v131, 0
v_mov_b32 v132, 0
v_mov_b32 v133, 0
v_mov_b32 v134, 0
v_mov_b32 v135, 0
v_mov_b32 v136, 0
v_mov_b32 v137, 0
v_mov_b32 v138, 0
v_mov_b32 v139, 0
v_mov_b32 v140, 0
v_mov_b32 v141, 0
v_mov_b32 v142, 0
v_mov_b32 v143, 0
v_mov_b32 v144, 0
v_mov_b32 v145, 0
v_mov_b32 v146, 0
v_mov_b32 v147, 0
v_mov_b32 v148, 0
v_mov_b32 v149, 0
v_mov_b32 v150, 0
v_mov_b32 v151, 0
v_mov_b32 v152, 0
v_mov_b32 v153, 0
v_mov_b32 v154, 0
v_mov_b32 v155, 0
v_mov_b32 v156, 0
v_mov_b32 v157, 0
v_mov_b32 v158, 0
v_mov_b32 v159, 0
v_min_u32 v12, 55, v0
v_and_b32 v9, 3, v12
v_lshlrev_b32 v9, 3, v9
v_lshrrev_b32 v12, 2, v12
v_lshl_add_u32 v9, v12, 7, v9
s_mov_b32 s43, 4352
Llz_95:
buffer_load_dwordx2 v[12:13], v9, s[4:7], s43 offen sc1
s_waitcnt vmcnt(0)
v_cmp_ne_u32 vcc, s88, v12
v_cmp_ne_u32 s[40:41], s88, v13
s_or_b64 vcc, vcc, s[40:41]
s_cbranch_vccz Llzok_96
s_sleep 8
s_sub_u32 s24, s24, 1
s_cbranch_scc0 Llz_95
s_endpgm
Llzok_96:
v_cmp_ne_u32 vcc, s88, v8
s_cmp_lg_u64 vcc, 0
s_cselect_b32 s35, 0x40000000, 0
s_add_u32 s29, s29, s35
s_add_u32 s30, s30, s35
v_mov_b32 v12, 0
v_mov_b32 v13, 0
v_mov_b32 v14, 0
v_mov_b32 v15, 0
.p2align 6
s_nop 0
S2_STEP1:
ds_read_b128 v[104:107], v2 offset:4096
ds_read_b128 v[108:111], v2 offset:5120
ds_read_b128 v[112:115], v2 offset:6144
ds_read_b128 v[116:119], v2 offset:7168
ds_read_b128 v[120:123], v2
ds_read_b128 v[124:127], v2 offset:1024
v_mov_b32 v128, 0
v_mov_b32 v129, 0
v_mov_b32 v130, 0
v_mov_b32 v131, 0
v_mov_b32 v132, 0
v_mov_b32 v133, 0
v_mov_b32 v134, 0
v_mov_b32 v135, 0
v_mov_b32 v136, 0
v_mov_b32 v137, 0
v_mov_b32 v138, 0
v_mov_b32 v139, 0
v_mov_b32 v140, 0
v_mov_b32 v141, 0
v_mov_b32 v142, 0
v_mov_b32 v143, 0
Lspin_97:
buffer_load_dwordx4 v[24:27], v1, s[4:7], s26 offen sc1
buffer_load_dwordx4 v[28:31], v1, s[4:7], s26 offen offset:1024 sc1
s_sub_u32 s24, s24, 1
s_cbranch_scc1 CODE_END
s_waitcnt vmcnt(0)
v_max3_u32 v9, v24, v25, v26
v_max3_u32 v9, v9, v27, v28
v_max3_u32 v9, v9, v29, v30
v_max_u32 v9, v9, v31
v_cmp_eq_u32 vcc, -1, v9
s_cbranch_vccnz Lspin_97
ds_write_b128 v1, v[24:27] offset:2048
ds_write_b128 v1, v[28:31] offset:3072
s_add_u32 s31, s31, 1792
s_waitcnt lgkmcnt(0)
s_barrier
ds_read_b128 v[16:19], v1
ds_read_b128 v[20:23], v1 offset:1024
ds_read_b128 v[32:35], v1 offset:4096
ds_read_b128 v[36:39], v1 offset:5120
ds_read_b128 v[40:43], v1 offset:6144
buffer_load_dword v8, off, s[4:7], s31 sc1
v_smfmac_f32_16x16x64_bf16 v[128:131], v[24:27], a[16:23], v7
v_smfmac_f32_16x16x64_bf16 v[132:135], v[24:27], a[72:79], v7
v_smfmac_f32_16x16x64_bf16 v[136:139], v[24:27], a[128:135], v7
v_mov_b32 v144, 0
v_mov_b32 v158, 0
v_smfmac_f32_16x16x64_bf16 v[140:143], v[24:27], v[104:111], v7
buffer_load_dwordx4 v[44:47], v1, s[4:7], s29 offen sc1
v_mov_b32 v145, 0
v_mov_b32 v159, 0
v_smfmac_f32_16x16x64_bf16 v[128:131], v[28:31], a[24:31], v7
ds_read_b128 v[104:107], v2 offset:2048
v_smfmac_f32_16x16x64_bf16 v[132:135], v[28:31], a[80:87], v7
ds_read_b128 v[108:111], v2 offset:3072
v_smfmac_f32_16x16x64_bf16 v[136:139], v[28:31], a[136:143], v7
v_mov_b32 v146, 0
v_smfmac_f32_16x16x64_bf16 v[140:143], v[28:31], v[112:119], v7
buffer_load_dwordx4 v[48:51], v1, s[4:7], s29 offen offset:1024 sc1
v_mov_b32 v147, 0
s_waitcnt lgkmcnt(6)
v_smfmac_f32_16x16x64_bf16 v[128:131], v[16:19], a[0:7], v7
ds_read_b128 v[112:115], v2 offset:8192
v_smfmac_f32_16x16x64_bf16 v[132:135], v[16:19], a[56:63], v7
ds_read_b128 v[116:119], v2 offset:9216
v_smfmac_f32_16x16x64_bf16 v[136:139], v[16:19], a[112:119], v7
v_mov_b32 v148, 0
v_smfmac_f32_16x16x64_bf16 v[140:143], v[16:19], v[120:127], v7
buffer_load_dwordx4 v[52:55], v1, s[4:7], s29 offen offset:2048 sc1
v_mov_b32 v149, 0
s_waitcnt lgkmcnt(7)
v_smfmac_f32_16x16x64_bf16 v[128:131], v[20:23], a[8:15], v7
ds_read_b128 v[120:123], v2 offset:10240
v_smfmac_f32_16x16x64_bf16 v[132:135], v[20:23], a[64:71], v7
ds_read_b128 v[124:127], v2 offset:11264
v_smfmac_f32_16x16x64_bf16 v[136:139], v[20:23], a[120:127], v7
v_mov_b32 v150, 0
s_waitcnt lgkmcnt(4)
v_smfmac_f32_16x16x64_bf16 v[140:143], v[20:23], v[104:111], v7
buffer_load_dwordx4 v[56:59], v1, s[4:7], s29 offen offset:3072 sc1
v_mov_b32 v151, 0
v_smfmac_f32_16x16x64_bf16 v[128:131], v[32:35], a[32:39], v7
ds_read_b128 v[104:107], v2 offset:12288
v_smfmac_f32_16x16x64_bf16 v[132:135], v[32:35], a[88:95], v7
ds_read_b128 v[108:111], v2 offset:13312
v_smfmac_f32_16x16x64_bf16 v[136:139], v[32:35], a[144:151], v7
v_mov_b32 v152, 0
s_waitcnt lgkmcnt(4)
v_smfmac_f32_16x16x64_bf16 v[140:143], v[32:35], v[112:119], v7
buffer_load_dwordx4 v[60:63], v1, s[4:7], s30 offen sc1
v_mov_b32 v153, 0
v_smfmac_f32_16x16x64_bf16 v[128:131], v[36:39], a[40:47], v7
ds_read_b128 v[112:115], v2 offset:18432
v_smfmac_f32_16x16x64_bf16 v[132:135], v[36:39], a[96:103], v7
ds_read_b128 v[116:119], v2 offset:19456
v_smfmac_f32_16x16x64_bf16 v[136:139], v[36:39], a[152:159], v7
v_mov_b32 v154, 0
s_waitcnt lgkmcnt(4)
v_smfmac_f32_16x16x64_bf16 v[140:143], v[36:39], v[120:127], v7
buffer_load_dwordx4 v[64:67], v1, s[4:7], s30 offen offset:1024 sc1
v_mov_b32 v155, 0
v_smfmac_f32_16x16x64_bf16 v[128:131], v[40:43], a[48:55], v7
ds_read_b128 v[120:123], v2 offset:20480
v_smfmac_f32_16x16x64_bf16 v[132:135], v[40:43], a[104:111], v7
ds_read_b128 v[124:127], v2 offset:21504
v_smfmac_f32_16x16x64_bf16 v[136:139], v[40:43], a[160:167], v7
v_mov_b32 v156, 0
s_waitcnt lgkmcnt(4)
v_smfmac_f32_16x16x64_bf16 v[140:143], v[40:43], v[104:111], v7
buffer_load_dwordx4 v[68:71], v1, s[4:7], s30 offen offset:2048 sc1
v_mov_b32 v157, 0
v_smfmac_f32_16x16x64_bf16 v[144:147], v[24:27], a[184:191], v7
ds_read_b128 v[104:107], v2 offset:14336
v_smfmac_f32_16x16x64_bf16 v[148:151], v[24:27], a[240:247], v7
ds_read_b128 v[108:111], v2 offset:15360
v_smfmac_f32_16x16x64_bf16 v[152:155], v[24:27], v[216:223], v7
v_cvt_pk_bf16_f32 v76, v128, v129
s_waitcnt lgkmcnt(4)
v_smfmac_f32_16x16x64_bf16 v[156:159], v[24:27], v[112:119], v7
buffer_load_dwordx4 v[72:75], v1, s[4:7], s30 offen offset:3072 sc1
v_cvt_pk_bf16_f32 v77, v130, v131
v_smfmac_f32_16x16x64_bf16 v[144:147], v[28:31], a[192:199], v7
ds_read_b128 v[112:115], v2 offset:16384
v_smfmac_f32_16x16x64_bf16 v[148:151], v[28:31], a[248:255], v7
ds_read_b128 v[116:119], v2 offset:17408
v_smfmac_f32_16x16x64_bf16 v[152:155], v[28:31], v[224:231], v7
v_cvt_pk_bf16_f32 v84, v132, v133
s_waitcnt lgkmcnt(4)
v_smfmac_f32_16x16x64_bf16 v[156:159], v[28:31], v[120:127], v7
v_cvt_pk_bf16_f32 v85, v134, v135
v_smfmac_f32_16x16x64_bf16 v[144:147], v[16:19], a[168:175], v7
ds_read_b128 v[120:123], v2 offset:22528
v_smfmac_f32_16x16x64_bf16 v[148:151], v[16:19], a[224:231], v7
ds_read_b128 v[124:127], v2 offset:23552
v_smfmac_f32_16x16x64_bf16 v[152:155], v[16:19], v[200:207], v7
v_cvt_pk_bf16_f32 v78, v136, v137
s_waitcnt lgkmcnt(4)
v_smfmac_f32_16x16x64_bf16 v[156:159], v[16:19], v[104:111], v7
v_cvt_pk_bf16_f32 v79, v138, v139
v_smfmac_f32_16x16x64_bf16 v[144:147], v[20:23], a[176:183], v7
ds_read_b128 v[104:107], v2 offset:24576
v_smfmac_f32_16x16x64_bf16 v[148:151], v[20:23], a[232:239], v7
ds_read_b128 v[108:111], v2 offset:25600
v_smfmac_f32_16x16x64_bf16 v[152:155], v[20:23], v[208:215], v7
v_cvt_pk_bf16_f32 v82, v140, v141
s_waitcnt lgkmcnt(4)
v_smfmac_f32_16x16x64_bf16 v[156:159], v[20:23], v[112:119], v7
v_cvt_pk_bf16_f32 v83, v142, v143
v_smfmac_f32_16x16x64_bf16 v[144:147], v[32:35], a[200:207], v7
ds_read_b128 v[112:115], v2 offset:26624
v_smfmac_f32_16x16x64_bf16 v[148:151], v[32:35], v[176:183], v7
ds_read_b128 v[116:119], v2 offset:27648
v_smfmac_f32_16x16x64_bf16 v[152:155], v[32:35], v[232:239], v7
s_waitcnt lgkmcnt(4)
v_smfmac_f32_16x16x64_bf16 v[156:159], v[32:35], v[120:127], v7
v_smfmac_f32_16x16x64_bf16 v[144:147], v[36:39], a[208:215], v7
v_smfmac_f32_16x16x64_bf16 v[148:151], v[36:39], v[184:191], v7
v_smfmac_f32_16x16x64_bf16 v[152:155], v[36:39], v[240:247], v7
s_waitcnt lgkmcnt(2)
v_smfmac_f32_16x16x64_bf16 v[156:159], v[36:39], v[104:111], v7
v_smfmac_f32_16x16x64_bf16 v[144:147], v[40:43], a[216:223], v7
v_smfmac_f32_16x16x64_bf16 v[148:151], v[40:43], v[192:199], v7
v_smfmac_f32_16x16x64_bf16 v[152:155], v[40:43], v[248:255], v7
s_waitcnt lgkmcnt(0)
v_smfmac_f32_16x16x64_bf16 v[156:159], v[40:43], v[112:119], v7
s_nop 2
v_cvt_pk_bf16_f32 v86, v144, v145
v_cvt_pk_bf16_f32 v87, v146, v147
v_cvt_pk_bf16_f32 v80, v148, v149
v_cvt_pk_bf16_f32 v81, v150, v151
v_cvt_pk_bf16_f32 v88, v152, v153
v_cvt_pk_bf16_f32 v89, v154, v155
v_cvt_pk_bf16_f32 v90, v156, v157
v_cvt_pk_bf16_f32 v91, v158, v159
v_mov_b32 v160, 0
v_mov_b32 v161, 0
v_mov_b32 v162, 0
v_mov_b32 v163, 0
v_mov_b32 v164, 0
v_mov_b32 v165, 0
v_mov_b32 v166, 0
v_mov_b32 v167, 0
s_cmp_eq_u32 s35, 0
s_cbranch_scc1 Lintime_98
s_sub_u32 s29, s29, s35
s_sub_u32 s30, s30, s35
s_mov_b32 s35, 0
s_sub_u32 s40, s31, 1792
s_branch Lfirst_100
Lflag_99:
v_cmp_ne_u32 vcc, s88, v10
s_cbranch_vccz Lset_101
s_sleep 2
Lfirst_100:
buffer_load_dword v10, off, s[4:7], s40 sc1
s_waitcnt vmcnt(0)
s_sub_u32 s24, s24, 1
s_cbranch_scc0 Lflag_99
s_endpgm
Lset_101:
buffer_load_dwordx4 v[44:47], v1, s[4:7], s29 offen sc1
buffer_load_dwordx4 v[48:51], v1, s[4:7], s29 offen offset:1024 sc1
buffer_load_dwordx4 v[52:55], v1, s[4:7], s29 offen offset:2048 sc1
buffer_load_dwordx4 v[56:59], v1, s[4:7], s29 offen offset:3072 sc1
buffer_load_dwordx4 v[60:63], v1, s[4:7], s30 offen sc1
buffer_load_dwordx4 v[64:67], v1, s[4:7], s30 offen offset:1024 sc1
buffer_load_dwordx4 v[68:71], v1, s[4:7], s30 offen offset:2048 sc1
buffer_load_dwordx4 v[72:75], v1, s[4:7], s30 offen offset:3072 sc1
Lintime_98:
s_waitcnt vmcnt(0)
v_cmp_ne_u32 s[36:37], s88, v8
buffer_load_dwordx4 v[92:95], v1, s[4:7], s27 offen sc1
buffer_load_dwordx4 v[96:99], v1, s[4:7], s27 offen offset:1024 sc1
buffer_load_dwordx4 v[100:103], v3, s[4:7], s28 offen sc1
s_nop 15
s_nop 13
Lspin_102:
buffer_load_dwordx4 v[92:95], v1, s[4:7], s27 offen sc1
buffer_load_dwordx4 v[96:99], v1, s[4:7], s27 offen offset:1024 sc1
buffer_load_dwordx4 v[100:103], v3, s[4:7], s28 offen sc1
s_sub_u32 s24, s24, 1
s_cbranch_scc1 CODE_END
v_mfma_f32_16x16x32_bf16 v[160:163], v[12:15], v[12:15], 0
s_waitcnt vmcnt(3)
v_max3_u32 v9, v92, v93, v94
v_max3_u32 v9, v9, v95, v96
v_max3_u32 v9, v9, v97, v98
v_max3_u32 v9, v9, v99, v100
v_max3_u32 v9, v9, v101, v102
v_max_u32 v9, v9, v103
v_cmp_eq_u32 vcc, -1, v9
v_smfmac_f32_16x16x64_bf16 v[160:163], v[92:95], v[44:51], v7
v_smfmac_f32_16x16x64_bf16 v[160:163], v[96:99], v[60:67], v7
s_cbranch_vccnz Lspin_102
v_smfmac_f32_16x16x64_bf16 v[160:163], v[100:103], v[76:83], v7
v_smfmac_f32_16x16x64_bf16 v[164:167], v[92:95], v[52:59], v7
v_smfmac_f32_16x16x64_bf16 v[164:167], v[96:99], v[68:75], v7
v_smfmac_f32_16x16x64_bf16 v[164:167], v[100:103], v[84:91], v7
v_permlane32_swap_b32 v160, v162
v_permlane32_swap_b32 v161, v163
v_add_f32 v160, v160, v162
v_add_f32 v161, v161, v163
ds_write2_b32 v4, v160, v161 offset0:0 offset1:16
s_nop 1
v_permlane32_swap_b32 v164, v166
v_permlane32_swap_b32 v165, v167
v_add_f32 v164, v164, v166
v_add_f32 v165, v165, v167
ds_write2_b32 v4, v164, v165 offset0:128 offset1:144
s_waitcnt lgkmcnt(0)
s_barrier
ds_read_b64 v[160:161], v5
ds_read_b64 v[162:163], v5 offset:1024
ds_read_b64 v[164:165], v5 offset:2048
ds_read_b64 v[166:167], v5 offset:3072
s_waitcnt lgkmcnt(2)
v_pk_add_f32 v[160:161], v[160:161], v[162:163]
s_waitcnt lgkmcnt(0)
v_pk_add_f32 v[164:165], v[164:165], v[166:167]
v_pk_add_f32 v[160:161], v[160:161], v[164:165]
v_cvt_pk_bf16_f32 v160, v160, v161
v_min_u32 v160, -2, v160
buffer_store_dword v160, v6, s[4:7], s32 offen
s_cmp_eq_u64 s[36:37], 0
s_cbranch_scc1 Lseen_103
buffer_load_dword v8, off, s[4:7], s31 sc1
s_waitcnt vmcnt(0)
v_cmp_ne_u32 vcc, s88, v8
s_cmp_lg_u64 vcc, 0
s_cselect_b32 s35, 0x40000000, 0
s_add_u32 s29, s29, s35
s_add_u32 s30, s30, s35
Lseen_103:
s_add_u32 s26, s26, 7168
s_add_u32 s32, s32, 7168
s_add_u32 s33, s33, 1
s_add_u32 s27, s27, 10240
s_add_u32 s28, s28, 10240
s_add_u32 s29, s29, 458752
s_add_u32 s30, s30, 458752
s_add_u32 s25, s25, 1
s_cmp_lt_u32 s25, 63
s_cbranch_scc1 S2_STEP1
s_endpgm
S2_W2:
s_sub_u32 s22, s22, 16
v_lshlrev_b32 v1, 4, v0
v_and_b32 v9, 7, v0
v_min_u32 v9, 6, v9
v_lshlrev_b32 v9, 2, v9
v_bfe_u32 v10, v0, 3, 2
v_lshl_add_u32 v9, v10, 7, v9
s_mov_b32 s40, 3072
s_branch Lfirst_105
Lflag_104:
v_cmp_ne_u32 vcc, s88, v10
s_cbranch_vccz Lset_106
s_sleep 4
Lfirst_105:
buffer_load_dword v10, v9, s[4:7], s40 offen sc1
s_waitcnt vmcnt(0)
s_sub_u32 s24, s24, 1
s_cbranch_scc0 Lflag_104
s_endpgm
Lset_106:
s_mul_i32 s40, s22, 458752
s_add_u32 s40, s40, 16531456
s_add_u32 s41, s40, 86016
s_add_u32 s43, s40, 57344
buffer_load_dwordx4 a[0:3], v1, s[4:7], s40 offen
buffer_load_dwordx4 a[4:7], v1, s[4:7], s40 offen offset:1024
buffer_load_dwordx4 a[8:11], v1, s[4:7], s40 offen offset:2048
buffer_load_dwordx4 a[12:15], v1, s[4:7], s40 offen offset:3072
s_add_u32 s40, s40, 4096
buffer_load_dwordx4 a[16:19], v1, s[4:7], s40 offen
buffer_load_dwordx4 a[20:23], v1, s[4:7], s40 offen offset:1024
buffer_load_dwordx4 a[24:27], v1, s[4:7], s40 offen offset:2048
buffer_load_dwordx4 a[28:31], v1, s[4:7], s40 offen offset:3072
s_add_u32 s40, s40, 4096
buffer_load_dwordx4 a[32:35], v1, s[4:7], s40 offen
buffer_load_dwordx4 a[36:39], v1, s[4:7], s40 offen offset:1024
buffer_load_dwordx4 a[40:43], v1, s[4:7], s40 offen offset:2048
buffer_load_dwordx4 a[44:47], v1, s[4:7], s40 offen offset:3072
s_add_u32 s40, s40, 4096
buffer_load_dwordx4 a[48:51], v1, s[4:7], s40 offen
buffer_load_dwordx4 a[52:55], v1, s[4:7], s40 offen offset:1024
buffer_load_dwordx4 a[56:59], v1, s[4:7], s40 offen offset:2048
buffer_load_dwordx4 a[60:63], v1, s[4:7], s40 offen offset:3072
s_add_u32 s40, s40, 4096
buffer_load_dwordx4 a[64:67], v1, s[4:7], s40 offen
buffer_load_dwordx4 a[68:71], v1, s[4:7], s40 offen offset:1024
buffer_load_dwordx4 a[72:75], v1, s[4:7], s40 offen offset:2048
buffer_load_dwordx4 a[76:79], v1, s[4:7], s40 offen offset:3072
s_add_u32 s40, s40, 4096
buffer_load_dwordx4 a[80:83], v1, s[4:7], s40 offen
buffer_load_dwordx4 a[84:87], v1, s[4:7], s40 offen offset:1024
buffer_load_dwordx4 a[88:91], v1, s[4:7], s40 offen offset:2048
buffer_load_dwordx4 a[92:95], v1, s[4:7], s40 offen offset:3072
s_add_u32 s40, s40, 4096
buffer_load_dwordx4 a[96:99], v1, s[4:7], s40 offen
buffer_load_dwordx4 a[100:103], v1, s[4:7], s40 offen offset:1024
buffer_load_dwordx4 a[104:107], v1, s[4:7], s40 offen offset:2048
buffer_load_dwordx4 a[108:111], v1, s[4:7], s40 offen offset:3072
s_add_u32 s40, s40, 4096
buffer_load_dwordx4 a[112:115], v1, s[4:7], s40 offen
buffer_load_dwordx4 a[116:119], v1, s[4:7], s40 offen offset:1024
buffer_load_dwordx4 a[120:123], v1, s[4:7], s40 offen offset:2048
buffer_load_dwordx4 a[124:127], v1, s[4:7], s40 offen offset:3072
s_add_u32 s40, s40, 4096
buffer_load_dwordx4 a[128:131], v1, s[4:7], s40 offen
buffer_load_dwordx4 a[132:135], v1, s[4:7], s40 offen offset:1024
buffer_load_dwordx4 a[136:139], v1, s[4:7], s40 offen offset:2048
buffer_load_dwordx4 a[140:143], v1, s[4:7], s40 offen offset:3072
s_add_u32 s40, s40, 4096
buffer_load_dwordx4 a[144:147], v1, s[4:7], s40 offen
buffer_load_dwordx4 a[148:151], v1, s[4:7], s40 offen offset:1024
buffer_load_dwordx4 a[152:155], v1, s[4:7], s40 offen offset:2048
buffer_load_dwordx4 a[156:159], v1, s[4:7], s40 offen offset:3072
s_add_u32 s40, s40, 4096
s_waitcnt vmcnt(32)
buffer_load_dwordx4 a[160:163], v1, s[4:7], s40 offen
buffer_load_dwordx4 a[164:167], v1, s[4:7], s40 offen offset:1024
buffer_load_dwordx4 a[168:171], v1, s[4:7], s40 offen offset:2048
buffer_load_dwordx4 a[172:175], v1, s[4:7], s40 offen offset:3072
s_add_u32 s40, s40, 4096
buffer_load_dwordx4 a[176:179], v1, s[4:7], s40 offen
buffer_load_dwordx4 a[180:183], v1, s[4:7], s40 offen offset:1024
buffer_load_dwordx4 a[184:187], v1, s[4:7], s40 offen offset:2048
buffer_load_dwordx4 a[188:191], v1, s[4:7], s40 offen offset:3072
s_add_u32 s40, s40, 4096
s_waitcnt vmcnt(32)
buffer_load_dwordx4 a[192:195], v1, s[4:7], s40 offen
buffer_load_dwordx4 a[196:199], v1, s[4:7], s40 offen offset:1024
buffer_load_dwordx4 a[200:203], v1, s[4:7], s40 offen offset:2048
buffer_load_dwordx4 a[204:207], v1, s[4:7], s40 offen offset:3072
s_add_u32 s40, s40, 4096
buffer_load_dwordx4 a[208:211], v1, s[4:7], s40 offen
buffer_load_dwordx4 a[212:215], v1, s[4:7], s40 offen offset:1024
buffer_load_dwordx4 a[216:219], v1, s[4:7], s40 offen offset:2048
buffer_load_dwordx4 a[220:223], v1, s[4:7], s40 offen offset:3072
s_waitcnt vmcnt(40)
s_mov_b32 m0, 106496
s_add_u32 s42, s41, 0
buffer_load_dwordx4 v1, s[4:7], s42 offen lds
s_mov_b32 m0, 107520
s_add_u32 s42, s41, 1024
buffer_load_dwordx4 v1, s[4:7], s42 offen lds
s_mov_b32 m0, 108544
s_add_u32 s42, s41, 2048
buffer_load_dwordx4 v1, s[4:7], s42 offen lds
s_mov_b32 m0, 109568
s_add_u32 s42, s41, 3072
buffer_load_dwordx4 v1, s[4:7], s42 offen lds
s_mov_b32 m0, 110592
s_add_u32 s42, s41, 4096
buffer_load_dwordx4 v1, s[4:7], s42 offen lds
s_mov_b32 m0, 111616
s_add_u32 s42, s41, 5120
buffer_load_dwordx4 v1, s[4:7], s42 offen lds
s_mov_b32 m0, 112640
s_add_u32 s42, s41, 6144
buffer_load_dwordx4 v1, s[4:7], s42 offen lds
s_mov_b32 m0, 113664
s_add_u32 s42, s41, 7168
buffer_load_dwordx4 v1, s[4:7], s42 offen lds
s_waitcnt vmcnt(40)
s_mov_b32 m0, 114688
s_add_u32 s42, s41, 8192
buffer_load_dwordx4 v1, s[4:7], s42 offen lds
s_mov_b32 m0, 115712
s_add_u32 s42, s41, 9216
buffer_load_dwordx4 v1, s[4:7], s42 offen lds
s_mov_b32 m0, 116736
s_add_u32 s42, s41, 10240
buffer_load_dwordx4 v1, s[4:7], s42 offen lds
s_mov_b32 m0, 117760
s_add_u32 s42, s41, 11264
buffer_load_dwordx4 v1, s[4:7], s42 offen lds
s_mov_b32 m0, 118784
s_add_u32 s42, s41, 12288
buffer_load_dwordx4 v1, s[4:7], s42 offen lds
s_mov_b32 m0, 119808
s_add_u32 s42, s41, 13312
buffer_load_dwordx4 v1, s[4:7], s42 offen lds
s_mov_b32 m0, 120832
s_add_u32 s42, s41, 14336
buffer_load_dwordx4 v1, s[4:7], s42 offen lds
s_mov_b32 m0, 121856
s_add_u32 s42, s41, 15360
buffer_load_dwordx4 v1, s[4:7], s42 offen lds
s_waitcnt vmcnt(40)
s_mov_b32 m0, 122880
s_add_u32 s42, s41, 16384
buffer_load_dwordx4 v1, s[4:7], s42 offen lds
s_mov_b32 m0, 123904
s_add_u32 s42, s41, 17408
buffer_load_dwordx4 v1, s[4:7], s42 offen lds
s_mov_b32 m0, 124928
s_add_u32 s42, s41, 18432
buffer_load_dwordx4 v1, s[4:7], s42 offen lds
s_mov_b32 m0, 125952
s_add_u32 s42, s41, 19456
buffer_load_dwordx4 v1, s[4:7], s42 offen lds
s_mov_b32 m0, 126976
s_add_u32 s42, s41, 20480
buffer_load_dwordx4 v1, s[4:7], s42 offen lds
s_mov_b32 m0, 128000
s_add_u32 s42, s41, 21504
buffer_load_dwordx4 v1, s[4:7], s42 offen lds
s_mov_b32 m0, 129024
s_add_u32 s42, s41, 22528
buffer_load_dwordx4 v1, s[4:7], s42 offen lds
s_mov_b32 m0, 130048
s_add_u32 s42, s41, 23552
buffer_load_dwordx4 v1, s[4:7], s42 offen lds
s_waitcnt vmcnt(40)
s_mov_b32 m0, 131072
s_add_u32 s42, s41, 24576
buffer_load_dwordx4 v1, s[4:7], s42 offen lds
s_mov_b32 m0, 132096
s_add_u32 s42, s41, 25600
buffer_load_dwordx4 v1, s[4:7], s42 offen lds
s_mov_b32 m0, 133120
s_add_u32 s42, s41, 26624
buffer_load_dwordx4 v1, s[4:7], s42 offen lds
s_mov_b32 m0, 134144
s_add_u32 s42, s41, 27648
buffer_load_dwordx4 v1, s[4:7], s42 offen lds
s_waitcnt vmcnt(52)
buffer_load_dwordx4 a[224:227], v1, s[4:7], s43 offen
buffer_load_dwordx4 a[228:231], v1, s[4:7], s43 offen offset:1024
buffer_load_dwordx4 a[232:235], v1, s[4:7], s43 offen offset:2048
buffer_load_dwordx4 a[236:239], v1, s[4:7], s43 offen offset:3072
s_add_u32 s43, s43, 4096
s_waitcnt vmcnt(52)
buffer_load_dwordx4 a[240:243], v1, s[4:7], s43 offen
buffer_load_dwordx4 a[244:247], v1, s[4:7], s43 offen offset:1024
buffer_load_dwordx4 a[248:251], v1, s[4:7], s43 offen offset:2048
buffer_load_dwordx4 a[252:255], v1, s[4:7], s43 offen offset:3072
s_add_u32 s43, s43, 4096
s_waitcnt vmcnt(52)
buffer_load_dwordx4 v[176:179], v1, s[4:7], s43 offen
buffer_load_dwordx4 v[180:183], v1, s[4:7], s43 offen offset:1024
buffer_load_dwordx4 v[184:187], v1, s[4:7], s43 offen offset:2048
buffer_load_dwordx4 v[188:191], v1, s[4:7], s43 offen offset:3072
s_add_u32 s43, s43, 4096
s_waitcnt vmcnt(52)
buffer_load_dwordx4 v[192:195], v1, s[4:7], s43 offen
buffer_load_dwordx4 v[196:199], v1, s[4:7], s43 offen offset:1024
buffer_load_dwordx4 v[200:203], v1, s[4:7], s43 offen offset:2048
buffer_load_dwordx4 v[204:207], v1, s[4:7], s43 offen offset:3072
s_add_u32 s43, s43, 4096
s_waitcnt vmcnt(52)
buffer_load_dwordx4 v[208:211], v1, s[4:7], s43 offen
buffer_load_dwordx4 v[212:215], v1, s[4:7], s43 offen offset:1024
buffer_load_dwordx4 v[216:219], v1, s[4:7], s43 offen offset:2048
buffer_load_dwordx4 v[220:223], v1, s[4:7], s43 offen offset:3072
s_add_u32 s43, s43, 4096
s_waitcnt vmcnt(52)
buffer_load_dwordx4 v[224:227], v1, s[4:7], s43 offen
buffer_load_dwordx4 v[228:231], v1, s[4:7], s43 offen offset:1024
buffer_load_dwordx4 v[232:235], v1, s[4:7], s43 offen offset:2048
buffer_load_dwordx4 v[236:239], v1, s[4:7], s43 offen offset:3072
s_add_u32 s43, s43, 4096
s_waitcnt vmcnt(52)
buffer_load_dwordx4 v[240:243], v1, s[4:7], s43 offen
buffer_load_dwordx4 v[244:247], v1, s[4:7], s43 offen offset:1024
buffer_load_dwordx4 v[248:251], v1, s[4:7], s43 offen offset:2048
buffer_load_dwordx4 v[252:255], v1, s[4:7], s43 offen offset:3072
s_add_u32 s43, s43, 4096
v_add_u32 v2, 106496, v1
v_and_b32 v9, 15, v0
v_lshrrev_b32 v10, 5, v0
v_lshlrev_b32 v3, 4, v9
v_lshl_add_u32 v3, v10, 8, v3
v_bfe_u32 v4, v0, 5, 1
v_bfe_u32 v10, v0, 4, 1
v_lshl_add_u32 v4, v10, 1, v4
v_lshlrev_b32 v4, 7, v4
v_lshl_add_u32 v4, v9, 2, v4
v_add_u32 v4, 10240, v4
v_lshlrev_b32 v5, 3, v0
v_add_u32 v5, 8192, v5
v_lshrrev_b32 v9, 3, v0
v_lshlrev_b32 v6, 4, v9
v_bfe_u32 v9, v0, 2, 1
v_lshl_add_u32 v6, v9, 7, v6
v_and_b32 v9, 3, v0
v_lshl_add_u32 v6, v9, 2, v6
v_and_b32 v9, 8, v0
v_cmp_eq_u32 vcc, 0, v9
v_mov_b32 v9, 0x88884444
v_mov_b32 v7, 0xddddeeee
v_cndmask_b32 v7, v7, v9, vcc
s_mul_i32 s26, s23, 458752
s_add_u32 s26, s26, 180224
s_mov_b32 s27, 1097728
s_mov_b32 s28, 1102848
s_lshl_b32 s29, s22, 15
s_add_u32 s29, s29, 30081024
s_add_u32 s30, s29, 4096
s_lshl_b32 s31, s22, 7
s_add_u32 s31, s31, 8200
s_lshl_b32 s32, s22, 9
s_add_u32 s32, s32, 642048
s_mov_b32 s25, 0
s_mov_b32 s89, 172032
s_lshl_b32 s34, s22, 2
s_add_u32 s34, s34, 172288
s_add_u32 s33, s88, 1
buffer_load_dword v8, off, s[4:7], s31 sc1
v_mov_b32 v128, 0
v_mov_b32 v129, 0
v_mov_b32 v130, 0
v_mov_b32 v131, 0
v_mov_b32 v132, 0
v_mov_b32 v133, 0
v_mov_b32 v134, 0
v_mov_b32 v135, 0
v_mov_b32 v136, 0
v_mov_b32 v137, 0
v_mov_b32 v138, 0
v_mov_b32 v139, 0
v_mov_b32 v140, 0
v_mov_b32 v141, 0
v_mov_b32 v142, 0
v_mov_b32 v143, 0
v_mov_b32 v144, 0
v_mov_b32 v145, 0
v_mov_b32 v146, 0
v_mov_b32 v147, 0
v_mov_b32 v148, 0
v_mov_b32 v149, 0
v_mov_b32 v150, 0
v_mov_b32 v151, 0
v_mov_b32 v152, 0
v_mov_b32 v153, 0
v_mov_b32 v154, 0
v_mov_b32 v155, 0
v_mov_b32 v156, 0
v_mov_b32 v157, 0
v_mov_b32 v158, 0
v_mov_b32 v159, 0
v_min_u32 v12, 55, v0
v_and_b32 v9, 3, v12
v_lshlrev_b32 v9, 3, v9
v_lshrrev_b32 v12, 2, v12
v_lshl_add_u32 v9, v12, 7, v9
s_mov_b32 s43, 4352
Llz_107:
buffer_load_dwordx2 v[12:13], v9, s[4:7], s43 offen sc1
s_waitcnt vmcnt(0)
v_cmp_ne_u32 vcc, s88, v12
v_cmp_ne_u32 s[40:41], s88, v13
s_or_b64 vcc, vcc, s[40:41]
s_cbranch_vccz Llzok_108
s_sleep 8
s_sub_u32 s24, s24, 1
s_cbranch_scc0 Llz_107
s_endpgm
Llzok_108:
v_cmp_ne_u32 vcc, s88, v8
s_cmp_lg_u64 vcc, 0
s_cselect_b32 s35, 0x40000000, 0
s_add_u32 s29, s29, s35
s_add_u32 s30, s30, s35
v_mov_b32 v12, 0
v_mov_b32 v13, 0
v_mov_b32 v14, 0
v_mov_b32 v15, 0
.p2align 6
s_nop 0
S2_STEP2:
ds_read_b128 v[104:107], v2 offset:8192
ds_read_b128 v[108:111], v2 offset:9216
ds_read_b128 v[112:115], v2 offset:10240
ds_read_b128 v[116:119], v2 offset:11264
ds_read_b128 v[120:123], v2
ds_read_b128 v[124:127], v2 offset:1024
v_mov_b32 v128, 0
v_mov_b32 v129, 0
v_mov_b32 v130, 0
v_mov_b32 v131, 0
v_mov_b32 v132, 0
v_mov_b32 v133, 0
v_mov_b32 v134, 0
v_mov_b32 v135, 0
v_mov_b32 v136, 0
v_mov_b32 v137, 0
v_mov_b32 v138, 0
v_mov_b32 v139, 0
v_mov_b32 v140, 0
v_mov_b32 v141, 0
v_mov_b32 v142, 0
v_mov_b32 v143, 0
Lspin_109:
buffer_load_dwordx4 v[32:35], v1, s[4:7], s26 offen sc1
buffer_load_dwordx4 v[36:39], v1, s[4:7], s26 offen offset:1024 sc1
s_sub_u32 s24, s24, 1
s_cbranch_scc1 CODE_END
s_waitcnt vmcnt(0)
v_max3_u32 v9, v32, v33, v34
v_max3_u32 v9, v9, v35, v36
v_max3_u32 v9, v9, v37, v38
v_max_u32 v9, v9, v39
v_cmp_eq_u32 vcc, -1, v9
s_cbranch_vccnz Lspin_109
ds_write_b128 v1, v[32:35] offset:4096
ds_write_b128 v1, v[36:39] offset:5120
s_add_u32 s31, s31, 1792
s_waitcnt lgkmcnt(0)
s_barrier
s_cmp_eq_u32 s25, 0
s_cselect_b32 s40, 1, s23
s_cmp_lg_u32 s40, 0
s_cbranch_scc1 Ldone_110
s_sub_u32 s40, s32, 7168
buffer_store_dword v160, v6, s[4:7], s40 offen sc1
Ldone_110:
ds_read_b128 v[16:19], v1
ds_read_b128 v[20:23], v1 offset:1024
ds_read_b128 v[24:27], v1 offset:2048
ds_read_b128 v[28:31], v1 offset:3072
ds_read_b128 v[40:43], v1 offset:6144
buffer_load_dword v8, off, s[4:7], s31 sc1
v_smfmac_f32_16x16x64_bf16 v[128:131], v[32:35], a[32:39], v7
v_smfmac_f32_16x16x64_bf16 v[132:135], v[32:35], a[88:95], v7
v_smfmac_f32_16x16x64_bf16 v[136:139], v[32:35], a[144:151], v7
v_mov_b32 v144, 0
v_mov_b32 v158, 0
v_smfmac_f32_16x16x64_bf16 v[140:143], v[32:35], v[104:111], v7
buffer_load_dwordx4 v[44:47], v1, s[4:7], s29 offen sc1
v_mov_b32 v145, 0
v_mov_b32 v159, 0
v_smfmac_f32_16x16x64_bf16 v[128:131], v[36:39], a[40:47], v7
ds_read_b128 v[104:107], v2 offset:2048
v_smfmac_f32_16x16x64_bf16 v[132:135], v[36:39], a[96:103], v7
ds_read_b128 v[108:111], v2 offset:3072
v_smfmac_f32_16x16x64_bf16 v[136:139], v[36:39], a[152:159], v7
v_mov_b32 v146, 0
v_smfmac_f32_16x16x64_bf16 v[140:143], v[36:39], v[112:119], v7
buffer_load_dwordx4 v[48:51], v1, s[4:7], s29 offen offset:1024 sc1
v_mov_b32 v147, 0
s_waitcnt lgkmcnt(6)
v_smfmac_f32_16x16x64_bf16 v[128:131], v[16:19], a[0:7], v7
ds_read_b128 v[112:115], v2 offset:4096
v_smfmac_f32_16x16x64_bf16 v[132:135], v[16:19], a[56:63], v7
ds_read_b128 v[116:119], v2 offset:5120
v_smfmac_f32_16x16x64_bf16 v[136:139], v[16:19], a[112:119], v7
v_mov_b32 v148, 0
v_smfmac_f32_16x16x64_bf16 v[140:143], v[16:19], v[120:127], v7
buffer_load_dwordx4 v[52:55], v1, s[4:7], s29 offen offset:2048 sc1
v_mov_b32 v149, 0
s_waitcnt lgkmcnt(7)
v_smfmac_f32_16x16x64_bf16 v[128:131], v[20:23], a[8:15], v7
ds_read_b128 v[120:123], v2 offset:6144
v_smfmac_f32_16x16x64_bf16 v[132:135], v[20:23], a[64:71], v7
ds_read_b128 v[124:127], v2 offset:7168
v_smfmac_f32_16x16x64_bf16 v[136:139], v[20:23], a[120:127], v7
v_mov_b32 v150, 0
s_waitcnt lgkmcnt(4)
v_smfmac_f32_16x16x64_bf16 v[140:143], v[20:23], v[104:111], v7
buffer_load_dwordx4 v[56:59], v1, s[4:7], s29 offen offset:3072 sc1
v_mov_b32 v151, 0
v_smfmac_f32_16x16x64_bf16 v[128:131], v[24:27], a[16:23], v7
ds_read_b128 v[104:107], v2 offset:12288
v_smfmac_f32_16x16x64_bf16 v[132:135], v[24:27], a[72:79], v7
ds_read_b128 v[108:111], v2 offset:13312
v_smfmac_f32_16x16x64_bf16 v[136:139], v[24:27], a[128:135], v7
v_mov_b32 v152, 0
s_waitcnt lgkmcnt(4)
v_smfmac_f32_16x16x64_bf16 v[140:143], v[24:27], v[112:119], v7
buffer_load_dwordx4 v[60:63], v1, s[4:7], s30 offen sc1
v_mov_b32 v153, 0
v_smfmac_f32_16x16x64_bf16 v[128:131], v[28:31], a[24:31], v7
ds_read_b128 v[112:115], v2 offset:22528
v_smfmac_f32_16x16x64_bf16 v[132:135], v[28:31], a[80:87], v7
ds_read_b128 v[116:119], v2 offset:23552
v_smfmac_f32_16x16x64_bf16 v[136:139], v[28:31], a[136:143], v7
v_mov_b32 v154, 0
s_waitcnt lgkmcnt(4)
v_smfmac_f32_16x16x64_bf16 v[140:143], v[28:31], v[120:127], v7
buffer_load_dwordx4 v[64:67], v1, s[4:7], s30 offen offset:1024 sc1
v_mov_b32 v155, 0
v_smfmac_f32_16x16x64_bf16 v[128:131], v[40:43], a[48:55], v7
ds_read_b128 v[120:123], v2 offset:24576
v_smfmac_f32_16x16x64_bf16 v[132:135], v[40:43], a[104:111], v7
ds_read_b128 v[124:127], v2 offset:25600
v_smfmac_f32_16x16x64_bf16 v[136:139], v[40:43], a[160:167], v7
v_mov_b32 v156, 0
s_waitcnt lgkmcnt(4)
v_smfmac_f32_16x16x64_bf16 v[140:143], v[40:43], v[104:111], v7
buffer_load_dwordx4 v[68:71], v1, s[4:7], s30 offen offset:2048 sc1
v_mov_b32 v157, 0
v_smfmac_f32_16x16x64_bf16 v[144:147], v[32:35], a[200:207], v7
ds_read_b128 v[104:107], v2 offset:14336
v_smfmac_f32_16x16x64_bf16 v[148:151], v[32:35], v[176:183], v7
ds_read_b128 v[108:111], v2 offset:15360
v_smfmac_f32_16x16x64_bf16 v[152:155], v[32:35], v[232:239], v7
v_cvt_pk_bf16_f32 v76, v128, v129
s_waitcnt lgkmcnt(4)
v_smfmac_f32_16x16x64_bf16 v[156:159], v[32:35], v[112:119], v7
buffer_load_dwordx4 v[72:75], v1, s[4:7], s30 offen offset:3072 sc1
v_cvt_pk_bf16_f32 v77, v130, v131
v_smfmac_f32_16x16x64_bf16 v[144:147], v[36:39], a[208:215], v7
ds_read_b128 v[112:115], v2 offset:16384
v_smfmac_f32_16x16x64_bf16 v[148:151], v[36:39], v[184:191], v7
ds_read_b128 v[116:119], v2 offset:17408
v_smfmac_f32_16x16x64_bf16 v[152:155], v[36:39], v[240:247], v7
v_cvt_pk_bf16_f32 v84, v132, v133
s_waitcnt lgkmcnt(4)
v_smfmac_f32_16x16x64_bf16 v[156:159], v[36:39], v[120:127], v7
v_cvt_pk_bf16_f32 v85, v134, v135
v_smfmac_f32_16x16x64_bf16 v[144:147], v[16:19], a[168:175], v7
ds_read_b128 v[120:123], v2 offset:18432
v_smfmac_f32_16x16x64_bf16 v[148:151], v[16:19], a[224:231], v7
ds_read_b128 v[124:127], v2 offset:19456
v_smfmac_f32_16x16x64_bf16 v[152:155], v[16:19], v[200:207], v7
v_cvt_pk_bf16_f32 v78, v136, v137
s_waitcnt lgkmcnt(4)
v_smfmac_f32_16x16x64_bf16 v[156:159], v[16:19], v[104:111], v7
v_cvt_pk_bf16_f32 v79, v138, v139
v_smfmac_f32_16x16x64_bf16 v[144:147], v[20:23], a[176:183], v7
ds_read_b128 v[104:107], v2 offset:20480
v_smfmac_f32_16x16x64_bf16 v[148:151], v[20:23], a[232:239], v7
ds_read_b128 v[108:111], v2 offset:21504
v_smfmac_f32_16x16x64_bf16 v[152:155], v[20:23], v[208:215], v7
v_cvt_pk_bf16_f32 v82, v140, v141
s_waitcnt lgkmcnt(4)
v_smfmac_f32_16x16x64_bf16 v[156:159], v[20:23], v[112:119], v7
v_cvt_pk_bf16_f32 v83, v142, v143
v_smfmac_f32_16x16x64_bf16 v[144:147], v[24:27], a[184:191], v7
ds_read_b128 v[112:115], v2 offset:26624
v_smfmac_f32_16x16x64_bf16 v[148:151], v[24:27], a[240:247], v7
ds_read_b128 v[116:119], v2 offset:27648
v_smfmac_f32_16x16x64_bf16 v[152:155], v[24:27], v[216:223], v7
s_waitcnt lgkmcnt(4)
v_smfmac_f32_16x16x64_bf16 v[156:159], v[24:27], v[120:127], v7
v_smfmac_f32_16x16x64_bf16 v[144:147], v[28:31], a[192:199], v7
v_smfmac_f32_16x16x64_bf16 v[148:151], v[28:31], a[248:255], v7
v_smfmac_f32_16x16x64_bf16 v[152:155], v[28:31], v[224:231], v7
s_waitcnt lgkmcnt(2)
v_smfmac_f32_16x16x64_bf16 v[156:159], v[28:31], v[104:111], v7
v_smfmac_f32_16x16x64_bf16 v[144:147], v[40:43], a[216:223], v7
v_smfmac_f32_16x16x64_bf16 v[148:151], v[40:43], v[192:199], v7
v_smfmac_f32_16x16x64_bf16 v[152:155], v[40:43], v[248:255], v7
s_waitcnt lgkmcnt(0)
v_smfmac_f32_16x16x64_bf16 v[156:159], v[40:43], v[112:119], v7
s_nop 2
v_cvt_pk_bf16_f32 v86, v144, v145
v_cvt_pk_bf16_f32 v87, v146, v147
v_cvt_pk_bf16_f32 v80, v148, v149
v_cvt_pk_bf16_f32 v81, v150, v151
v_cvt_pk_bf16_f32 v88, v152, v153
v_cvt_pk_bf16_f32 v89, v154, v155
v_cvt_pk_bf16_f32 v90, v156, v157
v_cvt_pk_bf16_f32 v91, v158, v159
v_mov_b32 v160, 0
v_mov_b32 v161, 0
v_mov_b32 v162, 0
v_mov_b32 v163, 0
v_mov_b32 v164, 0
v_mov_b32 v165, 0
v_mov_b32 v166, 0
v_mov_b32 v167, 0
s_cmp_eq_u32 s35, 0
s_cbranch_scc1 Lintime_111
s_sub_u32 s29, s29, s35
s_sub_u32 s30, s30, s35
s_mov_b32 s35, 0
s_sub_u32 s40, s31, 1792
s_branch Lfirst_113
Lflag_112:
v_cmp_ne_u32 vcc, s88, v10
s_cbranch_vccz Lset_114
s_sleep 2
Lfirst_113:
buffer_load_dword v10, off, s[4:7], s40 sc1
s_waitcnt vmcnt(0)
s_sub_u32 s24, s24, 1
s_cbranch_scc0 Lflag_112
s_endpgm
Lset_114:
buffer_load_dwordx4 v[44:47], v1, s[4:7], s29 offen sc1
buffer_load_dwordx4 v[48:51], v1, s[4:7], s29 offen offset:1024 sc1
buffer_load_dwordx4 v[52:55], v1, s[4:7], s29 offen offset:2048 sc1
buffer_load_dwordx4 v[56:59], v1, s[4:7], s29 offen offset:3072 sc1
buffer_load_dwordx4 v[60:63], v1, s[4:7], s30 offen sc1
buffer_load_dwordx4 v[64:67], v1, s[4:7], s30 offen offset:1024 sc1
buffer_load_dwordx4 v[68:71], v1, s[4:7], s30 offen offset:2048 sc1
buffer_load_dwordx4 v[72:75], v1, s[4:7], s30 offen offset:3072 sc1
Lintime_111:
s_waitcnt vmcnt(0)
v_cmp_ne_u32 s[36:37], s88, v8
buffer_load_dwordx4 v[92:95], v1, s[4:7], s27 offen sc1
buffer_load_dwordx4 v[96:99], v1, s[4:7], s27 offen offset:1024 sc1
buffer_load_dwordx4 v[100:103], v3, s[4:7], s28 offen sc1
s_nop 15
s_nop 13
Lspin_115:
buffer_load_dwordx4 v[92:95], v1, s[4:7], s27 offen sc1
buffer_load_dwordx4 v[96:99], v1, s[4:7], s27 offen offset:1024 sc1
buffer_load_dwordx4 v[100:103], v3, s[4:7], s28 offen sc1
s_sub_u32 s24, s24, 1
s_cbranch_scc1 CODE_END
v_mfma_f32_16x16x32_bf16 v[160:163], v[12:15], v[12:15], 0
s_waitcnt vmcnt(3)
v_max3_u32 v9, v92, v93, v94
v_max3_u32 v9, v9, v95, v96
v_max3_u32 v9, v9, v97, v98
v_max3_u32 v9, v9, v99, v100
v_max3_u32 v9, v9, v101, v102
v_max_u32 v9, v9, v103
v_cmp_eq_u32 vcc, -1, v9
v_smfmac_f32_16x16x64_bf16 v[160:163], v[92:95], v[44:51], v7
v_smfmac_f32_16x16x64_bf16 v[160:163], v[96:99], v[60:67], v7
s_cbranch_vccnz Lspin_115
v_smfmac_f32_16x16x64_bf16 v[160:163], v[100:103], v[76:83], v7
v_smfmac_f32_16x16x64_bf16 v[164:167], v[92:95], v[52:59], v7
v_smfmac_f32_16x16x64_bf16 v[164:167], v[96:99], v[68:75], v7
v_smfmac_f32_16x16x64_bf16 v[164:167], v[100:103], v[84:91], v7
v_permlane32_swap_b32 v160, v162
v_permlane32_swap_b32 v161, v163
v_add_f32 v160, v160, v162
v_add_f32 v161, v161, v163
ds_write2_b32 v4, v160, v161 offset0:0 offset1:16
s_nop 1
v_permlane32_swap_b32 v164, v166
v_permlane32_swap_b32 v165, v167
v_add_f32 v164, v164, v166
v_add_f32 v165, v165, v167
ds_write2_b32 v4, v164, v165 offset0:128 offset1:144
s_waitcnt lgkmcnt(0)
s_barrier
ds_read_b64 v[160:161], v5
ds_read_b64 v[162:163], v5 offset:1024
ds_read_b64 v[164:165], v5 offset:2048
ds_read_b64 v[166:167], v5 offset:3072
s_waitcnt lgkmcnt(2)
v_pk_add_f32 v[160:161], v[160:161], v[162:163]
s_waitcnt lgkmcnt(0)
v_pk_add_f32 v[164:165], v[164:165], v[166:167]
v_pk_add_f32 v[160:161], v[160:161], v[164:165]
v_cvt_pk_bf16_f32 v160, v160, v161
v_min_u32 v160, -2, v160
s_cmp_eq_u32 s25, 62
s_cselect_b32 s40, 1, s23
s_cmp_eq_u32 s40, 0
s_cbranch_scc1 Llater_116
buffer_store_dword v160, v6, s[4:7], s32 offen sc1
Llater_116:
s_cmp_eq_u64 s[36:37], 0
s_cbranch_scc1 Lseen_117
buffer_load_dword v8, off, s[4:7], s31 sc1
s_waitcnt vmcnt(0)
v_cmp_ne_u32 vcc, s88, v8
s_cmp_lg_u64 vcc, 0
s_cselect_b32 s35, 0x40000000, 0
s_add_u32 s29, s29, s35
s_add_u32 s30, s30, s35
Lseen_117:
s_add_u32 s26, s26, 7168
s_add_u32 s32, s32, 7168
s_add_u32 s33, s33, 1
s_add_u32 s27, s27, 10240
s_add_u32 s28, s28, 10240
s_add_u32 s29, s29, 458752
s_add_u32 s30, s30, 458752
s_add_u32 s25, s25, 1
s_cmp_lt_u32 s25, 63
s_cbranch_scc1 S2_STEP2
s_endpgm
S2_W3:
s_sub_u32 s22, s22, 16
v_lshlrev_b32 v1, 4, v0
v_and_b32 v9, 7, v0
v_min_u32 v9, 6, v9
v_lshlrev_b32 v9, 2, v9
v_bfe_u32 v10, v0, 3, 2
v_lshl_add_u32 v9, v10, 7, v9
s_mov_b32 s40, 3584
s_branch Lfirst_119
Lflag_118:
v_cmp_ne_u32 vcc, s88, v10
s_cbranch_vccz Lset_120
s_sleep 4
Lfirst_119:
buffer_load_dword v10, v9, s[4:7], s40 offen sc1
s_waitcnt vmcnt(0)
s_sub_u32 s24, s24, 1
s_cbranch_scc0 Lflag_118
s_endpgm
Lset_120:
s_mul_i32 s40, s22, 458752
s_add_u32 s40, s40, 16646144
s_add_u32 s41, s40, 86016
s_add_u32 s43, s40, 57344
buffer_load_dwordx4 a[0:3], v1, s[4:7], s40 offen
buffer_load_dwordx4 a[4:7], v1, s[4:7], s40 offen offset:1024
buffer_load_dwordx4 a[8:11], v1, s[4:7], s40 offen offset:2048
buffer_load_dwordx4 a[12:15], v1, s[4:7], s40 offen offset:3072
s_add_u32 s40, s40, 4096
buffer_load_dwordx4 a[16:19], v1, s[4:7], s40 offen
buffer_load_dwordx4 a[20:23], v1, s[4:7], s40 offen offset:1024
buffer_load_dwordx4 a[24:27], v1, s[4:7], s40 offen offset:2048
buffer_load_dwordx4 a[28:31], v1, s[4:7], s40 offen offset:3072
s_add_u32 s40, s40, 4096
buffer_load_dwordx4 a[32:35], v1, s[4:7], s40 offen
buffer_load_dwordx4 a[36:39], v1, s[4:7], s40 offen offset:1024
buffer_load_dwordx4 a[40:43], v1, s[4:7], s40 offen offset:2048
buffer_load_dwordx4 a[44:47], v1, s[4:7], s40 offen offset:3072
s_add_u32 s40, s40, 4096
buffer_load_dwordx4 a[48:51], v1, s[4:7], s40 offen
buffer_load_dwordx4 a[52:55], v1, s[4:7], s40 offen offset:1024
buffer_load_dwordx4 a[56:59], v1, s[4:7], s40 offen offset:2048
buffer_load_dwordx4 a[60:63], v1, s[4:7], s40 offen offset:3072
s_add_u32 s40, s40, 4096
buffer_load_dwordx4 a[64:67], v1, s[4:7], s40 offen
buffer_load_dwordx4 a[68:71], v1, s[4:7], s40 offen offset:1024
buffer_load_dwordx4 a[72:75], v1, s[4:7], s40 offen offset:2048
buffer_load_dwordx4 a[76:79], v1, s[4:7], s40 offen offset:3072
s_add_u32 s40, s40, 4096
buffer_load_dwordx4 a[80:83], v1, s[4:7], s40 offen
buffer_load_dwordx4 a[84:87], v1, s[4:7], s40 offen offset:1024
buffer_load_dwordx4 a[88:91], v1, s[4:7], s40 offen offset:2048
buffer_load_dwordx4 a[92:95], v1, s[4:7], s40 offen offset:3072
s_add_u32 s40, s40, 4096
buffer_load_dwordx4 a[96:99], v1, s[4:7], s40 offen
buffer_load_dwordx4 a[100:103], v1, s[4:7], s40 offen offset:1024
buffer_load_dwordx4 a[104:107], v1, s[4:7], s40 offen offset:2048
buffer_load_dwordx4 a[108:111], v1, s[4:7], s40 offen offset:3072
s_add_u32 s40, s40, 4096
buffer_load_dwordx4 a[112:115], v1, s[4:7], s40 offen
buffer_load_dwordx4 a[116:119], v1, s[4:7], s40 offen offset:1024
buffer_load_dwordx4 a[120:123], v1, s[4:7], s40 offen offset:2048
buffer_load_dwordx4 a[124:127], v1, s[4:7], s40 offen offset:3072
s_add_u32 s40, s40, 4096
buffer_load_dwordx4 a[128:131], v1, s[4:7], s40 offen
buffer_load_dwordx4 a[132:135], v1, s[4:7], s40 offen offset:1024
buffer_load_dwordx4 a[136:139], v1, s[4:7], s40 offen offset:2048
buffer_load_dwordx4 a[140:143], v1, s[4:7], s40 offen offset:3072
s_add_u32 s40, s40, 4096
buffer_load_dwordx4 a[144:147], v1, s[4:7], s40 offen
buffer_load_dwordx4 a[148:151], v1, s[4:7], s40 offen offset:1024
buffer_load_dwordx4 a[152:155], v1, s[4:7], s40 offen offset:2048
buffer_load_dwordx4 a[156:159], v1, s[4:7], s40 offen offset:3072
s_add_u32 s40, s40, 4096
s_waitcnt vmcnt(32)
buffer_load_dwordx4 a[160:163], v1, s[4:7], s40 offen
buffer_load_dwordx4 a[164:167], v1, s[4:7], s40 offen offset:1024
buffer_load_dwordx4 a[168:171], v1, s[4:7], s40 offen offset:2048
buffer_load_dwordx4 a[172:175], v1, s[4:7], s40 offen offset:3072
s_add_u32 s40, s40, 4096
buffer_load_dwordx4 a[176:179], v1, s[4:7], s40 offen
buffer_load_dwordx4 a[180:183], v1, s[4:7], s40 offen offset:1024
buffer_load_dwordx4 a[184:187], v1, s[4:7], s40 offen offset:2048
buffer_load_dwordx4 a[188:191], v1, s[4:7], s40 offen offset:3072
s_add_u32 s40, s40, 4096
s_waitcnt vmcnt(32)
buffer_load_dwordx4 a[192:195], v1, s[4:7], s40 offen
buffer_load_dwordx4 a[196:199], v1, s[4:7], s40 offen offset:1024
buffer_load_dwordx4 a[200:203], v1, s[4:7], s40 offen offset:2048
buffer_load_dwordx4 a[204:207], v1, s[4:7], s40 offen offset:3072
s_add_u32 s40, s40, 4096
buffer_load_dwordx4 a[208:211], v1, s[4:7], s40 offen
buffer_load_dwordx4 a[212:215], v1, s[4:7], s40 offen offset:1024
buffer_load_dwordx4 a[216:219], v1, s[4:7], s40 offen offset:2048
buffer_load_dwordx4 a[220:223], v1, s[4:7], s40 offen offset:3072
s_waitcnt vmcnt(40)
s_mov_b32 m0, 135168
s_add_u32 s42, s41, 0
buffer_load_dwordx4 v1, s[4:7], s42 offen lds
s_mov_b32 m0, 136192
s_add_u32 s42, s41, 1024
buffer_load_dwordx4 v1, s[4:7], s42 offen lds
s_mov_b32 m0, 137216
s_add_u32 s42, s41, 2048
buffer_load_dwordx4 v1, s[4:7], s42 offen lds
s_mov_b32 m0, 138240
s_add_u32 s42, s41, 3072
buffer_load_dwordx4 v1, s[4:7], s42 offen lds
s_mov_b32 m0, 139264
s_add_u32 s42, s41, 4096
buffer_load_dwordx4 v1, s[4:7], s42 offen lds
s_mov_b32 m0, 140288
s_add_u32 s42, s41, 5120
buffer_load_dwordx4 v1, s[4:7], s42 offen lds
s_mov_b32 m0, 141312
s_add_u32 s42, s41, 6144
buffer_load_dwordx4 v1, s[4:7], s42 offen lds
s_mov_b32 m0, 142336
s_add_u32 s42, s41, 7168
buffer_load_dwordx4 v1, s[4:7], s42 offen lds
s_waitcnt vmcnt(40)
s_mov_b32 m0, 143360
s_add_u32 s42, s41, 8192
buffer_load_dwordx4 v1, s[4:7], s42 offen lds
s_mov_b32 m0, 144384
s_add_u32 s42, s41, 9216
buffer_load_dwordx4 v1, s[4:7], s42 offen lds
s_mov_b32 m0, 145408
s_add_u32 s42, s41, 10240
buffer_load_dwordx4 v1, s[4:7], s42 offen lds
s_mov_b32 m0, 146432
s_add_u32 s42, s41, 11264
buffer_load_dwordx4 v1, s[4:7], s42 offen lds
s_mov_b32 m0, 147456
s_add_u32 s42, s41, 12288
buffer_load_dwordx4 v1, s[4:7], s42 offen lds
s_mov_b32 m0, 148480
s_add_u32 s42, s41, 13312
buffer_load_dwordx4 v1, s[4:7], s42 offen lds
s_mov_b32 m0, 149504
s_add_u32 s42, s41, 14336
buffer_load_dwordx4 v1, s[4:7], s42 offen lds
s_mov_b32 m0, 150528
s_add_u32 s42, s41, 15360
buffer_load_dwordx4 v1, s[4:7], s42 offen lds
s_waitcnt vmcnt(40)
s_mov_b32 m0, 151552
s_add_u32 s42, s41, 16384
buffer_load_dwordx4 v1, s[4:7], s42 offen lds
s_mov_b32 m0, 152576
s_add_u32 s42, s41, 17408
buffer_load_dwordx4 v1, s[4:7], s42 offen lds
s_mov_b32 m0, 153600
s_add_u32 s42, s41, 18432
buffer_load_dwordx4 v1, s[4:7], s42 offen lds
s_mov_b32 m0, 154624
s_add_u32 s42, s41, 19456
buffer_load_dwordx4 v1, s[4:7], s42 offen lds
s_mov_b32 m0, 155648
s_add_u32 s42, s41, 20480
buffer_load_dwordx4 v1, s[4:7], s42 offen lds
s_mov_b32 m0, 156672
s_add_u32 s42, s41, 21504
buffer_load_dwordx4 v1, s[4:7], s42 offen lds
s_mov_b32 m0, 157696
s_add_u32 s42, s41, 22528
buffer_load_dwordx4 v1, s[4:7], s42 offen lds
s_mov_b32 m0, 158720
s_add_u32 s42, s41, 23552
buffer_load_dwordx4 v1, s[4:7], s42 offen lds
s_waitcnt vmcnt(40)
s_mov_b32 m0, 159744
s_add_u32 s42, s41, 24576
buffer_load_dwordx4 v1, s[4:7], s42 offen lds
s_mov_b32 m0, 160768
s_add_u32 s42, s41, 25600
buffer_load_dwordx4 v1, s[4:7], s42 offen lds
s_mov_b32 m0, 161792
s_add_u32 s42, s41, 26624
buffer_load_dwordx4 v1, s[4:7], s42 offen lds
s_mov_b32 m0, 162816
s_add_u32 s42, s41, 27648
buffer_load_dwordx4 v1, s[4:7], s42 offen lds
s_waitcnt vmcnt(52)
buffer_load_dwordx4 a[224:227], v1, s[4:7], s43 offen
buffer_load_dwordx4 a[228:231], v1, s[4:7], s43 offen offset:1024
buffer_load_dwordx4 a[232:235], v1, s[4:7], s43 offen offset:2048
buffer_load_dwordx4 a[236:239], v1, s[4:7], s43 offen offset:3072
s_add_u32 s43, s43, 4096
s_waitcnt vmcnt(52)
buffer_load_dwordx4 a[240:243], v1, s[4:7], s43 offen
buffer_load_dwordx4 a[244:247], v1, s[4:7], s43 offen offset:1024
buffer_load_dwordx4 a[248:251], v1, s[4:7], s43 offen offset:2048
buffer_load_dwordx4 a[252:255], v1, s[4:7], s43 offen offset:3072
s_add_u32 s43, s43, 4096
s_waitcnt vmcnt(52)
buffer_load_dwordx4 v[176:179], v1, s[4:7], s43 offen
buffer_load_dwordx4 v[180:183], v1, s[4:7], s43 offen offset:1024
buffer_load_dwordx4 v[184:187], v1, s[4:7], s43 offen offset:2048
buffer_load_dwordx4 v[188:191], v1, s[4:7], s43 offen offset:3072
s_add_u32 s43, s43, 4096
s_waitcnt vmcnt(52)
buffer_load_dwordx4 v[192:195], v1, s[4:7], s43 offen
buffer_load_dwordx4 v[196:199], v1, s[4:7], s43 offen offset:1024
buffer_load_dwordx4 v[200:203], v1, s[4:7], s43 offen offset:2048
buffer_load_dwordx4 v[204:207], v1, s[4:7], s43 offen offset:3072
s_add_u32 s43, s43, 4096
s_waitcnt vmcnt(52)
buffer_load_dwordx4 v[208:211], v1, s[4:7], s43 offen
buffer_load_dwordx4 v[212:215], v1, s[4:7], s43 offen offset:1024
buffer_load_dwordx4 v[216:219], v1, s[4:7], s43 offen offset:2048
buffer_load_dwordx4 v[220:223], v1, s[4:7], s43 offen offset:3072
s_add_u32 s43, s43, 4096
s_waitcnt vmcnt(52)
buffer_load_dwordx4 v[224:227], v1, s[4:7], s43 offen
buffer_load_dwordx4 v[228:231], v1, s[4:7], s43 offen offset:1024
buffer_load_dwordx4 v[232:235], v1, s[4:7], s43 offen offset:2048
buffer_load_dwordx4 v[236:239], v1, s[4:7], s43 offen offset:3072
s_add_u32 s43, s43, 4096
s_waitcnt vmcnt(52)
buffer_load_dwordx4 v[240:243], v1, s[4:7], s43 offen
buffer_load_dwordx4 v[244:247], v1, s[4:7], s43 offen offset:1024
buffer_load_dwordx4 v[248:251], v1, s[4:7], s43 offen offset:2048
buffer_load_dwordx4 v[252:255], v1, s[4:7], s43 offen offset:3072
s_add_u32 s43, s43, 4096
v_add_u32 v2, 135168, v1
v_and_b32 v9, 15, v0
v_lshrrev_b32 v10, 5, v0
v_lshlrev_b32 v3, 4, v9
v_lshl_add_u32 v3, v10, 8, v3
v_bfe_u32 v4, v0, 5, 1
v_bfe_u32 v10, v0, 4, 1
v_lshl_add_u32 v4, v10, 1, v4
v_lshlrev_b32 v4, 7, v4
v_lshl_add_u32 v4, v9, 2, v4
v_add_u32 v4, 11264, v4
v_lshlrev_b32 v5, 3, v0
v_add_u32 v5, 8704, v5
v_lshrrev_b32 v9, 3, v0
v_lshlrev_b32 v6, 4, v9
v_bfe_u32 v9, v0, 2, 1
v_lshl_add_u32 v6, v9, 7, v6
v_and_b32 v9, 3, v0
v_lshl_add_u32 v6, v9, 2, v6
v_and_b32 v9, 8, v0
v_cmp_eq_u32 vcc, 0, v9
v_mov_b32 v9, 0x88884444
v_mov_b32 v7, 0xddddeeee
v_cndmask_b32 v7, v7, v9, vcc
s_mul_i32 s26, s23, 458752
s_add_u32 s26, s26, 182272
s_mov_b32 s27, 1099776
s_mov_b32 s28, 1103360
s_lshl_b32 s29, s22, 15
s_add_u32 s29, s29, 30089216
s_add_u32 s30, s29, 4096
s_lshl_b32 s31, s22, 7
s_add_u32 s31, s31, 8204
s_lshl_b32 s32, s22, 9
s_add_u32 s32, s32, 642304
s_mov_b32 s25, 0
s_mov_b32 s89, 172032
s_lshl_b32 s34, s22, 2
s_add_u32 s34, s34, 172288
s_add_u32 s33, s88, 1
buffer_load_dword v8, off, s[4:7], s31 sc1
v_mov_b32 v128, 0
v_mov_b32 v129, 0
v_mov_b32 v130, 0
v_mov_b32 v131, 0
v_mov_b32 v132, 0
v_mov_b32 v133, 0
v_mov_b32 v134, 0
v_mov_b32 v135, 0
v_mov_b32 v136, 0
v_mov_b32 v137, 0
v_mov_b32 v138, 0
v_mov_b32 v139, 0
v_mov_b32 v140, 0
v_mov_b32 v141, 0
v_mov_b32 v142, 0
v_mov_b32 v143, 0
v_mov_b32 v144, 0
v_mov_b32 v145, 0
v_mov_b32 v146, 0
v_mov_b32 v147, 0
v_mov_b32 v148, 0
v_mov_b32 v149, 0
v_mov_b32 v150, 0
v_mov_b32 v151, 0
v_mov_b32 v152, 0
v_mov_b32 v153, 0
v_mov_b32 v154, 0
v_mov_b32 v155, 0
v_mov_b32 v156, 0
v_mov_b32 v157, 0
v_mov_b32 v158, 0
v_mov_b32 v159, 0
v_min_u32 v12, 55, v0
v_and_b32 v9, 3, v12
v_lshlrev_b32 v9, 3, v9
v_lshrrev_b32 v12, 2, v12
v_lshl_add_u32 v9, v12, 7, v9
s_mov_b32 s43, 4352
Llz_121:
buffer_load_dwordx2 v[12:13], v9, s[4:7], s43 offen sc1
s_waitcnt vmcnt(0)
v_cmp_ne_u32 vcc, s88, v12
v_cmp_ne_u32 s[40:41], s88, v13
s_or_b64 vcc, vcc, s[40:41]
s_cbranch_vccz Llzok_122
s_sleep 8
s_sub_u32 s24, s24, 1
s_cbranch_scc0 Llz_121
s_endpgm
Llzok_122:
v_cmp_ne_u32 vcc, s88, v8
s_cmp_lg_u64 vcc, 0
s_cselect_b32 s35, 0x40000000, 0
s_add_u32 s29, s29, s35
s_add_u32 s30, s30, s35
v_mov_b32 v12, 0
v_mov_b32 v13, 0
v_mov_b32 v14, 0
v_mov_b32 v15, 0
.p2align 6
s_nop 0
S2_STEP3:
ds_read_b128 v[104:107], v2 offset:12288
ds_read_b128 v[108:111], v2 offset:13312
ds_read_b128 v[112:115], v2
ds_read_b128 v[116:119], v2 offset:1024
ds_read_b128 v[120:123], v2 offset:2048
ds_read_b128 v[124:127], v2 offset:3072
v_mov_b32 v128, 0
v_mov_b32 v129, 0
v_mov_b32 v130, 0
v_mov_b32 v131, 0
v_mov_b32 v132, 0
v_mov_b32 v133, 0
v_mov_b32 v134, 0
v_mov_b32 v135, 0
v_mov_b32 v136, 0
v_mov_b32 v137, 0
v_mov_b32 v138, 0
v_mov_b32 v139, 0
v_mov_b32 v140, 0
v_mov_b32 v141, 0
v_mov_b32 v142, 0
v_mov_b32 v143, 0
Lspin_123:
buffer_load_dwordx4 v[40:43], v1, s[4:7], s26 offen sc1
s_sub_u32 s24, s24, 1
s_cbranch_scc1 CODE_END
s_waitcnt vmcnt(0)
v_max3_u32 v9, v40, v41, v42
v_max_u32 v9, v9, v43
v_cmp_eq_u32 vcc, -1, v9
s_cbranch_vccnz Lspin_123
ds_write_b128 v1, v[40:43] offset:6144
s_add_u32 s31, s31, 1792
s_waitcnt lgkmcnt(0)
s_barrier
s_cmp_eq_u32 s25, 0
s_cselect_b32 s40, 1, s23
s_cmp_lg_u32 s40, 0
s_cbranch_scc1 Ldone_124
s_sub_u32 s40, s32, 7168
buffer_store_dword v160, v6, s[4:7], s40 offen sc1
Ldone_124:
ds_read_b128 v[16:19], v1
ds_read_b128 v[20:23], v1 offset:1024
ds_read_b128 v[24:27], v1 offset:2048
ds_read_b128 v[28:31], v1 offset:3072
ds_read_b128 v[32:35], v1 offset:4096
ds_read_b128 v[36:39], v1 offset:5120
buffer_load_dword v8, off, s[4:7], s31 sc1
v_smfmac_f32_16x16x64_bf16 v[128:131], v[40:43], a[48:55], v7
v_smfmac_f32_16x16x64_bf16 v[132:135], v[40:43], a[104:111], v7
v_smfmac_f32_16x16x64_bf16 v[136:139], v[40:43], a[160:167], v7
v_mov_b32 v144, 0
v_mov_b32 v158, 0
v_smfmac_f32_16x16x64_bf16 v[140:143], v[40:43], v[104:111], v7
buffer_load_dwordx4 v[44:47], v1, s[4:7], s29 offen sc1
v_mov_b32 v145, 0
v_mov_b32 v159, 0
s_waitcnt lgkmcnt(5)
v_smfmac_f32_16x16x64_bf16 v[128:131], v[16:19], a[0:7], v7
ds_read_b128 v[104:107], v2 offset:4096
v_smfmac_f32_16x16x64_bf16 v[132:135], v[16:19], a[56:63], v7
ds_read_b128 v[108:111], v2 offset:5120
v_smfmac_f32_16x16x64_bf16 v[136:139], v[16:19], a[112:119], v7
v_mov_b32 v146, 0
v_smfmac_f32_16x16x64_bf16 v[140:143], v[16:19], v[112:119], v7
buffer_load_dwordx4 v[48:51], v1, s[4:7], s29 offen offset:1024 sc1
v_mov_b32 v147, 0
s_waitcnt lgkmcnt(6)
v_smfmac_f32_16x16x64_bf16 v[128:131], v[20:23], a[8:15], v7
ds_read_b128 v[112:115], v2 offset:6144
v_smfmac_f32_16x16x64_bf16 v[132:135], v[20:23], a[64:71], v7
ds_read_b128 v[116:119], v2 offset:7168
v_smfmac_f32_16x16x64_bf16 v[136:139], v[20:23], a[120:127], v7
v_mov_b32 v148, 0
v_smfmac_f32_16x16x64_bf16 v[140:143], v[20:23], v[120:127], v7
buffer_load_dwordx4 v[52:55], v1, s[4:7], s29 offen offset:2048 sc1
v_mov_b32 v149, 0
s_waitcnt lgkmcnt(7)
v_smfmac_f32_16x16x64_bf16 v[128:131], v[24:27], a[16:23], v7
ds_read_b128 v[120:123], v2 offset:8192
v_smfmac_f32_16x16x64_bf16 v[132:135], v[24:27], a[72:79], v7
ds_read_b128 v[124:127], v2 offset:9216
v_smfmac_f32_16x16x64_bf16 v[136:139], v[24:27], a[128:135], v7
v_mov_b32 v150, 0
s_waitcnt lgkmcnt(4)
v_smfmac_f32_16x16x64_bf16 v[140:143], v[24:27], v[104:111], v7
buffer_load_dwordx4 v[56:59], v1, s[4:7], s29 offen offset:3072 sc1
v_mov_b32 v151, 0
v_smfmac_f32_16x16x64_bf16 v[128:131], v[28:31], a[24:31], v7
ds_read_b128 v[104:107], v2 offset:10240
v_smfmac_f32_16x16x64_bf16 v[132:135], v[28:31], a[80:87], v7
ds_read_b128 v[108:111], v2 offset:11264
v_smfmac_f32_16x16x64_bf16 v[136:139], v[28:31], a[136:143], v7
v_mov_b32 v152, 0
s_waitcnt lgkmcnt(4)
v_smfmac_f32_16x16x64_bf16 v[140:143], v[28:31], v[112:119], v7
buffer_load_dwordx4 v[60:63], v1, s[4:7], s30 offen sc1
v_mov_b32 v153, 0
v_smfmac_f32_16x16x64_bf16 v[128:131], v[32:35], a[32:39], v7
ds_read_b128 v[112:115], v2 offset:26624
v_smfmac_f32_16x16x64_bf16 v[132:135], v[32:35], a[88:95], v7
ds_read_b128 v[116:119], v2 offset:27648
v_smfmac_f32_16x16x64_bf16 v[136:139], v[32:35], a[144:151], v7
v_mov_b32 v154, 0
s_waitcnt lgkmcnt(4)
v_smfmac_f32_16x16x64_bf16 v[140:143], v[32:35], v[120:127], v7
buffer_load_dwordx4 v[64:67], v1, s[4:7], s30 offen offset:1024 sc1
v_mov_b32 v155, 0
v_smfmac_f32_16x16x64_bf16 v[128:131], v[36:39], a[40:47], v7
ds_read_b128 v[120:123], v2 offset:14336
v_smfmac_f32_16x16x64_bf16 v[132:135], v[36:39], a[96:103], v7
ds_read_b128 v[124:127], v2 offset:15360
v_smfmac_f32_16x16x64_bf16 v[136:139], v[36:39], a[152:159], v7
v_mov_b32 v156, 0
s_waitcnt lgkmcnt(4)
v_smfmac_f32_16x16x64_bf16 v[140:143], v[36:39], v[104:111], v7
buffer_load_dwordx4 v[68:71], v1, s[4:7], s30 offen offset:2048 sc1
v_mov_b32 v157, 0
v_smfmac_f32_16x16x64_bf16 v[144:147], v[40:43], a[216:223], v7
ds_read_b128 v[104:107], v2 offset:16384
v_smfmac_f32_16x16x64_bf16 v[148:151], v[40:43], v[192:199], v7
ds_read_b128 v[108:111], v2 offset:17408
v_smfmac_f32_16x16x64_bf16 v[152:155], v[40:43], v[248:255], v7
v_cvt_pk_bf16_f32 v76, v128, v129
s_waitcnt lgkmcnt(4)
v_smfmac_f32_16x16x64_bf16 v[156:159], v[40:43], v[112:119], v7
buffer_load_dwordx4 v[72:75], v1, s[4:7], s30 offen offset:3072 sc1
v_cvt_pk_bf16_f32 v77, v130, v131
v_smfmac_f32_16x16x64_bf16 v[144:147], v[16:19], a[168:175], v7
ds_read_b128 v[112:115], v2 offset:18432
v_smfmac_f32_16x16x64_bf16 v[148:151], v[16:19], a[224:231], v7
ds_read_b128 v[116:119], v2 offset:19456
v_smfmac_f32_16x16x64_bf16 v[152:155], v[16:19], v[200:207], v7
v_cvt_pk_bf16_f32 v84, v132, v133
s_waitcnt lgkmcnt(4)
v_smfmac_f32_16x16x64_bf16 v[156:159], v[16:19], v[120:127], v7
v_cvt_pk_bf16_f32 v85, v134, v135
v_smfmac_f32_16x16x64_bf16 v[144:147], v[20:23], a[176:183], v7
ds_read_b128 v[120:123], v2 offset:20480
v_smfmac_f32_16x16x64_bf16 v[148:151], v[20:23], a[232:239], v7
ds_read_b128 v[124:127], v2 offset:21504
v_smfmac_f32_16x16x64_bf16 v[152:155], v[20:23], v[208:215], v7
v_cvt_pk_bf16_f32 v78, v136, v137
s_waitcnt lgkmcnt(4)
v_smfmac_f32_16x16x64_bf16 v[156:159], v[20:23], v[104:111], v7
v_cvt_pk_bf16_f32 v79, v138, v139
v_smfmac_f32_16x16x64_bf16 v[144:147], v[24:27], a[184:191], v7
ds_read_b128 v[104:107], v2 offset:22528
v_smfmac_f32_16x16x64_bf16 v[148:151], v[24:27], a[240:247], v7
ds_read_b128 v[108:111], v2 offset:23552
v_smfmac_f32_16x16x64_bf16 v[152:155], v[24:27], v[216:223], v7
v_cvt_pk_bf16_f32 v82, v140, v141
s_waitcnt lgkmcnt(4)
v_smfmac_f32_16x16x64_bf16 v[156:159], v[24:27], v[112:119], v7
v_cvt_pk_bf16_f32 v83, v142, v143
v_smfmac_f32_16x16x64_bf16 v[144:147], v[28:31], a[192:199], v7
ds_read_b128 v[112:115], v2 offset:24576
v_smfmac_f32_16x16x64_bf16 v[148:151], v[28:31], a[248:255], v7
ds_read_b128 v[116:119], v2 offset:25600
v_smfmac_f32_16x16x64_bf16 v[152:155], v[28:31], v[224:231], v7
s_waitcnt lgkmcnt(4)
v_smfmac_f32_16x16x64_bf16 v[156:159], v[28:31], v[120:127], v7
v_smfmac_f32_16x16x64_bf16 v[144:147], v[32:35], a[200:207], v7
v_smfmac_f32_16x16x64_bf16 v[148:151], v[32:35], v[176:183], v7
v_smfmac_f32_16x16x64_bf16 v[152:155], v[32:35], v[232:239], v7
s_waitcnt lgkmcnt(2)
v_smfmac_f32_16x16x64_bf16 v[156:159], v[32:35], v[104:111], v7
v_smfmac_f32_16x16x64_bf16 v[144:147], v[36:39], a[208:215], v7
v_smfmac_f32_16x16x64_bf16 v[148:151], v[36:39], v[184:191], v7
v_smfmac_f32_16x16x64_bf16 v[152:155], v[36:39], v[240:247], v7
s_waitcnt lgkmcnt(0)
v_smfmac_f32_16x16x64_bf16 v[156:159], v[36:39], v[112:119], v7
s_nop 2
v_cvt_pk_bf16_f32 v86, v144, v145
v_cvt_pk_bf16_f32 v87, v146, v147
v_cvt_pk_bf16_f32 v80, v148, v149
v_cvt_pk_bf16_f32 v81, v150, v151
v_cvt_pk_bf16_f32 v88, v152, v153
v_cvt_pk_bf16_f32 v89, v154, v155
v_cvt_pk_bf16_f32 v90, v156, v157
v_cvt_pk_bf16_f32 v91, v158, v159
v_mov_b32 v160, 0
v_mov_b32 v161, 0
v_mov_b32 v162, 0
v_mov_b32 v163, 0
v_mov_b32 v164, 0
v_mov_b32 v165, 0
v_mov_b32 v166, 0
v_mov_b32 v167, 0
s_cmp_eq_u32 s35, 0
s_cbranch_scc1 Lintime_125
s_sub_u32 s29, s29, s35
s_sub_u32 s30, s30, s35
s_mov_b32 s35, 0
s_sub_u32 s40, s31, 1792
s_branch Lfirst_127
Lflag_126:
v_cmp_ne_u32 vcc, s88, v10
s_cbranch_vccz Lset_128
s_sleep 2
Lfirst_127:
buffer_load_dword v10, off, s[4:7], s40 sc1
s_waitcnt vmcnt(0)
s_sub_u32 s24, s24, 1
s_cbranch_scc0 Lflag_126
s_endpgm
Lset_128:
buffer_load_dwordx4 v[44:47], v1, s[4:7], s29 offen sc1
buffer_load_dwordx4 v[48:51], v1, s[4:7], s29 offen offset:1024 sc1
buffer_load_dwordx4 v[52:55], v1, s[4:7], s29 offen offset:2048 sc1
buffer_load_dwordx4 v[56:59], v1, s[4:7], s29 offen offset:3072 sc1
buffer_load_dwordx4 v[60:63], v1, s[4:7], s30 offen sc1
buffer_load_dwordx4 v[64:67], v1, s[4:7], s30 offen offset:1024 sc1
buffer_load_dwordx4 v[68:71], v1, s[4:7], s30 offen offset:2048 sc1
buffer_load_dwordx4 v[72:75], v1, s[4:7], s30 offen offset:3072 sc1
Lintime_125:
s_waitcnt vmcnt(0)
v_cmp_ne_u32 s[36:37], s88, v8
buffer_load_dwordx4 v[92:95], v1, s[4:7], s27 offen sc1
buffer_load_dwordx4 v[96:99], v1, s[4:7], s27 offen offset:1024 sc1
buffer_load_dwordx4 v[100:103], v3, s[4:7], s28 offen sc1
s_nop 15
s_nop 13
Lspin_129:
buffer_load_dwordx4 v[92:95], v1, s[4:7], s27 offen sc1
buffer_load_dwordx4 v[96:99], v1, s[4:7], s27 offen offset:1024 sc1
buffer_load_dwordx4 v[100:103], v3, s[4:7], s28 offen sc1
s_sub_u32 s24, s24, 1
s_cbranch_scc1 CODE_END
v_mfma_f32_16x16x32_bf16 v[160:163], v[12:15], v[12:15], 0
s_waitcnt vmcnt(3)
v_max3_u32 v9, v92, v93, v94
v_max3_u32 v9, v9, v95, v96
v_max3_u32 v9, v9, v97, v98
v_max3_u32 v9, v9, v99, v100
v_max3_u32 v9, v9, v101, v102
v_max_u32 v9, v9, v103
v_cmp_eq_u32 vcc, -1, v9
v_smfmac_f32_16x16x64_bf16 v[160:163], v[92:95], v[44:51], v7
v_smfmac_f32_16x16x64_bf16 v[160:163], v[96:99], v[60:67], v7
s_cbranch_vccnz Lspin_129
v_smfmac_f32_16x16x64_bf16 v[160:163], v[100:103], v[76:83], v7
v_smfmac_f32_16x16x64_bf16 v[164:167], v[92:95], v[52:59], v7
v_smfmac_f32_16x16x64_bf16 v[164:167], v[96:99], v[68:75], v7
v_smfmac_f32_16x16x64_bf16 v[164:167], v[100:103], v[84:91], v7
v_permlane32_swap_b32 v160, v162
v_permlane32_swap_b32 v161, v163
v_add_f32 v160, v160, v162
v_add_f32 v161, v161, v163
ds_write2_b32 v4, v160, v161 offset0:0 offset1:16
s_nop 1
v_permlane32_swap_b32 v164, v166
v_permlane32_swap_b32 v165, v167
v_add_f32 v164, v164, v166
v_add_f32 v165, v165, v167
ds_write2_b32 v4, v164, v165 offset0:128 offset1:144
s_waitcnt lgkmcnt(0)
s_barrier
ds_read_b64 v[160:161], v5
ds_read_b64 v[162:163], v5 offset:1024
ds_read_b64 v[164:165], v5 offset:2048
ds_read_b64 v[166:167], v5 offset:3072
s_waitcnt lgkmcnt(2)
v_pk_add_f32 v[160:161], v[160:161], v[162:163]
s_waitcnt lgkmcnt(0)
v_pk_add_f32 v[164:165], v[164:165], v[166:167]
v_pk_add_f32 v[160:161], v[160:161], v[164:165]
v_cvt_pk_bf16_f32 v160, v160, v161
v_min_u32 v160, -2, v160
s_cmp_eq_u32 s25, 62
s_cselect_b32 s40, 1, s23
s_cmp_eq_u32 s40, 0
s_cbranch_scc1 Llater_130
buffer_store_dword v160, v6, s[4:7], s32 offen sc1
Llater_130:
s_cmp_eq_u64 s[36:37], 0
s_cbranch_scc1 Lseen_131
buffer_load_dword v8, off, s[4:7], s31 sc1
s_waitcnt vmcnt(0)
v_cmp_ne_u32 vcc, s88, v8
s_cmp_lg_u64 vcc, 0
s_cselect_b32 s35, 0x40000000, 0
s_add_u32 s29, s29, s35
s_add_u32 s30, s30, s35
Lseen_131:
s_add_u32 s26, s26, 7168
s_add_u32 s32, s32, 7168
s_add_u32 s33, s33, 1
s_add_u32 s27, s27, 10240
s_add_u32 s28, s28, 10240
s_add_u32 s29, s29, 458752
s_add_u32 s30, s30, 458752
s_add_u32 s25, s25, 1
s_cmp_lt_u32 s25, 63
s_cbranch_scc1 S2_STEP3
s_endpgm
TA_W0:
v_lshlrev_b32 v1, 4, v0
s_cmp_lt_u32 s21, 2
s_cselect_b32 s42, 0, 4
s_add_u32 s42, s42, s21
s_lshl_b32 s40, s42, 7
s_add_u32 s40, s40, 139264
s_branch Lfirst_133
Lflag_132:
v_cmp_ne_u32 vcc, s88, v10
s_cbranch_vccz Lset_134
s_sleep 16
Lfirst_133:
buffer_load_dword v10, off, s[4:7], s40 sc1
s_waitcnt vmcnt(0)
s_sub_u32 s24, s24, 1
s_cbranch_scc0 Lflag_132
s_endpgm
Lset_134:
v_min_u32 v12, 55, v0
v_and_b32 v10, 3, v12
v_lshlrev_b32 v10, 3, v10
v_lshrrev_b32 v12, 2, v12
v_lshl_add_u32 v10, v12, 7, v10
s_mov_b32 s43, 4352
Llz_135:
buffer_load_dwordx2 v[12:13], v10, s[4:7], s43 offen sc1
s_waitcnt vmcnt(0)
v_cmp_ne_u32 vcc, s88, v12
v_cmp_ne_u32 s[40:41], s88, v13
s_or_b64 vcc, vcc, s[40:41]
s_cbranch_vccz Llzok_136
s_sleep 8
s_sub_u32 s24, s24, 1
s_cbranch_scc0 Llz_135
s_endpgm
Llzok_136:
s_mul_i32 s40, s21, 7168
s_add_u32 s40, s40, 656384
Lstp_137:
buffer_load_dword v10, off, s[4:7], s40 sc1
s_waitcnt vmcnt(0)
v_cmp_eq_u32 vcc, -1, v10
s_cbranch_vccz Lstpok_138
s_sleep 16
s_sub_u32 s24, s24, 1
s_cbranch_scc0 Lstp_137
s_endpgm
Lstpok_138:
v_min_u32 v10, 6, v0
v_lshlrev_b32 v10, 2, v10
s_lshl_b32 s40, s22, 7
s_branch Lfirst_140
Lflag_139:
v_cmp_ne_u32 vcc, s88, v11
s_cbranch_vccz Lset_141
s_sleep 4
Lfirst_140:
buffer_load_dword v11, v10, s[4:7], s40 offen sc1
s_waitcnt vmcnt(0)
s_sub_u32 s24, s24, 1
s_cbranch_scc0 Lflag_139
s_endpgm
Lset_141:
s_mul_i32 s40, s22, 401408
s_add_u32 s40, s40, 9879552
buffer_load_dwordx4 a[0:3], v1, s[4:7], s40 offen
buffer_load_dwordx4 a[4:7], v1, s[4:7], s40 offen offset:1024
buffer_load_dwordx4 a[8:11], v1, s[4:7], s40 offen offset:2048
buffer_load_dwordx4 a[12:15], v1, s[4:7], s40 offen offset:3072
s_add_u32 s40, s40, 4096
buffer_load_dwordx4 a[16:19], v1, s[4:7], s40 offen
buffer_load_dwordx4 a[20:23], v1, s[4:7], s40 offen offset:1024
buffer_load_dwordx4 a[24:27], v1, s[4:7], s40 offen offset:2048
buffer_load_dwordx4 a[28:31], v1, s[4:7], s40 offen offset:3072
s_add_u32 s40, s40, 4096
buffer_load_dwordx4 a[32:35], v1, s[4:7], s40 offen
buffer_load_dwordx4 a[36:39], v1, s[4:7], s40 offen offset:1024
buffer_load_dwordx4 a[40:43], v1, s[4:7], s40 offen offset:2048
buffer_load_dwordx4 a[44:47], v1, s[4:7], s40 offen offset:3072
s_add_u32 s40, s40, 4096
buffer_load_dwordx4 a[48:51], v1, s[4:7], s40 offen
buffer_load_dwordx4 a[52:55], v1, s[4:7], s40 offen offset:1024
buffer_load_dwordx4 a[56:59], v1, s[4:7], s40 offen offset:2048
buffer_load_dwordx4 a[60:63], v1, s[4:7], s40 offen offset:3072
s_add_u32 s40, s40, 4096
buffer_load_dwordx4 a[64:67], v1, s[4:7], s40 offen
buffer_load_dwordx4 a[68:71], v1, s[4:7], s40 offen offset:1024
buffer_load_dwordx4 a[72:75], v1, s[4:7], s40 offen offset:2048
buffer_load_dwordx4 a[76:79], v1, s[4:7], s40 offen offset:3072
s_add_u32 s40, s40, 4096
buffer_load_dwordx4 a[80:83], v1, s[4:7], s40 offen
buffer_load_dwordx4 a[84:87], v1, s[4:7], s40 offen offset:1024
buffer_load_dwordx4 a[88:91], v1, s[4:7], s40 offen offset:2048
buffer_load_dwordx4 a[92:95], v1, s[4:7], s40 offen offset:3072
s_add_u32 s40, s40, 4096
buffer_load_dwordx4 a[96:99], v1, s[4:7], s40 offen
buffer_load_dwordx4 a[100:103], v1, s[4:7], s40 offen offset:1024
buffer_load_dwordx4 a[104:107], v1, s[4:7], s40 offen offset:2048
buffer_load_dwordx4 a[108:111], v1, s[4:7], s40 offen offset:3072
s_add_u32 s40, s40, 4096
buffer_load_dwordx4 a[112:115], v1, s[4:7], s40 offen
buffer_load_dwordx4 a[116:119], v1, s[4:7], s40 offen offset:1024
buffer_load_dwordx4 a[120:123], v1, s[4:7], s40 offen offset:2048
buffer_load_dwordx4 a[124:127], v1, s[4:7], s40 offen offset:3072
s_add_u32 s40, s40, 4096
buffer_load_dwordx4 a[128:131], v1, s[4:7], s40 offen
buffer_load_dwordx4 a[132:135], v1, s[4:7], s40 offen offset:1024
buffer_load_dwordx4 a[136:139], v1, s[4:7], s40 offen offset:2048
buffer_load_dwordx4 a[140:143], v1, s[4:7], s40 offen offset:3072
s_add_u32 s40, s40, 4096
buffer_load_dwordx4 a[144:147], v1, s[4:7], s40 offen
buffer_load_dwordx4 a[148:151], v1, s[4:7], s40 offen offset:1024
buffer_load_dwordx4 a[152:155], v1, s[4:7], s40 offen offset:2048
buffer_load_dwordx4 a[156:159], v1, s[4:7], s40 offen offset:3072
s_add_u32 s40, s40, 4096
buffer_load_dwordx4 a[160:163], v1, s[4:7], s40 offen
buffer_load_dwordx4 a[164:167], v1, s[4:7], s40 offen offset:1024
buffer_load_dwordx4 a[168:171], v1, s[4:7], s40 offen offset:2048
buffer_load_dwordx4 a[172:175], v1, s[4:7], s40 offen offset:3072
s_add_u32 s40, s40, 4096
buffer_load_dwordx4 a[176:179], v1, s[4:7], s40 offen
buffer_load_dwordx4 a[180:183], v1, s[4:7], s40 offen offset:1024
buffer_load_dwordx4 a[184:187], v1, s[4:7], s40 offen offset:2048
buffer_load_dwordx4 a[188:191], v1, s[4:7], s40 offen offset:3072
s_add_u32 s40, s40, 4096
s_waitcnt vmcnt(40)
buffer_load_dwordx4 a[192:195], v1, s[4:7], s40 offen
buffer_load_dwordx4 a[196:199], v1, s[4:7], s40 offen offset:1024
buffer_load_dwordx4 a[200:203], v1, s[4:7], s40 offen offset:2048
buffer_load_dwordx4 a[204:207], v1, s[4:7], s40 offen offset:3072
s_add_u32 s40, s40, 4096
buffer_load_dwordx4 a[208:211], v1, s[4:7], s40 offen
buffer_load_dwordx4 a[212:215], v1, s[4:7], s40 offen offset:1024
buffer_load_dwordx4 a[216:219], v1, s[4:7], s40 offen offset:2048
buffer_load_dwordx4 a[220:223], v1, s[4:7], s40 offen offset:3072
s_add_u32 s40, s40, 4096
s_waitcnt vmcnt(40)
buffer_load_dwordx4 a[224:227], v1, s[4:7], s40 offen
buffer_load_dwordx4 a[228:231], v1, s[4:7], s40 offen offset:1024
buffer_load_dwordx4 a[232:235], v1, s[4:7], s40 offen offset:2048
buffer_load_dwordx4 a[236:239], v1, s[4:7], s40 offen offset:3072
s_add_u32 s40, s40, 4096
buffer_load_dwordx4 a[240:243], v1, s[4:7], s40 offen
buffer_load_dwordx4 a[244:247], v1, s[4:7], s40 offen offset:1024
buffer_load_dwordx4 a[248:251], v1, s[4:7], s40 offen offset:2048
buffer_load_dwordx4 a[252:255], v1, s[4:7], s40 offen offset:3072
s_add_u32 s40, s40, 4096
s_waitcnt vmcnt(40)
buffer_load_dwordx4 v[120:123], v1, s[4:7], s40 offen
buffer_load_dwordx4 v[124:127], v1, s[4:7], s40 offen offset:1024
buffer_load_dwordx4 v[128:131], v1, s[4:7], s40 offen offset:2048
buffer_load_dwordx4 v[132:135], v1, s[4:7], s40 offen offset:3072
s_add_u32 s40, s40, 4096
buffer_load_dwordx4 v[136:139], v1, s[4:7], s40 offen
buffer_load_dwordx4 v[140:143], v1, s[4:7], s40 offen offset:1024
buffer_load_dwordx4 v[144:147], v1, s[4:7], s40 offen offset:2048
buffer_load_dwordx4 v[148:151], v1, s[4:7], s40 offen offset:3072
s_add_u32 s40, s40, 4096
s_waitcnt vmcnt(40)
buffer_load_dwordx4 v[152:155], v1, s[4:7], s40 offen
buffer_load_dwordx4 v[156:159], v1, s[4:7], s40 offen offset:1024
buffer_load_dwordx4 v[160:163], v1, s[4:7], s40 offen offset:2048
buffer_load_dwordx4 v[164:167], v1, s[4:7], s40 offen offset:3072
s_add_u32 s40, s40, 4096
buffer_load_dwordx4 v[168:171], v1, s[4:7], s40 offen
buffer_load_dwordx4 v[172:175], v1, s[4:7], s40 offen offset:1024
buffer_load_dwordx4 v[176:179], v1, s[4:7], s40 offen offset:2048
buffer_load_dwordx4 v[180:183], v1, s[4:7], s40 offen offset:3072
s_add_u32 s40, s40, 4096
s_waitcnt vmcnt(40)
buffer_load_dwordx4 v[184:187], v1, s[4:7], s40 offen
buffer_load_dwordx4 v[188:191], v1, s[4:7], s40 offen offset:1024
buffer_load_dwordx4 v[192:195], v1, s[4:7], s40 offen offset:2048
buffer_load_dwordx4 v[196:199], v1, s[4:7], s40 offen offset:3072
s_add_u32 s40, s40, 4096
buffer_load_dwordx4 v[200:203], v1, s[4:7], s40 offen
buffer_load_dwordx4 v[204:207], v1, s[4:7], s40 offen offset:1024
buffer_load_dwordx4 v[208:211], v1, s[4:7], s40 offen offset:2048
buffer_load_dwordx4 v[212:215], v1, s[4:7], s40 offen offset:3072
s_add_u32 s40, s40, 4096
s_waitcnt vmcnt(40)
buffer_load_dwordx4 v[216:219], v1, s[4:7], s40 offen
buffer_load_dwordx4 v[220:223], v1, s[4:7], s40 offen offset:1024
buffer_load_dwordx4 v[224:227], v1, s[4:7], s40 offen offset:2048
buffer_load_dwordx4 v[228:231], v1, s[4:7], s40 offen offset:3072
s_add_u32 s40, s40, 4096
buffer_load_dwordx4 v[232:235], v1, s[4:7], s40 offen
buffer_load_dwordx4 v[236:239], v1, s[4:7], s40 offen offset:1024
buffer_load_dwordx4 v[240:243], v1, s[4:7], s40 offen offset:2048
buffer_load_dwordx4 v[244:247], v1, s[4:7], s40 offen offset:3072
s_add_u32 s40, s40, 4096
s_waitcnt vmcnt(40)
buffer_load_dwordx4 v[248:251], v1, s[4:7], s40 offen
buffer_load_dwordx4 v[252:255], v1, s[4:7], s40 offen offset:1024
v_and_b32 v10, 15, v0
v_lshrrev_b32 v11, 4, v0
v_lshrrev_b32 v3, 5, v0
v_add_u32 v3, 0, v3
v_lshrrev_b32 v2, 2, v3
v_lshlrev_b32 v2, 10, v2
v_and_b32 v4, 3, v3
v_lshl_add_u32 v2, v4, 8, v2
v_lshl_add_u32 v2, v10, 4, v2
v_and_b32 v4, 1, v11
v_lshl_add_u32 v2, v4, 3, v2
v_add_u32 v2, 28672, v2
v_lshlrev_b32 v3, 7, v3
v_lshl_add_u32 v3, v4, 3, v3
v_and_b32 v5, 7, v0
v_lshl_add_u32 v3, v5, 4, v3
v_mul_u32_u24 v6, 144, v10
v_lshl_add_u32 v7, v11, 4, v6
v_lshl_add_u32 v6, v4, 4, v6
v_add_u32 v4, 58368, v7
v_add_u32 v6, 76800, v6
v_lshrrev_b32 v10, 3, v0
v_add_u32 v10, 0, v10
v_and_b32 v11, 7, v0
v_mul_u32_u24 v7, 144, v10
v_lshl_add_u32 v5, v11, 4, v7
v_add_u32 v5, 58368, v5
v_lshl_add_u32 v7, v11, 2, v7
v_add_u32 v7, 76800, v7
v_lshlrev_b32 v8, 2, v11
v_sub_u32 v8, v10, v8
v_cmp_le_i32 s[32:33], 0, v8
v_cmp_le_i32 s[34:35], 1, v8
v_cmp_le_i32 s[36:37], 2, v8
v_cmp_le_i32 s[38:39], 3, v8
v_and_b32 v10, 15, v10
v_lshlrev_b32 v10, 4, v10
v_bfe_u32 v9, v0, 1, 1
v_lshl_add_u32 v10, v9, 2, v10
v_bfe_u32 v11, v0, 2, 1
v_lshl_add_u32 v9, v11, 8, v10
v_lshl_add_u32 v8, v11, 9, v10
v_and_b32 v11, 1, v0
v_lshl_add_u32 v8, v11, 8, v8
v_lshlrev_b32 v11, 30, v11
v_or_b32 v9, v9, v11
v_mov_b32 v10, 0
v_lshlrev_b32 v11, 2, v0
ds_write_b32 v11, v10 offset:57344
v_mov_b32 v102, 0
v_mov_b32 v103, 0
v_mov_b32 v118, 0
v_mov_b32 v119, 0
s_mul_i32 s26, s21, 28672
s_add_u32 s27, s26, 6205440
s_add_u32 s26, s26, 8044544
s_mul_i32 s28, s21, 7168
s_add_u32 s28, s28, 634880
s_mul_i32 s29, s21, 40960
s_add_u32 s29, s29, 1748992
s_lshr_b32 s30, s22, 1
s_lshl_b32 s30, s30, 10
s_and_b32 s40, s22, 1
s_lshl_b32 s40, s40, 3
s_add_u32 s30, s30, s40
s_add_u32 s30, s30, s29
s_add_u32 s30, s30, 32768
s_lshl_b32 s40, s22, 11
s_add_u32 s29, s29, s40
s_add_u32 s29, s29, 0
s_mov_b32 s47, 0xceabfb8f
s_mov_b32 s25, s21
v_min_u32 v12, 55, v0
v_and_b32 v10, 3, v12
v_lshlrev_b32 v10, 3, v10
v_lshrrev_b32 v12, 2, v12
v_lshl_add_u32 v10, v12, 7, v10
s_mov_b32 s43, 4352
Llz_142:
buffer_load_dwordx2 v[12:13], v10, s[4:7], s43 offen sc1
s_waitcnt vmcnt(0)
v_cmp_ne_u32 vcc, s88, v12
v_cmp_ne_u32 s[40:41], s88, v13
s_or_b64 vcc, vcc, s[40:41]
s_cbranch_vccz Llzok_143
s_sleep 8
s_sub_u32 s24, s24, 1
s_cbranch_scc0 Llz_142
s_endpgm
Llzok_143:
v_min_u32 v12, 47, v0
v_and_b32 v10, 3, v12
v_lshlrev_b32 v10, 3, v10
v_lshrrev_b32 v12, 2, v12
v_lshl_add_u32 v10, v12, 7, v10
s_mov_b32 s43, 6144
Llz_144:
buffer_load_dwordx2 v[12:13], v10, s[4:7], s43 offen sc1
s_waitcnt vmcnt(0)
v_cmp_ne_u32 vcc, s88, v12
v_cmp_ne_u32 s[40:41], s88, v13
s_or_b64 vcc, vcc, s[40:41]
s_cbranch_vccz Llzok_145
s_sleep 8
s_sub_u32 s24, s24, 1
s_cbranch_scc0 Llz_144
s_endpgm
Llzok_145:
TA_SEG0:
s_mov_b32 m0, 0
s_add_u32 s40, s26, 0
buffer_load_dwordx4 v1, s[4:7], s40 offen lds
s_mov_b32 m0, 1024
s_add_u32 s40, s26, 1024
buffer_load_dwordx4 v1, s[4:7], s40 offen lds
s_mov_b32 m0, 2048
s_add_u32 s40, s26, 2048
buffer_load_dwordx4 v1, s[4:7], s40 offen lds
s_mov_b32 m0, 3072
s_add_u32 s40, s26, 3072
buffer_load_dwordx4 v1, s[4:7], s40 offen lds
s_mov_b32 m0, 4096
s_add_u32 s40, s26, 4096
buffer_load_dwordx4 v1, s[4:7], s40 offen lds
s_mov_b32 m0, 5120
s_add_u32 s40, s26, 5120
buffer_load_dwordx4 v1, s[4:7], s40 offen lds
s_mov_b32 m0, 6144
s_add_u32 s40, s26, 6144
buffer_load_dwordx4 v1, s[4:7], s40 offen lds
s_mov_b32 m0, 28672
s_add_u32 s40, s27, 0
buffer_load_dwordx4 v1, s[4:7], s40 offen lds
s_mov_b32 m0, 29696
s_add_u32 s40, s27, 1024
buffer_load_dwordx4 v1, s[4:7], s40 offen lds
s_mov_b32 m0, 30720
s_add_u32 s40, s27, 2048
buffer_load_dwordx4 v1, s[4:7], s40 offen lds
s_mov_b32 m0, 31744
s_add_u32 s40, s27, 3072
buffer_load_dwordx4 v1, s[4:7], s40 offen lds
s_mov_b32 m0, 32768
s_add_u32 s40, s27, 4096
buffer_load_dwordx4 v1, s[4:7], s40 offen lds
s_mov_b32 m0, 33792
s_add_u32 s40, s27, 5120
buffer_load_dwordx4 v1, s[4:7], s40 offen lds
s_mov_b32 m0, 34816
s_add_u32 s40, s27, 6144
buffer_load_dwordx4 v1, s[4:7], s40 offen lds
s_waitcnt vmcnt(0) lgkmcnt(0)
s_barrier
ds_read_b128 v[72:75], v1
ds_read_b128 v[76:79], v1 offset:14336
s_waitcnt lgkmcnt(0)
v_mfma_f32_16x16x32_bf16 v[16:19], a[0:3], v[72:75], 0
v_mfma_f32_16x16x32_bf16 v[44:47], a[0:3], v[76:79], 0
ds_read_b128 v[80:83], v1 offset:1024
ds_read_b128 v[84:87], v1 offset:15360
v_mfma_f32_16x16x32_bf16 v[20:23], a[56:59], v[72:75], 0
v_mfma_f32_16x16x32_bf16 v[48:51], a[56:59], v[76:79], 0
v_mfma_f32_16x16x32_bf16 v[24:27], a[112:115], v[72:75], 0
v_mfma_f32_16x16x32_bf16 v[52:55], a[112:115], v[76:79], 0
v_mfma_f32_16x16x32_bf16 v[28:31], a[168:171], v[72:75], 0
v_mfma_f32_16x16x32_bf16 v[56:59], a[168:171], v[76:79], 0
v_mfma_f32_16x16x32_bf16 v[32:35], a[224:227], v[72:75], 0
v_mfma_f32_16x16x32_bf16 v[60:63], a[224:227], v[76:79], 0
v_mfma_f32_16x16x32_bf16 v[36:39], v[144:147], v[72:75], 0
v_mfma_f32_16x16x32_bf16 v[64:67], v[144:147], v[76:79], 0
v_mfma_f32_16x16x32_bf16 v[40:43], v[200:203], v[72:75], 0
v_mfma_f32_16x16x32_bf16 v[68:71], v[200:203], v[76:79], 0
s_waitcnt lgkmcnt(0)
v_mfma_f32_16x16x32_bf16 v[16:19], a[4:7], v[80:83], v[16:19]
v_mfma_f32_16x16x32_bf16 v[44:47], a[4:7], v[84:87], v[44:47]
ds_read_b128 v[72:75], v1 offset:2048
ds_read_b128 v[76:79], v1 offset:16384
v_mfma_f32_16x16x32_bf16 v[20:23], a[60:63], v[80:83], v[20:23]
v_mfma_f32_16x16x32_bf16 v[48:51], a[60:63], v[84:87], v[48:51]
v_mfma_f32_16x16x32_bf16 v[24:27], a[116:119], v[80:83], v[24:27]
v_mfma_f32_16x16x32_bf16 v[52:55], a[116:119], v[84:87], v[52:55]
v_mfma_f32_16x16x32_bf16 v[28:31], a[172:175], v[80:83], v[28:31]
v_mfma_f32_16x16x32_bf16 v[56:59], a[172:175], v[84:87], v[56:59]
v_mfma_f32_16x16x32_bf16 v[32:35], a[228:231], v[80:83], v[32:35]
v_mfma_f32_16x16x32_bf16 v[60:63], a[228:231], v[84:87], v[60:63]
v_mfma_f32_16x16x32_bf16 v[36:39], v[148:151], v[80:83], v[36:39]
v_mfma_f32_16x16x32_bf16 v[64:67], v[148:151], v[84:87], v[64:67]
v_mfma_f32_16x16x32_bf16 v[40:43], v[204:207], v[80:83], v[40:43]
v_mfma_f32_16x16x32_bf16 v[68:71], v[204:207], v[84:87], v[68:71]
s_waitcnt lgkmcnt(0)
v_mfma_f32_16x16x32_bf16 v[16:19], a[8:11], v[72:75], v[16:19]
v_mfma_f32_16x16x32_bf16 v[44:47], a[8:11], v[76:79], v[44:47]
ds_read_b128 v[80:83], v1 offset:3072
ds_read_b128 v[84:87], v1 offset:17408
v_mfma_f32_16x16x32_bf16 v[20:23], a[64:67], v[72:75], v[20:23]
v_mfma_f32_16x16x32_bf16 v[48:51], a[64:67], v[76:79], v[48:51]
v_mfma_f32_16x16x32_bf16 v[24:27], a[120:123], v[72:75], v[24:27]
v_mfma_f32_16x16x32_bf16 v[52:55], a[120:123], v[76:79], v[52:55]
v_mfma_f32_16x16x32_bf16 v[28:31], a[176:179], v[72:75], v[28:31]
v_mfma_f32_16x16x32_bf16 v[56:59], a[176:179], v[76:79], v[56:59]
v_mfma_f32_16x16x32_bf16 v[32:35], a[232:235], v[72:75], v[32:35]
v_mfma_f32_16x16x32_bf16 v[60:63], a[232:235], v[76:79], v[60:63]
v_mfma_f32_16x16x32_bf16 v[36:39], v[152:155], v[72:75], v[36:39]
v_mfma_f32_16x16x32_bf16 v[64:67], v[152:155], v[76:79], v[64:67]
v_mfma_f32_16x16x32_bf16 v[40:43], v[208:211], v[72:75], v[40:43]
v_mfma_f32_16x16x32_bf16 v[68:71], v[208:211], v[76:79], v[68:71]
s_waitcnt lgkmcnt(0)
v_mfma_f32_16x16x32_bf16 v[16:19], a[12:15], v[80:83], v[16:19]
v_mfma_f32_16x16x32_bf16 v[44:47], a[12:15], v[84:87], v[44:47]
ds_read_b128 v[72:75], v1 offset:4096
ds_read_b128 v[76:79], v1 offset:18432
v_mfma_f32_16x16x32_bf16 v[20:23], a[68:71], v[80:83], v[20:23]
v_mfma_f32_16x16x32_bf16 v[48:51], a[68:71], v[84:87], v[48:51]
v_mfma_f32_16x16x32_bf16 v[24:27], a[124:127], v[80:83], v[24:27]
v_mfma_f32_16x16x32_bf16 v[52:55], a[124:127], v[84:87], v[52:55]
v_mfma_f32_16x16x32_bf16 v[28:31], a[180:183], v[80:83], v[28:31]
v_mfma_f32_16x16x32_bf16 v[56:59], a[180:183], v[84:87], v[56:59]
v_mfma_f32_16x16x32_bf16 v[32:35], a[236:239], v[80:83], v[32:35]
v_mfma_f32_16x16x32_bf16 v[60:63], a[236:239], v[84:87], v[60:63]
v_mfma_f32_16x16x32_bf16 v[36:39], v[156:159], v[80:83], v[36:39]
v_mfma_f32_16x16x32_bf16 v[64:67], v[156:159], v[84:87], v[64:67]
v_mfma_f32_16x16x32_bf16 v[40:43], v[212:215], v[80:83], v[40:43]
v_mfma_f32_16x16x32_bf16 v[68:71], v[212:215], v[84:87], v[68:71]
s_waitcnt lgkmcnt(0)
v_mfma_f32_16x16x32_bf16 v[16:19], a[16:19], v[72:75], v[16:19]
v_mfma_f32_16x16x32_bf16 v[44:47], a[16:19], v[76:79], v[44:47]
ds_read_b128 v[80:83], v1 offset:5120
ds_read_b128 v[84:87], v1 offset:19456
v_mfma_f32_16x16x32_bf16 v[20:23], a[72:75], v[72:75], v[20:23]
v_mfma_f32_16x16x32_bf16 v[48:51], a[72:75], v[76:79], v[48:51]
v_mfma_f32_16x16x32_bf16 v[24:27], a[128:131], v[72:75], v[24:27]
v_mfma_f32_16x16x32_bf16 v[52:55], a[128:131], v[76:79], v[52:55]
v_mfma_f32_16x16x32_bf16 v[28:31], a[184:187], v[72:75], v[28:31]
v_mfma_f32_16x16x32_bf16 v[56:59], a[184:187], v[76:79], v[56:59]
v_mfma_f32_16x16x32_bf16 v[32:35], a[240:243], v[72:75], v[32:35]
v_mfma_f32_16x16x32_bf16 v[60:63], a[240:243], v[76:79], v[60:63]
v_mfma_f32_16x16x32_bf16 v[36:39], v[160:163], v[72:75], v[36:39]
v_mfma_f32_16x16x32_bf16 v[64:67], v[160:163], v[76:79], v[64:67]
v_mfma_f32_16x16x32_bf16 v[40:43], v[216:219], v[72:75], v[40:43]
v_mfma_f32_16x16x32_bf16 v[68:71], v[216:219], v[76:79], v[68:71]
s_waitcnt lgkmcnt(0)
v_mfma_f32_16x16x32_bf16 v[16:19], a[20:23], v[80:83], v[16:19]
v_mfma_f32_16x16x32_bf16 v[44:47], a[20:23], v[84:87], v[44:47]
ds_read_b128 v[72:75], v1 offset:6144
ds_read_b128 v[76:79], v1 offset:20480
v_mfma_f32_16x16x32_bf16 v[20:23], a[76:79], v[80:83], v[20:23]
v_mfma_f32_16x16x32_bf16 v[48:51], a[76:79], v[84:87], v[48:51]
v_mfma_f32_16x16x32_bf16 v[24:27], a[132:135], v[80:83], v[24:27]
v_mfma_f32_16x16x32_bf16 v[52:55], a[132:135], v[84:87], v[52:55]
v_mfma_f32_16x16x32_bf16 v[28:31], a[188:191], v[80:83], v[28:31]
v_mfma_f32_16x16x32_bf16 v[56:59], a[188:191], v[84:87], v[56:59]
v_mfma_f32_16x16x32_bf16 v[32:35], a[244:247], v[80:83], v[32:35]
v_mfma_f32_16x16x32_bf16 v[60:63], a[244:247], v[84:87], v[60:63]
v_mfma_f32_16x16x32_bf16 v[36:39], v[164:167], v[80:83], v[36:39]
v_mfma_f32_16x16x32_bf16 v[64:67], v[164:167], v[84:87], v[64:67]
v_mfma_f32_16x16x32_bf16 v[40:43], v[220:223], v[80:83], v[40:43]
v_mfma_f32_16x16x32_bf16 v[68:71], v[220:223], v[84:87], v[68:71]
s_waitcnt lgkmcnt(0)
v_mfma_f32_16x16x32_bf16 v[16:19], a[24:27], v[72:75], v[16:19]
v_mfma_f32_16x16x32_bf16 v[44:47], a[24:27], v[76:79], v[44:47]
ds_read_b128 v[80:83], v1 offset:7168
ds_read_b128 v[84:87], v1 offset:21504
v_mfma_f32_16x16x32_bf16 v[20:23], a[80:83], v[72:75], v[20:23]
v_mfma_f32_16x16x32_bf16 v[48:51], a[80:83], v[76:79], v[48:51]
v_mfma_f32_16x16x32_bf16 v[24:27], a[136:139], v[72:75], v[24:27]
v_mfma_f32_16x16x32_bf16 v[52:55], a[136:139], v[76:79], v[52:55]
v_mfma_f32_16x16x32_bf16 v[28:31], a[192:195], v[72:75], v[28:31]
v_mfma_f32_16x16x32_bf16 v[56:59], a[192:195], v[76:79], v[56:59]
v_mfma_f32_16x16x32_bf16 v[32:35], a[248:251], v[72:75], v[32:35]
v_mfma_f32_16x16x32_bf16 v[60:63], a[248:251], v[76:79], v[60:63]
v_mfma_f32_16x16x32_bf16 v[36:39], v[168:171], v[72:75], v[36:39]
v_mfma_f32_16x16x32_bf16 v[64:67], v[168:171], v[76:79], v[64:67]
v_mfma_f32_16x16x32_bf16 v[40:43], v[224:227], v[72:75], v[40:43]
v_mfma_f32_16x16x32_bf16 v[68:71], v[224:227], v[76:79], v[68:71]
s_waitcnt lgkmcnt(0)
v_mfma_f32_16x16x32_bf16 v[16:19], a[28:31], v[80:83], v[16:19]
v_mfma_f32_16x16x32_bf16 v[44:47], a[28:31], v[84:87], v[44:47]
ds_read_b128 v[72:75], v1 offset:8192
ds_read_b128 v[76:79], v1 offset:22528
v_mfma_f32_16x16x32_bf16 v[20:23], a[84:87], v[80:83], v[20:23]
v_mfma_f32_16x16x32_bf16 v[48:51], a[84:87], v[84:87], v[48:51]
v_mfma_f32_16x16x32_bf16 v[24:27], a[140:143], v[80:83], v[24:27]
v_mfma_f32_16x16x32_bf16 v[52:55], a[140:143], v[84:87], v[52:55]
v_mfma_f32_16x16x32_bf16 v[28:31], a[196:199], v[80:83], v[28:31]
v_mfma_f32_16x16x32_bf16 v[56:59], a[196:199], v[84:87], v[56:59]
v_mfma_f32_16x16x32_bf16 v[32:35], a[252:255], v[80:83], v[32:35]
v_mfma_f32_16x16x32_bf16 v[60:63], a[252:255], v[84:87], v[60:63]
v_mfma_f32_16x16x32_bf16 v[36:39], v[172:175], v[80:83], v[36:39]
v_mfma_f32_16x16x32_bf16 v[64:67], v[172:175], v[84:87], v[64:67]
v_mfma_f32_16x16x32_bf16 v[40:43], v[228:231], v[80:83], v[40:43]
v_mfma_f32_16x16x32_bf16 v[68:71], v[228:231], v[84:87], v[68:71]
s_waitcnt lgkmcnt(0)
v_mfma_f32_16x16x32_bf16 v[16:19], a[32:35], v[72:75], v[16:19]
v_mfma_f32_16x16x32_bf16 v[44:47], a[32:35], v[76:79], v[44:47]
ds_read_b128 v[80:83], v1 offset:9216
ds_read_b128 v[84:87], v1 offset:23552
v_mfma_f32_16x16x32_bf16 v[20:23], a[88:91], v[72:75], v[20:23]
v_mfma_f32_16x16x32_bf16 v[48:51], a[88:91], v[76:79], v[48:51]
v_mfma_f32_16x16x32_bf16 v[24:27], a[144:147], v[72:75], v[24:27]
v_mfma_f32_16x16x32_bf16 v[52:55], a[144:147], v[76:79], v[52:55]
v_mfma_f32_16x16x32_bf16 v[28:31], a[200:203], v[72:75], v[28:31]
v_mfma_f32_16x16x32_bf16 v[56:59], a[200:203], v[76:79], v[56:59]
v_mfma_f32_16x16x32_bf16 v[32:35], v[120:123], v[72:75], v[32:35]
v_mfma_f32_16x16x32_bf16 v[60:63], v[120:123], v[76:79], v[60:63]
v_mfma_f32_16x16x32_bf16 v[36:39], v[176:179], v[72:75], v[36:39]
v_mfma_f32_16x16x32_bf16 v[64:67], v[176:179], v[76:79], v[64:67]
v_mfma_f32_16x16x32_bf16 v[40:43], v[232:235], v[72:75], v[40:43]
v_mfma_f32_16x16x32_bf16 v[68:71], v[232:235], v[76:79], v[68:71]
s_waitcnt lgkmcnt(0)
v_mfma_f32_16x16x32_bf16 v[16:19], a[36:39], v[80:83], v[16:19]
v_mfma_f32_16x16x32_bf16 v[44:47], a[36:39], v[84:87], v[44:47]
ds_read_b128 v[72:75], v1 offset:10240
ds_read_b128 v[76:79], v1 offset:24576
v_mfma_f32_16x16x32_bf16 v[20:23], a[92:95], v[80:83], v[20:23]
v_mfma_f32_16x16x32_bf16 v[48:51], a[92:95], v[84:87], v[48:51]
v_mfma_f32_16x16x32_bf16 v[24:27], a[148:151], v[80:83], v[24:27]
v_mfma_f32_16x16x32_bf16 v[52:55], a[148:151], v[84:87], v[52:55]
v_mfma_f32_16x16x32_bf16 v[28:31], a[204:207], v[80:83], v[28:31]
v_mfma_f32_16x16x32_bf16 v[56:59], a[204:207], v[84:87], v[56:59]
v_mfma_f32_16x16x32_bf16 v[32:35], v[124:127], v[80:83], v[32:35]
v_mfma_f32_16x16x32_bf16 v[60:63], v[124:127], v[84:87], v[60:63]
v_mfma_f32_16x16x32_bf16 v[36:39], v[180:183], v[80:83], v[36:39]
v_mfma_f32_16x16x32_bf16 v[64:67], v[180:183], v[84:87], v[64:67]
v_mfma_f32_16x16x32_bf16 v[40:43], v[236:239], v[80:83], v[40:43]
v_mfma_f32_16x16x32_bf16 v[68:71], v[236:239], v[84:87], v[68:71]
s_waitcnt lgkmcnt(0)
v_mfma_f32_16x16x32_bf16 v[16:19], a[40:43], v[72:75], v[16:19]
v_mfma_f32_16x16x32_bf16 v[44:47], a[40:43], v[76:79], v[44:47]
ds_read_b128 v[80:83], v1 offset:11264
ds_read_b128 v[84:87], v1 offset:25600
v_mfma_f32_16x16x32_bf16 v[20:23], a[96:99], v[72:75], v[20:23]
v_mfma_f32_16x16x32_bf16 v[48:51], a[96:99], v[76:79], v[48:51]
v_mfma_f32_16x16x32_bf16 v[24:27], a[152:155], v[72:75], v[24:27]
v_mfma_f32_16x16x32_bf16 v[52:55], a[152:155], v[76:79], v[52:55]
v_mfma_f32_16x16x32_bf16 v[28:31], a[208:211], v[72:75], v[28:31]
v_mfma_f32_16x16x32_bf16 v[56:59], a[208:211], v[76:79], v[56:59]
v_mfma_f32_16x16x32_bf16 v[32:35], v[128:131], v[72:75], v[32:35]
v_mfma_f32_16x16x32_bf16 v[60:63], v[128:131], v[76:79], v[60:63]
v_mfma_f32_16x16x32_bf16 v[36:39], v[184:187], v[72:75], v[36:39]
v_mfma_f32_16x16x32_bf16 v[64:67], v[184:187], v[76:79], v[64:67]
v_mfma_f32_16x16x32_bf16 v[40:43], v[240:243], v[72:75], v[40:43]
v_mfma_f32_16x16x32_bf16 v[68:71], v[240:243], v[76:79], v[68:71]
s_waitcnt lgkmcnt(0)
v_mfma_f32_16x16x32_bf16 v[16:19], a[44:47], v[80:83], v[16:19]
v_mfma_f32_16x16x32_bf16 v[44:47], a[44:47], v[84:87], v[44:47]
ds_read_b128 v[72:75], v1 offset:12288
ds_read_b128 v[76:79], v1 offset:26624
v_mfma_f32_16x16x32_bf16 v[20:23], a[100:103], v[80:83], v[20:23]
v_mfma_f32_16x16x32_bf16 v[48:51], a[100:103], v[84:87], v[48:51]
v_mfma_f32_16x16x32_bf16 v[24:27], a[156:159], v[80:83], v[24:27]
v_mfma_f32_16x16x32_bf16 v[52:55], a[156:159], v[84:87], v[52:55]
v_mfma_f32_16x16x32_bf16 v[28:31], a[212:215], v[80:83], v[28:31]
v_mfma_f32_16x16x32_bf16 v[56:59], a[212:215], v[84:87], v[56:59]
v_mfma_f32_16x16x32_bf16 v[32:35], v[132:135], v[80:83], v[32:35]
v_mfma_f32_16x16x32_bf16 v[60:63], v[132:135], v[84:87], v[60:63]
v_mfma_f32_16x16x32_bf16 v[36:39], v[188:191], v[80:83], v[36:39]
v_mfma_f32_16x16x32_bf16 v[64:67], v[188:191], v[84:87], v[64:67]
v_mfma_f32_16x16x32_bf16 v[40:43], v[244:247], v[80:83], v[40:43]
v_mfma_f32_16x16x32_bf16 v[68:71], v[244:247], v[84:87], v[68:71]
s_waitcnt lgkmcnt(0)
v_mfma_f32_16x16x32_bf16 v[16:19], a[48:51], v[72:75], v[16:19]
v_mfma_f32_16x16x32_bf16 v[44:47], a[48:51], v[76:79], v[44:47]
ds_read_b128 v[80:83], v1 offset:13312
ds_read_b128 v[84:87], v1 offset:27648
v_mfma_f32_16x16x32_bf16 v[20:23], a[104:107], v[72:75], v[20:23]
v_mfma_f32_16x16x32_bf16 v[48:51], a[104:107], v[76:79], v[48:51]
v_mfma_f32_16x16x32_bf16 v[24:27], a[160:163], v[72:75], v[24:27]
v_mfma_f32_16x16x32_bf16 v[52:55], a[160:163], v[76:79], v[52:55]
v_mfma_f32_16x16x32_bf16 v[28:31], a[216:219], v[72:75], v[28:31]
v_mfma_f32_16x16x32_bf16 v[56:59], a[216:219], v[76:79], v[56:59]
v_mfma_f32_16x16x32_bf16 v[32:35], v[136:139], v[72:75], v[32:35]
v_mfma_f32_16x16x32_bf16 v[60:63], v[136:139], v[76:79], v[60:63]
v_mfma_f32_16x16x32_bf16 v[36:39], v[192:195], v[72:75], v[36:39]
v_mfma_f32_16x16x32_bf16 v[64:67], v[192:195], v[76:79], v[64:67]
v_mfma_f32_16x16x32_bf16 v[40:43], v[248:251], v[72:75], v[40:43]
v_mfma_f32_16x16x32_bf16 v[68:71], v[248:251], v[76:79], v[68:71]
s_waitcnt lgkmcnt(0)
v_mfma_f32_16x16x32_bf16 v[16:19], a[52:55], v[80:83], v[16:19]
v_mfma_f32_16x16x32_bf16 v[44:47], a[52:55], v[84:87], v[44:47]
v_mfma_f32_16x16x32_bf16 v[20:23], a[108:111], v[80:83], v[20:23]
v_mfma_f32_16x16x32_bf16 v[48:51], a[108:111], v[84:87], v[48:51]
v_mfma_f32_16x16x32_bf16 v[24:27], a[164:167], v[80:83], v[24:27]
v_mfma_f32_16x16x32_bf16 v[52:55], a[164:167], v[84:87], v[52:55]
v_mfma_f32_16x16x32_bf16 v[28:31], a[220:223], v[80:83], v[28:31]
v_mfma_f32_16x16x32_bf16 v[56:59], a[220:223], v[84:87], v[56:59]
v_mfma_f32_16x16x32_bf16 v[32:35], v[140:143], v[80:83], v[32:35]
v_mfma_f32_16x16x32_bf16 v[60:63], v[140:143], v[84:87], v[60:63]
v_mfma_f32_16x16x32_bf16 v[36:39], v[196:199], v[80:83], v[36:39]
v_mfma_f32_16x16x32_bf16 v[64:67], v[196:199], v[84:87], v[64:67]
v_mfma_f32_16x16x32_bf16 v[40:43], v[252:255], v[80:83], v[40:43]
v_mfma_f32_16x16x32_bf16 v[68:71], v[252:255], v[84:87], v[68:71]
s_nop 1
v_cvt_pk_bf16_f32 v88, v16, v17
v_cvt_pk_bf16_f32 v89, v18, v19
v_cvt_pk_bf16_f32 v104, v44, v45
v_cvt_pk_bf16_f32 v105, v46, v47
v_cvt_pk_bf16_f32 v90, v20, v21
v_cvt_pk_bf16_f32 v91, v22, v23
v_cvt_pk_bf16_f32 v106, v48, v49
v_cvt_pk_bf16_f32 v107, v50, v51
v_cvt_pk_bf16_f32 v92, v24, v25
v_cvt_pk_bf16_f32 v93, v26, v27
v_cvt_pk_bf16_f32 v108, v52, v53
v_cvt_pk_bf16_f32 v109, v54, v55
v_cvt_pk_bf16_f32 v94, v28, v29
v_cvt_pk_bf16_f32 v95, v30, v31
v_cvt_pk_bf16_f32 v110, v56, v57
v_cvt_pk_bf16_f32 v111, v58, v59
v_cvt_pk_bf16_f32 v96, v32, v33
v_cvt_pk_bf16_f32 v97, v34, v35
v_cvt_pk_bf16_f32 v112, v60, v61
v_cvt_pk_bf16_f32 v113, v62, v63
v_cvt_pk_bf16_f32 v98, v36, v37
v_cvt_pk_bf16_f32 v99, v38, v39
v_cvt_pk_bf16_f32 v114, v64, v65
v_cvt_pk_bf16_f32 v115, v66, v67
v_cvt_pk_bf16_f32 v100, v40, v41
v_cvt_pk_bf16_f32 v101, v42, v43
v_cvt_pk_bf16_f32 v116, v68, v69
v_cvt_pk_bf16_f32 v117, v70, v71
ds_read_b64 v[16:17], v2
ds_read_b64 v[18:19], v2 offset:512
ds_read_b64 v[20:21], v2 offset:14336
ds_read_b64 v[22:23], v2 offset:14848
ds_read_b64 v[24:25], v2 offset:1024
ds_read_b64 v[26:27], v2 offset:1536
ds_read_b64 v[28:29], v2 offset:15360
ds_read_b64 v[30:31], v2 offset:15872
s_waitcnt lgkmcnt(4)
v_mfma_f32_16x16x32_bf16 v[32:35], v[16:19], v[88:91], 0
v_mfma_f32_16x16x32_bf16 v[36:39], v[16:19], v[104:107], 0
v_mfma_f32_16x16x32_bf16 v[40:43], v[20:23], v[104:107], 0
ds_read_b64 v[16:17], v2 offset:2048
ds_read_b64 v[18:19], v2 offset:2560
ds_read_b64 v[20:21], v2 offset:16384
ds_read_b64 v[22:23], v2 offset:16896
s_waitcnt lgkmcnt(4)
v_mfma_f32_16x16x32_bf16 v[32:35], v[24:27], v[92:95], v[32:35]
v_mfma_f32_16x16x32_bf16 v[36:39], v[24:27], v[108:111], v[36:39]
v_mfma_f32_16x16x32_bf16 v[40:43], v[28:31], v[108:111], v[40:43]
ds_read_b64 v[24:25], v2 offset:3072
ds_read_b64 v[26:27], v2 offset:3584
ds_read_b64 v[28:29], v2 offset:17408
ds_read_b64 v[30:31], v2 offset:17920
s_waitcnt lgkmcnt(4)
v_mfma_f32_16x16x32_bf16 v[32:35], v[16:19], v[96:99], v[32:35]
v_mfma_f32_16x16x32_bf16 v[36:39], v[16:19], v[112:115], v[36:39]
v_mfma_f32_16x16x32_bf16 v[40:43], v[20:23], v[112:115], v[40:43]
s_waitcnt lgkmcnt(0)
v_mfma_f32_16x16x32_bf16 v[32:35], v[24:27], v[100:103], v[32:35]
v_mfma_f32_16x16x32_bf16 v[36:39], v[24:27], v[116:119], v[36:39]
v_mfma_f32_16x16x32_bf16 v[40:43], v[28:31], v[116:119], v[40:43]
v_mov_b32 v66, 0
v_mov_b32 v67, 0
s_nop 5
ds_write_b128 v4, v[32:35]
ds_write_b128 v4, v[36:39] offset:2304
ds_write_b128 v4, v[40:43] offset:2368
s_waitcnt lgkmcnt(0)
s_barrier
ds_read_b128 v[16:19], v5
ds_read_b128 v[20:23], v5 offset:4608
ds_read_b128 v[24:27], v5 offset:9216
ds_read_b128 v[28:31], v5 offset:13824
s_waitcnt lgkmcnt(0)
v_add_f32 v16, v16, v20
v_add_f32 v24, v24, v28
v_add_f32 v16, v16, v24
v_mov_b32 v68, s47
v_cndmask_b32 v68, v68, v16, s[32:33]
v_add_f32 v17, v17, v21
v_add_f32 v25, v25, v29
v_add_f32 v17, v17, v25
v_mov_b32 v69, s47
v_cndmask_b32 v69, v69, v17, s[34:35]
v_add_f32 v18, v18, v22
v_add_f32 v26, v26, v30
v_add_f32 v18, v18, v26
v_mov_b32 v70, s47
v_cndmask_b32 v70, v70, v18, s[36:37]
v_add_f32 v19, v19, v23
v_add_f32 v27, v27, v31
v_add_f32 v19, v19, v27
v_mov_b32 v71, s47
v_cndmask_b32 v71, v71, v19, s[38:39]
v_max3_f32 v32, v68, v69, v70
v_max_f32 v32, v32, v71
buffer_load_dwordx2 v[52:53], v3, s[4:7], s28 offen sc1
buffer_load_dwordx2 v[54:55], v3, s[4:7], s28 offen offset:256 sc1
buffer_load_dwordx2 v[56:57], v3, s[4:7], s28 offen offset:512 sc1
buffer_load_dwordx2 v[58:59], v3, s[4:7], s28 offen offset:768 sc1
buffer_load_dwordx2 v[60:61], v3, s[4:7], s28 offen offset:1024 sc1
buffer_load_dwordx2 v[62:63], v3, s[4:7], s28 offen offset:1280 sc1
buffer_load_dwordx2 v[64:65], v3, s[4:7], s28 offen offset:1536 sc1
s_sleep 6
Lspin_146:
buffer_load_dwordx2 v[52:53], v3, s[4:7], s28 offen sc1
buffer_load_dwordx2 v[54:55], v3, s[4:7], s28 offen offset:256 sc1
buffer_load_dwordx2 v[56:57], v3, s[4:7], s28 offen offset:512 sc1
buffer_load_dwordx2 v[58:59], v3, s[4:7], s28 offen offset:768 sc1
buffer_load_dwordx2 v[60:61], v3, s[4:7], s28 offen offset:1024 sc1
buffer_load_dwordx2 v[62:63], v3, s[4:7], s28 offen offset:1280 sc1
buffer_load_dwordx2 v[64:65], v3, s[4:7], s28 offen offset:1536 sc1
s_sub_u32 s24, s24, 1
s_cbranch_scc1 CODE_END
s_waitcnt vmcnt(7)
v_max3_u32 v10, v52, v53, v54
v_max3_u32 v10, v10, v55, v56
v_max3_u32 v10, v10, v57, v58
v_max3_u32 v10, v10, v59, v60
v_max3_u32 v10, v10, v61, v62
v_max3_u32 v10, v10, v63, v64
v_max_u32 v10, v10, v65
v_cmp_eq_u32 vcc, -1, v10
s_cbranch_vccz Lspin_146x
s_cmp_ge_u32 s25, 58
s_cbranch_scc1 Lspin_146
s_sleep 8
s_branch Lspin_146
Lspin_146x:
v_mfma_f32_16x16x32_bf16 v[44:47], v[52:55], v[88:91], 0
v_mfma_f32_16x16x32_bf16 v[48:51], v[52:55], v[104:107], 0
v_mfma_f32_16x16x32_bf16 v[44:47], v[56:59], v[92:95], v[44:47]
v_mfma_f32_16x16x32_bf16 v[48:51], v[56:59], v[108:111], v[48:51]
v_mfma_f32_16x16x32_bf16 v[44:47], v[60:63], v[96:99], v[44:47]
v_mfma_f32_16x16x32_bf16 v[48:51], v[60:63], v[112:115], v[48:51]
v_mfma_f32_16x16x32_bf16 v[44:47], v[64:67], v[100:103], v[44:47]
v_mfma_f32_16x16x32_bf16 v[48:51], v[64:67], v[116:119], v[48:51]
s_nop 6
ds_write_b128 v6, v[44:47]
ds_write_b128 v6, v[48:51] offset:2304
s_waitcnt lgkmcnt(0)
s_barrier
ds_read2_b32 v[20:21], v7 offset0:0 offset1:8
ds_read2_b32 v[22:23], v7 offset0:16 offset1:24
s_waitcnt lgkmcnt(0)
v_pk_add_f32 v[20:21], v[20:21], v[22:23]
v_add_f32 v17, v20, v21
v_max_f32 v16, v32, v17
s_nop 1
v_max_f32_dpp v16, v16, v16 quad_perm:[1,0,3,2] row_mask:0xf bank_mask:0xf
s_nop 1
v_max_f32_dpp v16, v16, v16 quad_perm:[2,3,0,1] row_mask:0xf bank_mask:0xf
s_nop 1
v_max_f32_dpp v16, v16, v16 row_half_mirror row_mask:0xf bank_mask:0xf
v_sub_f32 v17, v17, v16
v_sub_f32 v68, v68, v16
v_sub_f32 v69, v69, v16
v_sub_f32 v70, v70, v16
v_sub_f32 v71, v71, v16
v_exp_f32 v17, v17
v_exp_f32 v68, v68
v_exp_f32 v69, v69
v_exp_f32 v70, v70
v_exp_f32 v71, v71
v_add_f32 v16, v17, v68
v_add_f32 v18, v69, v70
v_add_f32 v16, v16, v71
v_add_f32 v16, v16, v18
v_mov_b32_dpp v18, v17 quad_perm:[1,0,3,2] row_mask:0xf bank_mask:0xf
s_nop 1
v_add_f32_dpp v16, v16, v16 quad_perm:[1,0,3,2] row_mask:0xf bank_mask:0xf
s_nop 1
v_add_f32_dpp v16, v16, v16 quad_perm:[2,3,0,1] row_mask:0xf bank_mask:0xf
s_nop 1
v_add_f32_dpp v16, v16, v16 row_half_mirror row_mask:0xf bank_mask:0xf
v_rcp_f32 v16, v16
s_cmp_lg_u32 s23, 0
v_mul_f32 v68, v68, v16 clamp
v_mul_f32 v69, v69, v16 clamp
v_mul_f32 v70, v70, v16 clamp
v_mul_f32 v71, v71, v16 clamp
v_mul_f32 v17, v17, v16 clamp
v_mul_f32 v18, v18, v16 clamp
v_cvt_pk_bf16_f32 v68, v68, v69
v_cvt_pk_bf16_f32 v70, v70, v71
v_cvt_pk_bf16_f32 v17, v17, v18
s_cbranch_scc1 Lwt_147
buffer_store_dword v68, v8, s[4:7], s29 offen
buffer_store_dword v70, v8, s[4:7], s29 offen offset:8
buffer_store_dword v17, v9, s[4:7], s30 offen
s_branch Lst_148
Lwt_147:
buffer_store_dword v68, v8, s[4:7], s29 offen sc1
buffer_store_dword v70, v8, s[4:7], s29 offen offset:8 sc1
buffer_store_dword v17, v9, s[4:7], s30 offen sc1
Lst_148:
s_add_u32 s26, s26, 114688
s_add_u32 s27, s27, 114688
s_add_u32 s28, s28, 28672
s_add_u32 s29, s29, 163840
s_add_u32 s30, s30, 163840
s_add_u32 s25, s25, 4
s_cmp_lt_u32 s25, 64
s_cbranch_scc1 TA_SEG0
s_endpgm
TA_W1:
v_lshlrev_b32 v1, 4, v0
s_cmp_lt_u32 s21, 2
s_cselect_b32 s42, 0, 4
s_add_u32 s42, s42, s21
s_lshl_b32 s40, s42, 7
s_add_u32 s40, s40, 139264
s_branch Lfirst_150
Lflag_149:
v_cmp_ne_u32 vcc, s88, v10
s_cbranch_vccz Lset_151
s_sleep 16
Lfirst_150:
buffer_load_dword v10, off, s[4:7], s40 sc1
s_waitcnt vmcnt(0)
s_sub_u32 s24, s24, 1
s_cbranch_scc0 Lflag_149
s_endpgm
Lset_151:
v_min_u32 v12, 55, v0
v_and_b32 v10, 3, v12
v_lshlrev_b32 v10, 3, v10
v_lshrrev_b32 v12, 2, v12
v_lshl_add_u32 v10, v12, 7, v10
s_mov_b32 s43, 4352
Llz_152:
buffer_load_dwordx2 v[12:13], v10, s[4:7], s43 offen sc1
s_waitcnt vmcnt(0)
v_cmp_ne_u32 vcc, s88, v12
v_cmp_ne_u32 s[40:41], s88, v13
s_or_b64 vcc, vcc, s[40:41]
s_cbranch_vccz Llzok_153
s_sleep 8
s_sub_u32 s24, s24, 1
s_cbranch_scc0 Llz_152
s_endpgm
Llzok_153:
s_mul_i32 s40, s21, 7168
s_add_u32 s40, s40, 656384
Lstp_154:
buffer_load_dword v10, off, s[4:7], s40 sc1
s_waitcnt vmcnt(0)
v_cmp_eq_u32 vcc, -1, v10
s_cbranch_vccz Lstpok_155
s_sleep 16
s_sub_u32 s24, s24, 1
s_cbranch_scc0 Lstp_154
s_endpgm
Lstpok_155:
v_min_u32 v10, 6, v0
v_lshlrev_b32 v10, 2, v10
s_lshl_b32 s40, s22, 7
s_branch Lfirst_157
Lflag_156:
v_cmp_ne_u32 vcc, s88, v11
s_cbranch_vccz Lset_158
s_sleep 4
Lfirst_157:
buffer_load_dword v11, v10, s[4:7], s40 offen sc1
s_waitcnt vmcnt(0)
s_sub_u32 s24, s24, 1
s_cbranch_scc0 Lflag_156
s_endpgm
Lset_158:
s_mul_i32 s40, s22, 401408
s_add_u32 s40, s40, 9979904
buffer_load_dwordx4 a[0:3], v1, s[4:7], s40 offen
buffer_load_dwordx4 a[4:7], v1, s[4:7], s40 offen offset:1024
buffer_load_dwordx4 a[8:11], v1, s[4:7], s40 offen offset:2048
buffer_load_dwordx4 a[12:15], v1, s[4:7], s40 offen offset:3072
s_add_u32 s40, s40, 4096
buffer_load_dwordx4 a[16:19], v1, s[4:7], s40 offen
buffer_load_dwordx4 a[20:23], v1, s[4:7], s40 offen offset:1024
buffer_load_dwordx4 a[24:27], v1, s[4:7], s40 offen offset:2048
buffer_load_dwordx4 a[28:31], v1, s[4:7], s40 offen offset:3072
s_add_u32 s40, s40, 4096
buffer_load_dwordx4 a[32:35], v1, s[4:7], s40 offen
buffer_load_dwordx4 a[36:39], v1, s[4:7], s40 offen offset:1024
buffer_load_dwordx4 a[40:43], v1, s[4:7], s40 offen offset:2048
buffer_load_dwordx4 a[44:47], v1, s[4:7], s40 offen offset:3072
s_add_u32 s40, s40, 4096
buffer_load_dwordx4 a[48:51], v1, s[4:7], s40 offen
buffer_load_dwordx4 a[52:55], v1, s[4:7], s40 offen offset:1024
buffer_load_dwordx4 a[56:59], v1, s[4:7], s40 offen offset:2048
buffer_load_dwordx4 a[60:63], v1, s[4:7], s40 offen offset:3072
s_add_u32 s40, s40, 4096
buffer_load_dwordx4 a[64:67], v1, s[4:7], s40 offen
buffer_load_dwordx4 a[68:71], v1, s[4:7], s40 offen offset:1024
buffer_load_dwordx4 a[72:75], v1, s[4:7], s40 offen offset:2048
buffer_load_dwordx4 a[76:79], v1, s[4:7], s40 offen offset:3072
s_add_u32 s40, s40, 4096
buffer_load_dwordx4 a[80:83], v1, s[4:7], s40 offen
buffer_load_dwordx4 a[84:87], v1, s[4:7], s40 offen offset:1024
buffer_load_dwordx4 a[88:91], v1, s[4:7], s40 offen offset:2048
buffer_load_dwordx4 a[92:95], v1, s[4:7], s40 offen offset:3072
s_add_u32 s40, s40, 4096
buffer_load_dwordx4 a[96:99], v1, s[4:7], s40 offen
buffer_load_dwordx4 a[100:103], v1, s[4:7], s40 offen offset:1024
buffer_load_dwordx4 a[104:107], v1, s[4:7], s40 offen offset:2048
buffer_load_dwordx4 a[108:111], v1, s[4:7], s40 offen offset:3072
s_add_u32 s40, s40, 4096
buffer_load_dwordx4 a[112:115], v1, s[4:7], s40 offen
buffer_load_dwordx4 a[116:119], v1, s[4:7], s40 offen offset:1024
buffer_load_dwordx4 a[120:123], v1, s[4:7], s40 offen offset:2048
buffer_load_dwordx4 a[124:127], v1, s[4:7], s40 offen offset:3072
s_add_u32 s40, s40, 4096
buffer_load_dwordx4 a[128:131], v1, s[4:7], s40 offen
buffer_load_dwordx4 a[132:135], v1, s[4:7], s40 offen offset:1024
buffer_load_dwordx4 a[136:139], v1, s[4:7], s40 offen offset:2048
buffer_load_dwordx4 a[140:143], v1, s[4:7], s40 offen offset:3072
s_add_u32 s40, s40, 4096
buffer_load_dwordx4 a[144:147], v1, s[4:7], s40 offen
buffer_load_dwordx4 a[148:151], v1, s[4:7], s40 offen offset:1024
buffer_load_dwordx4 a[152:155], v1, s[4:7], s40 offen offset:2048
buffer_load_dwordx4 a[156:159], v1, s[4:7], s40 offen offset:3072
s_add_u32 s40, s40, 4096
buffer_load_dwordx4 a[160:163], v1, s[4:7], s40 offen
buffer_load_dwordx4 a[164:167], v1, s[4:7], s40 offen offset:1024
buffer_load_dwordx4 a[168:171], v1, s[4:7], s40 offen offset:2048
buffer_load_dwordx4 a[172:175], v1, s[4:7], s40 offen offset:3072
s_add_u32 s40, s40, 4096
buffer_load_dwordx4 a[176:179], v1, s[4:7], s40 offen
buffer_load_dwordx4 a[180:183], v1, s[4:7], s40 offen offset:1024
buffer_load_dwordx4 a[184:187], v1, s[4:7], s40 offen offset:2048
buffer_load_dwordx4 a[188:191], v1, s[4:7], s40 offen offset:3072
s_add_u32 s40, s40, 4096
s_waitcnt vmcnt(40)
buffer_load_dwordx4 a[192:195], v1, s[4:7], s40 offen
buffer_load_dwordx4 a[196:199], v1, s[4:7], s40 offen offset:1024
buffer_load_dwordx4 a[200:203], v1, s[4:7], s40 offen offset:2048
buffer_load_dwordx4 a[204:207], v1, s[4:7], s40 offen offset:3072
s_add_u32 s40, s40, 4096
buffer_load_dwordx4 a[208:211], v1, s[4:7], s40 offen
buffer_load_dwordx4 a[212:215], v1, s[4:7], s40 offen offset:1024
buffer_load_dwordx4 a[216:219], v1, s[4:7], s40 offen offset:2048
buffer_load_dwordx4 a[220:223], v1, s[4:7], s40 offen offset:3072
s_add_u32 s40, s40, 4096
s_waitcnt vmcnt(40)
buffer_load_dwordx4 a[224:227], v1, s[4:7], s40 offen
buffer_load_dwordx4 a[228:231], v1, s[4:7], s40 offen offset:1024
buffer_load_dwordx4 a[232:235], v1, s[4:7], s40 offen offset:2048
buffer_load_dwordx4 a[236:239], v1, s[4:7], s40 offen offset:3072
s_add_u32 s40, s40, 4096
buffer_load_dwordx4 a[240:243], v1, s[4:7], s40 offen
buffer_load_dwordx4 a[244:247], v1, s[4:7], s40 offen offset:1024
buffer_load_dwordx4 a[248:251], v1, s[4:7], s40 offen offset:2048
buffer_load_dwordx4 a[252:255], v1, s[4:7], s40 offen offset:3072
s_add_u32 s40, s40, 4096
s_waitcnt vmcnt(40)
buffer_load_dwordx4 v[120:123], v1, s[4:7], s40 offen
buffer_load_dwordx4 v[124:127], v1, s[4:7], s40 offen offset:1024
buffer_load_dwordx4 v[128:131], v1, s[4:7], s40 offen offset:2048
buffer_load_dwordx4 v[132:135], v1, s[4:7], s40 offen offset:3072
s_add_u32 s40, s40, 4096
buffer_load_dwordx4 v[136:139], v1, s[4:7], s40 offen
buffer_load_dwordx4 v[140:143], v1, s[4:7], s40 offen offset:1024
buffer_load_dwordx4 v[144:147], v1, s[4:7], s40 offen offset:2048
buffer_load_dwordx4 v[148:151], v1, s[4:7], s40 offen offset:3072
s_add_u32 s40, s40, 4096
s_waitcnt vmcnt(40)
buffer_load_dwordx4 v[152:155], v1, s[4:7], s40 offen
buffer_load_dwordx4 v[156:159], v1, s[4:7], s40 offen offset:1024
buffer_load_dwordx4 v[160:163], v1, s[4:7], s40 offen offset:2048
buffer_load_dwordx4 v[164:167], v1, s[4:7], s40 offen offset:3072
s_add_u32 s40, s40, 4096
buffer_load_dwordx4 v[168:171], v1, s[4:7], s40 offen
buffer_load_dwordx4 v[172:175], v1, s[4:7], s40 offen offset:1024
buffer_load_dwordx4 v[176:179], v1, s[4:7], s40 offen offset:2048
buffer_load_dwordx4 v[180:183], v1, s[4:7], s40 offen offset:3072
s_add_u32 s40, s40, 4096
s_waitcnt vmcnt(40)
buffer_load_dwordx4 v[184:187], v1, s[4:7], s40 offen
buffer_load_dwordx4 v[188:191], v1, s[4:7], s40 offen offset:1024
buffer_load_dwordx4 v[192:195], v1, s[4:7], s40 offen offset:2048
buffer_load_dwordx4 v[196:199], v1, s[4:7], s40 offen offset:3072
s_add_u32 s40, s40, 4096
buffer_load_dwordx4 v[200:203], v1, s[4:7], s40 offen
buffer_load_dwordx4 v[204:207], v1, s[4:7], s40 offen offset:1024
buffer_load_dwordx4 v[208:211], v1, s[4:7], s40 offen offset:2048
buffer_load_dwordx4 v[212:215], v1, s[4:7], s40 offen offset:3072
s_add_u32 s40, s40, 4096
s_waitcnt vmcnt(40)
buffer_load_dwordx4 v[216:219], v1, s[4:7], s40 offen
buffer_load_dwordx4 v[220:223], v1, s[4:7], s40 offen offset:1024
buffer_load_dwordx4 v[224:227], v1, s[4:7], s40 offen offset:2048
buffer_load_dwordx4 v[228:231], v1, s[4:7], s40 offen offset:3072
s_add_u32 s40, s40, 4096
buffer_load_dwordx4 v[232:235], v1, s[4:7], s40 offen
buffer_load_dwordx4 v[236:239], v1, s[4:7], s40 offen offset:1024
buffer_load_dwordx4 v[240:243], v1, s[4:7], s40 offen offset:2048
buffer_load_dwordx4 v[244:247], v1, s[4:7], s40 offen offset:3072
s_add_u32 s40, s40, 4096
s_waitcnt vmcnt(40)
buffer_load_dwordx4 v[248:251], v1, s[4:7], s40 offen
buffer_load_dwordx4 v[252:255], v1, s[4:7], s40 offen offset:1024
v_and_b32 v10, 15, v0
v_lshrrev_b32 v11, 4, v0
v_lshrrev_b32 v3, 5, v0
v_add_u32 v3, 14, v3
v_lshrrev_b32 v2, 2, v3
v_lshlrev_b32 v2, 10, v2
v_and_b32 v4, 3, v3
v_lshl_add_u32 v2, v4, 8, v2
v_lshl_add_u32 v2, v10, 4, v2
v_and_b32 v4, 1, v11
v_lshl_add_u32 v2, v4, 3, v2
v_add_u32 v2, 28672, v2
v_lshlrev_b32 v3, 7, v3
v_lshl_add_u32 v3, v4, 3, v3
v_and_b32 v5, 7, v0
v_lshl_add_u32 v3, v5, 4, v3
v_mul_u32_u24 v6, 144, v10
v_lshl_add_u32 v7, v11, 4, v6
v_lshl_add_u32 v6, v4, 4, v6
v_add_u32 v4, 62976, v7
v_add_u32 v6, 76832, v6
v_lshrrev_b32 v10, 3, v0
v_add_u32 v10, 8, v10
v_and_b32 v11, 7, v0
v_mul_u32_u24 v7, 144, v10
v_lshl_add_u32 v5, v11, 4, v7
v_add_u32 v5, 58368, v5
v_lshl_add_u32 v7, v11, 2, v7
v_add_u32 v7, 76800, v7
v_lshlrev_b32 v8, 2, v11
v_sub_u32 v8, v10, v8
v_cmp_le_i32 s[32:33], 0, v8
v_cmp_le_i32 s[34:35], 1, v8
v_cmp_le_i32 s[36:37], 2, v8
v_cmp_le_i32 s[38:39], 3, v8
v_and_b32 v10, 15, v10
v_lshlrev_b32 v10, 4, v10
v_bfe_u32 v9, v0, 1, 1
v_lshl_add_u32 v10, v9, 2, v10
v_bfe_u32 v11, v0, 2, 1
v_lshl_add_u32 v9, v11, 8, v10
v_lshl_add_u32 v8, v11, 9, v10
v_and_b32 v11, 1, v0
v_lshl_add_u32 v8, v11, 8, v8
v_lshlrev_b32 v11, 30, v11
v_or_b32 v9, v9, v11
v_mov_b32 v10, 0
v_lshlrev_b32 v11, 2, v0
ds_write_b32 v11, v10 offset:57600
v_mov_b32 v102, 0
v_mov_b32 v103, 0
v_mov_b32 v118, 0
v_mov_b32 v119, 0
s_mul_i32 s26, s21, 28672
s_add_u32 s27, s26, 6205440
s_add_u32 s26, s26, 8044544
s_mul_i32 s28, s21, 7168
s_add_u32 s28, s28, 634880
s_mul_i32 s29, s21, 40960
s_add_u32 s29, s29, 1748992
s_lshr_b32 s30, s22, 1
s_lshl_b32 s30, s30, 10
s_and_b32 s40, s22, 1
s_lshl_b32 s40, s40, 3
s_add_u32 s30, s30, s40
s_add_u32 s30, s30, s29
s_add_u32 s30, s30, 32768
s_lshl_b32 s40, s22, 11
s_add_u32 s29, s29, s40
s_add_u32 s29, s29, 0
s_mov_b32 s47, 0xceabfb8f
s_mov_b32 s25, s21
v_min_u32 v12, 55, v0
v_and_b32 v10, 3, v12
v_lshlrev_b32 v10, 3, v10
v_lshrrev_b32 v12, 2, v12
v_lshl_add_u32 v10, v12, 7, v10
s_mov_b32 s43, 4352
Llz_159:
buffer_load_dwordx2 v[12:13], v10, s[4:7], s43 offen sc1
s_waitcnt vmcnt(0)
v_cmp_ne_u32 vcc, s88, v12
v_cmp_ne_u32 s[40:41], s88, v13
s_or_b64 vcc, vcc, s[40:41]
s_cbranch_vccz Llzok_160
s_sleep 8
s_sub_u32 s24, s24, 1
s_cbranch_scc0 Llz_159
s_endpgm
Llzok_160:
v_min_u32 v12, 47, v0
v_and_b32 v10, 3, v12
v_lshlrev_b32 v10, 3, v10
v_lshrrev_b32 v12, 2, v12
v_lshl_add_u32 v10, v12, 7, v10
s_mov_b32 s43, 6144
Llz_161:
buffer_load_dwordx2 v[12:13], v10, s[4:7], s43 offen sc1
s_waitcnt vmcnt(0)
v_cmp_ne_u32 vcc, s88, v12
v_cmp_ne_u32 s[40:41], s88, v13
s_or_b64 vcc, vcc, s[40:41]
s_cbranch_vccz Llzok_162
s_sleep 8
s_sub_u32 s24, s24, 1
s_cbranch_scc0 Llz_161
s_endpgm
Llzok_162:
TA_SEG1:
s_mov_b32 m0, 7168
s_add_u32 s40, s26, 7168
buffer_load_dwordx4 v1, s[4:7], s40 offen lds
s_mov_b32 m0, 8192
s_add_u32 s40, s26, 8192
buffer_load_dwordx4 v1, s[4:7], s40 offen lds
s_mov_b32 m0, 9216
s_add_u32 s40, s26, 9216
buffer_load_dwordx4 v1, s[4:7], s40 offen lds
s_mov_b32 m0, 10240
s_add_u32 s40, s26, 10240
buffer_load_dwordx4 v1, s[4:7], s40 offen lds
s_mov_b32 m0, 11264
s_add_u32 s40, s26, 11264
buffer_load_dwordx4 v1, s[4:7], s40 offen lds
s_mov_b32 m0, 12288
s_add_u32 s40, s26, 12288
buffer_load_dwordx4 v1, s[4:7], s40 offen lds
s_mov_b32 m0, 13312
s_add_u32 s40, s26, 13312
buffer_load_dwordx4 v1, s[4:7], s40 offen lds
s_mov_b32 m0, 35840
s_add_u32 s40, s27, 7168
buffer_load_dwordx4 v1, s[4:7], s40 offen lds
s_mov_b32 m0, 36864
s_add_u32 s40, s27, 8192
buffer_load_dwordx4 v1, s[4:7], s40 offen lds
s_mov_b32 m0, 37888
s_add_u32 s40, s27, 9216
buffer_load_dwordx4 v1, s[4:7], s40 offen lds
s_mov_b32 m0, 38912
s_add_u32 s40, s27, 10240
buffer_load_dwordx4 v1, s[4:7], s40 offen lds
s_mov_b32 m0, 39936
s_add_u32 s40, s27, 11264
buffer_load_dwordx4 v1, s[4:7], s40 offen lds
s_mov_b32 m0, 40960
s_add_u32 s40, s27, 12288
buffer_load_dwordx4 v1, s[4:7], s40 offen lds
s_mov_b32 m0, 41984
s_add_u32 s40, s27, 13312
buffer_load_dwordx4 v1, s[4:7], s40 offen lds
s_waitcnt vmcnt(0) lgkmcnt(0)
s_barrier
ds_read_b128 v[72:75], v1
ds_read_b128 v[76:79], v1 offset:14336
s_waitcnt lgkmcnt(0)
v_mfma_f32_16x16x32_bf16 v[16:19], a[0:3], v[72:75], 0
v_mfma_f32_16x16x32_bf16 v[44:47], a[0:3], v[76:79], 0
ds_read_b128 v[80:83], v1 offset:1024
ds_read_b128 v[84:87], v1 offset:15360
v_mfma_f32_16x16x32_bf16 v[20:23], a[56:59], v[72:75], 0
v_mfma_f32_16x16x32_bf16 v[48:51], a[56:59], v[76:79], 0
v_mfma_f32_16x16x32_bf16 v[24:27], a[112:115], v[72:75], 0
v_mfma_f32_16x16x32_bf16 v[52:55], a[112:115], v[76:79], 0
v_mfma_f32_16x16x32_bf16 v[28:31], a[168:171], v[72:75], 0
v_mfma_f32_16x16x32_bf16 v[56:59], a[168:171], v[76:79], 0
v_mfma_f32_16x16x32_bf16 v[32:35], a[224:227], v[72:75], 0
v_mfma_f32_16x16x32_bf16 v[60:63], a[224:227], v[76:79], 0
v_mfma_f32_16x16x32_bf16 v[36:39], v[144:147], v[72:75], 0
v_mfma_f32_16x16x32_bf16 v[64:67], v[144:147], v[76:79], 0
v_mfma_f32_16x16x32_bf16 v[40:43], v[200:203], v[72:75], 0
v_mfma_f32_16x16x32_bf16 v[68:71], v[200:203], v[76:79], 0
s_waitcnt lgkmcnt(0)
v_mfma_f32_16x16x32_bf16 v[16:19], a[4:7], v[80:83], v[16:19]
v_mfma_f32_16x16x32_bf16 v[44:47], a[4:7], v[84:87], v[44:47]
ds_read_b128 v[72:75], v1 offset:2048
ds_read_b128 v[76:79], v1 offset:16384
v_mfma_f32_16x16x32_bf16 v[20:23], a[60:63], v[80:83], v[20:23]
v_mfma_f32_16x16x32_bf16 v[48:51], a[60:63], v[84:87], v[48:51]
v_mfma_f32_16x16x32_bf16 v[24:27], a[116:119], v[80:83], v[24:27]
v_mfma_f32_16x16x32_bf16 v[52:55], a[116:119], v[84:87], v[52:55]
v_mfma_f32_16x16x32_bf16 v[28:31], a[172:175], v[80:83], v[28:31]
v_mfma_f32_16x16x32_bf16 v[56:59], a[172:175], v[84:87], v[56:59]
v_mfma_f32_16x16x32_bf16 v[32:35], a[228:231], v[80:83], v[32:35]
v_mfma_f32_16x16x32_bf16 v[60:63], a[228:231], v[84:87], v[60:63]
v_mfma_f32_16x16x32_bf16 v[36:39], v[148:151], v[80:83], v[36:39]
v_mfma_f32_16x16x32_bf16 v[64:67], v[148:151], v[84:87], v[64:67]
v_mfma_f32_16x16x32_bf16 v[40:43], v[204:207], v[80:83], v[40:43]
v_mfma_f32_16x16x32_bf16 v[68:71], v[204:207], v[84:87], v[68:71]
s_waitcnt lgkmcnt(0)
v_mfma_f32_16x16x32_bf16 v[16:19], a[8:11], v[72:75], v[16:19]
v_mfma_f32_16x16x32_bf16 v[44:47], a[8:11], v[76:79], v[44:47]
ds_read_b128 v[80:83], v1 offset:3072
ds_read_b128 v[84:87], v1 offset:17408
v_mfma_f32_16x16x32_bf16 v[20:23], a[64:67], v[72:75], v[20:23]
v_mfma_f32_16x16x32_bf16 v[48:51], a[64:67], v[76:79], v[48:51]
v_mfma_f32_16x16x32_bf16 v[24:27], a[120:123], v[72:75], v[24:27]
v_mfma_f32_16x16x32_bf16 v[52:55], a[120:123], v[76:79], v[52:55]
v_mfma_f32_16x16x32_bf16 v[28:31], a[176:179], v[72:75], v[28:31]
v_mfma_f32_16x16x32_bf16 v[56:59], a[176:179], v[76:79], v[56:59]
v_mfma_f32_16x16x32_bf16 v[32:35], a[232:235], v[72:75], v[32:35]
v_mfma_f32_16x16x32_bf16 v[60:63], a[232:235], v[76:79], v[60:63]
v_mfma_f32_16x16x32_bf16 v[36:39], v[152:155], v[72:75], v[36:39]
v_mfma_f32_16x16x32_bf16 v[64:67], v[152:155], v[76:79], v[64:67]
v_mfma_f32_16x16x32_bf16 v[40:43], v[208:211], v[72:75], v[40:43]
v_mfma_f32_16x16x32_bf16 v[68:71], v[208:211], v[76:79], v[68:71]
s_waitcnt lgkmcnt(0)
v_mfma_f32_16x16x32_bf16 v[16:19], a[12:15], v[80:83], v[16:19]
v_mfma_f32_16x16x32_bf16 v[44:47], a[12:15], v[84:87], v[44:47]
ds_read_b128 v[72:75], v1 offset:4096
ds_read_b128 v[76:79], v1 offset:18432
v_mfma_f32_16x16x32_bf16 v[20:23], a[68:71], v[80:83], v[20:23]
v_mfma_f32_16x16x32_bf16 v[48:51], a[68:71], v[84:87], v[48:51]
v_mfma_f32_16x16x32_bf16 v[24:27], a[124:127], v[80:83], v[24:27]
v_mfma_f32_16x16x32_bf16 v[52:55], a[124:127], v[84:87], v[52:55]
v_mfma_f32_16x16x32_bf16 v[28:31], a[180:183], v[80:83], v[28:31]
v_mfma_f32_16x16x32_bf16 v[56:59], a[180:183], v[84:87], v[56:59]
v_mfma_f32_16x16x32_bf16 v[32:35], a[236:239], v[80:83], v[32:35]
v_mfma_f32_16x16x32_bf16 v[60:63], a[236:239], v[84:87], v[60:63]
v_mfma_f32_16x16x32_bf16 v[36:39], v[156:159], v[80:83], v[36:39]
v_mfma_f32_16x16x32_bf16 v[64:67], v[156:159], v[84:87], v[64:67]
v_mfma_f32_16x16x32_bf16 v[40:43], v[212:215], v[80:83], v[40:43]
v_mfma_f32_16x16x32_bf16 v[68:71], v[212:215], v[84:87], v[68:71]
s_waitcnt lgkmcnt(0)
v_mfma_f32_16x16x32_bf16 v[16:19], a[16:19], v[72:75], v[16:19]
v_mfma_f32_16x16x32_bf16 v[44:47], a[16:19], v[76:79], v[44:47]
ds_read_b128 v[80:83], v1 offset:5120
ds_read_b128 v[84:87], v1 offset:19456
v_mfma_f32_16x16x32_bf16 v[20:23], a[72:75], v[72:75], v[20:23]
v_mfma_f32_16x16x32_bf16 v[48:51], a[72:75], v[76:79], v[48:51]
v_mfma_f32_16x16x32_bf16 v[24:27], a[128:131], v[72:75], v[24:27]
v_mfma_f32_16x16x32_bf16 v[52:55], a[128:131], v[76:79], v[52:55]
v_mfma_f32_16x16x32_bf16 v[28:31], a[184:187], v[72:75], v[28:31]
v_mfma_f32_16x16x32_bf16 v[56:59], a[184:187], v[76:79], v[56:59]
v_mfma_f32_16x16x32_bf16 v[32:35], a[240:243], v[72:75], v[32:35]
v_mfma_f32_16x16x32_bf16 v[60:63], a[240:243], v[76:79], v[60:63]
v_mfma_f32_16x16x32_bf16 v[36:39], v[160:163], v[72:75], v[36:39]
v_mfma_f32_16x16x32_bf16 v[64:67], v[160:163], v[76:79], v[64:67]
v_mfma_f32_16x16x32_bf16 v[40:43], v[216:219], v[72:75], v[40:43]
v_mfma_f32_16x16x32_bf16 v[68:71], v[216:219], v[76:79], v[68:71]
s_waitcnt lgkmcnt(0)
v_mfma_f32_16x16x32_bf16 v[16:19], a[20:23], v[80:83], v[16:19]
v_mfma_f32_16x16x32_bf16 v[44:47], a[20:23], v[84:87], v[44:47]
ds_read_b128 v[72:75], v1 offset:6144
ds_read_b128 v[76:79], v1 offset:20480
v_mfma_f32_16x16x32_bf16 v[20:23], a[76:79], v[80:83], v[20:23]
v_mfma_f32_16x16x32_bf16 v[48:51], a[76:79], v[84:87], v[48:51]
v_mfma_f32_16x16x32_bf16 v[24:27], a[132:135], v[80:83], v[24:27]
v_mfma_f32_16x16x32_bf16 v[52:55], a[132:135], v[84:87], v[52:55]
v_mfma_f32_16x16x32_bf16 v[28:31], a[188:191], v[80:83], v[28:31]
v_mfma_f32_16x16x32_bf16 v[56:59], a[188:191], v[84:87], v[56:59]
v_mfma_f32_16x16x32_bf16 v[32:35], a[244:247], v[80:83], v[32:35]
v_mfma_f32_16x16x32_bf16 v[60:63], a[244:247], v[84:87], v[60:63]
v_mfma_f32_16x16x32_bf16 v[36:39], v[164:167], v[80:83], v[36:39]
v_mfma_f32_16x16x32_bf16 v[64:67], v[164:167], v[84:87], v[64:67]
v_mfma_f32_16x16x32_bf16 v[40:43], v[220:223], v[80:83], v[40:43]
v_mfma_f32_16x16x32_bf16 v[68:71], v[220:223], v[84:87], v[68:71]
s_waitcnt lgkmcnt(0)
v_mfma_f32_16x16x32_bf16 v[16:19], a[24:27], v[72:75], v[16:19]
v_mfma_f32_16x16x32_bf16 v[44:47], a[24:27], v[76:79], v[44:47]
ds_read_b128 v[80:83], v1 offset:7168
ds_read_b128 v[84:87], v1 offset:21504
v_mfma_f32_16x16x32_bf16 v[20:23], a[80:83], v[72:75], v[20:23]
v_mfma_f32_16x16x32_bf16 v[48:51], a[80:83], v[76:79], v[48:51]
v_mfma_f32_16x16x32_bf16 v[24:27], a[136:139], v[72:75], v[24:27]
v_mfma_f32_16x16x32_bf16 v[52:55], a[136:139], v[76:79], v[52:55]
v_mfma_f32_16x16x32_bf16 v[28:31], a[192:195], v[72:75], v[28:31]
v_mfma_f32_16x16x32_bf16 v[56:59], a[192:195], v[76:79], v[56:59]
v_mfma_f32_16x16x32_bf16 v[32:35], a[248:251], v[72:75], v[32:35]
v_mfma_f32_16x16x32_bf16 v[60:63], a[248:251], v[76:79], v[60:63]
v_mfma_f32_16x16x32_bf16 v[36:39], v[168:171], v[72:75], v[36:39]
v_mfma_f32_16x16x32_bf16 v[64:67], v[168:171], v[76:79], v[64:67]
v_mfma_f32_16x16x32_bf16 v[40:43], v[224:227], v[72:75], v[40:43]
v_mfma_f32_16x16x32_bf16 v[68:71], v[224:227], v[76:79], v[68:71]
s_waitcnt lgkmcnt(0)
v_mfma_f32_16x16x32_bf16 v[16:19], a[28:31], v[80:83], v[16:19]
v_mfma_f32_16x16x32_bf16 v[44:47], a[28:31], v[84:87], v[44:47]
ds_read_b128 v[72:75], v1 offset:8192
ds_read_b128 v[76:79], v1 offset:22528
v_mfma_f32_16x16x32_bf16 v[20:23], a[84:87], v[80:83], v[20:23]
v_mfma_f32_16x16x32_bf16 v[48:51], a[84:87], v[84:87], v[48:51]
v_mfma_f32_16x16x32_bf16 v[24:27], a[140:143], v[80:83], v[24:27]
v_mfma_f32_16x16x32_bf16 v[52:55], a[140:143], v[84:87], v[52:55]
v_mfma_f32_16x16x32_bf16 v[28:31], a[196:199], v[80:83], v[28:31]
v_mfma_f32_16x16x32_bf16 v[56:59], a[196:199], v[84:87], v[56:59]
v_mfma_f32_16x16x32_bf16 v[32:35], a[252:255], v[80:83], v[32:35]
v_mfma_f32_16x16x32_bf16 v[60:63], a[252:255], v[84:87], v[60:63]
v_mfma_f32_16x16x32_bf16 v[36:39], v[172:175], v[80:83], v[36:39]
v_mfma_f32_16x16x32_bf16 v[64:67], v[172:175], v[84:87], v[64:67]
v_mfma_f32_16x16x32_bf16 v[40:43], v[228:231], v[80:83], v[40:43]
v_mfma_f32_16x16x32_bf16 v[68:71], v[228:231], v[84:87], v[68:71]
s_waitcnt lgkmcnt(0)
v_mfma_f32_16x16x32_bf16 v[16:19], a[32:35], v[72:75], v[16:19]
v_mfma_f32_16x16x32_bf16 v[44:47], a[32:35], v[76:79], v[44:47]
ds_read_b128 v[80:83], v1 offset:9216
ds_read_b128 v[84:87], v1 offset:23552
v_mfma_f32_16x16x32_bf16 v[20:23], a[88:91], v[72:75], v[20:23]
v_mfma_f32_16x16x32_bf16 v[48:51], a[88:91], v[76:79], v[48:51]
v_mfma_f32_16x16x32_bf16 v[24:27], a[144:147], v[72:75], v[24:27]
v_mfma_f32_16x16x32_bf16 v[52:55], a[144:147], v[76:79], v[52:55]
v_mfma_f32_16x16x32_bf16 v[28:31], a[200:203], v[72:75], v[28:31]
v_mfma_f32_16x16x32_bf16 v[56:59], a[200:203], v[76:79], v[56:59]
v_mfma_f32_16x16x32_bf16 v[32:35], v[120:123], v[72:75], v[32:35]
v_mfma_f32_16x16x32_bf16 v[60:63], v[120:123], v[76:79], v[60:63]
v_mfma_f32_16x16x32_bf16 v[36:39], v[176:179], v[72:75], v[36:39]
v_mfma_f32_16x16x32_bf16 v[64:67], v[176:179], v[76:79], v[64:67]
v_mfma_f32_16x16x32_bf16 v[40:43], v[232:235], v[72:75], v[40:43]
v_mfma_f32_16x16x32_bf16 v[68:71], v[232:235], v[76:79], v[68:71]
s_waitcnt lgkmcnt(0)
v_mfma_f32_16x16x32_bf16 v[16:19], a[36:39], v[80:83], v[16:19]
v_mfma_f32_16x16x32_bf16 v[44:47], a[36:39], v[84:87], v[44:47]
ds_read_b128 v[72:75], v1 offset:10240
ds_read_b128 v[76:79], v1 offset:24576
v_mfma_f32_16x16x32_bf16 v[20:23], a[92:95], v[80:83], v[20:23]
v_mfma_f32_16x16x32_bf16 v[48:51], a[92:95], v[84:87], v[48:51]
v_mfma_f32_16x16x32_bf16 v[24:27], a[148:151], v[80:83], v[24:27]
v_mfma_f32_16x16x32_bf16 v[52:55], a[148:151], v[84:87], v[52:55]
v_mfma_f32_16x16x32_bf16 v[28:31], a[204:207], v[80:83], v[28:31]
v_mfma_f32_16x16x32_bf16 v[56:59], a[204:207], v[84:87], v[56:59]
v_mfma_f32_16x16x32_bf16 v[32:35], v[124:127], v[80:83], v[32:35]
v_mfma_f32_16x16x32_bf16 v[60:63], v[124:127], v[84:87], v[60:63]
v_mfma_f32_16x16x32_bf16 v[36:39], v[180:183], v[80:83], v[36:39]
v_mfma_f32_16x16x32_bf16 v[64:67], v[180:183], v[84:87], v[64:67]
v_mfma_f32_16x16x32_bf16 v[40:43], v[236:239], v[80:83], v[40:43]
v_mfma_f32_16x16x32_bf16 v[68:71], v[236:239], v[84:87], v[68:71]
s_waitcnt lgkmcnt(0)
v_mfma_f32_16x16x32_bf16 v[16:19], a[40:43], v[72:75], v[16:19]
v_mfma_f32_16x16x32_bf16 v[44:47], a[40:43], v[76:79], v[44:47]
ds_read_b128 v[80:83], v1 offset:11264
ds_read_b128 v[84:87], v1 offset:25600
v_mfma_f32_16x16x32_bf16 v[20:23], a[96:99], v[72:75], v[20:23]
v_mfma_f32_16x16x32_bf16 v[48:51], a[96:99], v[76:79], v[48:51]
v_mfma_f32_16x16x32_bf16 v[24:27], a[152:155], v[72:75], v[24:27]
v_mfma_f32_16x16x32_bf16 v[52:55], a[152:155], v[76:79], v[52:55]
v_mfma_f32_16x16x32_bf16 v[28:31], a[208:211], v[72:75], v[28:31]
v_mfma_f32_16x16x32_bf16 v[56:59], a[208:211], v[76:79], v[56:59]
v_mfma_f32_16x16x32_bf16 v[32:35], v[128:131], v[72:75], v[32:35]
v_mfma_f32_16x16x32_bf16 v[60:63], v[128:131], v[76:79], v[60:63]
v_mfma_f32_16x16x32_bf16 v[36:39], v[184:187], v[72:75], v[36:39]
v_mfma_f32_16x16x32_bf16 v[64:67], v[184:187], v[76:79], v[64:67]
v_mfma_f32_16x16x32_bf16 v[40:43], v[240:243], v[72:75], v[40:43]
v_mfma_f32_16x16x32_bf16 v[68:71], v[240:243], v[76:79], v[68:71]
s_waitcnt lgkmcnt(0)
v_mfma_f32_16x16x32_bf16 v[16:19], a[44:47], v[80:83], v[16:19]
v_mfma_f32_16x16x32_bf16 v[44:47], a[44:47], v[84:87], v[44:47]
ds_read_b128 v[72:75], v1 offset:12288
ds_read_b128 v[76:79], v1 offset:26624
v_mfma_f32_16x16x32_bf16 v[20:23], a[100:103], v[80:83], v[20:23]
v_mfma_f32_16x16x32_bf16 v[48:51], a[100:103], v[84:87], v[48:51]
v_mfma_f32_16x16x32_bf16 v[24:27], a[156:159], v[80:83], v[24:27]
v_mfma_f32_16x16x32_bf16 v[52:55], a[156:159], v[84:87], v[52:55]
v_mfma_f32_16x16x32_bf16 v[28:31], a[212:215], v[80:83], v[28:31]
v_mfma_f32_16x16x32_bf16 v[56:59], a[212:215], v[84:87], v[56:59]
v_mfma_f32_16x16x32_bf16 v[32:35], v[132:135], v[80:83], v[32:35]
v_mfma_f32_16x16x32_bf16 v[60:63], v[132:135], v[84:87], v[60:63]
v_mfma_f32_16x16x32_bf16 v[36:39], v[188:191], v[80:83], v[36:39]
v_mfma_f32_16x16x32_bf16 v[64:67], v[188:191], v[84:87], v[64:67]
v_mfma_f32_16x16x32_bf16 v[40:43], v[244:247], v[80:83], v[40:43]
v_mfma_f32_16x16x32_bf16 v[68:71], v[244:247], v[84:87], v[68:71]
s_waitcnt lgkmcnt(0)
v_mfma_f32_16x16x32_bf16 v[16:19], a[48:51], v[72:75], v[16:19]
v_mfma_f32_16x16x32_bf16 v[44:47], a[48:51], v[76:79], v[44:47]
ds_read_b128 v[80:83], v1 offset:13312
ds_read_b128 v[84:87], v1 offset:27648
v_mfma_f32_16x16x32_bf16 v[20:23], a[104:107], v[72:75], v[20:23]
v_mfma_f32_16x16x32_bf16 v[48:51], a[104:107], v[76:79], v[48:51]
v_mfma_f32_16x16x32_bf16 v[24:27], a[160:163], v[72:75], v[24:27]
v_mfma_f32_16x16x32_bf16 v[52:55], a[160:163], v[76:79], v[52:55]
v_mfma_f32_16x16x32_bf16 v[28:31], a[216:219], v[72:75], v[28:31]
v_mfma_f32_16x16x32_bf16 v[56:59], a[216:219], v[76:79], v[56:59]
v_mfma_f32_16x16x32_bf16 v[32:35], v[136:139], v[72:75], v[32:35]
v_mfma_f32_16x16x32_bf16 v[60:63], v[136:139], v[76:79], v[60:63]
v_mfma_f32_16x16x32_bf16 v[36:39], v[192:195], v[72:75], v[36:39]
v_mfma_f32_16x16x32_bf16 v[64:67], v[192:195], v[76:79], v[64:67]
v_mfma_f32_16x16x32_bf16 v[40:43], v[248:251], v[72:75], v[40:43]
v_mfma_f32_16x16x32_bf16 v[68:71], v[248:251], v[76:79], v[68:71]
s_waitcnt lgkmcnt(0)
v_mfma_f32_16x16x32_bf16 v[16:19], a[52:55], v[80:83], v[16:19]
v_mfma_f32_16x16x32_bf16 v[44:47], a[52:55], v[84:87], v[44:47]
v_mfma_f32_16x16x32_bf16 v[20:23], a[108:111], v[80:83], v[20:23]
v_mfma_f32_16x16x32_bf16 v[48:51], a[108:111], v[84:87], v[48:51]
v_mfma_f32_16x16x32_bf16 v[24:27], a[164:167], v[80:83], v[24:27]
v_mfma_f32_16x16x32_bf16 v[52:55], a[164:167], v[84:87], v[52:55]
v_mfma_f32_16x16x32_bf16 v[28:31], a[220:223], v[80:83], v[28:31]
v_mfma_f32_16x16x32_bf16 v[56:59], a[220:223], v[84:87], v[56:59]
v_mfma_f32_16x16x32_bf16 v[32:35], v[140:143], v[80:83], v[32:35]
v_mfma_f32_16x16x32_bf16 v[60:63], v[140:143], v[84:87], v[60:63]
v_mfma_f32_16x16x32_bf16 v[36:39], v[196:199], v[80:83], v[36:39]
v_mfma_f32_16x16x32_bf16 v[64:67], v[196:199], v[84:87], v[64:67]
v_mfma_f32_16x16x32_bf16 v[40:43], v[252:255], v[80:83], v[40:43]
v_mfma_f32_16x16x32_bf16 v[68:71], v[252:255], v[84:87], v[68:71]
s_nop 1
v_cvt_pk_bf16_f32 v88, v16, v17
v_cvt_pk_bf16_f32 v89, v18, v19
v_cvt_pk_bf16_f32 v104, v44, v45
v_cvt_pk_bf16_f32 v105, v46, v47
v_cvt_pk_bf16_f32 v90, v20, v21
v_cvt_pk_bf16_f32 v91, v22, v23
v_cvt_pk_bf16_f32 v106, v48, v49
v_cvt_pk_bf16_f32 v107, v50, v51
v_cvt_pk_bf16_f32 v92, v24, v25
v_cvt_pk_bf16_f32 v93, v26, v27
v_cvt_pk_bf16_f32 v108, v52, v53
v_cvt_pk_bf16_f32 v109, v54, v55
v_cvt_pk_bf16_f32 v94, v28, v29
v_cvt_pk_bf16_f32 v95, v30, v31
v_cvt_pk_bf16_f32 v110, v56, v57
v_cvt_pk_bf16_f32 v111, v58, v59
v_cvt_pk_bf16_f32 v96, v32, v33
v_cvt_pk_bf16_f32 v97, v34, v35
v_cvt_pk_bf16_f32 v112, v60, v61
v_cvt_pk_bf16_f32 v113, v62, v63
v_cvt_pk_bf16_f32 v98, v36, v37
v_cvt_pk_bf16_f32 v99, v38, v39
v_cvt_pk_bf16_f32 v114, v64, v65
v_cvt_pk_bf16_f32 v115, v66, v67
v_cvt_pk_bf16_f32 v100, v40, v41
v_cvt_pk_bf16_f32 v101, v42, v43
v_cvt_pk_bf16_f32 v116, v68, v69
v_cvt_pk_bf16_f32 v117, v70, v71
ds_read_b64 v[16:17], v2
ds_read_b64 v[18:19], v2 offset:512
ds_read_b64 v[20:21], v2 offset:14336
ds_read_b64 v[22:23], v2 offset:14848
ds_read_b64 v[24:25], v2 offset:1024
ds_read_b64 v[26:27], v2 offset:1536
ds_read_b64 v[28:29], v2 offset:15360
ds_read_b64 v[30:31], v2 offset:15872
s_waitcnt lgkmcnt(4)
v_mfma_f32_16x16x32_bf16 v[32:35], v[16:19], v[88:91], 0
v_mfma_f32_16x16x32_bf16 v[36:39], v[16:19], v[104:107], 0
v_mfma_f32_16x16x32_bf16 v[40:43], v[20:23], v[104:107], 0
ds_read_b64 v[16:17], v2 offset:2048
ds_read_b64 v[18:19], v2 offset:2560
ds_read_b64 v[20:21], v2 offset:16384
ds_read_b64 v[22:23], v2 offset:16896
s_waitcnt lgkmcnt(4)
v_mfma_f32_16x16x32_bf16 v[32:35], v[24:27], v[92:95], v[32:35]
v_mfma_f32_16x16x32_bf16 v[36:39], v[24:27], v[108:111], v[36:39]
v_mfma_f32_16x16x32_bf16 v[40:43], v[28:31], v[108:111], v[40:43]
ds_read_b64 v[24:25], v2 offset:3072
ds_read_b64 v[26:27], v2 offset:3584
ds_read_b64 v[28:29], v2 offset:17408
ds_read_b64 v[30:31], v2 offset:17920
s_waitcnt lgkmcnt(4)
v_mfma_f32_16x16x32_bf16 v[32:35], v[16:19], v[96:99], v[32:35]
v_mfma_f32_16x16x32_bf16 v[36:39], v[16:19], v[112:115], v[36:39]
v_mfma_f32_16x16x32_bf16 v[40:43], v[20:23], v[112:115], v[40:43]
s_waitcnt lgkmcnt(0)
v_mfma_f32_16x16x32_bf16 v[32:35], v[24:27], v[100:103], v[32:35]
v_mfma_f32_16x16x32_bf16 v[36:39], v[24:27], v[116:119], v[36:39]
v_mfma_f32_16x16x32_bf16 v[40:43], v[28:31], v[116:119], v[40:43]
v_mov_b32 v66, 0
v_mov_b32 v67, 0
s_nop 5
ds_write_b128 v4, v[32:35]
ds_write_b128 v4, v[36:39] offset:2304
ds_write_b128 v4, v[40:43] offset:2368
s_waitcnt lgkmcnt(0)
s_barrier
ds_read_b128 v[16:19], v5
ds_read_b128 v[20:23], v5 offset:4608
ds_read_b128 v[24:27], v5 offset:9216
ds_read_b128 v[28:31], v5 offset:13824
s_waitcnt lgkmcnt(0)
v_add_f32 v16, v16, v20
v_add_f32 v24, v24, v28
v_add_f32 v16, v16, v24
v_mov_b32 v68, s47
v_cndmask_b32 v68, v68, v16, s[32:33]
v_add_f32 v17, v17, v21
v_add_f32 v25, v25, v29
v_add_f32 v17, v17, v25
v_mov_b32 v69, s47
v_cndmask_b32 v69, v69, v17, s[34:35]
v_add_f32 v18, v18, v22
v_add_f32 v26, v26, v30
v_add_f32 v18, v18, v26
v_mov_b32 v70, s47
v_cndmask_b32 v70, v70, v18, s[36:37]
v_add_f32 v19, v19, v23
v_add_f32 v27, v27, v31
v_add_f32 v19, v19, v27
v_mov_b32 v71, s47
v_cndmask_b32 v71, v71, v19, s[38:39]
v_max3_f32 v32, v68, v69, v70
v_max_f32 v32, v32, v71
buffer_load_dwordx2 v[52:53], v3, s[4:7], s28 offen sc1
buffer_load_dwordx2 v[54:55], v3, s[4:7], s28 offen offset:256 sc1
buffer_load_dwordx2 v[56:57], v3, s[4:7], s28 offen offset:512 sc1
buffer_load_dwordx2 v[58:59], v3, s[4:7], s28 offen offset:768 sc1
buffer_load_dwordx2 v[60:61], v3, s[4:7], s28 offen offset:1024 sc1
buffer_load_dwordx2 v[62:63], v3, s[4:7], s28 offen offset:1280 sc1
buffer_load_dwordx2 v[64:65], v3, s[4:7], s28 offen offset:1536 sc1
s_sleep 6
Lspin_163:
buffer_load_dwordx2 v[52:53], v3, s[4:7], s28 offen sc1
buffer_load_dwordx2 v[54:55], v3, s[4:7], s28 offen offset:256 sc1
buffer_load_dwordx2 v[56:57], v3, s[4:7], s28 offen offset:512 sc1
buffer_load_dwordx2 v[58:59], v3, s[4:7], s28 offen offset:768 sc1
buffer_load_dwordx2 v[60:61], v3, s[4:7], s28 offen offset:1024 sc1
buffer_load_dwordx2 v[62:63], v3, s[4:7], s28 offen offset:1280 sc1
buffer_load_dwordx2 v[64:65], v3, s[4:7], s28 offen offset:1536 sc1
s_sub_u32 s24, s24, 1
s_cbranch_scc1 CODE_END
s_waitcnt vmcnt(7)
v_max3_u32 v10, v52, v53, v54
v_max3_u32 v10, v10, v55, v56
v_max3_u32 v10, v10, v57, v58
v_max3_u32 v10, v10, v59, v60
v_max3_u32 v10, v10, v61, v62
v_max3_u32 v10, v10, v63, v64
v_max_u32 v10, v10, v65
v_cmp_eq_u32 vcc, -1, v10
s_cbranch_vccz Lspin_163x
s_cmp_ge_u32 s25, 58
s_cbranch_scc1 Lspin_163
s_sleep 8
s_branch Lspin_163
Lspin_163x:
v_mfma_f32_16x16x32_bf16 v[44:47], v[52:55], v[88:91], 0
v_mfma_f32_16x16x32_bf16 v[48:51], v[52:55], v[104:107], 0
v_mfma_f32_16x16x32_bf16 v[44:47], v[56:59], v[92:95], v[44:47]
v_mfma_f32_16x16x32_bf16 v[48:51], v[56:59], v[108:111], v[48:51]
v_mfma_f32_16x16x32_bf16 v[44:47], v[60:63], v[96:99], v[44:47]
v_mfma_f32_16x16x32_bf16 v[48:51], v[60:63], v[112:115], v[48:51]
v_mfma_f32_16x16x32_bf16 v[44:47], v[64:67], v[100:103], v[44:47]
v_mfma_f32_16x16x32_bf16 v[48:51], v[64:67], v[116:119], v[48:51]
s_nop 6
ds_write_b128 v6, v[44:47]
ds_write_b128 v6, v[48:51] offset:2304
s_waitcnt lgkmcnt(0)
s_barrier
ds_read2_b32 v[20:21], v7 offset0:0 offset1:8
ds_read2_b32 v[22:23], v7 offset0:16 offset1:24
s_waitcnt lgkmcnt(0)
v_pk_add_f32 v[20:21], v[20:21], v[22:23]
v_add_f32 v17, v20, v21
v_max_f32 v16, v32, v17
s_nop 1
v_max_f32_dpp v16, v16, v16 quad_perm:[1,0,3,2] row_mask:0xf bank_mask:0xf
s_nop 1
v_max_f32_dpp v16, v16, v16 quad_perm:[2,3,0,1] row_mask:0xf bank_mask:0xf
s_nop 1
v_max_f32_dpp v16, v16, v16 row_half_mirror row_mask:0xf bank_mask:0xf
v_sub_f32 v17, v17, v16
v_sub_f32 v68, v68, v16
v_sub_f32 v69, v69, v16
v_sub_f32 v70, v70, v16
v_sub_f32 v71, v71, v16
v_exp_f32 v17, v17
v_exp_f32 v68, v68
v_exp_f32 v69, v69
v_exp_f32 v70, v70
v_exp_f32 v71, v71
v_add_f32 v16, v17, v68
v_add_f32 v18, v69, v70
v_add_f32 v16, v16, v71
v_add_f32 v16, v16, v18
v_mov_b32_dpp v18, v17 quad_perm:[1,0,3,2] row_mask:0xf bank_mask:0xf
s_nop 1
v_add_f32_dpp v16, v16, v16 quad_perm:[1,0,3,2] row_mask:0xf bank_mask:0xf
s_nop 1
v_add_f32_dpp v16, v16, v16 quad_perm:[2,3,0,1] row_mask:0xf bank_mask:0xf
s_nop 1
v_add_f32_dpp v16, v16, v16 row_half_mirror row_mask:0xf bank_mask:0xf
v_rcp_f32 v16, v16
s_cmp_lg_u32 s23, 0
v_mul_f32 v68, v68, v16 clamp
v_mul_f32 v69, v69, v16 clamp
v_mul_f32 v70, v70, v16 clamp
v_mul_f32 v71, v71, v16 clamp
v_mul_f32 v17, v17, v16 clamp
v_mul_f32 v18, v18, v16 clamp
v_cvt_pk_bf16_f32 v68, v68, v69
v_cvt_pk_bf16_f32 v70, v70, v71
v_cvt_pk_bf16_f32 v17, v17, v18
s_cbranch_scc1 Lwt_164
buffer_store_dword v68, v8, s[4:7], s29 offen
buffer_store_dword v70, v8, s[4:7], s29 offen offset:8
buffer_store_dword v17, v9, s[4:7], s30 offen
s_branch Lst_165
Lwt_164:
buffer_store_dword v68, v8, s[4:7], s29 offen sc1
buffer_store_dword v70, v8, s[4:7], s29 offen offset:8 sc1
buffer_store_dword v17, v9, s[4:7], s30 offen sc1
Lst_165:
s_add_u32 s26, s26, 114688
s_add_u32 s27, s27, 114688
s_add_u32 s28, s28, 28672
s_add_u32 s29, s29, 163840
s_add_u32 s30, s30, 163840
s_add_u32 s25, s25, 4
s_cmp_lt_u32 s25, 64
s_cbranch_scc1 TA_SEG1
s_endpgm
TA_W2:
v_lshlrev_b32 v1, 4, v0
s_cmp_lt_u32 s21, 2
s_cselect_b32 s42, 0, 4
s_add_u32 s42, s42, s21
s_lshl_b32 s40, s42, 7
s_add_u32 s40, s40, 139264
s_branch Lfirst_167
Lflag_166:
v_cmp_ne_u32 vcc, s88, v10
s_cbranch_vccz Lset_168
s_sleep 16
Lfirst_167:
buffer_load_dword v10, off, s[4:7], s40 sc1
s_waitcnt vmcnt(0)
s_sub_u32 s24, s24, 1
s_cbranch_scc0 Lflag_166
s_endpgm
Lset_168:
v_min_u32 v12, 55, v0
v_and_b32 v10, 3, v12
v_lshlrev_b32 v10, 3, v10
v_lshrrev_b32 v12, 2, v12
v_lshl_add_u32 v10, v12, 7, v10
s_mov_b32 s43, 4352
Llz_169:
buffer_load_dwordx2 v[12:13], v10, s[4:7], s43 offen sc1
s_waitcnt vmcnt(0)
v_cmp_ne_u32 vcc, s88, v12
v_cmp_ne_u32 s[40:41], s88, v13
s_or_b64 vcc, vcc, s[40:41]
s_cbranch_vccz Llzok_170
s_sleep 8
s_sub_u32 s24, s24, 1
s_cbranch_scc0 Llz_169
s_endpgm
Llzok_170:
s_mul_i32 s40, s21, 7168
s_add_u32 s40, s40, 656384
Lstp_171:
buffer_load_dword v10, off, s[4:7], s40 sc1
s_waitcnt vmcnt(0)
v_cmp_eq_u32 vcc, -1, v10
s_cbranch_vccz Lstpok_172
s_sleep 16
s_sub_u32 s24, s24, 1
s_cbranch_scc0 Lstp_171
s_endpgm
Lstpok_172:
v_min_u32 v10, 6, v0
v_lshlrev_b32 v10, 2, v10
s_lshl_b32 s40, s22, 7
s_branch Lfirst_174
Lflag_173:
v_cmp_ne_u32 vcc, s88, v11
s_cbranch_vccz Lset_175
s_sleep 4
Lfirst_174:
buffer_load_dword v11, v10, s[4:7], s40 offen sc1
s_waitcnt vmcnt(0)
s_sub_u32 s24, s24, 1
s_cbranch_scc0 Lflag_173
s_endpgm
Lset_175:
s_mul_i32 s40, s22, 401408
s_add_u32 s40, s40, 10080256
buffer_load_dwordx4 a[0:3], v1, s[4:7], s40 offen
buffer_load_dwordx4 a[4:7], v1, s[4:7], s40 offen offset:1024
buffer_load_dwordx4 a[8:11], v1, s[4:7], s40 offen offset:2048
buffer_load_dwordx4 a[12:15], v1, s[4:7], s40 offen offset:3072
s_add_u32 s40, s40, 4096
buffer_load_dwordx4 a[16:19], v1, s[4:7], s40 offen
buffer_load_dwordx4 a[20:23], v1, s[4:7], s40 offen offset:1024
buffer_load_dwordx4 a[24:27], v1, s[4:7], s40 offen offset:2048
buffer_load_dwordx4 a[28:31], v1, s[4:7], s40 offen offset:3072
s_add_u32 s40, s40, 4096
buffer_load_dwordx4 a[32:35], v1, s[4:7], s40 offen
buffer_load_dwordx4 a[36:39], v1, s[4:7], s40 offen offset:1024
buffer_load_dwordx4 a[40:43], v1, s[4:7], s40 offen offset:2048
buffer_load_dwordx4 a[44:47], v1, s[4:7], s40 offen offset:3072
s_add_u32 s40, s40, 4096
buffer_load_dwordx4 a[48:51], v1, s[4:7], s40 offen
buffer_load_dwordx4 a[52:55], v1, s[4:7], s40 offen offset:1024
buffer_load_dwordx4 a[56:59], v1, s[4:7], s40 offen offset:2048
buffer_load_dwordx4 a[60:63], v1, s[4:7], s40 offen offset:3072
s_add_u32 s40, s40, 4096
buffer_load_dwordx4 a[64:67], v1, s[4:7], s40 offen
buffer_load_dwordx4 a[68:71], v1, s[4:7], s40 offen offset:1024
buffer_load_dwordx4 a[72:75], v1, s[4:7], s40 offen offset:2048
buffer_load_dwordx4 a[76:79], v1, s[4:7], s40 offen offset:3072
s_add_u32 s40, s40, 4096
buffer_load_dwordx4 a[80:83], v1, s[4:7], s40 offen
buffer_load_dwordx4 a[84:87], v1, s[4:7], s40 offen offset:1024
buffer_load_dwordx4 a[88:91], v1, s[4:7], s40 offen offset:2048
buffer_load_dwordx4 a[92:95], v1, s[4:7], s40 offen offset:3072
s_add_u32 s40, s40, 4096
buffer_load_dwordx4 a[96:99], v1, s[4:7], s40 offen
buffer_load_dwordx4 a[100:103], v1, s[4:7], s40 offen offset:1024
buffer_load_dwordx4 a[104:107], v1, s[4:7], s40 offen offset:2048
buffer_load_dwordx4 a[108:111], v1, s[4:7], s40 offen offset:3072
s_add_u32 s40, s40, 4096
buffer_load_dwordx4 a[112:115], v1, s[4:7], s40 offen
buffer_load_dwordx4 a[116:119], v1, s[4:7], s40 offen offset:1024
buffer_load_dwordx4 a[120:123], v1, s[4:7], s40 offen offset:2048
buffer_load_dwordx4 a[124:127], v1, s[4:7], s40 offen offset:3072
s_add_u32 s40, s40, 4096
buffer_load_dwordx4 a[128:131], v1, s[4:7], s40 offen
buffer_load_dwordx4 a[132:135], v1, s[4:7], s40 offen offset:1024
buffer_load_dwordx4 a[136:139], v1, s[4:7], s40 offen offset:2048
buffer_load_dwordx4 a[140:143], v1, s[4:7], s40 offen offset:3072
s_add_u32 s40, s40, 4096
buffer_load_dwordx4 a[144:147], v1, s[4:7], s40 offen
buffer_load_dwordx4 a[148:151], v1, s[4:7], s40 offen offset:1024
buffer_load_dwordx4 a[152:155], v1, s[4:7], s40 offen offset:2048
buffer_load_dwordx4 a[156:159], v1, s[4:7], s40 offen offset:3072
s_add_u32 s40, s40, 4096
buffer_load_dwordx4 a[160:163], v1, s[4:7], s40 offen
buffer_load_dwordx4 a[164:167], v1, s[4:7], s40 offen offset:1024
buffer_load_dwordx4 a[168:171], v1, s[4:7], s40 offen offset:2048
buffer_load_dwordx4 a[172:175], v1, s[4:7], s40 offen offset:3072
s_add_u32 s40, s40, 4096
buffer_load_dwordx4 a[176:179], v1, s[4:7], s40 offen
buffer_load_dwordx4 a[180:183], v1, s[4:7], s40 offen offset:1024
buffer_load_dwordx4 a[184:187], v1, s[4:7], s40 offen offset:2048
buffer_load_dwordx4 a[188:191], v1, s[4:7], s40 offen offset:3072
s_add_u32 s40, s40, 4096
s_waitcnt vmcnt(40)
buffer_load_dwordx4 a[192:195], v1, s[4:7], s40 offen
buffer_load_dwordx4 a[196:199], v1, s[4:7], s40 offen offset:1024
buffer_load_dwordx4 a[200:203], v1, s[4:7], s40 offen offset:2048
buffer_load_dwordx4 a[204:207], v1, s[4:7], s40 offen offset:3072
s_add_u32 s40, s40, 4096
buffer_load_dwordx4 a[208:211], v1, s[4:7], s40 offen
buffer_load_dwordx4 a[212:215], v1, s[4:7], s40 offen offset:1024
buffer_load_dwordx4 a[216:219], v1, s[4:7], s40 offen offset:2048
buffer_load_dwordx4 a[220:223], v1, s[4:7], s40 offen offset:3072
s_add_u32 s40, s40, 4096
s_waitcnt vmcnt(40)
buffer_load_dwordx4 a[224:227], v1, s[4:7], s40 offen
buffer_load_dwordx4 a[228:231], v1, s[4:7], s40 offen offset:1024
buffer_load_dwordx4 a[232:235], v1, s[4:7], s40 offen offset:2048
buffer_load_dwordx4 a[236:239], v1, s[4:7], s40 offen offset:3072
s_add_u32 s40, s40, 4096
buffer_load_dwordx4 a[240:243], v1, s[4:7], s40 offen
buffer_load_dwordx4 a[244:247], v1, s[4:7], s40 offen offset:1024
buffer_load_dwordx4 a[248:251], v1, s[4:7], s40 offen offset:2048
buffer_load_dwordx4 a[252:255], v1, s[4:7], s40 offen offset:3072
s_add_u32 s40, s40, 4096
s_waitcnt vmcnt(40)
buffer_load_dwordx4 v[120:123], v1, s[4:7], s40 offen
buffer_load_dwordx4 v[124:127], v1, s[4:7], s40 offen offset:1024
buffer_load_dwordx4 v[128:131], v1, s[4:7], s40 offen offset:2048
buffer_load_dwordx4 v[132:135], v1, s[4:7], s40 offen offset:3072
s_add_u32 s40, s40, 4096
buffer_load_dwordx4 v[136:139], v1, s[4:7], s40 offen
buffer_load_dwordx4 v[140:143], v1, s[4:7], s40 offen offset:1024
buffer_load_dwordx4 v[144:147], v1, s[4:7], s40 offen offset:2048
buffer_load_dwordx4 v[148:151], v1, s[4:7], s40 offen offset:3072
s_add_u32 s40, s40, 4096
s_waitcnt vmcnt(40)
buffer_load_dwordx4 v[152:155], v1, s[4:7], s40 offen
buffer_load_dwordx4 v[156:159], v1, s[4:7], s40 offen offset:1024
buffer_load_dwordx4 v[160:163], v1, s[4:7], s40 offen offset:2048
buffer_load_dwordx4 v[164:167], v1, s[4:7], s40 offen offset:3072
s_add_u32 s40, s40, 4096
buffer_load_dwordx4 v[168:171], v1, s[4:7], s40 offen
buffer_load_dwordx4 v[172:175], v1, s[4:7], s40 offen offset:1024
buffer_load_dwordx4 v[176:179], v1, s[4:7], s40 offen offset:2048
buffer_load_dwordx4 v[180:183], v1, s[4:7], s40 offen offset:3072
s_add_u32 s40, s40, 4096
s_waitcnt vmcnt(40)
buffer_load_dwordx4 v[184:187], v1, s[4:7], s40 offen
buffer_load_dwordx4 v[188:191], v1, s[4:7], s40 offen offset:1024
buffer_load_dwordx4 v[192:195], v1, s[4:7], s40 offen offset:2048
buffer_load_dwordx4 v[196:199], v1, s[4:7], s40 offen offset:3072
s_add_u32 s40, s40, 4096
buffer_load_dwordx4 v[200:203], v1, s[4:7], s40 offen
buffer_load_dwordx4 v[204:207], v1, s[4:7], s40 offen offset:1024
buffer_load_dwordx4 v[208:211], v1, s[4:7], s40 offen offset:2048
buffer_load_dwordx4 v[212:215], v1, s[4:7], s40 offen offset:3072
s_add_u32 s40, s40, 4096
s_waitcnt vmcnt(40)
buffer_load_dwordx4 v[216:219], v1, s[4:7], s40 offen
buffer_load_dwordx4 v[220:223], v1, s[4:7], s40 offen offset:1024
buffer_load_dwordx4 v[224:227], v1, s[4:7], s40 offen offset:2048
buffer_load_dwordx4 v[228:231], v1, s[4:7], s40 offen offset:3072
s_add_u32 s40, s40, 4096
buffer_load_dwordx4 v[232:235], v1, s[4:7], s40 offen
buffer_load_dwordx4 v[236:239], v1, s[4:7], s40 offen offset:1024
buffer_load_dwordx4 v[240:243], v1, s[4:7], s40 offen offset:2048
buffer_load_dwordx4 v[244:247], v1, s[4:7], s40 offen offset:3072
s_add_u32 s40, s40, 4096
s_waitcnt vmcnt(40)
buffer_load_dwordx4 v[248:251], v1, s[4:7], s40 offen
buffer_load_dwordx4 v[252:255], v1, s[4:7], s40 offen offset:1024
v_and_b32 v10, 15, v0
v_lshrrev_b32 v11, 4, v0
v_lshrrev_b32 v3, 5, v0
v_add_u32 v3, 28, v3
v_lshrrev_b32 v2, 2, v3
v_lshlrev_b32 v2, 10, v2
v_and_b32 v4, 3, v3
v_lshl_add_u32 v2, v4, 8, v2
v_lshl_add_u32 v2, v10, 4, v2
v_and_b32 v4, 1, v11
v_lshl_add_u32 v2, v4, 3, v2
v_add_u32 v2, 28672, v2
v_lshlrev_b32 v3, 7, v3
v_lshl_add_u32 v3, v4, 3, v3
v_and_b32 v5, 7, v0
v_lshl_add_u32 v3, v5, 4, v3
v_mul_u32_u24 v6, 144, v10
v_lshl_add_u32 v7, v11, 4, v6
v_lshl_add_u32 v6, v4, 4, v6
v_add_u32 v4, 67584, v7
v_add_u32 v6, 76864, v6
v_lshrrev_b32 v10, 3, v0
v_add_u32 v10, 16, v10
v_and_b32 v11, 7, v0
v_mul_u32_u24 v7, 144, v10
v_lshl_add_u32 v5, v11, 4, v7
v_add_u32 v5, 58368, v5
v_lshl_add_u32 v7, v11, 2, v7
v_add_u32 v7, 76800, v7
v_lshlrev_b32 v8, 2, v11
v_sub_u32 v8, v10, v8
v_cmp_le_i32 s[32:33], 0, v8
v_cmp_le_i32 s[34:35], 1, v8
v_cmp_le_i32 s[36:37], 2, v8
v_cmp_le_i32 s[38:39], 3, v8
v_and_b32 v10, 15, v10
v_lshlrev_b32 v10, 4, v10
v_bfe_u32 v9, v0, 1, 1
v_lshl_add_u32 v10, v9, 2, v10
v_bfe_u32 v11, v0, 2, 1
v_lshl_add_u32 v9, v11, 8, v10
v_lshl_add_u32 v8, v11, 9, v10
v_and_b32 v11, 1, v0
v_lshl_add_u32 v8, v11, 8, v8
v_lshlrev_b32 v11, 30, v11
v_or_b32 v9, v9, v11
v_mov_b32 v10, 0
v_lshlrev_b32 v11, 2, v0
ds_write_b32 v11, v10 offset:57856
v_mov_b32 v102, 0
v_mov_b32 v103, 0
v_mov_b32 v118, 0
v_mov_b32 v119, 0
s_mul_i32 s26, s21, 28672
s_add_u32 s27, s26, 6205440
s_add_u32 s26, s26, 8044544
s_mul_i32 s28, s21, 7168
s_add_u32 s28, s28, 634880
s_mul_i32 s29, s21, 40960
s_add_u32 s29, s29, 1748992
s_lshr_b32 s30, s22, 1
s_lshl_b32 s30, s30, 10
s_and_b32 s40, s22, 1
s_lshl_b32 s40, s40, 3
s_add_u32 s30, s30, s40
s_add_u32 s30, s30, s29
s_add_u32 s30, s30, 33280
s_lshl_b32 s40, s22, 11
s_add_u32 s29, s29, s40
s_add_u32 s29, s29, 1024
s_mov_b32 s47, 0xceabfb8f
s_mov_b32 s25, s21
v_min_u32 v12, 55, v0
v_and_b32 v10, 3, v12
v_lshlrev_b32 v10, 3, v10
v_lshrrev_b32 v12, 2, v12
v_lshl_add_u32 v10, v12, 7, v10
s_mov_b32 s43, 4352
Llz_176:
buffer_load_dwordx2 v[12:13], v10, s[4:7], s43 offen sc1
s_waitcnt vmcnt(0)
v_cmp_ne_u32 vcc, s88, v12
v_cmp_ne_u32 s[40:41], s88, v13
s_or_b64 vcc, vcc, s[40:41]
s_cbranch_vccz Llzok_177
s_sleep 8
s_sub_u32 s24, s24, 1
s_cbranch_scc0 Llz_176
s_endpgm
Llzok_177:
v_min_u32 v12, 47, v0
v_and_b32 v10, 3, v12
v_lshlrev_b32 v10, 3, v10
v_lshrrev_b32 v12, 2, v12
v_lshl_add_u32 v10, v12, 7, v10
s_mov_b32 s43, 6144
Llz_178:
buffer_load_dwordx2 v[12:13], v10, s[4:7], s43 offen sc1
s_waitcnt vmcnt(0)
v_cmp_ne_u32 vcc, s88, v12
v_cmp_ne_u32 s[40:41], s88, v13
s_or_b64 vcc, vcc, s[40:41]
s_cbranch_vccz Llzok_179
s_sleep 8
s_sub_u32 s24, s24, 1
s_cbranch_scc0 Llz_178
s_endpgm
Llzok_179:
TA_SEG2:
s_mov_b32 m0, 14336
s_add_u32 s40, s26, 14336
buffer_load_dwordx4 v1, s[4:7], s40 offen lds
s_mov_b32 m0, 15360
s_add_u32 s40, s26, 15360
buffer_load_dwordx4 v1, s[4:7], s40 offen lds
s_mov_b32 m0, 16384
s_add_u32 s40, s26, 16384
buffer_load_dwordx4 v1, s[4:7], s40 offen lds
s_mov_b32 m0, 17408
s_add_u32 s40, s26, 17408
buffer_load_dwordx4 v1, s[4:7], s40 offen lds
s_mov_b32 m0, 18432
s_add_u32 s40, s26, 18432
buffer_load_dwordx4 v1, s[4:7], s40 offen lds
s_mov_b32 m0, 19456
s_add_u32 s40, s26, 19456
buffer_load_dwordx4 v1, s[4:7], s40 offen lds
s_mov_b32 m0, 20480
s_add_u32 s40, s26, 20480
buffer_load_dwordx4 v1, s[4:7], s40 offen lds
s_mov_b32 m0, 43008
s_add_u32 s40, s27, 14336
buffer_load_dwordx4 v1, s[4:7], s40 offen lds
s_mov_b32 m0, 44032
s_add_u32 s40, s27, 15360
buffer_load_dwordx4 v1, s[4:7], s40 offen lds
s_mov_b32 m0, 45056
s_add_u32 s40, s27, 16384
buffer_load_dwordx4 v1, s[4:7], s40 offen lds
s_mov_b32 m0, 46080
s_add_u32 s40, s27, 17408
buffer_load_dwordx4 v1, s[4:7], s40 offen lds
s_mov_b32 m0, 47104
s_add_u32 s40, s27, 18432
buffer_load_dwordx4 v1, s[4:7], s40 offen lds
s_mov_b32 m0, 48128
s_add_u32 s40, s27, 19456
buffer_load_dwordx4 v1, s[4:7], s40 offen lds
s_mov_b32 m0, 49152
s_add_u32 s40, s27, 20480
buffer_load_dwordx4 v1, s[4:7], s40 offen lds
s_waitcnt vmcnt(0) lgkmcnt(0)
s_barrier
ds_read_b128 v[72:75], v1
ds_read_b128 v[76:79], v1 offset:14336
s_waitcnt lgkmcnt(0)
v_mfma_f32_16x16x32_bf16 v[16:19], a[0:3], v[72:75], 0
v_mfma_f32_16x16x32_bf16 v[44:47], a[0:3], v[76:79], 0
ds_read_b128 v[80:83], v1 offset:1024
ds_read_b128 v[84:87], v1 offset:15360
v_mfma_f32_16x16x32_bf16 v[20:23], a[56:59], v[72:75], 0
v_mfma_f32_16x16x32_bf16 v[48:51], a[56:59], v[76:79], 0
v_mfma_f32_16x16x32_bf16 v[24:27], a[112:115], v[72:75], 0
v_mfma_f32_16x16x32_bf16 v[52:55], a[112:115], v[76:79], 0
v_mfma_f32_16x16x32_bf16 v[28:31], a[168:171], v[72:75], 0
v_mfma_f32_16x16x32_bf16 v[56:59], a[168:171], v[76:79], 0
v_mfma_f32_16x16x32_bf16 v[32:35], a[224:227], v[72:75], 0
v_mfma_f32_16x16x32_bf16 v[60:63], a[224:227], v[76:79], 0
v_mfma_f32_16x16x32_bf16 v[36:39], v[144:147], v[72:75], 0
v_mfma_f32_16x16x32_bf16 v[64:67], v[144:147], v[76:79], 0
v_mfma_f32_16x16x32_bf16 v[40:43], v[200:203], v[72:75], 0
v_mfma_f32_16x16x32_bf16 v[68:71], v[200:203], v[76:79], 0
s_waitcnt lgkmcnt(0)
v_mfma_f32_16x16x32_bf16 v[16:19], a[4:7], v[80:83], v[16:19]
v_mfma_f32_16x16x32_bf16 v[44:47], a[4:7], v[84:87], v[44:47]
ds_read_b128 v[72:75], v1 offset:2048
ds_read_b128 v[76:79], v1 offset:16384
v_mfma_f32_16x16x32_bf16 v[20:23], a[60:63], v[80:83], v[20:23]
v_mfma_f32_16x16x32_bf16 v[48:51], a[60:63], v[84:87], v[48:51]
v_mfma_f32_16x16x32_bf16 v[24:27], a[116:119], v[80:83], v[24:27]
v_mfma_f32_16x16x32_bf16 v[52:55], a[116:119], v[84:87], v[52:55]
v_mfma_f32_16x16x32_bf16 v[28:31], a[172:175], v[80:83], v[28:31]
v_mfma_f32_16x16x32_bf16 v[56:59], a[172:175], v[84:87], v[56:59]
v_mfma_f32_16x16x32_bf16 v[32:35], a[228:231], v[80:83], v[32:35]
v_mfma_f32_16x16x32_bf16 v[60:63], a[228:231], v[84:87], v[60:63]
v_mfma_f32_16x16x32_bf16 v[36:39], v[148:151], v[80:83], v[36:39]
v_mfma_f32_16x16x32_bf16 v[64:67], v[148:151], v[84:87], v[64:67]
v_mfma_f32_16x16x32_bf16 v[40:43], v[204:207], v[80:83], v[40:43]
v_mfma_f32_16x16x32_bf16 v[68:71], v[204:207], v[84:87], v[68:71]
s_waitcnt lgkmcnt(0)
v_mfma_f32_16x16x32_bf16 v[16:19], a[8:11], v[72:75], v[16:19]
v_mfma_f32_16x16x32_bf16 v[44:47], a[8:11], v[76:79], v[44:47]
ds_read_b128 v[80:83], v1 offset:3072
ds_read_b128 v[84:87], v1 offset:17408
v_mfma_f32_16x16x32_bf16 v[20:23], a[64:67], v[72:75], v[20:23]
v_mfma_f32_16x16x32_bf16 v[48:51], a[64:67], v[76:79], v[48:51]
v_mfma_f32_16x16x32_bf16 v[24:27], a[120:123], v[72:75], v[24:27]
v_mfma_f32_16x16x32_bf16 v[52:55], a[120:123], v[76:79], v[52:55]
v_mfma_f32_16x16x32_bf16 v[28:31], a[176:179], v[72:75], v[28:31]
v_mfma_f32_16x16x32_bf16 v[56:59], a[176:179], v[76:79], v[56:59]
v_mfma_f32_16x16x32_bf16 v[32:35], a[232:235], v[72:75], v[32:35]
v_mfma_f32_16x16x32_bf16 v[60:63], a[232:235], v[76:79], v[60:63]
v_mfma_f32_16x16x32_bf16 v[36:39], v[152:155], v[72:75], v[36:39]
v_mfma_f32_16x16x32_bf16 v[64:67], v[152:155], v[76:79], v[64:67]
v_mfma_f32_16x16x32_bf16 v[40:43], v[208:211], v[72:75], v[40:43]
v_mfma_f32_16x16x32_bf16 v[68:71], v[208:211], v[76:79], v[68:71]
s_waitcnt lgkmcnt(0)
v_mfma_f32_16x16x32_bf16 v[16:19], a[12:15], v[80:83], v[16:19]
v_mfma_f32_16x16x32_bf16 v[44:47], a[12:15], v[84:87], v[44:47]
ds_read_b128 v[72:75], v1 offset:4096
ds_read_b128 v[76:79], v1 offset:18432
v_mfma_f32_16x16x32_bf16 v[20:23], a[68:71], v[80:83], v[20:23]
v_mfma_f32_16x16x32_bf16 v[48:51], a[68:71], v[84:87], v[48:51]
v_mfma_f32_16x16x32_bf16 v[24:27], a[124:127], v[80:83], v[24:27]
v_mfma_f32_16x16x32_bf16 v[52:55], a[124:127], v[84:87], v[52:55]
v_mfma_f32_16x16x32_bf16 v[28:31], a[180:183], v[80:83], v[28:31]
v_mfma_f32_16x16x32_bf16 v[56:59], a[180:183], v[84:87], v[56:59]
v_mfma_f32_16x16x32_bf16 v[32:35], a[236:239], v[80:83], v[32:35]
v_mfma_f32_16x16x32_bf16 v[60:63], a[236:239], v[84:87], v[60:63]
v_mfma_f32_16x16x32_bf16 v[36:39], v[156:159], v[80:83], v[36:39]
v_mfma_f32_16x16x32_bf16 v[64:67], v[156:159], v[84:87], v[64:67]
v_mfma_f32_16x16x32_bf16 v[40:43], v[212:215], v[80:83], v[40:43]
v_mfma_f32_16x16x32_bf16 v[68:71], v[212:215], v[84:87], v[68:71]
s_waitcnt lgkmcnt(0)
v_mfma_f32_16x16x32_bf16 v[16:19], a[16:19], v[72:75], v[16:19]
v_mfma_f32_16x16x32_bf16 v[44:47], a[16:19], v[76:79], v[44:47]
ds_read_b128 v[80:83], v1 offset:5120
ds_read_b128 v[84:87], v1 offset:19456
v_mfma_f32_16x16x32_bf16 v[20:23], a[72:75], v[72:75], v[20:23]
v_mfma_f32_16x16x32_bf16 v[48:51], a[72:75], v[76:79], v[48:51]
v_mfma_f32_16x16x32_bf16 v[24:27], a[128:131], v[72:75], v[24:27]
v_mfma_f32_16x16x32_bf16 v[52:55], a[128:131], v[76:79], v[52:55]
v_mfma_f32_16x16x32_bf16 v[28:31], a[184:187], v[72:75], v[28:31]
v_mfma_f32_16x16x32_bf16 v[56:59], a[184:187], v[76:79], v[56:59]
v_mfma_f32_16x16x32_bf16 v[32:35], a[240:243], v[72:75], v[32:35]
v_mfma_f32_16x16x32_bf16 v[60:63], a[240:243], v[76:79], v[60:63]
v_mfma_f32_16x16x32_bf16 v[36:39], v[160:163], v[72:75], v[36:39]
v_mfma_f32_16x16x32_bf16 v[64:67], v[160:163], v[76:79], v[64:67]
v_mfma_f32_16x16x32_bf16 v[40:43], v[216:219], v[72:75], v[40:43]
v_mfma_f32_16x16x32_bf16 v[68:71], v[216:219], v[76:79], v[68:71]
s_waitcnt lgkmcnt(0)
v_mfma_f32_16x16x32_bf16 v[16:19], a[20:23], v[80:83], v[16:19]
v_mfma_f32_16x16x32_bf16 v[44:47], a[20:23], v[84:87], v[44:47]
ds_read_b128 v[72:75], v1 offset:6144
ds_read_b128 v[76:79], v1 offset:20480
v_mfma_f32_16x16x32_bf16 v[20:23], a[76:79], v[80:83], v[20:23]
v_mfma_f32_16x16x32_bf16 v[48:51], a[76:79], v[84:87], v[48:51]
v_mfma_f32_16x16x32_bf16 v[24:27], a[132:135], v[80:83], v[24:27]
v_mfma_f32_16x16x32_bf16 v[52:55], a[132:135], v[84:87], v[52:55]
v_mfma_f32_16x16x32_bf16 v[28:31], a[188:191], v[80:83], v[28:31]
v_mfma_f32_16x16x32_bf16 v[56:59], a[188:191], v[84:87], v[56:59]
v_mfma_f32_16x16x32_bf16 v[32:35], a[244:247], v[80:83], v[32:35]
v_mfma_f32_16x16x32_bf16 v[60:63], a[244:247], v[84:87], v[60:63]
v_mfma_f32_16x16x32_bf16 v[36:39], v[164:167], v[80:83], v[36:39]
v_mfma_f32_16x16x32_bf16 v[64:67], v[164:167], v[84:87], v[64:67]
v_mfma_f32_16x16x32_bf16 v[40:43], v[220:223], v[80:83], v[40:43]
v_mfma_f32_16x16x32_bf16 v[68:71], v[220:223], v[84:87], v[68:71]
s_waitcnt lgkmcnt(0)
v_mfma_f32_16x16x32_bf16 v[16:19], a[24:27], v[72:75], v[16:19]
v_mfma_f32_16x16x32_bf16 v[44:47], a[24:27], v[76:79], v[44:47]
ds_read_b128 v[80:83], v1 offset:7168
ds_read_b128 v[84:87], v1 offset:21504
v_mfma_f32_16x16x32_bf16 v[20:23], a[80:83], v[72:75], v[20:23]
v_mfma_f32_16x16x32_bf16 v[48:51], a[80:83], v[76:79], v[48:51]
v_mfma_f32_16x16x32_bf16 v[24:27], a[136:139], v[72:75], v[24:27]
v_mfma_f32_16x16x32_bf16 v[52:55], a[136:139], v[76:79], v[52:55]
v_mfma_f32_16x16x32_bf16 v[28:31], a[192:195], v[72:75], v[28:31]
v_mfma_f32_16x16x32_bf16 v[56:59], a[192:195], v[76:79], v[56:59]
v_mfma_f32_16x16x32_bf16 v[32:35], a[248:251], v[72:75], v[32:35]
v_mfma_f32_16x16x32_bf16 v[60:63], a[248:251], v[76:79], v[60:63]
v_mfma_f32_16x16x32_bf16 v[36:39], v[168:171], v[72:75], v[36:39]
v_mfma_f32_16x16x32_bf16 v[64:67], v[168:171], v[76:79], v[64:67]
v_mfma_f32_16x16x32_bf16 v[40:43], v[224:227], v[72:75], v[40:43]
v_mfma_f32_16x16x32_bf16 v[68:71], v[224:227], v[76:79], v[68:71]
s_waitcnt lgkmcnt(0)
v_mfma_f32_16x16x32_bf16 v[16:19], a[28:31], v[80:83], v[16:19]
v_mfma_f32_16x16x32_bf16 v[44:47], a[28:31], v[84:87], v[44:47]
ds_read_b128 v[72:75], v1 offset:8192
ds_read_b128 v[76:79], v1 offset:22528
v_mfma_f32_16x16x32_bf16 v[20:23], a[84:87], v[80:83], v[20:23]
v_mfma_f32_16x16x32_bf16 v[48:51], a[84:87], v[84:87], v[48:51]
v_mfma_f32_16x16x32_bf16 v[24:27], a[140:143], v[80:83], v[24:27]
v_mfma_f32_16x16x32_bf16 v[52:55], a[140:143], v[84:87], v[52:55]
v_mfma_f32_16x16x32_bf16 v[28:31], a[196:199], v[80:83], v[28:31]
v_mfma_f32_16x16x32_bf16 v[56:59], a[196:199], v[84:87], v[56:59]
v_mfma_f32_16x16x32_bf16 v[32:35], a[252:255], v[80:83], v[32:35]
v_mfma_f32_16x16x32_bf16 v[60:63], a[252:255], v[84:87], v[60:63]
v_mfma_f32_16x16x32_bf16 v[36:39], v[172:175], v[80:83], v[36:39]
v_mfma_f32_16x16x32_bf16 v[64:67], v[172:175], v[84:87], v[64:67]
v_mfma_f32_16x16x32_bf16 v[40:43], v[228:231], v[80:83], v[40:43]
v_mfma_f32_16x16x32_bf16 v[68:71], v[228:231], v[84:87], v[68:71]
s_waitcnt lgkmcnt(0)
v_mfma_f32_16x16x32_bf16 v[16:19], a[32:35], v[72:75], v[16:19]
v_mfma_f32_16x16x32_bf16 v[44:47], a[32:35], v[76:79], v[44:47]
ds_read_b128 v[80:83], v1 offset:9216
ds_read_b128 v[84:87], v1 offset:23552
v_mfma_f32_16x16x32_bf16 v[20:23], a[88:91], v[72:75], v[20:23]
v_mfma_f32_16x16x32_bf16 v[48:51], a[88:91], v[76:79], v[48:51]
v_mfma_f32_16x16x32_bf16 v[24:27], a[144:147], v[72:75], v[24:27]
v_mfma_f32_16x16x32_bf16 v[52:55], a[144:147], v[76:79], v[52:55]
v_mfma_f32_16x16x32_bf16 v[28:31], a[200:203], v[72:75], v[28:31]
v_mfma_f32_16x16x32_bf16 v[56:59], a[200:203], v[76:79], v[56:59]
v_mfma_f32_16x16x32_bf16 v[32:35], v[120:123], v[72:75], v[32:35]
v_mfma_f32_16x16x32_bf16 v[60:63], v[120:123], v[76:79], v[60:63]
v_mfma_f32_16x16x32_bf16 v[36:39], v[176:179], v[72:75], v[36:39]
v_mfma_f32_16x16x32_bf16 v[64:67], v[176:179], v[76:79], v[64:67]
v_mfma_f32_16x16x32_bf16 v[40:43], v[232:235], v[72:75], v[40:43]
v_mfma_f32_16x16x32_bf16 v[68:71], v[232:235], v[76:79], v[68:71]
s_waitcnt lgkmcnt(0)
v_mfma_f32_16x16x32_bf16 v[16:19], a[36:39], v[80:83], v[16:19]
v_mfma_f32_16x16x32_bf16 v[44:47], a[36:39], v[84:87], v[44:47]
ds_read_b128 v[72:75], v1 offset:10240
ds_read_b128 v[76:79], v1 offset:24576
v_mfma_f32_16x16x32_bf16 v[20:23], a[92:95], v[80:83], v[20:23]
v_mfma_f32_16x16x32_bf16 v[48:51], a[92:95], v[84:87], v[48:51]
v_mfma_f32_16x16x32_bf16 v[24:27], a[148:151], v[80:83], v[24:27]
v_mfma_f32_16x16x32_bf16 v[52:55], a[148:151], v[84:87], v[52:55]
v_mfma_f32_16x16x32_bf16 v[28:31], a[204:207], v[80:83], v[28:31]
v_mfma_f32_16x16x32_bf16 v[56:59], a[204:207], v[84:87], v[56:59]
v_mfma_f32_16x16x32_bf16 v[32:35], v[124:127], v[80:83], v[32:35]
v_mfma_f32_16x16x32_bf16 v[60:63], v[124:127], v[84:87], v[60:63]
v_mfma_f32_16x16x32_bf16 v[36:39], v[180:183], v[80:83], v[36:39]
v_mfma_f32_16x16x32_bf16 v[64:67], v[180:183], v[84:87], v[64:67]
v_mfma_f32_16x16x32_bf16 v[40:43], v[236:239], v[80:83], v[40:43]
v_mfma_f32_16x16x32_bf16 v[68:71], v[236:239], v[84:87], v[68:71]
s_waitcnt lgkmcnt(0)
v_mfma_f32_16x16x32_bf16 v[16:19], a[40:43], v[72:75], v[16:19]
v_mfma_f32_16x16x32_bf16 v[44:47], a[40:43], v[76:79], v[44:47]
ds_read_b128 v[80:83], v1 offset:11264
ds_read_b128 v[84:87], v1 offset:25600
v_mfma_f32_16x16x32_bf16 v[20:23], a[96:99], v[72:75], v[20:23]
v_mfma_f32_16x16x32_bf16 v[48:51], a[96:99], v[76:79], v[48:51]
v_mfma_f32_16x16x32_bf16 v[24:27], a[152:155], v[72:75], v[24:27]
v_mfma_f32_16x16x32_bf16 v[52:55], a[152:155], v[76:79], v[52:55]
v_mfma_f32_16x16x32_bf16 v[28:31], a[208:211], v[72:75], v[28:31]
v_mfma_f32_16x16x32_bf16 v[56:59], a[208:211], v[76:79], v[56:59]
v_mfma_f32_16x16x32_bf16 v[32:35], v[128:131], v[72:75], v[32:35]
v_mfma_f32_16x16x32_bf16 v[60:63], v[128:131], v[76:79], v[60:63]
v_mfma_f32_16x16x32_bf16 v[36:39], v[184:187], v[72:75], v[36:39]
v_mfma_f32_16x16x32_bf16 v[64:67], v[184:187], v[76:79], v[64:67]
v_mfma_f32_16x16x32_bf16 v[40:43], v[240:243], v[72:75], v[40:43]
v_mfma_f32_16x16x32_bf16 v[68:71], v[240:243], v[76:79], v[68:71]
s_waitcnt lgkmcnt(0)
v_mfma_f32_16x16x32_bf16 v[16:19], a[44:47], v[80:83], v[16:19]
v_mfma_f32_16x16x32_bf16 v[44:47], a[44:47], v[84:87], v[44:47]
ds_read_b128 v[72:75], v1 offset:12288
ds_read_b128 v[76:79], v1 offset:26624
v_mfma_f32_16x16x32_bf16 v[20:23], a[100:103], v[80:83], v[20:23]
v_mfma_f32_16x16x32_bf16 v[48:51], a[100:103], v[84:87], v[48:51]
v_mfma_f32_16x16x32_bf16 v[24:27], a[156:159], v[80:83], v[24:27]
v_mfma_f32_16x16x32_bf16 v[52:55], a[156:159], v[84:87], v[52:55]
v_mfma_f32_16x16x32_bf16 v[28:31], a[212:215], v[80:83], v[28:31]
v_mfma_f32_16x16x32_bf16 v[56:59], a[212:215], v[84:87], v[56:59]
v_mfma_f32_16x16x32_bf16 v[32:35], v[132:135], v[80:83], v[32:35]
v_mfma_f32_16x16x32_bf16 v[60:63], v[132:135], v[84:87], v[60:63]
v_mfma_f32_16x16x32_bf16 v[36:39], v[188:191], v[80:83], v[36:39]
v_mfma_f32_16x16x32_bf16 v[64:67], v[188:191], v[84:87], v[64:67]
v_mfma_f32_16x16x32_bf16 v[40:43], v[244:247], v[80:83], v[40:43]
v_mfma_f32_16x16x32_bf16 v[68:71], v[244:247], v[84:87], v[68:71]
s_waitcnt lgkmcnt(0)
v_mfma_f32_16x16x32_bf16 v[16:19], a[48:51], v[72:75], v[16:19]
v_mfma_f32_16x16x32_bf16 v[44:47], a[48:51], v[76:79], v[44:47]
ds_read_b128 v[80:83], v1 offset:13312
ds_read_b128 v[84:87], v1 offset:27648
v_mfma_f32_16x16x32_bf16 v[20:23], a[104:107], v[72:75], v[20:23]
v_mfma_f32_16x16x32_bf16 v[48:51], a[104:107], v[76:79], v[48:51]
v_mfma_f32_16x16x32_bf16 v[24:27], a[160:163], v[72:75], v[24:27]
v_mfma_f32_16x16x32_bf16 v[52:55], a[160:163], v[76:79], v[52:55]
v_mfma_f32_16x16x32_bf16 v[28:31], a[216:219], v[72:75], v[28:31]
v_mfma_f32_16x16x32_bf16 v[56:59], a[216:219], v[76:79], v[56:59]
v_mfma_f32_16x16x32_bf16 v[32:35], v[136:139], v[72:75], v[32:35]
v_mfma_f32_16x16x32_bf16 v[60:63], v[136:139], v[76:79], v[60:63]
v_mfma_f32_16x16x32_bf16 v[36:39], v[192:195], v[72:75], v[36:39]
v_mfma_f32_16x16x32_bf16 v[64:67], v[192:195], v[76:79], v[64:67]
v_mfma_f32_16x16x32_bf16 v[40:43], v[248:251], v[72:75], v[40:43]
v_mfma_f32_16x16x32_bf16 v[68:71], v[248:251], v[76:79], v[68:71]
s_waitcnt lgkmcnt(0)
v_mfma_f32_16x16x32_bf16 v[16:19], a[52:55], v[80:83], v[16:19]
v_mfma_f32_16x16x32_bf16 v[44:47], a[52:55], v[84:87], v[44:47]
v_mfma_f32_16x16x32_bf16 v[20:23], a[108:111], v[80:83], v[20:23]
v_mfma_f32_16x16x32_bf16 v[48:51], a[108:111], v[84:87], v[48:51]
v_mfma_f32_16x16x32_bf16 v[24:27], a[164:167], v[80:83], v[24:27]
v_mfma_f32_16x16x32_bf16 v[52:55], a[164:167], v[84:87], v[52:55]
v_mfma_f32_16x16x32_bf16 v[28:31], a[220:223], v[80:83], v[28:31]
v_mfma_f32_16x16x32_bf16 v[56:59], a[220:223], v[84:87], v[56:59]
v_mfma_f32_16x16x32_bf16 v[32:35], v[140:143], v[80:83], v[32:35]
v_mfma_f32_16x16x32_bf16 v[60:63], v[140:143], v[84:87], v[60:63]
v_mfma_f32_16x16x32_bf16 v[36:39], v[196:199], v[80:83], v[36:39]
v_mfma_f32_16x16x32_bf16 v[64:67], v[196:199], v[84:87], v[64:67]
v_mfma_f32_16x16x32_bf16 v[40:43], v[252:255], v[80:83], v[40:43]
v_mfma_f32_16x16x32_bf16 v[68:71], v[252:255], v[84:87], v[68:71]
s_nop 1
v_cvt_pk_bf16_f32 v88, v16, v17
v_cvt_pk_bf16_f32 v89, v18, v19
v_cvt_pk_bf16_f32 v104, v44, v45
v_cvt_pk_bf16_f32 v105, v46, v47
v_cvt_pk_bf16_f32 v90, v20, v21
v_cvt_pk_bf16_f32 v91, v22, v23
v_cvt_pk_bf16_f32 v106, v48, v49
v_cvt_pk_bf16_f32 v107, v50, v51
v_cvt_pk_bf16_f32 v92, v24, v25
v_cvt_pk_bf16_f32 v93, v26, v27
v_cvt_pk_bf16_f32 v108, v52, v53
v_cvt_pk_bf16_f32 v109, v54, v55
v_cvt_pk_bf16_f32 v94, v28, v29
v_cvt_pk_bf16_f32 v95, v30, v31
v_cvt_pk_bf16_f32 v110, v56, v57
v_cvt_pk_bf16_f32 v111, v58, v59
v_cvt_pk_bf16_f32 v96, v32, v33
v_cvt_pk_bf16_f32 v97, v34, v35
v_cvt_pk_bf16_f32 v112, v60, v61
v_cvt_pk_bf16_f32 v113, v62, v63
v_cvt_pk_bf16_f32 v98, v36, v37
v_cvt_pk_bf16_f32 v99, v38, v39
v_cvt_pk_bf16_f32 v114, v64, v65
v_cvt_pk_bf16_f32 v115, v66, v67
v_cvt_pk_bf16_f32 v100, v40, v41
v_cvt_pk_bf16_f32 v101, v42, v43
v_cvt_pk_bf16_f32 v116, v68, v69
v_cvt_pk_bf16_f32 v117, v70, v71
ds_read_b64 v[16:17], v2
ds_read_b64 v[18:19], v2 offset:512
ds_read_b64 v[20:21], v2 offset:14336
ds_read_b64 v[22:23], v2 offset:14848
ds_read_b64 v[24:25], v2 offset:1024
ds_read_b64 v[26:27], v2 offset:1536
ds_read_b64 v[28:29], v2 offset:15360
ds_read_b64 v[30:31], v2 offset:15872
s_waitcnt lgkmcnt(4)
v_mfma_f32_16x16x32_bf16 v[32:35], v[16:19], v[88:91], 0
v_mfma_f32_16x16x32_bf16 v[36:39], v[16:19], v[104:107], 0
v_mfma_f32_16x16x32_bf16 v[40:43], v[20:23], v[104:107], 0
ds_read_b64 v[16:17], v2 offset:2048
ds_read_b64 v[18:19], v2 offset:2560
ds_read_b64 v[20:21], v2 offset:16384
ds_read_b64 v[22:23], v2 offset:16896
s_waitcnt lgkmcnt(4)
v_mfma_f32_16x16x32_bf16 v[32:35], v[24:27], v[92:95], v[32:35]
v_mfma_f32_16x16x32_bf16 v[36:39], v[24:27], v[108:111], v[36:39]
v_mfma_f32_16x16x32_bf16 v[40:43], v[28:31], v[108:111], v[40:43]
ds_read_b64 v[24:25], v2 offset:3072
ds_read_b64 v[26:27], v2 offset:3584
ds_read_b64 v[28:29], v2 offset:17408
ds_read_b64 v[30:31], v2 offset:17920
s_waitcnt lgkmcnt(4)
v_mfma_f32_16x16x32_bf16 v[32:35], v[16:19], v[96:99], v[32:35]
v_mfma_f32_16x16x32_bf16 v[36:39], v[16:19], v[112:115], v[36:39]
v_mfma_f32_16x16x32_bf16 v[40:43], v[20:23], v[112:115], v[40:43]
s_waitcnt lgkmcnt(0)
v_mfma_f32_16x16x32_bf16 v[32:35], v[24:27], v[100:103], v[32:35]
v_mfma_f32_16x16x32_bf16 v[36:39], v[24:27], v[116:119], v[36:39]
v_mfma_f32_16x16x32_bf16 v[40:43], v[28:31], v[116:119], v[40:43]
v_mov_b32 v66, 0
v_mov_b32 v67, 0
s_nop 5
ds_write_b128 v4, v[32:35]
ds_write_b128 v4, v[36:39] offset:2304
ds_write_b128 v4, v[40:43] offset:2368
s_waitcnt lgkmcnt(0)
s_barrier
ds_read_b128 v[16:19], v5
ds_read_b128 v[20:23], v5 offset:4608
ds_read_b128 v[24:27], v5 offset:9216
ds_read_b128 v[28:31], v5 offset:13824
s_waitcnt lgkmcnt(0)
v_add_f32 v16, v16, v20
v_add_f32 v24, v24, v28
v_add_f32 v16, v16, v24
v_mov_b32 v68, s47
v_cndmask_b32 v68, v68, v16, s[32:33]
v_add_f32 v17, v17, v21
v_add_f32 v25, v25, v29
v_add_f32 v17, v17, v25
v_mov_b32 v69, s47
v_cndmask_b32 v69, v69, v17, s[34:35]
v_add_f32 v18, v18, v22
v_add_f32 v26, v26, v30
v_add_f32 v18, v18, v26
v_mov_b32 v70, s47
v_cndmask_b32 v70, v70, v18, s[36:37]
v_add_f32 v19, v19, v23
v_add_f32 v27, v27, v31
v_add_f32 v19, v19, v27
v_mov_b32 v71, s47
v_cndmask_b32 v71, v71, v19, s[38:39]
v_max3_f32 v32, v68, v69, v70
v_max_f32 v32, v32, v71
buffer_load_dwordx2 v[52:53], v3, s[4:7], s28 offen sc1
buffer_load_dwordx2 v[54:55], v3, s[4:7], s28 offen offset:256 sc1
buffer_load_dwordx2 v[56:57], v3, s[4:7], s28 offen offset:512 sc1
buffer_load_dwordx2 v[58:59], v3, s[4:7], s28 offen offset:768 sc1
buffer_load_dwordx2 v[60:61], v3, s[4:7], s28 offen offset:1024 sc1
buffer_load_dwordx2 v[62:63], v3, s[4:7], s28 offen offset:1280 sc1
buffer_load_dwordx2 v[64:65], v3, s[4:7], s28 offen offset:1536 sc1
s_sleep 6
Lspin_180:
buffer_load_dwordx2 v[52:53], v3, s[4:7], s28 offen sc1
buffer_load_dwordx2 v[54:55], v3, s[4:7], s28 offen offset:256 sc1
buffer_load_dwordx2 v[56:57], v3, s[4:7], s28 offen offset:512 sc1
buffer_load_dwordx2 v[58:59], v3, s[4:7], s28 offen offset:768 sc1
buffer_load_dwordx2 v[60:61], v3, s[4:7], s28 offen offset:1024 sc1
buffer_load_dwordx2 v[62:63], v3, s[4:7], s28 offen offset:1280 sc1
buffer_load_dwordx2 v[64:65], v3, s[4:7], s28 offen offset:1536 sc1
s_sub_u32 s24, s24, 1
s_cbranch_scc1 CODE_END
s_waitcnt vmcnt(7)
v_max3_u32 v10, v52, v53, v54
v_max3_u32 v10, v10, v55, v56
v_max3_u32 v10, v10, v57, v58
v_max3_u32 v10, v10, v59, v60
v_max3_u32 v10, v10, v61, v62
v_max3_u32 v10, v10, v63, v64
v_max_u32 v10, v10, v65
v_cmp_eq_u32 vcc, -1, v10
s_cbranch_vccz Lspin_180x
s_cmp_ge_u32 s25, 58
s_cbranch_scc1 Lspin_180
s_sleep 8
s_branch Lspin_180
Lspin_180x:
v_mfma_f32_16x16x32_bf16 v[44:47], v[52:55], v[88:91], 0
v_mfma_f32_16x16x32_bf16 v[48:51], v[52:55], v[104:107], 0
v_mfma_f32_16x16x32_bf16 v[44:47], v[56:59], v[92:95], v[44:47]
v_mfma_f32_16x16x32_bf16 v[48:51], v[56:59], v[108:111], v[48:51]
v_mfma_f32_16x16x32_bf16 v[44:47], v[60:63], v[96:99], v[44:47]
v_mfma_f32_16x16x32_bf16 v[48:51], v[60:63], v[112:115], v[48:51]
v_mfma_f32_16x16x32_bf16 v[44:47], v[64:67], v[100:103], v[44:47]
v_mfma_f32_16x16x32_bf16 v[48:51], v[64:67], v[116:119], v[48:51]
s_nop 6
ds_write_b128 v6, v[44:47]
ds_write_b128 v6, v[48:51] offset:2304
s_waitcnt lgkmcnt(0)
s_barrier
ds_read2_b32 v[20:21], v7 offset0:0 offset1:8
ds_read2_b32 v[22:23], v7 offset0:16 offset1:24
s_waitcnt lgkmcnt(0)
v_pk_add_f32 v[20:21], v[20:21], v[22:23]
v_add_f32 v17, v20, v21
v_max_f32 v16, v32, v17
s_nop 1
v_max_f32_dpp v16, v16, v16 quad_perm:[1,0,3,2] row_mask:0xf bank_mask:0xf
s_nop 1
v_max_f32_dpp v16, v16, v16 quad_perm:[2,3,0,1] row_mask:0xf bank_mask:0xf
s_nop 1
v_max_f32_dpp v16, v16, v16 row_half_mirror row_mask:0xf bank_mask:0xf
v_sub_f32 v17, v17, v16
v_sub_f32 v68, v68, v16
v_sub_f32 v69, v69, v16
v_sub_f32 v70, v70, v16
v_sub_f32 v71, v71, v16
v_exp_f32 v17, v17
v_exp_f32 v68, v68
v_exp_f32 v69, v69
v_exp_f32 v70, v70
v_exp_f32 v71, v71
v_add_f32 v16, v17, v68
v_add_f32 v18, v69, v70
v_add_f32 v16, v16, v71
v_add_f32 v16, v16, v18
v_mov_b32_dpp v18, v17 quad_perm:[1,0,3,2] row_mask:0xf bank_mask:0xf
s_nop 1
v_add_f32_dpp v16, v16, v16 quad_perm:[1,0,3,2] row_mask:0xf bank_mask:0xf
s_nop 1
v_add_f32_dpp v16, v16, v16 quad_perm:[2,3,0,1] row_mask:0xf bank_mask:0xf
s_nop 1
v_add_f32_dpp v16, v16, v16 row_half_mirror row_mask:0xf bank_mask:0xf
v_rcp_f32 v16, v16
s_cmp_lg_u32 s23, 0
v_mul_f32 v68, v68, v16 clamp
v_mul_f32 v69, v69, v16 clamp
v_mul_f32 v70, v70, v16 clamp
v_mul_f32 v71, v71, v16 clamp
v_mul_f32 v17, v17, v16 clamp
v_mul_f32 v18, v18, v16 clamp
v_cvt_pk_bf16_f32 v68, v68, v69
v_cvt_pk_bf16_f32 v70, v70, v71
v_cvt_pk_bf16_f32 v17, v17, v18
s_cbranch_scc1 Lwt_181
buffer_store_dword v68, v8, s[4:7], s29 offen
buffer_store_dword v70, v8, s[4:7], s29 offen offset:8
buffer_store_dword v17, v9, s[4:7], s30 offen
s_branch Lst_182
Lwt_181:
buffer_store_dword v68, v8, s[4:7], s29 offen sc1
buffer_store_dword v70, v8, s[4:7], s29 offen offset:8 sc1
buffer_store_dword v17, v9, s[4:7], s30 offen sc1
Lst_182:
s_add_u32 s26, s26, 114688
s_add_u32 s27, s27, 114688
s_add_u32 s28, s28, 28672
s_add_u32 s29, s29, 163840
s_add_u32 s30, s30, 163840
s_add_u32 s25, s25, 4
s_cmp_lt_u32 s25, 64
s_cbranch_scc1 TA_SEG2
s_endpgm
TA_W3:
v_lshlrev_b32 v1, 4, v0
s_cmp_lt_u32 s21, 2
s_cselect_b32 s42, 0, 4
s_add_u32 s42, s42, s21
s_lshl_b32 s40, s42, 7
s_add_u32 s40, s40, 139264
s_branch Lfirst_184
Lflag_183:
v_cmp_ne_u32 vcc, s88, v10
s_cbranch_vccz Lset_185
s_sleep 16
Lfirst_184:
buffer_load_dword v10, off, s[4:7], s40 sc1
s_waitcnt vmcnt(0)
s_sub_u32 s24, s24, 1
s_cbranch_scc0 Lflag_183
s_endpgm
Lset_185:
v_min_u32 v12, 55, v0
v_and_b32 v10, 3, v12
v_lshlrev_b32 v10, 3, v10
v_lshrrev_b32 v12, 2, v12
v_lshl_add_u32 v10, v12, 7, v10
s_mov_b32 s43, 4352
Llz_186:
buffer_load_dwordx2 v[12:13], v10, s[4:7], s43 offen sc1
s_waitcnt vmcnt(0)
v_cmp_ne_u32 vcc, s88, v12
v_cmp_ne_u32 s[40:41], s88, v13
s_or_b64 vcc, vcc, s[40:41]
s_cbranch_vccz Llzok_187
s_sleep 8
s_sub_u32 s24, s24, 1
s_cbranch_scc0 Llz_186
s_endpgm
Llzok_187:
s_mul_i32 s40, s21, 7168
s_add_u32 s40, s40, 656384
Lstp_188:
buffer_load_dword v10, off, s[4:7], s40 sc1
s_waitcnt vmcnt(0)
v_cmp_eq_u32 vcc, -1, v10
s_cbranch_vccz Lstpok_189
s_sleep 16
s_sub_u32 s24, s24, 1
s_cbranch_scc0 Lstp_188
s_endpgm
Lstpok_189:
v_min_u32 v10, 6, v0
v_lshlrev_b32 v10, 2, v10
s_lshl_b32 s40, s22, 7
s_branch Lfirst_191
Lflag_190:
v_cmp_ne_u32 vcc, s88, v11
s_cbranch_vccz Lset_192
s_sleep 4
Lfirst_191:
buffer_load_dword v11, v10, s[4:7], s40 offen sc1
s_waitcnt vmcnt(0)
s_sub_u32 s24, s24, 1
s_cbranch_scc0 Lflag_190
s_endpgm
Lset_192:
s_mul_i32 s40, s22, 401408
s_add_u32 s40, s40, 10180608
buffer_load_dwordx4 a[0:3], v1, s[4:7], s40 offen
buffer_load_dwordx4 a[4:7], v1, s[4:7], s40 offen offset:1024
buffer_load_dwordx4 a[8:11], v1, s[4:7], s40 offen offset:2048
buffer_load_dwordx4 a[12:15], v1, s[4:7], s40 offen offset:3072
s_add_u32 s40, s40, 4096
buffer_load_dwordx4 a[16:19], v1, s[4:7], s40 offen
buffer_load_dwordx4 a[20:23], v1, s[4:7], s40 offen offset:1024
buffer_load_dwordx4 a[24:27], v1, s[4:7], s40 offen offset:2048
buffer_load_dwordx4 a[28:31], v1, s[4:7], s40 offen offset:3072
s_add_u32 s40, s40, 4096
buffer_load_dwordx4 a[32:35], v1, s[4:7], s40 offen
buffer_load_dwordx4 a[36:39], v1, s[4:7], s40 offen offset:1024
buffer_load_dwordx4 a[40:43], v1, s[4:7], s40 offen offset:2048
buffer_load_dwordx4 a[44:47], v1, s[4:7], s40 offen offset:3072
s_add_u32 s40, s40, 4096
buffer_load_dwordx4 a[48:51], v1, s[4:7], s40 offen
buffer_load_dwordx4 a[52:55], v1, s[4:7], s40 offen offset:1024
buffer_load_dwordx4 a[56:59], v1, s[4:7], s40 offen offset:2048
buffer_load_dwordx4 a[60:63], v1, s[4:7], s40 offen offset:3072
s_add_u32 s40, s40, 4096
buffer_load_dwordx4 a[64:67], v1, s[4:7], s40 offen
buffer_load_dwordx4 a[68:71], v1, s[4:7], s40 offen offset:1024
buffer_load_dwordx4 a[72:75], v1, s[4:7], s40 offen offset:2048
buffer_load_dwordx4 a[76:79], v1, s[4:7], s40 offen offset:3072
s_add_u32 s40, s40, 4096
buffer_load_dwordx4 a[80:83], v1, s[4:7], s40 offen
buffer_load_dwordx4 a[84:87], v1, s[4:7], s40 offen offset:1024
buffer_load_dwordx4 a[88:91], v1, s[4:7], s40 offen offset:2048
buffer_load_dwordx4 a[92:95], v1, s[4:7], s40 offen offset:3072
s_add_u32 s40, s40, 4096
buffer_load_dwordx4 a[96:99], v1, s[4:7], s40 offen
buffer_load_dwordx4 a[100:103], v1, s[4:7], s40 offen offset:1024
buffer_load_dwordx4 a[104:107], v1, s[4:7], s40 offen offset:2048
buffer_load_dwordx4 a[108:111], v1, s[4:7], s40 offen offset:3072
s_add_u32 s40, s40, 4096
buffer_load_dwordx4 a[112:115], v1, s[4:7], s40 offen
buffer_load_dwordx4 a[116:119], v1, s[4:7], s40 offen offset:1024
buffer_load_dwordx4 a[120:123], v1, s[4:7], s40 offen offset:2048
buffer_load_dwordx4 a[124:127], v1, s[4:7], s40 offen offset:3072
s_add_u32 s40, s40, 4096
buffer_load_dwordx4 a[128:131], v1, s[4:7], s40 offen
buffer_load_dwordx4 a[132:135], v1, s[4:7], s40 offen offset:1024
buffer_load_dwordx4 a[136:139], v1, s[4:7], s40 offen offset:2048
buffer_load_dwordx4 a[140:143], v1, s[4:7], s40 offen offset:3072
s_add_u32 s40, s40, 4096
buffer_load_dwordx4 a[144:147], v1, s[4:7], s40 offen
buffer_load_dwordx4 a[148:151], v1, s[4:7], s40 offen offset:1024
buffer_load_dwordx4 a[152:155], v1, s[4:7], s40 offen offset:2048
buffer_load_dwordx4 a[156:159], v1, s[4:7], s40 offen offset:3072
s_add_u32 s40, s40, 4096
buffer_load_dwordx4 a[160:163], v1, s[4:7], s40 offen
buffer_load_dwordx4 a[164:167], v1, s[4:7], s40 offen offset:1024
buffer_load_dwordx4 a[168:171], v1, s[4:7], s40 offen offset:2048
buffer_load_dwordx4 a[172:175], v1, s[4:7], s40 offen offset:3072
s_add_u32 s40, s40, 4096
buffer_load_dwordx4 a[176:179], v1, s[4:7], s40 offen
buffer_load_dwordx4 a[180:183], v1, s[4:7], s40 offen offset:1024
buffer_load_dwordx4 a[184:187], v1, s[4:7], s40 offen offset:2048
buffer_load_dwordx4 a[188:191], v1, s[4:7], s40 offen offset:3072
s_add_u32 s40, s40, 4096
s_waitcnt vmcnt(40)
buffer_load_dwordx4 a[192:195], v1, s[4:7], s40 offen
buffer_load_dwordx4 a[196:199], v1, s[4:7], s40 offen offset:1024
buffer_load_dwordx4 a[200:203], v1, s[4:7], s40 offen offset:2048
buffer_load_dwordx4 a[204:207], v1, s[4:7], s40 offen offset:3072
s_add_u32 s40, s40, 4096
buffer_load_dwordx4 a[208:211], v1, s[4:7], s40 offen
buffer_load_dwordx4 a[212:215], v1, s[4:7], s40 offen offset:1024
buffer_load_dwordx4 a[216:219], v1, s[4:7], s40 offen offset:2048
buffer_load_dwordx4 a[220:223], v1, s[4:7], s40 offen offset:3072
s_add_u32 s40, s40, 4096
s_waitcnt vmcnt(40)
buffer_load_dwordx4 a[224:227], v1, s[4:7], s40 offen
buffer_load_dwordx4 a[228:231], v1, s[4:7], s40 offen offset:1024
buffer_load_dwordx4 a[232:235], v1, s[4:7], s40 offen offset:2048
buffer_load_dwordx4 a[236:239], v1, s[4:7], s40 offen offset:3072
s_add_u32 s40, s40, 4096
buffer_load_dwordx4 a[240:243], v1, s[4:7], s40 offen
buffer_load_dwordx4 a[244:247], v1, s[4:7], s40 offen offset:1024
buffer_load_dwordx4 a[248:251], v1, s[4:7], s40 offen offset:2048
buffer_load_dwordx4 a[252:255], v1, s[4:7], s40 offen offset:3072
s_add_u32 s40, s40, 4096
s_waitcnt vmcnt(40)
buffer_load_dwordx4 v[120:123], v1, s[4:7], s40 offen
buffer_load_dwordx4 v[124:127], v1, s[4:7], s40 offen offset:1024
buffer_load_dwordx4 v[128:131], v1, s[4:7], s40 offen offset:2048
buffer_load_dwordx4 v[132:135], v1, s[4:7], s40 offen offset:3072
s_add_u32 s40, s40, 4096
buffer_load_dwordx4 v[136:139], v1, s[4:7], s40 offen
buffer_load_dwordx4 v[140:143], v1, s[4:7], s40 offen offset:1024
buffer_load_dwordx4 v[144:147], v1, s[4:7], s40 offen offset:2048
buffer_load_dwordx4 v[148:151], v1, s[4:7], s40 offen offset:3072
s_add_u32 s40, s40, 4096
s_waitcnt vmcnt(40)
buffer_load_dwordx4 v[152:155], v1, s[4:7], s40 offen
buffer_load_dwordx4 v[156:159], v1, s[4:7], s40 offen offset:1024
buffer_load_dwordx4 v[160:163], v1, s[4:7], s40 offen offset:2048
buffer_load_dwordx4 v[164:167], v1, s[4:7], s40 offen offset:3072
s_add_u32 s40, s40, 4096
buffer_load_dwordx4 v[168:171], v1, s[4:7], s40 offen
buffer_load_dwordx4 v[172:175], v1, s[4:7], s40 offen offset:1024
buffer_load_dwordx4 v[176:179], v1, s[4:7], s40 offen offset:2048
buffer_load_dwordx4 v[180:183], v1, s[4:7], s40 offen offset:3072
s_add_u32 s40, s40, 4096
s_waitcnt vmcnt(40)
buffer_load_dwordx4 v[184:187], v1, s[4:7], s40 offen
buffer_load_dwordx4 v[188:191], v1, s[4:7], s40 offen offset:1024
buffer_load_dwordx4 v[192:195], v1, s[4:7], s40 offen offset:2048
buffer_load_dwordx4 v[196:199], v1, s[4:7], s40 offen offset:3072
s_add_u32 s40, s40, 4096
buffer_load_dwordx4 v[200:203], v1, s[4:7], s40 offen
buffer_load_dwordx4 v[204:207], v1, s[4:7], s40 offen offset:1024
buffer_load_dwordx4 v[208:211], v1, s[4:7], s40 offen offset:2048
buffer_load_dwordx4 v[212:215], v1, s[4:7], s40 offen offset:3072
s_add_u32 s40, s40, 4096
s_waitcnt vmcnt(40)
buffer_load_dwordx4 v[216:219], v1, s[4:7], s40 offen
buffer_load_dwordx4 v[220:223], v1, s[4:7], s40 offen offset:1024
buffer_load_dwordx4 v[224:227], v1, s[4:7], s40 offen offset:2048
buffer_load_dwordx4 v[228:231], v1, s[4:7], s40 offen offset:3072
s_add_u32 s40, s40, 4096
buffer_load_dwordx4 v[232:235], v1, s[4:7], s40 offen
buffer_load_dwordx4 v[236:239], v1, s[4:7], s40 offen offset:1024
buffer_load_dwordx4 v[240:243], v1, s[4:7], s40 offen offset:2048
buffer_load_dwordx4 v[244:247], v1, s[4:7], s40 offen offset:3072
s_add_u32 s40, s40, 4096
s_waitcnt vmcnt(40)
buffer_load_dwordx4 v[248:251], v1, s[4:7], s40 offen
buffer_load_dwordx4 v[252:255], v1, s[4:7], s40 offen offset:1024
v_and_b32 v10, 15, v0
v_lshrrev_b32 v11, 4, v0
v_lshrrev_b32 v3, 5, v0
v_add_u32 v3, 42, v3
v_lshrrev_b32 v2, 2, v3
v_lshlrev_b32 v2, 10, v2
v_and_b32 v4, 3, v3
v_lshl_add_u32 v2, v4, 8, v2
v_lshl_add_u32 v2, v10, 4, v2
v_and_b32 v4, 1, v11
v_lshl_add_u32 v2, v4, 3, v2
v_add_u32 v2, 28672, v2
v_lshlrev_b32 v3, 7, v3
v_lshl_add_u32 v3, v4, 3, v3
v_and_b32 v5, 7, v0
v_lshl_add_u32 v3, v5, 4, v3
v_mul_u32_u24 v6, 144, v10
v_lshl_add_u32 v7, v11, 4, v6
v_lshl_add_u32 v6, v4, 4, v6
v_add_u32 v4, 72192, v7
v_add_u32 v6, 76896, v6
v_lshrrev_b32 v10, 3, v0
v_add_u32 v10, 24, v10
v_and_b32 v11, 7, v0
v_mul_u32_u24 v7, 144, v10
v_lshl_add_u32 v5, v11, 4, v7
v_add_u32 v5, 58368, v5
v_lshl_add_u32 v7, v11, 2, v7
v_add_u32 v7, 76800, v7
v_lshlrev_b32 v8, 2, v11
v_sub_u32 v8, v10, v8
v_cmp_le_i32 s[32:33], 0, v8
v_cmp_le_i32 s[34:35], 1, v8
v_cmp_le_i32 s[36:37], 2, v8
v_cmp_le_i32 s[38:39], 3, v8
v_and_b32 v10, 15, v10
v_lshlrev_b32 v10, 4, v10
v_bfe_u32 v9, v0, 1, 1
v_lshl_add_u32 v10, v9, 2, v10
v_bfe_u32 v11, v0, 2, 1
v_lshl_add_u32 v9, v11, 8, v10
v_lshl_add_u32 v8, v11, 9, v10
v_and_b32 v11, 1, v0
v_lshl_add_u32 v8, v11, 8, v8
v_lshlrev_b32 v11, 30, v11
v_or_b32 v9, v9, v11
v_mov_b32 v10, 0
v_lshlrev_b32 v11, 2, v0
ds_write_b32 v11, v10 offset:58112
v_mov_b32 v102, 0
v_mov_b32 v103, 0
v_mov_b32 v118, 0
v_mov_b32 v119, 0
s_mul_i32 s26, s21, 28672
s_add_u32 s27, s26, 6205440
s_add_u32 s26, s26, 8044544
s_mul_i32 s28, s21, 7168
s_add_u32 s28, s28, 634880
s_mul_i32 s29, s21, 40960
s_add_u32 s29, s29, 1748992
s_lshr_b32 s30, s22, 1
s_lshl_b32 s30, s30, 10
s_and_b32 s40, s22, 1
s_lshl_b32 s40, s40, 3
s_add_u32 s30, s30, s40
s_add_u32 s30, s30, s29
s_add_u32 s30, s30, 33280
s_lshl_b32 s40, s22, 11
s_add_u32 s29, s29, s40
s_add_u32 s29, s29, 1024
s_mov_b32 s47, 0xceabfb8f
s_mov_b32 s25, s21
v_min_u32 v12, 55, v0
v_and_b32 v10, 3, v12
v_lshlrev_b32 v10, 3, v10
v_lshrrev_b32 v12, 2, v12
v_lshl_add_u32 v10, v12, 7, v10
s_mov_b32 s43, 4352
Llz_193:
buffer_load_dwordx2 v[12:13], v10, s[4:7], s43 offen sc1
s_waitcnt vmcnt(0)
v_cmp_ne_u32 vcc, s88, v12
v_cmp_ne_u32 s[40:41], s88, v13
s_or_b64 vcc, vcc, s[40:41]
s_cbranch_vccz Llzok_194
s_sleep 8
s_sub_u32 s24, s24, 1
s_cbranch_scc0 Llz_193
s_endpgm
Llzok_194:
v_min_u32 v12, 47, v0
v_and_b32 v10, 3, v12
v_lshlrev_b32 v10, 3, v10
v_lshrrev_b32 v12, 2, v12
v_lshl_add_u32 v10, v12, 7, v10
s_mov_b32 s43, 6144
Llz_195:
buffer_load_dwordx2 v[12:13], v10, s[4:7], s43 offen sc1
s_waitcnt vmcnt(0)
v_cmp_ne_u32 vcc, s88, v12
v_cmp_ne_u32 s[40:41], s88, v13
s_or_b64 vcc, vcc, s[40:41]
s_cbranch_vccz Llzok_196
s_sleep 8
s_sub_u32 s24, s24, 1
s_cbranch_scc0 Llz_195
s_endpgm
Llzok_196:
TA_SEG3:
s_mov_b32 m0, 21504
s_add_u32 s40, s26, 21504
buffer_load_dwordx4 v1, s[4:7], s40 offen lds
s_mov_b32 m0, 22528
s_add_u32 s40, s26, 22528
buffer_load_dwordx4 v1, s[4:7], s40 offen lds
s_mov_b32 m0, 23552
s_add_u32 s40, s26, 23552
buffer_load_dwordx4 v1, s[4:7], s40 offen lds
s_mov_b32 m0, 24576
s_add_u32 s40, s26, 24576
buffer_load_dwordx4 v1, s[4:7], s40 offen lds
s_mov_b32 m0, 25600
s_add_u32 s40, s26, 25600
buffer_load_dwordx4 v1, s[4:7], s40 offen lds
s_mov_b32 m0, 26624
s_add_u32 s40, s26, 26624
buffer_load_dwordx4 v1, s[4:7], s40 offen lds
s_mov_b32 m0, 27648
s_add_u32 s40, s26, 27648
buffer_load_dwordx4 v1, s[4:7], s40 offen lds
s_mov_b32 m0, 50176
s_add_u32 s40, s27, 21504
buffer_load_dwordx4 v1, s[4:7], s40 offen lds
s_mov_b32 m0, 51200
s_add_u32 s40, s27, 22528
buffer_load_dwordx4 v1, s[4:7], s40 offen lds
s_mov_b32 m0, 52224
s_add_u32 s40, s27, 23552
buffer_load_dwordx4 v1, s[4:7], s40 offen lds
s_mov_b32 m0, 53248
s_add_u32 s40, s27, 24576
buffer_load_dwordx4 v1, s[4:7], s40 offen lds
s_mov_b32 m0, 54272
s_add_u32 s40, s27, 25600
buffer_load_dwordx4 v1, s[4:7], s40 offen lds
s_mov_b32 m0, 55296
s_add_u32 s40, s27, 26624
buffer_load_dwordx4 v1, s[4:7], s40 offen lds
s_mov_b32 m0, 56320
s_add_u32 s40, s27, 27648
buffer_load_dwordx4 v1, s[4:7], s40 offen lds
s_waitcnt vmcnt(0) lgkmcnt(0)
s_barrier
ds_read_b128 v[72:75], v1
ds_read_b128 v[76:79], v1 offset:14336
s_waitcnt lgkmcnt(0)
v_mfma_f32_16x16x32_bf16 v[16:19], a[0:3], v[72:75], 0
v_mfma_f32_16x16x32_bf16 v[44:47], a[0:3], v[76:79], 0
ds_read_b128 v[80:83], v1 offset:1024
ds_read_b128 v[84:87], v1 offset:15360
v_mfma_f32_16x16x32_bf16 v[20:23], a[56:59], v[72:75], 0
v_mfma_f32_16x16x32_bf16 v[48:51], a[56:59], v[76:79], 0
v_mfma_f32_16x16x32_bf16 v[24:27], a[112:115], v[72:75], 0
v_mfma_f32_16x16x32_bf16 v[52:55], a[112:115], v[76:79], 0
v_mfma_f32_16x16x32_bf16 v[28:31], a[168:171], v[72:75], 0
v_mfma_f32_16x16x32_bf16 v[56:59], a[168:171], v[76:79], 0
v_mfma_f32_16x16x32_bf16 v[32:35], a[224:227], v[72:75], 0
v_mfma_f32_16x16x32_bf16 v[60:63], a[224:227], v[76:79], 0
v_mfma_f32_16x16x32_bf16 v[36:39], v[144:147], v[72:75], 0
v_mfma_f32_16x16x32_bf16 v[64:67], v[144:147], v[76:79], 0
v_mfma_f32_16x16x32_bf16 v[40:43], v[200:203], v[72:75], 0
v_mfma_f32_16x16x32_bf16 v[68:71], v[200:203], v[76:79], 0
s_waitcnt lgkmcnt(0)
v_mfma_f32_16x16x32_bf16 v[16:19], a[4:7], v[80:83], v[16:19]
v_mfma_f32_16x16x32_bf16 v[44:47], a[4:7], v[84:87], v[44:47]
ds_read_b128 v[72:75], v1 offset:2048
ds_read_b128 v[76:79], v1 offset:16384
v_mfma_f32_16x16x32_bf16 v[20:23], a[60:63], v[80:83], v[20:23]
v_mfma_f32_16x16x32_bf16 v[48:51], a[60:63], v[84:87], v[48:51]
v_mfma_f32_16x16x32_bf16 v[24:27], a[116:119], v[80:83], v[24:27]
v_mfma_f32_16x16x32_bf16 v[52:55], a[116:119], v[84:87], v[52:55]
v_mfma_f32_16x16x32_bf16 v[28:31], a[172:175], v[80:83], v[28:31]
v_mfma_f32_16x16x32_bf16 v[56:59], a[172:175], v[84:87], v[56:59]
v_mfma_f32_16x16x32_bf16 v[32:35], a[228:231], v[80:83], v[32:35]
v_mfma_f32_16x16x32_bf16 v[60:63], a[228:231], v[84:87], v[60:63]
v_mfma_f32_16x16x32_bf16 v[36:39], v[148:151], v[80:83], v[36:39]
v_mfma_f32_16x16x32_bf16 v[64:67], v[148:151], v[84:87], v[64:67]
v_mfma_f32_16x16x32_bf16 v[40:43], v[204:207], v[80:83], v[40:43]
v_mfma_f32_16x16x32_bf16 v[68:71], v[204:207], v[84:87], v[68:71]
s_waitcnt lgkmcnt(0)
v_mfma_f32_16x16x32_bf16 v[16:19], a[8:11], v[72:75], v[16:19]
v_mfma_f32_16x16x32_bf16 v[44:47], a[8:11], v[76:79], v[44:47]
ds_read_b128 v[80:83], v1 offset:3072
ds_read_b128 v[84:87], v1 offset:17408
v_mfma_f32_16x16x32_bf16 v[20:23], a[64:67], v[72:75], v[20:23]
v_mfma_f32_16x16x32_bf16 v[48:51], a[64:67], v[76:79], v[48:51]
v_mfma_f32_16x16x32_bf16 v[24:27], a[120:123], v[72:75], v[24:27]
v_mfma_f32_16x16x32_bf16 v[52:55], a[120:123], v[76:79], v[52:55]
v_mfma_f32_16x16x32_bf16 v[28:31], a[176:179], v[72:75], v[28:31]
v_mfma_f32_16x16x32_bf16 v[56:59], a[176:179], v[76:79], v[56:59]
v_mfma_f32_16x16x32_bf16 v[32:35], a[232:235], v[72:75], v[32:35]
v_mfma_f32_16x16x32_bf16 v[60:63], a[232:235], v[76:79], v[60:63]
v_mfma_f32_16x16x32_bf16 v[36:39], v[152:155], v[72:75], v[36:39]
v_mfma_f32_16x16x32_bf16 v[64:67], v[152:155], v[76:79], v[64:67]
v_mfma_f32_16x16x32_bf16 v[40:43], v[208:211], v[72:75], v[40:43]
v_mfma_f32_16x16x32_bf16 v[68:71], v[208:211], v[76:79], v[68:71]
s_waitcnt lgkmcnt(0)
v_mfma_f32_16x16x32_bf16 v[16:19], a[12:15], v[80:83], v[16:19]
v_mfma_f32_16x16x32_bf16 v[44:47], a[12:15], v[84:87], v[44:47]
ds_read_b128 v[72:75], v1 offset:4096
ds_read_b128 v[76:79], v1 offset:18432
v_mfma_f32_16x16x32_bf16 v[20:23], a[68:71], v[80:83], v[20:23]
v_mfma_f32_16x16x32_bf16 v[48:51], a[68:71], v[84:87], v[48:51]
v_mfma_f32_16x16x32_bf16 v[24:27], a[124:127], v[80:83], v[24:27]
v_mfma_f32_16x16x32_bf16 v[52:55], a[124:127], v[84:87], v[52:55]
v_mfma_f32_16x16x32_bf16 v[28:31], a[180:183], v[80:83], v[28:31]
v_mfma_f32_16x16x32_bf16 v[56:59], a[180:183], v[84:87], v[56:59]
v_mfma_f32_16x16x32_bf16 v[32:35], a[236:239], v[80:83], v[32:35]
v_mfma_f32_16x16x32_bf16 v[60:63], a[236:239], v[84:87], v[60:63]
v_mfma_f32_16x16x32_bf16 v[36:39], v[156:159], v[80:83], v[36:39]
v_mfma_f32_16x16x32_bf16 v[64:67], v[156:159], v[84:87], v[64:67]
v_mfma_f32_16x16x32_bf16 v[40:43], v[212:215], v[80:83], v[40:43]
v_mfma_f32_16x16x32_bf16 v[68:71], v[212:215], v[84:87], v[68:71]
s_waitcnt lgkmcnt(0)
v_mfma_f32_16x16x32_bf16 v[16:19], a[16:19], v[72:75], v[16:19]
v_mfma_f32_16x16x32_bf16 v[44:47], a[16:19], v[76:79], v[44:47]
ds_read_b128 v[80:83], v1 offset:5120
ds_read_b128 v[84:87], v1 offset:19456
v_mfma_f32_16x16x32_bf16 v[20:23], a[72:75], v[72:75], v[20:23]
v_mfma_f32_16x16x32_bf16 v[48:51], a[72:75], v[76:79], v[48:51]
v_mfma_f32_16x16x32_bf16 v[24:27], a[128:131], v[72:75], v[24:27]
v_mfma_f32_16x16x32_bf16 v[52:55], a[128:131], v[76:79], v[52:55]
v_mfma_f32_16x16x32_bf16 v[28:31], a[184:187], v[72:75], v[28:31]
v_mfma_f32_16x16x32_bf16 v[56:59], a[184:187], v[76:79], v[56:59]
v_mfma_f32_16x16x32_bf16 v[32:35], a[240:243], v[72:75], v[32:35]
v_mfma_f32_16x16x32_bf16 v[60:63], a[240:243], v[76:79], v[60:63]
v_mfma_f32_16x16x32_bf16 v[36:39], v[160:163], v[72:75], v[36:39]
v_mfma_f32_16x16x32_bf16 v[64:67], v[160:163], v[76:79], v[64:67]
v_mfma_f32_16x16x32_bf16 v[40:43], v[216:219], v[72:75], v[40:43]
v_mfma_f32_16x16x32_bf16 v[68:71], v[216:219], v[76:79], v[68:71]
s_waitcnt lgkmcnt(0)
v_mfma_f32_16x16x32_bf16 v[16:19], a[20:23], v[80:83], v[16:19]
v_mfma_f32_16x16x32_bf16 v[44:47], a[20:23], v[84:87], v[44:47]
ds_read_b128 v[72:75], v1 offset:6144
ds_read_b128 v[76:79], v1 offset:20480
v_mfma_f32_16x16x32_bf16 v[20:23], a[76:79], v[80:83], v[20:23]
v_mfma_f32_16x16x32_bf16 v[48:51], a[76:79], v[84:87], v[48:51]
v_mfma_f32_16x16x32_bf16 v[24:27], a[132:135], v[80:83], v[24:27]
v_mfma_f32_16x16x32_bf16 v[52:55], a[132:135], v[84:87], v[52:55]
v_mfma_f32_16x16x32_bf16 v[28:31], a[188:191], v[80:83], v[28:31]
v_mfma_f32_16x16x32_bf16 v[56:59], a[188:191], v[84:87], v[56:59]
v_mfma_f32_16x16x32_bf16 v[32:35], a[244:247], v[80:83], v[32:35]
v_mfma_f32_16x16x32_bf16 v[60:63], a[244:247], v[84:87], v[60:63]
v_mfma_f32_16x16x32_bf16 v[36:39], v[164:167], v[80:83], v[36:39]
v_mfma_f32_16x16x32_bf16 v[64:67], v[164:167], v[84:87], v[64:67]
v_mfma_f32_16x16x32_bf16 v[40:43], v[220:223], v[80:83], v[40:43]
v_mfma_f32_16x16x32_bf16 v[68:71], v[220:223], v[84:87], v[68:71]
s_waitcnt lgkmcnt(0)
v_mfma_f32_16x16x32_bf16 v[16:19], a[24:27], v[72:75], v[16:19]
v_mfma_f32_16x16x32_bf16 v[44:47], a[24:27], v[76:79], v[44:47]
ds_read_b128 v[80:83], v1 offset:7168
ds_read_b128 v[84:87], v1 offset:21504
v_mfma_f32_16x16x32_bf16 v[20:23], a[80:83], v[72:75], v[20:23]
v_mfma_f32_16x16x32_bf16 v[48:51], a[80:83], v[76:79], v[48:51]
v_mfma_f32_16x16x32_bf16 v[24:27], a[136:139], v[72:75], v[24:27]
v_mfma_f32_16x16x32_bf16 v[52:55], a[136:139], v[76:79], v[52:55]
v_mfma_f32_16x16x32_bf16 v[28:31], a[192:195], v[72:75], v[28:31]
v_mfma_f32_16x16x32_bf16 v[56:59], a[192:195], v[76:79], v[56:59]
v_mfma_f32_16x16x32_bf16 v[32:35], a[248:251], v[72:75], v[32:35]
v_mfma_f32_16x16x32_bf16 v[60:63], a[248:251], v[76:79], v[60:63]
v_mfma_f32_16x16x32_bf16 v[36:39], v[168:171], v[72:75], v[36:39]
v_mfma_f32_16x16x32_bf16 v[64:67], v[168:171], v[76:79], v[64:67]
v_mfma_f32_16x16x32_bf16 v[40:43], v[224:227], v[72:75], v[40:43]
v_mfma_f32_16x16x32_bf16 v[68:71], v[224:227], v[76:79], v[68:71]
s_waitcnt lgkmcnt(0)
v_mfma_f32_16x16x32_bf16 v[16:19], a[28:31], v[80:83], v[16:19]
v_mfma_f32_16x16x32_bf16 v[44:47], a[28:31], v[84:87], v[44:47]
ds_read_b128 v[72:75], v1 offset:8192
ds_read_b128 v[76:79], v1 offset:22528
v_mfma_f32_16x16x32_bf16 v[20:23], a[84:87], v[80:83], v[20:23]
v_mfma_f32_16x16x32_bf16 v[48:51], a[84:87], v[84:87], v[48:51]
v_mfma_f32_16x16x32_bf16 v[24:27], a[140:143], v[80:83], v[24:27]
v_mfma_f32_16x16x32_bf16 v[52:55], a[140:143], v[84:87], v[52:55]
v_mfma_f32_16x16x32_bf16 v[28:31], a[196:199], v[80:83], v[28:31]
v_mfma_f32_16x16x32_bf16 v[56:59], a[196:199], v[84:87], v[56:59]
v_mfma_f32_16x16x32_bf16 v[32:35], a[252:255], v[80:83], v[32:35]
v_mfma_f32_16x16x32_bf16 v[60:63], a[252:255], v[84:87], v[60:63]
v_mfma_f32_16x16x32_bf16 v[36:39], v[172:175], v[80:83], v[36:39]
v_mfma_f32_16x16x32_bf16 v[64:67], v[172:175], v[84:87], v[64:67]
v_mfma_f32_16x16x32_bf16 v[40:43], v[228:231], v[80:83], v[40:43]
v_mfma_f32_16x16x32_bf16 v[68:71], v[228:231], v[84:87], v[68:71]
s_waitcnt lgkmcnt(0)
v_mfma_f32_16x16x32_bf16 v[16:19], a[32:35], v[72:75], v[16:19]
v_mfma_f32_16x16x32_bf16 v[44:47], a[32:35], v[76:79], v[44:47]
ds_read_b128 v[80:83], v1 offset:9216
ds_read_b128 v[84:87], v1 offset:23552
v_mfma_f32_16x16x32_bf16 v[20:23], a[88:91], v[72:75], v[20:23]
v_mfma_f32_16x16x32_bf16 v[48:51], a[88:91], v[76:79], v[48:51]
v_mfma_f32_16x16x32_bf16 v[24:27], a[144:147], v[72:75], v[24:27]
v_mfma_f32_16x16x32_bf16 v[52:55], a[144:147], v[76:79], v[52:55]
v_mfma_f32_16x16x32_bf16 v[28:31], a[200:203], v[72:75], v[28:31]
v_mfma_f32_16x16x32_bf16 v[56:59], a[200:203], v[76:79], v[56:59]
v_mfma_f32_16x16x32_bf16 v[32:35], v[120:123], v[72:75], v[32:35]
v_mfma_f32_16x16x32_bf16 v[60:63], v[120:123], v[76:79], v[60:63]
v_mfma_f32_16x16x32_bf16 v[36:39], v[176:179], v[72:75], v[36:39]
v_mfma_f32_16x16x32_bf16 v[64:67], v[176:179], v[76:79], v[64:67]
v_mfma_f32_16x16x32_bf16 v[40:43], v[232:235], v[72:75], v[40:43]
v_mfma_f32_16x16x32_bf16 v[68:71], v[232:235], v[76:79], v[68:71]
s_waitcnt lgkmcnt(0)
v_mfma_f32_16x16x32_bf16 v[16:19], a[36:39], v[80:83], v[16:19]
v_mfma_f32_16x16x32_bf16 v[44:47], a[36:39], v[84:87], v[44:47]
ds_read_b128 v[72:75], v1 offset:10240
ds_read_b128 v[76:79], v1 offset:24576
v_mfma_f32_16x16x32_bf16 v[20:23], a[92:95], v[80:83], v[20:23]
v_mfma_f32_16x16x32_bf16 v[48:51], a[92:95], v[84:87], v[48:51]
v_mfma_f32_16x16x32_bf16 v[24:27], a[148:151], v[80:83], v[24:27]
v_mfma_f32_16x16x32_bf16 v[52:55], a[148:151], v[84:87], v[52:55]
v_mfma_f32_16x16x32_bf16 v[28:31], a[204:207], v[80:83], v[28:31]
v_mfma_f32_16x16x32_bf16 v[56:59], a[204:207], v[84:87], v[56:59]
v_mfma_f32_16x16x32_bf16 v[32:35], v[124:127], v[80:83], v[32:35]
v_mfma_f32_16x16x32_bf16 v[60:63], v[124:127], v[84:87], v[60:63]
v_mfma_f32_16x16x32_bf16 v[36:39], v[180:183], v[80:83], v[36:39]
v_mfma_f32_16x16x32_bf16 v[64:67], v[180:183], v[84:87], v[64:67]
v_mfma_f32_16x16x32_bf16 v[40:43], v[236:239], v[80:83], v[40:43]
v_mfma_f32_16x16x32_bf16 v[68:71], v[236:239], v[84:87], v[68:71]
s_waitcnt lgkmcnt(0)
v_mfma_f32_16x16x32_bf16 v[16:19], a[40:43], v[72:75], v[16:19]
v_mfma_f32_16x16x32_bf16 v[44:47], a[40:43], v[76:79], v[44:47]
ds_read_b128 v[80:83], v1 offset:11264
ds_read_b128 v[84:87], v1 offset:25600
v_mfma_f32_16x16x32_bf16 v[20:23], a[96:99], v[72:75], v[20:23]
v_mfma_f32_16x16x32_bf16 v[48:51], a[96:99], v[76:79], v[48:51]
v_mfma_f32_16x16x32_bf16 v[24:27], a[152:155], v[72:75], v[24:27]
v_mfma_f32_16x16x32_bf16 v[52:55], a[152:155], v[76:79], v[52:55]
v_mfma_f32_16x16x32_bf16 v[28:31], a[208:211], v[72:75], v[28:31]
v_mfma_f32_16x16x32_bf16 v[56:59], a[208:211], v[76:79], v[56:59]
v_mfma_f32_16x16x32_bf16 v[32:35], v[128:131], v[72:75], v[32:35]
v_mfma_f32_16x16x32_bf16 v[60:63], v[128:131], v[76:79], v[60:63]
v_mfma_f32_16x16x32_bf16 v[36:39], v[184:187], v[72:75], v[36:39]
v_mfma_f32_16x16x32_bf16 v[64:67], v[184:187], v[76:79], v[64:67]
v_mfma_f32_16x16x32_bf16 v[40:43], v[240:243], v[72:75], v[40:43]
v_mfma_f32_16x16x32_bf16 v[68:71], v[240:243], v[76:79], v[68:71]
s_waitcnt lgkmcnt(0)
v_mfma_f32_16x16x32_bf16 v[16:19], a[44:47], v[80:83], v[16:19]
v_mfma_f32_16x16x32_bf16 v[44:47], a[44:47], v[84:87], v[44:47]
ds_read_b128 v[72:75], v1 offset:12288
ds_read_b128 v[76:79], v1 offset:26624
v_mfma_f32_16x16x32_bf16 v[20:23], a[100:103], v[80:83], v[20:23]
v_mfma_f32_16x16x32_bf16 v[48:51], a[100:103], v[84:87], v[48:51]
v_mfma_f32_16x16x32_bf16 v[24:27], a[156:159], v[80:83], v[24:27]
v_mfma_f32_16x16x32_bf16 v[52:55], a[156:159], v[84:87], v[52:55]
v_mfma_f32_16x16x32_bf16 v[28:31], a[212:215], v[80:83], v[28:31]
v_mfma_f32_16x16x32_bf16 v[56:59], a[212:215], v[84:87], v[56:59]
v_mfma_f32_16x16x32_bf16 v[32:35], v[132:135], v[80:83], v[32:35]
v_mfma_f32_16x16x32_bf16 v[60:63], v[132:135], v[84:87], v[60:63]
v_mfma_f32_16x16x32_bf16 v[36:39], v[188:191], v[80:83], v[36:39]
v_mfma_f32_16x16x32_bf16 v[64:67], v[188:191], v[84:87], v[64:67]
v_mfma_f32_16x16x32_bf16 v[40:43], v[244:247], v[80:83], v[40:43]
v_mfma_f32_16x16x32_bf16 v[68:71], v[244:247], v[84:87], v[68:71]
s_waitcnt lgkmcnt(0)
v_mfma_f32_16x16x32_bf16 v[16:19], a[48:51], v[72:75], v[16:19]
v_mfma_f32_16x16x32_bf16 v[44:47], a[48:51], v[76:79], v[44:47]
ds_read_b128 v[80:83], v1 offset:13312
ds_read_b128 v[84:87], v1 offset:27648
v_mfma_f32_16x16x32_bf16 v[20:23], a[104:107], v[72:75], v[20:23]
v_mfma_f32_16x16x32_bf16 v[48:51], a[104:107], v[76:79], v[48:51]
v_mfma_f32_16x16x32_bf16 v[24:27], a[160:163], v[72:75], v[24:27]
v_mfma_f32_16x16x32_bf16 v[52:55], a[160:163], v[76:79], v[52:55]
v_mfma_f32_16x16x32_bf16 v[28:31], a[216:219], v[72:75], v[28:31]
v_mfma_f32_16x16x32_bf16 v[56:59], a[216:219], v[76:79], v[56:59]
v_mfma_f32_16x16x32_bf16 v[32:35], v[136:139], v[72:75], v[32:35]
v_mfma_f32_16x16x32_bf16 v[60:63], v[136:139], v[76:79], v[60:63]
v_mfma_f32_16x16x32_bf16 v[36:39], v[192:195], v[72:75], v[36:39]
v_mfma_f32_16x16x32_bf16 v[64:67], v[192:195], v[76:79], v[64:67]
v_mfma_f32_16x16x32_bf16 v[40:43], v[248:251], v[72:75], v[40:43]
v_mfma_f32_16x16x32_bf16 v[68:71], v[248:251], v[76:79], v[68:71]
s_waitcnt lgkmcnt(0)
v_mfma_f32_16x16x32_bf16 v[16:19], a[52:55], v[80:83], v[16:19]
v_mfma_f32_16x16x32_bf16 v[44:47], a[52:55], v[84:87], v[44:47]
v_mfma_f32_16x16x32_bf16 v[20:23], a[108:111], v[80:83], v[20:23]
v_mfma_f32_16x16x32_bf16 v[48:51], a[108:111], v[84:87], v[48:51]
v_mfma_f32_16x16x32_bf16 v[24:27], a[164:167], v[80:83], v[24:27]
v_mfma_f32_16x16x32_bf16 v[52:55], a[164:167], v[84:87], v[52:55]
v_mfma_f32_16x16x32_bf16 v[28:31], a[220:223], v[80:83], v[28:31]
v_mfma_f32_16x16x32_bf16 v[56:59], a[220:223], v[84:87], v[56:59]
v_mfma_f32_16x16x32_bf16 v[32:35], v[140:143], v[80:83], v[32:35]
v_mfma_f32_16x16x32_bf16 v[60:63], v[140:143], v[84:87], v[60:63]
v_mfma_f32_16x16x32_bf16 v[36:39], v[196:199], v[80:83], v[36:39]
v_mfma_f32_16x16x32_bf16 v[64:67], v[196:199], v[84:87], v[64:67]
v_mfma_f32_16x16x32_bf16 v[40:43], v[252:255], v[80:83], v[40:43]
v_mfma_f32_16x16x32_bf16 v[68:71], v[252:255], v[84:87], v[68:71]
s_nop 1
v_cvt_pk_bf16_f32 v88, v16, v17
v_cvt_pk_bf16_f32 v89, v18, v19
v_cvt_pk_bf16_f32 v104, v44, v45
v_cvt_pk_bf16_f32 v105, v46, v47
v_cvt_pk_bf16_f32 v90, v20, v21
v_cvt_pk_bf16_f32 v91, v22, v23
v_cvt_pk_bf16_f32 v106, v48, v49
v_cvt_pk_bf16_f32 v107, v50, v51
v_cvt_pk_bf16_f32 v92, v24, v25
v_cvt_pk_bf16_f32 v93, v26, v27
v_cvt_pk_bf16_f32 v108, v52, v53
v_cvt_pk_bf16_f32 v109, v54, v55
v_cvt_pk_bf16_f32 v94, v28, v29
v_cvt_pk_bf16_f32 v95, v30, v31
v_cvt_pk_bf16_f32 v110, v56, v57
v_cvt_pk_bf16_f32 v111, v58, v59
v_cvt_pk_bf16_f32 v96, v32, v33
v_cvt_pk_bf16_f32 v97, v34, v35
v_cvt_pk_bf16_f32 v112, v60, v61
v_cvt_pk_bf16_f32 v113, v62, v63
v_cvt_pk_bf16_f32 v98, v36, v37
v_cvt_pk_bf16_f32 v99, v38, v39
v_cvt_pk_bf16_f32 v114, v64, v65
v_cvt_pk_bf16_f32 v115, v66, v67
v_cvt_pk_bf16_f32 v100, v40, v41
v_cvt_pk_bf16_f32 v101, v42, v43
v_cvt_pk_bf16_f32 v116, v68, v69
v_cvt_pk_bf16_f32 v117, v70, v71
ds_read_b64 v[16:17], v2
ds_read_b64 v[18:19], v2 offset:512
ds_read_b64 v[20:21], v2 offset:14336
ds_read_b64 v[22:23], v2 offset:14848
ds_read_b64 v[24:25], v2 offset:1024
ds_read_b64 v[26:27], v2 offset:1536
ds_read_b64 v[28:29], v2 offset:15360
ds_read_b64 v[30:31], v2 offset:15872
s_waitcnt lgkmcnt(4)
v_mfma_f32_16x16x32_bf16 v[32:35], v[16:19], v[88:91], 0
v_mfma_f32_16x16x32_bf16 v[36:39], v[16:19], v[104:107], 0
v_mfma_f32_16x16x32_bf16 v[40:43], v[20:23], v[104:107], 0
ds_read_b64 v[16:17], v2 offset:2048
ds_read_b64 v[18:19], v2 offset:2560
ds_read_b64 v[20:21], v2 offset:16384
ds_read_b64 v[22:23], v2 offset:16896
s_waitcnt lgkmcnt(4)
v_mfma_f32_16x16x32_bf16 v[32:35], v[24:27], v[92:95], v[32:35]
v_mfma_f32_16x16x32_bf16 v[36:39], v[24:27], v[108:111], v[36:39]
v_mfma_f32_16x16x32_bf16 v[40:43], v[28:31], v[108:111], v[40:43]
ds_read_b64 v[24:25], v2 offset:3072
ds_read_b64 v[26:27], v2 offset:3584
ds_read_b64 v[28:29], v2 offset:17408
ds_read_b64 v[30:31], v2 offset:17920
s_waitcnt lgkmcnt(4)
v_mfma_f32_16x16x32_bf16 v[32:35], v[16:19], v[96:99], v[32:35]
v_mfma_f32_16x16x32_bf16 v[36:39], v[16:19], v[112:115], v[36:39]
v_mfma_f32_16x16x32_bf16 v[40:43], v[20:23], v[112:115], v[40:43]
s_waitcnt lgkmcnt(0)
v_mfma_f32_16x16x32_bf16 v[32:35], v[24:27], v[100:103], v[32:35]
v_mfma_f32_16x16x32_bf16 v[36:39], v[24:27], v[116:119], v[36:39]
v_mfma_f32_16x16x32_bf16 v[40:43], v[28:31], v[116:119], v[40:43]
v_mov_b32 v66, 0
v_mov_b32 v67, 0
s_nop 5
ds_write_b128 v4, v[32:35]
ds_write_b128 v4, v[36:39] offset:2304
ds_write_b128 v4, v[40:43] offset:2368
s_waitcnt lgkmcnt(0)
s_barrier
ds_read_b128 v[16:19], v5
ds_read_b128 v[20:23], v5 offset:4608
ds_read_b128 v[24:27], v5 offset:9216
ds_read_b128 v[28:31], v5 offset:13824
s_waitcnt lgkmcnt(0)
v_add_f32 v16, v16, v20
v_add_f32 v24, v24, v28
v_add_f32 v16, v16, v24
v_mov_b32 v68, s47
v_cndmask_b32 v68, v68, v16, s[32:33]
v_add_f32 v17, v17, v21
v_add_f32 v25, v25, v29
v_add_f32 v17, v17, v25
v_mov_b32 v69, s47
v_cndmask_b32 v69, v69, v17, s[34:35]
v_add_f32 v18, v18, v22
v_add_f32 v26, v26, v30
v_add_f32 v18, v18, v26
v_mov_b32 v70, s47
v_cndmask_b32 v70, v70, v18, s[36:37]
v_add_f32 v19, v19, v23
v_add_f32 v27, v27, v31
v_add_f32 v19, v19, v27
v_mov_b32 v71, s47
v_cndmask_b32 v71, v71, v19, s[38:39]
v_max3_f32 v32, v68, v69, v70
v_max_f32 v32, v32, v71
buffer_load_dwordx2 v[52:53], v3, s[4:7], s28 offen sc1
buffer_load_dwordx2 v[54:55], v3, s[4:7], s28 offen offset:256 sc1
buffer_load_dwordx2 v[56:57], v3, s[4:7], s28 offen offset:512 sc1
buffer_load_dwordx2 v[58:59], v3, s[4:7], s28 offen offset:768 sc1
buffer_load_dwordx2 v[60:61], v3, s[4:7], s28 offen offset:1024 sc1
buffer_load_dwordx2 v[62:63], v3, s[4:7], s28 offen offset:1280 sc1
buffer_load_dwordx2 v[64:65], v3, s[4:7], s28 offen offset:1536 sc1
s_sleep 6
Lspin_197:
buffer_load_dwordx2 v[52:53], v3, s[4:7], s28 offen sc1
buffer_load_dwordx2 v[54:55], v3, s[4:7], s28 offen offset:256 sc1
buffer_load_dwordx2 v[56:57], v3, s[4:7], s28 offen offset:512 sc1
buffer_load_dwordx2 v[58:59], v3, s[4:7], s28 offen offset:768 sc1
buffer_load_dwordx2 v[60:61], v3, s[4:7], s28 offen offset:1024 sc1
buffer_load_dwordx2 v[62:63], v3, s[4:7], s28 offen offset:1280 sc1
buffer_load_dwordx2 v[64:65], v3, s[4:7], s28 offen offset:1536 sc1
s_sub_u32 s24, s24, 1
s_cbranch_scc1 CODE_END
s_waitcnt vmcnt(7)
v_max3_u32 v10, v52, v53, v54
v_max3_u32 v10, v10, v55, v56
v_max3_u32 v10, v10, v57, v58
v_max3_u32 v10, v10, v59, v60
v_max3_u32 v10, v10, v61, v62
v_max3_u32 v10, v10, v63, v64
v_max_u32 v10, v10, v65
v_cmp_eq_u32 vcc, -1, v10
s_cbranch_vccz Lspin_197x
s_cmp_ge_u32 s25, 58
s_cbranch_scc1 Lspin_197
s_sleep 8
s_branch Lspin_197
Lspin_197x:
v_mfma_f32_16x16x32_bf16 v[44:47], v[52:55], v[88:91], 0
v_mfma_f32_16x16x32_bf16 v[48:51], v[52:55], v[104:107], 0
v_mfma_f32_16x16x32_bf16 v[44:47], v[56:59], v[92:95], v[44:47]
v_mfma_f32_16x16x32_bf16 v[48:51], v[56:59], v[108:111], v[48:51]
v_mfma_f32_16x16x32_bf16 v[44:47], v[60:63], v[96:99], v[44:47]
v_mfma_f32_16x16x32_bf16 v[48:51], v[60:63], v[112:115], v[48:51]
v_mfma_f32_16x16x32_bf16 v[44:47], v[64:67], v[100:103], v[44:47]
v_mfma_f32_16x16x32_bf16 v[48:51], v[64:67], v[116:119], v[48:51]
s_nop 6
ds_write_b128 v6, v[44:47]
ds_write_b128 v6, v[48:51] offset:2304
s_waitcnt lgkmcnt(0)
s_barrier
ds_read2_b32 v[20:21], v7 offset0:0 offset1:8
ds_read2_b32 v[22:23], v7 offset0:16 offset1:24
s_waitcnt lgkmcnt(0)
v_pk_add_f32 v[20:21], v[20:21], v[22:23]
v_add_f32 v17, v20, v21
v_max_f32 v16, v32, v17
s_nop 1
v_max_f32_dpp v16, v16, v16 quad_perm:[1,0,3,2] row_mask:0xf bank_mask:0xf
s_nop 1
v_max_f32_dpp v16, v16, v16 quad_perm:[2,3,0,1] row_mask:0xf bank_mask:0xf
s_nop 1
v_max_f32_dpp v16, v16, v16 row_half_mirror row_mask:0xf bank_mask:0xf
v_sub_f32 v17, v17, v16
v_sub_f32 v68, v68, v16
v_sub_f32 v69, v69, v16
v_sub_f32 v70, v70, v16
v_sub_f32 v71, v71, v16
v_exp_f32 v17, v17
v_exp_f32 v68, v68
v_exp_f32 v69, v69
v_exp_f32 v70, v70
v_exp_f32 v71, v71
v_add_f32 v16, v17, v68
v_add_f32 v18, v69, v70
v_add_f32 v16, v16, v71
v_add_f32 v16, v16, v18
v_mov_b32_dpp v18, v17 quad_perm:[1,0,3,2] row_mask:0xf bank_mask:0xf
s_nop 1
v_add_f32_dpp v16, v16, v16 quad_perm:[1,0,3,2] row_mask:0xf bank_mask:0xf
s_nop 1
v_add_f32_dpp v16, v16, v16 quad_perm:[2,3,0,1] row_mask:0xf bank_mask:0xf
s_nop 1
v_add_f32_dpp v16, v16, v16 row_half_mirror row_mask:0xf bank_mask:0xf
v_rcp_f32 v16, v16
s_cmp_lg_u32 s23, 0
v_mul_f32 v68, v68, v16 clamp
v_mul_f32 v69, v69, v16 clamp
v_mul_f32 v70, v70, v16 clamp
v_mul_f32 v71, v71, v16 clamp
v_mul_f32 v17, v17, v16 clamp
v_mul_f32 v18, v18, v16 clamp
v_cvt_pk_bf16_f32 v68, v68, v69
v_cvt_pk_bf16_f32 v70, v70, v71
v_cvt_pk_bf16_f32 v17, v17, v18
s_cbranch_scc1 Lwt_198
buffer_store_dword v68, v8, s[4:7], s29 offen
buffer_store_dword v70, v8, s[4:7], s29 offen offset:8
buffer_store_dword v17, v9, s[4:7], s30 offen
s_branch Lst_199
Lwt_198:
buffer_store_dword v68, v8, s[4:7], s29 offen sc1
buffer_store_dword v70, v8, s[4:7], s29 offen offset:8 sc1
buffer_store_dword v17, v9, s[4:7], s30 offen sc1
Lst_199:
s_add_u32 s26, s26, 114688
s_add_u32 s27, s27, 114688
s_add_u32 s28, s28, 28672
s_add_u32 s29, s29, 163840
s_add_u32 s30, s30, 163840
s_add_u32 s25, s25, 4
s_cmp_lt_u32 s25, 64
s_cbranch_scc1 TA_SEG3
s_endpgm
TB_W0:
s_load_dwordx2 s[8:9], s[0:1], 0
s_mov_b32 s10, 1835008
s_mov_b32 s11, 0x00020000
s_sub_u32 s22, s22, 16
v_lshlrev_b32 v1, 4, v0
v_and_b32 v11, 7, v0
v_lshlrev_b32 v11, 2, v11
v_bfe_u32 v12, v0, 3, 1
v_lshl_add_u32 v11, v12, 7, v11
s_mov_b32 s40, 4352
s_branch Lfirst_201
Lflag_200:
v_cmp_ne_u32 vcc, s88, v12
s_cbranch_vccz Lset_202
s_sleep 4
Lfirst_201:
buffer_load_dword v12, v11, s[4:7], s40 offen sc1
s_waitcnt vmcnt(0)
s_sub_u32 s24, s24, 1
s_cbranch_scc0 Lflag_200
s_endpgm
Lset_202:
s_cmp_lt_u32 s21, 2
s_cselect_b32 s29, 0, 4
s_add_u32 s29, s29, s21
s_mul_i32 s26, s29, 28672
s_add_u32 s26, s26, 8044544
s_mov_b32 m0, 0
s_add_u32 s40, s26, 0
buffer_load_dwordx4 v1, s[4:7], s40 offen lds
s_mov_b32 m0, 1024
s_add_u32 s40, s26, 1024
buffer_load_dwordx4 v1, s[4:7], s40 offen lds
s_mov_b32 m0, 2048
s_add_u32 s40, s26, 2048
buffer_load_dwordx4 v1, s[4:7], s40 offen lds
s_mov_b32 m0, 3072
s_add_u32 s40, s26, 3072
buffer_load_dwordx4 v1, s[4:7], s40 offen lds
s_mov_b32 m0, 4096
s_add_u32 s40, s26, 4096
buffer_load_dwordx4 v1, s[4:7], s40 offen lds
s_mov_b32 m0, 5120
s_add_u32 s40, s26, 5120
buffer_load_dwordx4 v1, s[4:7], s40 offen lds
s_mov_b32 m0, 6144
s_add_u32 s40, s26, 6144
buffer_load_dwordx4 v1, s[4:7], s40 offen lds
v_and_b32 v11, 7, v0
v_min_u32 v11, 6, v11
v_lshlrev_b32 v11, 2, v11
v_bfe_u32 v12, v0, 3, 2
v_lshl_add_u32 v11, v12, 7, v11
s_mov_b32 s40, 2048
s_branch Lfirst_204
Lflag_203:
v_cmp_ne_u32 vcc, s88, v12
s_cbranch_vccz Lset_205
s_sleep 4
Lfirst_204:
buffer_load_dword v12, v11, s[4:7], s40 offen sc1
s_waitcnt vmcnt(0)
s_sub_u32 s24, s24, 1
s_cbranch_scc0 Lflag_203
s_endpgm
Lset_205:
s_cmp_lt_u32 s21, 2
s_cbranch_scc1 Learly_206
s_mov_b32 s40, 139264
s_branch Lfirst_208
Lflag_207:
v_cmp_ne_u32 vcc, s88, v11
s_cbranch_vccz Lset_209
s_sleep 16
Lfirst_208:
buffer_load_dword v11, off, s[4:7], s40 sc1
s_waitcnt vmcnt(0)
s_sub_u32 s24, s24, 1
s_cbranch_scc0 Lflag_207
s_endpgm
Lset_209:
Learly_206:
s_mul_i32 s40, s22, 458752
s_add_u32 s40, s40, 16302080
s_add_u32 s41, s40, 86016
s_add_u32 s43, s40, 57344
buffer_load_dwordx4 a[0:3], v1, s[4:7], s40 offen
buffer_load_dwordx4 a[4:7], v1, s[4:7], s40 offen offset:1024
buffer_load_dwordx4 a[8:11], v1, s[4:7], s40 offen offset:2048
buffer_load_dwordx4 a[12:15], v1, s[4:7], s40 offen offset:3072
s_add_u32 s40, s40, 4096
buffer_load_dwordx4 a[16:19], v1, s[4:7], s40 offen
buffer_load_dwordx4 a[20:23], v1, s[4:7], s40 offen offset:1024
buffer_load_dwordx4 a[24:27], v1, s[4:7], s40 offen offset:2048
buffer_load_dwordx4 a[28:31], v1, s[4:7], s40 offen offset:3072
s_add_u32 s40, s40, 4096
buffer_load_dwordx4 a[32:35], v1, s[4:7], s40 offen
buffer_load_dwordx4 a[36:39], v1, s[4:7], s40 offen offset:1024
buffer_load_dwordx4 a[40:43], v1, s[4:7], s40 offen offset:2048
buffer_load_dwordx4 a[44:47], v1, s[4:7], s40 offen offset:3072
s_add_u32 s40, s40, 4096
buffer_load_dwordx4 a[48:51], v1, s[4:7], s40 offen
buffer_load_dwordx4 a[52:55], v1, s[4:7], s40 offen offset:1024
buffer_load_dwordx4 a[56:59], v1, s[4:7], s40 offen offset:2048
buffer_load_dwordx4 a[60:63], v1, s[4:7], s40 offen offset:3072
s_add_u32 s40, s40, 4096
buffer_load_dwordx4 a[64:67], v1, s[4:7], s40 offen
buffer_load_dwordx4 a[68:71], v1, s[4:7], s40 offen offset:1024
buffer_load_dwordx4 a[72:75], v1, s[4:7], s40 offen offset:2048
buffer_load_dwordx4 a[76:79], v1, s[4:7], s40 offen offset:3072
s_add_u32 s40, s40, 4096
buffer_load_dwordx4 a[80:83], v1, s[4:7], s40 offen
buffer_load_dwordx4 a[84:87], v1, s[4:7], s40 offen offset:1024
buffer_load_dwordx4 a[88:91], v1, s[4:7], s40 offen offset:2048
buffer_load_dwordx4 a[92:95], v1, s[4:7], s40 offen offset:3072
s_add_u32 s40, s40, 4096
buffer_load_dwordx4 a[96:99], v1, s[4:7], s40 offen
buffer_load_dwordx4 a[100:103], v1, s[4:7], s40 offen offset:1024
buffer_load_dwordx4 a[104:107], v1, s[4:7], s40 offen offset:2048
buffer_load_dwordx4 a[108:111], v1, s[4:7], s40 offen offset:3072
s_add_u32 s40, s40, 4096
buffer_load_dwordx4 a[112:115], v1, s[4:7], s40 offen
buffer_load_dwordx4 a[116:119], v1, s[4:7], s40 offen offset:1024
buffer_load_dwordx4 a[120:123], v1, s[4:7], s40 offen offset:2048
buffer_load_dwordx4 a[124:127], v1, s[4:7], s40 offen offset:3072
s_add_u32 s40, s40, 4096
buffer_load_dwordx4 a[128:131], v1, s[4:7], s40 offen
buffer_load_dwordx4 a[132:135], v1, s[4:7], s40 offen offset:1024
buffer_load_dwordx4 a[136:139], v1, s[4:7], s40 offen offset:2048
buffer_load_dwordx4 a[140:143], v1, s[4:7], s40 offen offset:3072
s_add_u32 s40, s40, 4096
buffer_load_dwordx4 a[144:147], v1, s[4:7], s40 offen
buffer_load_dwordx4 a[148:151], v1, s[4:7], s40 offen offset:1024
buffer_load_dwordx4 a[152:155], v1, s[4:7], s40 offen offset:2048
buffer_load_dwordx4 a[156:159], v1, s[4:7], s40 offen offset:3072
s_add_u32 s40, s40, 4096
s_waitcnt vmcnt(32)
buffer_load_dwordx4 a[160:163], v1, s[4:7], s40 offen
buffer_load_dwordx4 a[164:167], v1, s[4:7], s40 offen offset:1024
buffer_load_dwordx4 a[168:171], v1, s[4:7], s40 offen offset:2048
buffer_load_dwordx4 a[172:175], v1, s[4:7], s40 offen offset:3072
s_add_u32 s40, s40, 4096
buffer_load_dwordx4 a[176:179], v1, s[4:7], s40 offen
buffer_load_dwordx4 a[180:183], v1, s[4:7], s40 offen offset:1024
buffer_load_dwordx4 a[184:187], v1, s[4:7], s40 offen offset:2048
buffer_load_dwordx4 a[188:191], v1, s[4:7], s40 offen offset:3072
s_add_u32 s40, s40, 4096
s_waitcnt vmcnt(32)
buffer_load_dwordx4 a[192:195], v1, s[4:7], s40 offen
buffer_load_dwordx4 a[196:199], v1, s[4:7], s40 offen offset:1024
buffer_load_dwordx4 a[200:203], v1, s[4:7], s40 offen offset:2048
buffer_load_dwordx4 a[204:207], v1, s[4:7], s40 offen offset:3072
s_add_u32 s40, s40, 4096
buffer_load_dwordx4 a[208:211], v1, s[4:7], s40 offen
buffer_load_dwordx4 a[212:215], v1, s[4:7], s40 offen offset:1024
buffer_load_dwordx4 a[216:219], v1, s[4:7], s40 offen offset:2048
buffer_load_dwordx4 a[220:223], v1, s[4:7], s40 offen offset:3072
s_waitcnt vmcnt(40)
s_mov_b32 m0, 49152
s_add_u32 s42, s41, 0
buffer_load_dwordx4 v1, s[4:7], s42 offen lds
s_mov_b32 m0, 50176
s_add_u32 s42, s41, 1024
buffer_load_dwordx4 v1, s[4:7], s42 offen lds
s_mov_b32 m0, 51200
s_add_u32 s42, s41, 2048
buffer_load_dwordx4 v1, s[4:7], s42 offen lds
s_mov_b32 m0, 52224
s_add_u32 s42, s41, 3072
buffer_load_dwordx4 v1, s[4:7], s42 offen lds
s_mov_b32 m0, 53248
s_add_u32 s42, s41, 4096
buffer_load_dwordx4 v1, s[4:7], s42 offen lds
s_mov_b32 m0, 54272
s_add_u32 s42, s41, 5120
buffer_load_dwordx4 v1, s[4:7], s42 offen lds
s_mov_b32 m0, 55296
s_add_u32 s42, s41, 6144
buffer_load_dwordx4 v1, s[4:7], s42 offen lds
s_mov_b32 m0, 56320
s_add_u32 s42, s41, 7168
buffer_load_dwordx4 v1, s[4:7], s42 offen lds
s_waitcnt vmcnt(40)
s_mov_b32 m0, 57344
s_add_u32 s42, s41, 8192
buffer_load_dwordx4 v1, s[4:7], s42 offen lds
s_mov_b32 m0, 58368
s_add_u32 s42, s41, 9216
buffer_load_dwordx4 v1, s[4:7], s42 offen lds
s_mov_b32 m0, 59392
s_add_u32 s42, s41, 10240
buffer_load_dwordx4 v1, s[4:7], s42 offen lds
s_mov_b32 m0, 60416
s_add_u32 s42, s41, 11264
buffer_load_dwordx4 v1, s[4:7], s42 offen lds
s_mov_b32 m0, 61440
s_add_u32 s42, s41, 12288
buffer_load_dwordx4 v1, s[4:7], s42 offen lds
s_mov_b32 m0, 62464
s_add_u32 s42, s41, 13312
buffer_load_dwordx4 v1, s[4:7], s42 offen lds
s_mov_b32 m0, 63488
s_add_u32 s42, s41, 14336
buffer_load_dwordx4 v1, s[4:7], s42 offen lds
s_mov_b32 m0, 64512
s_add_u32 s42, s41, 15360
buffer_load_dwordx4 v1, s[4:7], s42 offen lds
s_waitcnt vmcnt(40)
s_mov_b32 m0, 65536
s_add_u32 s42, s41, 16384
buffer_load_dwordx4 v1, s[4:7], s42 offen lds
s_mov_b32 m0, 66560
s_add_u32 s42, s41, 17408
buffer_load_dwordx4 v1, s[4:7], s42 offen lds
s_mov_b32 m0, 67584
s_add_u32 s42, s41, 18432
buffer_load_dwordx4 v1, s[4:7], s42 offen lds
s_mov_b32 m0, 68608
s_add_u32 s42, s41, 19456
buffer_load_dwordx4 v1, s[4:7], s42 offen lds
s_mov_b32 m0, 69632
s_add_u32 s42, s41, 20480
buffer_load_dwordx4 v1, s[4:7], s42 offen lds
s_mov_b32 m0, 70656
s_add_u32 s42, s41, 21504
buffer_load_dwordx4 v1, s[4:7], s42 offen lds
s_mov_b32 m0, 71680
s_add_u32 s42, s41, 22528
buffer_load_dwordx4 v1, s[4:7], s42 offen lds
s_mov_b32 m0, 72704
s_add_u32 s42, s41, 23552
buffer_load_dwordx4 v1, s[4:7], s42 offen lds
s_waitcnt vmcnt(40)
s_mov_b32 m0, 73728
s_add_u32 s42, s41, 24576
buffer_load_dwordx4 v1, s[4:7], s42 offen lds
s_mov_b32 m0, 74752
s_add_u32 s42, s41, 25600
buffer_load_dwordx4 v1, s[4:7], s42 offen lds
s_mov_b32 m0, 75776
s_add_u32 s42, s41, 26624
buffer_load_dwordx4 v1, s[4:7], s42 offen lds
s_mov_b32 m0, 76800
s_add_u32 s42, s41, 27648
buffer_load_dwordx4 v1, s[4:7], s42 offen lds
s_waitcnt vmcnt(52)
buffer_load_dwordx4 a[224:227], v1, s[4:7], s43 offen
buffer_load_dwordx4 a[228:231], v1, s[4:7], s43 offen offset:1024
buffer_load_dwordx4 a[232:235], v1, s[4:7], s43 offen offset:2048
buffer_load_dwordx4 a[236:239], v1, s[4:7], s43 offen offset:3072
s_add_u32 s43, s43, 4096
s_waitcnt vmcnt(52)
buffer_load_dwordx4 a[240:243], v1, s[4:7], s43 offen
buffer_load_dwordx4 a[244:247], v1, s[4:7], s43 offen offset:1024
buffer_load_dwordx4 a[248:251], v1, s[4:7], s43 offen offset:2048
buffer_load_dwordx4 a[252:255], v1, s[4:7], s43 offen offset:3072
s_add_u32 s43, s43, 4096
s_waitcnt vmcnt(52)
buffer_load_dwordx4 v[176:179], v1, s[4:7], s43 offen
buffer_load_dwordx4 v[180:183], v1, s[4:7], s43 offen offset:1024
buffer_load_dwordx4 v[184:187], v1, s[4:7], s43 offen offset:2048
buffer_load_dwordx4 v[188:191], v1, s[4:7], s43 offen offset:3072
s_add_u32 s43, s43, 4096
s_waitcnt vmcnt(52)
buffer_load_dwordx4 v[192:195], v1, s[4:7], s43 offen
buffer_load_dwordx4 v[196:199], v1, s[4:7], s43 offen offset:1024
buffer_load_dwordx4 v[200:203], v1, s[4:7], s43 offen offset:2048
buffer_load_dwordx4 v[204:207], v1, s[4:7], s43 offen offset:3072
s_add_u32 s43, s43, 4096
s_waitcnt vmcnt(52)
buffer_load_dwordx4 v[208:211], v1, s[4:7], s43 offen
buffer_load_dwordx4 v[212:215], v1, s[4:7], s43 offen offset:1024
buffer_load_dwordx4 v[216:219], v1, s[4:7], s43 offen offset:2048
buffer_load_dwordx4 v[220:223], v1, s[4:7], s43 offen offset:3072
s_add_u32 s43, s43, 4096
s_waitcnt vmcnt(52)
buffer_load_dwordx4 v[224:227], v1, s[4:7], s43 offen
buffer_load_dwordx4 v[228:231], v1, s[4:7], s43 offen offset:1024
buffer_load_dwordx4 v[232:235], v1, s[4:7], s43 offen offset:2048
buffer_load_dwordx4 v[236:239], v1, s[4:7], s43 offen offset:3072
s_add_u32 s43, s43, 4096
s_waitcnt vmcnt(52)
buffer_load_dwordx4 v[240:243], v1, s[4:7], s43 offen
buffer_load_dwordx4 v[244:247], v1, s[4:7], s43 offen offset:1024
buffer_load_dwordx4 v[248:251], v1, s[4:7], s43 offen offset:2048
buffer_load_dwordx4 v[252:255], v1, s[4:7], s43 offen offset:3072
s_add_u32 s43, s43, 4096
v_add_u32 v2, 49152, v1
v_and_b32 v11, 15, v0
v_lshrrev_b32 v12, 4, v0
v_bfe_u32 v3, v0, 3, 1
v_mul_u32_u24 v3, 14368, v3
v_lshl_add_u32 v3, v12, 8, v3
v_bfe_u32 v4, v0, 2, 1
v_lshl_add_u32 v3, v4, 6, v3
v_bfe_u32 v4, v0, 1, 1
v_lshl_add_u32 v3, v4, 7, v3
v_and_b32 v4, 1, v0
v_lshl_add_u32 v3, v4, 4, v3
v_and_b32 v4, 31, v0
v_lshlrev_b32 v4, 4, v4
v_mul_u32_u24 v5, 576, v12
v_lshl_add_u32 v5, v11, 2, v5
v_add_u32 v5, 28800, v5
v_add_u32 v6, 2304, v5
v_lshrrev_b32 v11, 3, v0
v_add_u32 v11, 0, v11
v_and_b32 v12, 7, v0
v_mul_u32_u24 v7, 144, v11
v_lshl_add_u32 v7, v12, 4, v7
v_add_u32 v7, 28800, v7
v_mul_u32_u24 v8, 896, v11
v_lshl_add_u32 v8, v12, 3, v8
v_and_b32 v9, 15, v11
v_lshlrev_b32 v9, 4, v9
v_lshrrev_b32 v11, 1, v12
v_lshl_add_u32 v9, v11, 8, v9
v_and_b32 v11, 1, v12
v_lshl_add_u32 v9, v11, 3, v9
v_and_b32 v11, 8, v0
v_cmp_eq_u32 vcc, 0, v11
v_mov_b32 v11, 0x88884444
v_mov_b32 v10, 0xddddeeee
v_cndmask_b32 v10, v10, v11, vcc
s_mul_i32 s34, s21, 28672
s_lshl_b32 s40, s22, 10
s_add_u32 s35, s34, s40
s_add_u32 s35, s35, 4370432
s_lshl_b32 s40, s22, 6
s_add_u32 s34, s34, s40
s_lshl_b32 s40, s22, 15
s_add_u32 s40, s40, 30064640
s_mul_i32 s30, s21, 458752
s_add_u32 s30, s30, s40
s_mul_i32 s27, s29, 458752
s_add_u32 s27, s27, s40
s_lshl_b32 s40, s22, 7
s_add_u32 s40, s40, 8192
s_mul_i32 s28, s29, 1792
s_add_u32 s28, s28, s40
s_mul_i32 s31, s21, 7168
s_add_u32 s31, s31, 634880
s_mul_i32 s32, s21, 40960
s_add_u32 s33, s32, 1781760
s_add_u32 s32, s32, 1748992
s_mov_b32 s25, s21
s_waitcnt vmcnt(56) lgkmcnt(0)
s_branch TB_Y0
TB_TOP0:
s_cmp_lt_u32 s29, 64
s_cbranch_scc0 TB_PV0
TB_Y0:
s_barrier
ds_read_b128 v[16:19], v3
ds_read_b128 v[20:23], v3 offset:32
ds_read_b128 v[24:27], v3 offset:1024
ds_read_b128 v[28:31], v3 offset:1056
s_waitcnt lgkmcnt(2)
v_mfma_f32_16x16x32_bf16 v[116:119], v[16:19], a[0:3], 0
v_mfma_f32_16x16x32_bf16 v[120:123], v[20:23], a[0:3], 0
ds_read_b128 v[32:35], v3 offset:2048
ds_read_b128 v[36:39], v3 offset:2080
v_mfma_f32_16x16x32_bf16 v[124:127], v[16:19], a[56:59], 0
v_mfma_f32_16x16x32_bf16 v[128:131], v[20:23], a[56:59], 0
v_mfma_f32_16x16x32_bf16 v[132:135], v[16:19], a[112:115], 0
v_mfma_f32_16x16x32_bf16 v[136:139], v[20:23], a[112:115], 0
v_mfma_f32_16x16x32_bf16 v[140:143], v[16:19], a[168:171], 0
v_mfma_f32_16x16x32_bf16 v[144:147], v[20:23], a[168:171], 0
s_waitcnt lgkmcnt(2)
v_mfma_f32_16x16x32_bf16 v[116:119], v[24:27], a[4:7], v[116:119]
v_mfma_f32_16x16x32_bf16 v[120:123], v[28:31], a[4:7], v[120:123]
ds_read_b128 v[16:19], v3 offset:3072
ds_read_b128 v[20:23], v3 offset:3104
v_mfma_f32_16x16x32_bf16 v[124:127], v[24:27], a[60:63], v[124:127]
v_mfma_f32_16x16x32_bf16 v[128:131], v[28:31], a[60:63], v[128:131]
v_mfma_f32_16x16x32_bf16 v[132:135], v[24:27], a[116:119], v[132:135]
v_mfma_f32_16x16x32_bf16 v[136:139], v[28:31], a[116:119], v[136:139]
v_mfma_f32_16x16x32_bf16 v[140:143], v[24:27], a[172:175], v[140:143]
v_mfma_f32_16x16x32_bf16 v[144:147], v[28:31], a[172:175], v[144:147]
s_waitcnt lgkmcnt(2)
v_mfma_f32_16x16x32_bf16 v[116:119], v[32:35], a[8:11], v[116:119]
v_mfma_f32_16x16x32_bf16 v[120:123], v[36:39], a[8:11], v[120:123]
ds_read_b128 v[24:27], v3 offset:4096
ds_read_b128 v[28:31], v3 offset:4128
v_mfma_f32_16x16x32_bf16 v[124:127], v[32:35], a[64:67], v[124:127]
v_mfma_f32_16x16x32_bf16 v[128:131], v[36:39], a[64:67], v[128:131]
v_mfma_f32_16x16x32_bf16 v[132:135], v[32:35], a[120:123], v[132:135]
v_mfma_f32_16x16x32_bf16 v[136:139], v[36:39], a[120:123], v[136:139]
v_mfma_f32_16x16x32_bf16 v[140:143], v[32:35], a[176:179], v[140:143]
v_mfma_f32_16x16x32_bf16 v[144:147], v[36:39], a[176:179], v[144:147]
s_waitcnt lgkmcnt(2)
v_mfma_f32_16x16x32_bf16 v[116:119], v[16:19], a[12:15], v[116:119]
v_mfma_f32_16x16x32_bf16 v[120:123], v[20:23], a[12:15], v[120:123]
ds_read_b128 v[32:35], v3 offset:5120
ds_read_b128 v[36:39], v3 offset:5152
v_mfma_f32_16x16x32_bf16 v[124:127], v[16:19], a[68:71], v[124:127]
v_mfma_f32_16x16x32_bf16 v[128:131], v[20:23], a[68:71], v[128:131]
v_mfma_f32_16x16x32_bf16 v[132:135], v[16:19], a[124:127], v[132:135]
v_mfma_f32_16x16x32_bf16 v[136:139], v[20:23], a[124:127], v[136:139]
v_mfma_f32_16x16x32_bf16 v[140:143], v[16:19], a[180:183], v[140:143]
v_mfma_f32_16x16x32_bf16 v[144:147], v[20:23], a[180:183], v[144:147]
s_waitcnt lgkmcnt(2)
v_mfma_f32_16x16x32_bf16 v[116:119], v[24:27], a[16:19], v[116:119]
v_mfma_f32_16x16x32_bf16 v[120:123], v[28:31], a[16:19], v[120:123]
ds_read_b128 v[16:19], v3 offset:6144
ds_read_b128 v[20:23], v3 offset:6176
v_mfma_f32_16x16x32_bf16 v[124:127], v[24:27], a[72:75], v[124:127]
v_mfma_f32_16x16x32_bf16 v[128:131], v[28:31], a[72:75], v[128:131]
v_mfma_f32_16x16x32_bf16 v[132:135], v[24:27], a[128:131], v[132:135]
v_mfma_f32_16x16x32_bf16 v[136:139], v[28:31], a[128:131], v[136:139]
v_mfma_f32_16x16x32_bf16 v[140:143], v[24:27], a[184:187], v[140:143]
v_mfma_f32_16x16x32_bf16 v[144:147], v[28:31], a[184:187], v[144:147]
s_waitcnt lgkmcnt(2)
v_mfma_f32_16x16x32_bf16 v[116:119], v[32:35], a[20:23], v[116:119]
v_mfma_f32_16x16x32_bf16 v[120:123], v[36:39], a[20:23], v[120:123]
ds_read_b128 v[24:27], v3 offset:7168
ds_read_b128 v[28:31], v3 offset:7200
v_mfma_f32_16x16x32_bf16 v[124:127], v[32:35], a[76:79], v[124:127]
v_mfma_f32_16x16x32_bf16 v[128:131], v[36:39], a[76:79], v[128:131]
v_mfma_f32_16x16x32_bf16 v[132:135], v[32:35], a[132:135], v[132:135]
v_mfma_f32_16x16x32_bf16 v[136:139], v[36:39], a[132:135], v[136:139]
v_mfma_f32_16x16x32_bf16 v[140:143], v[32:35], a[188:191], v[140:143]
v_mfma_f32_16x16x32_bf16 v[144:147], v[36:39], a[188:191], v[144:147]
s_waitcnt lgkmcnt(2)
v_mfma_f32_16x16x32_bf16 v[116:119], v[16:19], a[24:27], v[116:119]
v_mfma_f32_16x16x32_bf16 v[120:123], v[20:23], a[24:27], v[120:123]
ds_read_b128 v[32:35], v3 offset:8192
ds_read_b128 v[36:39], v3 offset:8224
v_mfma_f32_16x16x32_bf16 v[124:127], v[16:19], a[80:83], v[124:127]
v_mfma_f32_16x16x32_bf16 v[128:131], v[20:23], a[80:83], v[128:131]
v_mfma_f32_16x16x32_bf16 v[132:135], v[16:19], a[136:139], v[132:135]
v_mfma_f32_16x16x32_bf16 v[136:139], v[20:23], a[136:139], v[136:139]
v_mfma_f32_16x16x32_bf16 v[140:143], v[16:19], a[192:195], v[140:143]
v_mfma_f32_16x16x32_bf16 v[144:147], v[20:23], a[192:195], v[144:147]
s_waitcnt lgkmcnt(2)
v_mfma_f32_16x16x32_bf16 v[116:119], v[24:27], a[28:31], v[116:119]
v_mfma_f32_16x16x32_bf16 v[120:123], v[28:31], a[28:31], v[120:123]
ds_read_b128 v[16:19], v3 offset:9216
ds_read_b128 v[20:23], v3 offset:9248
v_mfma_f32_16x16x32_bf16 v[124:127], v[24:27], a[84:87], v[124:127]
v_mfma_f32_16x16x32_bf16 v[128:131], v[28:31], a[84:87], v[128:131]
v_mfma_f32_16x16x32_bf16 v[132:135], v[24:27], a[140:143], v[132:135]
v_mfma_f32_16x16x32_bf16 v[136:139], v[28:31], a[140:143], v[136:139]
v_mfma_f32_16x16x32_bf16 v[140:143], v[24:27], a[196:199], v[140:143]
v_mfma_f32_16x16x32_bf16 v[144:147], v[28:31], a[196:199], v[144:147]
s_waitcnt lgkmcnt(2)
v_mfma_f32_16x16x32_bf16 v[116:119], v[32:35], a[32:35], v[116:119]
v_mfma_f32_16x16x32_bf16 v[120:123], v[36:39], a[32:35], v[120:123]
ds_read_b128 v[24:27], v3 offset:10240
ds_read_b128 v[28:31], v3 offset:10272
v_mfma_f32_16x16x32_bf16 v[124:127], v[32:35], a[88:91], v[124:127]
v_mfma_f32_16x16x32_bf16 v[128:131], v[36:39], a[88:91], v[128:131]
v_mfma_f32_16x16x32_bf16 v[132:135], v[32:35], a[144:147], v[132:135]
v_mfma_f32_16x16x32_bf16 v[136:139], v[36:39], a[144:147], v[136:139]
v_mfma_f32_16x16x32_bf16 v[140:143], v[32:35], a[200:203], v[140:143]
v_mfma_f32_16x16x32_bf16 v[144:147], v[36:39], a[200:203], v[144:147]
s_waitcnt lgkmcnt(2)
v_mfma_f32_16x16x32_bf16 v[116:119], v[16:19], a[36:39], v[116:119]
v_mfma_f32_16x16x32_bf16 v[120:123], v[20:23], a[36:39], v[120:123]
ds_read_b128 v[32:35], v3 offset:11264
ds_read_b128 v[36:39], v3 offset:11296
v_mfma_f32_16x16x32_bf16 v[124:127], v[16:19], a[92:95], v[124:127]
v_mfma_f32_16x16x32_bf16 v[128:131], v[20:23], a[92:95], v[128:131]
v_mfma_f32_16x16x32_bf16 v[132:135], v[16:19], a[148:151], v[132:135]
v_mfma_f32_16x16x32_bf16 v[136:139], v[20:23], a[148:151], v[136:139]
v_mfma_f32_16x16x32_bf16 v[140:143], v[16:19], a[204:207], v[140:143]
v_mfma_f32_16x16x32_bf16 v[144:147], v[20:23], a[204:207], v[144:147]
s_waitcnt lgkmcnt(2)
v_mfma_f32_16x16x32_bf16 v[116:119], v[24:27], a[40:43], v[116:119]
v_mfma_f32_16x16x32_bf16 v[120:123], v[28:31], a[40:43], v[120:123]
ds_read_b128 v[16:19], v3 offset:12288
ds_read_b128 v[20:23], v3 offset:12320
v_mfma_f32_16x16x32_bf16 v[124:127], v[24:27], a[96:99], v[124:127]
v_mfma_f32_16x16x32_bf16 v[128:131], v[28:31], a[96:99], v[128:131]
v_mfma_f32_16x16x32_bf16 v[132:135], v[24:27], a[152:155], v[132:135]
v_mfma_f32_16x16x32_bf16 v[136:139], v[28:31], a[152:155], v[136:139]
v_mfma_f32_16x16x32_bf16 v[140:143], v[24:27], a[208:211], v[140:143]
v_mfma_f32_16x16x32_bf16 v[144:147], v[28:31], a[208:211], v[144:147]
s_waitcnt lgkmcnt(2)
v_mfma_f32_16x16x32_bf16 v[116:119], v[32:35], a[44:47], v[116:119]
v_mfma_f32_16x16x32_bf16 v[120:123], v[36:39], a[44:47], v[120:123]
ds_read_b128 v[24:27], v3 offset:13312
ds_read_b128 v[28:31], v3 offset:13344
v_mfma_f32_16x16x32_bf16 v[124:127], v[32:35], a[100:103], v[124:127]
v_mfma_f32_16x16x32_bf16 v[128:131], v[36:39], a[100:103], v[128:131]
v_mfma_f32_16x16x32_bf16 v[132:135], v[32:35], a[156:159], v[132:135]
v_mfma_f32_16x16x32_bf16 v[136:139], v[36:39], a[156:159], v[136:139]
v_mfma_f32_16x16x32_bf16 v[140:143], v[32:35], a[212:215], v[140:143]
v_mfma_f32_16x16x32_bf16 v[144:147], v[36:39], a[212:215], v[144:147]
s_waitcnt lgkmcnt(2)
v_mfma_f32_16x16x32_bf16 v[116:119], v[16:19], a[48:51], v[116:119]
v_mfma_f32_16x16x32_bf16 v[120:123], v[20:23], a[48:51], v[120:123]
v_mfma_f32_16x16x32_bf16 v[124:127], v[16:19], a[104:107], v[124:127]
v_mfma_f32_16x16x32_bf16 v[128:131], v[20:23], a[104:107], v[128:131]
v_mfma_f32_16x16x32_bf16 v[132:135], v[16:19], a[160:163], v[132:135]
v_mfma_f32_16x16x32_bf16 v[136:139], v[20:23], a[160:163], v[136:139]
v_mfma_f32_16x16x32_bf16 v[140:143], v[16:19], a[216:219], v[140:143]
v_mfma_f32_16x16x32_bf16 v[144:147], v[20:23], a[216:219], v[144:147]
s_waitcnt lgkmcnt(0)
v_mfma_f32_16x16x32_bf16 v[116:119], v[24:27], a[52:55], v[116:119]
v_mfma_f32_16x16x32_bf16 v[120:123], v[28:31], a[52:55], v[120:123]
v_mfma_f32_16x16x32_bf16 v[124:127], v[24:27], a[108:111], v[124:127]
v_mfma_f32_16x16x32_bf16 v[128:131], v[28:31], a[108:111], v[128:131]
v_mfma_f32_16x16x32_bf16 v[132:135], v[24:27], a[164:167], v[132:135]
v_mfma_f32_16x16x32_bf16 v[136:139], v[28:31], a[164:167], v[136:139]
v_mfma_f32_16x16x32_bf16 v[140:143], v[24:27], a[220:223], v[140:143]
v_mfma_f32_16x16x32_bf16 v[144:147], v[28:31], a[220:223], v[144:147]
s_nop 1
v_cvt_pk_bf16_f32 v44, v116, v117
v_cvt_pk_bf16_f32 v45, v118, v119
v_cvt_pk_bf16_f32 v46, v120, v121
v_cvt_pk_bf16_f32 v47, v122, v123
buffer_store_dwordx4 v[44:47], v1, s[4:7], s27 offen sc1
v_cvt_pk_bf16_f32 v48, v124, v125
v_cvt_pk_bf16_f32 v49, v126, v127
v_cvt_pk_bf16_f32 v50, v128, v129
v_cvt_pk_bf16_f32 v51, v130, v131
buffer_store_dwordx4 v[48:51], v1, s[4:7], s27 offen offset:2048 sc1
v_cvt_pk_bf16_f32 v52, v132, v133
v_cvt_pk_bf16_f32 v53, v134, v135
v_cvt_pk_bf16_f32 v54, v136, v137
v_cvt_pk_bf16_f32 v55, v138, v139
buffer_store_dwordx4 v[52:55], v1, s[4:7], s27 offen offset:1024 sc1
v_cvt_pk_bf16_f32 v56, v140, v141
v_cvt_pk_bf16_f32 v57, v142, v143
v_cvt_pk_bf16_f32 v58, v144, v145
v_cvt_pk_bf16_f32 v59, v146, v147
buffer_store_dwordx4 v[56:59], v1, s[4:7], s27 offen offset:3072 sc1
s_waitcnt vmcnt(4)
ds_read_b128 v[16:19], v3
ds_read_b128 v[20:23], v3 offset:32
ds_read_b128 v[92:95], v2
ds_read_b128 v[96:99], v2 offset:14336
ds_read_b128 v[24:27], v3 offset:1024
ds_read_b128 v[28:31], v3 offset:1056
ds_read_b128 v[100:103], v2 offset:1024
ds_read_b128 v[104:107], v2 offset:15360
s_waitcnt lgkmcnt(4)
v_mfma_f32_16x16x32_bf16 v[116:119], v[16:19], a[224:227], 0
v_mfma_f32_16x16x32_bf16 v[120:123], v[20:23], a[224:227], 0
ds_read_b128 v[32:35], v3 offset:2048
ds_read_b128 v[36:39], v3 offset:2080
ds_read_b128 v[108:111], v2 offset:2048
ds_read_b128 v[112:115], v2 offset:16384
v_mfma_f32_16x16x32_bf16 v[124:127], v[16:19], v[200:203], 0
v_mfma_f32_16x16x32_bf16 v[128:131], v[20:23], v[200:203], 0
v_mfma_f32_16x16x32_bf16 v[132:135], v[16:19], v[92:95], 0
v_mfma_f32_16x16x32_bf16 v[136:139], v[20:23], v[92:95], 0
v_mfma_f32_16x16x32_bf16 v[140:143], v[16:19], v[96:99], 0
v_mfma_f32_16x16x32_bf16 v[144:147], v[20:23], v[96:99], 0
s_waitcnt lgkmcnt(4)
v_mfma_f32_16x16x32_bf16 v[116:119], v[24:27], a[228:231], v[116:119]
v_mfma_f32_16x16x32_bf16 v[120:123], v[28:31], a[228:231], v[120:123]
ds_read_b128 v[16:19], v3 offset:3072
ds_read_b128 v[20:23], v3 offset:3104
ds_read_b128 v[92:95], v2 offset:3072
ds_read_b128 v[96:99], v2 offset:17408
v_mfma_f32_16x16x32_bf16 v[124:127], v[24:27], v[204:207], v[124:127]
v_mfma_f32_16x16x32_bf16 v[128:131], v[28:31], v[204:207], v[128:131]
v_mfma_f32_16x16x32_bf16 v[132:135], v[24:27], v[100:103], v[132:135]
v_mfma_f32_16x16x32_bf16 v[136:139], v[28:31], v[100:103], v[136:139]
v_mfma_f32_16x16x32_bf16 v[140:143], v[24:27], v[104:107], v[140:143]
v_mfma_f32_16x16x32_bf16 v[144:147], v[28:31], v[104:107], v[144:147]
s_waitcnt lgkmcnt(4)
v_mfma_f32_16x16x32_bf16 v[116:119], v[32:35], a[232:235], v[116:119]
v_mfma_f32_16x16x32_bf16 v[120:123], v[36:39], a[232:235], v[120:123]
ds_read_b128 v[24:27], v3 offset:4096
ds_read_b128 v[28:31], v3 offset:4128
ds_read_b128 v[100:103], v2 offset:4096
ds_read_b128 v[104:107], v2 offset:18432
v_mfma_f32_16x16x32_bf16 v[124:127], v[32:35], v[208:211], v[124:127]
v_mfma_f32_16x16x32_bf16 v[128:131], v[36:39], v[208:211], v[128:131]
v_mfma_f32_16x16x32_bf16 v[132:135], v[32:35], v[108:111], v[132:135]
v_mfma_f32_16x16x32_bf16 v[136:139], v[36:39], v[108:111], v[136:139]
v_mfma_f32_16x16x32_bf16 v[140:143], v[32:35], v[112:115], v[140:143]
v_mfma_f32_16x16x32_bf16 v[144:147], v[36:39], v[112:115], v[144:147]
s_waitcnt lgkmcnt(4)
v_mfma_f32_16x16x32_bf16 v[116:119], v[16:19], a[236:239], v[116:119]
v_mfma_f32_16x16x32_bf16 v[120:123], v[20:23], a[236:239], v[120:123]
ds_read_b128 v[32:35], v3 offset:5120
ds_read_b128 v[36:39], v3 offset:5152
ds_read_b128 v[108:111], v2 offset:5120
ds_read_b128 v[112:115], v2 offset:19456
v_mfma_f32_16x16x32_bf16 v[124:127], v[16:19], v[212:215], v[124:127]
v_mfma_f32_16x16x32_bf16 v[128:131], v[20:23], v[212:215], v[128:131]
v_mfma_f32_16x16x32_bf16 v[132:135], v[16:19], v[92:95], v[132:135]
v_mfma_f32_16x16x32_bf16 v[136:139], v[20:23], v[92:95], v[136:139]
v_mfma_f32_16x16x32_bf16 v[140:143], v[16:19], v[96:99], v[140:143]
v_mfma_f32_16x16x32_bf16 v[144:147], v[20:23], v[96:99], v[144:147]
s_waitcnt lgkmcnt(4)
v_mfma_f32_16x16x32_bf16 v[116:119], v[24:27], a[240:243], v[116:119]
v_mfma_f32_16x16x32_bf16 v[120:123], v[28:31], a[240:243], v[120:123]
ds_read_b128 v[16:19], v3 offset:6144
ds_read_b128 v[20:23], v3 offset:6176
ds_read_b128 v[92:95], v2 offset:6144
ds_read_b128 v[96:99], v2 offset:20480
v_mfma_f32_16x16x32_bf16 v[124:127], v[24:27], v[216:219], v[124:127]
v_mfma_f32_16x16x32_bf16 v[128:131], v[28:31], v[216:219], v[128:131]
v_mfma_f32_16x16x32_bf16 v[132:135], v[24:27], v[100:103], v[132:135]
v_mfma_f32_16x16x32_bf16 v[136:139], v[28:31], v[100:103], v[136:139]
v_mfma_f32_16x16x32_bf16 v[140:143], v[24:27], v[104:107], v[140:143]
v_mfma_f32_16x16x32_bf16 v[144:147], v[28:31], v[104:107], v[144:147]
s_waitcnt lgkmcnt(4)
v_mfma_f32_16x16x32_bf16 v[116:119], v[32:35], a[244:247], v[116:119]
v_mfma_f32_16x16x32_bf16 v[120:123], v[36:39], a[244:247], v[120:123]
ds_read_b128 v[24:27], v3 offset:7168
ds_read_b128 v[28:31], v3 offset:7200
ds_read_b128 v[100:103], v2 offset:7168
ds_read_b128 v[104:107], v2 offset:21504
v_mfma_f32_16x16x32_bf16 v[124:127], v[32:35], v[220:223], v[124:127]
v_mfma_f32_16x16x32_bf16 v[128:131], v[36:39], v[220:223], v[128:131]
v_mfma_f32_16x16x32_bf16 v[132:135], v[32:35], v[108:111], v[132:135]
v_mfma_f32_16x16x32_bf16 v[136:139], v[36:39], v[108:111], v[136:139]
v_mfma_f32_16x16x32_bf16 v[140:143], v[32:35], v[112:115], v[140:143]
v_mfma_f32_16x16x32_bf16 v[144:147], v[36:39], v[112:115], v[144:147]
s_waitcnt lgkmcnt(4)
v_mfma_f32_16x16x32_bf16 v[116:119], v[16:19], a[248:251], v[116:119]
v_mfma_f32_16x16x32_bf16 v[120:123], v[20:23], a[248:251], v[120:123]
ds_read_b128 v[32:35], v3 offset:8192
ds_read_b128 v[36:39], v3 offset:8224
ds_read_b128 v[108:111], v2 offset:8192
ds_read_b128 v[112:115], v2 offset:22528
v_mfma_f32_16x16x32_bf16 v[124:127], v[16:19], v[224:227], v[124:127]
v_mfma_f32_16x16x32_bf16 v[128:131], v[20:23], v[224:227], v[128:131]
v_mfma_f32_16x16x32_bf16 v[132:135], v[16:19], v[92:95], v[132:135]
v_mfma_f32_16x16x32_bf16 v[136:139], v[20:23], v[92:95], v[136:139]
v_mfma_f32_16x16x32_bf16 v[140:143], v[16:19], v[96:99], v[140:143]
v_mfma_f32_16x16x32_bf16 v[144:147], v[20:23], v[96:99], v[144:147]
s_waitcnt lgkmcnt(4)
v_mfma_f32_16x16x32_bf16 v[116:119], v[24:27], a[252:255], v[116:119]
v_mfma_f32_16x16x32_bf16 v[120:123], v[28:31], a[252:255], v[120:123]
ds_read_b128 v[16:19], v3 offset:9216
ds_read_b128 v[20:23], v3 offset:9248
ds_read_b128 v[92:95], v2 offset:9216
ds_read_b128 v[96:99], v2 offset:23552
v_mfma_f32_16x16x32_bf16 v[124:127], v[24:27], v[228:231], v[124:127]
v_mfma_f32_16x16x32_bf16 v[128:131], v[28:31], v[228:231], v[128:131]
v_mfma_f32_16x16x32_bf16 v[132:135], v[24:27], v[100:103], v[132:135]
v_mfma_f32_16x16x32_bf16 v[136:139], v[28:31], v[100:103], v[136:139]
v_mfma_f32_16x16x32_bf16 v[140:143], v[24:27], v[104:107], v[140:143]
v_mfma_f32_16x16x32_bf16 v[144:147], v[28:31], v[104:107], v[144:147]
s_waitcnt lgkmcnt(4)
v_mfma_f32_16x16x32_bf16 v[116:119], v[32:35], v[176:179], v[116:119]
v_mfma_f32_16x16x32_bf16 v[120:123], v[36:39], v[176:179], v[120:123]
ds_read_b128 v[24:27], v3 offset:10240
ds_read_b128 v[28:31], v3 offset:10272
ds_read_b128 v[100:103], v2 offset:10240
ds_read_b128 v[104:107], v2 offset:24576
v_mfma_f32_16x16x32_bf16 v[124:127], v[32:35], v[232:235], v[124:127]
v_mfma_f32_16x16x32_bf16 v[128:131], v[36:39], v[232:235], v[128:131]
v_mfma_f32_16x16x32_bf16 v[132:135], v[32:35], v[108:111], v[132:135]
v_mfma_f32_16x16x32_bf16 v[136:139], v[36:39], v[108:111], v[136:139]
v_mfma_f32_16x16x32_bf16 v[140:143], v[32:35], v[112:115], v[140:143]
v_mfma_f32_16x16x32_bf16 v[144:147], v[36:39], v[112:115], v[144:147]
s_waitcnt lgkmcnt(4)
v_mfma_f32_16x16x32_bf16 v[116:119], v[16:19], v[180:183], v[116:119]
v_mfma_f32_16x16x32_bf16 v[120:123], v[20:23], v[180:183], v[120:123]
ds_read_b128 v[32:35], v3 offset:11264
ds_read_b128 v[36:39], v3 offset:11296
ds_read_b128 v[108:111], v2 offset:11264
ds_read_b128 v[112:115], v2 offset:25600
v_mfma_f32_16x16x32_bf16 v[124:127], v[16:19], v[236:239], v[124:127]
v_mfma_f32_16x16x32_bf16 v[128:131], v[20:23], v[236:239], v[128:131]
v_mfma_f32_16x16x32_bf16 v[132:135], v[16:19], v[92:95], v[132:135]
v_mfma_f32_16x16x32_bf16 v[136:139], v[20:23], v[92:95], v[136:139]
v_mfma_f32_16x16x32_bf16 v[140:143], v[16:19], v[96:99], v[140:143]
v_mfma_f32_16x16x32_bf16 v[144:147], v[20:23], v[96:99], v[144:147]
s_waitcnt lgkmcnt(4)
v_mfma_f32_16x16x32_bf16 v[116:119], v[24:27], v[184:187], v[116:119]
v_mfma_f32_16x16x32_bf16 v[120:123], v[28:31], v[184:187], v[120:123]
ds_read_b128 v[16:19], v3 offset:12288
ds_read_b128 v[20:23], v3 offset:12320
ds_read_b128 v[92:95], v2 offset:12288
ds_read_b128 v[96:99], v2 offset:26624
v_mfma_f32_16x16x32_bf16 v[124:127], v[24:27], v[240:243], v[124:127]
v_mfma_f32_16x16x32_bf16 v[128:131], v[28:31], v[240:243], v[128:131]
v_mfma_f32_16x16x32_bf16 v[132:135], v[24:27], v[100:103], v[132:135]
v_mfma_f32_16x16x32_bf16 v[136:139], v[28:31], v[100:103], v[136:139]
v_mfma_f32_16x16x32_bf16 v[140:143], v[24:27], v[104:107], v[140:143]
v_mfma_f32_16x16x32_bf16 v[144:147], v[28:31], v[104:107], v[144:147]
s_waitcnt lgkmcnt(4)
v_mfma_f32_16x16x32_bf16 v[116:119], v[32:35], v[188:191], v[116:119]
v_mfma_f32_16x16x32_bf16 v[120:123], v[36:39], v[188:191], v[120:123]
ds_read_b128 v[24:27], v3 offset:13312
ds_read_b128 v[28:31], v3 offset:13344
ds_read_b128 v[100:103], v2 offset:13312
ds_read_b128 v[104:107], v2 offset:27648
v_mfma_f32_16x16x32_bf16 v[124:127], v[32:35], v[244:247], v[124:127]
v_mfma_f32_16x16x32_bf16 v[128:131], v[36:39], v[244:247], v[128:131]
v_mfma_f32_16x16x32_bf16 v[132:135], v[32:35], v[108:111], v[132:135]
v_mfma_f32_16x16x32_bf16 v[136:139], v[36:39], v[108:111], v[136:139]
v_mfma_f32_16x16x32_bf16 v[140:143], v[32:35], v[112:115], v[140:143]
v_mfma_f32_16x16x32_bf16 v[144:147], v[36:39], v[112:115], v[144:147]
s_waitcnt lgkmcnt(4)
v_mfma_f32_16x16x32_bf16 v[116:119], v[16:19], v[192:195], v[116:119]
v_mfma_f32_16x16x32_bf16 v[120:123], v[20:23], v[192:195], v[120:123]
v_mfma_f32_16x16x32_bf16 v[124:127], v[16:19], v[248:251], v[124:127]
v_mfma_f32_16x16x32_bf16 v[128:131], v[20:23], v[248:251], v[128:131]
v_mfma_f32_16x16x32_bf16 v[132:135], v[16:19], v[92:95], v[132:135]
v_mfma_f32_16x16x32_bf16 v[136:139], v[20:23], v[92:95], v[136:139]
v_mfma_f32_16x16x32_bf16 v[140:143], v[16:19], v[96:99], v[140:143]
v_mfma_f32_16x16x32_bf16 v[144:147], v[20:23], v[96:99], v[144:147]
s_waitcnt lgkmcnt(0)
v_mfma_f32_16x16x32_bf16 v[116:119], v[24:27], v[196:199], v[116:119]
v_mfma_f32_16x16x32_bf16 v[120:123], v[28:31], v[196:199], v[120:123]
v_mfma_f32_16x16x32_bf16 v[124:127], v[24:27], v[252:255], v[124:127]
v_mfma_f32_16x16x32_bf16 v[128:131], v[28:31], v[252:255], v[128:131]
v_mfma_f32_16x16x32_bf16 v[132:135], v[24:27], v[100:103], v[132:135]
v_mfma_f32_16x16x32_bf16 v[136:139], v[28:31], v[100:103], v[136:139]
v_mfma_f32_16x16x32_bf16 v[140:143], v[24:27], v[104:107], v[140:143]
v_mfma_f32_16x16x32_bf16 v[144:147], v[28:31], v[104:107], v[144:147]
s_nop 1
s_add_u32 s40, s27, 4096
v_cvt_pk_bf16_f32 v60, v116, v117
v_cvt_pk_bf16_f32 v61, v118, v119
v_cvt_pk_bf16_f32 v62, v120, v121
v_cvt_pk_bf16_f32 v63, v122, v123
buffer_store_dwordx4 v[60:63], v1, s[4:7], s40 offen sc1
v_cvt_pk_bf16_f32 v64, v124, v125
v_cvt_pk_bf16_f32 v65, v126, v127
v_cvt_pk_bf16_f32 v66, v128, v129
v_cvt_pk_bf16_f32 v67, v130, v131
buffer_store_dwordx4 v[64:67], v1, s[4:7], s40 offen offset:2048 sc1
v_cvt_pk_bf16_f32 v68, v132, v133
v_cvt_pk_bf16_f32 v69, v134, v135
v_cvt_pk_bf16_f32 v70, v136, v137
v_cvt_pk_bf16_f32 v71, v138, v139
buffer_store_dwordx4 v[68:71], v1, s[4:7], s40 offen offset:1024 sc1
v_cvt_pk_bf16_f32 v72, v140, v141
v_cvt_pk_bf16_f32 v73, v142, v143
v_cvt_pk_bf16_f32 v74, v144, v145
v_cvt_pk_bf16_f32 v75, v146, v147
buffer_store_dwordx4 v[72:75], v1, s[4:7], s40 offen offset:3072 sc1
s_mov_b32 s36, s28
s_cmp_lt_u32 s29, 4
s_cselect_b32 s41, 2, 4
s_mul_i32 s40, s41, 28672
s_add_u32 s26, s26, s40
s_mul_i32 s40, s41, 458752
s_add_u32 s27, s27, s40
s_mul_i32 s40, s41, 1792
s_add_u32 s28, s28, s40
s_mul_i32 s40, s41, 1
s_add_u32 s29, s29, s40
s_cmp_lt_u32 s25, 4
s_cbranch_scc0 TB_PV0
s_cmp_lt_u32 s29, 20
s_cbranch_scc0 TB_PV00
s_barrier
s_mov_b32 m0, 0
s_add_u32 s40, s26, 0
buffer_load_dwordx4 v1, s[4:7], s40 offen lds
s_mov_b32 m0, 1024
s_add_u32 s40, s26, 1024
buffer_load_dwordx4 v1, s[4:7], s40 offen lds
s_mov_b32 m0, 2048
s_add_u32 s40, s26, 2048
buffer_load_dwordx4 v1, s[4:7], s40 offen lds
s_mov_b32 m0, 3072
s_add_u32 s40, s26, 3072
buffer_load_dwordx4 v1, s[4:7], s40 offen lds
s_mov_b32 m0, 4096
s_add_u32 s40, s26, 4096
buffer_load_dwordx4 v1, s[4:7], s40 offen lds
s_mov_b32 m0, 5120
s_add_u32 s40, s26, 5120
buffer_load_dwordx4 v1, s[4:7], s40 offen lds
s_mov_b32 m0, 6144
s_add_u32 s40, s26, 6144
buffer_load_dwordx4 v1, s[4:7], s40 offen lds
s_waitcnt vmcnt(7)
v_mov_b32 v12, s88
buffer_store_dword v12, off, s[4:7], s36 sc1
s_mov_b32 s36, 0
s_waitcnt vmcnt(1)
s_branch TB_Y0
TB_PV00:
s_waitcnt vmcnt(0)
v_mov_b32 v12, s88
buffer_store_dword v12, off, s[4:7], s36 sc1
s_mov_b32 s36, 0
v_min_u32 v14, 55, v0
v_and_b32 v11, 3, v14
v_lshlrev_b32 v11, 3, v11
v_lshrrev_b32 v14, 2, v14
v_lshl_add_u32 v11, v14, 7, v11
s_mov_b32 s43, 4352
Llz_210:
buffer_load_dwordx2 v[14:15], v11, s[4:7], s43 offen sc1
s_waitcnt vmcnt(0)
v_cmp_ne_u32 vcc, s88, v14
v_cmp_ne_u32 s[40:41], s88, v15
s_or_b64 vcc, vcc, s[40:41]
s_cbranch_vccz Llzok_211
s_sleep 8
s_sub_u32 s24, s24, 1
s_cbranch_scc0 Llz_210
s_endpgm
Llzok_211:
v_min_u32 v14, 47, v0
v_and_b32 v11, 3, v14
v_lshlrev_b32 v11, 3, v11
v_lshrrev_b32 v14, 2, v14
v_lshl_add_u32 v11, v14, 7, v11
s_mov_b32 s43, 6144
Llz_212:
buffer_load_dwordx2 v[14:15], v11, s[4:7], s43 offen sc1
s_waitcnt vmcnt(0)
v_cmp_ne_u32 vcc, s88, v14
v_cmp_ne_u32 s[40:41], s88, v15
s_or_b64 vcc, vcc, s[40:41]
s_cbranch_vccz Llzok_213
s_sleep 8
s_sub_u32 s24, s24, 1
s_cbranch_scc0 Llz_212
s_endpgm
Llzok_213:
TB_PV0:
s_barrier
s_cmp_lt_u32 s29, 64
s_cbranch_scc0 Lnorows_214
s_mov_b32 m0, 0
s_add_u32 s40, s26, 0
buffer_load_dwordx4 v1, s[4:7], s40 offen lds
s_mov_b32 m0, 1024
s_add_u32 s40, s26, 1024
buffer_load_dwordx4 v1, s[4:7], s40 offen lds
s_mov_b32 m0, 2048
s_add_u32 s40, s26, 2048
buffer_load_dwordx4 v1, s[4:7], s40 offen lds
s_mov_b32 m0, 3072
s_add_u32 s40, s26, 3072
buffer_load_dwordx4 v1, s[4:7], s40 offen lds
s_mov_b32 m0, 4096
s_add_u32 s40, s26, 4096
buffer_load_dwordx4 v1, s[4:7], s40 offen lds
s_mov_b32 m0, 5120
s_add_u32 s40, s26, 5120
buffer_load_dwordx4 v1, s[4:7], s40 offen lds
s_mov_b32 m0, 6144
s_add_u32 s40, s26, 6144
buffer_load_dwordx4 v1, s[4:7], s40 offen lds
Lnorows_214:
s_cmp_lt_u32 s25, 8
s_cbranch_scc0 Lmine_215
s_lshl_b32 s40, s25, 7
s_add_u32 s40, s40, 139264
s_branch Lfirst_217
Lflag_216:
v_cmp_ne_u32 vcc, s88, v11
s_cbranch_vccz Lset_218
s_sleep 16
Lfirst_217:
buffer_load_dword v11, off, s[4:7], s40 sc1
s_waitcnt vmcnt(0)
s_sub_u32 s24, s24, 1
s_cbranch_scc0 Lflag_216
s_endpgm
Lset_218:
Lmine_215:
s_add_u32 s40, s30, 4096
buffer_load_dwordx4 v[44:47], v1, s[4:7], s30 offen sc1
buffer_load_dwordx4 v[48:51], v1, s[4:7], s30 offen offset:1024 sc1
buffer_load_dwordx4 v[52:55], v1, s[4:7], s30 offen offset:2048 sc1
buffer_load_dwordx4 v[56:59], v1, s[4:7], s30 offen offset:3072 sc1
buffer_load_dwordx4 v[60:63], v1, s[4:7], s40 offen sc1
buffer_load_dwordx4 v[64:67], v1, s[4:7], s40 offen offset:1024 sc1
buffer_load_dwordx4 v[68:71], v1, s[4:7], s40 offen offset:2048 sc1
buffer_load_dwordx4 v[72:75], v1, s[4:7], s40 offen offset:3072 sc1
buffer_load_dwordx2 v[14:15], v8, s[8:11], s34 offen
ds_read_b128 v[92:95], v2
ds_read_b128 v[96:99], v2 offset:1024
ds_read_b128 v[100:103], v2 offset:2048
ds_read_b128 v[104:107], v2 offset:3072
ds_read_b128 v[108:111], v2 offset:4096
ds_read_b128 v[112:115], v2 offset:5120
v_mov_b32 v116, 0
v_mov_b32 v117, 0
v_mov_b32 v118, 0
v_mov_b32 v119, 0
v_mov_b32 v120, 0
v_mov_b32 v121, 0
v_mov_b32 v122, 0
v_mov_b32 v123, 0
v_mov_b32 v124, 0
v_mov_b32 v125, 0
v_mov_b32 v126, 0
v_mov_b32 v127, 0
v_mov_b32 v128, 0
v_mov_b32 v129, 0
v_mov_b32 v130, 0
v_mov_b32 v131, 0
v_mov_b32 v132, 0
v_mov_b32 v133, 0
v_mov_b32 v134, 0
v_mov_b32 v135, 0
v_mov_b32 v136, 0
v_mov_b32 v137, 0
v_mov_b32 v138, 0
v_mov_b32 v139, 0
v_mov_b32 v140, 0
v_mov_b32 v141, 0
v_mov_b32 v142, 0
v_mov_b32 v143, 0
v_mov_b32 v144, 0
v_mov_b32 v145, 0
v_mov_b32 v146, 0
v_mov_b32 v147, 0
Lspin_219:
buffer_load_dwordx4 v[16:19], v1, s[4:7], s31 offen sc1
buffer_load_dwordx4 v[20:23], v1, s[4:7], s31 offen offset:1024 sc1
s_sub_u32 s24, s24, 1
s_cbranch_scc1 CODE_END
s_waitcnt vmcnt(0)
v_max3_u32 v11, v16, v17, v18
v_max3_u32 v11, v11, v19, v20
v_max3_u32 v11, v11, v21, v22
v_max_u32 v11, v11, v23
v_cmp_eq_u32 vcc, -1, v11
s_cbranch_vccz Lspin_219x
s_cmp_ge_u32 s25, 58
s_cbranch_scc1 Lspin_219
s_sleep 8
s_branch Lspin_219
Lspin_219x:
s_cmp_eq_u32 s36, 0
s_cbranch_scc1 Lpaid_220
v_mov_b32 v12, s88
buffer_store_dword v12, off, s[4:7], s36 sc1
s_mov_b32 s36, 0
Lpaid_220:
ds_write_b128 v1, v[16:19] offset:28800
ds_write_b128 v1, v[20:23] offset:29824
s_waitcnt lgkmcnt(0)
s_barrier
ds_read_b128 v[24:27], v1 offset:30848
ds_read_b128 v[28:31], v1 offset:31872
ds_read_b128 v[32:35], v1 offset:32896
ds_read_b128 v[36:39], v1 offset:33920
ds_read_b128 v[40:43], v1 offset:34944
v_smfmac_f32_16x16x64_bf16 v[116:119], v[16:19], a[0:7], v10
v_smfmac_f32_16x16x64_bf16 v[120:123], v[16:19], a[56:63], v10
v_smfmac_f32_16x16x64_bf16 v[124:127], v[16:19], a[112:119], v10
v_smfmac_f32_16x16x64_bf16 v[128:131], v[16:19], v[92:99], v10
v_smfmac_f32_16x16x64_bf16 v[116:119], v[20:23], a[8:15], v10
ds_read_b128 v[92:95], v2 offset:6144
v_smfmac_f32_16x16x64_bf16 v[120:123], v[20:23], a[64:71], v10
ds_read_b128 v[96:99], v2 offset:7168
v_smfmac_f32_16x16x64_bf16 v[124:127], v[20:23], a[120:127], v10
v_smfmac_f32_16x16x64_bf16 v[128:131], v[20:23], v[100:107], v10
s_waitcnt lgkmcnt(6)
v_smfmac_f32_16x16x64_bf16 v[116:119], v[24:27], a[16:23], v10
ds_read_b128 v[100:103], v2 offset:8192
v_smfmac_f32_16x16x64_bf16 v[120:123], v[24:27], a[72:79], v10
ds_read_b128 v[104:107], v2 offset:9216
v_smfmac_f32_16x16x64_bf16 v[124:127], v[24:27], a[128:135], v10
v_smfmac_f32_16x16x64_bf16 v[128:131], v[24:27], v[108:115], v10
s_waitcnt lgkmcnt(7)
v_smfmac_f32_16x16x64_bf16 v[116:119], v[28:31], a[24:31], v10
ds_read_b128 v[108:111], v2 offset:10240
v_smfmac_f32_16x16x64_bf16 v[120:123], v[28:31], a[80:87], v10
ds_read_b128 v[112:115], v2 offset:11264
v_smfmac_f32_16x16x64_bf16 v[124:127], v[28:31], a[136:143], v10
s_waitcnt lgkmcnt(4)
v_smfmac_f32_16x16x64_bf16 v[128:131], v[28:31], v[92:99], v10
v_smfmac_f32_16x16x64_bf16 v[116:119], v[32:35], a[32:39], v10
ds_read_b128 v[92:95], v2 offset:12288
v_smfmac_f32_16x16x64_bf16 v[120:123], v[32:35], a[88:95], v10
ds_read_b128 v[96:99], v2 offset:13312
v_smfmac_f32_16x16x64_bf16 v[124:127], v[32:35], a[144:151], v10
s_waitcnt lgkmcnt(4)
v_smfmac_f32_16x16x64_bf16 v[128:131], v[32:35], v[100:107], v10
v_smfmac_f32_16x16x64_bf16 v[116:119], v[36:39], a[40:47], v10
ds_read_b128 v[100:103], v2 offset:14336
v_smfmac_f32_16x16x64_bf16 v[120:123], v[36:39], a[96:103], v10
ds_read_b128 v[104:107], v2 offset:15360
v_smfmac_f32_16x16x64_bf16 v[124:127], v[36:39], a[152:159], v10
s_waitcnt lgkmcnt(4)
v_smfmac_f32_16x16x64_bf16 v[128:131], v[36:39], v[108:115], v10
v_smfmac_f32_16x16x64_bf16 v[116:119], v[40:43], a[48:55], v10
ds_read_b128 v[108:111], v2 offset:16384
v_smfmac_f32_16x16x64_bf16 v[120:123], v[40:43], a[104:111], v10
ds_read_b128 v[112:115], v2 offset:17408
v_smfmac_f32_16x16x64_bf16 v[124:127], v[40:43], a[160:167], v10
s_waitcnt lgkmcnt(4)
v_smfmac_f32_16x16x64_bf16 v[128:131], v[40:43], v[92:99], v10
v_smfmac_f32_16x16x64_bf16 v[132:135], v[16:19], a[168:175], v10
ds_read_b128 v[92:95], v2 offset:18432
v_smfmac_f32_16x16x64_bf16 v[136:139], v[16:19], a[224:231], v10
ds_read_b128 v[96:99], v2 offset:19456
v_smfmac_f32_16x16x64_bf16 v[140:143], v[16:19], v[200:207], v10
v_cvt_pk_bf16_f32 v76, v116, v117
s_waitcnt lgkmcnt(4)
v_smfmac_f32_16x16x64_bf16 v[144:147], v[16:19], v[100:107], v10
v_cvt_pk_bf16_f32 v77, v118, v119
v_smfmac_f32_16x16x64_bf16 v[132:135], v[20:23], a[176:183], v10
ds_read_b128 v[100:103], v2 offset:20480
v_smfmac_f32_16x16x64_bf16 v[136:139], v[20:23], a[232:239], v10
ds_read_b128 v[104:107], v2 offset:21504
v_smfmac_f32_16x16x64_bf16 v[140:143], v[20:23], v[208:215], v10
v_cvt_pk_bf16_f32 v84, v120, v121
s_waitcnt lgkmcnt(4)
v_smfmac_f32_16x16x64_bf16 v[144:147], v[20:23], v[108:115], v10
v_cvt_pk_bf16_f32 v85, v122, v123
v_smfmac_f32_16x16x64_bf16 v[132:135], v[24:27], a[184:191], v10
ds_read_b128 v[108:111], v2 offset:22528
v_smfmac_f32_16x16x64_bf16 v[136:139], v[24:27], a[240:247], v10
ds_read_b128 v[112:115], v2 offset:23552
v_smfmac_f32_16x16x64_bf16 v[140:143], v[24:27], v[216:223], v10
v_cvt_pk_bf16_f32 v78, v124, v125
s_waitcnt lgkmcnt(4)
v_smfmac_f32_16x16x64_bf16 v[144:147], v[24:27], v[92:99], v10
v_cvt_pk_bf16_f32 v79, v126, v127
v_smfmac_f32_16x16x64_bf16 v[132:135], v[28:31], a[192:199], v10
ds_read_b128 v[92:95], v2 offset:24576
v_smfmac_f32_16x16x64_bf16 v[136:139], v[28:31], a[248:255], v10
ds_read_b128 v[96:99], v2 offset:25600
v_smfmac_f32_16x16x64_bf16 v[140:143], v[28:31], v[224:231], v10
v_cvt_pk_bf16_f32 v82, v128, v129
s_waitcnt lgkmcnt(4)
v_smfmac_f32_16x16x64_bf16 v[144:147], v[28:31], v[100:107], v10
v_cvt_pk_bf16_f32 v83, v130, v131
v_smfmac_f32_16x16x64_bf16 v[132:135], v[32:35], a[200:207], v10
ds_read_b128 v[100:103], v2 offset:26624
v_smfmac_f32_16x16x64_bf16 v[136:139], v[32:35], v[176:183], v10
ds_read_b128 v[104:107], v2 offset:27648
v_smfmac_f32_16x16x64_bf16 v[140:143], v[32:35], v[232:239], v10
s_waitcnt lgkmcnt(4)
v_smfmac_f32_16x16x64_bf16 v[144:147], v[32:35], v[108:115], v10
v_smfmac_f32_16x16x64_bf16 v[132:135], v[36:39], a[208:215], v10
v_smfmac_f32_16x16x64_bf16 v[136:139], v[36:39], v[184:191], v10
v_smfmac_f32_16x16x64_bf16 v[140:143], v[36:39], v[240:247], v10
s_waitcnt lgkmcnt(2)
v_smfmac_f32_16x16x64_bf16 v[144:147], v[36:39], v[92:99], v10
v_smfmac_f32_16x16x64_bf16 v[132:135], v[40:43], a[216:223], v10
v_smfmac_f32_16x16x64_bf16 v[136:139], v[40:43], v[192:199], v10
v_smfmac_f32_16x16x64_bf16 v[140:143], v[40:43], v[248:255], v10
s_waitcnt lgkmcnt(0)
v_smfmac_f32_16x16x64_bf16 v[144:147], v[40:43], v[100:107], v10
s_nop 2
v_cvt_pk_bf16_f32 v86, v132, v133
v_cvt_pk_bf16_f32 v87, v134, v135
v_cvt_pk_bf16_f32 v80, v136, v137
v_cvt_pk_bf16_f32 v81, v138, v139
v_cvt_pk_bf16_f32 v88, v140, v141
v_cvt_pk_bf16_f32 v89, v142, v143
v_cvt_pk_bf16_f32 v90, v144, v145
v_cvt_pk_bf16_f32 v91, v146, v147
s_barrier
s_add_u32 s40, s32, 4096
Lpoll_221:
buffer_load_dwordx4 v[16:19], v1, s[4:7], s32 offen sc1
buffer_load_dwordx4 v[20:23], v1, s[4:7], s32 offen offset:1024 sc1
buffer_load_dwordx4 v[24:27], v1, s[4:7], s32 offen offset:2048 sc1
buffer_load_dwordx4 v[28:31], v1, s[4:7], s32 offen offset:3072 sc1
buffer_load_dwordx4 v[32:35], v1, s[4:7], s40 offen sc1
buffer_load_dwordx4 v[36:39], v1, s[4:7], s40 offen offset:1024 sc1
buffer_load_dwordx4 v[40:43], v1, s[4:7], s40 offen offset:2048 sc1
buffer_load_dwordx4 v[92:95], v1, s[4:7], s40 offen offset:3072 sc1
buffer_load_dwordx4 v[96:99], v4, s[4:7], s33 offen sc1
buffer_load_dwordx4 v[100:103], v4, s[4:7], s33 offen offset:512 sc1
buffer_load_dwordx4 v[104:107], v4, s[4:7], s33 offen offset:1024 sc1
buffer_load_dwordx4 v[108:111], v4, s[4:7], s33 offen offset:1536 sc1
s_waitcnt vmcnt(0)
v_max3_u32 v11, v16, v17, v18
v_max3_u32 v11, v11, v19, v20
v_max3_u32 v11, v11, v21, v22
v_max3_u32 v11, v11, v23, v24
v_max3_u32 v11, v11, v25, v26
v_max3_u32 v11, v11, v27, v28
v_max3_u32 v11, v11, v29, v30
v_max3_u32 v11, v11, v31, v32
v_max3_u32 v11, v11, v33, v34
v_max3_u32 v11, v11, v35, v36
v_max3_u32 v11, v11, v37, v38
v_max3_u32 v11, v11, v39, v40
v_max3_u32 v11, v11, v41, v42
v_max3_u32 v11, v11, v43, v92
v_max3_u32 v11, v11, v93, v94
v_max3_u32 v11, v11, v95, v96
v_max3_u32 v11, v11, v97, v98
v_max3_u32 v11, v11, v99, v100
v_max3_u32 v11, v11, v101, v102
v_max3_u32 v11, v11, v103, v104
v_max3_u32 v11, v11, v105, v106
v_max3_u32 v11, v11, v107, v108
v_max3_u32 v11, v11, v109, v110
v_max_u32 v11, v11, v111
v_cmp_eq_u32 vcc, -1, v11
s_cbranch_vccz Lgot_222
s_sub_u32 s24, s24, 1
s_cbranch_scc0 Lpoll_221
s_endpgm
Lgot_222:
v_mfma_f32_16x16x32_bf16 v[116:119], v[16:19], v[44:47], 0
v_mfma_f32_16x16x32_bf16 v[120:123], v[16:19], v[52:55], 0
v_mfma_f32_16x16x32_bf16 v[124:127], v[20:23], v[44:47], 0
v_mfma_f32_16x16x32_bf16 v[128:131], v[20:23], v[52:55], 0
v_mfma_f32_16x16x32_bf16 v[116:119], v[24:27], v[48:51], v[116:119]
v_mfma_f32_16x16x32_bf16 v[120:123], v[24:27], v[56:59], v[120:123]
v_mfma_f32_16x16x32_bf16 v[124:127], v[28:31], v[48:51], v[124:127]
v_mfma_f32_16x16x32_bf16 v[128:131], v[28:31], v[56:59], v[128:131]
v_mfma_f32_16x16x32_bf16 v[116:119], v[32:35], v[60:63], v[116:119]
v_mfma_f32_16x16x32_bf16 v[120:123], v[32:35], v[68:71], v[120:123]
v_mfma_f32_16x16x32_bf16 v[124:127], v[36:39], v[60:63], v[124:127]
v_mfma_f32_16x16x32_bf16 v[128:131], v[36:39], v[68:71], v[128:131]
v_mfma_f32_16x16x32_bf16 v[116:119], v[40:43], v[64:67], v[116:119]
v_mfma_f32_16x16x32_bf16 v[120:123], v[40:43], v[72:75], v[120:123]
v_mfma_f32_16x16x32_bf16 v[124:127], v[92:95], v[64:67], v[124:127]
v_mfma_f32_16x16x32_bf16 v[128:131], v[92:95], v[72:75], v[128:131]
v_mfma_f32_16x16x32_bf16 v[116:119], v[96:99], v[76:79], v[116:119]
v_mfma_f32_16x16x32_bf16 v[120:123], v[96:99], v[84:87], v[120:123]
v_mfma_f32_16x16x32_bf16 v[124:127], v[100:103], v[76:79], v[124:127]
v_mfma_f32_16x16x32_bf16 v[128:131], v[100:103], v[84:87], v[128:131]
v_mfma_f32_16x16x32_bf16 v[116:119], v[104:107], v[80:83], v[116:119]
v_mfma_f32_16x16x32_bf16 v[120:123], v[104:107], v[88:91], v[120:123]
v_mfma_f32_16x16x32_bf16 v[124:127], v[108:111], v[80:83], v[124:127]
v_mfma_f32_16x16x32_bf16 v[128:131], v[108:111], v[88:91], v[128:131]
s_nop 6
ds_write2_b32 v5, v116, v120 offset0:0 offset1:16
ds_write2_b32 v5, v117, v121 offset0:36 offset1:52
ds_write2_b32 v5, v118, v122 offset0:72 offset1:88
ds_write2_b32 v5, v119, v123 offset0:108 offset1:124
ds_write2_b32 v6, v124, v128 offset0:0 offset1:16
ds_write2_b32 v6, v125, v129 offset0:36 offset1:52
ds_write2_b32 v6, v126, v130 offset0:72 offset1:88
ds_write2_b32 v6, v127, v131 offset0:108 offset1:124
s_waitcnt lgkmcnt(0)
s_barrier
ds_read_b128 v[116:119], v7
ds_read_b128 v[120:123], v7 offset:4608
ds_read_b128 v[124:127], v7 offset:9216
ds_read_b128 v[128:131], v7 offset:13824
v_lshlrev_b32 v132, 16, v14
v_and_b32 v133, 0xffff0000, v14
v_lshlrev_b32 v134, 16, v15
v_and_b32 v135, 0xffff0000, v15
s_waitcnt lgkmcnt(0)
v_pk_add_f32 v[116:117], v[116:117], v[120:121]
v_pk_add_f32 v[124:125], v[124:125], v[128:129]
v_pk_add_f32 v[116:117], v[116:117], v[124:125]
v_cvt_pk_bf16_f32 v117, v116, v117
v_lshlrev_b32 v116, 16, v117
v_and_b32 v117, 0xffff0000, v117
v_pk_add_f32 v[116:117], v[116:117], v[132:133]
v_cvt_pk_bf16_f32 v136, v116, v117
v_min_u32 v136, -2, v136
v_pk_add_f32 v[118:119], v[118:119], v[122:123]
v_pk_add_f32 v[126:127], v[126:127], v[130:131]
v_pk_add_f32 v[118:119], v[118:119], v[126:127]
v_cvt_pk_bf16_f32 v119, v118, v119
v_lshlrev_b32 v118, 16, v119
v_and_b32 v119, 0xffff0000, v119
v_pk_add_f32 v[118:119], v[118:119], v[134:135]
v_cvt_pk_bf16_f32 v137, v118, v119
v_min_u32 v137, -2, v137
buffer_store_dwordx2 v[136:137], v9, s[4:7], s35 offen sc1
s_add_u32 s30, s30, 1835008
s_add_u32 s31, s31, 28672
s_add_u32 s32, s32, 163840
s_add_u32 s33, s33, 163840
s_add_u32 s34, s34, 114688
s_add_u32 s35, s35, 114688
s_add_u32 s25, s25, 4
s_cmp_lt_u32 s25, 64
s_cbranch_scc1 TB_TOP0
s_endpgm
TB_W1:
s_load_dwordx2 s[8:9], s[0:1], 0
s_mov_b32 s10, 1835008
s_mov_b32 s11, 0x00020000
s_sub_u32 s22, s22, 16
v_lshlrev_b32 v1, 4, v0
v_and_b32 v11, 7, v0
v_lshlrev_b32 v11, 2, v11
v_bfe_u32 v12, v0, 3, 1
v_lshl_add_u32 v11, v12, 7, v11
s_mov_b32 s40, 4352
s_branch Lfirst_224
Lflag_223:
v_cmp_ne_u32 vcc, s88, v12
s_cbranch_vccz Lset_225
s_sleep 4
Lfirst_224:
buffer_load_dword v12, v11, s[4:7], s40 offen sc1
s_waitcnt vmcnt(0)
s_sub_u32 s24, s24, 1
s_cbranch_scc0 Lflag_223
s_endpgm
Lset_225:
s_cmp_lt_u32 s21, 2
s_cselect_b32 s29, 0, 4
s_add_u32 s29, s29, s21
s_mul_i32 s26, s29, 28672
s_add_u32 s26, s26, 8044544
s_mov_b32 m0, 7168
s_add_u32 s40, s26, 7168
buffer_load_dwordx4 v1, s[4:7], s40 offen lds
s_mov_b32 m0, 8192
s_add_u32 s40, s26, 8192
buffer_load_dwordx4 v1, s[4:7], s40 offen lds
s_mov_b32 m0, 9216
s_add_u32 s40, s26, 9216
buffer_load_dwordx4 v1, s[4:7], s40 offen lds
s_mov_b32 m0, 10240
s_add_u32 s40, s26, 10240
buffer_load_dwordx4 v1, s[4:7], s40 offen lds
s_mov_b32 m0, 11264
s_add_u32 s40, s26, 11264
buffer_load_dwordx4 v1, s[4:7], s40 offen lds
s_mov_b32 m0, 12288
s_add_u32 s40, s26, 12288
buffer_load_dwordx4 v1, s[4:7], s40 offen lds
s_mov_b32 m0, 13312
s_add_u32 s40, s26, 13312
buffer_load_dwordx4 v1, s[4:7], s40 offen lds
v_and_b32 v11, 7, v0
v_min_u32 v11, 6, v11
v_lshlrev_b32 v11, 2, v11
v_bfe_u32 v12, v0, 3, 2
v_lshl_add_u32 v11, v12, 7, v11
s_mov_b32 s40, 2560
s_branch Lfirst_227
Lflag_226:
v_cmp_ne_u32 vcc, s88, v12
s_cbranch_vccz Lset_228
s_sleep 4
Lfirst_227:
buffer_load_dword v12, v11, s[4:7], s40 offen sc1
s_waitcnt vmcnt(0)
s_sub_u32 s24, s24, 1
s_cbranch_scc0 Lflag_226
s_endpgm
Lset_228:
s_cmp_lt_u32 s21, 2
s_cbranch_scc1 Learly_229
s_mov_b32 s40, 139264
s_branch Lfirst_231
Lflag_230:
v_cmp_ne_u32 vcc, s88, v11
s_cbranch_vccz Lset_232
s_sleep 16
Lfirst_231:
buffer_load_dword v11, off, s[4:7], s40 sc1
s_waitcnt vmcnt(0)
s_sub_u32 s24, s24, 1
s_cbranch_scc0 Lflag_230
s_endpgm
Lset_232:
Learly_229:
s_mul_i32 s40, s22, 458752
s_add_u32 s40, s40, 16416768
s_add_u32 s41, s40, 86016
s_add_u32 s43, s40, 57344
buffer_load_dwordx4 a[0:3], v1, s[4:7], s40 offen
buffer_load_dwordx4 a[4:7], v1, s[4:7], s40 offen offset:1024
buffer_load_dwordx4 a[8:11], v1, s[4:7], s40 offen offset:2048
buffer_load_dwordx4 a[12:15], v1, s[4:7], s40 offen offset:3072
s_add_u32 s40, s40, 4096
buffer_load_dwordx4 a[16:19], v1, s[4:7], s40 offen
buffer_load_dwordx4 a[20:23], v1, s[4:7], s40 offen offset:1024
buffer_load_dwordx4 a[24:27], v1, s[4:7], s40 offen offset:2048
buffer_load_dwordx4 a[28:31], v1, s[4:7], s40 offen offset:3072
s_add_u32 s40, s40, 4096
buffer_load_dwordx4 a[32:35], v1, s[4:7], s40 offen
buffer_load_dwordx4 a[36:39], v1, s[4:7], s40 offen offset:1024
buffer_load_dwordx4 a[40:43], v1, s[4:7], s40 offen offset:2048
buffer_load_dwordx4 a[44:47], v1, s[4:7], s40 offen offset:3072
s_add_u32 s40, s40, 4096
buffer_load_dwordx4 a[48:51], v1, s[4:7], s40 offen
buffer_load_dwordx4 a[52:55], v1, s[4:7], s40 offen offset:1024
buffer_load_dwordx4 a[56:59], v1, s[4:7], s40 offen offset:2048
buffer_load_dwordx4 a[60:63], v1, s[4:7], s40 offen offset:3072
s_add_u32 s40, s40, 4096
buffer_load_dwordx4 a[64:67], v1, s[4:7], s40 offen
buffer_load_dwordx4 a[68:71], v1, s[4:7], s40 offen offset:1024
buffer_load_dwordx4 a[72:75], v1, s[4:7], s40 offen offset:2048
buffer_load_dwordx4 a[76:79], v1, s[4:7], s40 offen offset:3072
s_add_u32 s40, s40, 4096
buffer_load_dwordx4 a[80:83], v1, s[4:7], s40 offen
buffer_load_dwordx4 a[84:87], v1, s[4:7], s40 offen offset:1024
buffer_load_dwordx4 a[88:91], v1, s[4:7], s40 offen offset:2048
buffer_load_dwordx4 a[92:95], v1, s[4:7], s40 offen offset:3072
s_add_u32 s40, s40, 4096
buffer_load_dwordx4 a[96:99], v1, s[4:7], s40 offen
buffer_load_dwordx4 a[100:103], v1, s[4:7], s40 offen offset:1024
buffer_load_dwordx4 a[104:107], v1, s[4:7], s40 offen offset:2048
buffer_load_dwordx4 a[108:111], v1, s[4:7], s40 offen offset:3072
s_add_u32 s40, s40, 4096
buffer_load_dwordx4 a[112:115], v1, s[4:7], s40 offen
buffer_load_dwordx4 a[116:119], v1, s[4:7], s40 offen offset:1024
buffer_load_dwordx4 a[120:123], v1, s[4:7], s40 offen offset:2048
buffer_load_dwordx4 a[124:127], v1, s[4:7], s40 offen offset:3072
s_add_u32 s40, s40, 4096
buffer_load_dwordx4 a[128:131], v1, s[4:7], s40 offen
buffer_load_dwordx4 a[132:135], v1, s[4:7], s40 offen offset:1024
buffer_load_dwordx4 a[136:139], v1, s[4:7], s40 offen offset:2048
buffer_load_dwordx4 a[140:143], v1, s[4:7], s40 offen offset:3072
s_add_u32 s40, s40, 4096
buffer_load_dwordx4 a[144:147], v1, s[4:7], s40 offen
buffer_load_dwordx4 a[148:151], v1, s[4:7], s40 offen offset:1024
buffer_load_dwordx4 a[152:155], v1, s[4:7], s40 offen offset:2048
buffer_load_dwordx4 a[156:159], v1, s[4:7], s40 offen offset:3072
s_add_u32 s40, s40, 4096
s_waitcnt vmcnt(32)
buffer_load_dwordx4 a[160:163], v1, s[4:7], s40 offen
buffer_load_dwordx4 a[164:167], v1, s[4:7], s40 offen offset:1024
buffer_load_dwordx4 a[168:171], v1, s[4:7], s40 offen offset:2048
buffer_load_dwordx4 a[172:175], v1, s[4:7], s40 offen offset:3072
s_add_u32 s40, s40, 4096
buffer_load_dwordx4 a[176:179], v1, s[4:7], s40 offen
buffer_load_dwordx4 a[180:183], v1, s[4:7], s40 offen offset:1024
buffer_load_dwordx4 a[184:187], v1, s[4:7], s40 offen offset:2048
buffer_load_dwordx4 a[188:191], v1, s[4:7], s40 offen offset:3072
s_add_u32 s40, s40, 4096
s_waitcnt vmcnt(32)
buffer_load_dwordx4 a[192:195], v1, s[4:7], s40 offen
buffer_load_dwordx4 a[196:199], v1, s[4:7], s40 offen offset:1024
buffer_load_dwordx4 a[200:203], v1, s[4:7], s40 offen offset:2048
buffer_load_dwordx4 a[204:207], v1, s[4:7], s40 offen offset:3072
s_add_u32 s40, s40, 4096
buffer_load_dwordx4 a[208:211], v1, s[4:7], s40 offen
buffer_load_dwordx4 a[212:215], v1, s[4:7], s40 offen offset:1024
buffer_load_dwordx4 a[216:219], v1, s[4:7], s40 offen offset:2048
buffer_load_dwordx4 a[220:223], v1, s[4:7], s40 offen offset:3072
s_waitcnt vmcnt(40)
s_mov_b32 m0, 77824
s_add_u32 s42, s41, 0
buffer_load_dwordx4 v1, s[4:7], s42 offen lds
s_mov_b32 m0, 78848
s_add_u32 s42, s41, 1024
buffer_load_dwordx4 v1, s[4:7], s42 offen lds
s_mov_b32 m0, 79872
s_add_u32 s42, s41, 2048
buffer_load_dwordx4 v1, s[4:7], s42 offen lds
s_mov_b32 m0, 80896
s_add_u32 s42, s41, 3072
buffer_load_dwordx4 v1, s[4:7], s42 offen lds
s_mov_b32 m0, 81920
s_add_u32 s42, s41, 4096
buffer_load_dwordx4 v1, s[4:7], s42 offen lds
s_mov_b32 m0, 82944
s_add_u32 s42, s41, 5120
buffer_load_dwordx4 v1, s[4:7], s42 offen lds
s_mov_b32 m0, 83968
s_add_u32 s42, s41, 6144
buffer_load_dwordx4 v1, s[4:7], s42 offen lds
s_mov_b32 m0, 84992
s_add_u32 s42, s41, 7168
buffer_load_dwordx4 v1, s[4:7], s42 offen lds
s_waitcnt vmcnt(40)
s_mov_b32 m0, 86016
s_add_u32 s42, s41, 8192
buffer_load_dwordx4 v1, s[4:7], s42 offen lds
s_mov_b32 m0, 87040
s_add_u32 s42, s41, 9216
buffer_load_dwordx4 v1, s[4:7], s42 offen lds
s_mov_b32 m0, 88064
s_add_u32 s42, s41, 10240
buffer_load_dwordx4 v1, s[4:7], s42 offen lds
s_mov_b32 m0, 89088
s_add_u32 s42, s41, 11264
buffer_load_dwordx4 v1, s[4:7], s42 offen lds
s_mov_b32 m0, 90112
s_add_u32 s42, s41, 12288
buffer_load_dwordx4 v1, s[4:7], s42 offen lds
s_mov_b32 m0, 91136
s_add_u32 s42, s41, 13312
buffer_load_dwordx4 v1, s[4:7], s42 offen lds
s_mov_b32 m0, 92160
s_add_u32 s42, s41, 14336
buffer_load_dwordx4 v1, s[4:7], s42 offen lds
s_mov_b32 m0, 93184
s_add_u32 s42, s41, 15360
buffer_load_dwordx4 v1, s[4:7], s42 offen lds
s_waitcnt vmcnt(40)
s_mov_b32 m0, 94208
s_add_u32 s42, s41, 16384
buffer_load_dwordx4 v1, s[4:7], s42 offen lds
s_mov_b32 m0, 95232
s_add_u32 s42, s41, 17408
buffer_load_dwordx4 v1, s[4:7], s42 offen lds
s_mov_b32 m0, 96256
s_add_u32 s42, s41, 18432
buffer_load_dwordx4 v1, s[4:7], s42 offen lds
s_mov_b32 m0, 97280
s_add_u32 s42, s41, 19456
buffer_load_dwordx4 v1, s[4:7], s42 offen lds
s_mov_b32 m0, 98304
s_add_u32 s42, s41, 20480
buffer_load_dwordx4 v1, s[4:7], s42 offen lds
s_mov_b32 m0, 99328
s_add_u32 s42, s41, 21504
buffer_load_dwordx4 v1, s[4:7], s42 offen lds
s_mov_b32 m0, 100352
s_add_u32 s42, s41, 22528
buffer_load_dwordx4 v1, s[4:7], s42 offen lds
s_mov_b32 m0, 101376
s_add_u32 s42, s41, 23552
buffer_load_dwordx4 v1, s[4:7], s42 offen lds
s_waitcnt vmcnt(40)
s_mov_b32 m0, 102400
s_add_u32 s42, s41, 24576
buffer_load_dwordx4 v1, s[4:7], s42 offen lds
s_mov_b32 m0, 103424
s_add_u32 s42, s41, 25600
buffer_load_dwordx4 v1, s[4:7], s42 offen lds
s_mov_b32 m0, 104448
s_add_u32 s42, s41, 26624
buffer_load_dwordx4 v1, s[4:7], s42 offen lds
s_mov_b32 m0, 105472
s_add_u32 s42, s41, 27648
buffer_load_dwordx4 v1, s[4:7], s42 offen lds
s_waitcnt vmcnt(52)
buffer_load_dwordx4 a[224:227], v1, s[4:7], s43 offen
buffer_load_dwordx4 a[228:231], v1, s[4:7], s43 offen offset:1024
buffer_load_dwordx4 a[232:235], v1, s[4:7], s43 offen offset:2048
buffer_load_dwordx4 a[236:239], v1, s[4:7], s43 offen offset:3072
s_add_u32 s43, s43, 4096
s_waitcnt vmcnt(52)
buffer_load_dwordx4 a[240:243], v1, s[4:7], s43 offen
buffer_load_dwordx4 a[244:247], v1, s[4:7], s43 offen offset:1024
buffer_load_dwordx4 a[248:251], v1, s[4:7], s43 offen offset:2048
buffer_load_dwordx4 a[252:255], v1, s[4:7], s43 offen offset:3072
s_add_u32 s43, s43, 4096
s_waitcnt vmcnt(52)
buffer_load_dwordx4 v[176:179], v1, s[4:7], s43 offen
buffer_load_dwordx4 v[180:183], v1, s[4:7], s43 offen offset:1024
buffer_load_dwordx4 v[184:187], v1, s[4:7], s43 offen offset:2048
buffer_load_dwordx4 v[188:191], v1, s[4:7], s43 offen offset:3072
s_add_u32 s43, s43, 4096
s_waitcnt vmcnt(52)
buffer_load_dwordx4 v[192:195], v1, s[4:7], s43 offen
buffer_load_dwordx4 v[196:199], v1, s[4:7], s43 offen offset:1024
buffer_load_dwordx4 v[200:203], v1, s[4:7], s43 offen offset:2048
buffer_load_dwordx4 v[204:207], v1, s[4:7], s43 offen offset:3072
s_add_u32 s43, s43, 4096
s_waitcnt vmcnt(52)
buffer_load_dwordx4 v[208:211], v1, s[4:7], s43 offen
buffer_load_dwordx4 v[212:215], v1, s[4:7], s43 offen offset:1024
buffer_load_dwordx4 v[216:219], v1, s[4:7], s43 offen offset:2048
buffer_load_dwordx4 v[220:223], v1, s[4:7], s43 offen offset:3072
s_add_u32 s43, s43, 4096
s_waitcnt vmcnt(52)
buffer_load_dwordx4 v[224:227], v1, s[4:7], s43 offen
buffer_load_dwordx4 v[228:231], v1, s[4:7], s43 offen offset:1024
buffer_load_dwordx4 v[232:235], v1, s[4:7], s43 offen offset:2048
buffer_load_dwordx4 v[236:239], v1, s[4:7], s43 offen offset:3072
s_add_u32 s43, s43, 4096
s_waitcnt vmcnt(52)
buffer_load_dwordx4 v[240:243], v1, s[4:7], s43 offen
buffer_load_dwordx4 v[244:247], v1, s[4:7], s43 offen offset:1024
buffer_load_dwordx4 v[248:251], v1, s[4:7], s43 offen offset:2048
buffer_load_dwordx4 v[252:255], v1, s[4:7], s43 offen offset:3072
s_add_u32 s43, s43, 4096
v_add_u32 v2, 77824, v1
v_and_b32 v11, 15, v0
v_lshrrev_b32 v12, 4, v0
v_bfe_u32 v3, v0, 3, 1
v_mul_u32_u24 v3, 14368, v3
v_lshl_add_u32 v3, v12, 8, v3
v_bfe_u32 v4, v0, 2, 1
v_lshl_add_u32 v3, v4, 6, v3
v_bfe_u32 v4, v0, 1, 1
v_lshl_add_u32 v3, v4, 7, v3
v_and_b32 v4, 1, v0
v_lshl_add_u32 v3, v4, 4, v3
v_and_b32 v4, 31, v0
v_lshlrev_b32 v4, 4, v4
v_mul_u32_u24 v5, 576, v12
v_lshl_add_u32 v5, v11, 2, v5
v_add_u32 v5, 33408, v5
v_add_u32 v6, 2304, v5
v_lshrrev_b32 v11, 3, v0
v_add_u32 v11, 8, v11
v_and_b32 v12, 7, v0
v_mul_u32_u24 v7, 144, v11
v_lshl_add_u32 v7, v12, 4, v7
v_add_u32 v7, 28800, v7
v_mul_u32_u24 v8, 896, v11
v_lshl_add_u32 v8, v12, 3, v8
v_and_b32 v9, 15, v11
v_lshlrev_b32 v9, 4, v9
v_lshrrev_b32 v11, 1, v12
v_lshl_add_u32 v9, v11, 8, v9
v_and_b32 v11, 1, v12
v_lshl_add_u32 v9, v11, 3, v9
v_and_b32 v11, 8, v0
v_cmp_eq_u32 vcc, 0, v11
v_mov_b32 v11, 0x88884444
v_mov_b32 v10, 0xddddeeee
v_cndmask_b32 v10, v10, v11, vcc
s_mul_i32 s34, s21, 28672
s_lshl_b32 s40, s22, 10
s_add_u32 s35, s34, s40
s_add_u32 s35, s35, 4370432
s_lshl_b32 s40, s22, 6
s_add_u32 s34, s34, s40
s_lshl_b32 s40, s22, 15
s_add_u32 s40, s40, 30072832
s_mul_i32 s30, s21, 458752
s_add_u32 s30, s30, s40
s_mul_i32 s27, s29, 458752
s_add_u32 s27, s27, s40
s_lshl_b32 s40, s22, 7
s_add_u32 s40, s40, 8196
s_mul_i32 s28, s29, 1792
s_add_u32 s28, s28, s40
s_mul_i32 s31, s21, 7168
s_add_u32 s31, s31, 636928
s_mul_i32 s32, s21, 40960
s_add_u32 s33, s32, 1783808
s_add_u32 s32, s32, 1757184
s_mov_b32 s25, s21
s_waitcnt vmcnt(56) lgkmcnt(0)
s_branch TB_Y1
TB_TOP1:
s_cmp_lt_u32 s29, 64
s_cbranch_scc0 TB_PV1
TB_Y1:
s_barrier
ds_read_b128 v[16:19], v3
ds_read_b128 v[20:23], v3 offset:32
ds_read_b128 v[24:27], v3 offset:1024
ds_read_b128 v[28:31], v3 offset:1056
s_waitcnt lgkmcnt(2)
v_mfma_f32_16x16x32_bf16 v[116:119], v[16:19], a[0:3], 0
v_mfma_f32_16x16x32_bf16 v[120:123], v[20:23], a[0:3], 0
ds_read_b128 v[32:35], v3 offset:2048
ds_read_b128 v[36:39], v3 offset:2080
v_mfma_f32_16x16x32_bf16 v[124:127], v[16:19], a[56:59], 0
v_mfma_f32_16x16x32_bf16 v[128:131], v[20:23], a[56:59], 0
v_mfma_f32_16x16x32_bf16 v[132:135], v[16:19], a[112:115], 0
v_mfma_f32_16x16x32_bf16 v[136:139], v[20:23], a[112:115], 0
v_mfma_f32_16x16x32_bf16 v[140:143], v[16:19], a[168:171], 0
v_mfma_f32_16x16x32_bf16 v[144:147], v[20:23], a[168:171], 0
s_waitcnt lgkmcnt(2)
v_mfma_f32_16x16x32_bf16 v[116:119], v[24:27], a[4:7], v[116:119]
v_mfma_f32_16x16x32_bf16 v[120:123], v[28:31], a[4:7], v[120:123]
ds_read_b128 v[16:19], v3 offset:3072
ds_read_b128 v[20:23], v3 offset:3104
v_mfma_f32_16x16x32_bf16 v[124:127], v[24:27], a[60:63], v[124:127]
v_mfma_f32_16x16x32_bf16 v[128:131], v[28:31], a[60:63], v[128:131]
v_mfma_f32_16x16x32_bf16 v[132:135], v[24:27], a[116:119], v[132:135]
v_mfma_f32_16x16x32_bf16 v[136:139], v[28:31], a[116:119], v[136:139]
v_mfma_f32_16x16x32_bf16 v[140:143], v[24:27], a[172:175], v[140:143]
v_mfma_f32_16x16x32_bf16 v[144:147], v[28:31], a[172:175], v[144:147]
s_waitcnt lgkmcnt(2)
v_mfma_f32_16x16x32_bf16 v[116:119], v[32:35], a[8:11], v[116:119]
v_mfma_f32_16x16x32_bf16 v[120:123], v[36:39], a[8:11], v[120:123]
ds_read_b128 v[24:27], v3 offset:4096
ds_read_b128 v[28:31], v3 offset:4128
v_mfma_f32_16x16x32_bf16 v[124:127], v[32:35], a[64:67], v[124:127]
v_mfma_f32_16x16x32_bf16 v[128:131], v[36:39], a[64:67], v[128:131]
v_mfma_f32_16x16x32_bf16 v[132:135], v[32:35], a[120:123], v[132:135]
v_mfma_f32_16x16x32_bf16 v[136:139], v[36:39], a[120:123], v[136:139]
v_mfma_f32_16x16x32_bf16 v[140:143], v[32:35], a[176:179], v[140:143]
v_mfma_f32_16x16x32_bf16 v[144:147], v[36:39], a[176:179], v[144:147]
s_waitcnt lgkmcnt(2)
v_mfma_f32_16x16x32_bf16 v[116:119], v[16:19], a[12:15], v[116:119]
v_mfma_f32_16x16x32_bf16 v[120:123], v[20:23], a[12:15], v[120:123]
ds_read_b128 v[32:35], v3 offset:5120
ds_read_b128 v[36:39], v3 offset:5152
v_mfma_f32_16x16x32_bf16 v[124:127], v[16:19], a[68:71], v[124:127]
v_mfma_f32_16x16x32_bf16 v[128:131], v[20:23], a[68:71], v[128:131]
v_mfma_f32_16x16x32_bf16 v[132:135], v[16:19], a[124:127], v[132:135]
v_mfma_f32_16x16x32_bf16 v[136:139], v[20:23], a[124:127], v[136:139]
v_mfma_f32_16x16x32_bf16 v[140:143], v[16:19], a[180:183], v[140:143]
v_mfma_f32_16x16x32_bf16 v[144:147], v[20:23], a[180:183], v[144:147]
s_waitcnt lgkmcnt(2)
v_mfma_f32_16x16x32_bf16 v[116:119], v[24:27], a[16:19], v[116:119]
v_mfma_f32_16x16x32_bf16 v[120:123], v[28:31], a[16:19], v[120:123]
ds_read_b128 v[16:19], v3 offset:6144
ds_read_b128 v[20:23], v3 offset:6176
v_mfma_f32_16x16x32_bf16 v[124:127], v[24:27], a[72:75], v[124:127]
v_mfma_f32_16x16x32_bf16 v[128:131], v[28:31], a[72:75], v[128:131]
v_mfma_f32_16x16x32_bf16 v[132:135], v[24:27], a[128:131], v[132:135]
v_mfma_f32_16x16x32_bf16 v[136:139], v[28:31], a[128:131], v[136:139]
v_mfma_f32_16x16x32_bf16 v[140:143], v[24:27], a[184:187], v[140:143]
v_mfma_f32_16x16x32_bf16 v[144:147], v[28:31], a[184:187], v[144:147]
s_waitcnt lgkmcnt(2)
v_mfma_f32_16x16x32_bf16 v[116:119], v[32:35], a[20:23], v[116:119]
v_mfma_f32_16x16x32_bf16 v[120:123], v[36:39], a[20:23], v[120:123]
ds_read_b128 v[24:27], v3 offset:7168
ds_read_b128 v[28:31], v3 offset:7200
v_mfma_f32_16x16x32_bf16 v[124:127], v[32:35], a[76:79], v[124:127]
v_mfma_f32_16x16x32_bf16 v[128:131], v[36:39], a[76:79], v[128:131]
v_mfma_f32_16x16x32_bf16 v[132:135], v[32:35], a[132:135], v[132:135]
v_mfma_f32_16x16x32_bf16 v[136:139], v[36:39], a[132:135], v[136:139]
v_mfma_f32_16x16x32_bf16 v[140:143], v[32:35], a[188:191], v[140:143]
v_mfma_f32_16x16x32_bf16 v[144:147], v[36:39], a[188:191], v[144:147]
s_waitcnt lgkmcnt(2)
v_mfma_f32_16x16x32_bf16 v[116:119], v[16:19], a[24:27], v[116:119]
v_mfma_f32_16x16x32_bf16 v[120:123], v[20:23], a[24:27], v[120:123]
ds_read_b128 v[32:35], v3 offset:8192
ds_read_b128 v[36:39], v3 offset:8224
v_mfma_f32_16x16x32_bf16 v[124:127], v[16:19], a[80:83], v[124:127]
v_mfma_f32_16x16x32_bf16 v[128:131], v[20:23], a[80:83], v[128:131]
v_mfma_f32_16x16x32_bf16 v[132:135], v[16:19], a[136:139], v[132:135]
v_mfma_f32_16x16x32_bf16 v[136:139], v[20:23], a[136:139], v[136:139]
v_mfma_f32_16x16x32_bf16 v[140:143], v[16:19], a[192:195], v[140:143]
v_mfma_f32_16x16x32_bf16 v[144:147], v[20:23], a[192:195], v[144:147]
s_waitcnt lgkmcnt(2)
v_mfma_f32_16x16x32_bf16 v[116:119], v[24:27], a[28:31], v[116:119]
v_mfma_f32_16x16x32_bf16 v[120:123], v[28:31], a[28:31], v[120:123]
ds_read_b128 v[16:19], v3 offset:9216
ds_read_b128 v[20:23], v3 offset:9248
v_mfma_f32_16x16x32_bf16 v[124:127], v[24:27], a[84:87], v[124:127]
v_mfma_f32_16x16x32_bf16 v[128:131], v[28:31], a[84:87], v[128:131]
v_mfma_f32_16x16x32_bf16 v[132:135], v[24:27], a[140:143], v[132:135]
v_mfma_f32_16x16x32_bf16 v[136:139], v[28:31], a[140:143], v[136:139]
v_mfma_f32_16x16x32_bf16 v[140:143], v[24:27], a[196:199], v[140:143]
v_mfma_f32_16x16x32_bf16 v[144:147], v[28:31], a[196:199], v[144:147]
s_waitcnt lgkmcnt(2)
v_mfma_f32_16x16x32_bf16 v[116:119], v[32:35], a[32:35], v[116:119]
v_mfma_f32_16x16x32_bf16 v[120:123], v[36:39], a[32:35], v[120:123]
ds_read_b128 v[24:27], v3 offset:10240
ds_read_b128 v[28:31], v3 offset:10272
v_mfma_f32_16x16x32_bf16 v[124:127], v[32:35], a[88:91], v[124:127]
v_mfma_f32_16x16x32_bf16 v[128:131], v[36:39], a[88:91], v[128:131]
v_mfma_f32_16x16x32_bf16 v[132:135], v[32:35], a[144:147], v[132:135]
v_mfma_f32_16x16x32_bf16 v[136:139], v[36:39], a[144:147], v[136:139]
v_mfma_f32_16x16x32_bf16 v[140:143], v[32:35], a[200:203], v[140:143]
v_mfma_f32_16x16x32_bf16 v[144:147], v[36:39], a[200:203], v[144:147]
s_waitcnt lgkmcnt(2)
v_mfma_f32_16x16x32_bf16 v[116:119], v[16:19], a[36:39], v[116:119]
v_mfma_f32_16x16x32_bf16 v[120:123], v[20:23], a[36:39], v[120:123]
ds_read_b128 v[32:35], v3 offset:11264
ds_read_b128 v[36:39], v3 offset:11296
v_mfma_f32_16x16x32_bf16 v[124:127], v[16:19], a[92:95], v[124:127]
v_mfma_f32_16x16x32_bf16 v[128:131], v[20:23], a[92:95], v[128:131]
v_mfma_f32_16x16x32_bf16 v[132:135], v[16:19], a[148:151], v[132:135]
v_mfma_f32_16x16x32_bf16 v[136:139], v[20:23], a[148:151], v[136:139]
v_mfma_f32_16x16x32_bf16 v[140:143], v[16:19], a[204:207], v[140:143]
v_mfma_f32_16x16x32_bf16 v[144:147], v[20:23], a[204:207], v[144:147]
s_waitcnt lgkmcnt(2)
v_mfma_f32_16x16x32_bf16 v[116:119], v[24:27], a[40:43], v[116:119]
v_mfma_f32_16x16x32_bf16 v[120:123], v[28:31], a[40:43], v[120:123]
ds_read_b128 v[16:19], v3 offset:12288
ds_read_b128 v[20:23], v3 offset:12320
v_mfma_f32_16x16x32_bf16 v[124:127], v[24:27], a[96:99], v[124:127]
v_mfma_f32_16x16x32_bf16 v[128:131], v[28:31], a[96:99], v[128:131]
v_mfma_f32_16x16x32_bf16 v[132:135], v[24:27], a[152:155], v[132:135]
v_mfma_f32_16x16x32_bf16 v[136:139], v[28:31], a[152:155], v[136:139]
v_mfma_f32_16x16x32_bf16 v[140:143], v[24:27], a[208:211], v[140:143]
v_mfma_f32_16x16x32_bf16 v[144:147], v[28:31], a[208:211], v[144:147]
s_waitcnt lgkmcnt(2)
v_mfma_f32_16x16x32_bf16 v[116:119], v[32:35], a[44:47], v[116:119]
v_mfma_f32_16x16x32_bf16 v[120:123], v[36:39], a[44:47], v[120:123]
ds_read_b128 v[24:27], v3 offset:13312
ds_read_b128 v[28:31], v3 offset:13344
v_mfma_f32_16x16x32_bf16 v[124:127], v[32:35], a[100:103], v[124:127]
v_mfma_f32_16x16x32_bf16 v[128:131], v[36:39], a[100:103], v[128:131]
v_mfma_f32_16x16x32_bf16 v[132:135], v[32:35], a[156:159], v[132:135]
v_mfma_f32_16x16x32_bf16 v[136:139], v[36:39], a[156:159], v[136:139]
v_mfma_f32_16x16x32_bf16 v[140:143], v[32:35], a[212:215], v[140:143]
v_mfma_f32_16x16x32_bf16 v[144:147], v[36:39], a[212:215], v[144:147]
s_waitcnt lgkmcnt(2)
v_mfma_f32_16x16x32_bf16 v[116:119], v[16:19], a[48:51], v[116:119]
v_mfma_f32_16x16x32_bf16 v[120:123], v[20:23], a[48:51], v[120:123]
v_mfma_f32_16x16x32_bf16 v[124:127], v[16:19], a[104:107], v[124:127]
v_mfma_f32_16x16x32_bf16 v[128:131], v[20:23], a[104:107], v[128:131]
v_mfma_f32_16x16x32_bf16 v[132:135], v[16:19], a[160:163], v[132:135]
v_mfma_f32_16x16x32_bf16 v[136:139], v[20:23], a[160:163], v[136:139]
v_mfma_f32_16x16x32_bf16 v[140:143], v[16:19], a[216:219], v[140:143]
v_mfma_f32_16x16x32_bf16 v[144:147], v[20:23], a[216:219], v[144:147]
s_waitcnt lgkmcnt(0)
v_mfma_f32_16x16x32_bf16 v[116:119], v[24:27], a[52:55], v[116:119]
v_mfma_f32_16x16x32_bf16 v[120:123], v[28:31], a[52:55], v[120:123]
v_mfma_f32_16x16x32_bf16 v[124:127], v[24:27], a[108:111], v[124:127]
v_mfma_f32_16x16x32_bf16 v[128:131], v[28:31], a[108:111], v[128:131]
v_mfma_f32_16x16x32_bf16 v[132:135], v[24:27], a[164:167], v[132:135]
v_mfma_f32_16x16x32_bf16 v[136:139], v[28:31], a[164:167], v[136:139]
v_mfma_f32_16x16x32_bf16 v[140:143], v[24:27], a[220:223], v[140:143]
v_mfma_f32_16x16x32_bf16 v[144:147], v[28:31], a[220:223], v[144:147]
s_nop 1
v_cvt_pk_bf16_f32 v44, v116, v117
v_cvt_pk_bf16_f32 v45, v118, v119
v_cvt_pk_bf16_f32 v46, v120, v121
v_cvt_pk_bf16_f32 v47, v122, v123
buffer_store_dwordx4 v[44:47], v1, s[4:7], s27 offen sc1
v_cvt_pk_bf16_f32 v48, v124, v125
v_cvt_pk_bf16_f32 v49, v126, v127
v_cvt_pk_bf16_f32 v50, v128, v129
v_cvt_pk_bf16_f32 v51, v130, v131
buffer_store_dwordx4 v[48:51], v1, s[4:7], s27 offen offset:2048 sc1
v_cvt_pk_bf16_f32 v52, v132, v133
v_cvt_pk_bf16_f32 v53, v134, v135
v_cvt_pk_bf16_f32 v54, v136, v137
v_cvt_pk_bf16_f32 v55, v138, v139
buffer_store_dwordx4 v[52:55], v1, s[4:7], s27 offen offset:1024 sc1
v_cvt_pk_bf16_f32 v56, v140, v141
v_cvt_pk_bf16_f32 v57, v142, v143
v_cvt_pk_bf16_f32 v58, v144, v145
v_cvt_pk_bf16_f32 v59, v146, v147
buffer_store_dwordx4 v[56:59], v1, s[4:7], s27 offen offset:3072 sc1
s_waitcnt vmcnt(4)
ds_read_b128 v[16:19], v3
ds_read_b128 v[20:23], v3 offset:32
ds_read_b128 v[92:95], v2
ds_read_b128 v[96:99], v2 offset:14336
ds_read_b128 v[24:27], v3 offset:1024
ds_read_b128 v[28:31], v3 offset:1056
ds_read_b128 v[100:103], v2 offset:1024
ds_read_b128 v[104:107], v2 offset:15360
s_waitcnt lgkmcnt(4)
v_mfma_f32_16x16x32_bf16 v[116:119], v[16:19], a[224:227], 0
v_mfma_f32_16x16x32_bf16 v[120:123], v[20:23], a[224:227], 0
ds_read_b128 v[32:35], v3 offset:2048
ds_read_b128 v[36:39], v3 offset:2080
ds_read_b128 v[108:111], v2 offset:2048
ds_read_b128 v[112:115], v2 offset:16384
v_mfma_f32_16x16x32_bf16 v[124:127], v[16:19], v[200:203], 0
v_mfma_f32_16x16x32_bf16 v[128:131], v[20:23], v[200:203], 0
v_mfma_f32_16x16x32_bf16 v[132:135], v[16:19], v[92:95], 0
v_mfma_f32_16x16x32_bf16 v[136:139], v[20:23], v[92:95], 0
v_mfma_f32_16x16x32_bf16 v[140:143], v[16:19], v[96:99], 0
v_mfma_f32_16x16x32_bf16 v[144:147], v[20:23], v[96:99], 0
s_waitcnt lgkmcnt(4)
v_mfma_f32_16x16x32_bf16 v[116:119], v[24:27], a[228:231], v[116:119]
v_mfma_f32_16x16x32_bf16 v[120:123], v[28:31], a[228:231], v[120:123]
ds_read_b128 v[16:19], v3 offset:3072
ds_read_b128 v[20:23], v3 offset:3104
ds_read_b128 v[92:95], v2 offset:3072
ds_read_b128 v[96:99], v2 offset:17408
v_mfma_f32_16x16x32_bf16 v[124:127], v[24:27], v[204:207], v[124:127]
v_mfma_f32_16x16x32_bf16 v[128:131], v[28:31], v[204:207], v[128:131]
v_mfma_f32_16x16x32_bf16 v[132:135], v[24:27], v[100:103], v[132:135]
v_mfma_f32_16x16x32_bf16 v[136:139], v[28:31], v[100:103], v[136:139]
v_mfma_f32_16x16x32_bf16 v[140:143], v[24:27], v[104:107], v[140:143]
v_mfma_f32_16x16x32_bf16 v[144:147], v[28:31], v[104:107], v[144:147]
s_waitcnt lgkmcnt(4)
v_mfma_f32_16x16x32_bf16 v[116:119], v[32:35], a[232:235], v[116:119]
v_mfma_f32_16x16x32_bf16 v[120:123], v[36:39], a[232:235], v[120:123]
ds_read_b128 v[24:27], v3 offset:4096
ds_read_b128 v[28:31], v3 offset:4128
ds_read_b128 v[100:103], v2 offset:4096
ds_read_b128 v[104:107], v2 offset:18432
v_mfma_f32_16x16x32_bf16 v[124:127], v[32:35], v[208:211], v[124:127]
v_mfma_f32_16x16x32_bf16 v[128:131], v[36:39], v[208:211], v[128:131]
v_mfma_f32_16x16x32_bf16 v[132:135], v[32:35], v[108:111], v[132:135]
v_mfma_f32_16x16x32_bf16 v[136:139], v[36:39], v[108:111], v[136:139]
v_mfma_f32_16x16x32_bf16 v[140:143], v[32:35], v[112:115], v[140:143]
v_mfma_f32_16x16x32_bf16 v[144:147], v[36:39], v[112:115], v[144:147]
s_waitcnt lgkmcnt(4)
v_mfma_f32_16x16x32_bf16 v[116:119], v[16:19], a[236:239], v[116:119]
v_mfma_f32_16x16x32_bf16 v[120:123], v[20:23], a[236:239], v[120:123]
ds_read_b128 v[32:35], v3 offset:5120
ds_read_b128 v[36:39], v3 offset:5152
ds_read_b128 v[108:111], v2 offset:5120
ds_read_b128 v[112:115], v2 offset:19456
v_mfma_f32_16x16x32_bf16 v[124:127], v[16:19], v[212:215], v[124:127]
v_mfma_f32_16x16x32_bf16 v[128:131], v[20:23], v[212:215], v[128:131]
v_mfma_f32_16x16x32_bf16 v[132:135], v[16:19], v[92:95], v[132:135]
v_mfma_f32_16x16x32_bf16 v[136:139], v[20:23], v[92:95], v[136:139]
v_mfma_f32_16x16x32_bf16 v[140:143], v[16:19], v[96:99], v[140:143]
v_mfma_f32_16x16x32_bf16 v[144:147], v[20:23], v[96:99], v[144:147]
s_waitcnt lgkmcnt(4)
v_mfma_f32_16x16x32_bf16 v[116:119], v[24:27], a[240:243], v[116:119]
v_mfma_f32_16x16x32_bf16 v[120:123], v[28:31], a[240:243], v[120:123]
ds_read_b128 v[16:19], v3 offset:6144
ds_read_b128 v[20:23], v3 offset:6176
ds_read_b128 v[92:95], v2 offset:6144
ds_read_b128 v[96:99], v2 offset:20480
v_mfma_f32_16x16x32_bf16 v[124:127], v[24:27], v[216:219], v[124:127]
v_mfma_f32_16x16x32_bf16 v[128:131], v[28:31], v[216:219], v[128:131]
v_mfma_f32_16x16x32_bf16 v[132:135], v[24:27], v[100:103], v[132:135]
v_mfma_f32_16x16x32_bf16 v[136:139], v[28:31], v[100:103], v[136:139]
v_mfma_f32_16x16x32_bf16 v[140:143], v[24:27], v[104:107], v[140:143]
v_mfma_f32_16x16x32_bf16 v[144:147], v[28:31], v[104:107], v[144:147]
s_waitcnt lgkmcnt(4)
v_mfma_f32_16x16x32_bf16 v[116:119], v[32:35], a[244:247], v[116:119]
v_mfma_f32_16x16x32_bf16 v[120:123], v[36:39], a[244:247], v[120:123]
ds_read_b128 v[24:27], v3 offset:7168
ds_read_b128 v[28:31], v3 offset:7200
ds_read_b128 v[100:103], v2 offset:7168
ds_read_b128 v[104:107], v2 offset:21504
v_mfma_f32_16x16x32_bf16 v[124:127], v[32:35], v[220:223], v[124:127]
v_mfma_f32_16x16x32_bf16 v[128:131], v[36:39], v[220:223], v[128:131]
v_mfma_f32_16x16x32_bf16 v[132:135], v[32:35], v[108:111], v[132:135]
v_mfma_f32_16x16x32_bf16 v[136:139], v[36:39], v[108:111], v[136:139]
v_mfma_f32_16x16x32_bf16 v[140:143], v[32:35], v[112:115], v[140:143]
v_mfma_f32_16x16x32_bf16 v[144:147], v[36:39], v[112:115], v[144:147]
s_waitcnt lgkmcnt(4)
v_mfma_f32_16x16x32_bf16 v[116:119], v[16:19], a[248:251], v[116:119]
v_mfma_f32_16x16x32_bf16 v[120:123], v[20:23], a[248:251], v[120:123]
ds_read_b128 v[32:35], v3 offset:8192
ds_read_b128 v[36:39], v3 offset:8224
ds_read_b128 v[108:111], v2 offset:8192
ds_read_b128 v[112:115], v2 offset:22528
v_mfma_f32_16x16x32_bf16 v[124:127], v[16:19], v[224:227], v[124:127]
v_mfma_f32_16x16x32_bf16 v[128:131], v[20:23], v[224:227], v[128:131]
v_mfma_f32_16x16x32_bf16 v[132:135], v[16:19], v[92:95], v[132:135]
v_mfma_f32_16x16x32_bf16 v[136:139], v[20:23], v[92:95], v[136:139]
v_mfma_f32_16x16x32_bf16 v[140:143], v[16:19], v[96:99], v[140:143]
v_mfma_f32_16x16x32_bf16 v[144:147], v[20:23], v[96:99], v[144:147]
s_waitcnt lgkmcnt(4)
v_mfma_f32_16x16x32_bf16 v[116:119], v[24:27], a[252:255], v[116:119]
v_mfma_f32_16x16x32_bf16 v[120:123], v[28:31], a[252:255], v[120:123]
ds_read_b128 v[16:19], v3 offset:9216
ds_read_b128 v[20:23], v3 offset:9248
ds_read_b128 v[92:95], v2 offset:9216
ds_read_b128 v[96:99], v2 offset:23552
v_mfma_f32_16x16x32_bf16 v[124:127], v[24:27], v[228:231], v[124:127]
v_mfma_f32_16x16x32_bf16 v[128:131], v[28:31], v[228:231], v[128:131]
v_mfma_f32_16x16x32_bf16 v[132:135], v[24:27], v[100:103], v[132:135]
v_mfma_f32_16x16x32_bf16 v[136:139], v[28:31], v[100:103], v[136:139]
v_mfma_f32_16x16x32_bf16 v[140:143], v[24:27], v[104:107], v[140:143]
v_mfma_f32_16x16x32_bf16 v[144:147], v[28:31], v[104:107], v[144:147]
s_waitcnt lgkmcnt(4)
v_mfma_f32_16x16x32_bf16 v[116:119], v[32:35], v[176:179], v[116:119]
v_mfma_f32_16x16x32_bf16 v[120:123], v[36:39], v[176:179], v[120:123]
ds_read_b128 v[24:27], v3 offset:10240
ds_read_b128 v[28:31], v3 offset:10272
ds_read_b128 v[100:103], v2 offset:10240
ds_read_b128 v[104:107], v2 offset:24576
v_mfma_f32_16x16x32_bf16 v[124:127], v[32:35], v[232:235], v[124:127]
v_mfma_f32_16x16x32_bf16 v[128:131], v[36:39], v[232:235], v[128:131]
v_mfma_f32_16x16x32_bf16 v[132:135], v[32:35], v[108:111], v[132:135]
v_mfma_f32_16x16x32_bf16 v[136:139], v[36:39], v[108:111], v[136:139]
v_mfma_f32_16x16x32_bf16 v[140:143], v[32:35], v[112:115], v[140:143]
v_mfma_f32_16x16x32_bf16 v[144:147], v[36:39], v[112:115], v[144:147]
s_waitcnt lgkmcnt(4)
v_mfma_f32_16x16x32_bf16 v[116:119], v[16:19], v[180:183], v[116:119]
v_mfma_f32_16x16x32_bf16 v[120:123], v[20:23], v[180:183], v[120:123]
ds_read_b128 v[32:35], v3 offset:11264
ds_read_b128 v[36:39], v3 offset:11296
ds_read_b128 v[108:111], v2 offset:11264
ds_read_b128 v[112:115], v2 offset:25600
v_mfma_f32_16x16x32_bf16 v[124:127], v[16:19], v[236:239], v[124:127]
v_mfma_f32_16x16x32_bf16 v[128:131], v[20:23], v[236:239], v[128:131]
v_mfma_f32_16x16x32_bf16 v[132:135], v[16:19], v[92:95], v[132:135]
v_mfma_f32_16x16x32_bf16 v[136:139], v[20:23], v[92:95], v[136:139]
v_mfma_f32_16x16x32_bf16 v[140:143], v[16:19], v[96:99], v[140:143]
v_mfma_f32_16x16x32_bf16 v[144:147], v[20:23], v[96:99], v[144:147]
s_waitcnt lgkmcnt(4)
v_mfma_f32_16x16x32_bf16 v[116:119], v[24:27], v[184:187], v[116:119]
v_mfma_f32_16x16x32_bf16 v[120:123], v[28:31], v[184:187], v[120:123]
ds_read_b128 v[16:19], v3 offset:12288
ds_read_b128 v[20:23], v3 offset:12320
ds_read_b128 v[92:95], v2 offset:12288
ds_read_b128 v[96:99], v2 offset:26624
v_mfma_f32_16x16x32_bf16 v[124:127], v[24:27], v[240:243], v[124:127]
v_mfma_f32_16x16x32_bf16 v[128:131], v[28:31], v[240:243], v[128:131]
v_mfma_f32_16x16x32_bf16 v[132:135], v[24:27], v[100:103], v[132:135]
v_mfma_f32_16x16x32_bf16 v[136:139], v[28:31], v[100:103], v[136:139]
v_mfma_f32_16x16x32_bf16 v[140:143], v[24:27], v[104:107], v[140:143]
v_mfma_f32_16x16x32_bf16 v[144:147], v[28:31], v[104:107], v[144:147]
s_waitcnt lgkmcnt(4)
v_mfma_f32_16x16x32_bf16 v[116:119], v[32:35], v[188:191], v[116:119]
v_mfma_f32_16x16x32_bf16 v[120:123], v[36:39], v[188:191], v[120:123]
ds_read_b128 v[24:27], v3 offset:13312
ds_read_b128 v[28:31], v3 offset:13344
ds_read_b128 v[100:103], v2 offset:13312
ds_read_b128 v[104:107], v2 offset:27648
v_mfma_f32_16x16x32_bf16 v[124:127], v[32:35], v[244:247], v[124:127]
v_mfma_f32_16x16x32_bf16 v[128:131], v[36:39], v[244:247], v[128:131]
v_mfma_f32_16x16x32_bf16 v[132:135], v[32:35], v[108:111], v[132:135]
v_mfma_f32_16x16x32_bf16 v[136:139], v[36:39], v[108:111], v[136:139]
v_mfma_f32_16x16x32_bf16 v[140:143], v[32:35], v[112:115], v[140:143]
v_mfma_f32_16x16x32_bf16 v[144:147], v[36:39], v[112:115], v[144:147]
s_waitcnt lgkmcnt(4)
v_mfma_f32_16x16x32_bf16 v[116:119], v[16:19], v[192:195], v[116:119]
v_mfma_f32_16x16x32_bf16 v[120:123], v[20:23], v[192:195], v[120:123]
v_mfma_f32_16x16x32_bf16 v[124:127], v[16:19], v[248:251], v[124:127]
v_mfma_f32_16x16x32_bf16 v[128:131], v[20:23], v[248:251], v[128:131]
v_mfma_f32_16x16x32_bf16 v[132:135], v[16:19], v[92:95], v[132:135]
v_mfma_f32_16x16x32_bf16 v[136:139], v[20:23], v[92:95], v[136:139]
v_mfma_f32_16x16x32_bf16 v[140:143], v[16:19], v[96:99], v[140:143]
v_mfma_f32_16x16x32_bf16 v[144:147], v[20:23], v[96:99], v[144:147]
s_waitcnt lgkmcnt(0)
v_mfma_f32_16x16x32_bf16 v[116:119], v[24:27], v[196:199], v[116:119]
v_mfma_f32_16x16x32_bf16 v[120:123], v[28:31], v[196:199], v[120:123]
v_mfma_f32_16x16x32_bf16 v[124:127], v[24:27], v[252:255], v[124:127]
v_mfma_f32_16x16x32_bf16 v[128:131], v[28:31], v[252:255], v[128:131]
v_mfma_f32_16x16x32_bf16 v[132:135], v[24:27], v[100:103], v[132:135]
v_mfma_f32_16x16x32_bf16 v[136:139], v[28:31], v[100:103], v[136:139]
v_mfma_f32_16x16x32_bf16 v[140:143], v[24:27], v[104:107], v[140:143]
v_mfma_f32_16x16x32_bf16 v[144:147], v[28:31], v[104:107], v[144:147]
s_nop 1
s_add_u32 s40, s27, 4096
v_cvt_pk_bf16_f32 v60, v116, v117
v_cvt_pk_bf16_f32 v61, v118, v119
v_cvt_pk_bf16_f32 v62, v120, v121
v_cvt_pk_bf16_f32 v63, v122, v123
buffer_store_dwordx4 v[60:63], v1, s[4:7], s40 offen sc1
v_cvt_pk_bf16_f32 v64, v124, v125
v_cvt_pk_bf16_f32 v65, v126, v127
v_cvt_pk_bf16_f32 v66, v128, v129
v_cvt_pk_bf16_f32 v67, v130, v131
buffer_store_dwordx4 v[64:67], v1, s[4:7], s40 offen offset:2048 sc1
v_cvt_pk_bf16_f32 v68, v132, v133
v_cvt_pk_bf16_f32 v69, v134, v135
v_cvt_pk_bf16_f32 v70, v136, v137
v_cvt_pk_bf16_f32 v71, v138, v139
buffer_store_dwordx4 v[68:71], v1, s[4:7], s40 offen offset:1024 sc1
v_cvt_pk_bf16_f32 v72, v140, v141
v_cvt_pk_bf16_f32 v73, v142, v143
v_cvt_pk_bf16_f32 v74, v144, v145
v_cvt_pk_bf16_f32 v75, v146, v147
buffer_store_dwordx4 v[72:75], v1, s[4:7], s40 offen offset:3072 sc1
s_mov_b32 s36, s28
s_cmp_lt_u32 s29, 4
s_cselect_b32 s41, 2, 4
s_mul_i32 s40, s41, 28672
s_add_u32 s26, s26, s40
s_mul_i32 s40, s41, 458752
s_add_u32 s27, s27, s40
s_mul_i32 s40, s41, 1792
s_add_u32 s28, s28, s40
s_mul_i32 s40, s41, 1
s_add_u32 s29, s29, s40
s_cmp_lt_u32 s25, 4
s_cbranch_scc0 TB_PV1
s_cmp_lt_u32 s29, 20
s_cbranch_scc0 TB_PV01
s_barrier
s_mov_b32 m0, 7168
s_add_u32 s40, s26, 7168
buffer_load_dwordx4 v1, s[4:7], s40 offen lds
s_mov_b32 m0, 8192
s_add_u32 s40, s26, 8192
buffer_load_dwordx4 v1, s[4:7], s40 offen lds
s_mov_b32 m0, 9216
s_add_u32 s40, s26, 9216
buffer_load_dwordx4 v1, s[4:7], s40 offen lds
s_mov_b32 m0, 10240
s_add_u32 s40, s26, 10240
buffer_load_dwordx4 v1, s[4:7], s40 offen lds
s_mov_b32 m0, 11264
s_add_u32 s40, s26, 11264
buffer_load_dwordx4 v1, s[4:7], s40 offen lds
s_mov_b32 m0, 12288
s_add_u32 s40, s26, 12288
buffer_load_dwordx4 v1, s[4:7], s40 offen lds
s_mov_b32 m0, 13312
s_add_u32 s40, s26, 13312
buffer_load_dwordx4 v1, s[4:7], s40 offen lds
s_waitcnt vmcnt(7)
v_mov_b32 v12, s88
buffer_store_dword v12, off, s[4:7], s36 sc1
s_mov_b32 s36, 0
s_waitcnt vmcnt(1)
s_branch TB_Y1
TB_PV01:
s_waitcnt vmcnt(0)
v_mov_b32 v12, s88
buffer_store_dword v12, off, s[4:7], s36 sc1
s_mov_b32 s36, 0
v_min_u32 v14, 55, v0
v_and_b32 v11, 3, v14
v_lshlrev_b32 v11, 3, v11
v_lshrrev_b32 v14, 2, v14
v_lshl_add_u32 v11, v14, 7, v11
s_mov_b32 s43, 4352
Llz_233:
buffer_load_dwordx2 v[14:15], v11, s[4:7], s43 offen sc1
s_waitcnt vmcnt(0)
v_cmp_ne_u32 vcc, s88, v14
v_cmp_ne_u32 s[40:41], s88, v15
s_or_b64 vcc, vcc, s[40:41]
s_cbranch_vccz Llzok_234
s_sleep 8
s_sub_u32 s24, s24, 1
s_cbranch_scc0 Llz_233
s_endpgm
Llzok_234:
v_min_u32 v14, 47, v0
v_and_b32 v11, 3, v14
v_lshlrev_b32 v11, 3, v11
v_lshrrev_b32 v14, 2, v14
v_lshl_add_u32 v11, v14, 7, v11
s_mov_b32 s43, 6144
Llz_235:
buffer_load_dwordx2 v[14:15], v11, s[4:7], s43 offen sc1
s_waitcnt vmcnt(0)
v_cmp_ne_u32 vcc, s88, v14
v_cmp_ne_u32 s[40:41], s88, v15
s_or_b64 vcc, vcc, s[40:41]
s_cbranch_vccz Llzok_236
s_sleep 8
s_sub_u32 s24, s24, 1
s_cbranch_scc0 Llz_235
s_endpgm
Llzok_236:
TB_PV1:
s_barrier
s_cmp_lt_u32 s29, 64
s_cbranch_scc0 Lnorows_237
s_mov_b32 m0, 7168
s_add_u32 s40, s26, 7168
buffer_load_dwordx4 v1, s[4:7], s40 offen lds
s_mov_b32 m0, 8192
s_add_u32 s40, s26, 8192
buffer_load_dwordx4 v1, s[4:7], s40 offen lds
s_mov_b32 m0, 9216
s_add_u32 s40, s26, 9216
buffer_load_dwordx4 v1, s[4:7], s40 offen lds
s_mov_b32 m0, 10240
s_add_u32 s40, s26, 10240
buffer_load_dwordx4 v1, s[4:7], s40 offen lds
s_mov_b32 m0, 11264
s_add_u32 s40, s26, 11264
buffer_load_dwordx4 v1, s[4:7], s40 offen lds
s_mov_b32 m0, 12288
s_add_u32 s40, s26, 12288
buffer_load_dwordx4 v1, s[4:7], s40 offen lds
s_mov_b32 m0, 13312
s_add_u32 s40, s26, 13312
buffer_load_dwordx4 v1, s[4:7], s40 offen lds
Lnorows_237:
s_cmp_lt_u32 s25, 8
s_cbranch_scc0 Lmine_238
s_lshl_b32 s40, s25, 7
s_add_u32 s40, s40, 139264
s_branch Lfirst_240
Lflag_239:
v_cmp_ne_u32 vcc, s88, v11
s_cbranch_vccz Lset_241
s_sleep 16
Lfirst_240:
buffer_load_dword v11, off, s[4:7], s40 sc1
s_waitcnt vmcnt(0)
s_sub_u32 s24, s24, 1
s_cbranch_scc0 Lflag_239
s_endpgm
Lset_241:
Lmine_238:
s_add_u32 s40, s30, 4096
buffer_load_dwordx4 v[44:47], v1, s[4:7], s30 offen sc1
buffer_load_dwordx4 v[48:51], v1, s[4:7], s30 offen offset:1024 sc1
buffer_load_dwordx4 v[52:55], v1, s[4:7], s30 offen offset:2048 sc1
buffer_load_dwordx4 v[56:59], v1, s[4:7], s30 offen offset:3072 sc1
buffer_load_dwordx4 v[60:63], v1, s[4:7], s40 offen sc1
buffer_load_dwordx4 v[64:67], v1, s[4:7], s40 offen offset:1024 sc1
buffer_load_dwordx4 v[68:71], v1, s[4:7], s40 offen offset:2048 sc1
buffer_load_dwordx4 v[72:75], v1, s[4:7], s40 offen offset:3072 sc1
buffer_load_dwordx2 v[14:15], v8, s[8:11], s34 offen
ds_read_b128 v[92:95], v2 offset:4096
ds_read_b128 v[96:99], v2 offset:5120
ds_read_b128 v[100:103], v2 offset:6144
ds_read_b128 v[104:107], v2 offset:7168
ds_read_b128 v[108:111], v2
ds_read_b128 v[112:115], v2 offset:1024
v_mov_b32 v116, 0
v_mov_b32 v117, 0
v_mov_b32 v118, 0
v_mov_b32 v119, 0
v_mov_b32 v120, 0
v_mov_b32 v121, 0
v_mov_b32 v122, 0
v_mov_b32 v123, 0
v_mov_b32 v124, 0
v_mov_b32 v125, 0
v_mov_b32 v126, 0
v_mov_b32 v127, 0
v_mov_b32 v128, 0
v_mov_b32 v129, 0
v_mov_b32 v130, 0
v_mov_b32 v131, 0
v_mov_b32 v132, 0
v_mov_b32 v133, 0
v_mov_b32 v134, 0
v_mov_b32 v135, 0
v_mov_b32 v136, 0
v_mov_b32 v137, 0
v_mov_b32 v138, 0
v_mov_b32 v139, 0
v_mov_b32 v140, 0
v_mov_b32 v141, 0
v_mov_b32 v142, 0
v_mov_b32 v143, 0
v_mov_b32 v144, 0
v_mov_b32 v145, 0
v_mov_b32 v146, 0
v_mov_b32 v147, 0
Lspin_242:
buffer_load_dwordx4 v[24:27], v1, s[4:7], s31 offen sc1
buffer_load_dwordx4 v[28:31], v1, s[4:7], s31 offen offset:1024 sc1
s_sub_u32 s24, s24, 1
s_cbranch_scc1 CODE_END
s_waitcnt vmcnt(0)
v_max3_u32 v11, v24, v25, v26
v_max3_u32 v11, v11, v27, v28
v_max3_u32 v11, v11, v29, v30
v_max_u32 v11, v11, v31
v_cmp_eq_u32 vcc, -1, v11
s_cbranch_vccz Lspin_242x
s_cmp_ge_u32 s25, 58
s_cbranch_scc1 Lspin_242
s_sleep 8
s_branch Lspin_242
Lspin_242x:
s_cmp_eq_u32 s36, 0
s_cbranch_scc1 Lpaid_243
v_mov_b32 v12, s88
buffer_store_dword v12, off, s[4:7], s36 sc1
s_mov_b32 s36, 0
Lpaid_243:
ds_write_b128 v1, v[24:27] offset:30848
ds_write_b128 v1, v[28:31] offset:31872
s_waitcnt lgkmcnt(0)
s_barrier
ds_read_b128 v[16:19], v1 offset:28800
ds_read_b128 v[20:23], v1 offset:29824
ds_read_b128 v[32:35], v1 offset:32896
ds_read_b128 v[36:39], v1 offset:33920
ds_read_b128 v[40:43], v1 offset:34944
v_smfmac_f32_16x16x64_bf16 v[116:119], v[24:27], a[16:23], v10
v_smfmac_f32_16x16x64_bf16 v[120:123], v[24:27], a[72:79], v10
v_smfmac_f32_16x16x64_bf16 v[124:127], v[24:27], a[128:135], v10
v_smfmac_f32_16x16x64_bf16 v[128:131], v[24:27], v[92:99], v10
v_smfmac_f32_16x16x64_bf16 v[116:119], v[28:31], a[24:31], v10
ds_read_b128 v[92:95], v2 offset:2048
v_smfmac_f32_16x16x64_bf16 v[120:123], v[28:31], a[80:87], v10
ds_read_b128 v[96:99], v2 offset:3072
v_smfmac_f32_16x16x64_bf16 v[124:127], v[28:31], a[136:143], v10
v_smfmac_f32_16x16x64_bf16 v[128:131], v[28:31], v[100:107], v10
s_waitcnt lgkmcnt(6)
v_smfmac_f32_16x16x64_bf16 v[116:119], v[16:19], a[0:7], v10
ds_read_b128 v[100:103], v2 offset:8192
v_smfmac_f32_16x16x64_bf16 v[120:123], v[16:19], a[56:63], v10
ds_read_b128 v[104:107], v2 offset:9216
v_smfmac_f32_16x16x64_bf16 v[124:127], v[16:19], a[112:119], v10
v_smfmac_f32_16x16x64_bf16 v[128:131], v[16:19], v[108:115], v10
s_waitcnt lgkmcnt(7)
v_smfmac_f32_16x16x64_bf16 v[116:119], v[20:23], a[8:15], v10
ds_read_b128 v[108:111], v2 offset:10240
v_smfmac_f32_16x16x64_bf16 v[120:123], v[20:23], a[64:71], v10
ds_read_b128 v[112:115], v2 offset:11264
v_smfmac_f32_16x16x64_bf16 v[124:127], v[20:23], a[120:127], v10
s_waitcnt lgkmcnt(4)
v_smfmac_f32_16x16x64_bf16 v[128:131], v[20:23], v[92:99], v10
v_smfmac_f32_16x16x64_bf16 v[116:119], v[32:35], a[32:39], v10
ds_read_b128 v[92:95], v2 offset:12288
v_smfmac_f32_16x16x64_bf16 v[120:123], v[32:35], a[88:95], v10
ds_read_b128 v[96:99], v2 offset:13312
v_smfmac_f32_16x16x64_bf16 v[124:127], v[32:35], a[144:151], v10
s_waitcnt lgkmcnt(4)
v_smfmac_f32_16x16x64_bf16 v[128:131], v[32:35], v[100:107], v10
v_smfmac_f32_16x16x64_bf16 v[116:119], v[36:39], a[40:47], v10
ds_read_b128 v[100:103], v2 offset:18432
v_smfmac_f32_16x16x64_bf16 v[120:123], v[36:39], a[96:103], v10
ds_read_b128 v[104:107], v2 offset:19456
v_smfmac_f32_16x16x64_bf16 v[124:127], v[36:39], a[152:159], v10
s_waitcnt lgkmcnt(4)
v_smfmac_f32_16x16x64_bf16 v[128:131], v[36:39], v[108:115], v10
v_smfmac_f32_16x16x64_bf16 v[116:119], v[40:43], a[48:55], v10
ds_read_b128 v[108:111], v2 offset:20480
v_smfmac_f32_16x16x64_bf16 v[120:123], v[40:43], a[104:111], v10
ds_read_b128 v[112:115], v2 offset:21504
v_smfmac_f32_16x16x64_bf16 v[124:127], v[40:43], a[160:167], v10
s_waitcnt lgkmcnt(4)
v_smfmac_f32_16x16x64_bf16 v[128:131], v[40:43], v[92:99], v10
v_smfmac_f32_16x16x64_bf16 v[132:135], v[24:27], a[184:191], v10
ds_read_b128 v[92:95], v2 offset:14336
v_smfmac_f32_16x16x64_bf16 v[136:139], v[24:27], a[240:247], v10
ds_read_b128 v[96:99], v2 offset:15360
v_smfmac_f32_16x16x64_bf16 v[140:143], v[24:27], v[216:223], v10
v_cvt_pk_bf16_f32 v76, v116, v117
s_waitcnt lgkmcnt(4)
v_smfmac_f32_16x16x64_bf16 v[144:147], v[24:27], v[100:107], v10
v_cvt_pk_bf16_f32 v77, v118, v119
v_smfmac_f32_16x16x64_bf16 v[132:135], v[28:31], a[192:199], v10
ds_read_b128 v[100:103], v2 offset:16384
v_smfmac_f32_16x16x64_bf16 v[136:139], v[28:31], a[248:255], v10
ds_read_b128 v[104:107], v2 offset:17408
v_smfmac_f32_16x16x64_bf16 v[140:143], v[28:31], v[224:231], v10
v_cvt_pk_bf16_f32 v84, v120, v121
s_waitcnt lgkmcnt(4)
v_smfmac_f32_16x16x64_bf16 v[144:147], v[28:31], v[108:115], v10
v_cvt_pk_bf16_f32 v85, v122, v123
v_smfmac_f32_16x16x64_bf16 v[132:135], v[16:19], a[168:175], v10
ds_read_b128 v[108:111], v2 offset:22528
v_smfmac_f32_16x16x64_bf16 v[136:139], v[16:19], a[224:231], v10
ds_read_b128 v[112:115], v2 offset:23552
v_smfmac_f32_16x16x64_bf16 v[140:143], v[16:19], v[200:207], v10
v_cvt_pk_bf16_f32 v78, v124, v125
s_waitcnt lgkmcnt(4)
v_smfmac_f32_16x16x64_bf16 v[144:147], v[16:19], v[92:99], v10
v_cvt_pk_bf16_f32 v79, v126, v127
v_smfmac_f32_16x16x64_bf16 v[132:135], v[20:23], a[176:183], v10
ds_read_b128 v[92:95], v2 offset:24576
v_smfmac_f32_16x16x64_bf16 v[136:139], v[20:23], a[232:239], v10
ds_read_b128 v[96:99], v2 offset:25600
v_smfmac_f32_16x16x64_bf16 v[140:143], v[20:23], v[208:215], v10
v_cvt_pk_bf16_f32 v82, v128, v129
s_waitcnt lgkmcnt(4)
v_smfmac_f32_16x16x64_bf16 v[144:147], v[20:23], v[100:107], v10
v_cvt_pk_bf16_f32 v83, v130, v131
v_smfmac_f32_16x16x64_bf16 v[132:135], v[32:35], a[200:207], v10
ds_read_b128 v[100:103], v2 offset:26624
v_smfmac_f32_16x16x64_bf16 v[136:139], v[32:35], v[176:183], v10
ds_read_b128 v[104:107], v2 offset:27648
v_smfmac_f32_16x16x64_bf16 v[140:143], v[32:35], v[232:239], v10
s_waitcnt lgkmcnt(4)
v_smfmac_f32_16x16x64_bf16 v[144:147], v[32:35], v[108:115], v10
v_smfmac_f32_16x16x64_bf16 v[132:135], v[36:39], a[208:215], v10
v_smfmac_f32_16x16x64_bf16 v[136:139], v[36:39], v[184:191], v10
v_smfmac_f32_16x16x64_bf16 v[140:143], v[36:39], v[240:247], v10
s_waitcnt lgkmcnt(2)
v_smfmac_f32_16x16x64_bf16 v[144:147], v[36:39], v[92:99], v10
v_smfmac_f32_16x16x64_bf16 v[132:135], v[40:43], a[216:223], v10
v_smfmac_f32_16x16x64_bf16 v[136:139], v[40:43], v[192:199], v10
v_smfmac_f32_16x16x64_bf16 v[140:143], v[40:43], v[248:255], v10
s_waitcnt lgkmcnt(0)
v_smfmac_f32_16x16x64_bf16 v[144:147], v[40:43], v[100:107], v10
s_nop 2
v_cvt_pk_bf16_f32 v86, v132, v133
v_cvt_pk_bf16_f32 v87, v134, v135
v_cvt_pk_bf16_f32 v80, v136, v137
v_cvt_pk_bf16_f32 v81, v138, v139
v_cvt_pk_bf16_f32 v88, v140, v141
v_cvt_pk_bf16_f32 v89, v142, v143
v_cvt_pk_bf16_f32 v90, v144, v145
v_cvt_pk_bf16_f32 v91, v146, v147
s_barrier
s_add_u32 s40, s32, 4096
Lpoll_244:
buffer_load_dwordx4 v[16:19], v1, s[4:7], s32 offen sc1
buffer_load_dwordx4 v[20:23], v1, s[4:7], s32 offen offset:1024 sc1
buffer_load_dwordx4 v[24:27], v1, s[4:7], s32 offen offset:2048 sc1
buffer_load_dwordx4 v[28:31], v1, s[4:7], s32 offen offset:3072 sc1
buffer_load_dwordx4 v[32:35], v1, s[4:7], s40 offen sc1
buffer_load_dwordx4 v[36:39], v1, s[4:7], s40 offen offset:1024 sc1
buffer_load_dwordx4 v[40:43], v1, s[4:7], s40 offen offset:2048 sc1
buffer_load_dwordx4 v[92:95], v1, s[4:7], s40 offen offset:3072 sc1
buffer_load_dwordx4 v[96:99], v4, s[4:7], s33 offen sc1
buffer_load_dwordx4 v[100:103], v4, s[4:7], s33 offen offset:512 sc1
buffer_load_dwordx4 v[104:107], v4, s[4:7], s33 offen offset:1024 sc1
buffer_load_dwordx4 v[108:111], v4, s[4:7], s33 offen offset:1536 sc1
s_waitcnt vmcnt(0)
v_max3_u32 v11, v16, v17, v18
v_max3_u32 v11, v11, v19, v20
v_max3_u32 v11, v11, v21, v22
v_max3_u32 v11, v11, v23, v24
v_max3_u32 v11, v11, v25, v26
v_max3_u32 v11, v11, v27, v28
v_max3_u32 v11, v11, v29, v30
v_max3_u32 v11, v11, v31, v32
v_max3_u32 v11, v11, v33, v34
v_max3_u32 v11, v11, v35, v36
v_max3_u32 v11, v11, v37, v38
v_max3_u32 v11, v11, v39, v40
v_max3_u32 v11, v11, v41, v42
v_max3_u32 v11, v11, v43, v92
v_max3_u32 v11, v11, v93, v94
v_max3_u32 v11, v11, v95, v96
v_max3_u32 v11, v11, v97, v98
v_max3_u32 v11, v11, v99, v100
v_max3_u32 v11, v11, v101, v102
v_max3_u32 v11, v11, v103, v104
v_max3_u32 v11, v11, v105, v106
v_max3_u32 v11, v11, v107, v108
v_max3_u32 v11, v11, v109, v110
v_max_u32 v11, v11, v111
v_cmp_eq_u32 vcc, -1, v11
s_cbranch_vccz Lgot_245
s_sub_u32 s24, s24, 1
s_cbranch_scc0 Lpoll_244
s_endpgm
Lgot_245:
v_mfma_f32_16x16x32_bf16 v[116:119], v[16:19], v[44:47], 0
v_mfma_f32_16x16x32_bf16 v[120:123], v[16:19], v[52:55], 0
v_mfma_f32_16x16x32_bf16 v[124:127], v[20:23], v[44:47], 0
v_mfma_f32_16x16x32_bf16 v[128:131], v[20:23], v[52:55], 0
v_mfma_f32_16x16x32_bf16 v[116:119], v[24:27], v[48:51], v[116:119]
v_mfma_f32_16x16x32_bf16 v[120:123], v[24:27], v[56:59], v[120:123]
v_mfma_f32_16x16x32_bf16 v[124:127], v[28:31], v[48:51], v[124:127]
v_mfma_f32_16x16x32_bf16 v[128:131], v[28:31], v[56:59], v[128:131]
v_mfma_f32_16x16x32_bf16 v[116:119], v[32:35], v[60:63], v[116:119]
v_mfma_f32_16x16x32_bf16 v[120:123], v[32:35], v[68:71], v[120:123]
v_mfma_f32_16x16x32_bf16 v[124:127], v[36:39], v[60:63], v[124:127]
v_mfma_f32_16x16x32_bf16 v[128:131], v[36:39], v[68:71], v[128:131]
v_mfma_f32_16x16x32_bf16 v[116:119], v[40:43], v[64:67], v[116:119]
v_mfma_f32_16x16x32_bf16 v[120:123], v[40:43], v[72:75], v[120:123]
v_mfma_f32_16x16x32_bf16 v[124:127], v[92:95], v[64:67], v[124:127]
v_mfma_f32_16x16x32_bf16 v[128:131], v[92:95], v[72:75], v[128:131]
v_mfma_f32_16x16x32_bf16 v[116:119], v[96:99], v[76:79], v[116:119]
v_mfma_f32_16x16x32_bf16 v[120:123], v[96:99], v[84:87], v[120:123]
v_mfma_f32_16x16x32_bf16 v[124:127], v[100:103], v[76:79], v[124:127]
v_mfma_f32_16x16x32_bf16 v[128:131], v[100:103], v[84:87], v[128:131]
v_mfma_f32_16x16x32_bf16 v[116:119], v[104:107], v[80:83], v[116:119]
v_mfma_f32_16x16x32_bf16 v[120:123], v[104:107], v[88:91], v[120:123]
v_mfma_f32_16x16x32_bf16 v[124:127], v[108:111], v[80:83], v[124:127]
v_mfma_f32_16x16x32_bf16 v[128:131], v[108:111], v[88:91], v[128:131]
s_nop 6
ds_write2_b32 v5, v116, v120 offset0:0 offset1:16
ds_write2_b32 v5, v117, v121 offset0:36 offset1:52
ds_write2_b32 v5, v118, v122 offset0:72 offset1:88
ds_write2_b32 v5, v119, v123 offset0:108 offset1:124
ds_write2_b32 v6, v124, v128 offset0:0 offset1:16
ds_write2_b32 v6, v125, v129 offset0:36 offset1:52
ds_write2_b32 v6, v126, v130 offset0:72 offset1:88
ds_write2_b32 v6, v127, v131 offset0:108 offset1:124
s_waitcnt lgkmcnt(0)
s_barrier
ds_read_b128 v[116:119], v7
ds_read_b128 v[120:123], v7 offset:4608
ds_read_b128 v[124:127], v7 offset:9216
ds_read_b128 v[128:131], v7 offset:13824
v_lshlrev_b32 v132, 16, v14
v_and_b32 v133, 0xffff0000, v14
v_lshlrev_b32 v134, 16, v15
v_and_b32 v135, 0xffff0000, v15
s_waitcnt lgkmcnt(0)
v_pk_add_f32 v[116:117], v[116:117], v[120:121]
v_pk_add_f32 v[124:125], v[124:125], v[128:129]
v_pk_add_f32 v[116:117], v[116:117], v[124:125]
v_cvt_pk_bf16_f32 v117, v116, v117
v_lshlrev_b32 v116, 16, v117
v_and_b32 v117, 0xffff0000, v117
v_pk_add_f32 v[116:117], v[116:117], v[132:133]
v_cvt_pk_bf16_f32 v136, v116, v117
v_min_u32 v136, -2, v136
v_pk_add_f32 v[118:119], v[118:119], v[122:123]
v_pk_add_f32 v[126:127], v[126:127], v[130:131]
v_pk_add_f32 v[118:119], v[118:119], v[126:127]
v_cvt_pk_bf16_f32 v119, v118, v119
v_lshlrev_b32 v118, 16, v119
v_and_b32 v119, 0xffff0000, v119
v_pk_add_f32 v[118:119], v[118:119], v[134:135]
v_cvt_pk_bf16_f32 v137, v118, v119
v_min_u32 v137, -2, v137
buffer_store_dwordx2 v[136:137], v9, s[4:7], s35 offen sc1
s_add_u32 s30, s30, 1835008
s_add_u32 s31, s31, 28672
s_add_u32 s32, s32, 163840
s_add_u32 s33, s33, 163840
s_add_u32 s34, s34, 114688
s_add_u32 s35, s35, 114688
s_add_u32 s25, s25, 4
s_cmp_lt_u32 s25, 64
s_cbranch_scc1 TB_TOP1
s_endpgm
TB_W2:
s_load_dwordx2 s[8:9], s[0:1], 0
s_mov_b32 s10, 1835008
s_mov_b32 s11, 0x00020000
s_sub_u32 s22, s22, 16
v_lshlrev_b32 v1, 4, v0
v_and_b32 v11, 7, v0
v_lshlrev_b32 v11, 2, v11
v_bfe_u32 v12, v0, 3, 1
v_lshl_add_u32 v11, v12, 7, v11
s_mov_b32 s40, 4352
s_branch Lfirst_247
Lflag_246:
v_cmp_ne_u32 vcc, s88, v12
s_cbranch_vccz Lset_248
s_sleep 4
Lfirst_247:
buffer_load_dword v12, v11, s[4:7], s40 offen sc1
s_waitcnt vmcnt(0)
s_sub_u32 s24, s24, 1
s_cbranch_scc0 Lflag_246
s_endpgm
Lset_248:
s_cmp_lt_u32 s21, 2
s_cselect_b32 s29, 0, 4
s_add_u32 s29, s29, s21
s_mul_i32 s26, s29, 28672
s_add_u32 s26, s26, 8044544
s_mov_b32 m0, 14368
s_add_u32 s40, s26, 14336
buffer_load_dwordx4 v1, s[4:7], s40 offen lds
s_mov_b32 m0, 15392
s_add_u32 s40, s26, 15360
buffer_load_dwordx4 v1, s[4:7], s40 offen lds
s_mov_b32 m0, 16416
s_add_u32 s40, s26, 16384
buffer_load_dwordx4 v1, s[4:7], s40 offen lds
s_mov_b32 m0, 17440
s_add_u32 s40, s26, 17408
buffer_load_dwordx4 v1, s[4:7], s40 offen lds
s_mov_b32 m0, 18464
s_add_u32 s40, s26, 18432
buffer_load_dwordx4 v1, s[4:7], s40 offen lds
s_mov_b32 m0, 19488
s_add_u32 s40, s26, 19456
buffer_load_dwordx4 v1, s[4:7], s40 offen lds
s_mov_b32 m0, 20512
s_add_u32 s40, s26, 20480
buffer_load_dwordx4 v1, s[4:7], s40 offen lds
v_and_b32 v11, 7, v0
v_min_u32 v11, 6, v11
v_lshlrev_b32 v11, 2, v11
v_bfe_u32 v12, v0, 3, 2
v_lshl_add_u32 v11, v12, 7, v11
s_mov_b32 s40, 3072
s_branch Lfirst_250
Lflag_249:
v_cmp_ne_u32 vcc, s88, v12
s_cbranch_vccz Lset_251
s_sleep 4
Lfirst_250:
buffer_load_dword v12, v11, s[4:7], s40 offen sc1
s_waitcnt vmcnt(0)
s_sub_u32 s24, s24, 1
s_cbranch_scc0 Lflag_249
s_endpgm
Lset_251:
s_cmp_lt_u32 s21, 2
s_cbranch_scc1 Learly_252
s_mov_b32 s40, 139264
s_branch Lfirst_254
Lflag_253:
v_cmp_ne_u32 vcc, s88, v11
s_cbranch_vccz Lset_255
s_sleep 16
Lfirst_254:
buffer_load_dword v11, off, s[4:7], s40 sc1
s_waitcnt vmcnt(0)
s_sub_u32 s24, s24, 1
s_cbranch_scc0 Lflag_253
s_endpgm
Lset_255:
Learly_252:
s_mul_i32 s40, s22, 458752
s_add_u32 s40, s40, 16531456
s_add_u32 s41, s40, 86016
s_add_u32 s43, s40, 57344
buffer_load_dwordx4 a[0:3], v1, s[4:7], s40 offen
buffer_load_dwordx4 a[4:7], v1, s[4:7], s40 offen offset:1024
buffer_load_dwordx4 a[8:11], v1, s[4:7], s40 offen offset:2048
buffer_load_dwordx4 a[12:15], v1, s[4:7], s40 offen offset:3072
s_add_u32 s40, s40, 4096
buffer_load_dwordx4 a[16:19], v1, s[4:7], s40 offen
buffer_load_dwordx4 a[20:23], v1, s[4:7], s40 offen offset:1024
buffer_load_dwordx4 a[24:27], v1, s[4:7], s40 offen offset:2048
buffer_load_dwordx4 a[28:31], v1, s[4:7], s40 offen offset:3072
s_add_u32 s40, s40, 4096
buffer_load_dwordx4 a[32:35], v1, s[4:7], s40 offen
buffer_load_dwordx4 a[36:39], v1, s[4:7], s40 offen offset:1024
buffer_load_dwordx4 a[40:43], v1, s[4:7], s40 offen offset:2048
buffer_load_dwordx4 a[44:47], v1, s[4:7], s40 offen offset:3072
s_add_u32 s40, s40, 4096
buffer_load_dwordx4 a[48:51], v1, s[4:7], s40 offen
buffer_load_dwordx4 a[52:55], v1, s[4:7], s40 offen offset:1024
buffer_load_dwordx4 a[56:59], v1, s[4:7], s40 offen offset:2048
buffer_load_dwordx4 a[60:63], v1, s[4:7], s40 offen offset:3072
s_add_u32 s40, s40, 4096
buffer_load_dwordx4 a[64:67], v1, s[4:7], s40 offen
buffer_load_dwordx4 a[68:71], v1, s[4:7], s40 offen offset:1024
buffer_load_dwordx4 a[72:75], v1, s[4:7], s40 offen offset:2048
buffer_load_dwordx4 a[76:79], v1, s[4:7], s40 offen offset:3072
s_add_u32 s40, s40, 4096
buffer_load_dwordx4 a[80:83], v1, s[4:7], s40 offen
buffer_load_dwordx4 a[84:87], v1, s[4:7], s40 offen offset:1024
buffer_load_dwordx4 a[88:91], v1, s[4:7], s40 offen offset:2048
buffer_load_dwordx4 a[92:95], v1, s[4:7], s40 offen offset:3072
s_add_u32 s40, s40, 4096
buffer_load_dwordx4 a[96:99], v1, s[4:7], s40 offen
buffer_load_dwordx4 a[100:103], v1, s[4:7], s40 offen offset:1024
buffer_load_dwordx4 a[104:107], v1, s[4:7], s40 offen offset:2048
buffer_load_dwordx4 a[108:111], v1, s[4:7], s40 offen offset:3072
s_add_u32 s40, s40, 4096
buffer_load_dwordx4 a[112:115], v1, s[4:7], s40 offen
buffer_load_dwordx4 a[116:119], v1, s[4:7], s40 offen offset:1024
buffer_load_dwordx4 a[120:123], v1, s[4:7], s40 offen offset:2048
buffer_load_dwordx4 a[124:127], v1, s[4:7], s40 offen offset:3072
s_add_u32 s40, s40, 4096
buffer_load_dwordx4 a[128:131], v1, s[4:7], s40 offen
buffer_load_dwordx4 a[132:135], v1, s[4:7], s40 offen offset:1024
buffer_load_dwordx4 a[136:139], v1, s[4:7], s40 offen offset:2048
buffer_load_dwordx4 a[140:143], v1, s[4:7], s40 offen offset:3072
s_add_u32 s40, s40, 4096
buffer_load_dwordx4 a[144:147], v1, s[4:7], s40 offen
buffer_load_dwordx4 a[148:151], v1, s[4:7], s40 offen offset:1024
buffer_load_dwordx4 a[152:155], v1, s[4:7], s40 offen offset:2048
buffer_load_dwordx4 a[156:159], v1, s[4:7], s40 offen offset:3072
s_add_u32 s40, s40, 4096
s_waitcnt vmcnt(32)
buffer_load_dwordx4 a[160:163], v1, s[4:7], s40 offen
buffer_load_dwordx4 a[164:167], v1, s[4:7], s40 offen offset:1024
buffer_load_dwordx4 a[168:171], v1, s[4:7], s40 offen offset:2048
buffer_load_dwordx4 a[172:175], v1, s[4:7], s40 offen offset:3072
s_add_u32 s40, s40, 4096
buffer_load_dwordx4 a[176:179], v1, s[4:7], s40 offen
buffer_load_dwordx4 a[180:183], v1, s[4:7], s40 offen offset:1024
buffer_load_dwordx4 a[184:187], v1, s[4:7], s40 offen offset:2048
buffer_load_dwordx4 a[188:191], v1, s[4:7], s40 offen offset:3072
s_add_u32 s40, s40, 4096
s_waitcnt vmcnt(32)
buffer_load_dwordx4 a[192:195], v1, s[4:7], s40 offen
buffer_load_dwordx4 a[196:199], v1, s[4:7], s40 offen offset:1024
buffer_load_dwordx4 a[200:203], v1, s[4:7], s40 offen offset:2048
buffer_load_dwordx4 a[204:207], v1, s[4:7], s40 offen offset:3072
s_add_u32 s40, s40, 4096
buffer_load_dwordx4 a[208:211], v1, s[4:7], s40 offen
buffer_load_dwordx4 a[212:215], v1, s[4:7], s40 offen offset:1024
buffer_load_dwordx4 a[216:219], v1, s[4:7], s40 offen offset:2048
buffer_load_dwordx4 a[220:223], v1, s[4:7], s40 offen offset:3072
s_waitcnt vmcnt(40)
s_mov_b32 m0, 106496
s_add_u32 s42, s41, 0
buffer_load_dwordx4 v1, s[4:7], s42 offen lds
s_mov_b32 m0, 107520
s_add_u32 s42, s41, 1024
buffer_load_dwordx4 v1, s[4:7], s42 offen lds
s_mov_b32 m0, 108544
s_add_u32 s42, s41, 2048
buffer_load_dwordx4 v1, s[4:7], s42 offen lds
s_mov_b32 m0, 109568
s_add_u32 s42, s41, 3072
buffer_load_dwordx4 v1, s[4:7], s42 offen lds
s_mov_b32 m0, 110592
s_add_u32 s42, s41, 4096
buffer_load_dwordx4 v1, s[4:7], s42 offen lds
s_mov_b32 m0, 111616
s_add_u32 s42, s41, 5120
buffer_load_dwordx4 v1, s[4:7], s42 offen lds
s_mov_b32 m0, 112640
s_add_u32 s42, s41, 6144
buffer_load_dwordx4 v1, s[4:7], s42 offen lds
s_mov_b32 m0, 113664
s_add_u32 s42, s41, 7168
buffer_load_dwordx4 v1, s[4:7], s42 offen lds
s_waitcnt vmcnt(40)
s_mov_b32 m0, 114688
s_add_u32 s42, s41, 8192
buffer_load_dwordx4 v1, s[4:7], s42 offen lds
s_mov_b32 m0, 115712
s_add_u32 s42, s41, 9216
buffer_load_dwordx4 v1, s[4:7], s42 offen lds
s_mov_b32 m0, 116736
s_add_u32 s42, s41, 10240
buffer_load_dwordx4 v1, s[4:7], s42 offen lds
s_mov_b32 m0, 117760
s_add_u32 s42, s41, 11264
buffer_load_dwordx4 v1, s[4:7], s42 offen lds
s_mov_b32 m0, 118784
s_add_u32 s42, s41, 12288
buffer_load_dwordx4 v1, s[4:7], s42 offen lds
s_mov_b32 m0, 119808
s_add_u32 s42, s41, 13312
buffer_load_dwordx4 v1, s[4:7], s42 offen lds
s_mov_b32 m0, 120832
s_add_u32 s42, s41, 14336
buffer_load_dwordx4 v1, s[4:7], s42 offen lds
s_mov_b32 m0, 121856
s_add_u32 s42, s41, 15360
buffer_load_dwordx4 v1, s[4:7], s42 offen lds
s_waitcnt vmcnt(40)
s_mov_b32 m0, 122880
s_add_u32 s42, s41, 16384
buffer_load_dwordx4 v1, s[4:7], s42 offen lds
s_mov_b32 m0, 123904
s_add_u32 s42, s41, 17408
buffer_load_dwordx4 v1, s[4:7], s42 offen lds
s_mov_b32 m0, 124928
s_add_u32 s42, s41, 18432
buffer_load_dwordx4 v1, s[4:7], s42 offen lds
s_mov_b32 m0, 125952
s_add_u32 s42, s41, 19456
buffer_load_dwordx4 v1, s[4:7], s42 offen lds
s_mov_b32 m0, 126976
s_add_u32 s42, s41, 20480
buffer_load_dwordx4 v1, s[4:7], s42 offen lds
s_mov_b32 m0, 128000
s_add_u32 s42, s41, 21504
buffer_load_dwordx4 v1, s[4:7], s42 offen lds
s_mov_b32 m0, 129024
s_add_u32 s42, s41, 22528
buffer_load_dwordx4 v1, s[4:7], s42 offen lds
s_mov_b32 m0, 130048
s_add_u32 s42, s41, 23552
buffer_load_dwordx4 v1, s[4:7], s42 offen lds
s_waitcnt vmcnt(40)
s_mov_b32 m0, 131072
s_add_u32 s42, s41, 24576
buffer_load_dwordx4 v1, s[4:7], s42 offen lds
s_mov_b32 m0, 132096
s_add_u32 s42, s41, 25600
buffer_load_dwordx4 v1, s[4:7], s42 offen lds
s_mov_b32 m0, 133120
s_add_u32 s42, s41, 26624
buffer_load_dwordx4 v1, s[4:7], s42 offen lds
s_mov_b32 m0, 134144
s_add_u32 s42, s41, 27648
buffer_load_dwordx4 v1, s[4:7], s42 offen lds
s_waitcnt vmcnt(52)
buffer_load_dwordx4 a[224:227], v1, s[4:7], s43 offen
buffer_load_dwordx4 a[228:231], v1, s[4:7], s43 offen offset:1024
buffer_load_dwordx4 a[232:235], v1, s[4:7], s43 offen offset:2048
buffer_load_dwordx4 a[236:239], v1, s[4:7], s43 offen offset:3072
s_add_u32 s43, s43, 4096
s_waitcnt vmcnt(52)
buffer_load_dwordx4 a[240:243], v1, s[4:7], s43 offen
buffer_load_dwordx4 a[244:247], v1, s[4:7], s43 offen offset:1024
buffer_load_dwordx4 a[248:251], v1, s[4:7], s43 offen offset:2048
buffer_load_dwordx4 a[252:255], v1, s[4:7], s43 offen offset:3072
s_add_u32 s43, s43, 4096
s_waitcnt vmcnt(52)
buffer_load_dwordx4 v[176:179], v1, s[4:7], s43 offen
buffer_load_dwordx4 v[180:183], v1, s[4:7], s43 offen offset:1024
buffer_load_dwordx4 v[184:187], v1, s[4:7], s43 offen offset:2048
buffer_load_dwordx4 v[188:191], v1, s[4:7], s43 offen offset:3072
s_add_u32 s43, s43, 4096
s_waitcnt vmcnt(52)
buffer_load_dwordx4 v[192:195], v1, s[4:7], s43 offen
buffer_load_dwordx4 v[196:199], v1, s[4:7], s43 offen offset:1024
buffer_load_dwordx4 v[200:203], v1, s[4:7], s43 offen offset:2048
buffer_load_dwordx4 v[204:207], v1, s[4:7], s43 offen offset:3072
s_add_u32 s43, s43, 4096
s_waitcnt vmcnt(52)
buffer_load_dwordx4 v[208:211], v1, s[4:7], s43 offen
buffer_load_dwordx4 v[212:215], v1, s[4:7], s43 offen offset:1024
buffer_load_dwordx4 v[216:219], v1, s[4:7], s43 offen offset:2048
buffer_load_dwordx4 v[220:223], v1, s[4:7], s43 offen offset:3072
s_add_u32 s43, s43, 4096
s_waitcnt vmcnt(52)
buffer_load_dwordx4 v[224:227], v1, s[4:7], s43 offen
buffer_load_dwordx4 v[228:231], v1, s[4:7], s43 offen offset:1024
buffer_load_dwordx4 v[232:235], v1, s[4:7], s43 offen offset:2048
buffer_load_dwordx4 v[236:239], v1, s[4:7], s43 offen offset:3072
s_add_u32 s43, s43, 4096
s_waitcnt vmcnt(52)
buffer_load_dwordx4 v[240:243], v1, s[4:7], s43 offen
buffer_load_dwordx4 v[244:247], v1, s[4:7], s43 offen offset:1024
buffer_load_dwordx4 v[248:251], v1, s[4:7], s43 offen offset:2048
buffer_load_dwordx4 v[252:255], v1, s[4:7], s43 offen offset:3072
s_add_u32 s43, s43, 4096
v_add_u32 v2, 106496, v1
v_and_b32 v11, 15, v0
v_lshrrev_b32 v12, 4, v0
v_bfe_u32 v3, v0, 3, 1
v_mul_u32_u24 v3, 14368, v3
v_lshl_add_u32 v3, v12, 8, v3
v_bfe_u32 v4, v0, 2, 1
v_lshl_add_u32 v3, v4, 6, v3
v_bfe_u32 v4, v0, 1, 1
v_lshl_add_u32 v3, v4, 7, v3
v_and_b32 v4, 1, v0
v_lshl_add_u32 v3, v4, 4, v3
v_and_b32 v4, 31, v0
v_lshlrev_b32 v4, 4, v4
v_mul_u32_u24 v5, 576, v12
v_lshl_add_u32 v5, v11, 2, v5
v_add_u32 v5, 38016, v5
v_add_u32 v6, 2304, v5
v_lshrrev_b32 v11, 3, v0
v_add_u32 v11, 16, v11
v_and_b32 v12, 7, v0
v_mul_u32_u24 v7, 144, v11
v_lshl_add_u32 v7, v12, 4, v7
v_add_u32 v7, 28800, v7
v_mul_u32_u24 v8, 896, v11
v_lshl_add_u32 v8, v12, 3, v8
v_and_b32 v9, 15, v11
v_lshlrev_b32 v9, 4, v9
v_lshrrev_b32 v11, 1, v12
v_lshl_add_u32 v9, v11, 8, v9
v_and_b32 v11, 1, v12
v_lshl_add_u32 v9, v11, 3, v9
v_and_b32 v11, 8, v0
v_cmp_eq_u32 vcc, 0, v11
v_mov_b32 v11, 0x88884444
v_mov_b32 v10, 0xddddeeee
v_cndmask_b32 v10, v10, v11, vcc
s_mul_i32 s34, s21, 28672
s_lshl_b32 s40, s22, 10
s_add_u32 s35, s34, s40
s_add_u32 s35, s35, 4384768
s_lshl_b32 s40, s22, 6
s_add_u32 s34, s34, s40
s_lshl_b32 s40, s22, 15
s_add_u32 s40, s40, 30081024
s_mul_i32 s30, s21, 458752
s_add_u32 s30, s30, s40
s_mul_i32 s27, s29, 458752
s_add_u32 s27, s27, s40
s_lshl_b32 s40, s22, 7
s_add_u32 s40, s40, 8200
s_mul_i32 s28, s29, 1792
s_add_u32 s28, s28, s40
s_mul_i32 s31, s21, 7168
s_add_u32 s31, s31, 638976
s_mul_i32 s32, s21, 40960
s_add_u32 s33, s32, 1785856
s_add_u32 s32, s32, 1765376
s_mov_b32 s25, s21
s_waitcnt vmcnt(56) lgkmcnt(0)
s_branch TB_Y2
TB_TOP2:
s_cmp_lt_u32 s29, 64
s_cbranch_scc0 TB_PV2
TB_Y2:
s_barrier
ds_read_b128 v[16:19], v3
ds_read_b128 v[20:23], v3 offset:32
ds_read_b128 v[24:27], v3 offset:1024
ds_read_b128 v[28:31], v3 offset:1056
s_waitcnt lgkmcnt(2)
v_mfma_f32_16x16x32_bf16 v[116:119], v[16:19], a[0:3], 0
v_mfma_f32_16x16x32_bf16 v[120:123], v[20:23], a[0:3], 0
ds_read_b128 v[32:35], v3 offset:2048
ds_read_b128 v[36:39], v3 offset:2080
v_mfma_f32_16x16x32_bf16 v[124:127], v[16:19], a[56:59], 0
v_mfma_f32_16x16x32_bf16 v[128:131], v[20:23], a[56:59], 0
v_mfma_f32_16x16x32_bf16 v[132:135], v[16:19], a[112:115], 0
v_mfma_f32_16x16x32_bf16 v[136:139], v[20:23], a[112:115], 0
v_mfma_f32_16x16x32_bf16 v[140:143], v[16:19], a[168:171], 0
v_mfma_f32_16x16x32_bf16 v[144:147], v[20:23], a[168:171], 0
s_waitcnt lgkmcnt(2)
v_mfma_f32_16x16x32_bf16 v[116:119], v[24:27], a[4:7], v[116:119]
v_mfma_f32_16x16x32_bf16 v[120:123], v[28:31], a[4:7], v[120:123]
ds_read_b128 v[16:19], v3 offset:3072
ds_read_b128 v[20:23], v3 offset:3104
v_mfma_f32_16x16x32_bf16 v[124:127], v[24:27], a[60:63], v[124:127]
v_mfma_f32_16x16x32_bf16 v[128:131], v[28:31], a[60:63], v[128:131]
v_mfma_f32_16x16x32_bf16 v[132:135], v[24:27], a[116:119], v[132:135]
v_mfma_f32_16x16x32_bf16 v[136:139], v[28:31], a[116:119], v[136:139]
v_mfma_f32_16x16x32_bf16 v[140:143], v[24:27], a[172:175], v[140:143]
v_mfma_f32_16x16x32_bf16 v[144:147], v[28:31], a[172:175], v[144:147]
s_waitcnt lgkmcnt(2)
v_mfma_f32_16x16x32_bf16 v[116:119], v[32:35], a[8:11], v[116:119]
v_mfma_f32_16x16x32_bf16 v[120:123], v[36:39], a[8:11], v[120:123]
ds_read_b128 v[24:27], v3 offset:4096
ds_read_b128 v[28:31], v3 offset:4128
v_mfma_f32_16x16x32_bf16 v[124:127], v[32:35], a[64:67], v[124:127]
v_mfma_f32_16x16x32_bf16 v[128:131], v[36:39], a[64:67], v[128:131]
v_mfma_f32_16x16x32_bf16 v[132:135], v[32:35], a[120:123], v[132:135]
v_mfma_f32_16x16x32_bf16 v[136:139], v[36:39], a[120:123], v[136:139]
v_mfma_f32_16x16x32_bf16 v[140:143], v[32:35], a[176:179], v[140:143]
v_mfma_f32_16x16x32_bf16 v[144:147], v[36:39], a[176:179], v[144:147]
s_waitcnt lgkmcnt(2)
v_mfma_f32_16x16x32_bf16 v[116:119], v[16:19], a[12:15], v[116:119]
v_mfma_f32_16x16x32_bf16 v[120:123], v[20:23], a[12:15], v[120:123]
ds_read_b128 v[32:35], v3 offset:5120
ds_read_b128 v[36:39], v3 offset:5152
v_mfma_f32_16x16x32_bf16 v[124:127], v[16:19], a[68:71], v[124:127]
v_mfma_f32_16x16x32_bf16 v[128:131], v[20:23], a[68:71], v[128:131]
v_mfma_f32_16x16x32_bf16 v[132:135], v[16:19], a[124:127], v[132:135]
v_mfma_f32_16x16x32_bf16 v[136:139], v[20:23], a[124:127], v[136:139]
v_mfma_f32_16x16x32_bf16 v[140:143], v[16:19], a[180:183], v[140:143]
v_mfma_f32_16x16x32_bf16 v[144:147], v[20:23], a[180:183], v[144:147]
s_waitcnt lgkmcnt(2)
v_mfma_f32_16x16x32_bf16 v[116:119], v[24:27], a[16:19], v[116:119]
v_mfma_f32_16x16x32_bf16 v[120:123], v[28:31], a[16:19], v[120:123]
ds_read_b128 v[16:19], v3 offset:6144
ds_read_b128 v[20:23], v3 offset:6176
v_mfma_f32_16x16x32_bf16 v[124:127], v[24:27], a[72:75], v[124:127]
v_mfma_f32_16x16x32_bf16 v[128:131], v[28:31], a[72:75], v[128:131]
v_mfma_f32_16x16x32_bf16 v[132:135], v[24:27], a[128:131], v[132:135]
v_mfma_f32_16x16x32_bf16 v[136:139], v[28:31], a[128:131], v[136:139]
v_mfma_f32_16x16x32_bf16 v[140:143], v[24:27], a[184:187], v[140:143]
v_mfma_f32_16x16x32_bf16 v[144:147], v[28:31], a[184:187], v[144:147]
s_waitcnt lgkmcnt(2)
v_mfma_f32_16x16x32_bf16 v[116:119], v[32:35], a[20:23], v[116:119]
v_mfma_f32_16x16x32_bf16 v[120:123], v[36:39], a[20:23], v[120:123]
ds_read_b128 v[24:27], v3 offset:7168
ds_read_b128 v[28:31], v3 offset:7200
v_mfma_f32_16x16x32_bf16 v[124:127], v[32:35], a[76:79], v[124:127]
v_mfma_f32_16x16x32_bf16 v[128:131], v[36:39], a[76:79], v[128:131]
v_mfma_f32_16x16x32_bf16 v[132:135], v[32:35], a[132:135], v[132:135]
v_mfma_f32_16x16x32_bf16 v[136:139], v[36:39], a[132:135], v[136:139]
v_mfma_f32_16x16x32_bf16 v[140:143], v[32:35], a[188:191], v[140:143]
v_mfma_f32_16x16x32_bf16 v[144:147], v[36:39], a[188:191], v[144:147]
s_waitcnt lgkmcnt(2)
v_mfma_f32_16x16x32_bf16 v[116:119], v[16:19], a[24:27], v[116:119]
v_mfma_f32_16x16x32_bf16 v[120:123], v[20:23], a[24:27], v[120:123]
ds_read_b128 v[32:35], v3 offset:8192
ds_read_b128 v[36:39], v3 offset:8224
v_mfma_f32_16x16x32_bf16 v[124:127], v[16:19], a[80:83], v[124:127]
v_mfma_f32_16x16x32_bf16 v[128:131], v[20:23], a[80:83], v[128:131]
v_mfma_f32_16x16x32_bf16 v[132:135], v[16:19], a[136:139], v[132:135]
v_mfma_f32_16x16x32_bf16 v[136:139], v[20:23], a[136:139], v[136:139]
v_mfma_f32_16x16x32_bf16 v[140:143], v[16:19], a[192:195], v[140:143]
v_mfma_f32_16x16x32_bf16 v[144:147], v[20:23], a[192:195], v[144:147]
s_waitcnt lgkmcnt(2)
v_mfma_f32_16x16x32_bf16 v[116:119], v[24:27], a[28:31], v[116:119]
v_mfma_f32_16x16x32_bf16 v[120:123], v[28:31], a[28:31], v[120:123]
ds_read_b128 v[16:19], v3 offset:9216
ds_read_b128 v[20:23], v3 offset:9248
v_mfma_f32_16x16x32_bf16 v[124:127], v[24:27], a[84:87], v[124:127]
v_mfma_f32_16x16x32_bf16 v[128:131], v[28:31], a[84:87], v[128:131]
v_mfma_f32_16x16x32_bf16 v[132:135], v[24:27], a[140:143], v[132:135]
v_mfma_f32_16x16x32_bf16 v[136:139], v[28:31], a[140:143], v[136:139]
v_mfma_f32_16x16x32_bf16 v[140:143], v[24:27], a[196:199], v[140:143]
v_mfma_f32_16x16x32_bf16 v[144:147], v[28:31], a[196:199], v[144:147]
s_waitcnt lgkmcnt(2)
v_mfma_f32_16x16x32_bf16 v[116:119], v[32:35], a[32:35], v[116:119]
v_mfma_f32_16x16x32_bf16 v[120:123], v[36:39], a[32:35], v[120:123]
ds_read_b128 v[24:27], v3 offset:10240
ds_read_b128 v[28:31], v3 offset:10272
v_mfma_f32_16x16x32_bf16 v[124:127], v[32:35], a[88:91], v[124:127]
v_mfma_f32_16x16x32_bf16 v[128:131], v[36:39], a[88:91], v[128:131]
v_mfma_f32_16x16x32_bf16 v[132:135], v[32:35], a[144:147], v[132:135]
v_mfma_f32_16x16x32_bf16 v[136:139], v[36:39], a[144:147], v[136:139]
v_mfma_f32_16x16x32_bf16 v[140:143], v[32:35], a[200:203], v[140:143]
v_mfma_f32_16x16x32_bf16 v[144:147], v[36:39], a[200:203], v[144:147]
s_waitcnt lgkmcnt(2)
v_mfma_f32_16x16x32_bf16 v[116:119], v[16:19], a[36:39], v[116:119]
v_mfma_f32_16x16x32_bf16 v[120:123], v[20:23], a[36:39], v[120:123]
ds_read_b128 v[32:35], v3 offset:11264
ds_read_b128 v[36:39], v3 offset:11296
v_mfma_f32_16x16x32_bf16 v[124:127], v[16:19], a[92:95], v[124:127]
v_mfma_f32_16x16x32_bf16 v[128:131], v[20:23], a[92:95], v[128:131]
v_mfma_f32_16x16x32_bf16 v[132:135], v[16:19], a[148:151], v[132:135]
v_mfma_f32_16x16x32_bf16 v[136:139], v[20:23], a[148:151], v[136:139]
v_mfma_f32_16x16x32_bf16 v[140:143], v[16:19], a[204:207], v[140:143]
v_mfma_f32_16x16x32_bf16 v[144:147], v[20:23], a[204:207], v[144:147]
s_waitcnt lgkmcnt(2)
v_mfma_f32_16x16x32_bf16 v[116:119], v[24:27], a[40:43], v[116:119]
v_mfma_f32_16x16x32_bf16 v[120:123], v[28:31], a[40:43], v[120:123]
ds_read_b128 v[16:19], v3 offset:12288
ds_read_b128 v[20:23], v3 offset:12320
v_mfma_f32_16x16x32_bf16 v[124:127], v[24:27], a[96:99], v[124:127]
v_mfma_f32_16x16x32_bf16 v[128:131], v[28:31], a[96:99], v[128:131]
v_mfma_f32_16x16x32_bf16 v[132:135], v[24:27], a[152:155], v[132:135]
v_mfma_f32_16x16x32_bf16 v[136:139], v[28:31], a[152:155], v[136:139]
v_mfma_f32_16x16x32_bf16 v[140:143], v[24:27], a[208:211], v[140:143]
v_mfma_f32_16x16x32_bf16 v[144:147], v[28:31], a[208:211], v[144:147]
s_waitcnt lgkmcnt(2)
v_mfma_f32_16x16x32_bf16 v[116:119], v[32:35], a[44:47], v[116:119]
v_mfma_f32_16x16x32_bf16 v[120:123], v[36:39], a[44:47], v[120:123]
ds_read_b128 v[24:27], v3 offset:13312
ds_read_b128 v[28:31], v3 offset:13344
v_mfma_f32_16x16x32_bf16 v[124:127], v[32:35], a[100:103], v[124:127]
v_mfma_f32_16x16x32_bf16 v[128:131], v[36:39], a[100:103], v[128:131]
v_mfma_f32_16x16x32_bf16 v[132:135], v[32:35], a[156:159], v[132:135]
v_mfma_f32_16x16x32_bf16 v[136:139], v[36:39], a[156:159], v[136:139]
v_mfma_f32_16x16x32_bf16 v[140:143], v[32:35], a[212:215], v[140:143]
v_mfma_f32_16x16x32_bf16 v[144:147], v[36:39], a[212:215], v[144:147]
s_waitcnt lgkmcnt(2)
v_mfma_f32_16x16x32_bf16 v[116:119], v[16:19], a[48:51], v[116:119]
v_mfma_f32_16x16x32_bf16 v[120:123], v[20:23], a[48:51], v[120:123]
v_mfma_f32_16x16x32_bf16 v[124:127], v[16:19], a[104:107], v[124:127]
v_mfma_f32_16x16x32_bf16 v[128:131], v[20:23], a[104:107], v[128:131]
v_mfma_f32_16x16x32_bf16 v[132:135], v[16:19], a[160:163], v[132:135]
v_mfma_f32_16x16x32_bf16 v[136:139], v[20:23], a[160:163], v[136:139]
v_mfma_f32_16x16x32_bf16 v[140:143], v[16:19], a[216:219], v[140:143]
v_mfma_f32_16x16x32_bf16 v[144:147], v[20:23], a[216:219], v[144:147]
s_waitcnt lgkmcnt(0)
v_mfma_f32_16x16x32_bf16 v[116:119], v[24:27], a[52:55], v[116:119]
v_mfma_f32_16x16x32_bf16 v[120:123], v[28:31], a[52:55], v[120:123]
v_mfma_f32_16x16x32_bf16 v[124:127], v[24:27], a[108:111], v[124:127]
v_mfma_f32_16x16x32_bf16 v[128:131], v[28:31], a[108:111], v[128:131]
v_mfma_f32_16x16x32_bf16 v[132:135], v[24:27], a[164:167], v[132:135]
v_mfma_f32_16x16x32_bf16 v[136:139], v[28:31], a[164:167], v[136:139]
v_mfma_f32_16x16x32_bf16 v[140:143], v[24:27], a[220:223], v[140:143]
v_mfma_f32_16x16x32_bf16 v[144:147], v[28:31], a[220:223], v[144:147]
s_nop 1
v_cvt_pk_bf16_f32 v44, v116, v117
v_cvt_pk_bf16_f32 v45, v118, v119
v_cvt_pk_bf16_f32 v46, v120, v121
v_cvt_pk_bf16_f32 v47, v122, v123
buffer_store_dwordx4 v[44:47], v1, s[4:7], s27 offen sc1
v_cvt_pk_bf16_f32 v48, v124, v125
v_cvt_pk_bf16_f32 v49, v126, v127
v_cvt_pk_bf16_f32 v50, v128, v129
v_cvt_pk_bf16_f32 v51, v130, v131
buffer_store_dwordx4 v[48:51], v1, s[4:7], s27 offen offset:2048 sc1
v_cvt_pk_bf16_f32 v52, v132, v133
v_cvt_pk_bf16_f32 v53, v134, v135
v_cvt_pk_bf16_f32 v54, v136, v137
v_cvt_pk_bf16_f32 v55, v138, v139
buffer_store_dwordx4 v[52:55], v1, s[4:7], s27 offen offset:1024 sc1
v_cvt_pk_bf16_f32 v56, v140, v141
v_cvt_pk_bf16_f32 v57, v142, v143
v_cvt_pk_bf16_f32 v58, v144, v145
v_cvt_pk_bf16_f32 v59, v146, v147
buffer_store_dwordx4 v[56:59], v1, s[4:7], s27 offen offset:3072 sc1
s_waitcnt vmcnt(4)
ds_read_b128 v[16:19], v3
ds_read_b128 v[20:23], v3 offset:32
ds_read_b128 v[92:95], v2
ds_read_b128 v[96:99], v2 offset:14336
ds_read_b128 v[24:27], v3 offset:1024
ds_read_b128 v[28:31], v3 offset:1056
ds_read_b128 v[100:103], v2 offset:1024
ds_read_b128 v[104:107], v2 offset:15360
s_waitcnt lgkmcnt(4)
v_mfma_f32_16x16x32_bf16 v[116:119], v[16:19], a[224:227], 0
v_mfma_f32_16x16x32_bf16 v[120:123], v[20:23], a[224:227], 0
ds_read_b128 v[32:35], v3 offset:2048
ds_read_b128 v[36:39], v3 offset:2080
ds_read_b128 v[108:111], v2 offset:2048
ds_read_b128 v[112:115], v2 offset:16384
v_mfma_f32_16x16x32_bf16 v[124:127], v[16:19], v[200:203], 0
v_mfma_f32_16x16x32_bf16 v[128:131], v[20:23], v[200:203], 0
v_mfma_f32_16x16x32_bf16 v[132:135], v[16:19], v[92:95], 0
v_mfma_f32_16x16x32_bf16 v[136:139], v[20:23], v[92:95], 0
v_mfma_f32_16x16x32_bf16 v[140:143], v[16:19], v[96:99], 0
v_mfma_f32_16x16x32_bf16 v[144:147], v[20:23], v[96:99], 0
s_waitcnt lgkmcnt(4)
v_mfma_f32_16x16x32_bf16 v[116:119], v[24:27], a[228:231], v[116:119]
v_mfma_f32_16x16x32_bf16 v[120:123], v[28:31], a[228:231], v[120:123]
ds_read_b128 v[16:19], v3 offset:3072
ds_read_b128 v[20:23], v3 offset:3104
ds_read_b128 v[92:95], v2 offset:3072
ds_read_b128 v[96:99], v2 offset:17408
v_mfma_f32_16x16x32_bf16 v[124:127], v[24:27], v[204:207], v[124:127]
v_mfma_f32_16x16x32_bf16 v[128:131], v[28:31], v[204:207], v[128:131]
v_mfma_f32_16x16x32_bf16 v[132:135], v[24:27], v[100:103], v[132:135]
v_mfma_f32_16x16x32_bf16 v[136:139], v[28:31], v[100:103], v[136:139]
v_mfma_f32_16x16x32_bf16 v[140:143], v[24:27], v[104:107], v[140:143]
v_mfma_f32_16x16x32_bf16 v[144:147], v[28:31], v[104:107], v[144:147]
s_waitcnt lgkmcnt(4)
v_mfma_f32_16x16x32_bf16 v[116:119], v[32:35], a[232:235], v[116:119]
v_mfma_f32_16x16x32_bf16 v[120:123], v[36:39], a[232:235], v[120:123]
ds_read_b128 v[24:27], v3 offset:4096
ds_read_b128 v[28:31], v3 offset:4128
ds_read_b128 v[100:103], v2 offset:4096
ds_read_b128 v[104:107], v2 offset:18432
v_mfma_f32_16x16x32_bf16 v[124:127], v[32:35], v[208:211], v[124:127]
v_mfma_f32_16x16x32_bf16 v[128:131], v[36:39], v[208:211], v[128:131]
v_mfma_f32_16x16x32_bf16 v[132:135], v[32:35], v[108:111], v[132:135]
v_mfma_f32_16x16x32_bf16 v[136:139], v[36:39], v[108:111], v[136:139]
v_mfma_f32_16x16x32_bf16 v[140:143], v[32:35], v[112:115], v[140:143]
v_mfma_f32_16x16x32_bf16 v[144:147], v[36:39], v[112:115], v[144:147]
s_waitcnt lgkmcnt(4)
v_mfma_f32_16x16x32_bf16 v[116:119], v[16:19], a[236:239], v[116:119]
v_mfma_f32_16x16x32_bf16 v[120:123], v[20:23], a[236:239], v[120:123]
ds_read_b128 v[32:35], v3 offset:5120
ds_read_b128 v[36:39], v3 offset:5152
ds_read_b128 v[108:111], v2 offset:5120
ds_read_b128 v[112:115], v2 offset:19456
v_mfma_f32_16x16x32_bf16 v[124:127], v[16:19], v[212:215], v[124:127]
v_mfma_f32_16x16x32_bf16 v[128:131], v[20:23], v[212:215], v[128:131]
v_mfma_f32_16x16x32_bf16 v[132:135], v[16:19], v[92:95], v[132:135]
v_mfma_f32_16x16x32_bf16 v[136:139], v[20:23], v[92:95], v[136:139]
v_mfma_f32_16x16x32_bf16 v[140:143], v[16:19], v[96:99], v[140:143]
v_mfma_f32_16x16x32_bf16 v[144:147], v[20:23], v[96:99], v[144:147]
s_waitcnt lgkmcnt(4)
v_mfma_f32_16x16x32_bf16 v[116:119], v[24:27], a[240:243], v[116:119]
v_mfma_f32_16x16x32_bf16 v[120:123], v[28:31], a[240:243], v[120:123]
ds_read_b128 v[16:19], v3 offset:6144
ds_read_b128 v[20:23], v3 offset:6176
ds_read_b128 v[92:95], v2 offset:6144
ds_read_b128 v[96:99], v2 offset:20480
v_mfma_f32_16x16x32_bf16 v[124:127], v[24:27], v[216:219], v[124:127]
v_mfma_f32_16x16x32_bf16 v[128:131], v[28:31], v[216:219], v[128:131]
v_mfma_f32_16x16x32_bf16 v[132:135], v[24:27], v[100:103], v[132:135]
v_mfma_f32_16x16x32_bf16 v[136:139], v[28:31], v[100:103], v[136:139]
v_mfma_f32_16x16x32_bf16 v[140:143], v[24:27], v[104:107], v[140:143]
v_mfma_f32_16x16x32_bf16 v[144:147], v[28:31], v[104:107], v[144:147]
s_waitcnt lgkmcnt(4)
v_mfma_f32_16x16x32_bf16 v[116:119], v[32:35], a[244:247], v[116:119]
v_mfma_f32_16x16x32_bf16 v[120:123], v[36:39], a[244:247], v[120:123]
ds_read_b128 v[24:27], v3 offset:7168
ds_read_b128 v[28:31], v3 offset:7200
ds_read_b128 v[100:103], v2 offset:7168
ds_read_b128 v[104:107], v2 offset:21504
v_mfma_f32_16x16x32_bf16 v[124:127], v[32:35], v[220:223], v[124:127]
v_mfma_f32_16x16x32_bf16 v[128:131], v[36:39], v[220:223], v[128:131]
v_mfma_f32_16x16x32_bf16 v[132:135], v[32:35], v[108:111], v[132:135]
v_mfma_f32_16x16x32_bf16 v[136:139], v[36:39], v[108:111], v[136:139]
v_mfma_f32_16x16x32_bf16 v[140:143], v[32:35], v[112:115], v[140:143]
v_mfma_f32_16x16x32_bf16 v[144:147], v[36:39], v[112:115], v[144:147]
s_waitcnt lgkmcnt(4)
v_mfma_f32_16x16x32_bf16 v[116:119], v[16:19], a[248:251], v[116:119]
v_mfma_f32_16x16x32_bf16 v[120:123], v[20:23], a[248:251], v[120:123]
ds_read_b128 v[32:35], v3 offset:8192
ds_read_b128 v[36:39], v3 offset:8224
ds_read_b128 v[108:111], v2 offset:8192
ds_read_b128 v[112:115], v2 offset:22528
v_mfma_f32_16x16x32_bf16 v[124:127], v[16:19], v[224:227], v[124:127]
v_mfma_f32_16x16x32_bf16 v[128:131], v[20:23], v[224:227], v[128:131]
v_mfma_f32_16x16x32_bf16 v[132:135], v[16:19], v[92:95], v[132:135]
v_mfma_f32_16x16x32_bf16 v[136:139], v[20:23], v[92:95], v[136:139]
v_mfma_f32_16x16x32_bf16 v[140:143], v[16:19], v[96:99], v[140:143]
v_mfma_f32_16x16x32_bf16 v[144:147], v[20:23], v[96:99], v[144:147]
s_waitcnt lgkmcnt(4)
v_mfma_f32_16x16x32_bf16 v[116:119], v[24:27], a[252:255], v[116:119]
v_mfma_f32_16x16x32_bf16 v[120:123], v[28:31], a[252:255], v[120:123]
ds_read_b128 v[16:19], v3 offset:9216
ds_read_b128 v[20:23], v3 offset:9248
ds_read_b128 v[92:95], v2 offset:9216
ds_read_b128 v[96:99], v2 offset:23552
v_mfma_f32_16x16x32_bf16 v[124:127], v[24:27], v[228:231], v[124:127]
v_mfma_f32_16x16x32_bf16 v[128:131], v[28:31], v[228:231], v[128:131]
v_mfma_f32_16x16x32_bf16 v[132:135], v[24:27], v[100:103], v[132:135]
v_mfma_f32_16x16x32_bf16 v[136:139], v[28:31], v[100:103], v[136:139]
v_mfma_f32_16x16x32_bf16 v[140:143], v[24:27], v[104:107], v[140:143]
v_mfma_f32_16x16x32_bf16 v[144:147], v[28:31], v[104:107], v[144:147]
s_waitcnt lgkmcnt(4)
v_mfma_f32_16x16x32_bf16 v[116:119], v[32:35], v[176:179], v[116:119]
v_mfma_f32_16x16x32_bf16 v[120:123], v[36:39], v[176:179], v[120:123]
ds_read_b128 v[24:27], v3 offset:10240
ds_read_b128 v[28:31], v3 offset:10272
ds_read_b128 v[100:103], v2 offset:10240
ds_read_b128 v[104:107], v2 offset:24576
v_mfma_f32_16x16x32_bf16 v[124:127], v[32:35], v[232:235], v[124:127]
v_mfma_f32_16x16x32_bf16 v[128:131], v[36:39], v[232:235], v[128:131]
v_mfma_f32_16x16x32_bf16 v[132:135], v[32:35], v[108:111], v[132:135]
v_mfma_f32_16x16x32_bf16 v[136:139], v[36:39], v[108:111], v[136:139]
v_mfma_f32_16x16x32_bf16 v[140:143], v[32:35], v[112:115], v[140:143]
v_mfma_f32_16x16x32_bf16 v[144:147], v[36:39], v[112:115], v[144:147]
s_waitcnt lgkmcnt(4)
v_mfma_f32_16x16x32_bf16 v[116:119], v[16:19], v[180:183], v[116:119]
v_mfma_f32_16x16x32_bf16 v[120:123], v[20:23], v[180:183], v[120:123]
ds_read_b128 v[32:35], v3 offset:11264
ds_read_b128 v[36:39], v3 offset:11296
ds_read_b128 v[108:111], v2 offset:11264
ds_read_b128 v[112:115], v2 offset:25600
v_mfma_f32_16x16x32_bf16 v[124:127], v[16:19], v[236:239], v[124:127]
v_mfma_f32_16x16x32_bf16 v[128:131], v[20:23], v[236:239], v[128:131]
v_mfma_f32_16x16x32_bf16 v[132:135], v[16:19], v[92:95], v[132:135]
v_mfma_f32_16x16x32_bf16 v[136:139], v[20:23], v[92:95], v[136:139]
v_mfma_f32_16x16x32_bf16 v[140:143], v[16:19], v[96:99], v[140:143]
v_mfma_f32_16x16x32_bf16 v[144:147], v[20:23], v[96:99], v[144:147]
s_waitcnt lgkmcnt(4)
v_mfma_f32_16x16x32_bf16 v[116:119], v[24:27], v[184:187], v[116:119]
v_mfma_f32_16x16x32_bf16 v[120:123], v[28:31], v[184:187], v[120:123]
ds_read_b128 v[16:19], v3 offset:12288
ds_read_b128 v[20:23], v3 offset:12320
ds_read_b128 v[92:95], v2 offset:12288
ds_read_b128 v[96:99], v2 offset:26624
v_mfma_f32_16x16x32_bf16 v[124:127], v[24:27], v[240:243], v[124:127]
v_mfma_f32_16x16x32_bf16 v[128:131], v[28:31], v[240:243], v[128:131]
v_mfma_f32_16x16x32_bf16 v[132:135], v[24:27], v[100:103], v[132:135]
v_mfma_f32_16x16x32_bf16 v[136:139], v[28:31], v[100:103], v[136:139]
v_mfma_f32_16x16x32_bf16 v[140:143], v[24:27], v[104:107], v[140:143]
v_mfma_f32_16x16x32_bf16 v[144:147], v[28:31], v[104:107], v[144:147]
s_waitcnt lgkmcnt(4)
v_mfma_f32_16x16x32_bf16 v[116:119], v[32:35], v[188:191], v[116:119]
v_mfma_f32_16x16x32_bf16 v[120:123], v[36:39], v[188:191], v[120:123]
ds_read_b128 v[24:27], v3 offset:13312
ds_read_b128 v[28:31], v3 offset:13344
ds_read_b128 v[100:103], v2 offset:13312
ds_read_b128 v[104:107], v2 offset:27648
v_mfma_f32_16x16x32_bf16 v[124:127], v[32:35], v[244:247], v[124:127]
v_mfma_f32_16x16x32_bf16 v[128:131], v[36:39], v[244:247], v[128:131]
v_mfma_f32_16x16x32_bf16 v[132:135], v[32:35], v[108:111], v[132:135]
v_mfma_f32_16x16x32_bf16 v[136:139], v[36:39], v[108:111], v[136:139]
v_mfma_f32_16x16x32_bf16 v[140:143], v[32:35], v[112:115], v[140:143]
v_mfma_f32_16x16x32_bf16 v[144:147], v[36:39], v[112:115], v[144:147]
s_waitcnt lgkmcnt(4)
v_mfma_f32_16x16x32_bf16 v[116:119], v[16:19], v[192:195], v[116:119]
v_mfma_f32_16x16x32_bf16 v[120:123], v[20:23], v[192:195], v[120:123]
v_mfma_f32_16x16x32_bf16 v[124:127], v[16:19], v[248:251], v[124:127]
v_mfma_f32_16x16x32_bf16 v[128:131], v[20:23], v[248:251], v[128:131]
v_mfma_f32_16x16x32_bf16 v[132:135], v[16:19], v[92:95], v[132:135]
v_mfma_f32_16x16x32_bf16 v[136:139], v[20:23], v[92:95], v[136:139]
v_mfma_f32_16x16x32_bf16 v[140:143], v[16:19], v[96:99], v[140:143]
v_mfma_f32_16x16x32_bf16 v[144:147], v[20:23], v[96:99], v[144:147]
s_waitcnt lgkmcnt(0)
v_mfma_f32_16x16x32_bf16 v[116:119], v[24:27], v[196:199], v[116:119]
v_mfma_f32_16x16x32_bf16 v[120:123], v[28:31], v[196:199], v[120:123]
v_mfma_f32_16x16x32_bf16 v[124:127], v[24:27], v[252:255], v[124:127]
v_mfma_f32_16x16x32_bf16 v[128:131], v[28:31], v[252:255], v[128:131]
v_mfma_f32_16x16x32_bf16 v[132:135], v[24:27], v[100:103], v[132:135]
v_mfma_f32_16x16x32_bf16 v[136:139], v[28:31], v[100:103], v[136:139]
v_mfma_f32_16x16x32_bf16 v[140:143], v[24:27], v[104:107], v[140:143]
v_mfma_f32_16x16x32_bf16 v[144:147], v[28:31], v[104:107], v[144:147]
s_nop 1
s_add_u32 s40, s27, 4096
v_cvt_pk_bf16_f32 v60, v116, v117
v_cvt_pk_bf16_f32 v61, v118, v119
v_cvt_pk_bf16_f32 v62, v120, v121
v_cvt_pk_bf16_f32 v63, v122, v123
buffer_store_dwordx4 v[60:63], v1, s[4:7], s40 offen sc1
v_cvt_pk_bf16_f32 v64, v124, v125
v_cvt_pk_bf16_f32 v65, v126, v127
v_cvt_pk_bf16_f32 v66, v128, v129
v_cvt_pk_bf16_f32 v67, v130, v131
buffer_store_dwordx4 v[64:67], v1, s[4:7], s40 offen offset:2048 sc1
v_cvt_pk_bf16_f32 v68, v132, v133
v_cvt_pk_bf16_f32 v69, v134, v135
v_cvt_pk_bf16_f32 v70, v136, v137
v_cvt_pk_bf16_f32 v71, v138, v139
buffer_store_dwordx4 v[68:71], v1, s[4:7], s40 offen offset:1024 sc1
v_cvt_pk_bf16_f32 v72, v140, v141
v_cvt_pk_bf16_f32 v73, v142, v143
v_cvt_pk_bf16_f32 v74, v144, v145
v_cvt_pk_bf16_f32 v75, v146, v147
buffer_store_dwordx4 v[72:75], v1, s[4:7], s40 offen offset:3072 sc1
s_mov_b32 s36, s28
s_cmp_lt_u32 s29, 4
s_cselect_b32 s41, 2, 4
s_mul_i32 s40, s41, 28672
s_add_u32 s26, s26, s40
s_mul_i32 s40, s41, 458752
s_add_u32 s27, s27, s40
s_mul_i32 s40, s41, 1792
s_add_u32 s28, s28, s40
s_mul_i32 s40, s41, 1
s_add_u32 s29, s29, s40
s_cmp_lt_u32 s25, 4
s_cbranch_scc0 TB_PV2
s_cmp_lt_u32 s29, 20
s_cbranch_scc0 TB_PV02
s_barrier
s_mov_b32 m0, 14368
s_add_u32 s40, s26, 14336
buffer_load_dwordx4 v1, s[4:7], s40 offen lds
s_mov_b32 m0, 15392
s_add_u32 s40, s26, 15360
buffer_load_dwordx4 v1, s[4:7], s40 offen lds
s_mov_b32 m0, 16416
s_add_u32 s40, s26, 16384
buffer_load_dwordx4 v1, s[4:7], s40 offen lds
s_mov_b32 m0, 17440
s_add_u32 s40, s26, 17408
buffer_load_dwordx4 v1, s[4:7], s40 offen lds
s_mov_b32 m0, 18464
s_add_u32 s40, s26, 18432
buffer_load_dwordx4 v1, s[4:7], s40 offen lds
s_mov_b32 m0, 19488
s_add_u32 s40, s26, 19456
buffer_load_dwordx4 v1, s[4:7], s40 offen lds
s_mov_b32 m0, 20512
s_add_u32 s40, s26, 20480
buffer_load_dwordx4 v1, s[4:7], s40 offen lds
s_waitcnt vmcnt(7)
v_mov_b32 v12, s88
buffer_store_dword v12, off, s[4:7], s36 sc1
s_mov_b32 s36, 0
s_waitcnt vmcnt(1)
s_branch TB_Y2
TB_PV02:
s_waitcnt vmcnt(0)
v_mov_b32 v12, s88
buffer_store_dword v12, off, s[4:7], s36 sc1
s_mov_b32 s36, 0
v_min_u32 v14, 55, v0
v_and_b32 v11, 3, v14
v_lshlrev_b32 v11, 3, v11
v_lshrrev_b32 v14, 2, v14
v_lshl_add_u32 v11, v14, 7, v11
s_mov_b32 s43, 4352
Llz_256:
buffer_load_dwordx2 v[14:15], v11, s[4:7], s43 offen sc1
s_waitcnt vmcnt(0)
v_cmp_ne_u32 vcc, s88, v14
v_cmp_ne_u32 s[40:41], s88, v15
s_or_b64 vcc, vcc, s[40:41]
s_cbranch_vccz Llzok_257
s_sleep 8
s_sub_u32 s24, s24, 1
s_cbranch_scc0 Llz_256
s_endpgm
Llzok_257:
v_min_u32 v14, 47, v0
v_and_b32 v11, 3, v14
v_lshlrev_b32 v11, 3, v11
v_lshrrev_b32 v14, 2, v14
v_lshl_add_u32 v11, v14, 7, v11
s_mov_b32 s43, 6144
Llz_258:
buffer_load_dwordx2 v[14:15], v11, s[4:7], s43 offen sc1
s_waitcnt vmcnt(0)
v_cmp_ne_u32 vcc, s88, v14
v_cmp_ne_u32 s[40:41], s88, v15
s_or_b64 vcc, vcc, s[40:41]
s_cbranch_vccz Llzok_259
s_sleep 8
s_sub_u32 s24, s24, 1
s_cbranch_scc0 Llz_258
s_endpgm
Llzok_259:
TB_PV2:
s_barrier
s_cmp_lt_u32 s29, 64
s_cbranch_scc0 Lnorows_260
s_mov_b32 m0, 14368
s_add_u32 s40, s26, 14336
buffer_load_dwordx4 v1, s[4:7], s40 offen lds
s_mov_b32 m0, 15392
s_add_u32 s40, s26, 15360
buffer_load_dwordx4 v1, s[4:7], s40 offen lds
s_mov_b32 m0, 16416
s_add_u32 s40, s26, 16384
buffer_load_dwordx4 v1, s[4:7], s40 offen lds
s_mov_b32 m0, 17440
s_add_u32 s40, s26, 17408
buffer_load_dwordx4 v1, s[4:7], s40 offen lds
s_mov_b32 m0, 18464
s_add_u32 s40, s26, 18432
buffer_load_dwordx4 v1, s[4:7], s40 offen lds
s_mov_b32 m0, 19488
s_add_u32 s40, s26, 19456
buffer_load_dwordx4 v1, s[4:7], s40 offen lds
s_mov_b32 m0, 20512
s_add_u32 s40, s26, 20480
buffer_load_dwordx4 v1, s[4:7], s40 offen lds
Lnorows_260:
s_cmp_lt_u32 s25, 8
s_cbranch_scc0 Lmine_261
s_lshl_b32 s40, s25, 7
s_add_u32 s40, s40, 139264
s_branch Lfirst_263
Lflag_262:
v_cmp_ne_u32 vcc, s88, v11
s_cbranch_vccz Lset_264
s_sleep 16
Lfirst_263:
buffer_load_dword v11, off, s[4:7], s40 sc1
s_waitcnt vmcnt(0)
s_sub_u32 s24, s24, 1
s_cbranch_scc0 Lflag_262
s_endpgm
Lset_264:
Lmine_261:
s_add_u32 s40, s30, 4096
buffer_load_dwordx4 v[44:47], v1, s[4:7], s30 offen sc1
buffer_load_dwordx4 v[48:51], v1, s[4:7], s30 offen offset:1024 sc1
buffer_load_dwordx4 v[52:55], v1, s[4:7], s30 offen offset:2048 sc1
buffer_load_dwordx4 v[56:59], v1, s[4:7], s30 offen offset:3072 sc1
buffer_load_dwordx4 v[60:63], v1, s[4:7], s40 offen sc1
buffer_load_dwordx4 v[64:67], v1, s[4:7], s40 offen offset:1024 sc1
buffer_load_dwordx4 v[68:71], v1, s[4:7], s40 offen offset:2048 sc1
buffer_load_dwordx4 v[72:75], v1, s[4:7], s40 offen offset:3072 sc1
buffer_load_dwordx2 v[14:15], v8, s[8:11], s34 offen
ds_read_b128 v[92:95], v2 offset:8192
ds_read_b128 v[96:99], v2 offset:9216
ds_read_b128 v[100:103], v2 offset:10240
ds_read_b128 v[104:107], v2 offset:11264
ds_read_b128 v[108:111], v2
ds_read_b128 v[112:115], v2 offset:1024
v_mov_b32 v116, 0
v_mov_b32 v117, 0
v_mov_b32 v118, 0
v_mov_b32 v119, 0
v_mov_b32 v120, 0
v_mov_b32 v121, 0
v_mov_b32 v122, 0
v_mov_b32 v123, 0
v_mov_b32 v124, 0
v_mov_b32 v125, 0
v_mov_b32 v126, 0
v_mov_b32 v127, 0
v_mov_b32 v128, 0
v_mov_b32 v129, 0
v_mov_b32 v130, 0
v_mov_b32 v131, 0
v_mov_b32 v132, 0
v_mov_b32 v133, 0
v_mov_b32 v134, 0
v_mov_b32 v135, 0
v_mov_b32 v136, 0
v_mov_b32 v137, 0
v_mov_b32 v138, 0
v_mov_b32 v139, 0
v_mov_b32 v140, 0
v_mov_b32 v141, 0
v_mov_b32 v142, 0
v_mov_b32 v143, 0
v_mov_b32 v144, 0
v_mov_b32 v145, 0
v_mov_b32 v146, 0
v_mov_b32 v147, 0
Lspin_265:
buffer_load_dwordx4 v[32:35], v1, s[4:7], s31 offen sc1
buffer_load_dwordx4 v[36:39], v1, s[4:7], s31 offen offset:1024 sc1
s_sub_u32 s24, s24, 1
s_cbranch_scc1 CODE_END
s_waitcnt vmcnt(0)
v_max3_u32 v11, v32, v33, v34
v_max3_u32 v11, v11, v35, v36
v_max3_u32 v11, v11, v37, v38
v_max_u32 v11, v11, v39
v_cmp_eq_u32 vcc, -1, v11
s_cbranch_vccz Lspin_265x
s_cmp_ge_u32 s25, 58
s_cbranch_scc1 Lspin_265
s_sleep 8
s_branch Lspin_265
Lspin_265x:
s_cmp_eq_u32 s36, 0
s_cbranch_scc1 Lpaid_266
v_mov_b32 v12, s88
buffer_store_dword v12, off, s[4:7], s36 sc1
s_mov_b32 s36, 0
Lpaid_266:
ds_write_b128 v1, v[32:35] offset:32896
ds_write_b128 v1, v[36:39] offset:33920
s_waitcnt lgkmcnt(0)
s_barrier
ds_read_b128 v[16:19], v1 offset:28800
ds_read_b128 v[20:23], v1 offset:29824
ds_read_b128 v[24:27], v1 offset:30848
ds_read_b128 v[28:31], v1 offset:31872
ds_read_b128 v[40:43], v1 offset:34944
v_smfmac_f32_16x16x64_bf16 v[116:119], v[32:35], a[32:39], v10
v_smfmac_f32_16x16x64_bf16 v[120:123], v[32:35], a[88:95], v10
v_smfmac_f32_16x16x64_bf16 v[124:127], v[32:35], a[144:151], v10
v_smfmac_f32_16x16x64_bf16 v[128:131], v[32:35], v[92:99], v10
v_smfmac_f32_16x16x64_bf16 v[116:119], v[36:39], a[40:47], v10
ds_read_b128 v[92:95], v2 offset:2048
v_smfmac_f32_16x16x64_bf16 v[120:123], v[36:39], a[96:103], v10
ds_read_b128 v[96:99], v2 offset:3072
v_smfmac_f32_16x16x64_bf16 v[124:127], v[36:39], a[152:159], v10
v_smfmac_f32_16x16x64_bf16 v[128:131], v[36:39], v[100:107], v10
s_waitcnt lgkmcnt(6)
v_smfmac_f32_16x16x64_bf16 v[116:119], v[16:19], a[0:7], v10
ds_read_b128 v[100:103], v2 offset:4096
v_smfmac_f32_16x16x64_bf16 v[120:123], v[16:19], a[56:63], v10
ds_read_b128 v[104:107], v2 offset:5120
v_smfmac_f32_16x16x64_bf16 v[124:127], v[16:19], a[112:119], v10
v_smfmac_f32_16x16x64_bf16 v[128:131], v[16:19], v[108:115], v10
s_waitcnt lgkmcnt(7)
v_smfmac_f32_16x16x64_bf16 v[116:119], v[20:23], a[8:15], v10
ds_read_b128 v[108:111], v2 offset:6144
v_smfmac_f32_16x16x64_bf16 v[120:123], v[20:23], a[64:71], v10
ds_read_b128 v[112:115], v2 offset:7168
v_smfmac_f32_16x16x64_bf16 v[124:127], v[20:23], a[120:127], v10
s_waitcnt lgkmcnt(4)
v_smfmac_f32_16x16x64_bf16 v[128:131], v[20:23], v[92:99], v10
v_smfmac_f32_16x16x64_bf16 v[116:119], v[24:27], a[16:23], v10
ds_read_b128 v[92:95], v2 offset:12288
v_smfmac_f32_16x16x64_bf16 v[120:123], v[24:27], a[72:79], v10
ds_read_b128 v[96:99], v2 offset:13312
v_smfmac_f32_16x16x64_bf16 v[124:127], v[24:27], a[128:135], v10
s_waitcnt lgkmcnt(4)
v_smfmac_f32_16x16x64_bf16 v[128:131], v[24:27], v[100:107], v10
v_smfmac_f32_16x16x64_bf16 v[116:119], v[28:31], a[24:31], v10
ds_read_b128 v[100:103], v2 offset:22528
v_smfmac_f32_16x16x64_bf16 v[120:123], v[28:31], a[80:87], v10
ds_read_b128 v[104:107], v2 offset:23552
v_smfmac_f32_16x16x64_bf16 v[124:127], v[28:31], a[136:143], v10
s_waitcnt lgkmcnt(4)
v_smfmac_f32_16x16x64_bf16 v[128:131], v[28:31], v[108:115], v10
v_smfmac_f32_16x16x64_bf16 v[116:119], v[40:43], a[48:55], v10
ds_read_b128 v[108:111], v2 offset:24576
v_smfmac_f32_16x16x64_bf16 v[120:123], v[40:43], a[104:111], v10
ds_read_b128 v[112:115], v2 offset:25600
v_smfmac_f32_16x16x64_bf16 v[124:127], v[40:43], a[160:167], v10
s_waitcnt lgkmcnt(4)
v_smfmac_f32_16x16x64_bf16 v[128:131], v[40:43], v[92:99], v10
v_smfmac_f32_16x16x64_bf16 v[132:135], v[32:35], a[200:207], v10
ds_read_b128 v[92:95], v2 offset:14336
v_smfmac_f32_16x16x64_bf16 v[136:139], v[32:35], v[176:183], v10
ds_read_b128 v[96:99], v2 offset:15360
v_smfmac_f32_16x16x64_bf16 v[140:143], v[32:35], v[232:239], v10
v_cvt_pk_bf16_f32 v76, v116, v117
s_waitcnt lgkmcnt(4)
v_smfmac_f32_16x16x64_bf16 v[144:147], v[32:35], v[100:107], v10
v_cvt_pk_bf16_f32 v77, v118, v119
v_smfmac_f32_16x16x64_bf16 v[132:135], v[36:39], a[208:215], v10
ds_read_b128 v[100:103], v2 offset:16384
v_smfmac_f32_16x16x64_bf16 v[136:139], v[36:39], v[184:191], v10
ds_read_b128 v[104:107], v2 offset:17408
v_smfmac_f32_16x16x64_bf16 v[140:143], v[36:39], v[240:247], v10
v_cvt_pk_bf16_f32 v84, v120, v121
s_waitcnt lgkmcnt(4)
v_smfmac_f32_16x16x64_bf16 v[144:147], v[36:39], v[108:115], v10
v_cvt_pk_bf16_f32 v85, v122, v123
v_smfmac_f32_16x16x64_bf16 v[132:135], v[16:19], a[168:175], v10
ds_read_b128 v[108:111], v2 offset:18432
v_smfmac_f32_16x16x64_bf16 v[136:139], v[16:19], a[224:231], v10
ds_read_b128 v[112:115], v2 offset:19456
v_smfmac_f32_16x16x64_bf16 v[140:143], v[16:19], v[200:207], v10
v_cvt_pk_bf16_f32 v78, v124, v125
s_waitcnt lgkmcnt(4)
v_smfmac_f32_16x16x64_bf16 v[144:147], v[16:19], v[92:99], v10
v_cvt_pk_bf16_f32 v79, v126, v127
v_smfmac_f32_16x16x64_bf16 v[132:135], v[20:23], a[176:183], v10
ds_read_b128 v[92:95], v2 offset:20480
v_smfmac_f32_16x16x64_bf16 v[136:139], v[20:23], a[232:239], v10
ds_read_b128 v[96:99], v2 offset:21504
v_smfmac_f32_16x16x64_bf16 v[140:143], v[20:23], v[208:215], v10
v_cvt_pk_bf16_f32 v82, v128, v129
s_waitcnt lgkmcnt(4)
v_smfmac_f32_16x16x64_bf16 v[144:147], v[20:23], v[100:107], v10
v_cvt_pk_bf16_f32 v83, v130, v131
v_smfmac_f32_16x16x64_bf16 v[132:135], v[24:27], a[184:191], v10
ds_read_b128 v[100:103], v2 offset:26624
v_smfmac_f32_16x16x64_bf16 v[136:139], v[24:27], a[240:247], v10
ds_read_b128 v[104:107], v2 offset:27648
v_smfmac_f32_16x16x64_bf16 v[140:143], v[24:27], v[216:223], v10
s_waitcnt lgkmcnt(4)
v_smfmac_f32_16x16x64_bf16 v[144:147], v[24:27], v[108:115], v10
v_smfmac_f32_16x16x64_bf16 v[132:135], v[28:31], a[192:199], v10
v_smfmac_f32_16x16x64_bf16 v[136:139], v[28:31], a[248:255], v10
v_smfmac_f32_16x16x64_bf16 v[140:143], v[28:31], v[224:231], v10
s_waitcnt lgkmcnt(2)
v_smfmac_f32_16x16x64_bf16 v[144:147], v[28:31], v[92:99], v10
v_smfmac_f32_16x16x64_bf16 v[132:135], v[40:43], a[216:223], v10
v_smfmac_f32_16x16x64_bf16 v[136:139], v[40:43], v[192:199], v10
v_smfmac_f32_16x16x64_bf16 v[140:143], v[40:43], v[248:255], v10
s_waitcnt lgkmcnt(0)
v_smfmac_f32_16x16x64_bf16 v[144:147], v[40:43], v[100:107], v10
s_nop 2
v_cvt_pk_bf16_f32 v86, v132, v133
v_cvt_pk_bf16_f32 v87, v134, v135
v_cvt_pk_bf16_f32 v80, v136, v137
v_cvt_pk_bf16_f32 v81, v138, v139
v_cvt_pk_bf16_f32 v88, v140, v141
v_cvt_pk_bf16_f32 v89, v142, v143
v_cvt_pk_bf16_f32 v90, v144, v145
v_cvt_pk_bf16_f32 v91, v146, v147
s_barrier
s_add_u32 s40, s32, 4096
Lpoll_267:
buffer_load_dwordx4 v[16:19], v1, s[4:7], s32 offen sc1
buffer_load_dwordx4 v[20:23], v1, s[4:7], s32 offen offset:1024 sc1
buffer_load_dwordx4 v[24:27], v1, s[4:7], s32 offen offset:2048 sc1
buffer_load_dwordx4 v[28:31], v1, s[4:7], s32 offen offset:3072 sc1
buffer_load_dwordx4 v[32:35], v1, s[4:7], s40 offen sc1
buffer_load_dwordx4 v[36:39], v1, s[4:7], s40 offen offset:1024 sc1
buffer_load_dwordx4 v[40:43], v1, s[4:7], s40 offen offset:2048 sc1
buffer_load_dwordx4 v[92:95], v1, s[4:7], s40 offen offset:3072 sc1
buffer_load_dwordx4 v[96:99], v4, s[4:7], s33 offen sc1
buffer_load_dwordx4 v[100:103], v4, s[4:7], s33 offen offset:512 sc1
buffer_load_dwordx4 v[104:107], v4, s[4:7], s33 offen offset:1024 sc1
buffer_load_dwordx4 v[108:111], v4, s[4:7], s33 offen offset:1536 sc1
s_waitcnt vmcnt(0)
v_max3_u32 v11, v16, v17, v18
v_max3_u32 v11, v11, v19, v20
v_max3_u32 v11, v11, v21, v22
v_max3_u32 v11, v11, v23, v24
v_max3_u32 v11, v11, v25, v26
v_max3_u32 v11, v11, v27, v28
v_max3_u32 v11, v11, v29, v30
v_max3_u32 v11, v11, v31, v32
v_max3_u32 v11, v11, v33, v34
v_max3_u32 v11, v11, v35, v36
v_max3_u32 v11, v11, v37, v38
v_max3_u32 v11, v11, v39, v40
v_max3_u32 v11, v11, v41, v42
v_max3_u32 v11, v11, v43, v92
v_max3_u32 v11, v11, v93, v94
v_max3_u32 v11, v11, v95, v96
v_max3_u32 v11, v11, v97, v98
v_max3_u32 v11, v11, v99, v100
v_max3_u32 v11, v11, v101, v102
v_max3_u32 v11, v11, v103, v104
v_max3_u32 v11, v11, v105, v106
v_max3_u32 v11, v11, v107, v108
v_max3_u32 v11, v11, v109, v110
v_max_u32 v11, v11, v111
v_cmp_eq_u32 vcc, -1, v11
s_cbranch_vccz Lgot_268
s_sub_u32 s24, s24, 1
s_cbranch_scc0 Lpoll_267
s_endpgm
Lgot_268:
v_mfma_f32_16x16x32_bf16 v[116:119], v[16:19], v[44:47], 0
v_mfma_f32_16x16x32_bf16 v[120:123], v[16:19], v[52:55], 0
v_mfma_f32_16x16x32_bf16 v[124:127], v[20:23], v[44:47], 0
v_mfma_f32_16x16x32_bf16 v[128:131], v[20:23], v[52:55], 0
v_mfma_f32_16x16x32_bf16 v[116:119], v[24:27], v[48:51], v[116:119]
v_mfma_f32_16x16x32_bf16 v[120:123], v[24:27], v[56:59], v[120:123]
v_mfma_f32_16x16x32_bf16 v[124:127], v[28:31], v[48:51], v[124:127]
v_mfma_f32_16x16x32_bf16 v[128:131], v[28:31], v[56:59], v[128:131]
v_mfma_f32_16x16x32_bf16 v[116:119], v[32:35], v[60:63], v[116:119]
v_mfma_f32_16x16x32_bf16 v[120:123], v[32:35], v[68:71], v[120:123]
v_mfma_f32_16x16x32_bf16 v[124:127], v[36:39], v[60:63], v[124:127]
v_mfma_f32_16x16x32_bf16 v[128:131], v[36:39], v[68:71], v[128:131]
v_mfma_f32_16x16x32_bf16 v[116:119], v[40:43], v[64:67], v[116:119]
v_mfma_f32_16x16x32_bf16 v[120:123], v[40:43], v[72:75], v[120:123]
v_mfma_f32_16x16x32_bf16 v[124:127], v[92:95], v[64:67], v[124:127]
v_mfma_f32_16x16x32_bf16 v[128:131], v[92:95], v[72:75], v[128:131]
v_mfma_f32_16x16x32_bf16 v[116:119], v[96:99], v[76:79], v[116:119]
v_mfma_f32_16x16x32_bf16 v[120:123], v[96:99], v[84:87], v[120:123]
v_mfma_f32_16x16x32_bf16 v[124:127], v[100:103], v[76:79], v[124:127]
v_mfma_f32_16x16x32_bf16 v[128:131], v[100:103], v[84:87], v[128:131]
v_mfma_f32_16x16x32_bf16 v[116:119], v[104:107], v[80:83], v[116:119]
v_mfma_f32_16x16x32_bf16 v[120:123], v[104:107], v[88:91], v[120:123]
v_mfma_f32_16x16x32_bf16 v[124:127], v[108:111], v[80:83], v[124:127]
v_mfma_f32_16x16x32_bf16 v[128:131], v[108:111], v[88:91], v[128:131]
s_nop 6
ds_write2_b32 v5, v116, v120 offset0:0 offset1:16
ds_write2_b32 v5, v117, v121 offset0:36 offset1:52
ds_write2_b32 v5, v118, v122 offset0:72 offset1:88
ds_write2_b32 v5, v119, v123 offset0:108 offset1:124
ds_write2_b32 v6, v124, v128 offset0:0 offset1:16
ds_write2_b32 v6, v125, v129 offset0:36 offset1:52
ds_write2_b32 v6, v126, v130 offset0:72 offset1:88
ds_write2_b32 v6, v127, v131 offset0:108 offset1:124
s_waitcnt lgkmcnt(0)
s_barrier
ds_read_b128 v[116:119], v7
ds_read_b128 v[120:123], v7 offset:4608
ds_read_b128 v[124:127], v7 offset:9216
ds_read_b128 v[128:131], v7 offset:13824
v_lshlrev_b32 v132, 16, v14
v_and_b32 v133, 0xffff0000, v14
v_lshlrev_b32 v134, 16, v15
v_and_b32 v135, 0xffff0000, v15
s_waitcnt lgkmcnt(0)
v_pk_add_f32 v[116:117], v[116:117], v[120:121]
v_pk_add_f32 v[124:125], v[124:125], v[128:129]
v_pk_add_f32 v[116:117], v[116:117], v[124:125]
v_cvt_pk_bf16_f32 v117, v116, v117
v_lshlrev_b32 v116, 16, v117
v_and_b32 v117, 0xffff0000, v117
v_pk_add_f32 v[116:117], v[116:117], v[132:133]
v_cvt_pk_bf16_f32 v136, v116, v117
v_min_u32 v136, -2, v136
v_pk_add_f32 v[118:119], v[118:119], v[122:123]
v_pk_add_f32 v[126:127], v[126:127], v[130:131]
v_pk_add_f32 v[118:119], v[118:119], v[126:127]
v_cvt_pk_bf16_f32 v119, v118, v119
v_lshlrev_b32 v118, 16, v119
v_and_b32 v119, 0xffff0000, v119
v_pk_add_f32 v[118:119], v[118:119], v[134:135]
v_cvt_pk_bf16_f32 v137, v118, v119
v_min_u32 v137, -2, v137
buffer_store_dwordx2 v[136:137], v9, s[4:7], s35 offen sc1
s_add_u32 s30, s30, 1835008
s_add_u32 s31, s31, 28672
s_add_u32 s32, s32, 163840
s_add_u32 s33, s33, 163840
s_add_u32 s34, s34, 114688
s_add_u32 s35, s35, 114688
s_add_u32 s25, s25, 4
s_cmp_lt_u32 s25, 64
s_cbranch_scc1 TB_TOP2
s_endpgm
TB_W3:
s_load_dwordx2 s[8:9], s[0:1], 0
s_mov_b32 s10, 1835008
s_mov_b32 s11, 0x00020000
s_sub_u32 s22, s22, 16
v_lshlrev_b32 v1, 4, v0
v_and_b32 v11, 7, v0
v_lshlrev_b32 v11, 2, v11
v_bfe_u32 v12, v0, 3, 1
v_lshl_add_u32 v11, v12, 7, v11
s_mov_b32 s40, 4352
s_branch Lfirst_270
Lflag_269:
v_cmp_ne_u32 vcc, s88, v12
s_cbranch_vccz Lset_271
s_sleep 4
Lfirst_270:
buffer_load_dword v12, v11, s[4:7], s40 offen sc1
s_waitcnt vmcnt(0)
s_sub_u32 s24, s24, 1
s_cbranch_scc0 Lflag_269
s_endpgm
Lset_271:
s_cmp_lt_u32 s21, 2
s_cselect_b32 s29, 0, 4
s_add_u32 s29, s29, s21
s_mul_i32 s26, s29, 28672
s_add_u32 s26, s26, 8044544
s_mov_b32 m0, 21536
s_add_u32 s40, s26, 21504
buffer_load_dwordx4 v1, s[4:7], s40 offen lds
s_mov_b32 m0, 22560
s_add_u32 s40, s26, 22528
buffer_load_dwordx4 v1, s[4:7], s40 offen lds
s_mov_b32 m0, 23584
s_add_u32 s40, s26, 23552
buffer_load_dwordx4 v1, s[4:7], s40 offen lds
s_mov_b32 m0, 24608
s_add_u32 s40, s26, 24576
buffer_load_dwordx4 v1, s[4:7], s40 offen lds
s_mov_b32 m0, 25632
s_add_u32 s40, s26, 25600
buffer_load_dwordx4 v1, s[4:7], s40 offen lds
s_mov_b32 m0, 26656
s_add_u32 s40, s26, 26624
buffer_load_dwordx4 v1, s[4:7], s40 offen lds
s_mov_b32 m0, 27680
s_add_u32 s40, s26, 27648
buffer_load_dwordx4 v1, s[4:7], s40 offen lds
v_and_b32 v11, 7, v0
v_min_u32 v11, 6, v11
v_lshlrev_b32 v11, 2, v11
v_bfe_u32 v12, v0, 3, 2
v_lshl_add_u32 v11, v12, 7, v11
s_mov_b32 s40, 3584
s_branch Lfirst_273
Lflag_272:
v_cmp_ne_u32 vcc, s88, v12
s_cbranch_vccz Lset_274
s_sleep 4
Lfirst_273:
buffer_load_dword v12, v11, s[4:7], s40 offen sc1
s_waitcnt vmcnt(0)
s_sub_u32 s24, s24, 1
s_cbranch_scc0 Lflag_272
s_endpgm
Lset_274:
s_cmp_lt_u32 s21, 2
s_cbranch_scc1 Learly_275
s_mov_b32 s40, 139264
s_branch Lfirst_277
Lflag_276:
v_cmp_ne_u32 vcc, s88, v11
s_cbranch_vccz Lset_278
s_sleep 16
Lfirst_277:
buffer_load_dword v11, off, s[4:7], s40 sc1
s_waitcnt vmcnt(0)
s_sub_u32 s24, s24, 1
s_cbranch_scc0 Lflag_276
s_endpgm
Lset_278:
Learly_275:
s_mul_i32 s40, s22, 458752
s_add_u32 s40, s40, 16646144
s_add_u32 s41, s40, 86016
s_add_u32 s43, s40, 57344
buffer_load_dwordx4 a[0:3], v1, s[4:7], s40 offen
buffer_load_dwordx4 a[4:7], v1, s[4:7], s40 offen offset:1024
buffer_load_dwordx4 a[8:11], v1, s[4:7], s40 offen offset:2048
buffer_load_dwordx4 a[12:15], v1, s[4:7], s40 offen offset:3072
s_add_u32 s40, s40, 4096
buffer_load_dwordx4 a[16:19], v1, s[4:7], s40 offen
buffer_load_dwordx4 a[20:23], v1, s[4:7], s40 offen offset:1024
buffer_load_dwordx4 a[24:27], v1, s[4:7], s40 offen offset:2048
buffer_load_dwordx4 a[28:31], v1, s[4:7], s40 offen offset:3072
s_add_u32 s40, s40, 4096
buffer_load_dwordx4 a[32:35], v1, s[4:7], s40 offen
buffer_load_dwordx4 a[36:39], v1, s[4:7], s40 offen offset:1024
buffer_load_dwordx4 a[40:43], v1, s[4:7], s40 offen offset:2048
buffer_load_dwordx4 a[44:47], v1, s[4:7], s40 offen offset:3072
s_add_u32 s40, s40, 4096
buffer_load_dwordx4 a[48:51], v1, s[4:7], s40 offen
buffer_load_dwordx4 a[52:55], v1, s[4:7], s40 offen offset:1024
buffer_load_dwordx4 a[56:59], v1, s[4:7], s40 offen offset:2048
buffer_load_dwordx4 a[60:63], v1, s[4:7], s40 offen offset:3072
s_add_u32 s40, s40, 4096
buffer_load_dwordx4 a[64:67], v1, s[4:7], s40 offen
buffer_load_dwordx4 a[68:71], v1, s[4:7], s40 offen offset:1024
buffer_load_dwordx4 a[72:75], v1, s[4:7], s40 offen offset:2048
buffer_load_dwordx4 a[76:79], v1, s[4:7], s40 offen offset:3072
s_add_u32 s40, s40, 4096
buffer_load_dwordx4 a[80:83], v1, s[4:7], s40 offen
buffer_load_dwordx4 a[84:87], v1, s[4:7], s40 offen offset:1024
buffer_load_dwordx4 a[88:91], v1, s[4:7], s40 offen offset:2048
buffer_load_dwordx4 a[92:95], v1, s[4:7], s40 offen offset:3072
s_add_u32 s40, s40, 4096
buffer_load_dwordx4 a[96:99], v1, s[4:7], s40 offen
buffer_load_dwordx4 a[100:103], v1, s[4:7], s40 offen offset:1024
buffer_load_dwordx4 a[104:107], v1, s[4:7], s40 offen offset:2048
buffer_load_dwordx4 a[108:111], v1, s[4:7], s40 offen offset:3072
s_add_u32 s40, s40, 4096
buffer_load_dwordx4 a[112:115], v1, s[4:7], s40 offen
buffer_load_dwordx4 a[116:119], v1, s[4:7], s40 offen offset:1024
buffer_load_dwordx4 a[120:123], v1, s[4:7], s40 offen offset:2048
buffer_load_dwordx4 a[124:127], v1, s[4:7], s40 offen offset:3072
s_add_u32 s40, s40, 4096
buffer_load_dwordx4 a[128:131], v1, s[4:7], s40 offen
buffer_load_dwordx4 a[132:135], v1, s[4:7], s40 offen offset:1024
buffer_load_dwordx4 a[136:139], v1, s[4:7], s40 offen offset:2048
buffer_load_dwordx4 a[140:143], v1, s[4:7], s40 offen offset:3072
s_add_u32 s40, s40, 4096
buffer_load_dwordx4 a[144:147], v1, s[4:7], s40 offen
buffer_load_dwordx4 a[148:151], v1, s[4:7], s40 offen offset:1024
buffer_load_dwordx4 a[152:155], v1, s[4:7], s40 offen offset:2048
buffer_load_dwordx4 a[156:159], v1, s[4:7], s40 offen offset:3072
s_add_u32 s40, s40, 4096
s_waitcnt vmcnt(32)
buffer_load_dwordx4 a[160:163], v1, s[4:7], s40 offen
buffer_load_dwordx4 a[164:167], v1, s[4:7], s40 offen offset:1024
buffer_load_dwordx4 a[168:171], v1, s[4:7], s40 offen offset:2048
buffer_load_dwordx4 a[172:175], v1, s[4:7], s40 offen offset:3072
s_add_u32 s40, s40, 4096
buffer_load_dwordx4 a[176:179], v1, s[4:7], s40 offen
buffer_load_dwordx4 a[180:183], v1, s[4:7], s40 offen offset:1024
buffer_load_dwordx4 a[184:187], v1, s[4:7], s40 offen offset:2048
buffer_load_dwordx4 a[188:191], v1, s[4:7], s40 offen offset:3072
s_add_u32 s40, s40, 4096
s_waitcnt vmcnt(32)
buffer_load_dwordx4 a[192:195], v1, s[4:7], s40 offen
buffer_load_dwordx4 a[196:199], v1, s[4:7], s40 offen offset:1024
buffer_load_dwordx4 a[200:203], v1, s[4:7], s40 offen offset:2048
buffer_load_dwordx4 a[204:207], v1, s[4:7], s40 offen offset:3072
s_add_u32 s40, s40, 4096
buffer_load_dwordx4 a[208:211], v1, s[4:7], s40 offen
buffer_load_dwordx4 a[212:215], v1, s[4:7], s40 offen offset:1024
buffer_load_dwordx4 a[216:219], v1, s[4:7], s40 offen offset:2048
buffer_load_dwordx4 a[220:223], v1, s[4:7], s40 offen offset:3072
s_waitcnt vmcnt(40)
s_mov_b32 m0, 135168
s_add_u32 s42, s41, 0
buffer_load_dwordx4 v1, s[4:7], s42 offen lds
s_mov_b32 m0, 136192
s_add_u32 s42, s41, 1024
buffer_load_dwordx4 v1, s[4:7], s42 offen lds
s_mov_b32 m0, 137216
s_add_u32 s42, s41, 2048
buffer_load_dwordx4 v1, s[4:7], s42 offen lds
s_mov_b32 m0, 138240
s_add_u32 s42, s41, 3072
buffer_load_dwordx4 v1, s[4:7], s42 offen lds
s_mov_b32 m0, 139264
s_add_u32 s42, s41, 4096
buffer_load_dwordx4 v1, s[4:7], s42 offen lds
s_mov_b32 m0, 140288
s_add_u32 s42, s41, 5120
buffer_load_dwordx4 v1, s[4:7], s42 offen lds
s_mov_b32 m0, 141312
s_add_u32 s42, s41, 6144
buffer_load_dwordx4 v1, s[4:7], s42 offen lds
s_mov_b32 m0, 142336
s_add_u32 s42, s41, 7168
buffer_load_dwordx4 v1, s[4:7], s42 offen lds
s_waitcnt vmcnt(40)
s_mov_b32 m0, 143360
s_add_u32 s42, s41, 8192
buffer_load_dwordx4 v1, s[4:7], s42 offen lds
s_mov_b32 m0, 144384
s_add_u32 s42, s41, 9216
buffer_load_dwordx4 v1, s[4:7], s42 offen lds
s_mov_b32 m0, 145408
s_add_u32 s42, s41, 10240
buffer_load_dwordx4 v1, s[4:7], s42 offen lds
s_mov_b32 m0, 146432
s_add_u32 s42, s41, 11264
buffer_load_dwordx4 v1, s[4:7], s42 offen lds
s_mov_b32 m0, 147456
s_add_u32 s42, s41, 12288
buffer_load_dwordx4 v1, s[4:7], s42 offen lds
s_mov_b32 m0, 148480
s_add_u32 s42, s41, 13312
buffer_load_dwordx4 v1, s[4:7], s42 offen lds
s_mov_b32 m0, 149504
s_add_u32 s42, s41, 14336
buffer_load_dwordx4 v1, s[4:7], s42 offen lds
s_mov_b32 m0, 150528
s_add_u32 s42, s41, 15360
buffer_load_dwordx4 v1, s[4:7], s42 offen lds
s_waitcnt vmcnt(40)
s_mov_b32 m0, 151552
s_add_u32 s42, s41, 16384
buffer_load_dwordx4 v1, s[4:7], s42 offen lds
s_mov_b32 m0, 152576
s_add_u32 s42, s41, 17408
buffer_load_dwordx4 v1, s[4:7], s42 offen lds
s_mov_b32 m0, 153600
s_add_u32 s42, s41, 18432
buffer_load_dwordx4 v1, s[4:7], s42 offen lds
s_mov_b32 m0, 154624
s_add_u32 s42, s41, 19456
buffer_load_dwordx4 v1, s[4:7], s42 offen lds
s_mov_b32 m0, 155648
s_add_u32 s42, s41, 20480
buffer_load_dwordx4 v1, s[4:7], s42 offen lds
s_mov_b32 m0, 156672
s_add_u32 s42, s41, 21504
buffer_load_dwordx4 v1, s[4:7], s42 offen lds
s_mov_b32 m0, 157696
s_add_u32 s42, s41, 22528
buffer_load_dwordx4 v1, s[4:7], s42 offen lds
s_mov_b32 m0, 158720
s_add_u32 s42, s41, 23552
buffer_load_dwordx4 v1, s[4:7], s42 offen lds
s_waitcnt vmcnt(40)
s_mov_b32 m0, 159744
s_add_u32 s42, s41, 24576
buffer_load_dwordx4 v1, s[4:7], s42 offen lds
s_mov_b32 m0, 160768
s_add_u32 s42, s41, 25600
buffer_load_dwordx4 v1, s[4:7], s42 offen lds
s_mov_b32 m0, 161792
s_add_u32 s42, s41, 26624
buffer_load_dwordx4 v1, s[4:7], s42 offen lds
s_mov_b32 m0, 162816
s_add_u32 s42, s41, 27648
buffer_load_dwordx4 v1, s[4:7], s42 offen lds
s_waitcnt vmcnt(52)
buffer_load_dwordx4 a[224:227], v1, s[4:7], s43 offen
buffer_load_dwordx4 a[228:231], v1, s[4:7], s43 offen offset:1024
buffer_load_dwordx4 a[232:235], v1, s[4:7], s43 offen offset:2048
buffer_load_dwordx4 a[236:239], v1, s[4:7], s43 offen offset:3072
s_add_u32 s43, s43, 4096
s_waitcnt vmcnt(52)
buffer_load_dwordx4 a[240:243], v1, s[4:7], s43 offen
buffer_load_dwordx4 a[244:247], v1, s[4:7], s43 offen offset:1024
buffer_load_dwordx4 a[248:251], v1, s[4:7], s43 offen offset:2048
buffer_load_dwordx4 a[252:255], v1, s[4:7], s43 offen offset:3072
s_add_u32 s43, s43, 4096
s_waitcnt vmcnt(52)
buffer_load_dwordx4 v[176:179], v1, s[4:7], s43 offen
buffer_load_dwordx4 v[180:183], v1, s[4:7], s43 offen offset:1024
buffer_load_dwordx4 v[184:187], v1, s[4:7], s43 offen offset:2048
buffer_load_dwordx4 v[188:191], v1, s[4:7], s43 offen offset:3072
s_add_u32 s43, s43, 4096
s_waitcnt vmcnt(52)
buffer_load_dwordx4 v[192:195], v1, s[4:7], s43 offen
buffer_load_dwordx4 v[196:199], v1, s[4:7], s43 offen offset:1024
buffer_load_dwordx4 v[200:203], v1, s[4:7], s43 offen offset:2048
buffer_load_dwordx4 v[204:207], v1, s[4:7], s43 offen offset:3072
s_add_u32 s43, s43, 4096
s_waitcnt vmcnt(52)
buffer_load_dwordx4 v[208:211], v1, s[4:7], s43 offen
buffer_load_dwordx4 v[212:215], v1, s[4:7], s43 offen offset:1024
buffer_load_dwordx4 v[216:219], v1, s[4:7], s43 offen offset:2048
buffer_load_dwordx4 v[220:223], v1, s[4:7], s43 offen offset:3072
s_add_u32 s43, s43, 4096
s_waitcnt vmcnt(52)
buffer_load_dwordx4 v[224:227], v1, s[4:7], s43 offen
buffer_load_dwordx4 v[228:231], v1, s[4:7], s43 offen offset:1024
buffer_load_dwordx4 v[232:235], v1, s[4:7], s43 offen offset:2048
buffer_load_dwordx4 v[236:239], v1, s[4:7], s43 offen offset:3072
s_add_u32 s43, s43, 4096
s_waitcnt vmcnt(52)
buffer_load_dwordx4 v[240:243], v1, s[4:7], s43 offen
buffer_load_dwordx4 v[244:247], v1, s[4:7], s43 offen offset:1024
buffer_load_dwordx4 v[248:251], v1, s[4:7], s43 offen offset:2048
buffer_load_dwordx4 v[252:255], v1, s[4:7], s43 offen offset:3072
s_add_u32 s43, s43, 4096
v_add_u32 v2, 135168, v1
v_and_b32 v11, 15, v0
v_lshrrev_b32 v12, 4, v0
v_bfe_u32 v3, v0, 3, 1
v_mul_u32_u24 v3, 14368, v3
v_lshl_add_u32 v3, v12, 8, v3
v_bfe_u32 v4, v0, 2, 1
v_lshl_add_u32 v3, v4, 6, v3
v_bfe_u32 v4, v0, 1, 1
v_lshl_add_u32 v3, v4, 7, v3
v_and_b32 v4, 1, v0
v_lshl_add_u32 v3, v4, 4, v3
v_and_b32 v4, 31, v0
v_lshlrev_b32 v4, 4, v4
v_mul_u32_u24 v5, 576, v12
v_lshl_add_u32 v5, v11, 2, v5
v_add_u32 v5, 42624, v5
v_add_u32 v6, 2304, v5
v_lshrrev_b32 v11, 3, v0
v_add_u32 v11, 24, v11
v_and_b32 v12, 7, v0
v_mul_u32_u24 v7, 144, v11
v_lshl_add_u32 v7, v12, 4, v7
v_add_u32 v7, 28800, v7
v_mul_u32_u24 v8, 896, v11
v_lshl_add_u32 v8, v12, 3, v8
v_and_b32 v9, 15, v11
v_lshlrev_b32 v9, 4, v9
v_lshrrev_b32 v11, 1, v12
v_lshl_add_u32 v9, v11, 8, v9
v_and_b32 v11, 1, v12
v_lshl_add_u32 v9, v11, 3, v9
v_and_b32 v11, 8, v0
v_cmp_eq_u32 vcc, 0, v11
v_mov_b32 v11, 0x88884444
v_mov_b32 v10, 0xddddeeee
v_cndmask_b32 v10, v10, v11, vcc
s_mul_i32 s34, s21, 28672
s_lshl_b32 s40, s22, 10
s_add_u32 s35, s34, s40
s_add_u32 s35, s35, 4384768
s_lshl_b32 s40, s22, 6
s_add_u32 s34, s34, s40
s_lshl_b32 s40, s22, 15
s_add_u32 s40, s40, 30089216
s_mul_i32 s30, s21, 458752
s_add_u32 s30, s30, s40
s_mul_i32 s27, s29, 458752
s_add_u32 s27, s27, s40
s_lshl_b32 s40, s22, 7
s_add_u32 s40, s40, 8204
s_mul_i32 s28, s29, 1792
s_add_u32 s28, s28, s40
s_mul_i32 s31, s21, 7168
s_add_u32 s31, s31, 641024
s_mul_i32 s32, s21, 40960
s_add_u32 s33, s32, 1787904
s_add_u32 s32, s32, 1773568
s_mov_b32 s25, s21
s_waitcnt vmcnt(56) lgkmcnt(0)
s_branch TB_Y3
TB_TOP3:
s_cmp_lt_u32 s29, 64
s_cbranch_scc0 TB_PV3
TB_Y3:
s_barrier
ds_read_b128 v[16:19], v3
ds_read_b128 v[20:23], v3 offset:32
ds_read_b128 v[24:27], v3 offset:1024
ds_read_b128 v[28:31], v3 offset:1056
s_waitcnt lgkmcnt(2)
v_mfma_f32_16x16x32_bf16 v[116:119], v[16:19], a[0:3], 0
v_mfma_f32_16x16x32_bf16 v[120:123], v[20:23], a[0:3], 0
ds_read_b128 v[32:35], v3 offset:2048
ds_read_b128 v[36:39], v3 offset:2080
v_mfma_f32_16x16x32_bf16 v[124:127], v[16:19], a[56:59], 0
v_mfma_f32_16x16x32_bf16 v[128:131], v[20:23], a[56:59], 0
v_mfma_f32_16x16x32_bf16 v[132:135], v[16:19], a[112:115], 0
v_mfma_f32_16x16x32_bf16 v[136:139], v[20:23], a[112:115], 0
v_mfma_f32_16x16x32_bf16 v[140:143], v[16:19], a[168:171], 0
v_mfma_f32_16x16x32_bf16 v[144:147], v[20:23], a[168:171], 0
s_waitcnt lgkmcnt(2)
v_mfma_f32_16x16x32_bf16 v[116:119], v[24:27], a[4:7], v[116:119]
v_mfma_f32_16x16x32_bf16 v[120:123], v[28:31], a[4:7], v[120:123]
ds_read_b128 v[16:19], v3 offset:3072
ds_read_b128 v[20:23], v3 offset:3104
v_mfma_f32_16x16x32_bf16 v[124:127], v[24:27], a[60:63], v[124:127]
v_mfma_f32_16x16x32_bf16 v[128:131], v[28:31], a[60:63], v[128:131]
v_mfma_f32_16x16x32_bf16 v[132:135], v[24:27], a[116:119], v[132:135]
v_mfma_f32_16x16x32_bf16 v[136:139], v[28:31], a[116:119], v[136:139]
v_mfma_f32_16x16x32_bf16 v[140:143], v[24:27], a[172:175], v[140:143]
v_mfma_f32_16x16x32_bf16 v[144:147], v[28:31], a[172:175], v[144:147]
s_waitcnt lgkmcnt(2)
v_mfma_f32_16x16x32_bf16 v[116:119], v[32:35], a[8:11], v[116:119]
v_mfma_f32_16x16x32_bf16 v[120:123], v[36:39], a[8:11], v[120:123]
ds_read_b128 v[24:27], v3 offset:4096
ds_read_b128 v[28:31], v3 offset:4128
v_mfma_f32_16x16x32_bf16 v[124:127], v[32:35], a[64:67], v[124:127]
v_mfma_f32_16x16x32_bf16 v[128:131], v[36:39], a[64:67], v[128:131]
v_mfma_f32_16x16x32_bf16 v[132:135], v[32:35], a[120:123], v[132:135]
v_mfma_f32_16x16x32_bf16 v[136:139], v[36:39], a[120:123], v[136:139]
v_mfma_f32_16x16x32_bf16 v[140:143], v[32:35], a[176:179], v[140:143]
v_mfma_f32_16x16x32_bf16 v[144:147], v[36:39], a[176:179], v[144:147]
s_waitcnt lgkmcnt(2)
v_mfma_f32_16x16x32_bf16 v[116:119], v[16:19], a[12:15], v[116:119]
v_mfma_f32_16x16x32_bf16 v[120:123], v[20:23], a[12:15], v[120:123]
ds_read_b128 v[32:35], v3 offset:5120
ds_read_b128 v[36:39], v3 offset:5152
v_mfma_f32_16x16x32_bf16 v[124:127], v[16:19], a[68:71], v[124:127]
v_mfma_f32_16x16x32_bf16 v[128:131], v[20:23], a[68:71], v[128:131]
v_mfma_f32_16x16x32_bf16 v[132:135], v[16:19], a[124:127], v[132:135]
v_mfma_f32_16x16x32_bf16 v[136:139], v[20:23], a[124:127], v[136:139]
v_mfma_f32_16x16x32_bf16 v[140:143], v[16:19], a[180:183], v[140:143]
v_mfma_f32_16x16x32_bf16 v[144:147], v[20:23], a[180:183], v[144:147]
s_waitcnt lgkmcnt(2)
v_mfma_f32_16x16x32_bf16 v[116:119], v[24:27], a[16:19], v[116:119]
v_mfma_f32_16x16x32_bf16 v[120:123], v[28:31], a[16:19], v[120:123]
ds_read_b128 v[16:19], v3 offset:6144
ds_read_b128 v[20:23], v3 offset:6176
v_mfma_f32_16x16x32_bf16 v[124:127], v[24:27], a[72:75], v[124:127]
v_mfma_f32_16x16x32_bf16 v[128:131], v[28:31], a[72:75], v[128:131]
v_mfma_f32_16x16x32_bf16 v[132:135], v[24:27], a[128:131], v[132:135]
v_mfma_f32_16x16x32_bf16 v[136:139], v[28:31], a[128:131], v[136:139]
v_mfma_f32_16x16x32_bf16 v[140:143], v[24:27], a[184:187], v[140:143]
v_mfma_f32_16x16x32_bf16 v[144:147], v[28:31], a[184:187], v[144:147]
s_waitcnt lgkmcnt(2)
v_mfma_f32_16x16x32_bf16 v[116:119], v[32:35], a[20:23], v[116:119]
v_mfma_f32_16x16x32_bf16 v[120:123], v[36:39], a[20:23], v[120:123]
ds_read_b128 v[24:27], v3 offset:7168
ds_read_b128 v[28:31], v3 offset:7200
v_mfma_f32_16x16x32_bf16 v[124:127], v[32:35], a[76:79], v[124:127]
v_mfma_f32_16x16x32_bf16 v[128:131], v[36:39], a[76:79], v[128:131]
v_mfma_f32_16x16x32_bf16 v[132:135], v[32:35], a[132:135], v[132:135]
v_mfma_f32_16x16x32_bf16 v[136:139], v[36:39], a[132:135], v[136:139]
v_mfma_f32_16x16x32_bf16 v[140:143], v[32:35], a[188:191], v[140:143]
v_mfma_f32_16x16x32_bf16 v[144:147], v[36:39], a[188:191], v[144:147]
s_waitcnt lgkmcnt(2)
v_mfma_f32_16x16x32_bf16 v[116:119], v[16:19], a[24:27], v[116:119]
v_mfma_f32_16x16x32_bf16 v[120:123], v[20:23], a[24:27], v[120:123]
ds_read_b128 v[32:35], v3 offset:8192
ds_read_b128 v[36:39], v3 offset:8224
v_mfma_f32_16x16x32_bf16 v[124:127], v[16:19], a[80:83], v[124:127]
v_mfma_f32_16x16x32_bf16 v[128:131], v[20:23], a[80:83], v[128:131]
v_mfma_f32_16x16x32_bf16 v[132:135], v[16:19], a[136:139], v[132:135]
v_mfma_f32_16x16x32_bf16 v[136:139], v[20:23], a[136:139], v[136:139]
v_mfma_f32_16x16x32_bf16 v[140:143], v[16:19], a[192:195], v[140:143]
v_mfma_f32_16x16x32_bf16 v[144:147], v[20:23], a[192:195], v[144:147]
s_waitcnt lgkmcnt(2)
v_mfma_f32_16x16x32_bf16 v[116:119], v[24:27], a[28:31], v[116:119]
v_mfma_f32_16x16x32_bf16 v[120:123], v[28:31], a[28:31], v[120:123]
ds_read_b128 v[16:19], v3 offset:9216
ds_read_b128 v[20:23], v3 offset:9248
v_mfma_f32_16x16x32_bf16 v[124:127], v[24:27], a[84:87], v[124:127]
v_mfma_f32_16x16x32_bf16 v[128:131], v[28:31], a[84:87], v[128:131]
v_mfma_f32_16x16x32_bf16 v[132:135], v[24:27], a[140:143], v[132:135]
v_mfma_f32_16x16x32_bf16 v[136:139], v[28:31], a[140:143], v[136:139]
v_mfma_f32_16x16x32_bf16 v[140:143], v[24:27], a[196:199], v[140:143]
v_mfma_f32_16x16x32_bf16 v[144:147], v[28:31], a[196:199], v[144:147]
s_waitcnt lgkmcnt(2)
v_mfma_f32_16x16x32_bf16 v[116:119], v[32:35], a[32:35], v[116:119]
v_mfma_f32_16x16x32_bf16 v[120:123], v[36:39], a[32:35], v[120:123]
ds_read_b128 v[24:27], v3 offset:10240
ds_read_b128 v[28:31], v3 offset:10272
v_mfma_f32_16x16x32_bf16 v[124:127], v[32:35], a[88:91], v[124:127]
v_mfma_f32_16x16x32_bf16 v[128:131], v[36:39], a[88:91], v[128:131]
v_mfma_f32_16x16x32_bf16 v[132:135], v[32:35], a[144:147], v[132:135]
v_mfma_f32_16x16x32_bf16 v[136:139], v[36:39], a[144:147], v[136:139]
v_mfma_f32_16x16x32_bf16 v[140:143], v[32:35], a[200:203], v[140:143]
v_mfma_f32_16x16x32_bf16 v[144:147], v[36:39], a[200:203], v[144:147]
s_waitcnt lgkmcnt(2)
v_mfma_f32_16x16x32_bf16 v[116:119], v[16:19], a[36:39], v[116:119]
v_mfma_f32_16x16x32_bf16 v[120:123], v[20:23], a[36:39], v[120:123]
ds_read_b128 v[32:35], v3 offset:11264
ds_read_b128 v[36:39], v3 offset:11296
v_mfma_f32_16x16x32_bf16 v[124:127], v[16:19], a[92:95], v[124:127]
v_mfma_f32_16x16x32_bf16 v[128:131], v[20:23], a[92:95], v[128:131]
v_mfma_f32_16x16x32_bf16 v[132:135], v[16:19], a[148:151], v[132:135]
v_mfma_f32_16x16x32_bf16 v[136:139], v[20:23], a[148:151], v[136:139]
v_mfma_f32_16x16x32_bf16 v[140:143], v[16:19], a[204:207], v[140:143]
v_mfma_f32_16x16x32_bf16 v[144:147], v[20:23], a[204:207], v[144:147]
s_waitcnt lgkmcnt(2)
v_mfma_f32_16x16x32_bf16 v[116:119], v[24:27], a[40:43], v[116:119]
v_mfma_f32_16x16x32_bf16 v[120:123], v[28:31], a[40:43], v[120:123]
ds_read_b128 v[16:19], v3 offset:12288
ds_read_b128 v[20:23], v3 offset:12320
v_mfma_f32_16x16x32_bf16 v[124:127], v[24:27], a[96:99], v[124:127]
v_mfma_f32_16x16x32_bf16 v[128:131], v[28:31], a[96:99], v[128:131]
v_mfma_f32_16x16x32_bf16 v[132:135], v[24:27], a[152:155], v[132:135]
v_mfma_f32_16x16x32_bf16 v[136:139], v[28:31], a[152:155], v[136:139]
v_mfma_f32_16x16x32_bf16 v[140:143], v[24:27], a[208:211], v[140:143]
v_mfma_f32_16x16x32_bf16 v[144:147], v[28:31], a[208:211], v[144:147]
s_waitcnt lgkmcnt(2)
v_mfma_f32_16x16x32_bf16 v[116:119], v[32:35], a[44:47], v[116:119]
v_mfma_f32_16x16x32_bf16 v[120:123], v[36:39], a[44:47], v[120:123]
ds_read_b128 v[24:27], v3 offset:13312
ds_read_b128 v[28:31], v3 offset:13344
v_mfma_f32_16x16x32_bf16 v[124:127], v[32:35], a[100:103], v[124:127]
v_mfma_f32_16x16x32_bf16 v[128:131], v[36:39], a[100:103], v[128:131]
v_mfma_f32_16x16x32_bf16 v[132:135], v[32:35], a[156:159], v[132:135]
v_mfma_f32_16x16x32_bf16 v[136:139], v[36:39], a[156:159], v[136:139]
v_mfma_f32_16x16x32_bf16 v[140:143], v[32:35], a[212:215], v[140:143]
v_mfma_f32_16x16x32_bf16 v[144:147], v[36:39], a[212:215], v[144:147]
s_waitcnt lgkmcnt(2)
v_mfma_f32_16x16x32_bf16 v[116:119], v[16:19], a[48:51], v[116:119]
v_mfma_f32_16x16x32_bf16 v[120:123], v[20:23], a[48:51], v[120:123]
v_mfma_f32_16x16x32_bf16 v[124:127], v[16:19], a[104:107], v[124:127]
v_mfma_f32_16x16x32_bf16 v[128:131], v[20:23], a[104:107], v[128:131]
v_mfma_f32_16x16x32_bf16 v[132:135], v[16:19], a[160:163], v[132:135]
v_mfma_f32_16x16x32_bf16 v[136:139], v[20:23], a[160:163], v[136:139]
v_mfma_f32_16x16x32_bf16 v[140:143], v[16:19], a[216:219], v[140:143]
v_mfma_f32_16x16x32_bf16 v[144:147], v[20:23], a[216:219], v[144:147]
s_waitcnt lgkmcnt(0)
v_mfma_f32_16x16x32_bf16 v[116:119], v[24:27], a[52:55], v[116:119]
v_mfma_f32_16x16x32_bf16 v[120:123], v[28:31], a[52:55], v[120:123]
v_mfma_f32_16x16x32_bf16 v[124:127], v[24:27], a[108:111], v[124:127]
v_mfma_f32_16x16x32_bf16 v[128:131], v[28:31], a[108:111], v[128:131]
v_mfma_f32_16x16x32_bf16 v[132:135], v[24:27], a[164:167], v[132:135]
v_mfma_f32_16x16x32_bf16 v[136:139], v[28:31], a[164:167], v[136:139]
v_mfma_f32_16x16x32_bf16 v[140:143], v[24:27], a[220:223], v[140:143]
v_mfma_f32_16x16x32_bf16 v[144:147], v[28:31], a[220:223], v[144:147]
s_nop 1
v_cvt_pk_bf16_f32 v44, v116, v117
v_cvt_pk_bf16_f32 v45, v118, v119
v_cvt_pk_bf16_f32 v46, v120, v121
v_cvt_pk_bf16_f32 v47, v122, v123
buffer_store_dwordx4 v[44:47], v1, s[4:7], s27 offen sc1
v_cvt_pk_bf16_f32 v48, v124, v125
v_cvt_pk_bf16_f32 v49, v126, v127
v_cvt_pk_bf16_f32 v50, v128, v129
v_cvt_pk_bf16_f32 v51, v130, v131
buffer_store_dwordx4 v[48:51], v1, s[4:7], s27 offen offset:2048 sc1
v_cvt_pk_bf16_f32 v52, v132, v133
v_cvt_pk_bf16_f32 v53, v134, v135
v_cvt_pk_bf16_f32 v54, v136, v137
v_cvt_pk_bf16_f32 v55, v138, v139
buffer_store_dwordx4 v[52:55], v1, s[4:7], s27 offen offset:1024 sc1
v_cvt_pk_bf16_f32 v56, v140, v141
v_cvt_pk_bf16_f32 v57, v142, v143
v_cvt_pk_bf16_f32 v58, v144, v145
v_cvt_pk_bf16_f32 v59, v146, v147
buffer_store_dwordx4 v[56:59], v1, s[4:7], s27 offen offset:3072 sc1
s_waitcnt vmcnt(4)
ds_read_b128 v[16:19], v3
ds_read_b128 v[20:23], v3 offset:32
ds_read_b128 v[92:95], v2
ds_read_b128 v[96:99], v2 offset:14336
ds_read_b128 v[24:27], v3 offset:1024
ds_read_b128 v[28:31], v3 offset:1056
ds_read_b128 v[100:103], v2 offset:1024
ds_read_b128 v[104:107], v2 offset:15360
s_waitcnt lgkmcnt(4)
v_mfma_f32_16x16x32_bf16 v[116:119], v[16:19], a[224:227], 0
v_mfma_f32_16x16x32_bf16 v[120:123], v[20:23], a[224:227], 0
ds_read_b128 v[32:35], v3 offset:2048
ds_read_b128 v[36:39], v3 offset:2080
ds_read_b128 v[108:111], v2 offset:2048
ds_read_b128 v[112:115], v2 offset:16384
v_mfma_f32_16x16x32_bf16 v[124:127], v[16:19], v[200:203], 0
v_mfma_f32_16x16x32_bf16 v[128:131], v[20:23], v[200:203], 0
v_mfma_f32_16x16x32_bf16 v[132:135], v[16:19], v[92:95], 0
v_mfma_f32_16x16x32_bf16 v[136:139], v[20:23], v[92:95], 0
v_mfma_f32_16x16x32_bf16 v[140:143], v[16:19], v[96:99], 0
v_mfma_f32_16x16x32_bf16 v[144:147], v[20:23], v[96:99], 0
s_waitcnt lgkmcnt(4)
v_mfma_f32_16x16x32_bf16 v[116:119], v[24:27], a[228:231], v[116:119]
v_mfma_f32_16x16x32_bf16 v[120:123], v[28:31], a[228:231], v[120:123]
ds_read_b128 v[16:19], v3 offset:3072
ds_read_b128 v[20:23], v3 offset:3104
ds_read_b128 v[92:95], v2 offset:3072
ds_read_b128 v[96:99], v2 offset:17408
v_mfma_f32_16x16x32_bf16 v[124:127], v[24:27], v[204:207], v[124:127]
v_mfma_f32_16x16x32_bf16 v[128:131], v[28:31], v[204:207], v[128:131]
v_mfma_f32_16x16x32_bf16 v[132:135], v[24:27], v[100:103], v[132:135]
v_mfma_f32_16x16x32_bf16 v[136:139], v[28:31], v[100:103], v[136:139]
v_mfma_f32_16x16x32_bf16 v[140:143], v[24:27], v[104:107], v[140:143]
v_mfma_f32_16x16x32_bf16 v[144:147], v[28:31], v[104:107], v[144:147]
s_waitcnt lgkmcnt(4)
v_mfma_f32_16x16x32_bf16 v[116:119], v[32:35], a[232:235], v[116:119]
v_mfma_f32_16x16x32_bf16 v[120:123], v[36:39], a[232:235], v[120:123]
ds_read_b128 v[24:27], v3 offset:4096
ds_read_b128 v[28:31], v3 offset:4128
ds_read_b128 v[100:103], v2 offset:4096
ds_read_b128 v[104:107], v2 offset:18432
v_mfma_f32_16x16x32_bf16 v[124:127], v[32:35], v[208:211], v[124:127]
v_mfma_f32_16x16x32_bf16 v[128:131], v[36:39], v[208:211], v[128:131]
v_mfma_f32_16x16x32_bf16 v[132:135], v[32:35], v[108:111], v[132:135]
v_mfma_f32_16x16x32_bf16 v[136:139], v[36:39], v[108:111], v[136:139]
v_mfma_f32_16x16x32_bf16 v[140:143], v[32:35], v[112:115], v[140:143]
v_mfma_f32_16x16x32_bf16 v[144:147], v[36:39], v[112:115], v[144:147]
s_waitcnt lgkmcnt(4)
v_mfma_f32_16x16x32_bf16 v[116:119], v[16:19], a[236:239], v[116:119]
v_mfma_f32_16x16x32_bf16 v[120:123], v[20:23], a[236:239], v[120:123]
ds_read_b128 v[32:35], v3 offset:5120
ds_read_b128 v[36:39], v3 offset:5152
ds_read_b128 v[108:111], v2 offset:5120
ds_read_b128 v[112:115], v2 offset:19456
v_mfma_f32_16x16x32_bf16 v[124:127], v[16:19], v[212:215], v[124:127]
v_mfma_f32_16x16x32_bf16 v[128:131], v[20:23], v[212:215], v[128:131]
v_mfma_f32_16x16x32_bf16 v[132:135], v[16:19], v[92:95], v[132:135]
v_mfma_f32_16x16x32_bf16 v[136:139], v[20:23], v[92:95], v[136:139]
v_mfma_f32_16x16x32_bf16 v[140:143], v[16:19], v[96:99], v[140:143]
v_mfma_f32_16x16x32_bf16 v[144:147], v[20:23], v[96:99], v[144:147]
s_waitcnt lgkmcnt(4)
v_mfma_f32_16x16x32_bf16 v[116:119], v[24:27], a[240:243], v[116:119]
v_mfma_f32_16x16x32_bf16 v[120:123], v[28:31], a[240:243], v[120:123]
ds_read_b128 v[16:19], v3 offset:6144
ds_read_b128 v[20:23], v3 offset:6176
ds_read_b128 v[92:95], v2 offset:6144
ds_read_b128 v[96:99], v2 offset:20480
v_mfma_f32_16x16x32_bf16 v[124:127], v[24:27], v[216:219], v[124:127]
v_mfma_f32_16x16x32_bf16 v[128:131], v[28:31], v[216:219], v[128:131]
v_mfma_f32_16x16x32_bf16 v[132:135], v[24:27], v[100:103], v[132:135]
v_mfma_f32_16x16x32_bf16 v[136:139], v[28:31], v[100:103], v[136:139]
v_mfma_f32_16x16x32_bf16 v[140:143], v[24:27], v[104:107], v[140:143]
v_mfma_f32_16x16x32_bf16 v[144:147], v[28:31], v[104:107], v[144:147]
s_waitcnt lgkmcnt(4)
v_mfma_f32_16x16x32_bf16 v[116:119], v[32:35], a[244:247], v[116:119]
v_mfma_f32_16x16x32_bf16 v[120:123], v[36:39], a[244:247], v[120:123]
ds_read_b128 v[24:27], v3 offset:7168
ds_read_b128 v[28:31], v3 offset:7200
ds_read_b128 v[100:103], v2 offset:7168
ds_read_b128 v[104:107], v2 offset:21504
v_mfma_f32_16x16x32_bf16 v[124:127], v[32:35], v[220:223], v[124:127]
v_mfma_f32_16x16x32_bf16 v[128:131], v[36:39], v[220:223], v[128:131]
v_mfma_f32_16x16x32_bf16 v[132:135], v[32:35], v[108:111], v[132:135]
v_mfma_f32_16x16x32_bf16 v[136:139], v[36:39], v[108:111], v[136:139]
v_mfma_f32_16x16x32_bf16 v[140:143], v[32:35], v[112:115], v[140:143]
v_mfma_f32_16x16x32_bf16 v[144:147], v[36:39], v[112:115], v[144:147]
s_waitcnt lgkmcnt(4)
v_mfma_f32_16x16x32_bf16 v[116:119], v[16:19], a[248:251], v[116:119]
v_mfma_f32_16x16x32_bf16 v[120:123], v[20:23], a[248:251], v[120:123]
ds_read_b128 v[32:35], v3 offset:8192
ds_read_b128 v[36:39], v3 offset:8224
ds_read_b128 v[108:111], v2 offset:8192
ds_read_b128 v[112:115], v2 offset:22528
v_mfma_f32_16x16x32_bf16 v[124:127], v[16:19], v[224:227], v[124:127]
v_mfma_f32_16x16x32_bf16 v[128:131], v[20:23], v[224:227], v[128:131]
v_mfma_f32_16x16x32_bf16 v[132:135], v[16:19], v[92:95], v[132:135]
v_mfma_f32_16x16x32_bf16 v[136:139], v[20:23], v[92:95], v[136:139]
v_mfma_f32_16x16x32_bf16 v[140:143], v[16:19], v[96:99], v[140:143]
v_mfma_f32_16x16x32_bf16 v[144:147], v[20:23], v[96:99], v[144:147]
s_waitcnt lgkmcnt(4)
v_mfma_f32_16x16x32_bf16 v[116:119], v[24:27], a[252:255], v[116:119]
v_mfma_f32_16x16x32_bf16 v[120:123], v[28:31], a[252:255], v[120:123]
ds_read_b128 v[16:19], v3 offset:9216
ds_read_b128 v[20:23], v3 offset:9248
ds_read_b128 v[92:95], v2 offset:9216
ds_read_b128 v[96:99], v2 offset:23552
v_mfma_f32_16x16x32_bf16 v[124:127], v[24:27], v[228:231], v[124:127]
v_mfma_f32_16x16x32_bf16 v[128:131], v[28:31], v[228:231], v[128:131]
v_mfma_f32_16x16x32_bf16 v[132:135], v[24:27], v[100:103], v[132:135]
v_mfma_f32_16x16x32_bf16 v[136:139], v[28:31], v[100:103], v[136:139]
v_mfma_f32_16x16x32_bf16 v[140:143], v[24:27], v[104:107], v[140:143]
v_mfma_f32_16x16x32_bf16 v[144:147], v[28:31], v[104:107], v[144:147]
s_waitcnt lgkmcnt(4)
v_mfma_f32_16x16x32_bf16 v[116:119], v[32:35], v[176:179], v[116:119]
v_mfma_f32_16x16x32_bf16 v[120:123], v[36:39], v[176:179], v[120:123]
ds_read_b128 v[24:27], v3 offset:10240
ds_read_b128 v[28:31], v3 offset:10272
ds_read_b128 v[100:103], v2 offset:10240
ds_read_b128 v[104:107], v2 offset:24576
v_mfma_f32_16x16x32_bf16 v[124:127], v[32:35], v[232:235], v[124:127]
v_mfma_f32_16x16x32_bf16 v[128:131], v[36:39], v[232:235], v[128:131]
v_mfma_f32_16x16x32_bf16 v[132:135], v[32:35], v[108:111], v[132:135]
v_mfma_f32_16x16x32_bf16 v[136:139], v[36:39], v[108:111], v[136:139]
v_mfma_f32_16x16x32_bf16 v[140:143], v[32:35], v[112:115], v[140:143]
v_mfma_f32_16x16x32_bf16 v[144:147], v[36:39], v[112:115], v[144:147]
s_waitcnt lgkmcnt(4)
v_mfma_f32_16x16x32_bf16 v[116:119], v[16:19], v[180:183], v[116:119]
v_mfma_f32_16x16x32_bf16 v[120:123], v[20:23], v[180:183], v[120:123]
ds_read_b128 v[32:35], v3 offset:11264
ds_read_b128 v[36:39], v3 offset:11296
ds_read_b128 v[108:111], v2 offset:11264
ds_read_b128 v[112:115], v2 offset:25600
v_mfma_f32_16x16x32_bf16 v[124:127], v[16:19], v[236:239], v[124:127]
v_mfma_f32_16x16x32_bf16 v[128:131], v[20:23], v[236:239], v[128:131]
v_mfma_f32_16x16x32_bf16 v[132:135], v[16:19], v[92:95], v[132:135]
v_mfma_f32_16x16x32_bf16 v[136:139], v[20:23], v[92:95], v[136:139]
v_mfma_f32_16x16x32_bf16 v[140:143], v[16:19], v[96:99], v[140:143]
v_mfma_f32_16x16x32_bf16 v[144:147], v[20:23], v[96:99], v[144:147]
s_waitcnt lgkmcnt(4)
v_mfma_f32_16x16x32_bf16 v[116:119], v[24:27], v[184:187], v[116:119]
v_mfma_f32_16x16x32_bf16 v[120:123], v[28:31], v[184:187], v[120:123]
ds_read_b128 v[16:19], v3 offset:12288
ds_read_b128 v[20:23], v3 offset:12320
ds_read_b128 v[92:95], v2 offset:12288
ds_read_b128 v[96:99], v2 offset:26624
v_mfma_f32_16x16x32_bf16 v[124:127], v[24:27], v[240:243], v[124:127]
v_mfma_f32_16x16x32_bf16 v[128:131], v[28:31], v[240:243], v[128:131]
v_mfma_f32_16x16x32_bf16 v[132:135], v[24:27], v[100:103], v[132:135]
v_mfma_f32_16x16x32_bf16 v[136:139], v[28:31], v[100:103], v[136:139]
v_mfma_f32_16x16x32_bf16 v[140:143], v[24:27], v[104:107], v[140:143]
v_mfma_f32_16x16x32_bf16 v[144:147], v[28:31], v[104:107], v[144:147]
s_waitcnt lgkmcnt(4)
v_mfma_f32_16x16x32_bf16 v[116:119], v[32:35], v[188:191], v[116:119]
v_mfma_f32_16x16x32_bf16 v[120:123], v[36:39], v[188:191], v[120:123]
ds_read_b128 v[24:27], v3 offset:13312
ds_read_b128 v[28:31], v3 offset:13344
ds_read_b128 v[100:103], v2 offset:13312
ds_read_b128 v[104:107], v2 offset:27648
v_mfma_f32_16x16x32_bf16 v[124:127], v[32:35], v[244:247], v[124:127]
v_mfma_f32_16x16x32_bf16 v[128:131], v[36:39], v[244:247], v[128:131]
v_mfma_f32_16x16x32_bf16 v[132:135], v[32:35], v[108:111], v[132:135]
v_mfma_f32_16x16x32_bf16 v[136:139], v[36:39], v[108:111], v[136:139]
v_mfma_f32_16x16x32_bf16 v[140:143], v[32:35], v[112:115], v[140:143]
v_mfma_f32_16x16x32_bf16 v[144:147], v[36:39], v[112:115], v[144:147]
s_waitcnt lgkmcnt(4)
v_mfma_f32_16x16x32_bf16 v[116:119], v[16:19], v[192:195], v[116:119]
v_mfma_f32_16x16x32_bf16 v[120:123], v[20:23], v[192:195], v[120:123]
v_mfma_f32_16x16x32_bf16 v[124:127], v[16:19], v[248:251], v[124:127]
v_mfma_f32_16x16x32_bf16 v[128:131], v[20:23], v[248:251], v[128:131]
v_mfma_f32_16x16x32_bf16 v[132:135], v[16:19], v[92:95], v[132:135]
v_mfma_f32_16x16x32_bf16 v[136:139], v[20:23], v[92:95], v[136:139]
v_mfma_f32_16x16x32_bf16 v[140:143], v[16:19], v[96:99], v[140:143]
v_mfma_f32_16x16x32_bf16 v[144:147], v[20:23], v[96:99], v[144:147]
s_waitcnt lgkmcnt(0)
v_mfma_f32_16x16x32_bf16 v[116:119], v[24:27], v[196:199], v[116:119]
v_mfma_f32_16x16x32_bf16 v[120:123], v[28:31], v[196:199], v[120:123]
v_mfma_f32_16x16x32_bf16 v[124:127], v[24:27], v[252:255], v[124:127]
v_mfma_f32_16x16x32_bf16 v[128:131], v[28:31], v[252:255], v[128:131]
v_mfma_f32_16x16x32_bf16 v[132:135], v[24:27], v[100:103], v[132:135]
v_mfma_f32_16x16x32_bf16 v[136:139], v[28:31], v[100:103], v[136:139]
v_mfma_f32_16x16x32_bf16 v[140:143], v[24:27], v[104:107], v[140:143]
v_mfma_f32_16x16x32_bf16 v[144:147], v[28:31], v[104:107], v[144:147]
s_nop 1
s_add_u32 s40, s27, 4096
v_cvt_pk_bf16_f32 v60, v116, v117
v_cvt_pk_bf16_f32 v61, v118, v119
v_cvt_pk_bf16_f32 v62, v120, v121
v_cvt_pk_bf16_f32 v63, v122, v123
buffer_store_dwordx4 v[60:63], v1, s[4:7], s40 offen sc1
v_cvt_pk_bf16_f32 v64, v124, v125
v_cvt_pk_bf16_f32 v65, v126, v127
v_cvt_pk_bf16_f32 v66, v128, v129
v_cvt_pk_bf16_f32 v67, v130, v131
buffer_store_dwordx4 v[64:67], v1, s[4:7], s40 offen offset:2048 sc1
v_cvt_pk_bf16_f32 v68, v132, v133
v_cvt_pk_bf16_f32 v69, v134, v135
v_cvt_pk_bf16_f32 v70, v136, v137
v_cvt_pk_bf16_f32 v71, v138, v139
buffer_store_dwordx4 v[68:71], v1, s[4:7], s40 offen offset:1024 sc1
v_cvt_pk_bf16_f32 v72, v140, v141
v_cvt_pk_bf16_f32 v73, v142, v143
v_cvt_pk_bf16_f32 v74, v144, v145
v_cvt_pk_bf16_f32 v75, v146, v147
buffer_store_dwordx4 v[72:75], v1, s[4:7], s40 offen offset:3072 sc1
s_mov_b32 s36, s28
s_cmp_lt_u32 s29, 4
s_cselect_b32 s41, 2, 4
s_mul_i32 s40, s41, 28672
s_add_u32 s26, s26, s40
s_mul_i32 s40, s41, 458752
s_add_u32 s27, s27, s40
s_mul_i32 s40, s41, 1792
s_add_u32 s28, s28, s40
s_mul_i32 s40, s41, 1
s_add_u32 s29, s29, s40
s_cmp_lt_u32 s25, 4
s_cbranch_scc0 TB_PV3
s_cmp_lt_u32 s29, 20
s_cbranch_scc0 TB_PV03
s_barrier
s_mov_b32 m0, 21536
s_add_u32 s40, s26, 21504
buffer_load_dwordx4 v1, s[4:7], s40 offen lds
s_mov_b32 m0, 22560
s_add_u32 s40, s26, 22528
buffer_load_dwordx4 v1, s[4:7], s40 offen lds
s_mov_b32 m0, 23584
s_add_u32 s40, s26, 23552
buffer_load_dwordx4 v1, s[4:7], s40 offen lds
s_mov_b32 m0, 24608
s_add_u32 s40, s26, 24576
buffer_load_dwordx4 v1, s[4:7], s40 offen lds
s_mov_b32 m0, 25632
s_add_u32 s40, s26, 25600
buffer_load_dwordx4 v1, s[4:7], s40 offen lds
s_mov_b32 m0, 26656
s_add_u32 s40, s26, 26624
buffer_load_dwordx4 v1, s[4:7], s40 offen lds
s_mov_b32 m0, 27680
s_add_u32 s40, s26, 27648
buffer_load_dwordx4 v1, s[4:7], s40 offen lds
s_waitcnt vmcnt(7)
v_mov_b32 v12, s88
buffer_store_dword v12, off, s[4:7], s36 sc1
s_mov_b32 s36, 0
s_waitcnt vmcnt(1)
s_branch TB_Y3
TB_PV03:
s_waitcnt vmcnt(0)
v_mov_b32 v12, s88
buffer_store_dword v12, off, s[4:7], s36 sc1
s_mov_b32 s36, 0
v_min_u32 v14, 55, v0
v_and_b32 v11, 3, v14
v_lshlrev_b32 v11, 3, v11
v_lshrrev_b32 v14, 2, v14
v_lshl_add_u32 v11, v14, 7, v11
s_mov_b32 s43, 4352
Llz_279:
buffer_load_dwordx2 v[14:15], v11, s[4:7], s43 offen sc1
s_waitcnt vmcnt(0)
v_cmp_ne_u32 vcc, s88, v14
v_cmp_ne_u32 s[40:41], s88, v15
s_or_b64 vcc, vcc, s[40:41]
s_cbranch_vccz Llzok_280
s_sleep 8
s_sub_u32 s24, s24, 1
s_cbranch_scc0 Llz_279
s_endpgm
Llzok_280:
v_min_u32 v14, 47, v0
v_and_b32 v11, 3, v14
v_lshlrev_b32 v11, 3, v11
v_lshrrev_b32 v14, 2, v14
v_lshl_add_u32 v11, v14, 7, v11
s_mov_b32 s43, 6144
Llz_281:
buffer_load_dwordx2 v[14:15], v11, s[4:7], s43 offen sc1
s_waitcnt vmcnt(0)
v_cmp_ne_u32 vcc, s88, v14
v_cmp_ne_u32 s[40:41], s88, v15
s_or_b64 vcc, vcc, s[40:41]
s_cbranch_vccz Llzok_282
s_sleep 8
s_sub_u32 s24, s24, 1
s_cbranch_scc0 Llz_281
s_endpgm
Llzok_282:
TB_PV3:
s_barrier
s_cmp_lt_u32 s29, 64
s_cbranch_scc0 Lnorows_283
s_mov_b32 m0, 21536
s_add_u32 s40, s26, 21504
buffer_load_dwordx4 v1, s[4:7], s40 offen lds
s_mov_b32 m0, 22560
s_add_u32 s40, s26, 22528
buffer_load_dwordx4 v1, s[4:7], s40 offen lds
s_mov_b32 m0, 23584
s_add_u32 s40, s26, 23552
buffer_load_dwordx4 v1, s[4:7], s40 offen lds
s_mov_b32 m0, 24608
s_add_u32 s40, s26, 24576
buffer_load_dwordx4 v1, s[4:7], s40 offen lds
s_mov_b32 m0, 25632
s_add_u32 s40, s26, 25600
buffer_load_dwordx4 v1, s[4:7], s40 offen lds
s_mov_b32 m0, 26656
s_add_u32 s40, s26, 26624
buffer_load_dwordx4 v1, s[4:7], s40 offen lds
s_mov_b32 m0, 27680
s_add_u32 s40, s26, 27648
buffer_load_dwordx4 v1, s[4:7], s40 offen lds
Lnorows_283:
s_cmp_lt_u32 s25, 8
s_cbranch_scc0 Lmine_284
s_lshl_b32 s40, s25, 7
s_add_u32 s40, s40, 139264
s_branch Lfirst_286
Lflag_285:
v_cmp_ne_u32 vcc, s88, v11
s_cbranch_vccz Lset_287
s_sleep 16
Lfirst_286:
buffer_load_dword v11, off, s[4:7], s40 sc1
s_waitcnt vmcnt(0)
s_sub_u32 s24, s24, 1
s_cbranch_scc0 Lflag_285
s_endpgm
Lset_287:
Lmine_284:
s_add_u32 s40, s30, 4096
buffer_load_dwordx4 v[44:47], v1, s[4:7], s30 offen sc1
buffer_load_dwordx4 v[48:51], v1, s[4:7], s30 offen offset:1024 sc1
buffer_load_dwordx4 v[52:55], v1, s[4:7], s30 offen offset:2048 sc1
buffer_load_dwordx4 v[56:59], v1, s[4:7], s30 offen offset:3072 sc1
buffer_load_dwordx4 v[60:63], v1, s[4:7], s40 offen sc1
buffer_load_dwordx4 v[64:67], v1, s[4:7], s40 offen offset:1024 sc1
buffer_load_dwordx4 v[68:71], v1, s[4:7], s40 offen offset:2048 sc1
buffer_load_dwordx4 v[72:75], v1, s[4:7], s40 offen offset:3072 sc1
buffer_load_dwordx2 v[14:15], v8, s[8:11], s34 offen
ds_read_b128 v[92:95], v2 offset:12288
ds_read_b128 v[96:99], v2 offset:13312
ds_read_b128 v[100:103], v2
ds_read_b128 v[104:107], v2 offset:1024
ds_read_b128 v[108:111], v2 offset:2048
ds_read_b128 v[112:115], v2 offset:3072
v_mov_b32 v116, 0
v_mov_b32 v117, 0
v_mov_b32 v118, 0
v_mov_b32 v119, 0
v_mov_b32 v120, 0
v_mov_b32 v121, 0
v_mov_b32 v122, 0
v_mov_b32 v123, 0
v_mov_b32 v124, 0
v_mov_b32 v125, 0
v_mov_b32 v126, 0
v_mov_b32 v127, 0
v_mov_b32 v128, 0
v_mov_b32 v129, 0
v_mov_b32 v130, 0
v_mov_b32 v131, 0
v_mov_b32 v132, 0
v_mov_b32 v133, 0
v_mov_b32 v134, 0
v_mov_b32 v135, 0
v_mov_b32 v136, 0
v_mov_b32 v137, 0
v_mov_b32 v138, 0
v_mov_b32 v139, 0
v_mov_b32 v140, 0
v_mov_b32 v141, 0
v_mov_b32 v142, 0
v_mov_b32 v143, 0
v_mov_b32 v144, 0
v_mov_b32 v145, 0
v_mov_b32 v146, 0
v_mov_b32 v147, 0
Lspin_288:
buffer_load_dwordx4 v[40:43], v1, s[4:7], s31 offen sc1
s_sub_u32 s24, s24, 1
s_cbranch_scc1 CODE_END
s_waitcnt vmcnt(0)
v_max3_u32 v11, v40, v41, v42
v_max_u32 v11, v11, v43
v_cmp_eq_u32 vcc, -1, v11
s_cbranch_vccz Lspin_288x
s_cmp_ge_u32 s25, 58
s_cbranch_scc1 Lspin_288
s_sleep 8
s_branch Lspin_288
Lspin_288x:
s_cmp_eq_u32 s36, 0
s_cbranch_scc1 Lpaid_289
v_mov_b32 v12, s88
buffer_store_dword v12, off, s[4:7], s36 sc1
s_mov_b32 s36, 0
Lpaid_289:
ds_write_b128 v1, v[40:43] offset:34944
s_waitcnt lgkmcnt(0)
s_barrier
ds_read_b128 v[16:19], v1 offset:28800
ds_read_b128 v[20:23], v1 offset:29824
ds_read_b128 v[24:27], v1 offset:30848
ds_read_b128 v[28:31], v1 offset:31872
ds_read_b128 v[32:35], v1 offset:32896
ds_read_b128 v[36:39], v1 offset:33920
v_smfmac_f32_16x16x64_bf16 v[116:119], v[40:43], a[48:55], v10
v_smfmac_f32_16x16x64_bf16 v[120:123], v[40:43], a[104:111], v10
v_smfmac_f32_16x16x64_bf16 v[124:127], v[40:43], a[160:167], v10
v_smfmac_f32_16x16x64_bf16 v[128:131], v[40:43], v[92:99], v10
s_waitcnt lgkmcnt(5)
v_smfmac_f32_16x16x64_bf16 v[116:119], v[16:19], a[0:7], v10
ds_read_b128 v[92:95], v2 offset:4096
v_smfmac_f32_16x16x64_bf16 v[120:123], v[16:19], a[56:63], v10
ds_read_b128 v[96:99], v2 offset:5120
v_smfmac_f32_16x16x64_bf16 v[124:127], v[16:19], a[112:119], v10
v_smfmac_f32_16x16x64_bf16 v[128:131], v[16:19], v[100:107], v10
s_waitcnt lgkmcnt(6)
v_smfmac_f32_16x16x64_bf16 v[116:119], v[20:23], a[8:15], v10
ds_read_b128 v[100:103], v2 offset:6144
v_smfmac_f32_16x16x64_bf16 v[120:123], v[20:23], a[64:71], v10
ds_read_b128 v[104:107], v2 offset:7168
v_smfmac_f32_16x16x64_bf16 v[124:127], v[20:23], a[120:127], v10
v_smfmac_f32_16x16x64_bf16 v[128:131], v[20:23], v[108:115], v10
s_waitcnt lgkmcnt(7)
v_smfmac_f32_16x16x64_bf16 v[116:119], v[24:27], a[16:23], v10
ds_read_b128 v[108:111], v2 offset:8192
v_smfmac_f32_16x16x64_bf16 v[120:123], v[24:27], a[72:79], v10
ds_read_b128 v[112:115], v2 offset:9216
v_smfmac_f32_16x16x64_bf16 v[124:127], v[24:27], a[128:135], v10
s_waitcnt lgkmcnt(4)
v_smfmac_f32_16x16x64_bf16 v[128:131], v[24:27], v[92:99], v10
v_smfmac_f32_16x16x64_bf16 v[116:119], v[28:31], a[24:31], v10
ds_read_b128 v[92:95], v2 offset:10240
v_smfmac_f32_16x16x64_bf16 v[120:123], v[28:31], a[80:87], v10
ds_read_b128 v[96:99], v2 offset:11264
v_smfmac_f32_16x16x64_bf16 v[124:127], v[28:31], a[136:143], v10
s_waitcnt lgkmcnt(4)
v_smfmac_f32_16x16x64_bf16 v[128:131], v[28:31], v[100:107], v10
v_smfmac_f32_16x16x64_bf16 v[116:119], v[32:35], a[32:39], v10
ds_read_b128 v[100:103], v2 offset:26624
v_smfmac_f32_16x16x64_bf16 v[120:123], v[32:35], a[88:95], v10
ds_read_b128 v[104:107], v2 offset:27648
v_smfmac_f32_16x16x64_bf16 v[124:127], v[32:35], a[144:151], v10
s_waitcnt lgkmcnt(4)
v_smfmac_f32_16x16x64_bf16 v[128:131], v[32:35], v[108:115], v10
v_smfmac_f32_16x16x64_bf16 v[116:119], v[36:39], a[40:47], v10
ds_read_b128 v[108:111], v2 offset:14336
v_smfmac_f32_16x16x64_bf16 v[120:123], v[36:39], a[96:103], v10
ds_read_b128 v[112:115], v2 offset:15360
v_smfmac_f32_16x16x64_bf16 v[124:127], v[36:39], a[152:159], v10
s_waitcnt lgkmcnt(4)
v_smfmac_f32_16x16x64_bf16 v[128:131], v[36:39], v[92:99], v10
v_smfmac_f32_16x16x64_bf16 v[132:135], v[40:43], a[216:223], v10
ds_read_b128 v[92:95], v2 offset:16384
v_smfmac_f32_16x16x64_bf16 v[136:139], v[40:43], v[192:199], v10
ds_read_b128 v[96:99], v2 offset:17408
v_smfmac_f32_16x16x64_bf16 v[140:143], v[40:43], v[248:255], v10
v_cvt_pk_bf16_f32 v76, v116, v117
s_waitcnt lgkmcnt(4)
v_smfmac_f32_16x16x64_bf16 v[144:147], v[40:43], v[100:107], v10
v_cvt_pk_bf16_f32 v77, v118, v119
v_smfmac_f32_16x16x64_bf16 v[132:135], v[16:19], a[168:175], v10
ds_read_b128 v[100:103], v2 offset:18432
v_smfmac_f32_16x16x64_bf16 v[136:139], v[16:19], a[224:231], v10
ds_read_b128 v[104:107], v2 offset:19456
v_smfmac_f32_16x16x64_bf16 v[140:143], v[16:19], v[200:207], v10
v_cvt_pk_bf16_f32 v84, v120, v121
s_waitcnt lgkmcnt(4)
v_smfmac_f32_16x16x64_bf16 v[144:147], v[16:19], v[108:115], v10
v_cvt_pk_bf16_f32 v85, v122, v123
v_smfmac_f32_16x16x64_bf16 v[132:135], v[20:23], a[176:183], v10
ds_read_b128 v[108:111], v2 offset:20480
v_smfmac_f32_16x16x64_bf16 v[136:139], v[20:23], a[232:239], v10
ds_read_b128 v[112:115], v2 offset:21504
v_smfmac_f32_16x16x64_bf16 v[140:143], v[20:23], v[208:215], v10
v_cvt_pk_bf16_f32 v78, v124, v125
s_waitcnt lgkmcnt(4)
v_smfmac_f32_16x16x64_bf16 v[144:147], v[20:23], v[92:99], v10
v_cvt_pk_bf16_f32 v79, v126, v127
v_smfmac_f32_16x16x64_bf16 v[132:135], v[24:27], a[184:191], v10
ds_read_b128 v[92:95], v2 offset:22528
v_smfmac_f32_16x16x64_bf16 v[136:139], v[24:27], a[240:247], v10
ds_read_b128 v[96:99], v2 offset:23552
v_smfmac_f32_16x16x64_bf16 v[140:143], v[24:27], v[216:223], v10
v_cvt_pk_bf16_f32 v82, v128, v129
s_waitcnt lgkmcnt(4)
v_smfmac_f32_16x16x64_bf16 v[144:147], v[24:27], v[100:107], v10
v_cvt_pk_bf16_f32 v83, v130, v131
v_smfmac_f32_16x16x64_bf16 v[132:135], v[28:31], a[192:199], v10
ds_read_b128 v[100:103], v2 offset:24576
v_smfmac_f32_16x16x64_bf16 v[136:139], v[28:31], a[248:255], v10
ds_read_b128 v[104:107], v2 offset:25600
v_smfmac_f32_16x16x64_bf16 v[140:143], v[28:31], v[224:231], v10
s_waitcnt lgkmcnt(4)
v_smfmac_f32_16x16x64_bf16 v[144:147], v[28:31], v[108:115], v10
v_smfmac_f32_16x16x64_bf16 v[132:135], v[32:35], a[200:207], v10
v_smfmac_f32_16x16x64_bf16 v[136:139], v[32:35], v[176:183], v10
v_smfmac_f32_16x16x64_bf16 v[140:143], v[32:35], v[232:239], v10
s_waitcnt lgkmcnt(2)
v_smfmac_f32_16x16x64_bf16 v[144:147], v[32:35], v[92:99], v10
v_smfmac_f32_16x16x64_bf16 v[132:135], v[36:39], a[208:215], v10
v_smfmac_f32_16x16x64_bf16 v[136:139], v[36:39], v[184:191], v10
v_smfmac_f32_16x16x64_bf16 v[140:143], v[36:39], v[240:247], v10
s_waitcnt lgkmcnt(0)
v_smfmac_f32_16x16x64_bf16 v[144:147], v[36:39], v[100:107], v10
s_nop 2
v_cvt_pk_bf16_f32 v86, v132, v133
v_cvt_pk_bf16_f32 v87, v134, v135
v_cvt_pk_bf16_f32 v80, v136, v137
v_cvt_pk_bf16_f32 v81, v138, v139
v_cvt_pk_bf16_f32 v88, v140, v141
v_cvt_pk_bf16_f32 v89, v142, v143
v_cvt_pk_bf16_f32 v90, v144, v145
v_cvt_pk_bf16_f32 v91, v146, v147
s_barrier
s_add_u32 s40, s32, 4096
Lpoll_290:
buffer_load_dwordx4 v[16:19], v1, s[4:7], s32 offen sc1
buffer_load_dwordx4 v[20:23], v1, s[4:7], s32 offen offset:1024 sc1
buffer_load_dwordx4 v[24:27], v1, s[4:7], s32 offen offset:2048 sc1
buffer_load_dwordx4 v[28:31], v1, s[4:7], s32 offen offset:3072 sc1
buffer_load_dwordx4 v[32:35], v1, s[4:7], s40 offen sc1
buffer_load_dwordx4 v[36:39], v1, s[4:7], s40 offen offset:1024 sc1
buffer_load_dwordx4 v[40:43], v1, s[4:7], s40 offen offset:2048 sc1
buffer_load_dwordx4 v[92:95], v1, s[4:7], s40 offen offset:3072 sc1
buffer_load_dwordx4 v[96:99], v4, s[4:7], s33 offen sc1
buffer_load_dwordx4 v[100:103], v4, s[4:7], s33 offen offset:512 sc1
buffer_load_dwordx4 v[104:107], v4, s[4:7], s33 offen offset:1024 sc1
buffer_load_dwordx4 v[108:111], v4, s[4:7], s33 offen offset:1536 sc1
s_waitcnt vmcnt(0)
v_max3_u32 v11, v16, v17, v18
v_max3_u32 v11, v11, v19, v20
v_max3_u32 v11, v11, v21, v22
v_max3_u32 v11, v11, v23, v24
v_max3_u32 v11, v11, v25, v26
v_max3_u32 v11, v11, v27, v28
v_max3_u32 v11, v11, v29, v30
v_max3_u32 v11, v11, v31, v32
v_max3_u32 v11, v11, v33, v34
v_max3_u32 v11, v11, v35, v36
v_max3_u32 v11, v11, v37, v38
v_max3_u32 v11, v11, v39, v40
v_max3_u32 v11, v11, v41, v42
v_max3_u32 v11, v11, v43, v92
v_max3_u32 v11, v11, v93, v94
v_max3_u32 v11, v11, v95, v96
v_max3_u32 v11, v11, v97, v98
v_max3_u32 v11, v11, v99, v100
v_max3_u32 v11, v11, v101, v102
v_max3_u32 v11, v11, v103, v104
v_max3_u32 v11, v11, v105, v106
v_max3_u32 v11, v11, v107, v108
v_max3_u32 v11, v11, v109, v110
v_max_u32 v11, v11, v111
v_cmp_eq_u32 vcc, -1, v11
s_cbranch_vccz Lgot_291
s_sub_u32 s24, s24, 1
s_cbranch_scc0 Lpoll_290
s_endpgm
Lgot_291:
v_mfma_f32_16x16x32_bf16 v[116:119], v[16:19], v[44:47], 0
v_mfma_f32_16x16x32_bf16 v[120:123], v[16:19], v[52:55], 0
v_mfma_f32_16x16x32_bf16 v[124:127], v[20:23], v[44:47], 0
v_mfma_f32_16x16x32_bf16 v[128:131], v[20:23], v[52:55], 0
v_mfma_f32_16x16x32_bf16 v[116:119], v[24:27], v[48:51], v[116:119]
v_mfma_f32_16x16x32_bf16 v[120:123], v[24:27], v[56:59], v[120:123]
v_mfma_f32_16x16x32_bf16 v[124:127], v[28:31], v[48:51], v[124:127]
v_mfma_f32_16x16x32_bf16 v[128:131], v[28:31], v[56:59], v[128:131]
v_mfma_f32_16x16x32_bf16 v[116:119], v[32:35], v[60:63], v[116:119]
v_mfma_f32_16x16x32_bf16 v[120:123], v[32:35], v[68:71], v[120:123]
v_mfma_f32_16x16x32_bf16 v[124:127], v[36:39], v[60:63], v[124:127]
v_mfma_f32_16x16x32_bf16 v[128:131], v[36:39], v[68:71], v[128:131]
v_mfma_f32_16x16x32_bf16 v[116:119], v[40:43], v[64:67], v[116:119]
v_mfma_f32_16x16x32_bf16 v[120:123], v[40:43], v[72:75], v[120:123]
v_mfma_f32_16x16x32_bf16 v[124:127], v[92:95], v[64:67], v[124:127]
v_mfma_f32_16x16x32_bf16 v[128:131], v[92:95], v[72:75], v[128:131]
v_mfma_f32_16x16x32_bf16 v[116:119], v[96:99], v[76:79], v[116:119]
v_mfma_f32_16x16x32_bf16 v[120:123], v[96:99], v[84:87], v[120:123]
v_mfma_f32_16x16x32_bf16 v[124:127], v[100:103], v[76:79], v[124:127]
v_mfma_f32_16x16x32_bf16 v[128:131], v[100:103], v[84:87], v[128:131]
v_mfma_f32_16x16x32_bf16 v[116:119], v[104:107], v[80:83], v[116:119]
v_mfma_f32_16x16x32_bf16 v[120:123], v[104:107], v[88:91], v[120:123]
v_mfma_f32_16x16x32_bf16 v[124:127], v[108:111], v[80:83], v[124:127]
v_mfma_f32_16x16x32_bf16 v[128:131], v[108:111], v[88:91], v[128:131]
s_nop 6
ds_write2_b32 v5, v116, v120 offset0:0 offset1:16
ds_write2_b32 v5, v117, v121 offset0:36 offset1:52
ds_write2_b32 v5, v118, v122 offset0:72 offset1:88
ds_write2_b32 v5, v119, v123 offset0:108 offset1:124
ds_write2_b32 v6, v124, v128 offset0:0 offset1:16
ds_write2_b32 v6, v125, v129 offset0:36 offset1:52
ds_write2_b32 v6, v126, v130 offset0:72 offset1:88
ds_write2_b32 v6, v127, v131 offset0:108 offset1:124
s_waitcnt lgkmcnt(0)
s_barrier
ds_read_b128 v[116:119], v7
ds_read_b128 v[120:123], v7 offset:4608
ds_read_b128 v[124:127], v7 offset:9216
ds_read_b128 v[128:131], v7 offset:13824
v_lshlrev_b32 v132, 16, v14
v_and_b32 v133, 0xffff0000, v14
v_lshlrev_b32 v134, 16, v15
v_and_b32 v135, 0xffff0000, v15
s_waitcnt lgkmcnt(0)
v_pk_add_f32 v[116:117], v[116:117], v[120:121]
v_pk_add_f32 v[124:125], v[124:125], v[128:129]
v_pk_add_f32 v[116:117], v[116:117], v[124:125]
v_cvt_pk_bf16_f32 v117, v116, v117
v_lshlrev_b32 v116, 16, v117
v_and_b32 v117, 0xffff0000, v117
v_pk_add_f32 v[116:117], v[116:117], v[132:133]
v_cvt_pk_bf16_f32 v136, v116, v117
v_min_u32 v136, -2, v136
v_pk_add_f32 v[118:119], v[118:119], v[122:123]
v_pk_add_f32 v[126:127], v[126:127], v[130:131]
v_pk_add_f32 v[118:119], v[118:119], v[126:127]
v_cvt_pk_bf16_f32 v119, v118, v119
v_lshlrev_b32 v118, 16, v119
v_and_b32 v119, 0xffff0000, v119
v_pk_add_f32 v[118:119], v[118:119], v[134:135]
v_cvt_pk_bf16_f32 v137, v118, v119
v_min_u32 v137, -2, v137
buffer_store_dwordx2 v[136:137], v9, s[4:7], s35 offen sc1
s_add_u32 s30, s30, 1835008
s_add_u32 s31, s31, 28672
s_add_u32 s32, s32, 163840
s_add_u32 s33, s33, 163840
s_add_u32 s34, s34, 114688
s_add_u32 s35, s35, 114688
s_add_u32 s25, s25, 4
s_cmp_lt_u32 s25, 64
s_cbranch_scc1 TB_TOP3
s_endpgm
F1_W0:
s_load_dwordx2 s[8:9], s[0:1], 64
s_mov_b32 s10, 1605632
s_mov_b32 s11, 0x00020000
s_load_dwordx2 s[16:17], s[0:1], 72
s_mov_b32 s18, 3584
s_mov_b32 s19, 0x00020000
v_lshlrev_b32 v1, 4, v0
v_lshrrev_b32 v5, 2, v0
v_mul_u32_u24 v2, 3584, v5
v_and_b32 v6, 3, v0
v_lshl_add_u32 v2, v6, 4, v2
v_lshrrev_b32 v3, 4, v0
v_lshlrev_b32 v4, 4, v3
v_lshlrev_b32 v3, 3, v3
v_and_b32 v5, 3, v5
v_add_u32 v3, v3, v5
v_lshlrev_b32 v3, 6, v3
v_lshl_add_u32 v3, v6, 4, v3
v_add_u32 v3, 32768, v3
s_lshl_b32 s40, s22, 8
s_add_u32 s40, s40, 0
s_waitcnt lgkmcnt(0)
buffer_load_dwordx4 v[32:35], v4, s[16:19], s40 offen
s_mov_b32 m0, 32768
s_add_u32 s41, s40, 0
buffer_load_dwordx4 v2, s[8:11], s41 offen lds
s_mov_b32 m0, 33792
s_add_u32 s41, s40, 57344
buffer_load_dwordx4 v2, s[8:11], s41 offen lds
s_mov_b32 m0, 34816
s_add_u32 s41, s40, 114688
buffer_load_dwordx4 v2, s[8:11], s41 offen lds
s_mov_b32 m0, 35840
s_add_u32 s41, s40, 172032
buffer_load_dwordx4 v2, s[8:11], s41 offen lds
s_mov_b32 m0, 36864
s_add_u32 s41, s40, 229376
buffer_load_dwordx4 v2, s[8:11], s41 offen lds
s_mov_b32 m0, 37888
s_add_u32 s41, s40, 286720
buffer_load_dwordx4 v2, s[8:11], s41 offen lds
s_mov_b32 m0, 38912
s_add_u32 s41, s40, 344064
buffer_load_dwordx4 v2, s[8:11], s41 offen lds
s_mov_b32 m0, 39936
s_add_u32 s41, s40, 401408
buffer_load_dwordx4 v2, s[8:11], s41 offen lds
s_mov_b32 m0, 40960
s_add_u32 s41, s40, 458752
buffer_load_dwordx4 v2, s[8:11], s41 offen lds
s_mov_b32 m0, 41984
s_add_u32 s41, s40, 516096
buffer_load_dwordx4 v2, s[8:11], s41 offen lds
s_mov_b32 m0, 43008
s_add_u32 s41, s40, 573440
buffer_load_dwordx4 v2, s[8:11], s41 offen lds
s_mov_b32 m0, 44032
s_add_u32 s41, s40, 630784
buffer_load_dwordx4 v2, s[8:11], s41 offen lds
s_mov_b32 m0, 45056
s_add_u32 s41, s40, 688128
buffer_load_dwordx4 v2, s[8:11], s41 offen lds
s_mov_b32 m0, 46080
s_add_u32 s41, s40, 745472
buffer_load_dwordx4 v2, s[8:11], s41 offen lds
s_mov_b32 m0, 47104
s_add_u32 s41, s40, 802816
buffer_load_dwordx4 v2, s[8:11], s41 offen lds
s_mov_b32 m0, 48128
s_add_u32 s41, s40, 860160
buffer_load_dwordx4 v2, s[8:11], s41 offen lds
s_mov_b32 m0, 49152
s_add_u32 s41, s40, 917504
buffer_load_dwordx4 v2, s[8:11], s41 offen lds
s_mov_b32 m0, 50176
s_add_u32 s41, s40, 974848
buffer_load_dwordx4 v2, s[8:11], s41 offen lds
s_mov_b32 m0, 51200
s_add_u32 s41, s40, 1032192
buffer_load_dwordx4 v2, s[8:11], s41 offen lds
s_mov_b32 m0, 52224
s_add_u32 s41, s40, 1089536
buffer_load_dwordx4 v2, s[8:11], s41 offen lds
s_mov_b32 m0, 53248
s_add_u32 s41, s40, 1146880
buffer_load_dwordx4 v2, s[8:11], s41 offen lds
s_mov_b32 m0, 54272
s_add_u32 s41, s40, 1204224
buffer_load_dwordx4 v2, s[8:11], s41 offen lds
s_mov_b32 m0, 55296
s_add_u32 s41, s40, 1261568
buffer_load_dwordx4 v2, s[8:11], s41 offen lds
s_mov_b32 m0, 56320
s_add_u32 s41, s40, 1318912
buffer_load_dwordx4 v2, s[8:11], s41 offen lds
s_mov_b32 m0, 57344
s_add_u32 s41, s40, 1376256
buffer_load_dwordx4 v2, s[8:11], s41 offen lds
s_mov_b32 m0, 58368
s_add_u32 s41, s40, 1433600
buffer_load_dwordx4 v2, s[8:11], s41 offen lds
s_mov_b32 m0, 59392
s_add_u32 s41, s40, 1490944
buffer_load_dwordx4 v2, s[8:11], s41 offen lds
s_mov_b32 m0, 60416
s_add_u32 s41, s40, 1548288
buffer_load_dwordx4 v2, s[8:11], s41 offen lds
v_and_b32 v4, 15, v0
v_lshlrev_b32 v4, 5, v4
v_add_u32 v4, 14336, v4
v_bfe_u32 v5, v0, 2, 2
v_lshrrev_b32 v6, 4, v0
v_cmp_eq_u32 vcc, v5, v6
v_add_u32 v5, 0, v4
v_lshlrev_b32 v14, 3, v0
v_add_u32 v14, 14848, v14
v_cndmask_b32 v14, v14, v5, vcc
v_and_b32 v5, 1, v0
v_cmp_ne_u32 s[32:33], 0, v5
v_and_b32 v5, 2, v0
v_cmp_ne_u32 s[34:35], 0, v5
s_mul_i32 s26, s21, 14336
s_add_u32 s26, s26, 4370432
s_mul_i32 s27, s21, 57344
s_lshl_b32 s41, s22, 12
s_add_u32 s27, s27, s41
s_add_u32 s27, s27, 22724608
s_mul_i32 s28, s21, 224
s_lshl_b32 s41, s22, 4
s_add_u32 s28, s28, s41
s_add_u32 s28, s28, 143360
s_mov_b32 s29, 0xc0135761
s_mov_b32 s30, 0xbdd2d3e8
s_mov_b32 s25, s21
s_waitcnt vmcnt(0)
v_lshlrev_b32 v16, 16, v32
v_and_b32 v17, 0xffff0000, v32
v_lshlrev_b32 v18, 16, v33
v_and_b32 v19, 0xffff0000, v33
v_lshlrev_b32 v20, 16, v34
v_and_b32 v21, 0xffff0000, v34
v_lshlrev_b32 v22, 16, v35
v_and_b32 v23, 0xffff0000, v35
v_mov_b32 v112, 0x3f803f80
v_mov_b32 v113, 0x3f803f80
v_mov_b32 v114, 0x3f803f80
v_mov_b32 v115, 0x3f803f80
ds_read_b64_tr_b16 a[0:1], v3
ds_read_b64_tr_b16 a[2:3], v3 offset:256
ds_read_b64_tr_b16 a[4:5], v3 offset:8
ds_read_b64_tr_b16 a[6:7], v3 offset:264
ds_read_b64_tr_b16 a[8:9], v3 offset:2048
ds_read_b64_tr_b16 a[10:11], v3 offset:2304
ds_read_b64_tr_b16 a[12:13], v3 offset:2056
ds_read_b64_tr_b16 a[14:15], v3 offset:2312
ds_read_b64_tr_b16 a[16:17], v3 offset:4096
ds_read_b64_tr_b16 a[18:19], v3 offset:4352
ds_read_b64_tr_b16 a[20:21], v3 offset:4104
ds_read_b64_tr_b16 a[22:23], v3 offset:4360
s_waitcnt lgkmcnt(0)
ds_read_b64_tr_b16 a[24:25], v3 offset:6144
ds_read_b64_tr_b16 a[26:27], v3 offset:6400
ds_read_b64_tr_b16 a[28:29], v3 offset:6152
ds_read_b64_tr_b16 a[30:31], v3 offset:6408
ds_read_b64_tr_b16 a[32:33], v3 offset:8192
ds_read_b64_tr_b16 a[34:35], v3 offset:8448
ds_read_b64_tr_b16 a[36:37], v3 offset:8200
ds_read_b64_tr_b16 a[38:39], v3 offset:8456
ds_read_b64_tr_b16 a[40:41], v3 offset:10240
ds_read_b64_tr_b16 a[42:43], v3 offset:10496
ds_read_b64_tr_b16 a[44:45], v3 offset:10248
ds_read_b64_tr_b16 a[46:47], v3 offset:10504
s_waitcnt lgkmcnt(0)
ds_read_b64_tr_b16 a[48:49], v3 offset:12288
ds_read_b64_tr_b16 a[50:51], v3 offset:12544
ds_read_b64_tr_b16 a[52:53], v3 offset:12296
ds_read_b64_tr_b16 a[54:55], v3 offset:12552
ds_read_b64_tr_b16 a[56:57], v3 offset:14336
ds_read_b64_tr_b16 a[58:59], v3 offset:14592
ds_read_b64_tr_b16 a[60:61], v3 offset:14344
ds_read_b64_tr_b16 a[62:63], v3 offset:14600
ds_read_b64_tr_b16 a[64:65], v3 offset:16384
ds_read_b64_tr_b16 a[66:67], v3 offset:16640
ds_read_b64_tr_b16 a[68:69], v3 offset:16392
ds_read_b64_tr_b16 a[70:71], v3 offset:16648
s_waitcnt lgkmcnt(0)
ds_read_b64_tr_b16 a[72:73], v3 offset:18432
ds_read_b64_tr_b16 a[74:75], v3 offset:18688
ds_read_b64_tr_b16 a[76:77], v3 offset:18440
ds_read_b64_tr_b16 a[78:79], v3 offset:18696
ds_read_b64_tr_b16 a[80:81], v3 offset:20480
ds_read_b64_tr_b16 a[82:83], v3 offset:20736
ds_read_b64_tr_b16 a[84:85], v3 offset:20488
ds_read_b64_tr_b16 a[86:87], v3 offset:20744
ds_read_b64_tr_b16 a[88:89], v3 offset:22528
ds_read_b64_tr_b16 a[90:91], v3 offset:22784
ds_read_b64_tr_b16 a[92:93], v3 offset:22536
ds_read_b64_tr_b16 a[94:95], v3 offset:22792
s_waitcnt lgkmcnt(0)
ds_read_b64_tr_b16 a[96:97], v3 offset:24576
ds_read_b64_tr_b16 a[98:99], v3 offset:24832
ds_read_b64_tr_b16 a[100:101], v3 offset:24584
ds_read_b64_tr_b16 a[102:103], v3 offset:24840
ds_read_b64_tr_b16 a[104:105], v3 offset:26624
ds_read_b64_tr_b16 a[106:107], v3 offset:26880
ds_read_b64_tr_b16 a[108:109], v3 offset:26632
ds_read_b64_tr_b16 a[110:111], v3 offset:26888
s_waitcnt lgkmcnt(0)
v_mfma_f32_16x16x32_bf16 v[24:27], a[0:3], v[112:115], 0
v_mfma_f32_16x16x32_bf16 v[28:31], a[4:7], v[112:115], 0
v_mfma_f32_16x16x32_bf16 v[24:27], a[8:11], v[112:115], v[24:27]
v_mfma_f32_16x16x32_bf16 v[28:31], a[12:15], v[112:115], v[28:31]
v_mfma_f32_16x16x32_bf16 v[24:27], a[16:19], v[112:115], v[24:27]
v_mfma_f32_16x16x32_bf16 v[28:31], a[20:23], v[112:115], v[28:31]
v_mfma_f32_16x16x32_bf16 v[24:27], a[24:27], v[112:115], v[24:27]
v_mfma_f32_16x16x32_bf16 v[28:31], a[28:31], v[112:115], v[28:31]
v_mfma_f32_16x16x32_bf16 v[24:27], a[32:35], v[112:115], v[24:27]
v_mfma_f32_16x16x32_bf16 v[28:31], a[36:39], v[112:115], v[28:31]
v_mfma_f32_16x16x32_bf16 v[24:27], a[40:43], v[112:115], v[24:27]
v_mfma_f32_16x16x32_bf16 v[28:31], a[44:47], v[112:115], v[28:31]
v_mfma_f32_16x16x32_bf16 v[24:27], a[48:51], v[112:115], v[24:27]
v_mfma_f32_16x16x32_bf16 v[28:31], a[52:55], v[112:115], v[28:31]
v_mfma_f32_16x16x32_bf16 v[24:27], a[56:59], v[112:115], v[24:27]
v_mfma_f32_16x16x32_bf16 v[28:31], a[60:63], v[112:115], v[28:31]
v_mfma_f32_16x16x32_bf16 v[24:27], a[64:67], v[112:115], v[24:27]
v_mfma_f32_16x16x32_bf16 v[28:31], a[68:71], v[112:115], v[28:31]
v_mfma_f32_16x16x32_bf16 v[24:27], a[72:75], v[112:115], v[24:27]
v_mfma_f32_16x16x32_bf16 v[28:31], a[76:79], v[112:115], v[28:31]
v_mfma_f32_16x16x32_bf16 v[24:27], a[80:83], v[112:115], v[24:27]
v_mfma_f32_16x16x32_bf16 v[28:31], a[84:87], v[112:115], v[28:31]
v_mfma_f32_16x16x32_bf16 v[24:27], a[88:91], v[112:115], v[24:27]
v_mfma_f32_16x16x32_bf16 v[28:31], a[92:95], v[112:115], v[28:31]
v_mfma_f32_16x16x32_bf16 v[24:27], a[96:99], v[112:115], v[24:27]
v_mfma_f32_16x16x32_bf16 v[28:31], a[100:103], v[112:115], v[28:31]
v_mfma_f32_16x16x32_bf16 v[24:27], a[104:107], v[112:115], v[24:27]
v_mfma_f32_16x16x32_bf16 v[28:31], a[108:111], v[112:115], v[28:31]
v_min_u32 v12, 47, v0
v_and_b32 v5, 3, v12
v_lshlrev_b32 v5, 3, v5
v_lshrrev_b32 v12, 2, v12
v_lshl_add_u32 v5, v12, 7, v5
s_mov_b32 s43, 6144
Llz_292:
buffer_load_dwordx2 v[12:13], v5, s[4:7], s43 offen sc1
s_waitcnt vmcnt(0)
v_cmp_ne_u32 vcc, s88, v12
v_cmp_ne_u32 s[40:41], s88, v13
s_or_b64 vcc, vcc, s[40:41]
s_cbranch_vccz Llzok_293
s_sleep 8
s_sub_u32 s24, s24, 1
s_cbranch_scc0 Llz_292
s_endpgm
Llzok_293:
F1_JOB0:
s_barrier
buffer_load_dwordx4 v[32:35], v1, s[4:7], s26 offen sc1
buffer_load_dwordx4 v[36:39], v1, s[4:7], s26 offen offset:1024 sc1
buffer_load_dwordx4 v[40:43], v1, s[4:7], s26 offen offset:2048 sc1
buffer_load_dwordx4 v[44:47], v1, s[4:7], s26 offen offset:3072 sc1
s_sleep 6
Lspin_294:
buffer_load_dwordx4 v[32:35], v1, s[4:7], s26 offen sc1
buffer_load_dwordx4 v[36:39], v1, s[4:7], s26 offen offset:1024 sc1
buffer_load_dwordx4 v[40:43], v1, s[4:7], s26 offen offset:2048 sc1
buffer_load_dwordx4 v[44:47], v1, s[4:7], s26 offen offset:3072 sc1
s_sub_u32 s24, s24, 1
s_cbranch_scc1 CODE_END
s_waitcnt vmcnt(4)
v_max3_u32 v5, v32, v33, v34
v_max3_u32 v5, v5, v35, v36
v_max3_u32 v5, v5, v37, v38
v_max3_u32 v5, v5, v39, v40
v_max3_u32 v5, v5, v41, v42
v_max3_u32 v5, v5, v43, v44
v_max3_u32 v5, v5, v45, v46
v_max_u32 v5, v5, v47
v_cmp_eq_u32 vcc, -1, v5
s_cbranch_vccz Lspin_294x
s_cmp_ge_u32 s25, 120
s_cbranch_scc1 Lspin_294
s_sleep 8
s_branch Lspin_294
Lspin_294x:
v_mfma_f32_16x16x32_bf16 v[48:51], v[32:35], v[32:35], 0
ds_write_b128 v1, v[32:35]
v_mfma_f32_16x16x32_bf16 v[48:51], v[36:39], v[36:39], v[48:51]
ds_write_b128 v1, v[36:39] offset:1024
v_mfma_f32_16x16x32_bf16 v[48:51], v[40:43], v[40:43], v[48:51]
ds_write_b128 v1, v[40:43] offset:2048
v_mfma_f32_16x16x32_bf16 v[48:51], v[44:47], v[44:47], v[48:51]
ds_write_b128 v1, v[44:47] offset:3072
v_mfma_f32_16x16x32_bf16 v[52:55], v[112:115], v[32:35], 0
v_mfma_f32_16x16x32_bf16 v[52:55], v[112:115], v[36:39], v[52:55]
v_mfma_f32_16x16x32_bf16 v[52:55], v[112:115], v[40:43], v[52:55]
v_mfma_f32_16x16x32_bf16 v[52:55], v[112:115], v[44:47], v[52:55]
v_cndmask_b32 v48, v48, v49, s[32:33]
v_cndmask_b32 v50, v50, v51, s[32:33]
s_nop 5
v_cndmask_b32 v53, v48, v50, s[34:35]
ds_write_b64 v14, v[52:53]
s_waitcnt lgkmcnt(0)
s_barrier
ds_read_b128 v[80:83], v1
ds_read_b128 v[84:87], v1 offset:1024
ds_read_b128 v[88:91], v1 offset:2048
ds_read_b128 v[104:107], v4
ds_read_b128 v[108:111], v4 offset:16
s_waitcnt lgkmcnt(4)
v_mfma_f32_16x16x32_bf16 v[96:99], a[0:3], v[80:83], 0
ds_read_b128 v[92:95], v1 offset:3072
v_mfma_f32_16x16x32_bf16 v[100:103], a[4:7], v[80:83], 0
s_waitcnt lgkmcnt(4)
v_mfma_f32_16x16x32_bf16 v[96:99], a[8:11], v[84:87], v[96:99]
ds_read_b128 v[80:83], v1 offset:4096
v_mfma_f32_16x16x32_bf16 v[100:103], a[12:15], v[84:87], v[100:103]
s_waitcnt lgkmcnt(4)
v_mfma_f32_16x16x32_bf16 v[96:99], a[16:19], v[88:91], v[96:99]
ds_read_b128 v[84:87], v1 offset:5120
v_mfma_f32_16x16x32_bf16 v[100:103], a[20:23], v[88:91], v[100:103]
s_waitcnt lgkmcnt(2)
v_mfma_f32_16x16x32_bf16 v[96:99], a[24:27], v[92:95], v[96:99]
ds_read_b128 v[88:91], v1 offset:6144
v_add_f32 v7, v104, v106
v_add_f32 v8, v105, v107
v_mfma_f32_16x16x32_bf16 v[100:103], a[28:31], v[92:95], v[100:103]
v_add_f32 v9, v108, v110
v_add_f32 v10, v109, v111
s_waitcnt lgkmcnt(2)
v_mfma_f32_16x16x32_bf16 v[96:99], a[32:35], v[80:83], v[96:99]
ds_read_b128 v[92:95], v1 offset:7168
v_add_f32 v7, v7, v9
v_add_f32 v8, v8, v10
v_mfma_f32_16x16x32_bf16 v[100:103], a[36:39], v[80:83], v[100:103]
v_mul_f32 v7, 0x3b124925, v7
v_mul_f32 v8, 0x3b124925, v8
s_waitcnt lgkmcnt(2)
v_mfma_f32_16x16x32_bf16 v[96:99], a[40:43], v[84:87], v[96:99]
ds_read_b128 v[80:83], v1 offset:8192
v_fma_f32 v8, -v7, v7, v8
v_max_f32 v8, 0, v8
v_mfma_f32_16x16x32_bf16 v[100:103], a[44:47], v[84:87], v[100:103]
v_cvt_pk_bf16_f32 v7, v7, v7
v_and_b32 v7, 0xffff0000, v7
s_waitcnt lgkmcnt(2)
v_mfma_f32_16x16x32_bf16 v[96:99], a[48:51], v[88:91], v[96:99]
ds_read_b128 v[84:87], v1 offset:9216
v_cvt_pk_bf16_f32 v8, v8, v8
v_and_b32 v8, 0xffff0000, v8
v_mfma_f32_16x16x32_bf16 v[100:103], a[52:55], v[88:91], v[100:103]
v_add_f32 v8, 0x3727c5ac, v8
v_cvt_pk_bf16_f32 v8, v8, v8
s_waitcnt lgkmcnt(2)
v_mfma_f32_16x16x32_bf16 v[96:99], a[56:59], v[92:95], v[96:99]
ds_read_b128 v[88:91], v1 offset:10240
v_and_b32 v8, 0xffff0000, v8
v_sqrt_f32 v8, v8
v_mfma_f32_16x16x32_bf16 v[100:103], a[60:63], v[92:95], v[100:103]
s_nop 0
v_cvt_pk_bf16_f32 v8, v8, v8
s_waitcnt lgkmcnt(2)
v_mfma_f32_16x16x32_bf16 v[96:99], a[64:67], v[80:83], v[96:99]
ds_read_b128 v[92:95], v1 offset:11264
v_and_b32 v8, 0xffff0000, v8
v_rcp_f32 v8, v8
v_mfma_f32_16x16x32_bf16 v[100:103], a[68:71], v[80:83], v[100:103]
s_nop 0
v_sub_f32 v6, 0, v7
s_waitcnt lgkmcnt(2)
v_mfma_f32_16x16x32_bf16 v[96:99], a[72:75], v[84:87], v[96:99]
ds_read_b128 v[80:83], v1 offset:12288
v_mov_b32 v5, s29
v_mfma_f32_16x16x32_bf16 v[100:103], a[76:79], v[84:87], v[100:103]
s_waitcnt lgkmcnt(2)
v_mfma_f32_16x16x32_bf16 v[96:99], a[80:83], v[88:91], v[96:99]
ds_read_b128 v[84:87], v1 offset:13312
v_mfma_f32_16x16x32_bf16 v[100:103], a[84:87], v[88:91], v[100:103]
s_waitcnt lgkmcnt(2)
v_mfma_f32_16x16x32_bf16 v[96:99], a[88:91], v[92:95], v[96:99]
v_mfma_f32_16x16x32_bf16 v[100:103], a[92:95], v[92:95], v[100:103]
s_waitcnt lgkmcnt(1)
v_mfma_f32_16x16x32_bf16 v[96:99], a[96:99], v[80:83], v[96:99]
v_mfma_f32_16x16x32_bf16 v[100:103], a[100:103], v[80:83], v[100:103]
s_waitcnt lgkmcnt(0)
v_mfma_f32_16x16x32_bf16 v[96:99], a[104:107], v[84:87], v[96:99]
v_mfma_f32_16x16x32_bf16 v[100:103], a[108:111], v[84:87], v[100:103]
s_nop 6
v_pk_fma_f32 v[96:97], v[24:25], v[6:7], v[96:97] op_sel_hi:[1,0,1]
v_pk_fma_f32 v[98:99], v[26:27], v[6:7], v[98:99] op_sel_hi:[1,0,1]
v_pk_fma_f32 v[100:101], v[28:29], v[6:7], v[100:101] op_sel_hi:[1,0,1]
v_pk_fma_f32 v[102:103], v[30:31], v[6:7], v[102:103] op_sel_hi:[1,0,1]
v_pk_fma_f32 v[96:97], v[96:97], v[8:9], v[16:17] op_sel_hi:[1,0,1]
v_pk_fma_f32 v[98:99], v[98:99], v[8:9], v[18:19] op_sel_hi:[1,0,1]
v_pk_fma_f32 v[100:101], v[100:101], v[8:9], v[20:21] op_sel_hi:[1,0,1]
v_pk_fma_f32 v[102:103], v[102:103], v[8:9], v[22:23] op_sel_hi:[1,0,1]
v_pk_mul_f32 v[48:49], v[96:97], v[96:97]
v_pk_mul_f32 v[50:51], v[98:99], v[98:99]
v_pk_mul_f32 v[52:53], v[100:101], v[100:101]
v_pk_mul_f32 v[54:55], v[102:103], v[102:103]
v_fma_f32 v48, v48, s30, v5
v_fma_f32 v49, v49, s30, v5
v_fma_f32 v50, v50, s30, v5
v_fma_f32 v51, v51, s30, v5
v_fma_f32 v52, v52, s30, v5
v_fma_f32 v53, v53, s30, v5
v_fma_f32 v54, v54, s30, v5
v_fma_f32 v55, v55, s30, v5
v_pk_mul_f32 v[48:49], v[48:49], v[96:97]
v_pk_mul_f32 v[50:51], v[50:51], v[98:99]
v_pk_mul_f32 v[52:53], v[52:53], v[100:101]
v_pk_mul_f32 v[54:55], v[54:55], v[102:103]
v_exp_f32 v48, v48
v_exp_f32 v49, v49
v_exp_f32 v50, v50
v_exp_f32 v51, v51
v_exp_f32 v52, v52
v_exp_f32 v53, v53
v_exp_f32 v54, v54
v_exp_f32 v55, v55
v_add_f32 v48, 1.0, v48
v_add_f32 v49, 1.0, v49
v_add_f32 v50, 1.0, v50
v_add_f32 v51, 1.0, v51
v_add_f32 v52, 1.0, v52
v_add_f32 v53, 1.0, v53
v_add_f32 v54, 1.0, v54
v_add_f32 v55, 1.0, v55
v_rcp_f32 v48, v48
v_rcp_f32 v49, v49
v_rcp_f32 v50, v50
v_rcp_f32 v51, v51
v_rcp_f32 v52, v52
v_rcp_f32 v53, v53
v_rcp_f32 v54, v54
v_rcp_f32 v55, v55
v_pk_mul_f32 v[96:97], v[96:97], v[48:49]
v_pk_mul_f32 v[98:99], v[98:99], v[50:51]
v_pk_mul_f32 v[100:101], v[100:101], v[52:53]
v_pk_mul_f32 v[102:103], v[102:103], v[54:55]
s_waitcnt vmcnt(0)
v_cvt_pk_bf16_f32 v32, v96, v97
v_cvt_pk_bf16_f32 v33, v98, v99
v_cvt_pk_bf16_f32 v34, v100, v101
v_cvt_pk_bf16_f32 v35, v102, v103
s_cmp_lg_u32 s23, 0
s_cbranch_scc1 Lwt_295
buffer_store_dwordx4 v[32:35], v1, s[4:7], s27 offen
s_branch Lst_296
Lwt_295:
buffer_store_dwordx4 v[32:35], v1, s[4:7], s27 offen sc1
Lst_296:
v_mov_b32 v5, s88
s_waitcnt vmcnt(0)
s_cmp_lg_u32 s23, 0
s_cbranch_scc1 Lwt_297
buffer_store_dword v5, off, s[4:7], s28
s_branch Lst_298
Lwt_297:
buffer_store_dword v5, off, s[4:7], s28 sc1
Lst_298:
s_add_u32 s26, s26, 43008
s_add_u32 s27, s27, 172032
s_add_u32 s28, s28, 672
s_add_u32 s25, s25, 3
s_cmp_lt_u32 s25, 128
s_cbranch_scc1 F1_JOB0
s_endpgm
F1_W1:
s_load_dwordx2 s[8:9], s[0:1], 64
s_mov_b32 s10, 1605632
s_mov_b32 s11, 0x00020000
s_load_dwordx2 s[16:17], s[0:1], 72
s_mov_b32 s18, 3584
s_mov_b32 s19, 0x00020000
v_lshlrev_b32 v1, 4, v0
v_lshrrev_b32 v5, 2, v0
v_mul_u32_u24 v2, 3584, v5
v_and_b32 v6, 3, v0
v_lshl_add_u32 v2, v6, 4, v2
v_lshrrev_b32 v3, 4, v0
v_lshlrev_b32 v4, 4, v3
v_lshlrev_b32 v3, 3, v3
v_and_b32 v5, 3, v5
v_add_u32 v3, v3, v5
v_lshlrev_b32 v3, 6, v3
v_lshl_add_u32 v3, v6, 4, v3
v_add_u32 v3, 61440, v3
s_lshl_b32 s40, s22, 8
s_add_u32 s40, s40, 64
s_waitcnt lgkmcnt(0)
buffer_load_dwordx4 v[32:35], v4, s[16:19], s40 offen
s_mov_b32 m0, 61440
s_add_u32 s41, s40, 0
buffer_load_dwordx4 v2, s[8:11], s41 offen lds
s_mov_b32 m0, 62464
s_add_u32 s41, s40, 57344
buffer_load_dwordx4 v2, s[8:11], s41 offen lds
s_mov_b32 m0, 63488
s_add_u32 s41, s40, 114688
buffer_load_dwordx4 v2, s[8:11], s41 offen lds
s_mov_b32 m0, 64512
s_add_u32 s41, s40, 172032
buffer_load_dwordx4 v2, s[8:11], s41 offen lds
s_mov_b32 m0, 65536
s_add_u32 s41, s40, 229376
buffer_load_dwordx4 v2, s[8:11], s41 offen lds
s_mov_b32 m0, 66560
s_add_u32 s41, s40, 286720
buffer_load_dwordx4 v2, s[8:11], s41 offen lds
s_mov_b32 m0, 67584
s_add_u32 s41, s40, 344064
buffer_load_dwordx4 v2, s[8:11], s41 offen lds
s_mov_b32 m0, 68608
s_add_u32 s41, s40, 401408
buffer_load_dwordx4 v2, s[8:11], s41 offen lds
s_mov_b32 m0, 69632
s_add_u32 s41, s40, 458752
buffer_load_dwordx4 v2, s[8:11], s41 offen lds
s_mov_b32 m0, 70656
s_add_u32 s41, s40, 516096
buffer_load_dwordx4 v2, s[8:11], s41 offen lds
s_mov_b32 m0, 71680
s_add_u32 s41, s40, 573440
buffer_load_dwordx4 v2, s[8:11], s41 offen lds
s_mov_b32 m0, 72704
s_add_u32 s41, s40, 630784
buffer_load_dwordx4 v2, s[8:11], s41 offen lds
s_mov_b32 m0, 73728
s_add_u32 s41, s40, 688128
buffer_load_dwordx4 v2, s[8:11], s41 offen lds
s_mov_b32 m0, 74752
s_add_u32 s41, s40, 745472
buffer_load_dwordx4 v2, s[8:11], s41 offen lds
s_mov_b32 m0, 75776
s_add_u32 s41, s40, 802816
buffer_load_dwordx4 v2, s[8:11], s41 offen lds
s_mov_b32 m0, 76800
s_add_u32 s41, s40, 860160
buffer_load_dwordx4 v2, s[8:11], s41 offen lds
s_mov_b32 m0, 77824
s_add_u32 s41, s40, 917504
buffer_load_dwordx4 v2, s[8:11], s41 offen lds
s_mov_b32 m0, 78848
s_add_u32 s41, s40, 974848
buffer_load_dwordx4 v2, s[8:11], s41 offen lds
s_mov_b32 m0, 79872
s_add_u32 s41, s40, 1032192
buffer_load_dwordx4 v2, s[8:11], s41 offen lds
s_mov_b32 m0, 80896
s_add_u32 s41, s40, 1089536
buffer_load_dwordx4 v2, s[8:11], s41 offen lds
s_mov_b32 m0, 81920
s_add_u32 s41, s40, 1146880
buffer_load_dwordx4 v2, s[8:11], s41 offen lds
s_mov_b32 m0, 82944
s_add_u32 s41, s40, 1204224
buffer_load_dwordx4 v2, s[8:11], s41 offen lds
s_mov_b32 m0, 83968
s_add_u32 s41, s40, 1261568
buffer_load_dwordx4 v2, s[8:11], s41 offen lds
s_mov_b32 m0, 84992
s_add_u32 s41, s40, 1318912
buffer_load_dwordx4 v2, s[8:11], s41 offen lds
s_mov_b32 m0, 86016
s_add_u32 s41, s40, 1376256
buffer_load_dwordx4 v2, s[8:11], s41 offen lds
s_mov_b32 m0, 87040
s_add_u32 s41, s40, 1433600
buffer_load_dwordx4 v2, s[8:11], s41 offen lds
s_mov_b32 m0, 88064
s_add_u32 s41, s40, 1490944
buffer_load_dwordx4 v2, s[8:11], s41 offen lds
s_mov_b32 m0, 89088
s_add_u32 s41, s40, 1548288
buffer_load_dwordx4 v2, s[8:11], s41 offen lds
v_and_b32 v4, 15, v0
v_lshlrev_b32 v4, 5, v4
v_add_u32 v4, 14336, v4
v_bfe_u32 v5, v0, 2, 2
v_lshrrev_b32 v6, 4, v0
v_cmp_eq_u32 vcc, v5, v6
v_add_u32 v5, 8, v4
v_lshlrev_b32 v14, 3, v0
v_add_u32 v14, 14848, v14
v_cndmask_b32 v14, v14, v5, vcc
v_and_b32 v5, 1, v0
v_cmp_ne_u32 s[32:33], 0, v5
v_and_b32 v5, 2, v0
v_cmp_ne_u32 s[34:35], 0, v5
s_mul_i32 s26, s21, 14336
s_add_u32 s26, s26, 4374528
s_mul_i32 s27, s21, 57344
s_lshl_b32 s41, s22, 12
s_add_u32 s27, s27, s41
s_add_u32 s27, s27, 22725632
s_mul_i32 s28, s21, 224
s_lshl_b32 s41, s22, 4
s_add_u32 s28, s28, s41
s_add_u32 s28, s28, 143364
s_mov_b32 s29, 0xc0135761
s_mov_b32 s30, 0xbdd2d3e8
s_mov_b32 s25, s21
s_waitcnt vmcnt(0)
v_lshlrev_b32 v16, 16, v32
v_and_b32 v17, 0xffff0000, v32
v_lshlrev_b32 v18, 16, v33
v_and_b32 v19, 0xffff0000, v33
v_lshlrev_b32 v20, 16, v34
v_and_b32 v21, 0xffff0000, v34
v_lshlrev_b32 v22, 16, v35
v_and_b32 v23, 0xffff0000, v35
v_mov_b32 v112, 0x3f803f80
v_mov_b32 v113, 0x3f803f80
v_mov_b32 v114, 0x3f803f80
v_mov_b32 v115, 0x3f803f80
ds_read_b64_tr_b16 a[0:1], v3
ds_read_b64_tr_b16 a[2:3], v3 offset:256
ds_read_b64_tr_b16 a[4:5], v3 offset:8
ds_read_b64_tr_b16 a[6:7], v3 offset:264
ds_read_b64_tr_b16 a[8:9], v3 offset:2048
ds_read_b64_tr_b16 a[10:11], v3 offset:2304
ds_read_b64_tr_b16 a[12:13], v3 offset:2056
ds_read_b64_tr_b16 a[14:15], v3 offset:2312
ds_read_b64_tr_b16 a[16:17], v3 offset:4096
ds_read_b64_tr_b16 a[18:19], v3 offset:4352
ds_read_b64_tr_b16 a[20:21], v3 offset:4104
ds_read_b64_tr_b16 a[22:23], v3 offset:4360
s_waitcnt lgkmcnt(0)
ds_read_b64_tr_b16 a[24:25], v3 offset:6144
ds_read_b64_tr_b16 a[26:27], v3 offset:6400
ds_read_b64_tr_b16 a[28:29], v3 offset:6152
ds_read_b64_tr_b16 a[30:31], v3 offset:6408
ds_read_b64_tr_b16 a[32:33], v3 offset:8192
ds_read_b64_tr_b16 a[34:35], v3 offset:8448
ds_read_b64_tr_b16 a[36:37], v3 offset:8200
ds_read_b64_tr_b16 a[38:39], v3 offset:8456
ds_read_b64_tr_b16 a[40:41], v3 offset:10240
ds_read_b64_tr_b16 a[42:43], v3 offset:10496
ds_read_b64_tr_b16 a[44:45], v3 offset:10248
ds_read_b64_tr_b16 a[46:47], v3 offset:10504
s_waitcnt lgkmcnt(0)
ds_read_b64_tr_b16 a[48:49], v3 offset:12288
ds_read_b64_tr_b16 a[50:51], v3 offset:12544
ds_read_b64_tr_b16 a[52:53], v3 offset:12296
ds_read_b64_tr_b16 a[54:55], v3 offset:12552
ds_read_b64_tr_b16 a[56:57], v3 offset:14336
ds_read_b64_tr_b16 a[58:59], v3 offset:14592
ds_read_b64_tr_b16 a[60:61], v3 offset:14344
ds_read_b64_tr_b16 a[62:63], v3 offset:14600
ds_read_b64_tr_b16 a[64:65], v3 offset:16384
ds_read_b64_tr_b16 a[66:67], v3 offset:16640
ds_read_b64_tr_b16 a[68:69], v3 offset:16392
ds_read_b64_tr_b16 a[70:71], v3 offset:16648
s_waitcnt lgkmcnt(0)
ds_read_b64_tr_b16 a[72:73], v3 offset:18432
ds_read_b64_tr_b16 a[74:75], v3 offset:18688
ds_read_b64_tr_b16 a[76:77], v3 offset:18440
ds_read_b64_tr_b16 a[78:79], v3 offset:18696
ds_read_b64_tr_b16 a[80:81], v3 offset:20480
ds_read_b64_tr_b16 a[82:83], v3 offset:20736
ds_read_b64_tr_b16 a[84:85], v3 offset:20488
ds_read_b64_tr_b16 a[86:87], v3 offset:20744
ds_read_b64_tr_b16 a[88:89], v3 offset:22528
ds_read_b64_tr_b16 a[90:91], v3 offset:22784
ds_read_b64_tr_b16 a[92:93], v3 offset:22536
ds_read_b64_tr_b16 a[94:95], v3 offset:22792
s_waitcnt lgkmcnt(0)
ds_read_b64_tr_b16 a[96:97], v3 offset:24576
ds_read_b64_tr_b16 a[98:99], v3 offset:24832
ds_read_b64_tr_b16 a[100:101], v3 offset:24584
ds_read_b64_tr_b16 a[102:103], v3 offset:24840
ds_read_b64_tr_b16 a[104:105], v3 offset:26624
ds_read_b64_tr_b16 a[106:107], v3 offset:26880
ds_read_b64_tr_b16 a[108:109], v3 offset:26632
ds_read_b64_tr_b16 a[110:111], v3 offset:26888
s_waitcnt lgkmcnt(0)
v_mfma_f32_16x16x32_bf16 v[24:27], a[0:3], v[112:115], 0
v_mfma_f32_16x16x32_bf16 v[28:31], a[4:7], v[112:115], 0
v_mfma_f32_16x16x32_bf16 v[24:27], a[8:11], v[112:115], v[24:27]
v_mfma_f32_16x16x32_bf16 v[28:31], a[12:15], v[112:115], v[28:31]
v_mfma_f32_16x16x32_bf16 v[24:27], a[16:19], v[112:115], v[24:27]
v_mfma_f32_16x16x32_bf16 v[28:31], a[20:23], v[112:115], v[28:31]
v_mfma_f32_16x16x32_bf16 v[24:27], a[24:27], v[112:115], v[24:27]
v_mfma_f32_16x16x32_bf16 v[28:31], a[28:31], v[112:115], v[28:31]
v_mfma_f32_16x16x32_bf16 v[24:27], a[32:35], v[112:115], v[24:27]
v_mfma_f32_16x16x32_bf16 v[28:31], a[36:39], v[112:115], v[28:31]
v_mfma_f32_16x16x32_bf16 v[24:27], a[40:43], v[112:115], v[24:27]
v_mfma_f32_16x16x32_bf16 v[28:31], a[44:47], v[112:115], v[28:31]
v_mfma_f32_16x16x32_bf16 v[24:27], a[48:51], v[112:115], v[24:27]
v_mfma_f32_16x16x32_bf16 v[28:31], a[52:55], v[112:115], v[28:31]
v_mfma_f32_16x16x32_bf16 v[24:27], a[56:59], v[112:115], v[24:27]
v_mfma_f32_16x16x32_bf16 v[28:31], a[60:63], v[112:115], v[28:31]
v_mfma_f32_16x16x32_bf16 v[24:27], a[64:67], v[112:115], v[24:27]
v_mfma_f32_16x16x32_bf16 v[28:31], a[68:71], v[112:115], v[28:31]
v_mfma_f32_16x16x32_bf16 v[24:27], a[72:75], v[112:115], v[24:27]
v_mfma_f32_16x16x32_bf16 v[28:31], a[76:79], v[112:115], v[28:31]
v_mfma_f32_16x16x32_bf16 v[24:27], a[80:83], v[112:115], v[24:27]
v_mfma_f32_16x16x32_bf16 v[28:31], a[84:87], v[112:115], v[28:31]
v_mfma_f32_16x16x32_bf16 v[24:27], a[88:91], v[112:115], v[24:27]
v_mfma_f32_16x16x32_bf16 v[28:31], a[92:95], v[112:115], v[28:31]
v_mfma_f32_16x16x32_bf16 v[24:27], a[96:99], v[112:115], v[24:27]
v_mfma_f32_16x16x32_bf16 v[28:31], a[100:103], v[112:115], v[28:31]
v_mfma_f32_16x16x32_bf16 v[24:27], a[104:107], v[112:115], v[24:27]
v_mfma_f32_16x16x32_bf16 v[28:31], a[108:111], v[112:115], v[28:31]
v_min_u32 v12, 47, v0
v_and_b32 v5, 3, v12
v_lshlrev_b32 v5, 3, v5
v_lshrrev_b32 v12, 2, v12
v_lshl_add_u32 v5, v12, 7, v5
s_mov_b32 s43, 6144
Llz_299:
buffer_load_dwordx2 v[12:13], v5, s[4:7], s43 offen sc1
s_waitcnt vmcnt(0)
v_cmp_ne_u32 vcc, s88, v12
v_cmp_ne_u32 s[40:41], s88, v13
s_or_b64 vcc, vcc, s[40:41]
s_cbranch_vccz Llzok_300
s_sleep 8
s_sub_u32 s24, s24, 1
s_cbranch_scc0 Llz_299
s_endpgm
Llzok_300:
F1_JOB1:
s_barrier
buffer_load_dwordx4 v[32:35], v1, s[4:7], s26 offen sc1
buffer_load_dwordx4 v[36:39], v1, s[4:7], s26 offen offset:1024 sc1
buffer_load_dwordx4 v[40:43], v1, s[4:7], s26 offen offset:2048 sc1
buffer_load_dwordx4 v[44:47], v1, s[4:7], s26 offen offset:3072 sc1
s_sleep 6
Lspin_301:
buffer_load_dwordx4 v[32:35], v1, s[4:7], s26 offen sc1
buffer_load_dwordx4 v[36:39], v1, s[4:7], s26 offen offset:1024 sc1
buffer_load_dwordx4 v[40:43], v1, s[4:7], s26 offen offset:2048 sc1
buffer_load_dwordx4 v[44:47], v1, s[4:7], s26 offen offset:3072 sc1
s_sub_u32 s24, s24, 1
s_cbranch_scc1 CODE_END
s_waitcnt vmcnt(4)
v_max3_u32 v5, v32, v33, v34
v_max3_u32 v5, v5, v35, v36
v_max3_u32 v5, v5, v37, v38
v_max3_u32 v5, v5, v39, v40
v_max3_u32 v5, v5, v41, v42
v_max3_u32 v5, v5, v43, v44
v_max3_u32 v5, v5, v45, v46
v_max_u32 v5, v5, v47
v_cmp_eq_u32 vcc, -1, v5
s_cbranch_vccz Lspin_301x
s_cmp_ge_u32 s25, 120
s_cbranch_scc1 Lspin_301
s_sleep 8
s_branch Lspin_301
Lspin_301x:
v_mfma_f32_16x16x32_bf16 v[48:51], v[32:35], v[32:35], 0
ds_write_b128 v1, v[32:35] offset:4096
v_mfma_f32_16x16x32_bf16 v[48:51], v[36:39], v[36:39], v[48:51]
ds_write_b128 v1, v[36:39] offset:5120
v_mfma_f32_16x16x32_bf16 v[48:51], v[40:43], v[40:43], v[48:51]
ds_write_b128 v1, v[40:43] offset:6144
v_mfma_f32_16x16x32_bf16 v[48:51], v[44:47], v[44:47], v[48:51]
ds_write_b128 v1, v[44:47] offset:7168
v_mfma_f32_16x16x32_bf16 v[52:55], v[112:115], v[32:35], 0
v_mfma_f32_16x16x32_bf16 v[52:55], v[112:115], v[36:39], v[52:55]
v_mfma_f32_16x16x32_bf16 v[52:55], v[112:115], v[40:43], v[52:55]
v_mfma_f32_16x16x32_bf16 v[52:55], v[112:115], v[44:47], v[52:55]
v_cndmask_b32 v48, v48, v49, s[32:33]
v_cndmask_b32 v50, v50, v51, s[32:33]
s_nop 5
v_cndmask_b32 v53, v48, v50, s[34:35]
ds_write_b64 v14, v[52:53]
s_waitcnt lgkmcnt(0)
s_barrier
ds_read_b128 v[80:83], v1
ds_read_b128 v[84:87], v1 offset:1024
ds_read_b128 v[88:91], v1 offset:2048
ds_read_b128 v[104:107], v4
ds_read_b128 v[108:111], v4 offset:16
s_waitcnt lgkmcnt(4)
v_mfma_f32_16x16x32_bf16 v[96:99], a[0:3], v[80:83], 0
ds_read_b128 v[92:95], v1 offset:3072
v_mfma_f32_16x16x32_bf16 v[100:103], a[4:7], v[80:83], 0
s_waitcnt lgkmcnt(4)
v_mfma_f32_16x16x32_bf16 v[96:99], a[8:11], v[84:87], v[96:99]
ds_read_b128 v[80:83], v1 offset:4096
v_mfma_f32_16x16x32_bf16 v[100:103], a[12:15], v[84:87], v[100:103]
s_waitcnt lgkmcnt(4)
v_mfma_f32_16x16x32_bf16 v[96:99], a[16:19], v[88:91], v[96:99]
ds_read_b128 v[84:87], v1 offset:5120
v_mfma_f32_16x16x32_bf16 v[100:103], a[20:23], v[88:91], v[100:103]
s_waitcnt lgkmcnt(2)
v_mfma_f32_16x16x32_bf16 v[96:99], a[24:27], v[92:95], v[96:99]
ds_read_b128 v[88:91], v1 offset:6144
v_add_f32 v7, v104, v106
v_add_f32 v8, v105, v107
v_mfma_f32_16x16x32_bf16 v[100:103], a[28:31], v[92:95], v[100:103]
v_add_f32 v9, v108, v110
v_add_f32 v10, v109, v111
s_waitcnt lgkmcnt(2)
v_mfma_f32_16x16x32_bf16 v[96:99], a[32:35], v[80:83], v[96:99]
ds_read_b128 v[92:95], v1 offset:7168
v_add_f32 v7, v7, v9
v_add_f32 v8, v8, v10
v_mfma_f32_16x16x32_bf16 v[100:103], a[36:39], v[80:83], v[100:103]
v_mul_f32 v7, 0x3b124925, v7
v_mul_f32 v8, 0x3b124925, v8
s_waitcnt lgkmcnt(2)
v_mfma_f32_16x16x32_bf16 v[96:99], a[40:43], v[84:87], v[96:99]
ds_read_b128 v[80:83], v1 offset:8192
v_fma_f32 v8, -v7, v7, v8
v_max_f32 v8, 0, v8
v_mfma_f32_16x16x32_bf16 v[100:103], a[44:47], v[84:87], v[100:103]
v_cvt_pk_bf16_f32 v7, v7, v7
v_and_b32 v7, 0xffff0000, v7
s_waitcnt lgkmcnt(2)
v_mfma_f32_16x16x32_bf16 v[96:99], a[48:51], v[88:91], v[96:99]
ds_read_b128 v[84:87], v1 offset:9216
v_cvt_pk_bf16_f32 v8, v8, v8
v_and_b32 v8, 0xffff0000, v8
v_mfma_f32_16x16x32_bf16 v[100:103], a[52:55], v[88:91], v[100:103]
v_add_f32 v8, 0x3727c5ac, v8
v_cvt_pk_bf16_f32 v8, v8, v8
s_waitcnt lgkmcnt(2)
v_mfma_f32_16x16x32_bf16 v[96:99], a[56:59], v[92:95], v[96:99]
ds_read_b128 v[88:91], v1 offset:10240
v_and_b32 v8, 0xffff0000, v8
v_sqrt_f32 v8, v8
v_mfma_f32_16x16x32_bf16 v[100:103], a[60:63], v[92:95], v[100:103]
s_nop 0
v_cvt_pk_bf16_f32 v8, v8, v8
s_waitcnt lgkmcnt(2)
v_mfma_f32_16x16x32_bf16 v[96:99], a[64:67], v[80:83], v[96:99]
ds_read_b128 v[92:95], v1 offset:11264
v_and_b32 v8, 0xffff0000, v8
v_rcp_f32 v8, v8
v_mfma_f32_16x16x32_bf16 v[100:103], a[68:71], v[80:83], v[100:103]
s_nop 0
v_sub_f32 v6, 0, v7
s_waitcnt lgkmcnt(2)
v_mfma_f32_16x16x32_bf16 v[96:99], a[72:75], v[84:87], v[96:99]
ds_read_b128 v[80:83], v1 offset:12288
v_mov_b32 v5, s29
v_mfma_f32_16x16x32_bf16 v[100:103], a[76:79], v[84:87], v[100:103]
s_waitcnt lgkmcnt(2)
v_mfma_f32_16x16x32_bf16 v[96:99], a[80:83], v[88:91], v[96:99]
ds_read_b128 v[84:87], v1 offset:13312
v_mfma_f32_16x16x32_bf16 v[100:103], a[84:87], v[88:91], v[100:103]
s_waitcnt lgkmcnt(2)
v_mfma_f32_16x16x32_bf16 v[96:99], a[88:91], v[92:95], v[96:99]
v_mfma_f32_16x16x32_bf16 v[100:103], a[92:95], v[92:95], v[100:103]
s_waitcnt lgkmcnt(1)
v_mfma_f32_16x16x32_bf16 v[96:99], a[96:99], v[80:83], v[96:99]
v_mfma_f32_16x16x32_bf16 v[100:103], a[100:103], v[80:83], v[100:103]
s_waitcnt lgkmcnt(0)
v_mfma_f32_16x16x32_bf16 v[96:99], a[104:107], v[84:87], v[96:99]
v_mfma_f32_16x16x32_bf16 v[100:103], a[108:111], v[84:87], v[100:103]
s_nop 6
v_pk_fma_f32 v[96:97], v[24:25], v[6:7], v[96:97] op_sel_hi:[1,0,1]
v_pk_fma_f32 v[98:99], v[26:27], v[6:7], v[98:99] op_sel_hi:[1,0,1]
v_pk_fma_f32 v[100:101], v[28:29], v[6:7], v[100:101] op_sel_hi:[1,0,1]
v_pk_fma_f32 v[102:103], v[30:31], v[6:7], v[102:103] op_sel_hi:[1,0,1]
v_pk_fma_f32 v[96:97], v[96:97], v[8:9], v[16:17] op_sel_hi:[1,0,1]
v_pk_fma_f32 v[98:99], v[98:99], v[8:9], v[18:19] op_sel_hi:[1,0,1]
v_pk_fma_f32 v[100:101], v[100:101], v[8:9], v[20:21] op_sel_hi:[1,0,1]
v_pk_fma_f32 v[102:103], v[102:103], v[8:9], v[22:23] op_sel_hi:[1,0,1]
v_pk_mul_f32 v[48:49], v[96:97], v[96:97]
v_pk_mul_f32 v[50:51], v[98:99], v[98:99]
v_pk_mul_f32 v[52:53], v[100:101], v[100:101]
v_pk_mul_f32 v[54:55], v[102:103], v[102:103]
v_fma_f32 v48, v48, s30, v5
v_fma_f32 v49, v49, s30, v5
v_fma_f32 v50, v50, s30, v5
v_fma_f32 v51, v51, s30, v5
v_fma_f32 v52, v52, s30, v5
v_fma_f32 v53, v53, s30, v5
v_fma_f32 v54, v54, s30, v5
v_fma_f32 v55, v55, s30, v5
v_pk_mul_f32 v[48:49], v[48:49], v[96:97]
v_pk_mul_f32 v[50:51], v[50:51], v[98:99]
v_pk_mul_f32 v[52:53], v[52:53], v[100:101]
v_pk_mul_f32 v[54:55], v[54:55], v[102:103]
v_exp_f32 v48, v48
v_exp_f32 v49, v49
v_exp_f32 v50, v50
v_exp_f32 v51, v51
v_exp_f32 v52, v52
v_exp_f32 v53, v53
v_exp_f32 v54, v54
v_exp_f32 v55, v55
v_add_f32 v48, 1.0, v48
v_add_f32 v49, 1.0, v49
v_add_f32 v50, 1.0, v50
v_add_f32 v51, 1.0, v51
v_add_f32 v52, 1.0, v52
v_add_f32 v53, 1.0, v53
v_add_f32 v54, 1.0, v54
v_add_f32 v55, 1.0, v55
v_rcp_f32 v48, v48
v_rcp_f32 v49, v49
v_rcp_f32 v50, v50
v_rcp_f32 v51, v51
v_rcp_f32 v52, v52
v_rcp_f32 v53, v53
v_rcp_f32 v54, v54
v_rcp_f32 v55, v55
v_pk_mul_f32 v[96:97], v[96:97], v[48:49]
v_pk_mul_f32 v[98:99], v[98:99], v[50:51]
v_pk_mul_f32 v[100:101], v[100:101], v[52:53]
v_pk_mul_f32 v[102:103], v[102:103], v[54:55]
s_waitcnt vmcnt(0)
v_cvt_pk_bf16_f32 v32, v96, v97
v_cvt_pk_bf16_f32 v33, v98, v99
v_cvt_pk_bf16_f32 v34, v100, v101
v_cvt_pk_bf16_f32 v35, v102, v103
s_cmp_lg_u32 s23, 0
s_cbranch_scc1 Lwt_302
buffer_store_dwordx4 v[32:35], v1, s[4:7], s27 offen
s_branch Lst_303
Lwt_302:
buffer_store_dwordx4 v[32:35], v1, s[4:7], s27 offen sc1
Lst_303:
v_mov_b32 v5, s88
s_waitcnt vmcnt(0)
s_cmp_lg_u32 s23, 0
s_cbranch_scc1 Lwt_304
buffer_store_dword v5, off, s[4:7], s28
s_branch Lst_305
Lwt_304:
buffer_store_dword v5, off, s[4:7], s28 sc1
Lst_305:
s_add_u32 s26, s26, 43008
s_add_u32 s27, s27, 172032
s_add_u32 s28, s28, 672
s_add_u32 s25, s25, 3
s_cmp_lt_u32 s25, 128
s_cbranch_scc1 F1_JOB1
s_endpgm
F1_W2:
s_load_dwordx2 s[8:9], s[0:1], 64
s_mov_b32 s10, 1605632
s_mov_b32 s11, 0x00020000
s_load_dwordx2 s[16:17], s[0:1], 72
s_mov_b32 s18, 3584
s_mov_b32 s19, 0x00020000
v_lshlrev_b32 v1, 4, v0
v_lshrrev_b32 v5, 2, v0
v_mul_u32_u24 v2, 3584, v5
v_and_b32 v6, 3, v0
v_lshl_add_u32 v2, v6, 4, v2
v_lshrrev_b32 v3, 4, v0
v_lshlrev_b32 v4, 4, v3
v_lshlrev_b32 v3, 3, v3
v_and_b32 v5, 3, v5
v_add_u32 v3, v3, v5
v_lshlrev_b32 v3, 6, v3
v_lshl_add_u32 v3, v6, 4, v3
v_add_u32 v3, 90112, v3
s_lshl_b32 s40, s22, 8
s_add_u32 s40, s40, 128
s_waitcnt lgkmcnt(0)
buffer_load_dwordx4 v[32:35], v4, s[16:19], s40 offen
s_mov_b32 m0, 90112
s_add_u32 s41, s40, 0
buffer_load_dwordx4 v2, s[8:11], s41 offen lds
s_mov_b32 m0, 91136
s_add_u32 s41, s40, 57344
buffer_load_dwordx4 v2, s[8:11], s41 offen lds
s_mov_b32 m0, 92160
s_add_u32 s41, s40, 114688
buffer_load_dwordx4 v2, s[8:11], s41 offen lds
s_mov_b32 m0, 93184
s_add_u32 s41, s40, 172032
buffer_load_dwordx4 v2, s[8:11], s41 offen lds
s_mov_b32 m0, 94208
s_add_u32 s41, s40, 229376
buffer_load_dwordx4 v2, s[8:11], s41 offen lds
s_mov_b32 m0, 95232
s_add_u32 s41, s40, 286720
buffer_load_dwordx4 v2, s[8:11], s41 offen lds
s_mov_b32 m0, 96256
s_add_u32 s41, s40, 344064
buffer_load_dwordx4 v2, s[8:11], s41 offen lds
s_mov_b32 m0, 97280
s_add_u32 s41, s40, 401408
buffer_load_dwordx4 v2, s[8:11], s41 offen lds
s_mov_b32 m0, 98304
s_add_u32 s41, s40, 458752
buffer_load_dwordx4 v2, s[8:11], s41 offen lds
s_mov_b32 m0, 99328
s_add_u32 s41, s40, 516096
buffer_load_dwordx4 v2, s[8:11], s41 offen lds
s_mov_b32 m0, 100352
s_add_u32 s41, s40, 573440
buffer_load_dwordx4 v2, s[8:11], s41 offen lds
s_mov_b32 m0, 101376
s_add_u32 s41, s40, 630784
buffer_load_dwordx4 v2, s[8:11], s41 offen lds
s_mov_b32 m0, 102400
s_add_u32 s41, s40, 688128
buffer_load_dwordx4 v2, s[8:11], s41 offen lds
s_mov_b32 m0, 103424
s_add_u32 s41, s40, 745472
buffer_load_dwordx4 v2, s[8:11], s41 offen lds
s_mov_b32 m0, 104448
s_add_u32 s41, s40, 802816
buffer_load_dwordx4 v2, s[8:11], s41 offen lds
s_mov_b32 m0, 105472
s_add_u32 s41, s40, 860160
buffer_load_dwordx4 v2, s[8:11], s41 offen lds
s_mov_b32 m0, 106496
s_add_u32 s41, s40, 917504
buffer_load_dwordx4 v2, s[8:11], s41 offen lds
s_mov_b32 m0, 107520
s_add_u32 s41, s40, 974848
buffer_load_dwordx4 v2, s[8:11], s41 offen lds
s_mov_b32 m0, 108544
s_add_u32 s41, s40, 1032192
buffer_load_dwordx4 v2, s[8:11], s41 offen lds
s_mov_b32 m0, 109568
s_add_u32 s41, s40, 1089536
buffer_load_dwordx4 v2, s[8:11], s41 offen lds
s_mov_b32 m0, 110592
s_add_u32 s41, s40, 1146880
buffer_load_dwordx4 v2, s[8:11], s41 offen lds
s_mov_b32 m0, 111616
s_add_u32 s41, s40, 1204224
buffer_load_dwordx4 v2, s[8:11], s41 offen lds
s_mov_b32 m0, 112640
s_add_u32 s41, s40, 1261568
buffer_load_dwordx4 v2, s[8:11], s41 offen lds
s_mov_b32 m0, 113664
s_add_u32 s41, s40, 1318912
buffer_load_dwordx4 v2, s[8:11], s41 offen lds
s_mov_b32 m0, 114688
s_add_u32 s41, s40, 1376256
buffer_load_dwordx4 v2, s[8:11], s41 offen lds
s_mov_b32 m0, 115712
s_add_u32 s41, s40, 1433600
buffer_load_dwordx4 v2, s[8:11], s41 offen lds
s_mov_b32 m0, 116736
s_add_u32 s41, s40, 1490944
buffer_load_dwordx4 v2, s[8:11], s41 offen lds
s_mov_b32 m0, 117760
s_add_u32 s41, s40, 1548288
buffer_load_dwordx4 v2, s[8:11], s41 offen lds
v_and_b32 v4, 15, v0
v_lshlrev_b32 v4, 5, v4
v_add_u32 v4, 14336, v4
v_bfe_u32 v5, v0, 2, 2
v_lshrrev_b32 v6, 4, v0
v_cmp_eq_u32 vcc, v5, v6
v_add_u32 v5, 16, v4
v_lshlrev_b32 v14, 3, v0
v_add_u32 v14, 14848, v14
v_cndmask_b32 v14, v14, v5, vcc
v_and_b32 v5, 1, v0
v_cmp_ne_u32 s[32:33], 0, v5
v_and_b32 v5, 2, v0
v_cmp_ne_u32 s[34:35], 0, v5
s_mul_i32 s26, s21, 14336
s_add_u32 s26, s26, 4378624
s_mul_i32 s27, s21, 57344
s_lshl_b32 s41, s22, 12
s_add_u32 s27, s27, s41
s_add_u32 s27, s27, 22726656
s_mul_i32 s28, s21, 224
s_lshl_b32 s41, s22, 4
s_add_u32 s28, s28, s41
s_add_u32 s28, s28, 143368
s_mov_b32 s29, 0xc0135761
s_mov_b32 s30, 0xbdd2d3e8
s_mov_b32 s25, s21
s_waitcnt vmcnt(0)
v_lshlrev_b32 v16, 16, v32
v_and_b32 v17, 0xffff0000, v32
v_lshlrev_b32 v18, 16, v33
v_and_b32 v19, 0xffff0000, v33
v_lshlrev_b32 v20, 16, v34
v_and_b32 v21, 0xffff0000, v34
v_lshlrev_b32 v22, 16, v35
v_and_b32 v23, 0xffff0000, v35
v_mov_b32 v112, 0x3f803f80
v_mov_b32 v113, 0x3f803f80
v_mov_b32 v114, 0x3f803f80
v_mov_b32 v115, 0x3f803f80
ds_read_b64_tr_b16 a[0:1], v3
ds_read_b64_tr_b16 a[2:3], v3 offset:256
ds_read_b64_tr_b16 a[4:5], v3 offset:8
ds_read_b64_tr_b16 a[6:7], v3 offset:264
ds_read_b64_tr_b16 a[8:9], v3 offset:2048
ds_read_b64_tr_b16 a[10:11], v3 offset:2304
ds_read_b64_tr_b16 a[12:13], v3 offset:2056
ds_read_b64_tr_b16 a[14:15], v3 offset:2312
ds_read_b64_tr_b16 a[16:17], v3 offset:4096
ds_read_b64_tr_b16 a[18:19], v3 offset:4352
ds_read_b64_tr_b16 a[20:21], v3 offset:4104
ds_read_b64_tr_b16 a[22:23], v3 offset:4360
s_waitcnt lgkmcnt(0)
ds_read_b64_tr_b16 a[24:25], v3 offset:6144
ds_read_b64_tr_b16 a[26:27], v3 offset:6400
ds_read_b64_tr_b16 a[28:29], v3 offset:6152
ds_read_b64_tr_b16 a[30:31], v3 offset:6408
ds_read_b64_tr_b16 a[32:33], v3 offset:8192
ds_read_b64_tr_b16 a[34:35], v3 offset:8448
ds_read_b64_tr_b16 a[36:37], v3 offset:8200
ds_read_b64_tr_b16 a[38:39], v3 offset:8456
ds_read_b64_tr_b16 a[40:41], v3 offset:10240
ds_read_b64_tr_b16 a[42:43], v3 offset:10496
ds_read_b64_tr_b16 a[44:45], v3 offset:10248
ds_read_b64_tr_b16 a[46:47], v3 offset:10504
s_waitcnt lgkmcnt(0)
ds_read_b64_tr_b16 a[48:49], v3 offset:12288
ds_read_b64_tr_b16 a[50:51], v3 offset:12544
ds_read_b64_tr_b16 a[52:53], v3 offset:12296
ds_read_b64_tr_b16 a[54:55], v3 offset:12552
ds_read_b64_tr_b16 a[56:57], v3 offset:14336
ds_read_b64_tr_b16 a[58:59], v3 offset:14592
ds_read_b64_tr_b16 a[60:61], v3 offset:14344
ds_read_b64_tr_b16 a[62:63], v3 offset:14600
ds_read_b64_tr_b16 a[64:65], v3 offset:16384
ds_read_b64_tr_b16 a[66:67], v3 offset:16640
ds_read_b64_tr_b16 a[68:69], v3 offset:16392
ds_read_b64_tr_b16 a[70:71], v3 offset:16648
s_waitcnt lgkmcnt(0)
ds_read_b64_tr_b16 a[72:73], v3 offset:18432
ds_read_b64_tr_b16 a[74:75], v3 offset:18688
ds_read_b64_tr_b16 a[76:77], v3 offset:18440
ds_read_b64_tr_b16 a[78:79], v3 offset:18696
ds_read_b64_tr_b16 a[80:81], v3 offset:20480
ds_read_b64_tr_b16 a[82:83], v3 offset:20736
ds_read_b64_tr_b16 a[84:85], v3 offset:20488
ds_read_b64_tr_b16 a[86:87], v3 offset:20744
ds_read_b64_tr_b16 a[88:89], v3 offset:22528
ds_read_b64_tr_b16 a[90:91], v3 offset:22784
ds_read_b64_tr_b16 a[92:93], v3 offset:22536
ds_read_b64_tr_b16 a[94:95], v3 offset:22792
s_waitcnt lgkmcnt(0)
ds_read_b64_tr_b16 a[96:97], v3 offset:24576
ds_read_b64_tr_b16 a[98:99], v3 offset:24832
ds_read_b64_tr_b16 a[100:101], v3 offset:24584
ds_read_b64_tr_b16 a[102:103], v3 offset:24840
ds_read_b64_tr_b16 a[104:105], v3 offset:26624
ds_read_b64_tr_b16 a[106:107], v3 offset:26880
ds_read_b64_tr_b16 a[108:109], v3 offset:26632
ds_read_b64_tr_b16 a[110:111], v3 offset:26888
s_waitcnt lgkmcnt(0)
v_mfma_f32_16x16x32_bf16 v[24:27], a[0:3], v[112:115], 0
v_mfma_f32_16x16x32_bf16 v[28:31], a[4:7], v[112:115], 0
v_mfma_f32_16x16x32_bf16 v[24:27], a[8:11], v[112:115], v[24:27]
v_mfma_f32_16x16x32_bf16 v[28:31], a[12:15], v[112:115], v[28:31]
v_mfma_f32_16x16x32_bf16 v[24:27], a[16:19], v[112:115], v[24:27]
v_mfma_f32_16x16x32_bf16 v[28:31], a[20:23], v[112:115], v[28:31]
v_mfma_f32_16x16x32_bf16 v[24:27], a[24:27], v[112:115], v[24:27]
v_mfma_f32_16x16x32_bf16 v[28:31], a[28:31], v[112:115], v[28:31]
v_mfma_f32_16x16x32_bf16 v[24:27], a[32:35], v[112:115], v[24:27]
v_mfma_f32_16x16x32_bf16 v[28:31], a[36:39], v[112:115], v[28:31]
v_mfma_f32_16x16x32_bf16 v[24:27], a[40:43], v[112:115], v[24:27]
v_mfma_f32_16x16x32_bf16 v[28:31], a[44:47], v[112:115], v[28:31]
v_mfma_f32_16x16x32_bf16 v[24:27], a[48:51], v[112:115], v[24:27]
v_mfma_f32_16x16x32_bf16 v[28:31], a[52:55], v[112:115], v[28:31]
v_mfma_f32_16x16x32_bf16 v[24:27], a[56:59], v[112:115], v[24:27]
v_mfma_f32_16x16x32_bf16 v[28:31], a[60:63], v[112:115], v[28:31]
v_mfma_f32_16x16x32_bf16 v[24:27], a[64:67], v[112:115], v[24:27]
v_mfma_f32_16x16x32_bf16 v[28:31], a[68:71], v[112:115], v[28:31]
v_mfma_f32_16x16x32_bf16 v[24:27], a[72:75], v[112:115], v[24:27]
v_mfma_f32_16x16x32_bf16 v[28:31], a[76:79], v[112:115], v[28:31]
v_mfma_f32_16x16x32_bf16 v[24:27], a[80:83], v[112:115], v[24:27]
v_mfma_f32_16x16x32_bf16 v[28:31], a[84:87], v[112:115], v[28:31]
v_mfma_f32_16x16x32_bf16 v[24:27], a[88:91], v[112:115], v[24:27]
v_mfma_f32_16x16x32_bf16 v[28:31], a[92:95], v[112:115], v[28:31]
v_mfma_f32_16x16x32_bf16 v[24:27], a[96:99], v[112:115], v[24:27]
v_mfma_f32_16x16x32_bf16 v[28:31], a[100:103], v[112:115], v[28:31]
v_mfma_f32_16x16x32_bf16 v[24:27], a[104:107], v[112:115], v[24:27]
v_mfma_f32_16x16x32_bf16 v[28:31], a[108:111], v[112:115], v[28:31]
v_min_u32 v12, 47, v0
v_and_b32 v5, 3, v12
v_lshlrev_b32 v5, 3, v5
v_lshrrev_b32 v12, 2, v12
v_lshl_add_u32 v5, v12, 7, v5
s_mov_b32 s43, 6144
Llz_306:
buffer_load_dwordx2 v[12:13], v5, s[4:7], s43 offen sc1
s_waitcnt vmcnt(0)
v_cmp_ne_u32 vcc, s88, v12
v_cmp_ne_u32 s[40:41], s88, v13
s_or_b64 vcc, vcc, s[40:41]
s_cbranch_vccz Llzok_307
s_sleep 8
s_sub_u32 s24, s24, 1
s_cbranch_scc0 Llz_306
s_endpgm
Llzok_307:
F1_JOB2:
s_barrier
buffer_load_dwordx4 v[32:35], v1, s[4:7], s26 offen sc1
buffer_load_dwordx4 v[36:39], v1, s[4:7], s26 offen offset:1024 sc1
buffer_load_dwordx4 v[40:43], v1, s[4:7], s26 offen offset:2048 sc1
s_sleep 6
Lspin_308:
buffer_load_dwordx4 v[32:35], v1, s[4:7], s26 offen sc1
buffer_load_dwordx4 v[36:39], v1, s[4:7], s26 offen offset:1024 sc1
buffer_load_dwordx4 v[40:43], v1, s[4:7], s26 offen offset:2048 sc1
s_sub_u32 s24, s24, 1
s_cbranch_scc1 CODE_END
s_waitcnt vmcnt(3)
v_max3_u32 v5, v32, v33, v34
v_max3_u32 v5, v5, v35, v36
v_max3_u32 v5, v5, v37, v38
v_max3_u32 v5, v5, v39, v40
v_max3_u32 v5, v5, v41, v42
v_max_u32 v5, v5, v43
v_cmp_eq_u32 vcc, -1, v5
s_cbranch_vccz Lspin_308x
s_cmp_ge_u32 s25, 120
s_cbranch_scc1 Lspin_308
s_sleep 8
s_branch Lspin_308
Lspin_308x:
v_mfma_f32_16x16x32_bf16 v[48:51], v[32:35], v[32:35], 0
ds_write_b128 v1, v[32:35] offset:8192
v_mfma_f32_16x16x32_bf16 v[48:51], v[36:39], v[36:39], v[48:51]
ds_write_b128 v1, v[36:39] offset:9216
v_mfma_f32_16x16x32_bf16 v[48:51], v[40:43], v[40:43], v[48:51]
ds_write_b128 v1, v[40:43] offset:10240
v_mfma_f32_16x16x32_bf16 v[52:55], v[112:115], v[32:35], 0
v_mfma_f32_16x16x32_bf16 v[52:55], v[112:115], v[36:39], v[52:55]
v_mfma_f32_16x16x32_bf16 v[52:55], v[112:115], v[40:43], v[52:55]
v_cndmask_b32 v48, v48, v49, s[32:33]
v_cndmask_b32 v50, v50, v51, s[32:33]
s_nop 5
v_cndmask_b32 v53, v48, v50, s[34:35]
ds_write_b64 v14, v[52:53]
s_waitcnt lgkmcnt(0)
s_barrier
ds_read_b128 v[80:83], v1
ds_read_b128 v[84:87], v1 offset:1024
ds_read_b128 v[88:91], v1 offset:2048
ds_read_b128 v[104:107], v4
ds_read_b128 v[108:111], v4 offset:16
s_waitcnt lgkmcnt(4)
v_mfma_f32_16x16x32_bf16 v[96:99], a[0:3], v[80:83], 0
ds_read_b128 v[92:95], v1 offset:3072
v_mfma_f32_16x16x32_bf16 v[100:103], a[4:7], v[80:83], 0
s_waitcnt lgkmcnt(4)
v_mfma_f32_16x16x32_bf16 v[96:99], a[8:11], v[84:87], v[96:99]
ds_read_b128 v[80:83], v1 offset:4096
v_mfma_f32_16x16x32_bf16 v[100:103], a[12:15], v[84:87], v[100:103]
s_waitcnt lgkmcnt(4)
v_mfma_f32_16x16x32_bf16 v[96:99], a[16:19], v[88:91], v[96:99]
ds_read_b128 v[84:87], v1 offset:5120
v_mfma_f32_16x16x32_bf16 v[100:103], a[20:23], v[88:91], v[100:103]
s_waitcnt lgkmcnt(2)
v_mfma_f32_16x16x32_bf16 v[96:99], a[24:27], v[92:95], v[96:99]
ds_read_b128 v[88:91], v1 offset:6144
v_add_f32 v7, v104, v106
v_add_f32 v8, v105, v107
v_mfma_f32_16x16x32_bf16 v[100:103], a[28:31], v[92:95], v[100:103]
v_add_f32 v9, v108, v110
v_add_f32 v10, v109, v111
s_waitcnt lgkmcnt(2)
v_mfma_f32_16x16x32_bf16 v[96:99], a[32:35], v[80:83], v[96:99]
ds_read_b128 v[92:95], v1 offset:7168
v_add_f32 v7, v7, v9
v_add_f32 v8, v8, v10
v_mfma_f32_16x16x32_bf16 v[100:103], a[36:39], v[80:83], v[100:103]
v_mul_f32 v7, 0x3b124925, v7
v_mul_f32 v8, 0x3b124925, v8
s_waitcnt lgkmcnt(2)
v_mfma_f32_16x16x32_bf16 v[96:99], a[40:43], v[84:87], v[96:99]
ds_read_b128 v[80:83], v1 offset:8192
v_fma_f32 v8, -v7, v7, v8
v_max_f32 v8, 0, v8
v_mfma_f32_16x16x32_bf16 v[100:103], a[44:47], v[84:87], v[100:103]
v_cvt_pk_bf16_f32 v7, v7, v7
v_and_b32 v7, 0xffff0000, v7
s_waitcnt lgkmcnt(2)
v_mfma_f32_16x16x32_bf16 v[96:99], a[48:51], v[88:91], v[96:99]
ds_read_b128 v[84:87], v1 offset:9216
v_cvt_pk_bf16_f32 v8, v8, v8
v_and_b32 v8, 0xffff0000, v8
v_mfma_f32_16x16x32_bf16 v[100:103], a[52:55], v[88:91], v[100:103]
v_add_f32 v8, 0x3727c5ac, v8
v_cvt_pk_bf16_f32 v8, v8, v8
s_waitcnt lgkmcnt(2)
v_mfma_f32_16x16x32_bf16 v[96:99], a[56:59], v[92:95], v[96:99]
ds_read_b128 v[88:91], v1 offset:10240
v_and_b32 v8, 0xffff0000, v8
v_sqrt_f32 v8, v8
v_mfma_f32_16x16x32_bf16 v[100:103], a[60:63], v[92:95], v[100:103]
s_nop 0
v_cvt_pk_bf16_f32 v8, v8, v8
s_waitcnt lgkmcnt(2)
v_mfma_f32_16x16x32_bf16 v[96:99], a[64:67], v[80:83], v[96:99]
ds_read_b128 v[92:95], v1 offset:11264
v_and_b32 v8, 0xffff0000, v8
v_rcp_f32 v8, v8
v_mfma_f32_16x16x32_bf16 v[100:103], a[68:71], v[80:83], v[100:103]
s_nop 0
v_sub_f32 v6, 0, v7
s_waitcnt lgkmcnt(2)
v_mfma_f32_16x16x32_bf16 v[96:99], a[72:75], v[84:87], v[96:99]
ds_read_b128 v[80:83], v1 offset:12288
v_mov_b32 v5, s29
v_mfma_f32_16x16x32_bf16 v[100:103], a[76:79], v[84:87], v[100:103]
s_waitcnt lgkmcnt(2)
v_mfma_f32_16x16x32_bf16 v[96:99], a[80:83], v[88:91], v[96:99]
ds_read_b128 v[84:87], v1 offset:13312
v_mfma_f32_16x16x32_bf16 v[100:103], a[84:87], v[88:91], v[100:103]
s_waitcnt lgkmcnt(2)
v_mfma_f32_16x16x32_bf16 v[96:99], a[88:91], v[92:95], v[96:99]
v_mfma_f32_16x16x32_bf16 v[100:103], a[92:95], v[92:95], v[100:103]
s_waitcnt lgkmcnt(1)
v_mfma_f32_16x16x32_bf16 v[96:99], a[96:99], v[80:83], v[96:99]
v_mfma_f32_16x16x32_bf16 v[100:103], a[100:103], v[80:83], v[100:103]
s_waitcnt lgkmcnt(0)
v_mfma_f32_16x16x32_bf16 v[96:99], a[104:107], v[84:87], v[96:99]
v_mfma_f32_16x16x32_bf16 v[100:103], a[108:111], v[84:87], v[100:103]
s_nop 6
v_pk_fma_f32 v[96:97], v[24:25], v[6:7], v[96:97] op_sel_hi:[1,0,1]
v_pk_fma_f32 v[98:99], v[26:27], v[6:7], v[98:99] op_sel_hi:[1,0,1]
v_pk_fma_f32 v[100:101], v[28:29], v[6:7], v[100:101] op_sel_hi:[1,0,1]
v_pk_fma_f32 v[102:103], v[30:31], v[6:7], v[102:103] op_sel_hi:[1,0,1]
v_pk_fma_f32 v[96:97], v[96:97], v[8:9], v[16:17] op_sel_hi:[1,0,1]
v_pk_fma_f32 v[98:99], v[98:99], v[8:9], v[18:19] op_sel_hi:[1,0,1]
v_pk_fma_f32 v[100:101], v[100:101], v[8:9], v[20:21] op_sel_hi:[1,0,1]
v_pk_fma_f32 v[102:103], v[102:103], v[8:9], v[22:23] op_sel_hi:[1,0,1]
v_pk_mul_f32 v[48:49], v[96:97], v[96:97]
v_pk_mul_f32 v[50:51], v[98:99], v[98:99]
v_pk_mul_f32 v[52:53], v[100:101], v[100:101]
v_pk_mul_f32 v[54:55], v[102:103], v[102:103]
v_fma_f32 v48, v48, s30, v5
v_fma_f32 v49, v49, s30, v5
v_fma_f32 v50, v50, s30, v5
v_fma_f32 v51, v51, s30, v5
v_fma_f32 v52, v52, s30, v5
v_fma_f32 v53, v53, s30, v5
v_fma_f32 v54, v54, s30, v5
v_fma_f32 v55, v55, s30, v5
v_pk_mul_f32 v[48:49], v[48:49], v[96:97]
v_pk_mul_f32 v[50:51], v[50:51], v[98:99]
v_pk_mul_f32 v[52:53], v[52:53], v[100:101]
v_pk_mul_f32 v[54:55], v[54:55], v[102:103]
v_exp_f32 v48, v48
v_exp_f32 v49, v49
v_exp_f32 v50, v50
v_exp_f32 v51, v51
v_exp_f32 v52, v52
v_exp_f32 v53, v53
v_exp_f32 v54, v54
v_exp_f32 v55, v55
v_add_f32 v48, 1.0, v48
v_add_f32 v49, 1.0, v49
v_add_f32 v50, 1.0, v50
v_add_f32 v51, 1.0, v51
v_add_f32 v52, 1.0, v52
v_add_f32 v53, 1.0, v53
v_add_f32 v54, 1.0, v54
v_add_f32 v55, 1.0, v55
v_rcp_f32 v48, v48
v_rcp_f32 v49, v49
v_rcp_f32 v50, v50
v_rcp_f32 v51, v51
v_rcp_f32 v52, v52
v_rcp_f32 v53, v53
v_rcp_f32 v54, v54
v_rcp_f32 v55, v55
v_pk_mul_f32 v[96:97], v[96:97], v[48:49]
v_pk_mul_f32 v[98:99], v[98:99], v[50:51]
v_pk_mul_f32 v[100:101], v[100:101], v[52:53]
v_pk_mul_f32 v[102:103], v[102:103], v[54:55]
s_waitcnt vmcnt(0)
v_cvt_pk_bf16_f32 v32, v96, v97
v_cvt_pk_bf16_f32 v33, v98, v99
v_cvt_pk_bf16_f32 v34, v100, v101
v_cvt_pk_bf16_f32 v35, v102, v103
s_cmp_lg_u32 s23, 0
s_cbranch_scc1 Lwt_309
buffer_store_dwordx4 v[32:35], v1, s[4:7], s27 offen
s_branch Lst_310
Lwt_309:
buffer_store_dwordx4 v[32:35], v1, s[4:7], s27 offen sc1
Lst_310:
v_mov_b32 v5, s88
s_waitcnt vmcnt(0)
s_cmp_lg_u32 s23, 0
s_cbranch_scc1 Lwt_311
buffer_store_dword v5, off, s[4:7], s28
s_branch Lst_312
Lwt_311:
buffer_store_dword v5, off, s[4:7], s28 sc1
Lst_312:
s_add_u32 s26, s26, 43008
s_add_u32 s27, s27, 172032
s_add_u32 s28, s28, 672
s_add_u32 s25, s25, 3
s_cmp_lt_u32 s25, 128
s_cbranch_scc1 F1_JOB2
s_endpgm
F1_W3:
s_load_dwordx2 s[8:9], s[0:1], 64
s_mov_b32 s10, 1605632
s_mov_b32 s11, 0x00020000
s_load_dwordx2 s[16:17], s[0:1], 72
s_mov_b32 s18, 3584
s_mov_b32 s19, 0x00020000
v_lshlrev_b32 v1, 4, v0
v_lshrrev_b32 v5, 2, v0
v_mul_u32_u24 v2, 3584, v5
v_and_b32 v6, 3, v0
v_lshl_add_u32 v2, v6, 4, v2
v_lshrrev_b32 v3, 4, v0
v_lshlrev_b32 v4, 4, v3
v_lshlrev_b32 v3, 3, v3
v_and_b32 v5, 3, v5
v_add_u32 v3, v3, v5
v_lshlrev_b32 v3, 6, v3
v_lshl_add_u32 v3, v6, 4, v3
v_add_u32 v3, 118784, v3
s_lshl_b32 s40, s22, 8
s_add_u32 s40, s40, 192
s_waitcnt lgkmcnt(0)
buffer_load_dwordx4 v[32:35], v4, s[16:19], s40 offen
s_mov_b32 m0, 118784
s_add_u32 s41, s40, 0
buffer_load_dwordx4 v2, s[8:11], s41 offen lds
s_mov_b32 m0, 119808
s_add_u32 s41, s40, 57344
buffer_load_dwordx4 v2, s[8:11], s41 offen lds
s_mov_b32 m0, 120832
s_add_u32 s41, s40, 114688
buffer_load_dwordx4 v2, s[8:11], s41 offen lds
s_mov_b32 m0, 121856
s_add_u32 s41, s40, 172032
buffer_load_dwordx4 v2, s[8:11], s41 offen lds
s_mov_b32 m0, 122880
s_add_u32 s41, s40, 229376
buffer_load_dwordx4 v2, s[8:11], s41 offen lds
s_mov_b32 m0, 123904
s_add_u32 s41, s40, 286720
buffer_load_dwordx4 v2, s[8:11], s41 offen lds
s_mov_b32 m0, 124928
s_add_u32 s41, s40, 344064
buffer_load_dwordx4 v2, s[8:11], s41 offen lds
s_mov_b32 m0, 125952
s_add_u32 s41, s40, 401408
buffer_load_dwordx4 v2, s[8:11], s41 offen lds
s_mov_b32 m0, 126976
s_add_u32 s41, s40, 458752
buffer_load_dwordx4 v2, s[8:11], s41 offen lds
s_mov_b32 m0, 128000
s_add_u32 s41, s40, 516096
buffer_load_dwordx4 v2, s[8:11], s41 offen lds
s_mov_b32 m0, 129024
s_add_u32 s41, s40, 573440
buffer_load_dwordx4 v2, s[8:11], s41 offen lds
s_mov_b32 m0, 130048
s_add_u32 s41, s40, 630784
buffer_load_dwordx4 v2, s[8:11], s41 offen lds
s_mov_b32 m0, 131072
s_add_u32 s41, s40, 688128
buffer_load_dwordx4 v2, s[8:11], s41 offen lds
s_mov_b32 m0, 132096
s_add_u32 s41, s40, 745472
buffer_load_dwordx4 v2, s[8:11], s41 offen lds
s_mov_b32 m0, 133120
s_add_u32 s41, s40, 802816
buffer_load_dwordx4 v2, s[8:11], s41 offen lds
s_mov_b32 m0, 134144
s_add_u32 s41, s40, 860160
buffer_load_dwordx4 v2, s[8:11], s41 offen lds
s_mov_b32 m0, 135168
s_add_u32 s41, s40, 917504
buffer_load_dwordx4 v2, s[8:11], s41 offen lds
s_mov_b32 m0, 136192
s_add_u32 s41, s40, 974848
buffer_load_dwordx4 v2, s[8:11], s41 offen lds
s_mov_b32 m0, 137216
s_add_u32 s41, s40, 1032192
buffer_load_dwordx4 v2, s[8:11], s41 offen lds
s_mov_b32 m0, 138240
s_add_u32 s41, s40, 1089536
buffer_load_dwordx4 v2, s[8:11], s41 offen lds
s_mov_b32 m0, 139264
s_add_u32 s41, s40, 1146880
buffer_load_dwordx4 v2, s[8:11], s41 offen lds
s_mov_b32 m0, 140288
s_add_u32 s41, s40, 1204224
buffer_load_dwordx4 v2, s[8:11], s41 offen lds
s_mov_b32 m0, 141312
s_add_u32 s41, s40, 1261568
buffer_load_dwordx4 v2, s[8:11], s41 offen lds
s_mov_b32 m0, 142336
s_add_u32 s41, s40, 1318912
buffer_load_dwordx4 v2, s[8:11], s41 offen lds
s_mov_b32 m0, 143360
s_add_u32 s41, s40, 1376256
buffer_load_dwordx4 v2, s[8:11], s41 offen lds
s_mov_b32 m0, 144384
s_add_u32 s41, s40, 1433600
buffer_load_dwordx4 v2, s[8:11], s41 offen lds
s_mov_b32 m0, 145408
s_add_u32 s41, s40, 1490944
buffer_load_dwordx4 v2, s[8:11], s41 offen lds
s_mov_b32 m0, 146432
s_add_u32 s41, s40, 1548288
buffer_load_dwordx4 v2, s[8:11], s41 offen lds
v_and_b32 v4, 15, v0
v_lshlrev_b32 v4, 5, v4
v_add_u32 v4, 14336, v4
v_bfe_u32 v5, v0, 2, 2
v_lshrrev_b32 v6, 4, v0
v_cmp_eq_u32 vcc, v5, v6
v_add_u32 v5, 24, v4
v_lshlrev_b32 v14, 3, v0
v_add_u32 v14, 14848, v14
v_cndmask_b32 v14, v14, v5, vcc
v_and_b32 v5, 1, v0
v_cmp_ne_u32 s[32:33], 0, v5
v_and_b32 v5, 2, v0
v_cmp_ne_u32 s[34:35], 0, v5
s_mul_i32 s26, s21, 14336
s_add_u32 s26, s26, 4381696
s_mul_i32 s27, s21, 57344
s_lshl_b32 s41, s22, 12
s_add_u32 s27, s27, s41
s_add_u32 s27, s27, 22727680
s_mul_i32 s28, s21, 224
s_lshl_b32 s41, s22, 4
s_add_u32 s28, s28, s41
s_add_u32 s28, s28, 143372
s_mov_b32 s29, 0xc0135761
s_mov_b32 s30, 0xbdd2d3e8
s_mov_b32 s25, s21
s_waitcnt vmcnt(0)
v_lshlrev_b32 v16, 16, v32
v_and_b32 v17, 0xffff0000, v32
v_lshlrev_b32 v18, 16, v33
v_and_b32 v19, 0xffff0000, v33
v_lshlrev_b32 v20, 16, v34
v_and_b32 v21, 0xffff0000, v34
v_lshlrev_b32 v22, 16, v35
v_and_b32 v23, 0xffff0000, v35
v_mov_b32 v112, 0x3f803f80
v_mov_b32 v113, 0x3f803f80
v_mov_b32 v114, 0x3f803f80
v_mov_b32 v115, 0x3f803f80
ds_read_b64_tr_b16 a[0:1], v3
ds_read_b64_tr_b16 a[2:3], v3 offset:256
ds_read_b64_tr_b16 a[4:5], v3 offset:8
ds_read_b64_tr_b16 a[6:7], v3 offset:264
ds_read_b64_tr_b16 a[8:9], v3 offset:2048
ds_read_b64_tr_b16 a[10:11], v3 offset:2304
ds_read_b64_tr_b16 a[12:13], v3 offset:2056
ds_read_b64_tr_b16 a[14:15], v3 offset:2312
ds_read_b64_tr_b16 a[16:17], v3 offset:4096
ds_read_b64_tr_b16 a[18:19], v3 offset:4352
ds_read_b64_tr_b16 a[20:21], v3 offset:4104
ds_read_b64_tr_b16 a[22:23], v3 offset:4360
s_waitcnt lgkmcnt(0)
ds_read_b64_tr_b16 a[24:25], v3 offset:6144
ds_read_b64_tr_b16 a[26:27], v3 offset:6400
ds_read_b64_tr_b16 a[28:29], v3 offset:6152
ds_read_b64_tr_b16 a[30:31], v3 offset:6408
ds_read_b64_tr_b16 a[32:33], v3 offset:8192
ds_read_b64_tr_b16 a[34:35], v3 offset:8448
ds_read_b64_tr_b16 a[36:37], v3 offset:8200
ds_read_b64_tr_b16 a[38:39], v3 offset:8456
ds_read_b64_tr_b16 a[40:41], v3 offset:10240
ds_read_b64_tr_b16 a[42:43], v3 offset:10496
ds_read_b64_tr_b16 a[44:45], v3 offset:10248
ds_read_b64_tr_b16 a[46:47], v3 offset:10504
s_waitcnt lgkmcnt(0)
ds_read_b64_tr_b16 a[48:49], v3 offset:12288
ds_read_b64_tr_b16 a[50:51], v3 offset:12544
ds_read_b64_tr_b16 a[52:53], v3 offset:12296
ds_read_b64_tr_b16 a[54:55], v3 offset:12552
ds_read_b64_tr_b16 a[56:57], v3 offset:14336
ds_read_b64_tr_b16 a[58:59], v3 offset:14592
ds_read_b64_tr_b16 a[60:61], v3 offset:14344
ds_read_b64_tr_b16 a[62:63], v3 offset:14600
ds_read_b64_tr_b16 a[64:65], v3 offset:16384
ds_read_b64_tr_b16 a[66:67], v3 offset:16640
ds_read_b64_tr_b16 a[68:69], v3 offset:16392
ds_read_b64_tr_b16 a[70:71], v3 offset:16648
s_waitcnt lgkmcnt(0)
ds_read_b64_tr_b16 a[72:73], v3 offset:18432
ds_read_b64_tr_b16 a[74:75], v3 offset:18688
ds_read_b64_tr_b16 a[76:77], v3 offset:18440
ds_read_b64_tr_b16 a[78:79], v3 offset:18696
ds_read_b64_tr_b16 a[80:81], v3 offset:20480
ds_read_b64_tr_b16 a[82:83], v3 offset:20736
ds_read_b64_tr_b16 a[84:85], v3 offset:20488
ds_read_b64_tr_b16 a[86:87], v3 offset:20744
ds_read_b64_tr_b16 a[88:89], v3 offset:22528
ds_read_b64_tr_b16 a[90:91], v3 offset:22784
ds_read_b64_tr_b16 a[92:93], v3 offset:22536
ds_read_b64_tr_b16 a[94:95], v3 offset:22792
s_waitcnt lgkmcnt(0)
ds_read_b64_tr_b16 a[96:97], v3 offset:24576
ds_read_b64_tr_b16 a[98:99], v3 offset:24832
ds_read_b64_tr_b16 a[100:101], v3 offset:24584
ds_read_b64_tr_b16 a[102:103], v3 offset:24840
ds_read_b64_tr_b16 a[104:105], v3 offset:26624
ds_read_b64_tr_b16 a[106:107], v3 offset:26880
ds_read_b64_tr_b16 a[108:109], v3 offset:26632
ds_read_b64_tr_b16 a[110:111], v3 offset:26888
s_waitcnt lgkmcnt(0)
v_mfma_f32_16x16x32_bf16 v[24:27], a[0:3], v[112:115], 0
v_mfma_f32_16x16x32_bf16 v[28:31], a[4:7], v[112:115], 0
v_mfma_f32_16x16x32_bf16 v[24:27], a[8:11], v[112:115], v[24:27]
v_mfma_f32_16x16x32_bf16 v[28:31], a[12:15], v[112:115], v[28:31]
v_mfma_f32_16x16x32_bf16 v[24:27], a[16:19], v[112:115], v[24:27]
v_mfma_f32_16x16x32_bf16 v[28:31], a[20:23], v[112:115], v[28:31]
v_mfma_f32_16x16x32_bf16 v[24:27], a[24:27], v[112:115], v[24:27]
v_mfma_f32_16x16x32_bf16 v[28:31], a[28:31], v[112:115], v[28:31]
v_mfma_f32_16x16x32_bf16 v[24:27], a[32:35], v[112:115], v[24:27]
v_mfma_f32_16x16x32_bf16 v[28:31], a[36:39], v[112:115], v[28:31]
v_mfma_f32_16x16x32_bf16 v[24:27], a[40:43], v[112:115], v[24:27]
v_mfma_f32_16x16x32_bf16 v[28:31], a[44:47], v[112:115], v[28:31]
v_mfma_f32_16x16x32_bf16 v[24:27], a[48:51], v[112:115], v[24:27]
v_mfma_f32_16x16x32_bf16 v[28:31], a[52:55], v[112:115], v[28:31]
v_mfma_f32_16x16x32_bf16 v[24:27], a[56:59], v[112:115], v[24:27]
v_mfma_f32_16x16x32_bf16 v[28:31], a[60:63], v[112:115], v[28:31]
v_mfma_f32_16x16x32_bf16 v[24:27], a[64:67], v[112:115], v[24:27]
v_mfma_f32_16x16x32_bf16 v[28:31], a[68:71], v[112:115], v[28:31]
v_mfma_f32_16x16x32_bf16 v[24:27], a[72:75], v[112:115], v[24:27]
v_mfma_f32_16x16x32_bf16 v[28:31], a[76:79], v[112:115], v[28:31]
v_mfma_f32_16x16x32_bf16 v[24:27], a[80:83], v[112:115], v[24:27]
v_mfma_f32_16x16x32_bf16 v[28:31], a[84:87], v[112:115], v[28:31]
v_mfma_f32_16x16x32_bf16 v[24:27], a[88:91], v[112:115], v[24:27]
v_mfma_f32_16x16x32_bf16 v[28:31], a[92:95], v[112:115], v[28:31]
v_mfma_f32_16x16x32_bf16 v[24:27], a[96:99], v[112:115], v[24:27]
v_mfma_f32_16x16x32_bf16 v[28:31], a[100:103], v[112:115], v[28:31]
v_mfma_f32_16x16x32_bf16 v[24:27], a[104:107], v[112:115], v[24:27]
v_mfma_f32_16x16x32_bf16 v[28:31], a[108:111], v[112:115], v[28:31]
v_min_u32 v12, 47, v0
v_and_b32 v5, 3, v12
v_lshlrev_b32 v5, 3, v5
v_lshrrev_b32 v12, 2, v12
v_lshl_add_u32 v5, v12, 7, v5
s_mov_b32 s43, 6144
Llz_313:
buffer_load_dwordx2 v[12:13], v5, s[4:7], s43 offen sc1
s_waitcnt vmcnt(0)
v_cmp_ne_u32 vcc, s88, v12
v_cmp_ne_u32 s[40:41], s88, v13
s_or_b64 vcc, vcc, s[40:41]
s_cbranch_vccz Llzok_314
s_sleep 8
s_sub_u32 s24, s24, 1
s_cbranch_scc0 Llz_313
s_endpgm
Llzok_314:
F1_JOB3:
s_barrier
buffer_load_dwordx4 v[32:35], v1, s[4:7], s26 offen sc1
buffer_load_dwordx4 v[36:39], v1, s[4:7], s26 offen offset:1024 sc1
buffer_load_dwordx4 v[40:43], v1, s[4:7], s26 offen offset:2048 sc1
s_sleep 6
Lspin_315:
buffer_load_dwordx4 v[32:35], v1, s[4:7], s26 offen sc1
buffer_load_dwordx4 v[36:39], v1, s[4:7], s26 offen offset:1024 sc1
buffer_load_dwordx4 v[40:43], v1, s[4:7], s26 offen offset:2048 sc1
s_sub_u32 s24, s24, 1
s_cbranch_scc1 CODE_END
s_waitcnt vmcnt(3)
v_max3_u32 v5, v32, v33, v34
v_max3_u32 v5, v5, v35, v36
v_max3_u32 v5, v5, v37, v38
v_max3_u32 v5, v5, v39, v40
v_max3_u32 v5, v5, v41, v42
v_max_u32 v5, v5, v43
v_cmp_eq_u32 vcc, -1, v5
s_cbranch_vccz Lspin_315x
s_cmp_ge_u32 s25, 120
s_cbranch_scc1 Lspin_315
s_sleep 8
s_branch Lspin_315
Lspin_315x:
v_mfma_f32_16x16x32_bf16 v[48:51], v[32:35], v[32:35], 0
ds_write_b128 v1, v[32:35] offset:11264
v_mfma_f32_16x16x32_bf16 v[48:51], v[36:39], v[36:39], v[48:51]
ds_write_b128 v1, v[36:39] offset:12288
v_mfma_f32_16x16x32_bf16 v[48:51], v[40:43], v[40:43], v[48:51]
ds_write_b128 v1, v[40:43] offset:13312
v_mfma_f32_16x16x32_bf16 v[52:55], v[112:115], v[32:35], 0
v_mfma_f32_16x16x32_bf16 v[52:55], v[112:115], v[36:39], v[52:55]
v_mfma_f32_16x16x32_bf16 v[52:55], v[112:115], v[40:43], v[52:55]
v_cndmask_b32 v48, v48, v49, s[32:33]
v_cndmask_b32 v50, v50, v51, s[32:33]
s_nop 5
v_cndmask_b32 v53, v48, v50, s[34:35]
ds_write_b64 v14, v[52:53]
s_waitcnt lgkmcnt(0)
s_barrier
ds_read_b128 v[80:83], v1
ds_read_b128 v[84:87], v1 offset:1024
ds_read_b128 v[88:91], v1 offset:2048
ds_read_b128 v[104:107], v4
ds_read_b128 v[108:111], v4 offset:16
s_waitcnt lgkmcnt(4)
v_mfma_f32_16x16x32_bf16 v[96:99], a[0:3], v[80:83], 0
ds_read_b128 v[92:95], v1 offset:3072
v_mfma_f32_16x16x32_bf16 v[100:103], a[4:7], v[80:83], 0
s_waitcnt lgkmcnt(4)
v_mfma_f32_16x16x32_bf16 v[96:99], a[8:11], v[84:87], v[96:99]
ds_read_b128 v[80:83], v1 offset:4096
v_mfma_f32_16x16x32_bf16 v[100:103], a[12:15], v[84:87], v[100:103]
s_waitcnt lgkmcnt(4)
v_mfma_f32_16x16x32_bf16 v[96:99], a[16:19], v[88:91], v[96:99]
ds_read_b128 v[84:87], v1 offset:5120
v_mfma_f32_16x16x32_bf16 v[100:103], a[20:23], v[88:91], v[100:103]
s_waitcnt lgkmcnt(2)
v_mfma_f32_16x16x32_bf16 v[96:99], a[24:27], v[92:95], v[96:99]
ds_read_b128 v[88:91], v1 offset:6144
v_add_f32 v7, v104, v106
v_add_f32 v8, v105, v107
v_mfma_f32_16x16x32_bf16 v[100:103], a[28:31], v[92:95], v[100:103]
v_add_f32 v9, v108, v110
v_add_f32 v10, v109, v111
s_waitcnt lgkmcnt(2)
v_mfma_f32_16x16x32_bf16 v[96:99], a[32:35], v[80:83], v[96:99]
ds_read_b128 v[92:95], v1 offset:7168
v_add_f32 v7, v7, v9
v_add_f32 v8, v8, v10
v_mfma_f32_16x16x32_bf16 v[100:103], a[36:39], v[80:83], v[100:103]
v_mul_f32 v7, 0x3b124925, v7
v_mul_f32 v8, 0x3b124925, v8
s_waitcnt lgkmcnt(2)
v_mfma_f32_16x16x32_bf16 v[96:99], a[40:43], v[84:87], v[96:99]
ds_read_b128 v[80:83], v1 offset:8192
v_fma_f32 v8, -v7, v7, v8
v_max_f32 v8, 0, v8
v_mfma_f32_16x16x32_bf16 v[100:103], a[44:47], v[84:87], v[100:103]
v_cvt_pk_bf16_f32 v7, v7, v7
v_and_b32 v7, 0xffff0000, v7
s_waitcnt lgkmcnt(2)
v_mfma_f32_16x16x32_bf16 v[96:99], a[48:51], v[88:91], v[96:99]
ds_read_b128 v[84:87], v1 offset:9216
v_cvt_pk_bf16_f32 v8, v8, v8
v_and_b32 v8, 0xffff0000, v8
v_mfma_f32_16x16x32_bf16 v[100:103], a[52:55], v[88:91], v[100:103]
v_add_f32 v8, 0x3727c5ac, v8
v_cvt_pk_bf16_f32 v8, v8, v8
s_waitcnt lgkmcnt(2)
v_mfma_f32_16x16x32_bf16 v[96:99], a[56:59], v[92:95], v[96:99]
ds_read_b128 v[88:91], v1 offset:10240
v_and_b32 v8, 0xffff0000, v8
v_sqrt_f32 v8, v8
v_mfma_f32_16x16x32_bf16 v[100:103], a[60:63], v[92:95], v[100:103]
s_nop 0
v_cvt_pk_bf16_f32 v8, v8, v8
s_waitcnt lgkmcnt(2)
v_mfma_f32_16x16x32_bf16 v[96:99], a[64:67], v[80:83], v[96:99]
ds_read_b128 v[92:95], v1 offset:11264
v_and_b32 v8, 0xffff0000, v8
v_rcp_f32 v8, v8
v_mfma_f32_16x16x32_bf16 v[100:103], a[68:71], v[80:83], v[100:103]
s_nop 0
v_sub_f32 v6, 0, v7
s_waitcnt lgkmcnt(2)
v_mfma_f32_16x16x32_bf16 v[96:99], a[72:75], v[84:87], v[96:99]
ds_read_b128 v[80:83], v1 offset:12288
v_mov_b32 v5, s29
v_mfma_f32_16x16x32_bf16 v[100:103], a[76:79], v[84:87], v[100:103]
s_waitcnt lgkmcnt(2)
v_mfma_f32_16x16x32_bf16 v[96:99], a[80:83], v[88:91], v[96:99]
ds_read_b128 v[84:87], v1 offset:13312
v_mfma_f32_16x16x32_bf16 v[100:103], a[84:87], v[88:91], v[100:103]
s_waitcnt lgkmcnt(2)
v_mfma_f32_16x16x32_bf16 v[96:99], a[88:91], v[92:95], v[96:99]
v_mfma_f32_16x16x32_bf16 v[100:103], a[92:95], v[92:95], v[100:103]
s_waitcnt lgkmcnt(1)
v_mfma_f32_16x16x32_bf16 v[96:99], a[96:99], v[80:83], v[96:99]
v_mfma_f32_16x16x32_bf16 v[100:103], a[100:103], v[80:83], v[100:103]
s_waitcnt lgkmcnt(0)
v_mfma_f32_16x16x32_bf16 v[96:99], a[104:107], v[84:87], v[96:99]
v_mfma_f32_16x16x32_bf16 v[100:103], a[108:111], v[84:87], v[100:103]
s_nop 6
v_pk_fma_f32 v[96:97], v[24:25], v[6:7], v[96:97] op_sel_hi:[1,0,1]
v_pk_fma_f32 v[98:99], v[26:27], v[6:7], v[98:99] op_sel_hi:[1,0,1]
v_pk_fma_f32 v[100:101], v[28:29], v[6:7], v[100:101] op_sel_hi:[1,0,1]
v_pk_fma_f32 v[102:103], v[30:31], v[6:7], v[102:103] op_sel_hi:[1,0,1]
v_pk_fma_f32 v[96:97], v[96:97], v[8:9], v[16:17] op_sel_hi:[1,0,1]
v_pk_fma_f32 v[98:99], v[98:99], v[8:9], v[18:19] op_sel_hi:[1,0,1]
v_pk_fma_f32 v[100:101], v[100:101], v[8:9], v[20:21] op_sel_hi:[1,0,1]
v_pk_fma_f32 v[102:103], v[102:103], v[8:9], v[22:23] op_sel_hi:[1,0,1]
v_pk_mul_f32 v[48:49], v[96:97], v[96:97]
v_pk_mul_f32 v[50:51], v[98:99], v[98:99]
v_pk_mul_f32 v[52:53], v[100:101], v[100:101]
v_pk_mul_f32 v[54:55], v[102:103], v[102:103]
v_fma_f32 v48, v48, s30, v5
v_fma_f32 v49, v49, s30, v5
v_fma_f32 v50, v50, s30, v5
v_fma_f32 v51, v51, s30, v5
v_fma_f32 v52, v52, s30, v5
v_fma_f32 v53, v53, s30, v5
v_fma_f32 v54, v54, s30, v5
v_fma_f32 v55, v55, s30, v5
v_pk_mul_f32 v[48:49], v[48:49], v[96:97]
v_pk_mul_f32 v[50:51], v[50:51], v[98:99]
v_pk_mul_f32 v[52:53], v[52:53], v[100:101]
v_pk_mul_f32 v[54:55], v[54:55], v[102:103]
v_exp_f32 v48, v48
v_exp_f32 v49, v49
v_exp_f32 v50, v50
v_exp_f32 v51, v51
v_exp_f32 v52, v52
v_exp_f32 v53, v53
v_exp_f32 v54, v54
v_exp_f32 v55, v55
v_add_f32 v48, 1.0, v48
v_add_f32 v49, 1.0, v49
v_add_f32 v50, 1.0, v50
v_add_f32 v51, 1.0, v51
v_add_f32 v52, 1.0, v52
v_add_f32 v53, 1.0, v53
v_add_f32 v54, 1.0, v54
v_add_f32 v55, 1.0, v55
v_rcp_f32 v48, v48
v_rcp_f32 v49, v49
v_rcp_f32 v50, v50
v_rcp_f32 v51, v51
v_rcp_f32 v52, v52
v_rcp_f32 v53, v53
v_rcp_f32 v54, v54
v_rcp_f32 v55, v55
v_pk_mul_f32 v[96:97], v[96:97], v[48:49]
v_pk_mul_f32 v[98:99], v[98:99], v[50:51]
v_pk_mul_f32 v[100:101], v[100:101], v[52:53]
v_pk_mul_f32 v[102:103], v[102:103], v[54:55]
s_waitcnt vmcnt(0)
v_cvt_pk_bf16_f32 v32, v96, v97
v_cvt_pk_bf16_f32 v33, v98, v99
v_cvt_pk_bf16_f32 v34, v100, v101
v_cvt_pk_bf16_f32 v35, v102, v103
s_cmp_lg_u32 s23, 0
s_cbranch_scc1 Lwt_316
buffer_store_dwordx4 v[32:35], v1, s[4:7], s27 offen
s_branch Lst_317
Lwt_316:
buffer_store_dwordx4 v[32:35], v1, s[4:7], s27 offen sc1
Lst_317:
v_mov_b32 v5, s88
s_waitcnt vmcnt(0)
s_cmp_lg_u32 s23, 0
s_cbranch_scc1 Lwt_318
buffer_store_dword v5, off, s[4:7], s28
s_branch Lst_319
Lwt_318:
buffer_store_dword v5, off, s[4:7], s28 sc1
Lst_319:
s_add_u32 s26, s26, 43008
s_add_u32 s27, s27, 172032
s_add_u32 s28, s28, 672
s_add_u32 s25, s25, 3
s_cmp_lt_u32 s25, 128
s_cbranch_scc1 F1_JOB3
s_endpgm
F2_W0:
s_load_dwordx2 s[8:9], s[0:1], 80
s_mov_b32 s10, 1605632
s_mov_b32 s11, 0x00020000
s_load_dwordx2 s[16:17], s[0:1], 88
s_mov_b32 s18, 896
s_mov_b32 s19, 0x00020000
s_load_dwordx2 s[12:13], s[0:1], 96
s_mov_b32 s14, 1835008
s_mov_b32 s15, 0x00020000
s_sub_u32 s22, s22, 14
v_lshlrev_b32 v1, 4, v0
v_lshrrev_b32 v9, 2, v0
v_mul_u32_u24 v2, 896, v9
v_and_b32 v10, 3, v0
v_lshl_add_u32 v2, v10, 4, v2
v_lshrrev_b32 v3, 4, v0
v_lshlrev_b32 v3, 3, v3
v_and_b32 v9, 3, v9
v_add_u32 v3, v3, v9
v_lshlrev_b32 v3, 6, v3
v_lshl_add_u32 v3, v10, 3, v3
v_add_u32 v3, 16384, v3
v_min_u32 v4, 13, v0
v_lshlrev_b32 v4, 2, v4
v_and_b32 v9, 15, v0
v_lshrrev_b32 v10, 4, v0
v_mul_u32_u24 v5, 144, v9
v_lshl_add_u32 v5, v10, 4, v5
v_add_u32 v5, 0, v5
v_add_u32 v10, 0, v10
v_mul_u32_u24 v6, 144, v10
v_lshl_add_u32 v6, v9, 3, v6
v_mul_u32_u24 v8, 896, v10
v_lshl_add_u32 v8, v9, 2, v8
v_lshlrev_b32 v7, 4, v10
v_lshrrev_b32 v10, 2, v9
v_lshl_add_u32 v7, v10, 8, v7
v_and_b32 v10, 3, v9
v_lshl_add_u32 v7, v10, 2, v7
v_lshlrev_b32 v9, 2, v9
s_lshl_b32 s40, s22, 6
s_waitcnt lgkmcnt(0)
buffer_load_dword v11, v9, s[16:19], s40 offen
s_add_u32 s40, s40, 0
s_mov_b32 m0, 16384
s_add_u32 s41, s40, 0
buffer_load_dwordx4 v2, s[8:11], s41 offen lds
s_mov_b32 m0, 17408
s_add_u32 s41, s40, 14336
buffer_load_dwordx4 v2, s[8:11], s41 offen lds
s_mov_b32 m0, 18432
s_add_u32 s41, s40, 28672
buffer_load_dwordx4 v2, s[8:11], s41 offen lds
s_mov_b32 m0, 19456
s_add_u32 s41, s40, 43008
buffer_load_dwordx4 v2, s[8:11], s41 offen lds
s_mov_b32 m0, 20480
s_add_u32 s41, s40, 57344
buffer_load_dwordx4 v2, s[8:11], s41 offen lds
s_mov_b32 m0, 21504
s_add_u32 s41, s40, 71680
buffer_load_dwordx4 v2, s[8:11], s41 offen lds
s_mov_b32 m0, 22528
s_add_u32 s41, s40, 86016
buffer_load_dwordx4 v2, s[8:11], s41 offen lds
s_mov_b32 m0, 23552
s_add_u32 s41, s40, 100352
buffer_load_dwordx4 v2, s[8:11], s41 offen lds
s_mov_b32 m0, 24576
s_add_u32 s41, s40, 114688
buffer_load_dwordx4 v2, s[8:11], s41 offen lds
s_mov_b32 m0, 25600
s_add_u32 s41, s40, 129024
buffer_load_dwordx4 v2, s[8:11], s41 offen lds
s_mov_b32 m0, 26624
s_add_u32 s41, s40, 143360
buffer_load_dwordx4 v2, s[8:11], s41 offen lds
s_mov_b32 m0, 27648
s_add_u32 s41, s40, 157696
buffer_load_dwordx4 v2, s[8:11], s41 offen lds
s_mov_b32 m0, 28672
s_add_u32 s41, s40, 172032
buffer_load_dwordx4 v2, s[8:11], s41 offen lds
s_mov_b32 m0, 29696
s_add_u32 s41, s40, 186368
buffer_load_dwordx4 v2, s[8:11], s41 offen lds
s_mov_b32 m0, 30720
s_add_u32 s41, s40, 200704
buffer_load_dwordx4 v2, s[8:11], s41 offen lds
s_mov_b32 m0, 31744
s_add_u32 s41, s40, 215040
buffer_load_dwordx4 v2, s[8:11], s41 offen lds
s_mov_b32 m0, 32768
s_add_u32 s41, s40, 229376
buffer_load_dwordx4 v2, s[8:11], s41 offen lds
s_mov_b32 m0, 33792
s_add_u32 s41, s40, 243712
buffer_load_dwordx4 v2, s[8:11], s41 offen lds
s_mov_b32 m0, 34816
s_add_u32 s41, s40, 258048
buffer_load_dwordx4 v2, s[8:11], s41 offen lds
s_mov_b32 m0, 35840
s_add_u32 s41, s40, 272384
buffer_load_dwordx4 v2, s[8:11], s41 offen lds
s_mov_b32 m0, 36864
s_add_u32 s41, s40, 286720
buffer_load_dwordx4 v2, s[8:11], s41 offen lds
s_mov_b32 m0, 37888
s_add_u32 s41, s40, 301056
buffer_load_dwordx4 v2, s[8:11], s41 offen lds
s_mov_b32 m0, 38912
s_add_u32 s41, s40, 315392
buffer_load_dwordx4 v2, s[8:11], s41 offen lds
s_mov_b32 m0, 39936
s_add_u32 s41, s40, 329728
buffer_load_dwordx4 v2, s[8:11], s41 offen lds
s_mov_b32 m0, 40960
s_add_u32 s41, s40, 344064
buffer_load_dwordx4 v2, s[8:11], s41 offen lds
s_mov_b32 m0, 41984
s_add_u32 s41, s40, 358400
buffer_load_dwordx4 v2, s[8:11], s41 offen lds
s_mov_b32 m0, 43008
s_add_u32 s41, s40, 372736
buffer_load_dwordx4 v2, s[8:11], s41 offen lds
s_mov_b32 m0, 44032
s_add_u32 s41, s40, 387072
buffer_load_dwordx4 v2, s[8:11], s41 offen lds
s_waitcnt vmcnt(0)
ds_read_b64_tr_b16 a[0:1], v3
ds_read_b64_tr_b16 a[2:3], v3 offset:256
ds_read_b64_tr_b16 a[4:5], v3 offset:32
ds_read_b64_tr_b16 a[6:7], v3 offset:288
ds_read_b64_tr_b16 a[8:9], v3 offset:2048
ds_read_b64_tr_b16 a[10:11], v3 offset:2304
ds_read_b64_tr_b16 a[12:13], v3 offset:2080
ds_read_b64_tr_b16 a[14:15], v3 offset:2336
ds_read_b64_tr_b16 a[16:17], v3 offset:4096
ds_read_b64_tr_b16 a[18:19], v3 offset:4352
ds_read_b64_tr_b16 a[20:21], v3 offset:4128
ds_read_b64_tr_b16 a[22:23], v3 offset:4384
s_waitcnt lgkmcnt(0)
ds_read_b64_tr_b16 a[24:25], v3 offset:6144
ds_read_b64_tr_b16 a[26:27], v3 offset:6400
ds_read_b64_tr_b16 a[28:29], v3 offset:6176
ds_read_b64_tr_b16 a[30:31], v3 offset:6432
ds_read_b64_tr_b16 a[32:33], v3 offset:8192
ds_read_b64_tr_b16 a[34:35], v3 offset:8448
ds_read_b64_tr_b16 a[36:37], v3 offset:8224
ds_read_b64_tr_b16 a[38:39], v3 offset:8480
ds_read_b64_tr_b16 a[40:41], v3 offset:10240
ds_read_b64_tr_b16 a[42:43], v3 offset:10496
ds_read_b64_tr_b16 a[44:45], v3 offset:10272
ds_read_b64_tr_b16 a[46:47], v3 offset:10528
s_waitcnt lgkmcnt(0)
ds_read_b64_tr_b16 a[48:49], v3 offset:12288
ds_read_b64_tr_b16 a[50:51], v3 offset:12544
ds_read_b64_tr_b16 a[52:53], v3 offset:12320
ds_read_b64_tr_b16 a[54:55], v3 offset:12576
ds_read_b64_tr_b16 a[56:57], v3 offset:14336
ds_read_b64_tr_b16 a[58:59], v3 offset:14592
ds_read_b64_tr_b16 a[60:61], v3 offset:14368
ds_read_b64_tr_b16 a[62:63], v3 offset:14624
ds_read_b64_tr_b16 a[64:65], v3 offset:16384
ds_read_b64_tr_b16 a[66:67], v3 offset:16640
ds_read_b64_tr_b16 a[68:69], v3 offset:16416
ds_read_b64_tr_b16 a[70:71], v3 offset:16672
s_waitcnt lgkmcnt(0)
ds_read_b64_tr_b16 a[72:73], v3 offset:18432
ds_read_b64_tr_b16 a[74:75], v3 offset:18688
ds_read_b64_tr_b16 a[76:77], v3 offset:18464
ds_read_b64_tr_b16 a[78:79], v3 offset:18720
ds_read_b64_tr_b16 a[80:81], v3 offset:20480
ds_read_b64_tr_b16 a[82:83], v3 offset:20736
ds_read_b64_tr_b16 a[84:85], v3 offset:20512
ds_read_b64_tr_b16 a[86:87], v3 offset:20768
ds_read_b64_tr_b16 a[88:89], v3 offset:22528
ds_read_b64_tr_b16 a[90:91], v3 offset:22784
ds_read_b64_tr_b16 a[92:93], v3 offset:22560
ds_read_b64_tr_b16 a[94:95], v3 offset:22816
s_waitcnt lgkmcnt(0)
ds_read_b64_tr_b16 a[96:97], v3 offset:24576
ds_read_b64_tr_b16 a[98:99], v3 offset:24832
ds_read_b64_tr_b16 a[100:101], v3 offset:24608
ds_read_b64_tr_b16 a[102:103], v3 offset:24864
ds_read_b64_tr_b16 a[104:105], v3 offset:26624
ds_read_b64_tr_b16 a[106:107], v3 offset:26880
ds_read_b64_tr_b16 a[108:109], v3 offset:26656
ds_read_b64_tr_b16 a[110:111], v3 offset:26912
s_waitcnt lgkmcnt(0)
v_lshlrev_b32 v12, 16, v11
v_and_b32 v13, 0xffff0000, v11
s_mul_i32 s26, s21, 57344
s_add_u32 s26, s26, 22724608
s_mul_i32 s27, s21, 224
s_add_u32 s27, s27, 143360
s_mul_i32 s29, s21, 14336
s_lshl_b32 s40, s22, 10
s_add_u32 s28, s29, s40
s_add_u32 s28, s28, 4370432
s_lshl_b32 s40, s22, 6
s_add_u32 s29, s29, s40
s_mov_b32 s25, s21
s_lshl_b32 s30, s22, 10
s_add_u32 s30, s30, 344064
v_and_b32 v80, 7, v0
v_lshlrev_b32 v80, 7, v80
v_min_u32 v14, 47, v0
v_and_b32 v9, 3, v14
v_lshlrev_b32 v9, 3, v9
v_lshrrev_b32 v14, 2, v14
v_lshl_add_u32 v9, v14, 7, v9
s_mov_b32 s43, 6144
Llz_320:
buffer_load_dwordx2 v[14:15], v9, s[4:7], s43 offen sc1
s_waitcnt vmcnt(0)
v_cmp_ne_u32 vcc, s88, v14
v_cmp_ne_u32 s[40:41], s88, v15
s_or_b64 vcc, vcc, s[40:41]
s_cbranch_vccz Llzok_321
s_sleep 8
s_sub_u32 s24, s24, 1
s_cbranch_scc0 Llz_320
s_endpgm
Llzok_321:
F2_JOB0:
s_barrier
Ljob_322:
buffer_load_dword v11, v7, s[4:7], s28 offen sc1
buffer_load_dword v9, v4, s[4:7], s27 offen sc1
s_sub_u32 s24, s24, 1
s_cbranch_scc1 CODE_END
s_waitcnt vmcnt(0)
v_cmp_eq_u32 s[40:41], -1, v11
v_cmp_ne_u32 vcc, s88, v9
s_or_b64 vcc, vcc, s[40:41]
s_cbranch_scc1 Ljob_322
s_mov_b32 s40, s26
buffer_load_dwordx4 v[16:19], v1, s[4:7], s40 offen sc1
buffer_load_dwordx4 v[20:23], v1, s[4:7], s40 offen offset:1024 sc1
buffer_load_dwordx4 v[24:27], v1, s[4:7], s40 offen offset:2048 sc1
buffer_load_dwordx4 v[28:31], v1, s[4:7], s40 offen offset:3072 sc1
s_add_u32 s40, s40, 4096
buffer_load_dwordx4 v[32:35], v1, s[4:7], s40 offen sc1
buffer_load_dwordx4 v[36:39], v1, s[4:7], s40 offen offset:1024 sc1
buffer_load_dwordx4 v[40:43], v1, s[4:7], s40 offen offset:2048 sc1
buffer_load_dwordx4 v[44:47], v1, s[4:7], s40 offen offset:3072 sc1
s_add_u32 s40, s40, 4096
buffer_load_dwordx4 v[48:51], v1, s[4:7], s40 offen sc1
buffer_load_dwordx4 v[52:55], v1, s[4:7], s40 offen offset:1024 sc1
buffer_load_dwordx4 v[56:59], v1, s[4:7], s40 offen offset:2048 sc1
buffer_load_dwordx4 v[60:63], v1, s[4:7], s40 offen offset:3072 sc1
s_add_u32 s40, s40, 4096
buffer_load_dwordx4 v[64:67], v1, s[4:7], s40 offen sc1
buffer_load_dwordx4 v[68:71], v1, s[4:7], s40 offen offset:1024 sc1
v_lshlrev_b32 v14, 16, v11
v_and_b32 v15, 0xffff0000, v11
s_waitcnt vmcnt(13)
v_mfma_f32_16x16x32_bf16 v[72:75], a[0:3], v[16:19], 0
v_mfma_f32_16x16x32_bf16 v[76:79], a[4:7], v[16:19], 0
s_waitcnt vmcnt(12)
v_mfma_f32_16x16x32_bf16 v[72:75], a[8:11], v[20:23], v[72:75]
v_mfma_f32_16x16x32_bf16 v[76:79], a[12:15], v[20:23], v[76:79]
s_waitcnt vmcnt(11)
v_mfma_f32_16x16x32_bf16 v[72:75], a[16:19], v[24:27], v[72:75]
v_mfma_f32_16x16x32_bf16 v[76:79], a[20:23], v[24:27], v[76:79]
s_waitcnt vmcnt(10)
v_mfma_f32_16x16x32_bf16 v[72:75], a[24:27], v[28:31], v[72:75]
v_mfma_f32_16x16x32_bf16 v[76:79], a[28:31], v[28:31], v[76:79]
s_waitcnt vmcnt(9)
v_mfma_f32_16x16x32_bf16 v[72:75], a[32:35], v[32:35], v[72:75]
v_mfma_f32_16x16x32_bf16 v[76:79], a[36:39], v[32:35], v[76:79]
s_waitcnt vmcnt(8)
v_mfma_f32_16x16x32_bf16 v[72:75], a[40:43], v[36:39], v[72:75]
v_mfma_f32_16x16x32_bf16 v[76:79], a[44:47], v[36:39], v[76:79]
s_waitcnt vmcnt(7)
v_mfma_f32_16x16x32_bf16 v[72:75], a[48:51], v[40:43], v[72:75]
v_mfma_f32_16x16x32_bf16 v[76:79], a[52:55], v[40:43], v[76:79]
s_waitcnt vmcnt(6)
v_mfma_f32_16x16x32_bf16 v[72:75], a[56:59], v[44:47], v[72:75]
v_mfma_f32_16x16x32_bf16 v[76:79], a[60:63], v[44:47], v[76:79]
s_waitcnt vmcnt(5)
v_mfma_f32_16x16x32_bf16 v[72:75], a[64:67], v[48:51], v[72:75]
v_mfma_f32_16x16x32_bf16 v[76:79], a[68:71], v[48:51], v[76:79]
s_waitcnt vmcnt(4)
v_mfma_f32_16x16x32_bf16 v[72:75], a[72:75], v[52:55], v[72:75]
v_mfma_f32_16x16x32_bf16 v[76:79], a[76:79], v[52:55], v[76:79]
s_waitcnt vmcnt(3)
v_mfma_f32_16x16x32_bf16 v[72:75], a[80:83], v[56:59], v[72:75]
v_mfma_f32_16x16x32_bf16 v[76:79], a[84:87], v[56:59], v[76:79]
s_waitcnt vmcnt(2)
v_mfma_f32_16x16x32_bf16 v[72:75], a[88:91], v[60:63], v[72:75]
v_mfma_f32_16x16x32_bf16 v[76:79], a[92:95], v[60:63], v[76:79]
s_waitcnt vmcnt(1)
v_mfma_f32_16x16x32_bf16 v[72:75], a[96:99], v[64:67], v[72:75]
v_mfma_f32_16x16x32_bf16 v[76:79], a[100:103], v[64:67], v[76:79]
s_waitcnt vmcnt(0)
v_mfma_f32_16x16x32_bf16 v[72:75], a[104:107], v[68:71], v[72:75]
v_mfma_f32_16x16x32_bf16 v[76:79], a[108:111], v[68:71], v[76:79]
s_nop 6
ds_write_b128 v5, v[72:75]
ds_write_b128 v5, v[76:79] offset:64
s_waitcnt lgkmcnt(0)
s_barrier
ds_read_b64 v[72:73], v6
ds_read_b64 v[74:75], v6 offset:2304
ds_read_b64 v[76:77], v6 offset:4608
ds_read_b64 v[78:79], v6 offset:6912
s_waitcnt lgkmcnt(0)
v_pk_add_f32 v[72:73], v[72:73], v[74:75]
v_pk_add_f32 v[76:77], v[76:77], v[78:79]
v_pk_add_f32 v[72:73], v[72:73], v[12:13]
v_pk_add_f32 v[72:73], v[72:73], v[76:77]
v_cvt_pk_bf16_f32 v73, v72, v73
v_lshlrev_b32 v72, 16, v73
v_and_b32 v73, 0xffff0000, v73
v_pk_add_f32 v[72:73], v[72:73], v[14:15]
v_cvt_pk_bf16_f32 v72, v72, v73
buffer_store_dword v72, v8, s[12:15], s29 offen
s_add_u32 s40, s26, s30
buffer_load_dword v10, v80, s[4:7], s40 offen sc1
s_add_u32 s26, s26, 172032
s_add_u32 s27, s27, 672
s_add_u32 s28, s28, 43008
s_add_u32 s29, s29, 43008
s_add_u32 s25, s25, 3
s_cmp_lt_u32 s25, 128
s_cbranch_scc1 F2_JOB0
s_endpgm
F2_W1:
s_load_dwordx2 s[8:9], s[0:1], 80
s_mov_b32 s10, 1605632
s_mov_b32 s11, 0x00020000
s_load_dwordx2 s[16:17], s[0:1], 88
s_mov_b32 s18, 896
s_mov_b32 s19, 0x00020000
s_load_dwordx2 s[12:13], s[0:1], 96
s_mov_b32 s14, 1835008
s_mov_b32 s15, 0x00020000
s_sub_u32 s22, s22, 14
v_lshlrev_b32 v1, 4, v0
v_lshrrev_b32 v9, 2, v0
v_mul_u32_u24 v2, 896, v9
v_and_b32 v10, 3, v0
v_lshl_add_u32 v2, v10, 4, v2
v_lshrrev_b32 v3, 4, v0
v_lshlrev_b32 v3, 3, v3
v_and_b32 v9, 3, v9
v_add_u32 v3, v3, v9
v_lshlrev_b32 v3, 6, v3
v_lshl_add_u32 v3, v10, 3, v3
v_add_u32 v3, 45056, v3
v_min_u32 v4, 13, v0
v_lshlrev_b32 v4, 2, v4
v_and_b32 v9, 15, v0
v_lshrrev_b32 v10, 4, v0
v_mul_u32_u24 v5, 144, v9
v_lshl_add_u32 v5, v10, 4, v5
v_add_u32 v5, 2304, v5
v_add_u32 v10, 4, v10
v_mul_u32_u24 v6, 144, v10
v_lshl_add_u32 v6, v9, 3, v6
v_mul_u32_u24 v8, 896, v10
v_lshl_add_u32 v8, v9, 2, v8
v_lshlrev_b32 v7, 4, v10
v_lshrrev_b32 v10, 2, v9
v_lshl_add_u32 v7, v10, 8, v7
v_and_b32 v10, 3, v9
v_lshl_add_u32 v7, v10, 2, v7
v_lshlrev_b32 v9, 2, v9
s_lshl_b32 s40, s22, 6
s_waitcnt lgkmcnt(0)
buffer_load_dword v11, v9, s[16:19], s40 offen
s_add_u32 s40, s40, 401408
s_mov_b32 m0, 45056
s_add_u32 s41, s40, 0
buffer_load_dwordx4 v2, s[8:11], s41 offen lds
s_mov_b32 m0, 46080
s_add_u32 s41, s40, 14336
buffer_load_dwordx4 v2, s[8:11], s41 offen lds
s_mov_b32 m0, 47104
s_add_u32 s41, s40, 28672
buffer_load_dwordx4 v2, s[8:11], s41 offen lds
s_mov_b32 m0, 48128
s_add_u32 s41, s40, 43008
buffer_load_dwordx4 v2, s[8:11], s41 offen lds
s_mov_b32 m0, 49152
s_add_u32 s41, s40, 57344
buffer_load_dwordx4 v2, s[8:11], s41 offen lds
s_mov_b32 m0, 50176
s_add_u32 s41, s40, 71680
buffer_load_dwordx4 v2, s[8:11], s41 offen lds
s_mov_b32 m0, 51200
s_add_u32 s41, s40, 86016
buffer_load_dwordx4 v2, s[8:11], s41 offen lds
s_mov_b32 m0, 52224
s_add_u32 s41, s40, 100352
buffer_load_dwordx4 v2, s[8:11], s41 offen lds
s_mov_b32 m0, 53248
s_add_u32 s41, s40, 114688
buffer_load_dwordx4 v2, s[8:11], s41 offen lds
s_mov_b32 m0, 54272
s_add_u32 s41, s40, 129024
buffer_load_dwordx4 v2, s[8:11], s41 offen lds
s_mov_b32 m0, 55296
s_add_u32 s41, s40, 143360
buffer_load_dwordx4 v2, s[8:11], s41 offen lds
s_mov_b32 m0, 56320
s_add_u32 s41, s40, 157696
buffer_load_dwordx4 v2, s[8:11], s41 offen lds
s_mov_b32 m0, 57344
s_add_u32 s41, s40, 172032
buffer_load_dwordx4 v2, s[8:11], s41 offen lds
s_mov_b32 m0, 58368
s_add_u32 s41, s40, 186368
buffer_load_dwordx4 v2, s[8:11], s41 offen lds
s_mov_b32 m0, 59392
s_add_u32 s41, s40, 200704
buffer_load_dwordx4 v2, s[8:11], s41 offen lds
s_mov_b32 m0, 60416
s_add_u32 s41, s40, 215040
buffer_load_dwordx4 v2, s[8:11], s41 offen lds
s_mov_b32 m0, 61440
s_add_u32 s41, s40, 229376
buffer_load_dwordx4 v2, s[8:11], s41 offen lds
s_mov_b32 m0, 62464
s_add_u32 s41, s40, 243712
buffer_load_dwordx4 v2, s[8:11], s41 offen lds
s_mov_b32 m0, 63488
s_add_u32 s41, s40, 258048
buffer_load_dwordx4 v2, s[8:11], s41 offen lds
s_mov_b32 m0, 64512
s_add_u32 s41, s40, 272384
buffer_load_dwordx4 v2, s[8:11], s41 offen lds
s_mov_b32 m0, 65536
s_add_u32 s41, s40, 286720
buffer_load_dwordx4 v2, s[8:11], s41 offen lds
s_mov_b32 m0, 66560
s_add_u32 s41, s40, 301056
buffer_load_dwordx4 v2, s[8:11], s41 offen lds
s_mov_b32 m0, 67584
s_add_u32 s41, s40, 315392
buffer_load_dwordx4 v2, s[8:11], s41 offen lds
s_mov_b32 m0, 68608
s_add_u32 s41, s40, 329728
buffer_load_dwordx4 v2, s[8:11], s41 offen lds
s_mov_b32 m0, 69632
s_add_u32 s41, s40, 344064
buffer_load_dwordx4 v2, s[8:11], s41 offen lds
s_mov_b32 m0, 70656
s_add_u32 s41, s40, 358400
buffer_load_dwordx4 v2, s[8:11], s41 offen lds
s_mov_b32 m0, 71680
s_add_u32 s41, s40, 372736
buffer_load_dwordx4 v2, s[8:11], s41 offen lds
s_mov_b32 m0, 72704
s_add_u32 s41, s40, 387072
buffer_load_dwordx4 v2, s[8:11], s41 offen lds
s_waitcnt vmcnt(0)
ds_read_b64_tr_b16 a[0:1], v3
ds_read_b64_tr_b16 a[2:3], v3 offset:256
ds_read_b64_tr_b16 a[4:5], v3 offset:32
ds_read_b64_tr_b16 a[6:7], v3 offset:288
ds_read_b64_tr_b16 a[8:9], v3 offset:2048
ds_read_b64_tr_b16 a[10:11], v3 offset:2304
ds_read_b64_tr_b16 a[12:13], v3 offset:2080
ds_read_b64_tr_b16 a[14:15], v3 offset:2336
ds_read_b64_tr_b16 a[16:17], v3 offset:4096
ds_read_b64_tr_b16 a[18:19], v3 offset:4352
ds_read_b64_tr_b16 a[20:21], v3 offset:4128
ds_read_b64_tr_b16 a[22:23], v3 offset:4384
s_waitcnt lgkmcnt(0)
ds_read_b64_tr_b16 a[24:25], v3 offset:6144
ds_read_b64_tr_b16 a[26:27], v3 offset:6400
ds_read_b64_tr_b16 a[28:29], v3 offset:6176
ds_read_b64_tr_b16 a[30:31], v3 offset:6432
ds_read_b64_tr_b16 a[32:33], v3 offset:8192
ds_read_b64_tr_b16 a[34:35], v3 offset:8448
ds_read_b64_tr_b16 a[36:37], v3 offset:8224
ds_read_b64_tr_b16 a[38:39], v3 offset:8480
ds_read_b64_tr_b16 a[40:41], v3 offset:10240
ds_read_b64_tr_b16 a[42:43], v3 offset:10496
ds_read_b64_tr_b16 a[44:45], v3 offset:10272
ds_read_b64_tr_b16 a[46:47], v3 offset:10528
s_waitcnt lgkmcnt(0)
ds_read_b64_tr_b16 a[48:49], v3 offset:12288
ds_read_b64_tr_b16 a[50:51], v3 offset:12544
ds_read_b64_tr_b16 a[52:53], v3 offset:12320
ds_read_b64_tr_b16 a[54:55], v3 offset:12576
ds_read_b64_tr_b16 a[56:57], v3 offset:14336
ds_read_b64_tr_b16 a[58:59], v3 offset:14592
ds_read_b64_tr_b16 a[60:61], v3 offset:14368
ds_read_b64_tr_b16 a[62:63], v3 offset:14624
ds_read_b64_tr_b16 a[64:65], v3 offset:16384
ds_read_b64_tr_b16 a[66:67], v3 offset:16640
ds_read_b64_tr_b16 a[68:69], v3 offset:16416
ds_read_b64_tr_b16 a[70:71], v3 offset:16672
s_waitcnt lgkmcnt(0)
ds_read_b64_tr_b16 a[72:73], v3 offset:18432
ds_read_b64_tr_b16 a[74:75], v3 offset:18688
ds_read_b64_tr_b16 a[76:77], v3 offset:18464
ds_read_b64_tr_b16 a[78:79], v3 offset:18720
ds_read_b64_tr_b16 a[80:81], v3 offset:20480
ds_read_b64_tr_b16 a[82:83], v3 offset:20736
ds_read_b64_tr_b16 a[84:85], v3 offset:20512
ds_read_b64_tr_b16 a[86:87], v3 offset:20768
ds_read_b64_tr_b16 a[88:89], v3 offset:22528
ds_read_b64_tr_b16 a[90:91], v3 offset:22784
ds_read_b64_tr_b16 a[92:93], v3 offset:22560
ds_read_b64_tr_b16 a[94:95], v3 offset:22816
s_waitcnt lgkmcnt(0)
ds_read_b64_tr_b16 a[96:97], v3 offset:24576
ds_read_b64_tr_b16 a[98:99], v3 offset:24832
ds_read_b64_tr_b16 a[100:101], v3 offset:24608
ds_read_b64_tr_b16 a[102:103], v3 offset:24864
ds_read_b64_tr_b16 a[104:105], v3 offset:26624
ds_read_b64_tr_b16 a[106:107], v3 offset:26880
ds_read_b64_tr_b16 a[108:109], v3 offset:26656
ds_read_b64_tr_b16 a[110:111], v3 offset:26912
s_waitcnt lgkmcnt(0)
v_lshlrev_b32 v12, 16, v11
v_and_b32 v13, 0xffff0000, v11
s_mul_i32 s26, s21, 57344
s_add_u32 s26, s26, 22738944
s_mul_i32 s27, s21, 224
s_add_u32 s27, s27, 143416
s_mul_i32 s29, s21, 14336
s_lshl_b32 s40, s22, 10
s_add_u32 s28, s29, s40
s_add_u32 s28, s28, 4370432
s_lshl_b32 s40, s22, 6
s_add_u32 s29, s29, s40
s_mov_b32 s25, s21
s_lshl_b32 s30, s22, 10
s_add_u32 s30, s30, 344064
v_and_b32 v80, 7, v0
v_lshlrev_b32 v80, 7, v80
v_min_u32 v14, 47, v0
v_and_b32 v9, 3, v14
v_lshlrev_b32 v9, 3, v9
v_lshrrev_b32 v14, 2, v14
v_lshl_add_u32 v9, v14, 7, v9
s_mov_b32 s43, 6144
Llz_323:
buffer_load_dwordx2 v[14:15], v9, s[4:7], s43 offen sc1
s_waitcnt vmcnt(0)
v_cmp_ne_u32 vcc, s88, v14
v_cmp_ne_u32 s[40:41], s88, v15
s_or_b64 vcc, vcc, s[40:41]
s_cbranch_vccz Llzok_324
s_sleep 8
s_sub_u32 s24, s24, 1
s_cbranch_scc0 Llz_323
s_endpgm
Llzok_324:
F2_JOB1:
s_barrier
Ljob_325:
buffer_load_dword v11, v7, s[4:7], s28 offen sc1
buffer_load_dword v9, v4, s[4:7], s27 offen sc1
s_sub_u32 s24, s24, 1
s_cbranch_scc1 CODE_END
s_waitcnt vmcnt(0)
v_cmp_eq_u32 s[40:41], -1, v11
v_cmp_ne_u32 vcc, s88, v9
s_or_b64 vcc, vcc, s[40:41]
s_cbranch_scc1 Ljob_325
s_mov_b32 s40, s26
buffer_load_dwordx4 v[16:19], v1, s[4:7], s40 offen sc1
buffer_load_dwordx4 v[20:23], v1, s[4:7], s40 offen offset:1024 sc1
buffer_load_dwordx4 v[24:27], v1, s[4:7], s40 offen offset:2048 sc1
buffer_load_dwordx4 v[28:31], v1, s[4:7], s40 offen offset:3072 sc1
s_add_u32 s40, s40, 4096
buffer_load_dwordx4 v[32:35], v1, s[4:7], s40 offen sc1
buffer_load_dwordx4 v[36:39], v1, s[4:7], s40 offen offset:1024 sc1
buffer_load_dwordx4 v[40:43], v1, s[4:7], s40 offen offset:2048 sc1
buffer_load_dwordx4 v[44:47], v1, s[4:7], s40 offen offset:3072 sc1
s_add_u32 s40, s40, 4096
buffer_load_dwordx4 v[48:51], v1, s[4:7], s40 offen sc1
buffer_load_dwordx4 v[52:55], v1, s[4:7], s40 offen offset:1024 sc1
buffer_load_dwordx4 v[56:59], v1, s[4:7], s40 offen offset:2048 sc1
buffer_load_dwordx4 v[60:63], v1, s[4:7], s40 offen offset:3072 sc1
s_add_u32 s40, s40, 4096
buffer_load_dwordx4 v[64:67], v1, s[4:7], s40 offen sc1
buffer_load_dwordx4 v[68:71], v1, s[4:7], s40 offen offset:1024 sc1
v_lshlrev_b32 v14, 16, v11
v_and_b32 v15, 0xffff0000, v11
s_waitcnt vmcnt(13)
v_mfma_f32_16x16x32_bf16 v[72:75], a[0:3], v[16:19], 0
v_mfma_f32_16x16x32_bf16 v[76:79], a[4:7], v[16:19], 0
s_waitcnt vmcnt(12)
v_mfma_f32_16x16x32_bf16 v[72:75], a[8:11], v[20:23], v[72:75]
v_mfma_f32_16x16x32_bf16 v[76:79], a[12:15], v[20:23], v[76:79]
s_waitcnt vmcnt(11)
v_mfma_f32_16x16x32_bf16 v[72:75], a[16:19], v[24:27], v[72:75]
v_mfma_f32_16x16x32_bf16 v[76:79], a[20:23], v[24:27], v[76:79]
s_waitcnt vmcnt(10)
v_mfma_f32_16x16x32_bf16 v[72:75], a[24:27], v[28:31], v[72:75]
v_mfma_f32_16x16x32_bf16 v[76:79], a[28:31], v[28:31], v[76:79]
s_waitcnt vmcnt(9)
v_mfma_f32_16x16x32_bf16 v[72:75], a[32:35], v[32:35], v[72:75]
v_mfma_f32_16x16x32_bf16 v[76:79], a[36:39], v[32:35], v[76:79]
s_waitcnt vmcnt(8)
v_mfma_f32_16x16x32_bf16 v[72:75], a[40:43], v[36:39], v[72:75]
v_mfma_f32_16x16x32_bf16 v[76:79], a[44:47], v[36:39], v[76:79]
s_waitcnt vmcnt(7)
v_mfma_f32_16x16x32_bf16 v[72:75], a[48:51], v[40:43], v[72:75]
v_mfma_f32_16x16x32_bf16 v[76:79], a[52:55], v[40:43], v[76:79]
s_waitcnt vmcnt(6)
v_mfma_f32_16x16x32_bf16 v[72:75], a[56:59], v[44:47], v[72:75]
v_mfma_f32_16x16x32_bf16 v[76:79], a[60:63], v[44:47], v[76:79]
s_waitcnt vmcnt(5)
v_mfma_f32_16x16x32_bf16 v[72:75], a[64:67], v[48:51], v[72:75]
v_mfma_f32_16x16x32_bf16 v[76:79], a[68:71], v[48:51], v[76:79]
s_waitcnt vmcnt(4)
v_mfma_f32_16x16x32_bf16 v[72:75], a[72:75], v[52:55], v[72:75]
v_mfma_f32_16x16x32_bf16 v[76:79], a[76:79], v[52:55], v[76:79]
s_waitcnt vmcnt(3)
v_mfma_f32_16x16x32_bf16 v[72:75], a[80:83], v[56:59], v[72:75]
v_mfma_f32_16x16x32_bf16 v[76:79], a[84:87], v[56:59], v[76:79]
s_waitcnt vmcnt(2)
v_mfma_f32_16x16x32_bf16 v[72:75], a[88:91], v[60:63], v[72:75]
v_mfma_f32_16x16x32_bf16 v[76:79], a[92:95], v[60:63], v[76:79]
s_waitcnt vmcnt(1)
v_mfma_f32_16x16x32_bf16 v[72:75], a[96:99], v[64:67], v[72:75]
v_mfma_f32_16x16x32_bf16 v[76:79], a[100:103], v[64:67], v[76:79]
s_waitcnt vmcnt(0)
v_mfma_f32_16x16x32_bf16 v[72:75], a[104:107], v[68:71], v[72:75]
v_mfma_f32_16x16x32_bf16 v[76:79], a[108:111], v[68:71], v[76:79]
s_nop 6
ds_write_b128 v5, v[72:75]
ds_write_b128 v5, v[76:79] offset:64
s_waitcnt lgkmcnt(0)
s_barrier
ds_read_b64 v[72:73], v6
ds_read_b64 v[74:75], v6 offset:2304
ds_read_b64 v[76:77], v6 offset:4608
ds_read_b64 v[78:79], v6 offset:6912
s_waitcnt lgkmcnt(0)
v_pk_add_f32 v[72:73], v[72:73], v[74:75]
v_pk_add_f32 v[76:77], v[76:77], v[78:79]
v_pk_add_f32 v[72:73], v[72:73], v[12:13]
v_pk_add_f32 v[72:73], v[72:73], v[76:77]
v_cvt_pk_bf16_f32 v73, v72, v73
v_lshlrev_b32 v72, 16, v73
v_and_b32 v73, 0xffff0000, v73
v_pk_add_f32 v[72:73], v[72:73], v[14:15]
v_cvt_pk_bf16_f32 v72, v72, v73
buffer_store_dword v72, v8, s[12:15], s29 offen
s_add_u32 s40, s26, s30
buffer_load_dword v10, v80, s[4:7], s40 offen sc1
s_add_u32 s26, s26, 172032
s_add_u32 s27, s27, 672
s_add_u32 s28, s28, 43008
s_add_u32 s29, s29, 43008
s_add_u32 s25, s25, 3
s_cmp_lt_u32 s25, 128
s_cbranch_scc1 F2_JOB1
s_endpgm
F2_W2:
s_load_dwordx2 s[8:9], s[0:1], 80
s_mov_b32 s10, 1605632
s_mov_b32 s11, 0x00020000
s_load_dwordx2 s[16:17], s[0:1], 88
s_mov_b32 s18, 896
s_mov_b32 s19, 0x00020000
s_load_dwordx2 s[12:13], s[0:1], 96
s_mov_b32 s14, 1835008
s_mov_b32 s15, 0x00020000
s_sub_u32 s22, s22, 14
v_lshlrev_b32 v1, 4, v0
v_lshrrev_b32 v9, 2, v0
v_mul_u32_u24 v2, 896, v9
v_and_b32 v10, 3, v0
v_lshl_add_u32 v2, v10, 4, v2
v_lshrrev_b32 v3, 4, v0
v_lshlrev_b32 v3, 3, v3
v_and_b32 v9, 3, v9
v_add_u32 v3, v3, v9
v_lshlrev_b32 v3, 6, v3
v_lshl_add_u32 v3, v10, 3, v3
v_add_u32 v3, 73728, v3
v_min_u32 v4, 13, v0
v_lshlrev_b32 v4, 2, v4
v_and_b32 v9, 15, v0
v_lshrrev_b32 v10, 4, v0
v_mul_u32_u24 v5, 144, v9
v_lshl_add_u32 v5, v10, 4, v5
v_add_u32 v5, 4608, v5
v_add_u32 v10, 8, v10
v_mul_u32_u24 v6, 144, v10
v_lshl_add_u32 v6, v9, 3, v6
v_mul_u32_u24 v8, 896, v10
v_lshl_add_u32 v8, v9, 2, v8
v_lshlrev_b32 v7, 4, v10
v_lshrrev_b32 v10, 2, v9
v_lshl_add_u32 v7, v10, 8, v7
v_and_b32 v10, 3, v9
v_lshl_add_u32 v7, v10, 2, v7
v_lshlrev_b32 v9, 2, v9
s_lshl_b32 s40, s22, 6
s_waitcnt lgkmcnt(0)
buffer_load_dword v11, v9, s[16:19], s40 offen
s_add_u32 s40, s40, 802816
s_mov_b32 m0, 73728
s_add_u32 s41, s40, 0
buffer_load_dwordx4 v2, s[8:11], s41 offen lds
s_mov_b32 m0, 74752
s_add_u32 s41, s40, 14336
buffer_load_dwordx4 v2, s[8:11], s41 offen lds
s_mov_b32 m0, 75776
s_add_u32 s41, s40, 28672
buffer_load_dwordx4 v2, s[8:11], s41 offen lds
s_mov_b32 m0, 76800
s_add_u32 s41, s40, 43008
buffer_load_dwordx4 v2, s[8:11], s41 offen lds
s_mov_b32 m0, 77824
s_add_u32 s41, s40, 57344
buffer_load_dwordx4 v2, s[8:11], s41 offen lds
s_mov_b32 m0, 78848
s_add_u32 s41, s40, 71680
buffer_load_dwordx4 v2, s[8:11], s41 offen lds
s_mov_b32 m0, 79872
s_add_u32 s41, s40, 86016
buffer_load_dwordx4 v2, s[8:11], s41 offen lds
s_mov_b32 m0, 80896
s_add_u32 s41, s40, 100352
buffer_load_dwordx4 v2, s[8:11], s41 offen lds
s_mov_b32 m0, 81920
s_add_u32 s41, s40, 114688
buffer_load_dwordx4 v2, s[8:11], s41 offen lds
s_mov_b32 m0, 82944
s_add_u32 s41, s40, 129024
buffer_load_dwordx4 v2, s[8:11], s41 offen lds
s_mov_b32 m0, 83968
s_add_u32 s41, s40, 143360
buffer_load_dwordx4 v2, s[8:11], s41 offen lds
s_mov_b32 m0, 84992
s_add_u32 s41, s40, 157696
buffer_load_dwordx4 v2, s[8:11], s41 offen lds
s_mov_b32 m0, 86016
s_add_u32 s41, s40, 172032
buffer_load_dwordx4 v2, s[8:11], s41 offen lds
s_mov_b32 m0, 87040
s_add_u32 s41, s40, 186368
buffer_load_dwordx4 v2, s[8:11], s41 offen lds
s_mov_b32 m0, 88064
s_add_u32 s41, s40, 200704
buffer_load_dwordx4 v2, s[8:11], s41 offen lds
s_mov_b32 m0, 89088
s_add_u32 s41, s40, 215040
buffer_load_dwordx4 v2, s[8:11], s41 offen lds
s_mov_b32 m0, 90112
s_add_u32 s41, s40, 229376
buffer_load_dwordx4 v2, s[8:11], s41 offen lds
s_mov_b32 m0, 91136
s_add_u32 s41, s40, 243712
buffer_load_dwordx4 v2, s[8:11], s41 offen lds
s_mov_b32 m0, 92160
s_add_u32 s41, s40, 258048
buffer_load_dwordx4 v2, s[8:11], s41 offen lds
s_mov_b32 m0, 93184
s_add_u32 s41, s40, 272384
buffer_load_dwordx4 v2, s[8:11], s41 offen lds
s_mov_b32 m0, 94208
s_add_u32 s41, s40, 286720
buffer_load_dwordx4 v2, s[8:11], s41 offen lds
s_mov_b32 m0, 95232
s_add_u32 s41, s40, 301056
buffer_load_dwordx4 v2, s[8:11], s41 offen lds
s_mov_b32 m0, 96256
s_add_u32 s41, s40, 315392
buffer_load_dwordx4 v2, s[8:11], s41 offen lds
s_mov_b32 m0, 97280
s_add_u32 s41, s40, 329728
buffer_load_dwordx4 v2, s[8:11], s41 offen lds
s_mov_b32 m0, 98304
s_add_u32 s41, s40, 344064
buffer_load_dwordx4 v2, s[8:11], s41 offen lds
s_mov_b32 m0, 99328
s_add_u32 s41, s40, 358400
buffer_load_dwordx4 v2, s[8:11], s41 offen lds
s_mov_b32 m0, 100352
s_add_u32 s41, s40, 372736
buffer_load_dwordx4 v2, s[8:11], s41 offen lds
s_mov_b32 m0, 101376
s_add_u32 s41, s40, 387072
buffer_load_dwordx4 v2, s[8:11], s41 offen lds
s_waitcnt vmcnt(0)
ds_read_b64_tr_b16 a[0:1], v3
ds_read_b64_tr_b16 a[2:3], v3 offset:256
ds_read_b64_tr_b16 a[4:5], v3 offset:32
ds_read_b64_tr_b16 a[6:7], v3 offset:288
ds_read_b64_tr_b16 a[8:9], v3 offset:2048
ds_read_b64_tr_b16 a[10:11], v3 offset:2304
ds_read_b64_tr_b16 a[12:13], v3 offset:2080
ds_read_b64_tr_b16 a[14:15], v3 offset:2336
ds_read_b64_tr_b16 a[16:17], v3 offset:4096
ds_read_b64_tr_b16 a[18:19], v3 offset:4352
ds_read_b64_tr_b16 a[20:21], v3 offset:4128
ds_read_b64_tr_b16 a[22:23], v3 offset:4384
s_waitcnt lgkmcnt(0)
ds_read_b64_tr_b16 a[24:25], v3 offset:6144
ds_read_b64_tr_b16 a[26:27], v3 offset:6400
ds_read_b64_tr_b16 a[28:29], v3 offset:6176
ds_read_b64_tr_b16 a[30:31], v3 offset:6432
ds_read_b64_tr_b16 a[32:33], v3 offset:8192
ds_read_b64_tr_b16 a[34:35], v3 offset:8448
ds_read_b64_tr_b16 a[36:37], v3 offset:8224
ds_read_b64_tr_b16 a[38:39], v3 offset:8480
ds_read_b64_tr_b16 a[40:41], v3 offset:10240
ds_read_b64_tr_b16 a[42:43], v3 offset:10496
ds_read_b64_tr_b16 a[44:45], v3 offset:10272
ds_read_b64_tr_b16 a[46:47], v3 offset:10528
s_waitcnt lgkmcnt(0)
ds_read_b64_tr_b16 a[48:49], v3 offset:12288
ds_read_b64_tr_b16 a[50:51], v3 offset:12544
ds_read_b64_tr_b16 a[52:53], v3 offset:12320
ds_read_b64_tr_b16 a[54:55], v3 offset:12576
ds_read_b64_tr_b16 a[56:57], v3 offset:14336
ds_read_b64_tr_b16 a[58:59], v3 offset:14592
ds_read_b64_tr_b16 a[60:61], v3 offset:14368
ds_read_b64_tr_b16 a[62:63], v3 offset:14624
ds_read_b64_tr_b16 a[64:65], v3 offset:16384
ds_read_b64_tr_b16 a[66:67], v3 offset:16640
ds_read_b64_tr_b16 a[68:69], v3 offset:16416
ds_read_b64_tr_b16 a[70:71], v3 offset:16672
s_waitcnt lgkmcnt(0)
ds_read_b64_tr_b16 a[72:73], v3 offset:18432
ds_read_b64_tr_b16 a[74:75], v3 offset:18688
ds_read_b64_tr_b16 a[76:77], v3 offset:18464
ds_read_b64_tr_b16 a[78:79], v3 offset:18720
ds_read_b64_tr_b16 a[80:81], v3 offset:20480
ds_read_b64_tr_b16 a[82:83], v3 offset:20736
ds_read_b64_tr_b16 a[84:85], v3 offset:20512
ds_read_b64_tr_b16 a[86:87], v3 offset:20768
ds_read_b64_tr_b16 a[88:89], v3 offset:22528
ds_read_b64_tr_b16 a[90:91], v3 offset:22784
ds_read_b64_tr_b16 a[92:93], v3 offset:22560
ds_read_b64_tr_b16 a[94:95], v3 offset:22816
s_waitcnt lgkmcnt(0)
ds_read_b64_tr_b16 a[96:97], v3 offset:24576
ds_read_b64_tr_b16 a[98:99], v3 offset:24832
ds_read_b64_tr_b16 a[100:101], v3 offset:24608
ds_read_b64_tr_b16 a[102:103], v3 offset:24864
ds_read_b64_tr_b16 a[104:105], v3 offset:26624
ds_read_b64_tr_b16 a[106:107], v3 offset:26880
ds_read_b64_tr_b16 a[108:109], v3 offset:26656
ds_read_b64_tr_b16 a[110:111], v3 offset:26912
s_waitcnt lgkmcnt(0)
v_lshlrev_b32 v12, 16, v11
v_and_b32 v13, 0xffff0000, v11
s_mul_i32 s26, s21, 57344
s_add_u32 s26, s26, 22753280
s_mul_i32 s27, s21, 224
s_add_u32 s27, s27, 143472
s_mul_i32 s29, s21, 14336
s_lshl_b32 s40, s22, 10
s_add_u32 s28, s29, s40
s_add_u32 s28, s28, 4370432
s_lshl_b32 s40, s22, 6
s_add_u32 s29, s29, s40
s_mov_b32 s25, s21
s_lshl_b32 s30, s22, 10
s_add_u32 s30, s30, 344064
v_and_b32 v80, 7, v0
v_lshlrev_b32 v80, 7, v80
v_min_u32 v14, 47, v0
v_and_b32 v9, 3, v14
v_lshlrev_b32 v9, 3, v9
v_lshrrev_b32 v14, 2, v14
v_lshl_add_u32 v9, v14, 7, v9
s_mov_b32 s43, 6144
Llz_326:
buffer_load_dwordx2 v[14:15], v9, s[4:7], s43 offen sc1
s_waitcnt vmcnt(0)
v_cmp_ne_u32 vcc, s88, v14
v_cmp_ne_u32 s[40:41], s88, v15
s_or_b64 vcc, vcc, s[40:41]
s_cbranch_vccz Llzok_327
s_sleep 8
s_sub_u32 s24, s24, 1
s_cbranch_scc0 Llz_326
s_endpgm
Llzok_327:
F2_JOB2:
s_barrier
Ljob_328:
buffer_load_dword v11, v7, s[4:7], s28 offen sc1
buffer_load_dword v9, v4, s[4:7], s27 offen sc1
s_sub_u32 s24, s24, 1
s_cbranch_scc1 CODE_END
s_waitcnt vmcnt(0)
v_cmp_eq_u32 s[40:41], -1, v11
v_cmp_ne_u32 vcc, s88, v9
s_or_b64 vcc, vcc, s[40:41]
s_cbranch_scc1 Ljob_328
s_mov_b32 s40, s26
buffer_load_dwordx4 v[16:19], v1, s[4:7], s40 offen sc1
buffer_load_dwordx4 v[20:23], v1, s[4:7], s40 offen offset:1024 sc1
buffer_load_dwordx4 v[24:27], v1, s[4:7], s40 offen offset:2048 sc1
buffer_load_dwordx4 v[28:31], v1, s[4:7], s40 offen offset:3072 sc1
s_add_u32 s40, s40, 4096
buffer_load_dwordx4 v[32:35], v1, s[4:7], s40 offen sc1
buffer_load_dwordx4 v[36:39], v1, s[4:7], s40 offen offset:1024 sc1
buffer_load_dwordx4 v[40:43], v1, s[4:7], s40 offen offset:2048 sc1
buffer_load_dwordx4 v[44:47], v1, s[4:7], s40 offen offset:3072 sc1
s_add_u32 s40, s40, 4096
buffer_load_dwordx4 v[48:51], v1, s[4:7], s40 offen sc1
buffer_load_dwordx4 v[52:55], v1, s[4:7], s40 offen offset:1024 sc1
buffer_load_dwordx4 v[56:59], v1, s[4:7], s40 offen offset:2048 sc1
buffer_load_dwordx4 v[60:63], v1, s[4:7], s40 offen offset:3072 sc1
s_add_u32 s40, s40, 4096
buffer_load_dwordx4 v[64:67], v1, s[4:7], s40 offen sc1
buffer_load_dwordx4 v[68:71], v1, s[4:7], s40 offen offset:1024 sc1
v_lshlrev_b32 v14, 16, v11
v_and_b32 v15, 0xffff0000, v11
s_waitcnt vmcnt(13)
v_mfma_f32_16x16x32_bf16 v[72:75], a[0:3], v[16:19], 0
v_mfma_f32_16x16x32_bf16 v[76:79], a[4:7], v[16:19], 0
s_waitcnt vmcnt(12)
v_mfma_f32_16x16x32_bf16 v[72:75], a[8:11], v[20:23], v[72:75]
v_mfma_f32_16x16x32_bf16 v[76:79], a[12:15], v[20:23], v[76:79]
s_waitcnt vmcnt(11)
v_mfma_f32_16x16x32_bf16 v[72:75], a[16:19], v[24:27], v[72:75]
v_mfma_f32_16x16x32_bf16 v[76:79], a[20:23], v[24:27], v[76:79]
s_waitcnt vmcnt(10)
v_mfma_f32_16x16x32_bf16 v[72:75], a[24:27], v[28:31], v[72:75]
v_mfma_f32_16x16x32_bf16 v[76:79], a[28:31], v[28:31], v[76:79]
s_waitcnt vmcnt(9)
v_mfma_f32_16x16x32_bf16 v[72:75], a[32:35], v[32:35], v[72:75]
v_mfma_f32_16x16x32_bf16 v[76:79], a[36:39], v[32:35], v[76:79]
s_waitcnt vmcnt(8)
v_mfma_f32_16x16x32_bf16 v[72:75], a[40:43], v[36:39], v[72:75]
v_mfma_f32_16x16x32_bf16 v[76:79], a[44:47], v[36:39], v[76:79]
s_waitcnt vmcnt(7)
v_mfma_f32_16x16x32_bf16 v[72:75], a[48:51], v[40:43], v[72:75]
v_mfma_f32_16x16x32_bf16 v[76:79], a[52:55], v[40:43], v[76:79]
s_waitcnt vmcnt(6)
v_mfma_f32_16x16x32_bf16 v[72:75], a[56:59], v[44:47], v[72:75]
v_mfma_f32_16x16x32_bf16 v[76:79], a[60:63], v[44:47], v[76:79]
s_waitcnt vmcnt(5)
v_mfma_f32_16x16x32_bf16 v[72:75], a[64:67], v[48:51], v[72:75]
v_mfma_f32_16x16x32_bf16 v[76:79], a[68:71], v[48:51], v[76:79]
s_waitcnt vmcnt(4)
v_mfma_f32_16x16x32_bf16 v[72:75], a[72:75], v[52:55], v[72:75]
v_mfma_f32_16x16x32_bf16 v[76:79], a[76:79], v[52:55], v[76:79]
s_waitcnt vmcnt(3)
v_mfma_f32_16x16x32_bf16 v[72:75], a[80:83], v[56:59], v[72:75]
v_mfma_f32_16x16x32_bf16 v[76:79], a[84:87], v[56:59], v[76:79]
s_waitcnt vmcnt(2)
v_mfma_f32_16x16x32_bf16 v[72:75], a[88:91], v[60:63], v[72:75]
v_mfma_f32_16x16x32_bf16 v[76:79], a[92:95], v[60:63], v[76:79]
s_waitcnt vmcnt(1)
v_mfma_f32_16x16x32_bf16 v[72:75], a[96:99], v[64:67], v[72:75]
v_mfma_f32_16x16x32_bf16 v[76:79], a[100:103], v[64:67], v[76:79]
s_waitcnt vmcnt(0)
v_mfma_f32_16x16x32_bf16 v[72:75], a[104:107], v[68:71], v[72:75]
v_mfma_f32_16x16x32_bf16 v[76:79], a[108:111], v[68:71], v[76:79]
s_nop 6
ds_write_b128 v5, v[72:75]
ds_write_b128 v5, v[76:79] offset:64
s_waitcnt lgkmcnt(0)
s_barrier
ds_read_b64 v[72:73], v6
ds_read_b64 v[74:75], v6 offset:2304
ds_read_b64 v[76:77], v6 offset:4608
ds_read_b64 v[78:79], v6 offset:6912
s_waitcnt lgkmcnt(0)
v_pk_add_f32 v[72:73], v[72:73], v[74:75]
v_pk_add_f32 v[76:77], v[76:77], v[78:79]
v_pk_add_f32 v[72:73], v[72:73], v[12:13]
v_pk_add_f32 v[72:73], v[72:73], v[76:77]
v_cvt_pk_bf16_f32 v73, v72, v73
v_lshlrev_b32 v72, 16, v73
v_and_b32 v73, 0xffff0000, v73
v_pk_add_f32 v[72:73], v[72:73], v[14:15]
v_cvt_pk_bf16_f32 v72, v72, v73
buffer_store_dword v72, v8, s[12:15], s29 offen
s_add_u32 s40, s26, s30
buffer_load_dword v10, v80, s[4:7], s40 offen sc1
s_add_u32 s26, s26, 172032
s_add_u32 s27, s27, 672
s_add_u32 s28, s28, 43008
s_add_u32 s29, s29, 43008
s_add_u32 s25, s25, 3
s_cmp_lt_u32 s25, 128
s_cbranch_scc1 F2_JOB2
s_endpgm
F2_W3:
s_load_dwordx2 s[8:9], s[0:1], 80
s_mov_b32 s10, 1605632
s_mov_b32 s11, 0x00020000
s_load_dwordx2 s[16:17], s[0:1], 88
s_mov_b32 s18, 896
s_mov_b32 s19, 0x00020000
s_load_dwordx2 s[12:13], s[0:1], 96
s_mov_b32 s14, 1835008
s_mov_b32 s15, 0x00020000
s_sub_u32 s22, s22, 14
v_lshlrev_b32 v1, 4, v0
v_lshrrev_b32 v9, 2, v0
v_mul_u32_u24 v2, 896, v9
v_and_b32 v10, 3, v0
v_lshl_add_u32 v2, v10, 4, v2
v_lshrrev_b32 v3, 4, v0
v_lshlrev_b32 v3, 3, v3
v_and_b32 v9, 3, v9
v_add_u32 v3, v3, v9
v_lshlrev_b32 v3, 6, v3
v_lshl_add_u32 v3, v10, 3, v3
v_add_u32 v3, 102400, v3
v_min_u32 v4, 13, v0
v_lshlrev_b32 v4, 2, v4
v_and_b32 v9, 15, v0
v_lshrrev_b32 v10, 4, v0
v_mul_u32_u24 v5, 144, v9
v_lshl_add_u32 v5, v10, 4, v5
v_add_u32 v5, 6912, v5
v_add_u32 v10, 12, v10
v_mul_u32_u24 v6, 144, v10
v_lshl_add_u32 v6, v9, 3, v6
v_mul_u32_u24 v8, 896, v10
v_lshl_add_u32 v8, v9, 2, v8
v_lshlrev_b32 v7, 4, v10
v_lshrrev_b32 v10, 2, v9
v_lshl_add_u32 v7, v10, 8, v7
v_and_b32 v10, 3, v9
v_lshl_add_u32 v7, v10, 2, v7
v_lshlrev_b32 v9, 2, v9
s_lshl_b32 s40, s22, 6
s_waitcnt lgkmcnt(0)
buffer_load_dword v11, v9, s[16:19], s40 offen
s_add_u32 s40, s40, 1204224
s_mov_b32 m0, 102400
s_add_u32 s41, s40, 0
buffer_load_dwordx4 v2, s[8:11], s41 offen lds
s_mov_b32 m0, 103424
s_add_u32 s41, s40, 14336
buffer_load_dwordx4 v2, s[8:11], s41 offen lds
s_mov_b32 m0, 104448
s_add_u32 s41, s40, 28672
buffer_load_dwordx4 v2, s[8:11], s41 offen lds
s_mov_b32 m0, 105472
s_add_u32 s41, s40, 43008
buffer_load_dwordx4 v2, s[8:11], s41 offen lds
s_mov_b32 m0, 106496
s_add_u32 s41, s40, 57344
buffer_load_dwordx4 v2, s[8:11], s41 offen lds
s_mov_b32 m0, 107520
s_add_u32 s41, s40, 71680
buffer_load_dwordx4 v2, s[8:11], s41 offen lds
s_mov_b32 m0, 108544
s_add_u32 s41, s40, 86016
buffer_load_dwordx4 v2, s[8:11], s41 offen lds
s_mov_b32 m0, 109568
s_add_u32 s41, s40, 100352
buffer_load_dwordx4 v2, s[8:11], s41 offen lds
s_mov_b32 m0, 110592
s_add_u32 s41, s40, 114688
buffer_load_dwordx4 v2, s[8:11], s41 offen lds
s_mov_b32 m0, 111616
s_add_u32 s41, s40, 129024
buffer_load_dwordx4 v2, s[8:11], s41 offen lds
s_mov_b32 m0, 112640
s_add_u32 s41, s40, 143360
buffer_load_dwordx4 v2, s[8:11], s41 offen lds
s_mov_b32 m0, 113664
s_add_u32 s41, s40, 157696
buffer_load_dwordx4 v2, s[8:11], s41 offen lds
s_mov_b32 m0, 114688
s_add_u32 s41, s40, 172032
buffer_load_dwordx4 v2, s[8:11], s41 offen lds
s_mov_b32 m0, 115712
s_add_u32 s41, s40, 186368
buffer_load_dwordx4 v2, s[8:11], s41 offen lds
s_mov_b32 m0, 116736
s_add_u32 s41, s40, 200704
buffer_load_dwordx4 v2, s[8:11], s41 offen lds
s_mov_b32 m0, 117760
s_add_u32 s41, s40, 215040
buffer_load_dwordx4 v2, s[8:11], s41 offen lds
s_mov_b32 m0, 118784
s_add_u32 s41, s40, 229376
buffer_load_dwordx4 v2, s[8:11], s41 offen lds
s_mov_b32 m0, 119808
s_add_u32 s41, s40, 243712
buffer_load_dwordx4 v2, s[8:11], s41 offen lds
s_mov_b32 m0, 120832
s_add_u32 s41, s40, 258048
buffer_load_dwordx4 v2, s[8:11], s41 offen lds
s_mov_b32 m0, 121856
s_add_u32 s41, s40, 272384
buffer_load_dwordx4 v2, s[8:11], s41 offen lds
s_mov_b32 m0, 122880
s_add_u32 s41, s40, 286720
buffer_load_dwordx4 v2, s[8:11], s41 offen lds
s_mov_b32 m0, 123904
s_add_u32 s41, s40, 301056
buffer_load_dwordx4 v2, s[8:11], s41 offen lds
s_mov_b32 m0, 124928
s_add_u32 s41, s40, 315392
buffer_load_dwordx4 v2, s[8:11], s41 offen lds
s_mov_b32 m0, 125952
s_add_u32 s41, s40, 329728
buffer_load_dwordx4 v2, s[8:11], s41 offen lds
s_mov_b32 m0, 126976
s_add_u32 s41, s40, 344064
buffer_load_dwordx4 v2, s[8:11], s41 offen lds
s_mov_b32 m0, 128000
s_add_u32 s41, s40, 358400
buffer_load_dwordx4 v2, s[8:11], s41 offen lds
s_mov_b32 m0, 129024
s_add_u32 s41, s40, 372736
buffer_load_dwordx4 v2, s[8:11], s41 offen lds
s_mov_b32 m0, 130048
s_add_u32 s41, s40, 387072
buffer_load_dwordx4 v2, s[8:11], s41 offen lds
s_waitcnt vmcnt(0)
ds_read_b64_tr_b16 a[0:1], v3
ds_read_b64_tr_b16 a[2:3], v3 offset:256
ds_read_b64_tr_b16 a[4:5], v3 offset:32
ds_read_b64_tr_b16 a[6:7], v3 offset:288
ds_read_b64_tr_b16 a[8:9], v3 offset:2048
ds_read_b64_tr_b16 a[10:11], v3 offset:2304
ds_read_b64_tr_b16 a[12:13], v3 offset:2080
ds_read_b64_tr_b16 a[14:15], v3 offset:2336
ds_read_b64_tr_b16 a[16:17], v3 offset:4096
ds_read_b64_tr_b16 a[18:19], v3 offset:4352
ds_read_b64_tr_b16 a[20:21], v3 offset:4128
ds_read_b64_tr_b16 a[22:23], v3 offset:4384
s_waitcnt lgkmcnt(0)
ds_read_b64_tr_b16 a[24:25], v3 offset:6144
ds_read_b64_tr_b16 a[26:27], v3 offset:6400
ds_read_b64_tr_b16 a[28:29], v3 offset:6176
ds_read_b64_tr_b16 a[30:31], v3 offset:6432
ds_read_b64_tr_b16 a[32:33], v3 offset:8192
ds_read_b64_tr_b16 a[34:35], v3 offset:8448
ds_read_b64_tr_b16 a[36:37], v3 offset:8224
ds_read_b64_tr_b16 a[38:39], v3 offset:8480
ds_read_b64_tr_b16 a[40:41], v3 offset:10240
ds_read_b64_tr_b16 a[42:43], v3 offset:10496
ds_read_b64_tr_b16 a[44:45], v3 offset:10272
ds_read_b64_tr_b16 a[46:47], v3 offset:10528
s_waitcnt lgkmcnt(0)
ds_read_b64_tr_b16 a[48:49], v3 offset:12288
ds_read_b64_tr_b16 a[50:51], v3 offset:12544
ds_read_b64_tr_b16 a[52:53], v3 offset:12320
ds_read_b64_tr_b16 a[54:55], v3 offset:12576
ds_read_b64_tr_b16 a[56:57], v3 offset:14336
ds_read_b64_tr_b16 a[58:59], v3 offset:14592
ds_read_b64_tr_b16 a[60:61], v3 offset:14368
ds_read_b64_tr_b16 a[62:63], v3 offset:14624
ds_read_b64_tr_b16 a[64:65], v3 offset:16384
ds_read_b64_tr_b16 a[66:67], v3 offset:16640
ds_read_b64_tr_b16 a[68:69], v3 offset:16416
ds_read_b64_tr_b16 a[70:71], v3 offset:16672
s_waitcnt lgkmcnt(0)
ds_read_b64_tr_b16 a[72:73], v3 offset:18432
ds_read_b64_tr_b16 a[74:75], v3 offset:18688
ds_read_b64_tr_b16 a[76:77], v3 offset:18464
ds_read_b64_tr_b16 a[78:79], v3 offset:18720
ds_read_b64_tr_b16 a[80:81], v3 offset:20480
ds_read_b64_tr_b16 a[82:83], v3 offset:20736
ds_read_b64_tr_b16 a[84:85], v3 offset:20512
ds_read_b64_tr_b16 a[86:87], v3 offset:20768
ds_read_b64_tr_b16 a[88:89], v3 offset:22528
ds_read_b64_tr_b16 a[90:91], v3 offset:22784
ds_read_b64_tr_b16 a[92:93], v3 offset:22560
ds_read_b64_tr_b16 a[94:95], v3 offset:22816
s_waitcnt lgkmcnt(0)
ds_read_b64_tr_b16 a[96:97], v3 offset:24576
ds_read_b64_tr_b16 a[98:99], v3 offset:24832
ds_read_b64_tr_b16 a[100:101], v3 offset:24608
ds_read_b64_tr_b16 a[102:103], v3 offset:24864
ds_read_b64_tr_b16 a[104:105], v3 offset:26624
ds_read_b64_tr_b16 a[106:107], v3 offset:26880
ds_read_b64_tr_b16 a[108:109], v3 offset:26656
ds_read_b64_tr_b16 a[110:111], v3 offset:26912
s_waitcnt lgkmcnt(0)
v_lshlrev_b32 v12, 16, v11
v_and_b32 v13, 0xffff0000, v11
s_mul_i32 s26, s21, 57344
s_add_u32 s26, s26, 22767616
s_mul_i32 s27, s21, 224
s_add_u32 s27, s27, 143528
s_mul_i32 s29, s21, 14336
s_lshl_b32 s40, s22, 10
s_add_u32 s28, s29, s40
s_add_u32 s28, s28, 4370432
s_lshl_b32 s40, s22, 6
s_add_u32 s29, s29, s40
s_mov_b32 s25, s21
s_lshl_b32 s30, s22, 10
s_add_u32 s30, s30, 344064
v_and_b32 v80, 7, v0
v_lshlrev_b32 v80, 7, v80
v_min_u32 v14, 47, v0
v_and_b32 v9, 3, v14
v_lshlrev_b32 v9, 3, v9
v_lshrrev_b32 v14, 2, v14
v_lshl_add_u32 v9, v14, 7, v9
s_mov_b32 s43, 6144
Llz_329:
buffer_load_dwordx2 v[14:15], v9, s[4:7], s43 offen sc1
s_waitcnt vmcnt(0)
v_cmp_ne_u32 vcc, s88, v14
v_cmp_ne_u32 s[40:41], s88, v15
s_or_b64 vcc, vcc, s[40:41]
s_cbranch_vccz Llzok_330
s_sleep 8
s_sub_u32 s24, s24, 1
s_cbranch_scc0 Llz_329
s_endpgm
Llzok_330:
F2_JOB3:
s_barrier
Ljob_331:
buffer_load_dword v11, v7, s[4:7], s28 offen sc1
buffer_load_dword v9, v4, s[4:7], s27 offen sc1
s_sub_u32 s24, s24, 1
s_cbranch_scc1 CODE_END
s_waitcnt vmcnt(0)
v_cmp_eq_u32 s[40:41], -1, v11
v_cmp_ne_u32 vcc, s88, v9
s_or_b64 vcc, vcc, s[40:41]
s_cbranch_scc1 Ljob_331
s_mov_b32 s40, s26
buffer_load_dwordx4 v[16:19], v1, s[4:7], s40 offen sc1
buffer_load_dwordx4 v[20:23], v1, s[4:7], s40 offen offset:1024 sc1
buffer_load_dwordx4 v[24:27], v1, s[4:7], s40 offen offset:2048 sc1
buffer_load_dwordx4 v[28:31], v1, s[4:7], s40 offen offset:3072 sc1
s_add_u32 s40, s40, 4096
buffer_load_dwordx4 v[32:35], v1, s[4:7], s40 offen sc1
buffer_load_dwordx4 v[36:39], v1, s[4:7], s40 offen offset:1024 sc1
buffer_load_dwordx4 v[40:43], v1, s[4:7], s40 offen offset:2048 sc1
buffer_load_dwordx4 v[44:47], v1, s[4:7], s40 offen offset:3072 sc1
s_add_u32 s40, s40, 4096
buffer_load_dwordx4 v[48:51], v1, s[4:7], s40 offen sc1
buffer_load_dwordx4 v[52:55], v1, s[4:7], s40 offen offset:1024 sc1
buffer_load_dwordx4 v[56:59], v1, s[4:7], s40 offen offset:2048 sc1
buffer_load_dwordx4 v[60:63], v1, s[4:7], s40 offen offset:3072 sc1
s_add_u32 s40, s40, 4096
buffer_load_dwordx4 v[64:67], v1, s[4:7], s40 offen sc1
buffer_load_dwordx4 v[68:71], v1, s[4:7], s40 offen offset:1024 sc1
v_lshlrev_b32 v14, 16, v11
v_and_b32 v15, 0xffff0000, v11
s_waitcnt vmcnt(13)
v_mfma_f32_16x16x32_bf16 v[72:75], a[0:3], v[16:19], 0
v_mfma_f32_16x16x32_bf16 v[76:79], a[4:7], v[16:19], 0
s_waitcnt vmcnt(12)
v_mfma_f32_16x16x32_bf16 v[72:75], a[8:11], v[20:23], v[72:75]
v_mfma_f32_16x16x32_bf16 v[76:79], a[12:15], v[20:23], v[76:79]
s_waitcnt vmcnt(11)
v_mfma_f32_16x16x32_bf16 v[72:75], a[16:19], v[24:27], v[72:75]
v_mfma_f32_16x16x32_bf16 v[76:79], a[20:23], v[24:27], v[76:79]
s_waitcnt vmcnt(10)
v_mfma_f32_16x16x32_bf16 v[72:75], a[24:27], v[28:31], v[72:75]
v_mfma_f32_16x16x32_bf16 v[76:79], a[28:31], v[28:31], v[76:79]
s_waitcnt vmcnt(9)
v_mfma_f32_16x16x32_bf16 v[72:75], a[32:35], v[32:35], v[72:75]
v_mfma_f32_16x16x32_bf16 v[76:79], a[36:39], v[32:35], v[76:79]
s_waitcnt vmcnt(8)
v_mfma_f32_16x16x32_bf16 v[72:75], a[40:43], v[36:39], v[72:75]
v_mfma_f32_16x16x32_bf16 v[76:79], a[44:47], v[36:39], v[76:79]
s_waitcnt vmcnt(7)
v_mfma_f32_16x16x32_bf16 v[72:75], a[48:51], v[40:43], v[72:75]
v_mfma_f32_16x16x32_bf16 v[76:79], a[52:55], v[40:43], v[76:79]
s_waitcnt vmcnt(6)
v_mfma_f32_16x16x32_bf16 v[72:75], a[56:59], v[44:47], v[72:75]
v_mfma_f32_16x16x32_bf16 v[76:79], a[60:63], v[44:47], v[76:79]
s_waitcnt vmcnt(5)
v_mfma_f32_16x16x32_bf16 v[72:75], a[64:67], v[48:51], v[72:75]
v_mfma_f32_16x16x32_bf16 v[76:79], a[68:71], v[48:51], v[76:79]
s_waitcnt vmcnt(4)
v_mfma_f32_16x16x32_bf16 v[72:75], a[72:75], v[52:55], v[72:75]
v_mfma_f32_16x16x32_bf16 v[76:79], a[76:79], v[52:55], v[76:79]
s_waitcnt vmcnt(3)
v_mfma_f32_16x16x32_bf16 v[72:75], a[80:83], v[56:59], v[72:75]
v_mfma_f32_16x16x32_bf16 v[76:79], a[84:87], v[56:59], v[76:79]
s_waitcnt vmcnt(2)
v_mfma_f32_16x16x32_bf16 v[72:75], a[88:91], v[60:63], v[72:75]
v_mfma_f32_16x16x32_bf16 v[76:79], a[92:95], v[60:63], v[76:79]
s_waitcnt vmcnt(1)
v_mfma_f32_16x16x32_bf16 v[72:75], a[96:99], v[64:67], v[72:75]
v_mfma_f32_16x16x32_bf16 v[76:79], a[100:103], v[64:67], v[76:79]
s_waitcnt vmcnt(0)
v_mfma_f32_16x16x32_bf16 v[72:75], a[104:107], v[68:71], v[72:75]
v_mfma_f32_16x16x32_bf16 v[76:79], a[108:111], v[68:71], v[76:79]
s_nop 6
ds_write_b128 v5, v[72:75]
ds_write_b128 v5, v[76:79] offset:64
s_waitcnt lgkmcnt(0)
s_barrier
ds_read_b64 v[72:73], v6
ds_read_b64 v[74:75], v6 offset:2304
ds_read_b64 v[76:77], v6 offset:4608
ds_read_b64 v[78:79], v6 offset:6912
s_waitcnt lgkmcnt(0)
v_pk_add_f32 v[72:73], v[72:73], v[74:75]
v_pk_add_f32 v[76:77], v[76:77], v[78:79]
v_pk_add_f32 v[72:73], v[72:73], v[12:13]
v_pk_add_f32 v[72:73], v[72:73], v[76:77]
v_cvt_pk_bf16_f32 v73, v72, v73
v_lshlrev_b32 v72, 16, v73
v_and_b32 v73, 0xffff0000, v73
v_pk_add_f32 v[72:73], v[72:73], v[14:15]
v_cvt_pk_bf16_f32 v72, v72, v73
buffer_store_dword v72, v8, s[12:15], s29 offen
s_add_u32 s40, s26, s30
buffer_load_dword v10, v80, s[4:7], s40 offen sc1
s_add_u32 s26, s26, 172032
s_add_u32 s27, s27, 672
s_add_u32 s28, s28, 43008
s_add_u32 s29, s29, 43008
s_add_u32 s25, s25, 3
s_cmp_lt_u32 s25, 128
s_cbranch_scc1 F2_JOB3
s_endpgm
CODE_END:
s_endpgm
.section .rodata,"a"
.p2align 6
.amdhsa_kernel sequential_preLN__memory_aug_recurrent_mem_tr__dense_activation_gelu__prompt_kernel
  .amdhsa_next_free_vgpr 512
  .amdhsa_next_free_sgpr 102
  .amdhsa_accum_offset 256
  .amdhsa_group_segment_fixed_size 0
  .amdhsa_kernarg_size 120
  .amdhsa_user_sgpr_count 2
  .amdhsa_user_sgpr_kernarg_segment_ptr 1
  .amdhsa_system_sgpr_workgroup_id_x 1
  .amdhsa_float_denorm_mode_32 3
.end_amdhsa_kernel
```
